```python
import torch

def _softmax(x, axis=-1):
    return torch.softmax(x, dim=axis)

def _gelu(x):
    return torch.nn.functional.gelu(x, approximate='tanh')

def _silu(x):
    return torch.nn.functional.silu(x)

def _sigmoid(x):
    return torch.sigmoid(x)

def _layernorm(x, axis=-1, eps=1e-05):
    m = x.mean(dim=axis, keepdim=True)
    v = x.var(dim=axis, keepdim=True, unbiased=False)
    return (x - m) / torch.sqrt(v + eps)

def _scatter_add(tgt, idx, src, axis=0):
    return tgt.clone().index_add_(axis, idx, src)

def _segment_sum(src, seg, n):
    out = torch.zeros((n,) + src.shape[1:], dtype=src.dtype)
    return out.index_add_(0, seg, src)

def _pad(x, pw):
    flat = tuple((v for pair in reversed(pw) for v in pair))
    return torch.nn.functional.pad(x, flat)
kernel_name = 'interleave_layers__spectral_gfnet__memory_aug_recurrent_mem_tr__prompt'

def setup_inputs():

    _w = lambda a: (lambda t: t.to(torch.bfloat16) if t.is_floating_point() else t)(torch.as_tensor(a))

    def _A_setup():
        B, S, D = (1, 2048, 640)
        Df = D // 2 + 1
        return {'x': _w((lambda *s: torch.randn(*s, dtype=torch.bfloat16) * 0.05)(B, S, D)), 'w_r': _w((lambda *s: torch.randn(*s, dtype=torch.bfloat16) * 0.4)(S, Df) * 0.02), 'w_i': _w((lambda *s: torch.randn(*s, dtype=torch.bfloat16) * 0.4)(S, Df) * 0.02)}
    _A_in = _A_setup()

    def _B_setup():
        B, S, Dm = (1, 2048, 640)
        H, Dh = (32, 128)
        M, seg = (8, 32)
        seg = min(seg, S)
        S = S // seg * seg
        return {'x': _w((lambda *s: torch.randn(*s, dtype=torch.bfloat16) * 0.05)(B, S, Dm)), 'mem0': _w((lambda *s: torch.randn(*s, dtype=torch.bfloat16) * 0.2)(B, M, Dm)), 'Wq': _w((lambda *s: torch.randn(*s, dtype=torch.bfloat16) * 1.6)(Dm, H, Dh) * Dm ** (-0.5)), 'Wk': _w((lambda *s: torch.randn(*s, dtype=torch.bfloat16) * 1.6)(Dm, H, Dh) * Dm ** (-0.5)), 'Wv': _w((lambda *s: torch.randn(*s, dtype=torch.bfloat16) * 0.2)(Dm, H, Dh) * Dm ** (-0.5)), 'Wo': _w((lambda *s: torch.randn(*s, dtype=torch.bfloat16) * 0.2)(H, Dh, Dm) * (H * Dh) ** (-0.5)), 'seg_len': seg}
    _B_in = _B_setup()
    return {'A_x': _A_in['x'], 'A_w_r': _A_in['w_r'], 'A_w_i': _A_in['w_i'], 'B_x': _B_in['x'], 'B_mem0': _B_in['mem0'], 'B_Wq': _B_in['Wq'], 'B_Wk': _B_in['Wk'], 'B_Wv': _B_in['Wv'], 'B_Wo': _B_in['Wo'], 'B_seg_len': _B_in['seg_len']}

def reference(A_x, A_w_r, A_w_i, B_x, B_mem0, B_Wq, B_Wk, B_Wv, B_Wo, B_seg_len):

    def _A_ref(x, w_r, w_i):
        B, S, D = x.shape
        X = (lambda x, axes=(-2, -1): torch.fft.rfft2(x.float(), dim=axes))(x, axes=(-2, -1))
        W = w_r + 1j * w_i
        X = X * W
        y = (lambda x, s, axes=(-2, -1): torch.fft.irfft2(x, s=s, dim=axes).to(torch.bfloat16))(X, (S, D), axes=(-2, -1))
        return y

    def _B_ref(x, mem0, Wq, Wk, Wv, Wo, seg_len):
        B, S, Dm = x.shape
        H, Dh = (Wq.shape[1], Wq.shape[2])
        M = mem0.shape[1]
        scale = Dh ** (-0.5)
        n_seg = S // seg_len
        L = M + seg_len
        idx = torch.arange(L)
        mask = (idx[:, None] < M) | (idx[:, None] >= idx[None, :])
        mem = mem0
        outs = []
        for s in range(n_seg):
            xs = x[:, s * seg_len:(s + 1) * seg_len, :].clone()
            h = torch.concatenate([mem, xs], axis=1)
            q = torch.einsum('btd,dhe->bhte', h, Wq)
            k = torch.einsum('btd,dhe->bhte', h, Wk)
            v = torch.einsum('btd,dhe->bhte', h, Wv)
            scores = torch.einsum('bhqe,bhke->bhqk', q, k) * scale
            scores = torch.where(mask[None, None], scores, -1000000000.0)
            p = _softmax(scores, axis=-1)
            o = torch.einsum('bhqk,bhke->bhqe', p, v)
            o = torch.einsum('bhte,hed->btd', o, Wo)
            mem = o[:, :M, :].clone()
            outs.append(o[:, M:, :])
        return torch.concatenate(outs, axis=1)
    x = A_x
    x = x + _A_ref(_layernorm(x, axis=-1), A_w_r, A_w_i)
    x = x + _B_ref(_layernorm(x, axis=-1), B_mem0, B_Wq, B_Wk, B_Wv, B_Wo, B_seg_len)
    x = x + _A_ref(_layernorm(x, axis=-1), A_w_r, A_w_i)
    x = x + _B_ref(_layernorm(x, axis=-1), B_mem0, B_Wq, B_Wk, B_Wv, B_Wo, B_seg_len)
    return x
```

```asm
; @launch grid=(256,1,1) block=(256,1,1) lds=163840
.amdgcn_target "amdgcn-amd-amdhsa--gfx950"
.text
.globl interleave_layers__spectral_gfnet__memory_aug_recurrent_mem_tr__prompt_kernel
.p2align 8
.type interleave_layers__spectral_gfnet__memory_aug_recurrent_mem_tr__prompt_kernel,@function
interleave_layers__spectral_gfnet__memory_aug_recurrent_mem_tr__prompt_kernel:
    s_cmp_ge_u32 s2, 256
    s_cbranch_scc1 L_end0
    v_lshrrev_b32 v1, 6, v0
    s_and_b32 s3, s2, 7
    s_lshr_b32 s2, s2, 3
    s_cmp_ge_u32 s3, 2
    s_cbranch_scc1 L_worker0
    s_mov_b32 s19, s3
    s_mov_b32 s20, s2
    v_readfirstlane_b32 s21, v1
    s_branch L_chain
L_worker0:
    s_branch L_worker
L_end0:
    s_endpgm
L_chain:
    s_load_dwordx2 s[32:33], s[0:1], 96
    s_mov_b32 s34, 268435456
    s_mov_b32 s35, 0x20000
    s_load_dwordx2 s[36:37], s[0:1], 96
    s_mov_b32 s38, 268435456
    s_mov_b32 s39, 0x20000
    s_load_dwordx2 s[28:29], s[0:1], 96
    s_mov_b32 s30, 196608
    s_mov_b32 s31, 0x20000
    s_load_dwordx2 s[4:5], s[0:1], 88
    s_mov_b32 s6, 256
    s_mov_b32 s7, 0x20000
    v_and_b32 v12, 63, v0
    v_lshrrev_b32 v13, 4, v12
    v_and_b32 v14, 15, v12
    v_lshlrev_b32 v0, 4, v12
    s_lshl_b32 s64, s21, 15
    s_add_u32 s64, s64, 32768
    v_add_u32 v1, s64, v0
    v_bfe_u32 v8, v14, 1, 1
    v_mul_u32_u24 v8, 0xAAAA, v8
    v_add_u32 v2, 0x4444, v8
    s_mul_i32 s47, s21, 544
    s_add_u32 s47, s47, 10240
    v_lshrrev_b32 v8, 1, v13
    v_and_b32 v9, 1, v13
    v_lshlrev_b32 v10, 3, v12
    v_lshl_add_u32 v10, v8, 5, v10
    v_add_u32 v3, s47, v10
    v_mul_u32_u24 v10, 544, v8
    v_and_b32 v11, 3, v14
    v_lshl_add_u32 v10, v11, 7, v10
    v_bfe_u32 v11, v14, 1, 1
    v_lshl_add_u32 v10, v11, 5, v10
    v_lshl_add_u32 v10, v9, 6, v10
    v_lshrrev_b32 v4, 2, v14
    v_lshl_add_u32 v10, v4, 3, v10
    v_add_u32 v4, 10240, v10
    s_lshl_b32 s47, s21, 9
    s_add_u32 s47, s47, 10240
    v_mul_u32_u24 v10, 2080, v11
    v_and_b32 v11, 13, v14
    v_lshl_add_u32 v11, v9, 1, v11
    v_lshl_add_u32 v11, v8, 4, v11
    v_lshl_add_u32 v11, v11, 4, v10
    v_add_u32 v5, s47, v11
    s_lshl_b32 s47, s21, 14
    s_lshl_b32 s48, s20, 6
    s_add_u32 s47, s47, s48
    v_lshrrev_b32 v8, 3, v12
    v_and_b32 v9, 7, v12
    v_lshlrev_b32 v9, 3, v9
    v_lshl_add_u32 v8, v8, 11, v9
    v_add_u32 v7, s47, v8
    v_and_b32 v8, 1, v14
    v_lshlrev_b32 v8, 3, v8
    v_lshl_add_u32 v9, v13, 4, v8
    v_and_b32 v8, 2, v14
    v_lshl_add_u32 v9, v8, 4, v9
    v_lshrrev_b32 v11, 3, v14
    s_cmp_ge_u32 s21, 2
    s_cbranch_scc1 CH_s_1
    s_lshl_b32 s46, s21, 16
    s_lshl_b32 s47, s20, 11
    s_add_u32 s46, s46, s47
    s_lshl_b32 s47, s21, 11
    s_lshr_b32 s48, s20, 3
    s_lshl_b32 s48, s48, 9
    s_add_u32 s47, s47, s48
    s_and_b32 s48, s20, 1
    s_lshl_b32 s48, s48, 8
    s_add_u32 s47, s47, s48
    s_bfe_u32 s48, s20, 0x20001
    s_lshl_b32 s48, s48, 6
    s_add_u32 s47, s47, s48
    v_bfe_u32 v10, v14, 2, 1
    v_or_b32 v10, v10, v8
    s_mov_b32 s91, 0
    s_mov_b32 s95, 0
    s_branch CH_s_2
CH_s_1:
    s_and_b32 s48, s20, 15
    s_lshl_b32 s46, s48, 11
    s_add_u32 s46, s46, 131072
    s_lshl_b32 s47, s48, 6
    s_add_u32 s47, s47, 4096
    v_and_b32 v10, 3, v14
    s_mov_b32 s91, 2
    s_and_b32 s95, s20, 16
CH_s_2:
    v_add_u32 v9, s47, v9
    v_lshl_add_u32 v10, v11, 2, v10
    v_and_b32 v8, 0x2c, v12
    v_or_b32 v8, s95, v8
    v_cmp_eq_u32 vcc, 0, v8
    v_mov_b32 v11, 1073741824
    s_nop 0
    v_cndmask_b32 v6, v11, v9, vcc
    v_cmp_eq_u32 s[52:53], 0, v10
    v_cmp_eq_u32 s[54:55], 1, v10
    v_cmp_eq_u32 s[56:57], 2, v10
    v_cmp_eq_u32 s[58:59], 3, v10
    s_lshl_b32 s47, s19, 5
    s_add_u32 s47, s47, s20
    s_lshl_b32 s47, s47, 2
    s_add_u32 s47, s47, s21
    s_mul_i32 s45, s47, 143360
    s_lshl_b32 s63, s21, 11
    s_add_u32 s63, s63, 16384
    s_mov_b32 s51, 0x3e0293ee
    s_mov_b32 s61, 65536
    s_lshl_b32 s47, s21, 13
    s_lshl_b32 s48, s20, 6
    s_add_u32 s47, s47, s48
    s_add_u32 s62, s47, 131072
    s_mov_b32 s94, 0xfffff800
    s_mov_b32 s65, 0x3f80
    s_mov_b32 s22, 0x3f803f80
    s_mov_b32 s23, 0x3f803f80
    s_lshl_b32 s92, s21, 10
    s_lshl_b32 s93, s21, 8
    s_add_u32 s93, s93, 4096
    s_waitcnt lgkmcnt(0)
    s_or_b32 s47, s19, s20
    s_or_b32 s47, s47, s21
    s_cmp_lg_u32 s47, 0
    s_cbranch_scc1 CH_np_3
    v_bfe_u32 v8, v0, 2, 6
    v_mov_b32 v9, -1
    s_mov_b32 s74, -1
    s_mov_b32 s75, -1
    s_mov_b32 s47, 2103296
    s_memtime s[66:67]
    s_waitcnt lgkmcnt(0)
    buffer_store_dword v9, v8, s[36:39], s47 offen sc1
    s_waitcnt vmcnt(0)
    s_memtime s[68:69]
    s_waitcnt lgkmcnt(0)
    s_sub_u32 s70, s68, s66
    s_min_u32 s74, s74, s70
    s_mov_b32 s47, 2111488
    s_memtime s[66:67]
    s_waitcnt lgkmcnt(0)
    buffer_store_dword v9, v8, s[36:39], s47 offen sc1
    s_waitcnt vmcnt(0)
    s_memtime s[68:69]
    s_waitcnt lgkmcnt(0)
    s_sub_u32 s70, s68, s66
    s_min_u32 s75, s75, s70
    s_mov_b32 s47, 2103296
    s_memtime s[66:67]
    s_waitcnt lgkmcnt(0)
    buffer_store_dword v9, v8, s[36:39], s47 offen sc1
    s_waitcnt vmcnt(0)
    s_memtime s[68:69]
    s_waitcnt lgkmcnt(0)
    s_sub_u32 s70, s68, s66
    s_min_u32 s74, s74, s70
    s_mov_b32 s47, 2111488
    s_memtime s[66:67]
    s_waitcnt lgkmcnt(0)
    buffer_store_dword v9, v8, s[36:39], s47 offen sc1
    s_waitcnt vmcnt(0)
    s_memtime s[68:69]
    s_waitcnt lgkmcnt(0)
    s_sub_u32 s70, s68, s66
    s_min_u32 s75, s75, s70
    s_mov_b32 s47, 2103296
    s_memtime s[66:67]
    s_waitcnt lgkmcnt(0)
    buffer_store_dword v9, v8, s[36:39], s47 offen sc1
    s_waitcnt vmcnt(0)
    s_memtime s[68:69]
    s_waitcnt lgkmcnt(0)
    s_sub_u32 s70, s68, s66
    s_min_u32 s74, s74, s70
    s_mov_b32 s47, 2111488
    s_memtime s[66:67]
    s_waitcnt lgkmcnt(0)
    buffer_store_dword v9, v8, s[36:39], s47 offen sc1
    s_waitcnt vmcnt(0)
    s_memtime s[68:69]
    s_waitcnt lgkmcnt(0)
    s_sub_u32 s70, s68, s66
    s_min_u32 s75, s75, s70
    s_cmp_lt_u32 s75, s74
    s_cselect_b32 s47, 3, 1
    v_mov_b32 v9, s47
    buffer_store_dword v9, off, s[4:7], 0 offset:4 sc1
CH_np_3:
    v_mov_b64 v[8:9], 0
    v_mov_b64 v[10:11], 0
    v_mov_b64 v[12:13], -1
    v_mov_b64 v[14:15], -1
    s_lshr_b32 s47, s21, 1
    s_lshl_b32 s47, s47, 1
    s_add_u32 s47, s47, s19
    s_mul_i32 s47, s47, 196608
    s_lshl_b32 s48, s20, 10
    s_add_u32 s47, s47, s48
    s_add_u32 s47, s47, 65536
    s_bitcmp1_b32 s21, 0
    s_cbranch_scc1 CH_i_4
    s_add_u32 s48, s47, 0
    buffer_store_dwordx4 v[8:11], v0, s[32:35], s48 offen sc1
    s_add_u32 s48, s47, 32768
    buffer_store_dwordx4 v[8:11], v0, s[32:35], s48 offen sc1
    s_add_u32 s48, s47, 65536
    buffer_store_dwordx4 v[8:11], v0, s[32:35], s48 offen sc1
    s_branch CH_i_5
CH_i_4:
    s_add_u32 s48, s47, 98304
    buffer_store_dwordx4 v[8:11], v0, s[32:35], s48 offen sc1
    s_add_u32 s48, s47, 131072
    buffer_store_dwordx4 v[8:11], v0, s[32:35], s48 offen sc1
    s_add_u32 s48, s47, 163840
    buffer_store_dwordx4 v[12:15], v0, s[32:35], s48 offen sc1
CH_i_5:
    s_waitcnt vmcnt(0)
    s_barrier
    s_getreg_b32 s101, hwreg(HW_REG_XCC_ID, 0, 3)
    s_mul_i32 s101, s101, 6
    s_cmp_lg_u32 s21, 0
    s_cbranch_scc1 CH_i_6
    s_lshl_b64 s[66:67], 1, s101
    s_or_b32 s67, s67, 0x10000
    v_mov_b64 v[8:9], s[66:67]
    s_lshl_b32 s47, s19, 3
    s_mov_b64 exec, 1
    buffer_atomic_add_x2 v[8:9], off, s[4:7], s47 offset:128
    s_mov_b64 exec, -1
CH_i_6:
    s_waitcnt vmcnt(0)
    s_load_dwordx2 s[4:5], s[0:1], 40
    s_mov_b32 s6, 5242880
    s_mov_b32 s7, 0x20000
    s_load_dwordx2 s[8:9], s[0:1], 48
    s_mov_b32 s10, 5242880
    s_mov_b32 s11, 0x20000
    s_load_dwordx2 s[12:13], s[0:1], 56
    s_mov_b32 s14, 5242880
    s_mov_b32 s15, 0x20000
    s_load_dwordx2 s[24:25], s[0:1], 64
    s_mov_b32 s26, 5242880
    s_mov_b32 s27, 0x20000
    v_lshrrev_b32 v8, 4, v0
    v_bfe_u32 v9, v8, 2, 4
    v_mul_u32_u24 v9, 8192, v9
    v_bfe_u32 v17, v8, 0, 2
    v_lshl_add_u32 v9, v17, 4, v9
    v_bfe_u32 v10, v8, 2, 4
    v_mul_u32_u24 v10, 1280, v10
    v_bfe_u32 v17, v8, 0, 2
    v_lshl_add_u32 v10, v17, 4, v10
    v_bfe_u32 v11, v8, 1, 5
    v_mul_u32_u24 v11, 1280, v11
    v_bfe_u32 v17, v8, 0, 1
    v_lshl_add_u32 v11, v17, 4, v11
    v_bfe_u32 v12, v8, 5, 1
    v_mul_u32_u24 v12, 1024, v12
    v_bfe_u32 v17, v8, 3, 1
    v_lshl_add_u32 v12, v17, 9, v12
    v_bfe_u32 v17, v8, 2, 1
    v_lshl_add_u32 v12, v17, 8, v12
    v_bfe_u32 v17, v8, 4, 1
    v_lshl_add_u32 v12, v17, 7, v12
    v_bfe_u32 v17, v8, 0, 2
    v_lshl_add_u32 v12, v17, 3, v12
    v_bfe_u32 v13, v8, 5, 1
    v_mul_u32_u24 v13, 1024, v13
    v_bfe_u32 v17, v8, 3, 1
    v_lshl_add_u32 v13, v17, 9, v13
    v_bfe_u32 v17, v8, 4, 1
    v_lshl_add_u32 v13, v17, 8, v13
    v_bfe_u32 v17, v8, 2, 1
    v_lshl_add_u32 v13, v17, 6, v13
    v_bfe_u32 v17, v8, 0, 2
    v_lshl_add_u32 v13, v17, 3, v13
    v_bfe_u32 v14, v8, 4, 1
    v_mul_u32_u24 v14, 1024, v14
    v_bfe_u32 v17, v8, 5, 1
    v_lshl_add_u32 v14, v17, 9, v14
    v_bfe_u32 v17, v8, 3, 1
    v_lshl_add_u32 v14, v17, 8, v14
    v_bfe_u32 v17, v8, 2, 1
    v_lshl_add_u32 v14, v17, 6, v14
    v_bfe_u32 v17, v8, 0, 2
    v_lshl_add_u32 v14, v17, 4, v14
    v_bfe_u32 v15, v8, 4, 1
    v_mul_u32_u24 v15, 512, v15
    v_bfe_u32 v17, v8, 5, 1
    v_lshl_add_u32 v15, v17, 8, v15
    v_bfe_u32 v17, v8, 3, 1
    v_lshl_add_u32 v15, v17, 7, v15
    v_bfe_u32 v17, v8, 2, 1
    v_lshl_add_u32 v15, v17, 5, v15
    v_bfe_u32 v17, v8, 0, 2
    v_lshl_add_u32 v15, v17, 3, v15
    s_lshl_b32 s47, s20, 8
    s_lshl_b32 s48, s21, 6
    s_add_u32 s47, s47, s48
    s_mul_i32 s48, s19, 2621440
    s_add_u32 s66, s47, s48
    s_sub_u32 s67, s47, s48
    s_add_u32 s67, s67, 2621440
    s_mul_i32 s47, s20, 163840
    s_mul_i32 s48, s19, 640
    s_add_u32 s47, s47, s48
    s_lshl_b32 s48, s21, 6
    s_add_u32 s68, s47, s48
    s_lshl_b32 s48, s21, 5
    s_add_u32 s69, s47, s48
    s_add_u32 s69, s69, 512
    s_lshl_b32 s70, s21, 13
    s_waitcnt lgkmcnt(0)
    s_add_u32 m0, s64, 4096
    s_add_u32 s47, s66, 0
    buffer_load_dwordx4 v9, s[4:7], s47 offen lds
    s_add_u32 m0, s64, 5120
    s_add_u32 s47, s66, 131072
    buffer_load_dwordx4 v9, s[4:7], s47 offen lds
    s_add_u32 m0, s64, 6144
    s_add_u32 s47, s66, 262144
    buffer_load_dwordx4 v9, s[4:7], s47 offen lds
    s_add_u32 m0, s64, 7168
    s_add_u32 s47, s66, 393216
    buffer_load_dwordx4 v9, s[4:7], s47 offen lds
    s_add_u32 m0, s64, 8192
    s_add_u32 s47, s66, 524288
    buffer_load_dwordx4 v9, s[4:7], s47 offen lds
    s_add_u32 m0, s64, 9216
    s_add_u32 s47, s66, 655360
    buffer_load_dwordx4 v9, s[4:7], s47 offen lds
    s_add_u32 m0, s64, 10240
    s_add_u32 s47, s66, 786432
    buffer_load_dwordx4 v9, s[4:7], s47 offen lds
    s_add_u32 m0, s64, 11264
    s_add_u32 s47, s66, 917504
    buffer_load_dwordx4 v9, s[4:7], s47 offen lds
    s_add_u32 m0, s64, 12288
    s_add_u32 s47, s66, 2097152
    buffer_load_dwordx4 v9, s[4:7], s47 offen lds
    s_add_u32 m0, s64, 13312
    s_add_u32 s47, s66, 2228224
    buffer_load_dwordx4 v9, s[4:7], s47 offen lds
    s_add_u32 m0, s64, 14336
    s_add_u32 s47, s66, 2359296
    buffer_load_dwordx4 v9, s[4:7], s47 offen lds
    s_add_u32 m0, s64, 15360
    s_add_u32 s47, s66, 2490368
    buffer_load_dwordx4 v9, s[4:7], s47 offen lds
    s_add_u32 m0, s64, 16384
    s_add_u32 s47, s67, 0
    buffer_load_dwordx4 v9, s[4:7], s47 offen lds
    s_add_u32 m0, s64, 17408
    s_add_u32 s47, s67, 131072
    buffer_load_dwordx4 v9, s[4:7], s47 offen lds
    s_add_u32 m0, s64, 18432
    s_add_u32 s47, s67, 262144
    buffer_load_dwordx4 v9, s[4:7], s47 offen lds
    s_add_u32 m0, s64, 19456
    s_add_u32 s47, s67, 393216
    buffer_load_dwordx4 v9, s[4:7], s47 offen lds
    s_add_u32 m0, s64, 20480
    s_add_u32 s47, s67, 2097152
    buffer_load_dwordx4 v9, s[4:7], s47 offen lds
    s_add_u32 m0, s64, 21504
    s_add_u32 s47, s67, 2228224
    buffer_load_dwordx4 v9, s[4:7], s47 offen lds
    s_add_u32 m0, s64, 22528
    s_add_u32 s47, s67, 2359296
    buffer_load_dwordx4 v9, s[4:7], s47 offen lds
    s_add_u32 m0, s64, 23552
    s_add_u32 s47, s67, 2490368
    buffer_load_dwordx4 v9, s[4:7], s47 offen lds
    s_add_u32 m0, s64, 24576
    s_add_u32 s47, s66, 0
    buffer_load_dwordx4 v9, s[8:11], s47 offen lds
    s_add_u32 m0, s64, 25600
    s_add_u32 s47, s66, 131072
    buffer_load_dwordx4 v9, s[8:11], s47 offen lds
    s_add_u32 m0, s64, 26624
    s_add_u32 s47, s66, 262144
    buffer_load_dwordx4 v9, s[8:11], s47 offen lds
    s_add_u32 m0, s64, 27648
    s_add_u32 s47, s66, 393216
    buffer_load_dwordx4 v9, s[8:11], s47 offen lds
    v_add_u32 v16, s64, v12
    s_waitcnt vmcnt(20)
    ds_read_b64_tr_b16 v[64:65], v16 offset:4096
    ds_read_b64_tr_b16 v[66:67], v16 offset:4160
    ds_read_b64_tr_b16 v[68:69], v16 offset:6144
    ds_read_b64_tr_b16 v[70:71], v16 offset:6208
    ds_read_b64_tr_b16 v[72:73], v16 offset:4128
    ds_read_b64_tr_b16 v[74:75], v16 offset:4192
    ds_read_b64_tr_b16 v[76:77], v16 offset:6176
    ds_read_b64_tr_b16 v[78:79], v16 offset:6240
    s_waitcnt lgkmcnt(0)
    s_add_u32 m0, s64, 4096
    s_add_u32 s47, s66, 1048576
    buffer_load_dwordx4 v9, s[8:11], s47 offen lds
    s_add_u32 m0, s64, 5120
    s_add_u32 s47, s66, 1179648
    buffer_load_dwordx4 v9, s[8:11], s47 offen lds
    s_add_u32 m0, s64, 6144
    s_add_u32 s47, s66, 1310720
    buffer_load_dwordx4 v9, s[8:11], s47 offen lds
    s_add_u32 m0, s64, 7168
    s_add_u32 s47, s66, 1441792
    buffer_load_dwordx4 v9, s[8:11], s47 offen lds
    v_add_u32 v16, s64, v12
    s_waitcnt vmcnt(20)
    ds_read_b64_tr_b16 v[104:105], v16 offset:8192
    ds_read_b64_tr_b16 v[106:107], v16 offset:8256
    ds_read_b64_tr_b16 v[108:109], v16 offset:10240
    ds_read_b64_tr_b16 v[110:111], v16 offset:10304
    ds_read_b64_tr_b16 v[112:113], v16 offset:8224
    ds_read_b64_tr_b16 v[114:115], v16 offset:8288
    ds_read_b64_tr_b16 v[116:117], v16 offset:10272
    ds_read_b64_tr_b16 v[118:119], v16 offset:10336
    s_waitcnt lgkmcnt(0)
    s_add_u32 m0, s64, 8192
    s_add_u32 s47, s66, 1572864
    buffer_load_dwordx4 v9, s[8:11], s47 offen lds
    s_add_u32 m0, s64, 9216
    s_add_u32 s47, s66, 1703936
    buffer_load_dwordx4 v9, s[8:11], s47 offen lds
    s_add_u32 m0, s64, 10240
    s_add_u32 s47, s66, 1835008
    buffer_load_dwordx4 v9, s[8:11], s47 offen lds
    s_add_u32 m0, s64, 11264
    s_add_u32 s47, s66, 1966080
    buffer_load_dwordx4 v9, s[8:11], s47 offen lds
    v_add_u32 v16, s64, v13
    s_waitcnt vmcnt(20)
    ds_read_b64_tr_b16 v[208:209], v16 offset:12288
    ds_read_b64_tr_b16 v[210:211], v16 offset:12416
    ds_read_b64_tr_b16 v[212:213], v16 offset:14336
    ds_read_b64_tr_b16 v[214:215], v16 offset:14464
    ds_read_b64_tr_b16 v[216:217], v16 offset:12320
    ds_read_b64_tr_b16 v[218:219], v16 offset:12448
    ds_read_b64_tr_b16 v[220:221], v16 offset:14368
    ds_read_b64_tr_b16 v[222:223], v16 offset:14496
    s_waitcnt lgkmcnt(0)
    s_add_u32 m0, s64, 12288
    s_add_u32 s47, s67, 0
    buffer_load_dwordx4 v9, s[8:11], s47 offen lds
    s_add_u32 m0, s64, 13312
    s_add_u32 s47, s67, 131072
    buffer_load_dwordx4 v9, s[8:11], s47 offen lds
    s_add_u32 m0, s64, 14336
    s_add_u32 s47, s67, 262144
    buffer_load_dwordx4 v9, s[8:11], s47 offen lds
    s_add_u32 m0, s64, 15360
    s_add_u32 s47, s67, 393216
    buffer_load_dwordx4 v9, s[8:11], s47 offen lds
    v_add_u32 v16, s64, v12
    s_waitcnt vmcnt(20)
    ds_read_b64_tr_b16 v[232:233], v16 offset:16384
    ds_read_b64_tr_b16 v[234:235], v16 offset:16448
    ds_read_b64_tr_b16 v[236:237], v16 offset:18432
    ds_read_b64_tr_b16 v[238:239], v16 offset:18496
    ds_read_b64_tr_b16 v[240:241], v16 offset:16416
    ds_read_b64_tr_b16 v[242:243], v16 offset:16480
    ds_read_b64_tr_b16 v[244:245], v16 offset:18464
    ds_read_b64_tr_b16 v[246:247], v16 offset:18528
    s_waitcnt lgkmcnt(0)
    s_add_u32 m0, s64, 16384
    s_add_u32 s47, s67, 524288
    buffer_load_dwordx4 v9, s[8:11], s47 offen lds
    s_add_u32 m0, s64, 17408
    s_add_u32 s47, s67, 655360
    buffer_load_dwordx4 v9, s[8:11], s47 offen lds
    s_add_u32 m0, s64, 18432
    s_add_u32 s47, s67, 786432
    buffer_load_dwordx4 v9, s[8:11], s47 offen lds
    s_add_u32 m0, s64, 19456
    s_add_u32 s47, s67, 917504
    buffer_load_dwordx4 v9, s[8:11], s47 offen lds
    v_add_u32 v16, s64, v13
    s_waitcnt vmcnt(20)
    ds_read_b64_tr_b16 a[64:65], v16 offset:20480
    ds_read_b64_tr_b16 a[66:67], v16 offset:20608
    ds_read_b64_tr_b16 a[68:69], v16 offset:22528
    ds_read_b64_tr_b16 a[70:71], v16 offset:22656
    ds_read_b64_tr_b16 a[72:73], v16 offset:20512
    ds_read_b64_tr_b16 a[74:75], v16 offset:20640
    ds_read_b64_tr_b16 a[76:77], v16 offset:22560
    ds_read_b64_tr_b16 a[78:79], v16 offset:22688
    s_waitcnt lgkmcnt(0)
    s_add_u32 m0, s64, 20480
    s_add_u32 s47, s67, 1048576
    buffer_load_dwordx4 v9, s[8:11], s47 offen lds
    s_add_u32 m0, s64, 21504
    s_add_u32 s47, s67, 1179648
    buffer_load_dwordx4 v9, s[8:11], s47 offen lds
    s_add_u32 m0, s64, 22528
    s_add_u32 s47, s67, 1310720
    buffer_load_dwordx4 v9, s[8:11], s47 offen lds
    s_add_u32 m0, s64, 23552
    s_add_u32 s47, s67, 1441792
    buffer_load_dwordx4 v9, s[8:11], s47 offen lds
    v_add_u32 v16, s64, v12
    s_waitcnt vmcnt(20)
    ds_read_b64_tr_b16 v[80:81], v16 offset:24576
    ds_read_b64_tr_b16 v[82:83], v16 offset:24640
    ds_read_b64_tr_b16 v[84:85], v16 offset:26624
    ds_read_b64_tr_b16 v[86:87], v16 offset:26688
    ds_read_b64_tr_b16 v[88:89], v16 offset:24608
    ds_read_b64_tr_b16 v[90:91], v16 offset:24672
    ds_read_b64_tr_b16 v[92:93], v16 offset:26656
    ds_read_b64_tr_b16 v[94:95], v16 offset:26720
    s_waitcnt lgkmcnt(0)
    s_add_u32 m0, s64, 24576
    s_add_u32 s47, s67, 1572864
    buffer_load_dwordx4 v9, s[8:11], s47 offen lds
    s_add_u32 m0, s64, 25600
    s_add_u32 s47, s67, 1703936
    buffer_load_dwordx4 v9, s[8:11], s47 offen lds
    s_add_u32 m0, s64, 26624
    s_add_u32 s47, s67, 1835008
    buffer_load_dwordx4 v9, s[8:11], s47 offen lds
    s_add_u32 m0, s64, 27648
    s_add_u32 s47, s67, 1966080
    buffer_load_dwordx4 v9, s[8:11], s47 offen lds
    v_add_u32 v16, s64, v12
    s_waitcnt vmcnt(20)
    ds_read_b64_tr_b16 v[152:153], v16 offset:4096
    ds_read_b64_tr_b16 v[154:155], v16 offset:4160
    ds_read_b64_tr_b16 v[156:157], v16 offset:6144
    ds_read_b64_tr_b16 v[158:159], v16 offset:6208
    ds_read_b64_tr_b16 v[160:161], v16 offset:4128
    ds_read_b64_tr_b16 v[162:163], v16 offset:4192
    ds_read_b64_tr_b16 v[164:165], v16 offset:6176
    ds_read_b64_tr_b16 v[166:167], v16 offset:6240
    s_waitcnt lgkmcnt(0)
    s_add_u32 m0, s64, 4096
    s_add_u32 s47, s67, 2097152
    buffer_load_dwordx4 v9, s[8:11], s47 offen lds
    s_add_u32 m0, s64, 5120
    s_add_u32 s47, s67, 2228224
    buffer_load_dwordx4 v9, s[8:11], s47 offen lds
    s_add_u32 m0, s64, 6144
    s_add_u32 s47, s67, 2359296
    buffer_load_dwordx4 v9, s[8:11], s47 offen lds
    s_add_u32 m0, s64, 7168
    s_add_u32 s47, s67, 2490368
    buffer_load_dwordx4 v9, s[8:11], s47 offen lds
    v_add_u32 v16, s64, v12
    s_waitcnt vmcnt(20)
    ds_read_b64_tr_b16 v[192:193], v16 offset:8192
    ds_read_b64_tr_b16 v[194:195], v16 offset:8256
    ds_read_b64_tr_b16 v[196:197], v16 offset:10240
    ds_read_b64_tr_b16 v[198:199], v16 offset:10304
    ds_read_b64_tr_b16 v[200:201], v16 offset:8224
    ds_read_b64_tr_b16 v[202:203], v16 offset:8288
    ds_read_b64_tr_b16 v[204:205], v16 offset:10272
    ds_read_b64_tr_b16 v[206:207], v16 offset:10336
    s_waitcnt lgkmcnt(0)
    s_add_u32 m0, s64, 8192
    s_add_u32 s47, s66, 524288
    buffer_load_dwordx4 v9, s[12:15], s47 offen lds
    s_add_u32 m0, s64, 9216
    s_add_u32 s47, s66, 655360
    buffer_load_dwordx4 v9, s[12:15], s47 offen lds
    s_add_u32 m0, s64, 10240
    s_add_u32 s47, s66, 786432
    buffer_load_dwordx4 v9, s[12:15], s47 offen lds
    s_add_u32 m0, s64, 11264
    s_add_u32 s47, s66, 917504
    buffer_load_dwordx4 v9, s[12:15], s47 offen lds
    v_add_u32 v16, s64, v12
    s_waitcnt vmcnt(20)
    ds_read_b64_tr_b16 v[248:249], v16 offset:12288
    ds_read_b64_tr_b16 v[250:251], v16 offset:12352
    ds_read_b64_tr_b16 v[252:253], v16 offset:14336
    ds_read_b64_tr_b16 v[254:255], v16 offset:14400
    ds_read_b64_tr_b16 a[0:1], v16 offset:12320
    ds_read_b64_tr_b16 a[2:3], v16 offset:12384
    ds_read_b64_tr_b16 a[4:5], v16 offset:14368
    ds_read_b64_tr_b16 a[6:7], v16 offset:14432
    s_waitcnt lgkmcnt(0)
    s_add_u32 m0, s64, 12288
    s_add_u32 s47, s66, 1048576
    buffer_load_dwordx4 v9, s[12:15], s47 offen lds
    s_add_u32 m0, s64, 13312
    s_add_u32 s47, s66, 1179648
    buffer_load_dwordx4 v9, s[12:15], s47 offen lds
    s_add_u32 m0, s64, 14336
    s_add_u32 s47, s66, 1310720
    buffer_load_dwordx4 v9, s[12:15], s47 offen lds
    s_add_u32 m0, s64, 15360
    s_add_u32 s47, s66, 1441792
    buffer_load_dwordx4 v9, s[12:15], s47 offen lds
    v_add_u32 v16, s64, v12
    s_waitcnt vmcnt(20)
    ds_read_b64_tr_b16 a[16:17], v16 offset:16384
    ds_read_b64_tr_b16 a[18:19], v16 offset:16448
    ds_read_b64_tr_b16 a[20:21], v16 offset:18432
    ds_read_b64_tr_b16 a[22:23], v16 offset:18496
    ds_read_b64_tr_b16 a[24:25], v16 offset:16416
    ds_read_b64_tr_b16 a[26:27], v16 offset:16480
    ds_read_b64_tr_b16 a[28:29], v16 offset:18464
    ds_read_b64_tr_b16 a[30:31], v16 offset:18528
    s_waitcnt lgkmcnt(0)
    s_add_u32 m0, s64, 16384
    s_add_u32 s47, s66, 1572864
    buffer_load_dwordx4 v9, s[12:15], s47 offen lds
    s_add_u32 m0, s64, 17408
    s_add_u32 s47, s66, 1703936
    buffer_load_dwordx4 v9, s[12:15], s47 offen lds
    s_add_u32 m0, s64, 18432
    s_add_u32 s47, s66, 1835008
    buffer_load_dwordx4 v9, s[12:15], s47 offen lds
    s_add_u32 m0, s64, 19456
    s_add_u32 s47, s66, 1966080
    buffer_load_dwordx4 v9, s[12:15], s47 offen lds
    v_add_u32 v16, s64, v12
    s_waitcnt vmcnt(20)
    ds_read_b64_tr_b16 a[40:41], v16 offset:20480
    ds_read_b64_tr_b16 a[42:43], v16 offset:20544
    ds_read_b64_tr_b16 a[44:45], v16 offset:22528
    ds_read_b64_tr_b16 a[46:47], v16 offset:22592
    ds_read_b64_tr_b16 a[48:49], v16 offset:20512
    ds_read_b64_tr_b16 a[50:51], v16 offset:20576
    ds_read_b64_tr_b16 a[52:53], v16 offset:22560
    ds_read_b64_tr_b16 a[54:55], v16 offset:22624
    s_waitcnt lgkmcnt(0)
    s_add_u32 m0, s64, 20480
    s_add_u32 s47, s66, 2097152
    buffer_load_dwordx4 v9, s[12:15], s47 offen lds
    s_add_u32 m0, s64, 21504
    s_add_u32 s47, s66, 2228224
    buffer_load_dwordx4 v9, s[12:15], s47 offen lds
    s_add_u32 m0, s64, 22528
    s_add_u32 s47, s66, 2359296
    buffer_load_dwordx4 v9, s[12:15], s47 offen lds
    s_add_u32 m0, s64, 23552
    s_add_u32 s47, s66, 2490368
    buffer_load_dwordx4 v9, s[12:15], s47 offen lds
    v_add_u32 v16, s64, v12
    s_waitcnt vmcnt(20)
    ds_read_b64_tr_b16 a[80:81], v16 offset:24576
    ds_read_b64_tr_b16 a[82:83], v16 offset:24640
    ds_read_b64_tr_b16 a[84:85], v16 offset:26624
    ds_read_b64_tr_b16 a[86:87], v16 offset:26688
    ds_read_b64_tr_b16 a[96:97], v16 offset:24608
    ds_read_b64_tr_b16 a[98:99], v16 offset:24672
    ds_read_b64_tr_b16 a[100:101], v16 offset:26656
    ds_read_b64_tr_b16 a[102:103], v16 offset:26720
    s_waitcnt lgkmcnt(0)
    s_add_u32 m0, s64, 24576
    s_add_u32 s47, s67, 0
    buffer_load_dwordx4 v9, s[12:15], s47 offen lds
    s_add_u32 m0, s64, 25600
    s_add_u32 s47, s67, 131072
    buffer_load_dwordx4 v9, s[12:15], s47 offen lds
    s_add_u32 m0, s64, 26624
    s_add_u32 s47, s67, 262144
    buffer_load_dwordx4 v9, s[12:15], s47 offen lds
    s_add_u32 m0, s64, 27648
    s_add_u32 s47, s67, 393216
    buffer_load_dwordx4 v9, s[12:15], s47 offen lds
    v_add_u32 v16, s64, v13
    s_waitcnt vmcnt(20)
    ds_read_b64_tr_b16 a[88:89], v16 offset:4096
    ds_read_b64_tr_b16 a[90:91], v16 offset:4224
    ds_read_b64_tr_b16 a[92:93], v16 offset:6144
    ds_read_b64_tr_b16 a[94:95], v16 offset:6272
    ds_read_b64_tr_b16 a[104:105], v16 offset:4128
    ds_read_b64_tr_b16 a[106:107], v16 offset:4256
    ds_read_b64_tr_b16 a[108:109], v16 offset:6176
    ds_read_b64_tr_b16 a[110:111], v16 offset:6304
    s_waitcnt lgkmcnt(0)
    s_add_u32 m0, s64, 4096
    s_add_u32 s47, s67, 524288
    buffer_load_dwordx4 v9, s[12:15], s47 offen lds
    s_add_u32 m0, s64, 5120
    s_add_u32 s47, s67, 655360
    buffer_load_dwordx4 v9, s[12:15], s47 offen lds
    s_add_u32 m0, s64, 6144
    s_add_u32 s47, s67, 786432
    buffer_load_dwordx4 v9, s[12:15], s47 offen lds
    s_add_u32 m0, s64, 7168
    s_add_u32 s47, s67, 917504
    buffer_load_dwordx4 v9, s[12:15], s47 offen lds
    v_add_u32 v16, s64, v12
    s_waitcnt vmcnt(20)
    ds_read_b64_tr_b16 v[128:129], v16 offset:8192
    ds_read_b64_tr_b16 v[130:131], v16 offset:8256
    ds_read_b64_tr_b16 v[132:133], v16 offset:10240
    ds_read_b64_tr_b16 v[134:135], v16 offset:10304
    ds_read_b64_tr_b16 v[136:137], v16 offset:8224
    ds_read_b64_tr_b16 v[138:139], v16 offset:8288
    ds_read_b64_tr_b16 v[140:141], v16 offset:10272
    ds_read_b64_tr_b16 v[142:143], v16 offset:10336
    s_waitcnt lgkmcnt(0)
    s_add_u32 m0, s64, 8192
    s_add_u32 s47, s67, 1048576
    buffer_load_dwordx4 v9, s[12:15], s47 offen lds
    s_add_u32 m0, s64, 9216
    s_add_u32 s47, s67, 1179648
    buffer_load_dwordx4 v9, s[12:15], s47 offen lds
    s_add_u32 m0, s64, 10240
    s_add_u32 s47, s67, 1310720
    buffer_load_dwordx4 v9, s[12:15], s47 offen lds
    s_add_u32 m0, s64, 11264
    s_add_u32 s47, s67, 1441792
    buffer_load_dwordx4 v9, s[12:15], s47 offen lds
    v_add_u32 v16, s64, v12
    s_waitcnt vmcnt(20)
    ds_read_b64_tr_b16 v[168:169], v16 offset:12288
    ds_read_b64_tr_b16 v[170:171], v16 offset:12352
    ds_read_b64_tr_b16 v[172:173], v16 offset:14336
    ds_read_b64_tr_b16 v[174:175], v16 offset:14400
    ds_read_b64_tr_b16 v[176:177], v16 offset:12320
    ds_read_b64_tr_b16 v[178:179], v16 offset:12384
    ds_read_b64_tr_b16 v[180:181], v16 offset:14368
    ds_read_b64_tr_b16 v[182:183], v16 offset:14432
    s_waitcnt lgkmcnt(0)
    s_add_u32 m0, s64, 12288
    s_add_u32 s47, s67, 1572864
    buffer_load_dwordx4 v9, s[12:15], s47 offen lds
    s_add_u32 m0, s64, 13312
    s_add_u32 s47, s67, 1703936
    buffer_load_dwordx4 v9, s[12:15], s47 offen lds
    s_add_u32 m0, s64, 14336
    s_add_u32 s47, s67, 1835008
    buffer_load_dwordx4 v9, s[12:15], s47 offen lds
    s_add_u32 m0, s64, 15360
    s_add_u32 s47, s67, 1966080
    buffer_load_dwordx4 v9, s[12:15], s47 offen lds
    v_add_u32 v16, s64, v12
    s_waitcnt vmcnt(20)
    ds_read_b64_tr_b16 a[112:113], v16 offset:16384
    ds_read_b64_tr_b16 a[114:115], v16 offset:16448
    ds_read_b64_tr_b16 a[116:117], v16 offset:18432
    ds_read_b64_tr_b16 a[118:119], v16 offset:18496
    ds_read_b64_tr_b16 a[120:121], v16 offset:16416
    ds_read_b64_tr_b16 a[122:123], v16 offset:16480
    ds_read_b64_tr_b16 a[124:125], v16 offset:18464
    ds_read_b64_tr_b16 a[126:127], v16 offset:18528
    s_waitcnt lgkmcnt(0)
    s_add_u32 m0, s64, 16384
    s_add_u32 s47, s67, 2097152
    buffer_load_dwordx4 v9, s[12:15], s47 offen lds
    s_add_u32 m0, s64, 17408
    s_add_u32 s47, s67, 2228224
    buffer_load_dwordx4 v9, s[12:15], s47 offen lds
    s_add_u32 m0, s64, 18432
    s_add_u32 s47, s67, 2359296
    buffer_load_dwordx4 v9, s[12:15], s47 offen lds
    s_add_u32 m0, s64, 19456
    s_add_u32 s47, s67, 2490368
    buffer_load_dwordx4 v9, s[12:15], s47 offen lds
    v_add_u32 v16, s64, v13
    s_waitcnt vmcnt(20)
    ds_read_b64_tr_b16 a[128:129], v16 offset:20480
    ds_read_b64_tr_b16 a[130:131], v16 offset:20608
    ds_read_b64_tr_b16 a[132:133], v16 offset:22528
    ds_read_b64_tr_b16 a[134:135], v16 offset:22656
    ds_read_b64_tr_b16 a[136:137], v16 offset:20512
    ds_read_b64_tr_b16 a[138:139], v16 offset:20640
    ds_read_b64_tr_b16 a[140:141], v16 offset:22560
    ds_read_b64_tr_b16 a[142:143], v16 offset:22688
    s_waitcnt lgkmcnt(0)
    s_add_u32 m0, s64, 20480
    s_add_u32 s47, s68, 82176
    buffer_load_dwordx4 v10, s[24:27], s47 offen lds
    s_add_u32 m0, s64, 21504
    s_add_u32 s47, s68, 102656
    buffer_load_dwordx4 v10, s[24:27], s47 offen lds
    s_add_u32 m0, s64, 22528
    s_add_u32 s47, s68, 123136
    buffer_load_dwordx4 v10, s[24:27], s47 offen lds
    s_add_u32 m0, s64, 23552
    s_add_u32 s47, s68, 143616
    buffer_load_dwordx4 v10, s[24:27], s47 offen lds
    v_add_u32 v16, s64, v12
    s_waitcnt vmcnt(20)
    ds_read_b64_tr_b16 a[144:145], v16 offset:24576
    ds_read_b64_tr_b16 a[146:147], v16 offset:24640
    ds_read_b64_tr_b16 a[148:149], v16 offset:26624
    ds_read_b64_tr_b16 a[150:151], v16 offset:26688
    ds_read_b64_tr_b16 a[152:153], v16 offset:24608
    ds_read_b64_tr_b16 a[154:155], v16 offset:24672
    ds_read_b64_tr_b16 a[156:157], v16 offset:26656
    ds_read_b64_tr_b16 a[158:159], v16 offset:26720
    s_waitcnt lgkmcnt(0)
    s_add_u32 m0, s64, 24576
    s_add_u32 s47, s66, 0
    buffer_load_dwordx4 v9, s[12:15], s47 offen lds
    s_add_u32 m0, s64, 25600
    s_add_u32 s47, s66, 131072
    buffer_load_dwordx4 v9, s[12:15], s47 offen lds
    s_add_u32 m0, s64, 26624
    s_add_u32 s47, s66, 262144
    buffer_load_dwordx4 v9, s[12:15], s47 offen lds
    s_add_u32 m0, s64, 27648
    s_add_u32 s47, s66, 393216
    buffer_load_dwordx4 v9, s[12:15], s47 offen lds
    v_add_u32 v16, s64, v12
    s_waitcnt vmcnt(20)
    ds_read_b64_tr_b16 a[160:161], v16 offset:4096
    ds_read_b64_tr_b16 a[162:163], v16 offset:4160
    ds_read_b64_tr_b16 a[164:165], v16 offset:6144
    ds_read_b64_tr_b16 a[166:167], v16 offset:6208
    ds_read_b64_tr_b16 a[168:169], v16 offset:4128
    ds_read_b64_tr_b16 a[170:171], v16 offset:4192
    ds_read_b64_tr_b16 a[172:173], v16 offset:6176
    ds_read_b64_tr_b16 a[174:175], v16 offset:6240
    s_waitcnt lgkmcnt(0)
    s_add_u32 m0, s64, 28672
    s_add_u32 s47, s66, 524288
    buffer_load_dwordx4 v9, s[8:11], s47 offen lds
    s_add_u32 m0, s64, 29696
    s_add_u32 s47, s66, 655360
    buffer_load_dwordx4 v9, s[8:11], s47 offen lds
    s_add_u32 m0, s64, 30720
    s_add_u32 s47, s66, 786432
    buffer_load_dwordx4 v9, s[8:11], s47 offen lds
    s_add_u32 m0, s64, 31744
    s_add_u32 s47, s66, 917504
    buffer_load_dwordx4 v9, s[8:11], s47 offen lds
    v_add_u32 v16, s64, v12
    s_waitcnt vmcnt(20)
    ds_read_b64_tr_b16 a[176:177], v16 offset:8192
    ds_read_b64_tr_b16 a[178:179], v16 offset:8256
    ds_read_b64_tr_b16 a[180:181], v16 offset:10240
    ds_read_b64_tr_b16 a[182:183], v16 offset:10304
    ds_read_b64_tr_b16 a[184:185], v16 offset:8224
    ds_read_b64_tr_b16 a[186:187], v16 offset:8288
    ds_read_b64_tr_b16 a[188:189], v16 offset:10272
    ds_read_b64_tr_b16 a[190:191], v16 offset:10336
    s_waitcnt lgkmcnt(0)
    s_add_u32 m0, s70, 0
    s_add_u32 s47, s66, 1048576
    buffer_load_dwordx4 v9, s[4:7], s47 offen lds
    s_add_u32 m0, s70, 1024
    s_add_u32 s47, s66, 1179648
    buffer_load_dwordx4 v9, s[4:7], s47 offen lds
    s_add_u32 m0, s70, 2048
    s_add_u32 s47, s66, 1310720
    buffer_load_dwordx4 v9, s[4:7], s47 offen lds
    s_add_u32 m0, s70, 3072
    s_add_u32 s47, s66, 1441792
    buffer_load_dwordx4 v9, s[4:7], s47 offen lds
    v_add_u32 v16, s64, v12
    s_waitcnt vmcnt(20)
    ds_read_b64_tr_b16 a[192:193], v16 offset:12288
    ds_read_b64_tr_b16 a[194:195], v16 offset:12352
    ds_read_b64_tr_b16 a[196:197], v16 offset:14336
    ds_read_b64_tr_b16 a[198:199], v16 offset:14400
    ds_read_b64_tr_b16 a[200:201], v16 offset:12320
    ds_read_b64_tr_b16 a[202:203], v16 offset:12384
    ds_read_b64_tr_b16 a[204:205], v16 offset:14368
    ds_read_b64_tr_b16 a[206:207], v16 offset:14432
    s_waitcnt lgkmcnt(0)
    s_add_u32 m0, s64, 12288
    s_add_u32 s47, s66, 1572864
    buffer_load_dwordx4 v9, s[4:7], s47 offen lds
    s_add_u32 m0, s64, 13312
    s_add_u32 s47, s66, 1703936
    buffer_load_dwordx4 v9, s[4:7], s47 offen lds
    s_add_u32 m0, s64, 14336
    s_add_u32 s47, s66, 1835008
    buffer_load_dwordx4 v9, s[4:7], s47 offen lds
    s_add_u32 m0, s64, 15360
    s_add_u32 s47, s66, 1966080
    buffer_load_dwordx4 v9, s[4:7], s47 offen lds
    v_add_u32 v16, s64, v13
    s_waitcnt vmcnt(20)
    ds_read_b64_tr_b16 a[208:209], v16 offset:16384
    ds_read_b64_tr_b16 a[210:211], v16 offset:16512
    ds_read_b64_tr_b16 a[212:213], v16 offset:18432
    ds_read_b64_tr_b16 a[214:215], v16 offset:18560
    ds_read_b64_tr_b16 a[216:217], v16 offset:16416
    ds_read_b64_tr_b16 a[218:219], v16 offset:16544
    ds_read_b64_tr_b16 a[220:221], v16 offset:18464
    ds_read_b64_tr_b16 a[222:223], v16 offset:18592
    s_waitcnt lgkmcnt(0)
    s_add_u32 m0, s64, 16384
    s_add_u32 s47, s66, 2097152
    buffer_load_dwordx4 v9, s[8:11], s47 offen lds
    s_add_u32 m0, s64, 17408
    s_add_u32 s47, s66, 2228224
    buffer_load_dwordx4 v9, s[8:11], s47 offen lds
    s_add_u32 m0, s64, 18432
    s_add_u32 s47, s66, 2359296
    buffer_load_dwordx4 v9, s[8:11], s47 offen lds
    s_add_u32 m0, s64, 19456
    s_add_u32 s47, s66, 2490368
    buffer_load_dwordx4 v9, s[8:11], s47 offen lds
    v_add_u32 v16, s64, v14
    s_waitcnt vmcnt(20)
    ds_read_b64_tr_b16 a[240:241], v16 offset:20480
    ds_read_b64_tr_b16 a[242:243], v16 offset:20608
    ds_read_b64_tr_b16 a[244:245], v16 offset:22528
    ds_read_b64_tr_b16 a[246:247], v16 offset:22656
    ds_read_b64_tr_b16 a[248:249], v16 offset:20488
    ds_read_b64_tr_b16 a[250:251], v16 offset:20616
    ds_read_b64_tr_b16 a[252:253], v16 offset:22536
    ds_read_b64_tr_b16 a[254:255], v16 offset:22664
    s_waitcnt lgkmcnt(0)
    s_add_u32 m0, s64, 20480
    s_add_u32 s47, s67, 524288
    buffer_load_dwordx4 v9, s[4:7], s47 offen lds
    s_add_u32 m0, s64, 21504
    s_add_u32 s47, s67, 655360
    buffer_load_dwordx4 v9, s[4:7], s47 offen lds
    s_add_u32 m0, s64, 22528
    s_add_u32 s47, s67, 786432
    buffer_load_dwordx4 v9, s[4:7], s47 offen lds
    s_add_u32 m0, s64, 23552
    s_add_u32 s47, s67, 917504
    buffer_load_dwordx4 v9, s[4:7], s47 offen lds
    v_add_u32 v16, s64, v12
    s_waitcnt vmcnt(20)
    ds_read_b64_tr_b16 v[24:25], v16 offset:24576
    ds_read_b64_tr_b16 v[26:27], v16 offset:24640
    ds_read_b64_tr_b16 v[28:29], v16 offset:26624
    ds_read_b64_tr_b16 v[30:31], v16 offset:26688
    ds_read_b64_tr_b16 v[96:97], v16 offset:24608
    ds_read_b64_tr_b16 v[98:99], v16 offset:24672
    ds_read_b64_tr_b16 v[100:101], v16 offset:26656
    ds_read_b64_tr_b16 v[102:103], v16 offset:26720
    s_waitcnt lgkmcnt(6)
    ds_write_b128 v1, v[24:27] offset:4096
    s_waitcnt lgkmcnt(5)
    ds_write_b128 v1, v[28:31] offset:5120
    s_waitcnt lgkmcnt(0)
    s_add_u32 m0, s64, 24576
    s_add_u32 s47, s67, 1048576
    buffer_load_dwordx4 v9, s[4:7], s47 offen lds
    s_add_u32 m0, s64, 25600
    s_add_u32 s47, s67, 1179648
    buffer_load_dwordx4 v9, s[4:7], s47 offen lds
    s_add_u32 m0, s64, 26624
    s_add_u32 s47, s67, 1310720
    buffer_load_dwordx4 v9, s[4:7], s47 offen lds
    s_add_u32 m0, s64, 27648
    s_add_u32 s47, s67, 1441792
    buffer_load_dwordx4 v9, s[4:7], s47 offen lds
    v_add_u32 v16, s64, v12
    s_waitcnt vmcnt(20)
    ds_read_b64_tr_b16 v[24:25], v16 offset:28672
    ds_read_b64_tr_b16 v[26:27], v16 offset:28736
    ds_read_b64_tr_b16 v[28:29], v16 offset:30720
    ds_read_b64_tr_b16 v[30:31], v16 offset:30784
    ds_read_b64_tr_b16 v[120:121], v16 offset:28704
    ds_read_b64_tr_b16 v[122:123], v16 offset:28768
    ds_read_b64_tr_b16 v[124:125], v16 offset:30752
    ds_read_b64_tr_b16 v[126:127], v16 offset:30816
    s_waitcnt lgkmcnt(6)
    ds_write_b128 v1, v[24:27] offset:6144
    s_waitcnt lgkmcnt(5)
    ds_write_b128 v1, v[28:31] offset:7168
    s_waitcnt lgkmcnt(0)
    s_add_u32 m0, s64, 28672
    s_add_u32 s47, s67, 1572864
    buffer_load_dwordx4 v9, s[4:7], s47 offen lds
    s_add_u32 m0, s64, 29696
    s_add_u32 s47, s67, 1703936
    buffer_load_dwordx4 v9, s[4:7], s47 offen lds
    s_add_u32 m0, s64, 30720
    s_add_u32 s47, s67, 1835008
    buffer_load_dwordx4 v9, s[4:7], s47 offen lds
    s_add_u32 m0, s64, 31744
    s_add_u32 s47, s67, 1966080
    buffer_load_dwordx4 v9, s[4:7], s47 offen lds
    v_add_u32 v16, s70, v12
    s_waitcnt vmcnt(20)
    ds_read_b64_tr_b16 v[144:145], v16 offset:0
    ds_read_b64_tr_b16 v[146:147], v16 offset:64
    ds_read_b64_tr_b16 v[148:149], v16 offset:2048
    ds_read_b64_tr_b16 v[150:151], v16 offset:2112
    ds_read_b64_tr_b16 v[32:33], v16 offset:32
    ds_read_b64_tr_b16 v[34:35], v16 offset:96
    ds_read_b64_tr_b16 v[36:37], v16 offset:2080
    ds_read_b64_tr_b16 v[38:39], v16 offset:2144
    s_waitcnt lgkmcnt(2)
    ds_write_b128 v1, v[32:35] offset:8192
    s_waitcnt lgkmcnt(1)
    ds_write_b128 v1, v[36:39] offset:9216
    s_waitcnt lgkmcnt(0)
    s_add_u32 m0, s70, 4096
    s_add_u32 s47, s68, 81920
    buffer_load_dwordx4 v10, s[24:27], s47 offen lds
    s_add_u32 m0, s70, 5120
    s_add_u32 s47, s68, 102400
    buffer_load_dwordx4 v10, s[24:27], s47 offen lds
    s_add_u32 m0, s70, 6144
    s_add_u32 s47, s68, 122880
    buffer_load_dwordx4 v10, s[24:27], s47 offen lds
    s_add_u32 m0, s70, 7168
    s_add_u32 s47, s68, 143360
    buffer_load_dwordx4 v10, s[24:27], s47 offen lds
    v_add_u32 v16, s64, v12
    s_waitcnt vmcnt(20)
    ds_read_b64_tr_b16 v[24:25], v16 offset:12288
    ds_read_b64_tr_b16 v[26:27], v16 offset:12352
    ds_read_b64_tr_b16 v[28:29], v16 offset:14336
    ds_read_b64_tr_b16 v[30:31], v16 offset:14400
    ds_read_b64_tr_b16 v[184:185], v16 offset:12320
    ds_read_b64_tr_b16 v[186:187], v16 offset:12384
    ds_read_b64_tr_b16 v[188:189], v16 offset:14368
    ds_read_b64_tr_b16 v[190:191], v16 offset:14432
    s_waitcnt lgkmcnt(6)
    ds_write_b128 v1, v[24:27] offset:10240
    s_waitcnt lgkmcnt(5)
    ds_write_b128 v1, v[28:31] offset:11264
    s_waitcnt lgkmcnt(0)
    s_add_u32 m0, s64, 0
    s_add_u32 s47, s68, 0
    buffer_load_dwordx4 v10, s[24:27], s47 offen lds
    s_add_u32 m0, s64, 1024
    s_add_u32 s47, s68, 20480
    buffer_load_dwordx4 v10, s[24:27], s47 offen lds
    s_add_u32 m0, s64, 2048
    s_add_u32 s47, s68, 40960
    buffer_load_dwordx4 v10, s[24:27], s47 offen lds
    s_add_u32 m0, s64, 3072
    s_add_u32 s47, s68, 61440
    buffer_load_dwordx4 v10, s[24:27], s47 offen lds
    v_add_u32 v16, s64, v13
    s_waitcnt vmcnt(20)
    ds_read_b64_tr_b16 v[224:225], v16 offset:16384
    ds_read_b64_tr_b16 v[226:227], v16 offset:16512
    ds_read_b64_tr_b16 v[228:229], v16 offset:18432
    ds_read_b64_tr_b16 v[230:231], v16 offset:18560
    ds_read_b64_tr_b16 v[32:33], v16 offset:16416
    ds_read_b64_tr_b16 v[34:35], v16 offset:16544
    ds_read_b64_tr_b16 v[36:37], v16 offset:18464
    ds_read_b64_tr_b16 v[38:39], v16 offset:18592
    s_waitcnt lgkmcnt(2)
    ds_write_b128 v1, v[32:35] offset:12288
    s_waitcnt lgkmcnt(1)
    ds_write_b128 v1, v[36:39] offset:13312
    s_waitcnt lgkmcnt(0)
    s_add_u32 m0, s70, 0
    s_add_u32 s47, s68, 256
    buffer_load_dwordx4 v10, s[24:27], s47 offen lds
    s_add_u32 m0, s70, 1024
    s_add_u32 s47, s68, 20736
    buffer_load_dwordx4 v10, s[24:27], s47 offen lds
    s_add_u32 m0, s70, 2048
    s_add_u32 s47, s68, 41216
    buffer_load_dwordx4 v10, s[24:27], s47 offen lds
    s_add_u32 m0, s70, 3072
    s_add_u32 s47, s68, 61696
    buffer_load_dwordx4 v10, s[24:27], s47 offen lds
    v_add_u32 v16, s64, v12
    s_waitcnt vmcnt(20)
    ds_read_b64_tr_b16 v[24:25], v16 offset:20480
    ds_read_b64_tr_b16 v[26:27], v16 offset:20544
    ds_read_b64_tr_b16 v[28:29], v16 offset:22528
    ds_read_b64_tr_b16 v[30:31], v16 offset:22592
    ds_read_b64_tr_b16 a[8:9], v16 offset:20512
    ds_read_b64_tr_b16 a[10:11], v16 offset:20576
    ds_read_b64_tr_b16 a[12:13], v16 offset:22560
    ds_read_b64_tr_b16 a[14:15], v16 offset:22624
    s_waitcnt lgkmcnt(6)
    ds_write_b128 v1, v[24:27] offset:14336
    s_waitcnt lgkmcnt(5)
    ds_write_b128 v1, v[28:31] offset:15360
    s_waitcnt lgkmcnt(0)
    v_add_u32 v16, s64, v12
    s_waitcnt vmcnt(16)
    ds_read_b64_tr_b16 v[24:25], v16 offset:24576
    ds_read_b64_tr_b16 v[26:27], v16 offset:24640
    ds_read_b64_tr_b16 v[28:29], v16 offset:26624
    ds_read_b64_tr_b16 v[30:31], v16 offset:26688
    ds_read_b64_tr_b16 a[32:33], v16 offset:24608
    ds_read_b64_tr_b16 a[34:35], v16 offset:24672
    ds_read_b64_tr_b16 a[36:37], v16 offset:26656
    ds_read_b64_tr_b16 a[38:39], v16 offset:26720
    s_waitcnt lgkmcnt(6)
    ds_write_b128 v1, v[24:27] offset:16384
    s_waitcnt lgkmcnt(5)
    ds_write_b128 v1, v[28:31] offset:17408
    s_waitcnt lgkmcnt(0)
    v_add_u32 v16, s64, v12
    s_waitcnt vmcnt(12)
    ds_read_b64_tr_b16 a[56:57], v16 offset:28672
    ds_read_b64_tr_b16 a[58:59], v16 offset:28736
    ds_read_b64_tr_b16 a[60:61], v16 offset:30720
    ds_read_b64_tr_b16 a[62:63], v16 offset:30784
    ds_read_b64_tr_b16 v[32:33], v16 offset:28704
    ds_read_b64_tr_b16 v[34:35], v16 offset:28768
    ds_read_b64_tr_b16 v[36:37], v16 offset:30752
    ds_read_b64_tr_b16 v[38:39], v16 offset:30816
    s_waitcnt lgkmcnt(2)
    ds_write_b128 v1, v[32:35] offset:18432
    s_waitcnt lgkmcnt(1)
    ds_write_b128 v1, v[36:39] offset:19456
    s_waitcnt lgkmcnt(0)
    v_add_u32 v16, s70, v14
    s_waitcnt vmcnt(8)
    ds_read_b64_tr_b16 v[24:25], v16 offset:4096
    ds_read_b64_tr_b16 v[26:27], v16 offset:4224
    ds_read_b64_tr_b16 v[28:29], v16 offset:6144
    ds_read_b64_tr_b16 v[30:31], v16 offset:6272
    ds_read_b64_tr_b16 a[224:225], v16 offset:4104
    ds_read_b64_tr_b16 a[226:227], v16 offset:4232
    ds_read_b64_tr_b16 a[228:229], v16 offset:6152
    ds_read_b64_tr_b16 a[230:231], v16 offset:6280
    s_waitcnt lgkmcnt(6)
    ds_write_b128 v1, v[24:27] offset:22528
    s_waitcnt lgkmcnt(5)
    ds_write_b128 v1, v[28:31] offset:23552
    s_waitcnt lgkmcnt(0)
    s_add_u32 m0, s70, 4096
    s_add_u32 s47, s69, 0
    buffer_load_dwordx4 v11, s[24:27], s47 offen lds
    s_add_u32 m0, s70, 5120
    s_add_u32 s47, s69, 40960
    buffer_load_dwordx4 v11, s[24:27], s47 offen lds
    s_add_u32 m0, s70, 6144
    s_add_u32 s47, s69, 81920
    buffer_load_dwordx4 v11, s[24:27], s47 offen lds
    s_add_u32 m0, s70, 7168
    s_add_u32 s47, s69, 122880
    buffer_load_dwordx4 v11, s[24:27], s47 offen lds
    v_add_u32 v16, s64, v14
    s_waitcnt vmcnt(8)
    ds_read_b64_tr_b16 v[24:25], v16 offset:0
    ds_read_b64_tr_b16 v[26:27], v16 offset:128
    ds_read_b64_tr_b16 v[28:29], v16 offset:2048
    ds_read_b64_tr_b16 v[30:31], v16 offset:2176
    ds_read_b64_tr_b16 v[32:33], v16 offset:8
    ds_read_b64_tr_b16 v[34:35], v16 offset:136
    ds_read_b64_tr_b16 v[36:37], v16 offset:2056
    ds_read_b64_tr_b16 v[38:39], v16 offset:2184
    s_waitcnt lgkmcnt(6)
    ds_write_b128 v1, v[24:27] offset:20480
    s_waitcnt lgkmcnt(5)
    ds_write_b128 v1, v[28:31] offset:21504
    s_waitcnt lgkmcnt(4)
    ds_write_b128 v1, v[32:35] offset:24576
    s_waitcnt lgkmcnt(3)
    ds_write_b128 v1, v[36:39] offset:25600
    s_waitcnt lgkmcnt(0)
    v_add_u32 v16, s70, v14
    s_waitcnt vmcnt(4)
    ds_read_b64_tr_b16 a[232:233], v16 offset:0
    ds_read_b64_tr_b16 a[234:235], v16 offset:128
    ds_read_b64_tr_b16 a[236:237], v16 offset:2048
    ds_read_b64_tr_b16 a[238:239], v16 offset:2176
    ds_read_b64_tr_b16 v[32:33], v16 offset:8
    ds_read_b64_tr_b16 v[34:35], v16 offset:136
    ds_read_b64_tr_b16 v[36:37], v16 offset:2056
    ds_read_b64_tr_b16 v[38:39], v16 offset:2184
    s_waitcnt lgkmcnt(2)
    ds_write_b128 v1, v[32:35] offset:26624
    s_waitcnt lgkmcnt(1)
    ds_write_b128 v1, v[36:39] offset:27648
    s_waitcnt lgkmcnt(0)
    v_add_u32 v16, s70, v15
    s_waitcnt vmcnt(0)
    ds_read_b64_tr_b16 v[24:25], v16 offset:4096
    ds_read_b64_tr_b16 v[26:27], v16 offset:4160
    ds_read_b64_tr_b16 v[28:29], v16 offset:5120
    ds_read_b64_tr_b16 v[30:31], v16 offset:5184
    ds_read_b64_tr_b16 v[32:33], v16 offset:6144
    ds_read_b64_tr_b16 v[34:35], v16 offset:6208
    ds_read_b64_tr_b16 v[36:37], v16 offset:7168
    ds_read_b64_tr_b16 v[38:39], v16 offset:7232
    s_waitcnt lgkmcnt(6)
    ds_write_b128 v1, v[24:27] offset:28672
    s_waitcnt lgkmcnt(5)
    ds_write_b128 v1, v[28:31] offset:29696
    s_waitcnt lgkmcnt(4)
    ds_write_b128 v1, v[32:35] offset:30720
    s_waitcnt lgkmcnt(3)
    ds_write_b128 v1, v[36:39] offset:31744
    s_waitcnt lgkmcnt(0)
    s_load_dwordx2 s[4:5], s[0:1], 88
    s_mov_b32 s6, 256
    s_mov_b32 s7, 0x20000
    s_load_dwordx2 s[8:9], s[0:1], 32
    s_mov_b32 s10, 10240
    s_mov_b32 s11, 0x20000
    s_waitcnt lgkmcnt(0)
    s_lshl_b32 s47, s19, 3
    v_mov_b32 v8, 132
    s_mov_b32 s49, 0
CP_7:
    buffer_load_dword v9, v8, s[4:7], s47 offen sc1
    s_waitcnt vmcnt(0)
    v_cmp_gt_u32 vcc, 2097152, v9
    s_cbranch_vccz CP_8
    s_add_u32 s49, s49, 1
    s_cmp_gt_u32 s49, 400000
    s_cbranch_scc1 L_end
    s_sleep 1
    s_branch CP_7
CP_8:
    buffer_load_dwordx2 v[8:9], off, s[4:7], s47 offset:128 sc1
    s_waitcnt vmcnt(0)
    v_readfirstlane_b32 s66, v8
    v_readfirstlane_b32 s67, v9
    s_nop 0
    s_lshr_b64 s[66:67], s[66:67], s101
    s_and_b32 s101, s66, 63
    v_mov_b32 v8, 4
    s_mov_b32 s49, 0
CP_9:
    buffer_load_dword v9, v8, s[4:7], 0 offen sc1
    s_waitcnt vmcnt(0)
    v_cmp_gt_u32 vcc, 1, v9
    s_cbranch_vccz CP_10
    s_add_u32 s49, s49, 1
    s_cmp_gt_u32 s49, 400000
    s_cbranch_scc1 L_end
    s_sleep 1
    s_branch CP_9
CP_10:
    v_readfirstlane_b32 s41, v9
    s_nop 0
    s_and_b32 s41, s41, 2
    s_lshl_b32 s41, s41, 12
    v_mov_b32 v8, 0
    s_mov_b32 s49, 0
CP_11:
    buffer_load_dword v9, v8, s[4:7], 0 offen sc1
    s_waitcnt vmcnt(0)
    v_cmp_gt_u32 vcc, 1, v9
    s_cbranch_vccz CP_12
    s_add_u32 s49, s49, 1
    s_cmp_gt_u32 s49, 400000
    s_cbranch_scc1 L_end
    s_sleep 1
    s_branch CP_11
CP_12:
    v_and_b32 v8, 511, v0
    s_mov_b32 s47, 31232
    s_mov_b32 s49, 0
CP_13:
    buffer_load_dword v9, v8, s[32:35], s47 offen sc1
    s_waitcnt vmcnt(0)
    v_cmp_gt_u32 vcc, 1, v9
    s_cbranch_vccz CP_14
    s_add_u32 s49, s49, 1
    s_cmp_gt_u32 s49, 400000
    s_cbranch_scc1 L_end
    s_sleep 1
    s_branch CP_13
CP_14:
    s_mul_i32 s47, s19, 196608
    s_add_u32 s47, s47, 65536
    s_add_u32 s28, s28, s47
    s_addc_u32 s29, s29, 0
    s_mul_i32 s98, s20, 96
    s_add_u32 s98, s98, 16384
    s_mov_b32 s100, 0
    s_barrier
CH_layer_15:
    s_mul_i32 s42, s100, 34603008
    s_add_u32 s42, s42, 117440512
    s_mul_i32 s50, s100, 4194304
    s_add_u32 s50, s50, 2097152
    s_mul_i32 s96, s100, 8388608
    s_add_u32 s96, s96, 100663296
    s_lshl_b32 s47, s20, 14
    s_lshl_b32 s48, s21, 11
    s_add_u32 s47, s47, s48
    s_add_u32 s42, s42, s47
    s_lshr_b32 s47, s47, 2
    s_add_u32 s96, s96, s47
    s_add_u32 s97, s96, 2048
    s_cmp_eq_u32 s19, 0
    s_cselect_b32 s96, s96, 1073741824
    s_cselect_b32 s97, 1073741824, s97
    s_lshl_b32 s47, s19, 14
    s_add_u32 s47, s47, s41
    s_add_u32 s50, s50, s47
    s_xor_b32 s90, s50, 0x4000
    s_sub_u32 s90, s90, 32768
    s_mov_b32 s40, 0
    s_mov_b32 s43, 163840
    s_lshl_b32 s99, s100, 6
    v_lshrrev_b32 v8, 4, v0
    s_lshl_b32 s47, s21, 7
    v_bfe_u32 v9, v8, 2, 2
    v_mul_u32_u24 v9, 2560, v9
    v_bfe_u32 v11, v8, 0, 1
    v_mul_u32_u24 v11, 1280, v11
    v_add_u32 v9, v9, v11
    v_bfe_u32 v11, v8, 4, 2
    v_lshl_add_u32 v9, v11, 5, v9
    v_bfe_u32 v11, v8, 1, 1
    v_lshl_add_u32 v9, v11, 4, v9
    v_add_u32 v9, s47, v9
    s_lshl_b32 s47, s21, 5
    s_add_u32 s47, s47, 512
    v_bfe_u32 v10, v8, 4, 2
    v_mul_u32_u24 v10, 2560, v10
    v_bfe_u32 v11, v8, 2, 1
    v_mul_u32_u24 v11, 1280, v11
    v_add_u32 v10, v10, v11
    v_bfe_u32 v11, v8, 3, 1
    v_lshl_add_u32 v10, v11, 4, v10
    v_bfe_u32 v11, v8, 0, 2
    v_lshl_add_u32 v10, v11, 2, v10
    v_add_u32 v10, s47, v10
    s_mov_b32 s66, 0x05040100
    s_mov_b32 s67, 0x07060302
    s_xor_b32 s47, s19, 0
    s_mul_i32 s47, s47, 640
    buffer_load_dwordx4 v[12:15], v9, s[8:11], s47 offen
    buffer_load_dword v28, v10, s[8:11], s47 offen
    s_waitcnt vmcnt(1)
    v_perm_b32 v24, v14, v12, s66
    v_perm_b32 v25, v14, v12, s67
    v_perm_b32 v26, v15, v13, s66
    v_perm_b32 v27, v15, v13, s67
    v_min_u32 v24, -2, v24
    v_min_u32 v26, -2, v26
    s_waitcnt vmcnt(0)
    v_min_u32 v28, -2, v28
    s_xor_b32 s47, s19, 1
    s_mul_i32 s47, s47, 640
    buffer_load_dwordx4 v[12:15], v9, s[8:11], s47 offen
    buffer_load_dword v60, v10, s[8:11], s47 offen
    s_waitcnt vmcnt(1)
    v_perm_b32 v56, v14, v12, s66
    v_perm_b32 v57, v14, v12, s67
    v_perm_b32 v58, v15, v13, s66
    v_perm_b32 v59, v15, v13, s67
    v_min_u32 v56, -2, v56
    v_min_u32 v58, -2, v58
    s_waitcnt vmcnt(0)
    v_min_u32 v60, -2, v60
    v_add_u32 v61, s92, v0
    v_lshrrev_b32 v62, 2, v0
    v_add_u32 v62, s93, v62
    ds_write_b128 v61, v[24:27] offset:0
    ds_write_b32 v62, v28 offset:0
    v_and_b32 v8, 48, v0
    s_add_u32 s47, s99, 2
    s_mov_b32 s49, 0
CP_16:
    buffer_load_dword v9, v8, s[32:35], s98 offen sc1
    s_waitcnt vmcnt(0)
    v_cmp_gt_u32 vcc, s47, v9
    s_cbranch_vccz CP_17
    s_add_u32 s49, s49, 1
    s_cmp_gt_u32 s49, 400000
    s_cbranch_scc1 L_end
    s_sleep 1
    s_branch CP_16
CP_17:
    s_add_u32 m0, s63, 0
    s_add_u32 s60, s42, 8192
    buffer_load_dwordx4 v0, s[32:35], s42 offen offset:0 sc1 lds
    buffer_load_dwordx4 v0, s[32:35], s42 offen offset:1024 sc1 lds
    s_add_u32 m0, s64, 0
    s_add_u32 s42, s42, 524288
    buffer_load_dwordx4 v0, s[32:35], s60 offen offset:0 sc1 lds
    buffer_load_dwordx4 v0, s[32:35], s60 offen offset:1024 sc1 lds
    s_mov_b32 m0, 15360
    s_nop 0
    buffer_load_dwordx4 v0, s[32:35], s98 offen offset:0 sc1 lds
    v_mov_b64 v[8:9], 0
    v_mov_b64 v[10:11], 0
    v_mov_b64 v[12:13], 0
    v_mov_b64 v[14:15], 0
    v_mov_b64 v[16:17], 0
    v_mov_b64 v[18:19], 0
    v_mov_b64 v[20:21], 0
    v_mov_b64 v[22:23], 0
    v_mov_b64 v[48:49], 0
    v_mov_b64 v[50:51], 0
    v_mov_b64 v[52:53], 0
    v_mov_b64 v[54:55], 0
    s_mov_b32 s49, 0
    s_waitcnt vmcnt(0) lgkmcnt(0)
    s_cmp_lg_u32 s101, 32
    s_cbranch_scc1 CH_slow_18
.p2align 6
CH_top_34:
    s_waitcnt lgkmcnt(0)
    s_barrier
    ds_read_b128 v[24:27], v0 offset:0
    ds_read_b128 v[28:31], v0 offset:1024
    ds_read_b128 v[32:35], v1 offset:4096
    ds_read_b128 v[36:39], v1 offset:5120
    s_waitcnt lgkmcnt(3)
    v_smfmac_f32_16x16x64_bf16 v[8:11], v[24:27], v[64:71], v2
    ds_read_b128 v[40:43], v1 offset:6144
    ds_read_b128 v[44:47], v1 offset:7168
    v_smfmac_f32_16x16x64_bf16 v[12:15], v[24:27], v[72:79], v2
    v_smfmac_f32_16x16x64_bf16 v[16:19], v[24:27], v[80:87], v2
    v_smfmac_f32_16x16x64_bf16 v[20:23], v[24:27], v[88:95], v2
    s_waitcnt lgkmcnt(2)
    v_smfmac_f32_16x16x64_bf16 v[48:51], v[24:27], v[32:39], v2
    ds_read_b128 v[32:35], v1 offset:8192
    ds_read_b128 v[36:39], v1 offset:9216
    v_smfmac_f32_16x16x64_bf16 v[52:55], v[24:27], v[96:103], v2
    ds_read_b128 v[24:27], v0 offset:2048
    v_smfmac_f32_16x16x64_bf16 v[8:11], v[28:31], v[104:111], v2
    v_smfmac_f32_16x16x64_bf16 v[12:15], v[28:31], v[112:119], v2
    s_waitcnt lgkmcnt(3)
    v_smfmac_f32_16x16x64_bf16 v[16:19], v[28:31], v[40:47], v2
    ds_read_b128 v[40:43], v1 offset:10240
    ds_read_b128 v[44:47], v1 offset:11264
    v_smfmac_f32_16x16x64_bf16 v[20:23], v[28:31], v[120:127], v2
    v_smfmac_f32_16x16x64_bf16 v[48:51], v[28:31], v[128:135], v2
    v_smfmac_f32_16x16x64_bf16 v[52:55], v[28:31], v[136:143], v2
    ds_read_b128 v[28:31], v0 offset:3072
    s_waitcnt lgkmcnt(3)
    v_smfmac_f32_16x16x64_bf16 v[8:11], v[24:27], v[144:151], v2
    v_smfmac_f32_16x16x64_bf16 v[12:15], v[24:27], v[32:39], v2
    ds_read_b128 v[32:35], v1 offset:12288
    ds_read_b128 v[36:39], v1 offset:13312
    v_smfmac_f32_16x16x64_bf16 v[16:19], v[24:27], v[152:159], v2
    v_smfmac_f32_16x16x64_bf16 v[20:23], v[24:27], v[160:167], v2
    v_smfmac_f32_16x16x64_bf16 v[48:51], v[24:27], v[168:175], v2
    s_waitcnt vmcnt(1)
    ds_write_b128 v61, v[56:59] offset:5120
    v_smfmac_f32_16x16x64_bf16 v[52:55], v[24:27], v[176:183], v2
    ds_read_b128 v[24:27], v0 offset:4096
    s_waitcnt vmcnt(0)
    ds_write_b32 v62, v60 offset:5120
    v_max3_u32 v63, v56, v58, v60
    s_waitcnt lgkmcnt(5)
    v_smfmac_f32_16x16x64_bf16 v[8:11], v[28:31], v[40:47], v2
    ds_read_b128 v[40:43], v1 offset:14336
    v_cmp_eq_u32 vcc, -1, v63
    v_smfmac_f32_16x16x64_bf16 v[12:15], v[28:31], v[184:191], v2
    ds_read_b128 v[44:47], v1 offset:15360
    v_smfmac_f32_16x16x64_bf16 v[16:19], v[28:31], v[192:199], v2
    s_cbranch_vccnz CH_re_36
CH_bk_37:
    v_smfmac_f32_16x16x64_bf16 v[20:23], v[28:31], v[200:207], v2
    s_waitcnt lgkmcnt(2)
    s_barrier
    ds_read_b128 v[28:31], v0 offset:5120
    v_smfmac_f32_16x16x64_bf16 v[8:11], v[24:27], v[208:215], v2
    v_smfmac_f32_16x16x64_bf16 v[12:15], v[24:27], v[216:223], v2
    v_smfmac_f32_16x16x64_bf16 v[16:19], v[24:27], v[224:231], v2
    s_add_u32 m0, s63, 8192
    s_add_u32 s60, s42, 8192
    buffer_load_dwordx4 v0, s[32:35], s42 offen offset:0 sc1 lds
    v_smfmac_f32_16x16x64_bf16 v[20:23], v[24:27], v[32:39], v2
    ds_read_b128 v[24:27], v0 offset:6144
    ds_read_b128 v[32:35], v1 offset:16384
    s_waitcnt lgkmcnt(2)
    v_smfmac_f32_16x16x64_bf16 v[8:11], v[28:31], v[232:239], v2
    ds_read_b128 v[36:39], v1 offset:17408
    v_smfmac_f32_16x16x64_bf16 v[12:15], v[28:31], v[240:247], v2
    v_smfmac_f32_16x16x64_bf16 v[16:19], v[28:31], v[248:255], v2
    buffer_load_dwordx4 v0, s[32:35], s42 offen offset:1024 sc1 lds
    v_smfmac_f32_16x16x64_bf16 v[20:23], v[28:31], a[0:7], v2
    ds_read_b128 v[28:31], v0 offset:7168
    s_waitcnt lgkmcnt(3)
    v_smfmac_f32_16x16x64_bf16 v[8:11], v[24:27], v[40:47], v2
    ds_read_b128 v[40:43], v1 offset:18432
    ds_read_b128 v[44:47], v1 offset:19456
    v_smfmac_f32_16x16x64_bf16 v[12:15], v[24:27], a[8:15], v2
    v_smfmac_f32_16x16x64_bf16 v[16:19], v[24:27], a[16:23], v2
    s_add_u32 m0, s64, 2048
    s_add_u32 s42, s42, 524288
    buffer_load_dwordx4 v0, s[32:35], s60 offen offset:0 sc1 lds
    v_smfmac_f32_16x16x64_bf16 v[20:23], v[24:27], a[24:31], v2
    ds_read_b128 v[24:27], v0 offset:8192
    s_waitcnt lgkmcnt(3)
    v_smfmac_f32_16x16x64_bf16 v[8:11], v[28:31], v[32:39], v2
    ds_read_b128 v[32:35], v0 offset:9216
    v_smfmac_f32_16x16x64_bf16 v[12:15], v[28:31], a[32:39], v2
    v_smfmac_f32_16x16x64_bf16 v[16:19], v[28:31], a[40:47], v2
    buffer_load_dwordx4 v0, s[32:35], s60 offen offset:1024 sc1 lds
    v_smfmac_f32_16x16x64_bf16 v[20:23], v[28:31], a[48:55], v2
    ds_read_b128 v[28:31], v0 offset:3072
    s_waitcnt lgkmcnt(2)
    v_smfmac_f32_16x16x64_bf16 v[8:11], v[24:27], a[56:63], v2
    ds_read_b128 v[56:59], v0 offset:18432
    ds_read_b128 v[60:63], v0 offset:19456
    v_smfmac_f32_16x16x64_bf16 v[12:15], v[24:27], v[40:47], v2
    s_waitcnt lgkmcnt(3)
    v_smfmac_f32_16x16x64_bf16 v[8:11], v[32:35], a[64:71], v2
    ds_read_b128 v[40:43], v0 offset:16384
    ds_read_b128 v[44:47], v0 offset:17408
    v_smfmac_f32_16x16x64_bf16 v[12:15], v[32:35], a[72:79], v2
    s_mov_b32 m0, 15360
    s_nop 0
    buffer_load_dwordx4 v0, s[32:35], s98 offen offset:0 sc1 lds
    v_smfmac_f32_16x16x64_bf16 v[16:19], v[24:27], a[80:87], v2
    v_add_f32 v8, v8, v10
    v_smfmac_f32_16x16x64_bf16 v[16:19], v[32:35], a[88:95], v2
    v_add_f32 v9, v9, v11
    v_add_f32 v12, v12, v14
    v_smfmac_f32_16x16x64_bf16 v[20:23], v[24:27], a[96:103], v2
    ds_read_b128 v[24:27], v0 offset:4096
    v_add_f32 v13, v13, v15
    v_cvt_pk_bf16_f32 v8, v8, v9
    v_smfmac_f32_16x16x64_bf16 v[20:23], v[32:35], a[104:111], v2
    s_waitcnt lgkmcnt(5)
    ds_read_b128 v[32:35], v0 offset:5120
    v_cvt_pk_bf16_f32 v9, v12, v13
    v_add_f32 v16, v16, v18
    v_add_f32 v17, v17, v19
    v_smfmac_f32_16x16x64_bf16 v[48:51], v[28:31], a[112:119], v2
    ds_write_b64 v3, v[8:9]
    v_cvt_pk_bf16_f32 v10, v16, v17
    v_add_f32 v20, v20, v22
    v_add_f32 v21, v21, v23
    v_cvt_pk_bf16_f32 v11, v20, v21
    v_smfmac_f32_16x16x64_bf16 v[52:55], v[28:31], a[120:127], v2
    s_waitcnt lgkmcnt(2)
    ds_write_b64 v3, v[10:11] offset:2176
    v_smfmac_f32_16x16x64_bf16 v[48:51], v[24:27], a[128:135], v2
    ds_read_b128 v[28:31], v0 offset:6144
    v_lshrrev_b32 v12, 1, v0
    v_smfmac_f32_16x16x64_bf16 v[52:55], v[24:27], a[136:143], v2
    s_waitcnt lgkmcnt(3)
    ds_read_b128 v[24:27], v0 offset:7168
    v_permlane16_swap_b32 v10, v11
    v_smfmac_f32_16x16x64_bf16 v[48:51], v[32:35], a[144:151], v2
    buffer_store_dwordx2 v[10:11], v12, s[32:35], s96 offen sc1
    s_waitcnt lgkmcnt(2)
    s_barrier
    ds_read_b64_tr_b16 v[12:13], v4 offset:0
    ds_read_b64_tr_b16 v[14:15], v4 offset:32
    v_smfmac_f32_16x16x64_bf16 v[52:55], v[32:35], a[152:159], v2
    s_waitcnt lgkmcnt(3)
    ds_read_b64_tr_b16 v[16:17], v4 offset:1088
    ds_read_b64_tr_b16 v[18:19], v4 offset:1120
    ds_read_b64_tr_b16 v[20:21], v4 offset:2176
    v_smfmac_f32_16x16x64_bf16 v[48:51], v[28:31], a[160:167], v2
    ds_read_b64_tr_b16 v[22:23], v4 offset:2208
    ds_read_b64_tr_b16 v[36:37], v4 offset:3264
    ds_read_b64_tr_b16 v[38:39], v4 offset:3296
    v_smfmac_f32_16x16x64_bf16 v[52:55], v[28:31], a[168:175], v2
    s_waitcnt lgkmcnt(8)
    ds_read_b128 v[32:35], v0 offset:22528
    ds_read_b128 v[28:31], v0 offset:21504
    v_smfmac_f32_16x16x64_bf16 v[48:51], v[24:27], a[176:183], v2
    v_smfmac_f32_16x16x64_bf16 v[52:55], v[24:27], a[184:191], v2
    ds_read_b128 v[24:27], v0 offset:20480
    s_waitcnt lgkmcnt(9)
    v_mfma_f32_16x16x32_bf16 v[8:11], v[40:43], v[12:15], 0
    s_waitcnt lgkmcnt(7)
    v_mfma_f32_16x16x32_bf16 v[8:11], v[44:47], v[16:19], v[8:11]
    ds_read_b128 v[44:47], v0 offset:23552
    v_mfma_f32_16x16x32_bf16 v[40:43], v[56:59], v[12:15], 0
    v_mfma_f32_16x16x32_bf16 v[40:43], v[60:63], v[16:19], v[40:43]
    s_waitcnt lgkmcnt(6)
    ds_read_b128 v[60:63], v0 offset:8192
    v_add_f32_dpp v8, v10, v8 quad_perm:[2,3,2,3] row_mask:0xf bank_mask:0xf
    v_mfma_f32_16x16x32_bf16 v[56:59], v[20:23], v[12:15], 0
    s_waitcnt lgkmcnt(5)
    v_add_f32_dpp v9, v11, v9 quad_perm:[2,3,2,3] row_mask:0xf bank_mask:0xf
    v_max_f32 v10, v8, v9
    v_mfma_f32_16x16x32_bf16 v[56:59], v[36:39], v[16:19], v[56:59]
    s_waitcnt lgkmcnt(2)
    ds_read_b128 v[36:39], v0 offset:9216
    v_add_f32_dpp v40, v42, v40 quad_perm:[2,3,2,3] row_mask:0xf bank_mask:0xf
    v_mfma_f32_16x16x32_bf16 v[20:23], v[24:27], v[12:15], 0
    v_add_f32_dpp v41, v43, v41 quad_perm:[2,3,2,3] row_mask:0xf bank_mask:0xf
    v_max3_f32 v10, v10, v40, v41
    v_mfma_f32_16x16x32_bf16 v[20:23], v[28:31], v[16:19], v[20:23]
    v_add_f32_dpp v56, v58, v56 quad_perm:[2,3,2,3] row_mask:0xf bank_mask:0xf
    v_mfma_f32_16x16x32_bf16 v[24:27], v[32:35], v[12:15], 0
    s_waitcnt lgkmcnt(2)
    v_add_f32_dpp v57, v59, v57 quad_perm:[2,3,2,3] row_mask:0xf bank_mask:0xf
    v_max3_f32 v10, v10, v56, v57
    v_mfma_f32_16x16x32_bf16 v[24:27], v[44:47], v[16:19], v[24:27]
    s_waitcnt lgkmcnt(1)
    v_add_f32_dpp v20, v22, v20 quad_perm:[2,3,2,3] row_mask:0xf bank_mask:0xf
    v_add_f32_dpp v21, v23, v21 quad_perm:[2,3,2,3] row_mask:0xf bank_mask:0xf
    v_smfmac_f32_16x16x64_bf16 v[48:51], v[60:63], a[192:199], v2
    ds_read_b128 v[32:35], v1 offset:0
    v_max3_f32 v10, v10, v20, v21
    v_mov_b32 v17, 0
    s_nop 0
    v_add_f32_dpp v24, v26, v24 quad_perm:[2,3,2,3] row_mask:0xf bank_mask:0xf
    v_add_f32_dpp v25, v27, v25 quad_perm:[2,3,2,3] row_mask:0xf bank_mask:0xf
    v_max3_f32 v10, v10, v24, v25
    v_mov_b32 v11, v10
    v_smfmac_f32_16x16x64_bf16 v[52:55], v[60:63], a[200:207], v2
    s_waitcnt lgkmcnt(1)
    ds_read_b128 v[44:47], v1 offset:1024
    v_permlane32_swap_b32 v10, v11
    v_max_f32 v10, v10, v11
    v_mov_b32 v11, v10
    v_smfmac_f32_16x16x64_bf16 v[48:51], v[36:39], a[208:215], v2
    s_barrier
    v_permlane16_swap_b32 v10, v11
    v_max_f32 v10, v10, v11
    v_mul_f32 v10, s51, v10
    v_fma_f32 v8, v8, s51, -v10
    v_smfmac_f32_16x16x64_bf16 v[52:55], v[36:39], a[216:223], v2
    v_fma_f32 v9, v9, s51, -v10
    v_exp_f32 v8, v8
    v_fma_f32 v40, v40, s51, -v10
    v_exp_f32 v9, v9
    v_fma_f32 v41, v41, s51, -v10
    v_exp_f32 v40, v40
    v_cvt_pk_bf16_f32 v12, v8, v9
    v_fma_f32 v20, v20, s51, -v10
    v_exp_f32 v41, v41
    v_fma_f32 v21, v21, s51, -v10
    v_exp_f32 v20, v20
    v_cvt_pk_bf16_f32 v13, v40, v41
    v_fma_f32 v24, v24, s51, -v10
    v_exp_f32 v21, v21
    v_fma_f32 v25, v25, s51, -v10
    v_exp_f32 v24, v24
    v_cvt_pk_bf16_f32 v14, v20, v21
    v_fma_f32 v56, v56, s51, -v10
    v_exp_f32 v25, v25
    v_mov_b64 v[28:29], s[22:23]
    v_mov_b64 v[30:31], s[22:23]
    v_cvt_pk_bf16_f32 v15, v24, v25
    v_fma_f32 v57, v57, s51, -v10
    v_exp_f32 v56, v56
    v_mfma_f32_16x16x32_bf16 v[60:63], v[28:31], v[12:15], 0
    v_exp_f32 v57, v57
    s_waitcnt lgkmcnt(1)
    v_mfma_f32_16x16x32_bf16 v[32:35], v[32:35], v[12:15], 0
    v_cvt_pk_bf16_f32 v16, v56, v57
    v_add_f32 v48, v48, v50
    s_waitcnt lgkmcnt(0)
    v_mfma_f32_16x16x32_bf16 v[44:47], v[44:47], v[12:15], 0
    v_add_f32 v49, v49, v51
    v_add_f32 v52, v52, v54
    v_mfma_f32_16x16x16_bf16 v[60:63], v[28:29], v[16:17], v[60:63]
    v_add_f32 v53, v53, v55
    v_cvt_pk_bf16_f32 v22, v48, v49
    v_cvt_pk_bf16_f32 v23, v52, v53
    v_mov_b32 v18, 0
    v_mov_b32 v19, v16
    v_mfma_f32_16x16x16_bf16 v[32:35], v[22:23], v[16:17], v[32:35]
    ds_read_b128 v[48:51], v1 offset:20480
    ds_read_b128 v[52:55], v1 offset:21504
    v_mfma_f32_16x16x16_bf16 v[44:47], v[22:23], v[18:19], v[44:47]
    ds_read_b128 v[36:39], v1 offset:24576
    ds_read_b128 v[40:43], v1 offset:25600
    v_rcp_f32 v10, v60
    v_mov_b64 v[12:13], 0
    v_lshrrev_b32 v14, 1, v0
    v_permlane16_swap_b32 v22, v23
    v_pk_mul_f32 v[32:33], v[32:33], v[10:11] op_sel_hi:[1,0]
    v_pk_mul_f32 v[34:35], v[34:35], v[10:11] op_sel_hi:[1,0]
    v_cvt_pk_bf16_f32 v32, v32, v33
    v_cvt_pk_bf16_f32 v33, v34, v35
    v_pk_mul_f32 v[44:45], v[44:45], v[10:11] op_sel_hi:[1,0]
    v_pk_mul_f32 v[46:47], v[46:47], v[10:11] op_sel_hi:[1,0]
    v_cvt_pk_bf16_f32 v34, v44, v45
    v_cvt_pk_bf16_f32 v35, v46, v47
    v_mfma_f32_16x16x16_bf16 v[16:19], v[12:13], v[12:13], 0
    ds_write_b128 v5, v[32:35]
    buffer_store_dwordx2 v[22:23], v14, s[32:35], s97 offen sc1
    v_mfma_f32_16x16x16_bf16 v[20:23], v[12:13], v[12:13], 0
    ds_read_b128 v[56:59], v1 offset:22528
    ds_read_b128 v[60:63], v1 offset:23552
    v_mfma_f32_16x16x16_bf16 v[24:27], v[12:13], v[12:13], 0
    v_mfma_f32_16x16x16_bf16 v[28:31], v[12:13], v[12:13], 0
    v_mfma_f32_16x16x16_bf16 v[8:11], v[12:13], v[12:13], 0
    s_waitcnt lgkmcnt(2)
    s_barrier
    ds_read_b128 v[32:35], v0 offset:10240
    ds_read_b128 v[44:47], v0 offset:11264
    v_lshlrev_b32 v15, 3, v0
    v_bfe_u32 v14, v0, 2, 6
    v_and_or_b32 v14, v15, s94, v14
    s_waitcnt lgkmcnt(1)
    v_smfmac_f32_16x16x64_bf16 v[16:19], v[32:35], v[48:55], v2
    ds_read_b128 v[48:51], v1 offset:26624
    ds_read_b128 v[52:55], v1 offset:27648
    s_waitcnt lgkmcnt(2)
    v_smfmac_f32_16x16x64_bf16 v[16:19], v[44:47], v[56:63], v2
    ds_read_b128 v[56:59], v1 offset:28672
    ds_read_b128 v[60:63], v1 offset:29696
    v_smfmac_f32_16x16x64_bf16 v[20:23], v[32:35], v[36:43], v2
    ds_read_b128 v[36:39], v1 offset:30720
    ds_read_b128 v[40:43], v1 offset:31744
    v_smfmac_f32_16x16x64_bf16 v[20:23], v[44:47], a[224:231], v2
    v_add_f32 v16, v16, v18
    v_add_f32 v17, v17, v19
    v_smfmac_f32_16x16x64_bf16 v[24:27], v[32:35], a[232:239], v2
    v_smfmac_f32_16x16x64_bf16 v[24:27], v[44:47], a[240:247], v2
    s_waitcnt lgkmcnt(4)
    v_add_f32 v20, v20, v22
    v_add_f32 v21, v21, v23
    v_smfmac_f32_16x16x64_bf16 v[28:31], v[32:35], v[48:55], v2
    v_cvt_pk_bf16_f32 v16, v16, v20
    v_cvt_pk_bf16_f32 v17, v17, v21
    v_smfmac_f32_16x16x64_bf16 v[28:31], v[44:47], a[248:255], v2
    s_waitcnt lgkmcnt(2)
    v_and_or_b32 v16, v16, -2, 1
    v_smfmac_f32_16x16x64_bf16 v[8:11], v[32:35], v[56:63], v2
    s_waitcnt lgkmcnt(0)
    buffer_store_dwordx2 v[16:17], v7, s[28:31], 0 offen
    v_add_f32 v24, v24, v26
    v_add_f32 v25, v25, v27
    v_smfmac_f32_16x16x64_bf16 v[8:11], v[44:47], v[36:43], v2
    v_add_f32 v28, v28, v30
    v_add_f32 v29, v29, v31
    s_cmp_eq_u32 s21, 3
    v_cvt_pk_bf16_f32 v24, v24, v28
    v_cvt_pk_bf16_f32 v25, v25, v29
    v_and_or_b32 v24, v24, -2, 1
    buffer_store_dwordx2 v[24:25], v7, s[28:31], s61 offen
    s_nop 0
    v_add_f32 v8, v8, v10
    v_add_f32 v9, v9, v11
    v_cvt_pk_bf16_f32 v8, v8, v9
    v_and_or_b32 v8, v8, -2, 1
    buffer_store_dword v8, v14, s[28:31], s62 offen
    s_cbranch_scc1 CH_h_38
    v_lshrrev_b32 v56, s91, v0
    v_and_b32 v56, 16, v56
    v_lshlrev_b32_e64 v56, v56, s65
    v_cndmask_b32 v40, 0, v56, s[52:53]
    v_cndmask_b32 v41, 0, v56, s[54:55]
    v_cndmask_b32 v42, 0, v56, s[56:57]
    v_cndmask_b32 v43, 0, v56, s[58:59]
    v_mov_b64 v[58:59], -1
    s_mov_b32 s44, s43
    s_add_u32 s43, s43, 0x2000
    s_and_b32 s43, s43, 0x7fff
    s_add_u32 s43, s43, 163840
    s_mov_b32 s49, 0
    s_add_u32 s40, s40, 1
    s_add_u32 s90, s90, 32768
    s_add_u32 s96, s96, 131072
    s_add_u32 s97, s97, 131072
    s_cmp_lg_u32 s95, 0
    s_cbranch_scc1 CH_nt_42
    s_nop 5
    s_cmp_le_u32 s21, 0
    s_cbranch_scc1 CH_d_44
    s_nop 7
    s_cmp_le_u32 s21, 1
    s_cbranch_scc1 CH_d_44
    s_nop 7
CH_d_44:
    buffer_load_dwordx4 v[32:35], v0, s[28:31], s46 offen offset:0 sc1
    buffer_load_dwordx4 v[36:39], v0, s[28:31], s46 offen offset:1024 sc1
    v_add_u32 v61, s92, v0
    v_lshrrev_b32 v62, 2, v0
    v_add_u32 v62, s93, v62
    v_mov_b64 v[8:9], 0
    v_mov_b64 v[10:11], 0
    v_mov_b64 v[12:13], 0
    v_mov_b64 v[14:15], 0
    v_mov_b64 v[48:49], 0
    v_mov_b64 v[50:51], 0
    v_mov_b64 v[52:53], 0
    v_mov_b64 v[54:55], 0
    s_cmp_eq_u32 s21, 2
    s_cselect_b32 s47, 0, 1
    s_nop 15
    buffer_load_dwordx4 v[24:27], v0, s[28:31], s46 offen offset:0 sc1
    buffer_load_dwordx4 v[28:31], v0, s[28:31], s46 offen offset:1024 sc1
CH_h_41:
    s_waitcnt vmcnt(3)
    v_mfma_f32_16x16x32_bf16 v[44:47], v[40:43], v[32:35], 0
    s_waitcnt vmcnt(2)
    v_mfma_f32_16x16x32_bf16 v[44:47], v[40:43], v[36:39], v[44:47]
    v_bitop3_b32 v56, v33, v35, v37 bitop3:0x80
    v_bitop3_b32 v57, v32, v34, v36 bitop3:0x80
    v_bitop3_b32 v56, v56, v39, s47 bitop3:0xea
    v_bitop3_b32 v56, v56, v57, v38 bitop3:0x80
    v_and_b32 v56, 1, v56
    v_cmp_ne_u32 vcc, 1, v56
CH_ok_45:
    s_nop 1
    v_add_f32_dpp v44, v44, v44 row_ror:8 row_mask:0xf bank_mask:0xf
    v_add_f32_dpp v45, v45, v45 row_ror:8 row_mask:0xf bank_mask:0xf
    v_add_f32_dpp v46, v46, v46 row_ror:8 row_mask:0xf bank_mask:0xf
    v_add_f32_dpp v47, v47, v47 row_ror:8 row_mask:0xf bank_mask:0xf
    v_add_f32_dpp v44, v44, v44 row_ror:4 row_mask:0xf bank_mask:0xf
    v_add_f32_dpp v45, v45, v45 row_ror:4 row_mask:0xf bank_mask:0xf
    v_add_f32_dpp v46, v46, v46 row_ror:4 row_mask:0xf bank_mask:0xf
    v_add_f32_dpp v47, v47, v47 row_ror:4 row_mask:0xf bank_mask:0xf
    v_cvt_pk_bf16_f32 v56, v44, v45
    v_cvt_pk_bf16_f32 v57, v46, v47
    v_min_u32 v56, -2, v56
    v_min_u32 v57, -2, v57
    s_cbranch_vccnz CH_h_40
    buffer_store_dwordx2 v[56:57], v6, s[28:31], s43 offen
CH_x0_43:
    s_barrier
    buffer_store_dwordx2 v[56:57], v6, s[36:39], s50 offen sc1
    buffer_store_dwordx2 v[58:59], v6, s[28:31], s44 offen
    s_add_u32 s50, s50, 32768
    v_mov_b64 v[16:17], 0
    v_mov_b64 v[18:19], 0
    v_mov_b64 v[20:21], 0
    v_mov_b64 v[22:23], 0
    s_nop 15
    s_nop 15
    s_nop 15
    s_nop 15
    s_nop 3
    s_branch CH_h_39
CH_h_38:
    v_add_u32 v61, s92, v0
    v_lshrrev_b32 v62, 2, v0
    v_add_u32 v62, s93, v62
    v_mov_b64 v[48:49], 0
    v_mov_b64 v[50:51], 0
    v_mov_b64 v[52:53], 0
    v_mov_b64 v[54:55], 0
    s_mov_b32 s44, s43
    s_add_u32 s43, s43, 0x2000
    s_and_b32 s43, s43, 0x7fff
    s_add_u32 s43, s43, 163840
    s_mov_b32 s49, 0
    s_add_u32 s40, s40, 1
    s_add_u32 s90, s90, 32768
    s_add_u32 s96, s96, 131072
    s_add_u32 s97, s97, 131072
    v_mfma_f32_32x32x2_f32 v[8:23], v48, v48, 0
    v_mfma_f32_32x32x2_f32 v[8:23], v48, v48, v[8:23]
    v_mfma_f32_32x32x2_f32 v[8:23], v48, v48, v[8:23]
    v_mfma_f32_32x32x2_f32 v[8:23], v48, v48, v[8:23]
    v_mfma_f32_32x32x2_f32 v[8:23], v48, v48, v[8:23]
    s_waitcnt vmcnt(0)
    v_and_b32 v40, 48, v0
    ds_read_b32 v41, v40 offset:15360
    s_add_u32 s47, s40, 2
    s_min_u32 s47, s47, 64
    s_add_u32 s47, s47, s99
CH_fb_47:
    s_waitcnt lgkmcnt(0)
    v_cmp_gt_u32 vcc, s47, v41
    s_cbranch_vccnz CH_fp_46
    v_mfma_f32_32x32x2_f32 v[8:23], v48, v48, v[8:23]
    s_barrier
    s_nop 15
    s_nop 15
    s_nop 15
    s_nop 15
    s_nop 15
CH_h_39:
    buffer_load_dwordx4 v[24:27], v61, s[28:31], s43 offen sc1
    buffer_load_dword v28, v62, s[28:31], s43 offen sc1
    s_waitcnt vmcnt(1)
    ds_write_b128 v61, v[24:27] offset:0
    s_waitcnt vmcnt(0)
    ds_write_b32 v62, v28 offset:0
    v_max3_u32 v63, v24, v26, v28
    v_cmp_eq_u32 vcc, -1, v63
    s_cbranch_vccnz CH_re_48
CH_bk_49:
    buffer_load_dwordx4 v[56:59], v61, s[36:39], s90 offen sc1
    buffer_load_dword v60, v62, s[36:39], s90 offen sc1
    s_waitcnt lgkmcnt(0)
    s_barrier
    ds_read_b128 v[24:27], v0 offset:0
    ds_read_b128 v[28:31], v0 offset:1024
    ds_read_b128 v[32:35], v1 offset:4096
    ds_read_b128 v[36:39], v1 offset:5120
    s_waitcnt lgkmcnt(3)
    v_smfmac_f32_16x16x64_bf16 v[8:11], v[24:27], v[64:71], v2
    ds_read_b128 v[40:43], v1 offset:6144
    ds_read_b128 v[44:47], v1 offset:7168
    v_smfmac_f32_16x16x64_bf16 v[12:15], v[24:27], v[72:79], v2
    v_smfmac_f32_16x16x64_bf16 v[16:19], v[24:27], v[80:87], v2
    v_smfmac_f32_16x16x64_bf16 v[20:23], v[24:27], v[88:95], v2
    s_waitcnt lgkmcnt(2)
    v_smfmac_f32_16x16x64_bf16 v[48:51], v[24:27], v[32:39], v2
    ds_read_b128 v[32:35], v1 offset:8192
    ds_read_b128 v[36:39], v1 offset:9216
    v_smfmac_f32_16x16x64_bf16 v[52:55], v[24:27], v[96:103], v2
    ds_read_b128 v[24:27], v0 offset:2048
    v_smfmac_f32_16x16x64_bf16 v[8:11], v[28:31], v[104:111], v2
    v_smfmac_f32_16x16x64_bf16 v[12:15], v[28:31], v[112:119], v2
    s_waitcnt lgkmcnt(3)
    v_smfmac_f32_16x16x64_bf16 v[16:19], v[28:31], v[40:47], v2
    ds_read_b128 v[40:43], v1 offset:10240
    ds_read_b128 v[44:47], v1 offset:11264
    v_smfmac_f32_16x16x64_bf16 v[20:23], v[28:31], v[120:127], v2
    v_smfmac_f32_16x16x64_bf16 v[48:51], v[28:31], v[128:135], v2
    v_smfmac_f32_16x16x64_bf16 v[52:55], v[28:31], v[136:143], v2
    ds_read_b128 v[28:31], v0 offset:3072
    s_waitcnt lgkmcnt(3)
    v_smfmac_f32_16x16x64_bf16 v[8:11], v[24:27], v[144:151], v2
    v_smfmac_f32_16x16x64_bf16 v[12:15], v[24:27], v[32:39], v2
    ds_read_b128 v[32:35], v1 offset:12288
    ds_read_b128 v[36:39], v1 offset:13312
    v_smfmac_f32_16x16x64_bf16 v[16:19], v[24:27], v[152:159], v2
    v_smfmac_f32_16x16x64_bf16 v[20:23], v[24:27], v[160:167], v2
    v_smfmac_f32_16x16x64_bf16 v[48:51], v[24:27], v[168:175], v2
    s_waitcnt vmcnt(1)
    ds_write_b128 v61, v[56:59] offset:5120
    v_smfmac_f32_16x16x64_bf16 v[52:55], v[24:27], v[176:183], v2
    ds_read_b128 v[24:27], v0 offset:4096
    s_waitcnt vmcnt(0)
    ds_write_b32 v62, v60 offset:5120
    v_max3_u32 v63, v56, v58, v60
    s_waitcnt lgkmcnt(5)
    v_smfmac_f32_16x16x64_bf16 v[8:11], v[28:31], v[40:47], v2
    ds_read_b128 v[40:43], v1 offset:14336
    v_cmp_eq_u32 vcc, -1, v63
    v_smfmac_f32_16x16x64_bf16 v[12:15], v[28:31], v[184:191], v2
    ds_read_b128 v[44:47], v1 offset:15360
    v_smfmac_f32_16x16x64_bf16 v[16:19], v[28:31], v[192:199], v2
    s_cbranch_vccnz CH_re_50
CH_bk_51:
    v_smfmac_f32_16x16x64_bf16 v[20:23], v[28:31], v[200:207], v2
    s_waitcnt lgkmcnt(2)
    s_barrier
    ds_read_b128 v[28:31], v0 offset:5120
    v_smfmac_f32_16x16x64_bf16 v[8:11], v[24:27], v[208:215], v2
    v_smfmac_f32_16x16x64_bf16 v[12:15], v[24:27], v[216:223], v2
    v_smfmac_f32_16x16x64_bf16 v[16:19], v[24:27], v[224:231], v2
    s_add_u32 m0, s63, 0
    s_add_u32 s60, s42, 8192
    buffer_load_dwordx4 v0, s[32:35], s42 offen offset:0 sc1 lds
    v_smfmac_f32_16x16x64_bf16 v[20:23], v[24:27], v[32:39], v2
    ds_read_b128 v[24:27], v0 offset:6144
    ds_read_b128 v[32:35], v1 offset:16384
    s_waitcnt lgkmcnt(2)
    v_smfmac_f32_16x16x64_bf16 v[8:11], v[28:31], v[232:239], v2
    ds_read_b128 v[36:39], v1 offset:17408
    v_smfmac_f32_16x16x64_bf16 v[12:15], v[28:31], v[240:247], v2
    v_smfmac_f32_16x16x64_bf16 v[16:19], v[28:31], v[248:255], v2
    buffer_load_dwordx4 v0, s[32:35], s42 offen offset:1024 sc1 lds
    v_smfmac_f32_16x16x64_bf16 v[20:23], v[28:31], a[0:7], v2
    ds_read_b128 v[28:31], v0 offset:7168
    s_waitcnt lgkmcnt(3)
    v_smfmac_f32_16x16x64_bf16 v[8:11], v[24:27], v[40:47], v2
    ds_read_b128 v[40:43], v1 offset:18432
    ds_read_b128 v[44:47], v1 offset:19456
    v_smfmac_f32_16x16x64_bf16 v[12:15], v[24:27], a[8:15], v2
    v_smfmac_f32_16x16x64_bf16 v[16:19], v[24:27], a[16:23], v2
    s_add_u32 m0, s64, 0
    s_add_u32 s42, s42, 524288
    buffer_load_dwordx4 v0, s[32:35], s60 offen offset:0 sc1 lds
    v_smfmac_f32_16x16x64_bf16 v[20:23], v[24:27], a[24:31], v2
    ds_read_b128 v[24:27], v0 offset:8192
    s_waitcnt lgkmcnt(3)
    v_smfmac_f32_16x16x64_bf16 v[8:11], v[28:31], v[32:39], v2
    ds_read_b128 v[32:35], v0 offset:9216
    v_smfmac_f32_16x16x64_bf16 v[12:15], v[28:31], a[32:39], v2
    v_smfmac_f32_16x16x64_bf16 v[16:19], v[28:31], a[40:47], v2
    buffer_load_dwordx4 v0, s[32:35], s60 offen offset:1024 sc1 lds
    v_smfmac_f32_16x16x64_bf16 v[20:23], v[28:31], a[48:55], v2
    ds_read_b128 v[28:31], v0 offset:3072
    s_waitcnt lgkmcnt(2)
    v_smfmac_f32_16x16x64_bf16 v[8:11], v[24:27], a[56:63], v2
    ds_read_b128 v[56:59], v0 offset:26624
    ds_read_b128 v[60:63], v0 offset:27648
    v_smfmac_f32_16x16x64_bf16 v[12:15], v[24:27], v[40:47], v2
    s_waitcnt lgkmcnt(3)
    v_smfmac_f32_16x16x64_bf16 v[8:11], v[32:35], a[64:71], v2
    ds_read_b128 v[40:43], v0 offset:24576
    ds_read_b128 v[44:47], v0 offset:25600
    v_smfmac_f32_16x16x64_bf16 v[12:15], v[32:35], a[72:79], v2
    s_mov_b32 m0, 15360
    s_nop 0
    buffer_load_dwordx4 v0, s[32:35], s98 offen offset:0 sc1 lds
    v_smfmac_f32_16x16x64_bf16 v[16:19], v[24:27], a[80:87], v2
    v_add_f32 v8, v8, v10
    v_smfmac_f32_16x16x64_bf16 v[16:19], v[32:35], a[88:95], v2
    v_add_f32 v9, v9, v11
    v_add_f32 v12, v12, v14
    v_smfmac_f32_16x16x64_bf16 v[20:23], v[24:27], a[96:103], v2
    ds_read_b128 v[24:27], v0 offset:4096
    v_add_f32 v13, v13, v15
    v_cvt_pk_bf16_f32 v8, v8, v9
    v_smfmac_f32_16x16x64_bf16 v[20:23], v[32:35], a[104:111], v2
    s_waitcnt lgkmcnt(5)
    ds_read_b128 v[32:35], v0 offset:5120
    v_cvt_pk_bf16_f32 v9, v12, v13
    v_add_f32 v16, v16, v18
    v_add_f32 v17, v17, v19
    v_smfmac_f32_16x16x64_bf16 v[48:51], v[28:31], a[112:119], v2
    ds_write_b64 v3, v[8:9]
    v_cvt_pk_bf16_f32 v10, v16, v17
    v_add_f32 v20, v20, v22
    v_add_f32 v21, v21, v23
    v_cvt_pk_bf16_f32 v11, v20, v21
    v_smfmac_f32_16x16x64_bf16 v[52:55], v[28:31], a[120:127], v2
    s_waitcnt lgkmcnt(2)
    ds_write_b64 v3, v[10:11] offset:2176
    v_smfmac_f32_16x16x64_bf16 v[48:51], v[24:27], a[128:135], v2
    ds_read_b128 v[28:31], v0 offset:6144
    v_lshrrev_b32 v12, 1, v0
    v_smfmac_f32_16x16x64_bf16 v[52:55], v[24:27], a[136:143], v2
    s_waitcnt lgkmcnt(3)
    ds_read_b128 v[24:27], v0 offset:7168
    v_permlane16_swap_b32 v10, v11
    v_smfmac_f32_16x16x64_bf16 v[48:51], v[32:35], a[144:151], v2
    buffer_store_dwordx2 v[10:11], v12, s[32:35], s96 offen sc1
    s_waitcnt lgkmcnt(2)
    s_barrier
    ds_read_b64_tr_b16 v[12:13], v4 offset:0
    ds_read_b64_tr_b16 v[14:15], v4 offset:32
    v_smfmac_f32_16x16x64_bf16 v[52:55], v[32:35], a[152:159], v2
    s_waitcnt lgkmcnt(3)
    ds_read_b64_tr_b16 v[16:17], v4 offset:1088
    ds_read_b64_tr_b16 v[18:19], v4 offset:1120
    ds_read_b64_tr_b16 v[20:21], v4 offset:2176
    v_smfmac_f32_16x16x64_bf16 v[48:51], v[28:31], a[160:167], v2
    ds_read_b64_tr_b16 v[22:23], v4 offset:2208
    ds_read_b64_tr_b16 v[36:37], v4 offset:3264
    ds_read_b64_tr_b16 v[38:39], v4 offset:3296
    v_smfmac_f32_16x16x64_bf16 v[52:55], v[28:31], a[168:175], v2
    s_waitcnt lgkmcnt(8)
    ds_read_b128 v[32:35], v0 offset:30720
    ds_read_b128 v[28:31], v0 offset:29696
    v_smfmac_f32_16x16x64_bf16 v[48:51], v[24:27], a[176:183], v2
    v_smfmac_f32_16x16x64_bf16 v[52:55], v[24:27], a[184:191], v2
    ds_read_b128 v[24:27], v0 offset:28672
    s_waitcnt lgkmcnt(9)
    v_mfma_f32_16x16x32_bf16 v[8:11], v[40:43], v[12:15], 0
    s_waitcnt lgkmcnt(7)
    v_mfma_f32_16x16x32_bf16 v[8:11], v[44:47], v[16:19], v[8:11]
    ds_read_b128 v[44:47], v0 offset:31744
    v_mfma_f32_16x16x32_bf16 v[40:43], v[56:59], v[12:15], 0
    v_mfma_f32_16x16x32_bf16 v[40:43], v[60:63], v[16:19], v[40:43]
    s_waitcnt lgkmcnt(6)
    ds_read_b128 v[60:63], v0 offset:8192
    v_add_f32_dpp v8, v10, v8 quad_perm:[2,3,2,3] row_mask:0xf bank_mask:0xf
    v_mfma_f32_16x16x32_bf16 v[56:59], v[20:23], v[12:15], 0
    s_waitcnt lgkmcnt(5)
    v_add_f32_dpp v9, v11, v9 quad_perm:[2,3,2,3] row_mask:0xf bank_mask:0xf
    v_max_f32 v10, v8, v9
    v_mfma_f32_16x16x32_bf16 v[56:59], v[36:39], v[16:19], v[56:59]
    s_waitcnt lgkmcnt(2)
    ds_read_b128 v[36:39], v0 offset:9216
    v_add_f32_dpp v40, v42, v40 quad_perm:[2,3,2,3] row_mask:0xf bank_mask:0xf
    v_mfma_f32_16x16x32_bf16 v[20:23], v[24:27], v[12:15], 0
    v_add_f32_dpp v41, v43, v41 quad_perm:[2,3,2,3] row_mask:0xf bank_mask:0xf
    v_max3_f32 v10, v10, v40, v41
    v_mfma_f32_16x16x32_bf16 v[20:23], v[28:31], v[16:19], v[20:23]
    v_add_f32_dpp v56, v58, v56 quad_perm:[2,3,2,3] row_mask:0xf bank_mask:0xf
    v_mfma_f32_16x16x32_bf16 v[24:27], v[32:35], v[12:15], 0
    s_waitcnt lgkmcnt(2)
    v_add_f32_dpp v57, v59, v57 quad_perm:[2,3,2,3] row_mask:0xf bank_mask:0xf
    v_max3_f32 v10, v10, v56, v57
    v_mfma_f32_16x16x32_bf16 v[24:27], v[44:47], v[16:19], v[24:27]
    s_waitcnt lgkmcnt(1)
    v_add_f32_dpp v20, v22, v20 quad_perm:[2,3,2,3] row_mask:0xf bank_mask:0xf
    v_add_f32_dpp v21, v23, v21 quad_perm:[2,3,2,3] row_mask:0xf bank_mask:0xf
    v_smfmac_f32_16x16x64_bf16 v[48:51], v[60:63], a[192:199], v2
    ds_read_b128 v[32:35], v1 offset:2048
    v_max3_f32 v10, v10, v20, v21
    v_mov_b32 v17, 0
    s_nop 0
    v_add_f32_dpp v24, v26, v24 quad_perm:[2,3,2,3] row_mask:0xf bank_mask:0xf
    v_add_f32_dpp v25, v27, v25 quad_perm:[2,3,2,3] row_mask:0xf bank_mask:0xf
    v_max3_f32 v10, v10, v24, v25
    v_mov_b32 v11, v10
    v_smfmac_f32_16x16x64_bf16 v[52:55], v[60:63], a[200:207], v2
    s_waitcnt lgkmcnt(1)
    ds_read_b128 v[44:47], v1 offset:3072
    v_permlane32_swap_b32 v10, v11
    v_max_f32 v10, v10, v11
    v_mov_b32 v11, v10
    v_smfmac_f32_16x16x64_bf16 v[48:51], v[36:39], a[208:215], v2
    s_barrier
    v_permlane16_swap_b32 v10, v11
    v_max_f32 v10, v10, v11
    v_mul_f32 v10, s51, v10
    v_fma_f32 v8, v8, s51, -v10
    v_smfmac_f32_16x16x64_bf16 v[52:55], v[36:39], a[216:223], v2
    v_fma_f32 v9, v9, s51, -v10
    v_exp_f32 v8, v8
    v_fma_f32 v40, v40, s51, -v10
    v_exp_f32 v9, v9
    v_fma_f32 v41, v41, s51, -v10
    v_exp_f32 v40, v40
    v_cvt_pk_bf16_f32 v12, v8, v9
    v_fma_f32 v20, v20, s51, -v10
    v_exp_f32 v41, v41
    v_fma_f32 v21, v21, s51, -v10
    v_exp_f32 v20, v20
    v_cvt_pk_bf16_f32 v13, v40, v41
    v_fma_f32 v24, v24, s51, -v10
    v_exp_f32 v21, v21
    v_fma_f32 v25, v25, s51, -v10
    v_exp_f32 v24, v24
    v_cvt_pk_bf16_f32 v14, v20, v21
    v_fma_f32 v56, v56, s51, -v10
    v_exp_f32 v25, v25
    v_mov_b64 v[28:29], s[22:23]
    v_mov_b64 v[30:31], s[22:23]
    v_cvt_pk_bf16_f32 v15, v24, v25
    v_fma_f32 v57, v57, s51, -v10
    v_exp_f32 v56, v56
    v_mfma_f32_16x16x32_bf16 v[60:63], v[28:31], v[12:15], 0
    v_exp_f32 v57, v57
    s_waitcnt lgkmcnt(1)
    v_mfma_f32_16x16x32_bf16 v[32:35], v[32:35], v[12:15], 0
    v_cvt_pk_bf16_f32 v16, v56, v57
    v_add_f32 v48, v48, v50
    s_waitcnt lgkmcnt(0)
    v_mfma_f32_16x16x32_bf16 v[44:47], v[44:47], v[12:15], 0
    v_add_f32 v49, v49, v51
    v_add_f32 v52, v52, v54
    v_mfma_f32_16x16x16_bf16 v[60:63], v[28:29], v[16:17], v[60:63]
    v_add_f32 v53, v53, v55
    v_cvt_pk_bf16_f32 v22, v48, v49
    v_cvt_pk_bf16_f32 v23, v52, v53
    v_mov_b32 v18, 0
    v_mov_b32 v19, v16
    v_mfma_f32_16x16x16_bf16 v[32:35], v[22:23], v[16:17], v[32:35]
    ds_read_b128 v[48:51], v1 offset:20480
    ds_read_b128 v[52:55], v1 offset:21504
    v_mfma_f32_16x16x16_bf16 v[44:47], v[22:23], v[18:19], v[44:47]
    ds_read_b128 v[36:39], v1 offset:24576
    ds_read_b128 v[40:43], v1 offset:25600
    v_rcp_f32 v10, v60
    v_mov_b64 v[12:13], 0
    v_lshrrev_b32 v14, 1, v0
    v_permlane16_swap_b32 v22, v23
    v_pk_mul_f32 v[32:33], v[32:33], v[10:11] op_sel_hi:[1,0]
    v_pk_mul_f32 v[34:35], v[34:35], v[10:11] op_sel_hi:[1,0]
    v_cvt_pk_bf16_f32 v32, v32, v33
    v_cvt_pk_bf16_f32 v33, v34, v35
    v_pk_mul_f32 v[44:45], v[44:45], v[10:11] op_sel_hi:[1,0]
    v_pk_mul_f32 v[46:47], v[46:47], v[10:11] op_sel_hi:[1,0]
    v_cvt_pk_bf16_f32 v34, v44, v45
    v_cvt_pk_bf16_f32 v35, v46, v47
    v_mfma_f32_16x16x16_bf16 v[16:19], v[12:13], v[12:13], 0
    ds_write_b128 v5, v[32:35]
    buffer_store_dwordx2 v[22:23], v14, s[32:35], s97 offen sc1
    s_cmp_eq_u32 s40, 63
    s_cbranch_scc1 CH_exit_35
    v_mfma_f32_16x16x16_bf16 v[20:23], v[12:13], v[12:13], 0
    ds_read_b128 v[56:59], v1 offset:22528
    ds_read_b128 v[60:63], v1 offset:23552
    v_mfma_f32_16x16x16_bf16 v[24:27], v[12:13], v[12:13], 0
    v_mfma_f32_16x16x16_bf16 v[28:31], v[12:13], v[12:13], 0
    v_mfma_f32_16x16x16_bf16 v[8:11], v[12:13], v[12:13], 0
    s_waitcnt lgkmcnt(2)
    s_barrier
    ds_read_b128 v[32:35], v0 offset:10240
    ds_read_b128 v[44:47], v0 offset:11264
    v_lshlrev_b32 v15, 3, v0
    v_bfe_u32 v14, v0, 2, 6
    v_and_or_b32 v14, v15, s94, v14
    s_waitcnt lgkmcnt(1)
    v_smfmac_f32_16x16x64_bf16 v[16:19], v[32:35], v[48:55], v2
    ds_read_b128 v[48:51], v1 offset:26624
    ds_read_b128 v[52:55], v1 offset:27648
    s_waitcnt lgkmcnt(2)
    v_smfmac_f32_16x16x64_bf16 v[16:19], v[44:47], v[56:63], v2
    ds_read_b128 v[56:59], v1 offset:28672
    ds_read_b128 v[60:63], v1 offset:29696
    v_smfmac_f32_16x16x64_bf16 v[20:23], v[32:35], v[36:43], v2
    ds_read_b128 v[36:39], v1 offset:30720
    ds_read_b128 v[40:43], v1 offset:31744
    v_smfmac_f32_16x16x64_bf16 v[20:23], v[44:47], a[224:231], v2
    v_add_f32 v16, v16, v18
    v_add_f32 v17, v17, v19
    v_smfmac_f32_16x16x64_bf16 v[24:27], v[32:35], a[232:239], v2
    v_smfmac_f32_16x16x64_bf16 v[24:27], v[44:47], a[240:247], v2
    s_waitcnt lgkmcnt(4)
    v_add_f32 v20, v20, v22
    v_add_f32 v21, v21, v23
    v_smfmac_f32_16x16x64_bf16 v[28:31], v[32:35], v[48:55], v2
    v_cvt_pk_bf16_f32 v16, v16, v20
    v_cvt_pk_bf16_f32 v17, v17, v21
    v_smfmac_f32_16x16x64_bf16 v[28:31], v[44:47], a[248:255], v2
    s_waitcnt lgkmcnt(2)
    v_and_or_b32 v16, v16, -2, 0
    v_smfmac_f32_16x16x64_bf16 v[8:11], v[32:35], v[56:63], v2
    s_waitcnt lgkmcnt(0)
    buffer_store_dwordx2 v[16:17], v7, s[28:31], 0 offen
    v_add_f32 v24, v24, v26
    v_add_f32 v25, v25, v27
    v_smfmac_f32_16x16x64_bf16 v[8:11], v[44:47], v[36:43], v2
    v_add_f32 v28, v28, v30
    v_add_f32 v29, v29, v31
    s_cmp_eq_u32 s21, 3
    v_cvt_pk_bf16_f32 v24, v24, v28
    v_cvt_pk_bf16_f32 v25, v25, v29
    v_and_or_b32 v24, v24, -2, 0
    buffer_store_dwordx2 v[24:25], v7, s[28:31], s61 offen
    s_nop 0
    v_add_f32 v8, v8, v10
    v_add_f32 v9, v9, v11
    v_cvt_pk_bf16_f32 v8, v8, v9
    v_and_or_b32 v8, v8, -2, 0
    buffer_store_dword v8, v14, s[28:31], s62 offen
    s_cbranch_scc1 CH_h_52
    v_lshrrev_b32 v56, s91, v0
    v_and_b32 v56, 16, v56
    v_lshlrev_b32_e64 v56, v56, s65
    v_cndmask_b32 v40, 0, v56, s[52:53]
    v_cndmask_b32 v41, 0, v56, s[54:55]
    v_cndmask_b32 v42, 0, v56, s[56:57]
    v_cndmask_b32 v43, 0, v56, s[58:59]
    v_mov_b64 v[58:59], -1
    s_mov_b32 s44, s43
    s_add_u32 s43, s43, 0x2000
    s_and_b32 s43, s43, 0x7fff
    s_add_u32 s43, s43, 163840
    s_mov_b32 s49, 0
    s_add_u32 s40, s40, 1
    s_add_u32 s90, s90, 32768
    s_add_u32 s96, s96, 131072
    s_add_u32 s97, s97, 131072
    s_cmp_lg_u32 s95, 0
    s_cbranch_scc1 CH_nt_56
    s_nop 5
    s_cmp_le_u32 s21, 0
    s_cbranch_scc1 CH_d_58
    s_nop 7
    s_cmp_le_u32 s21, 1
    s_cbranch_scc1 CH_d_58
    s_nop 7
CH_d_58:
    buffer_load_dwordx4 v[32:35], v0, s[28:31], s46 offen offset:0 sc1
    buffer_load_dwordx4 v[36:39], v0, s[28:31], s46 offen offset:1024 sc1
    v_add_u32 v61, s92, v0
    v_lshrrev_b32 v62, 2, v0
    v_add_u32 v62, s93, v62
    v_mov_b64 v[8:9], 0
    v_mov_b64 v[10:11], 0
    v_mov_b64 v[12:13], 0
    v_mov_b64 v[14:15], 0
    v_mov_b64 v[48:49], 0
    v_mov_b64 v[50:51], 0
    v_mov_b64 v[52:53], 0
    v_mov_b64 v[54:55], 0
    s_cmp_eq_u32 s21, 2
    s_cselect_b32 s47, 1, 0
    s_nop 15
    buffer_load_dwordx4 v[24:27], v0, s[28:31], s46 offen offset:0 sc1
    buffer_load_dwordx4 v[28:31], v0, s[28:31], s46 offen offset:1024 sc1
CH_h_55:
    s_waitcnt vmcnt(3)
    v_mfma_f32_16x16x32_bf16 v[44:47], v[40:43], v[32:35], 0
    s_waitcnt vmcnt(2)
    v_mfma_f32_16x16x32_bf16 v[44:47], v[40:43], v[36:39], v[44:47]
    v_bitop3_b32 v56, v33, v35, v37 bitop3:0xfe
    v_bitop3_b32 v57, v32, v34, v36 bitop3:0xfe
    v_bitop3_b32 v56, v56, v39, s47 bitop3:0xa8
    v_bitop3_b32 v56, v56, v57, v38 bitop3:0xfe
    v_and_b32 v56, 1, v56
    v_cmp_ne_u32 vcc, 0, v56
CH_ok_59:
    s_nop 1
    v_add_f32_dpp v44, v44, v44 row_ror:8 row_mask:0xf bank_mask:0xf
    v_add_f32_dpp v45, v45, v45 row_ror:8 row_mask:0xf bank_mask:0xf
    v_add_f32_dpp v46, v46, v46 row_ror:8 row_mask:0xf bank_mask:0xf
    v_add_f32_dpp v47, v47, v47 row_ror:8 row_mask:0xf bank_mask:0xf
    v_add_f32_dpp v44, v44, v44 row_ror:4 row_mask:0xf bank_mask:0xf
    v_add_f32_dpp v45, v45, v45 row_ror:4 row_mask:0xf bank_mask:0xf
    v_add_f32_dpp v46, v46, v46 row_ror:4 row_mask:0xf bank_mask:0xf
    v_add_f32_dpp v47, v47, v47 row_ror:4 row_mask:0xf bank_mask:0xf
    v_cvt_pk_bf16_f32 v56, v44, v45
    v_cvt_pk_bf16_f32 v57, v46, v47
    v_min_u32 v56, -2, v56
    v_min_u32 v57, -2, v57
    s_cbranch_vccnz CH_h_54
    buffer_store_dwordx2 v[56:57], v6, s[28:31], s43 offen
CH_x0_57:
    s_barrier
    buffer_store_dwordx2 v[56:57], v6, s[36:39], s50 offen sc1
    buffer_store_dwordx2 v[58:59], v6, s[28:31], s44 offen
    s_add_u32 s50, s50, 32768
    v_mov_b64 v[16:17], 0
    v_mov_b64 v[18:19], 0
    v_mov_b64 v[20:21], 0
    v_mov_b64 v[22:23], 0
    s_nop 15
    s_nop 15
    s_nop 15
    s_nop 15
    s_nop 3
    s_branch CH_h_53
CH_h_52:
    v_add_u32 v61, s92, v0
    v_lshrrev_b32 v62, 2, v0
    v_add_u32 v62, s93, v62
    v_mov_b64 v[48:49], 0
    v_mov_b64 v[50:51], 0
    v_mov_b64 v[52:53], 0
    v_mov_b64 v[54:55], 0
    s_mov_b32 s44, s43
    s_add_u32 s43, s43, 0x2000
    s_and_b32 s43, s43, 0x7fff
    s_add_u32 s43, s43, 163840
    s_mov_b32 s49, 0
    s_add_u32 s40, s40, 1
    s_add_u32 s90, s90, 32768
    s_add_u32 s96, s96, 131072
    s_add_u32 s97, s97, 131072
    v_mfma_f32_32x32x2_f32 v[8:23], v48, v48, 0
    v_mfma_f32_32x32x2_f32 v[8:23], v48, v48, v[8:23]
    v_mfma_f32_32x32x2_f32 v[8:23], v48, v48, v[8:23]
    v_mfma_f32_32x32x2_f32 v[8:23], v48, v48, v[8:23]
    v_mfma_f32_32x32x2_f32 v[8:23], v48, v48, v[8:23]
    s_waitcnt vmcnt(0)
    v_and_b32 v40, 48, v0
    ds_read_b32 v41, v40 offset:15360
    s_add_u32 s47, s40, 2
    s_min_u32 s47, s47, 64
    s_add_u32 s47, s47, s99
CH_fb_61:
    s_waitcnt lgkmcnt(0)
    v_cmp_gt_u32 vcc, s47, v41
    s_cbranch_vccnz CH_fp_60
    v_mfma_f32_32x32x2_f32 v[8:23], v48, v48, v[8:23]
    s_barrier
    s_nop 15
    s_nop 15
    s_nop 15
    s_nop 15
    s_nop 15
CH_h_53:
    buffer_load_dwordx4 v[24:27], v61, s[28:31], s43 offen sc1
    buffer_load_dword v28, v62, s[28:31], s43 offen sc1
    s_waitcnt vmcnt(1)
    ds_write_b128 v61, v[24:27] offset:0
    s_waitcnt vmcnt(0)
    ds_write_b32 v62, v28 offset:0
    v_max3_u32 v63, v24, v26, v28
    v_cmp_eq_u32 vcc, -1, v63
    s_cbranch_vccnz CH_re_62
CH_bk_63:
    buffer_load_dwordx4 v[56:59], v61, s[36:39], s90 offen sc1
    buffer_load_dword v60, v62, s[36:39], s90 offen sc1
    s_branch CH_top_34
CH_re_36:
    buffer_load_dwordx4 v[56:59], v61, s[36:39], s90 offen sc1
    buffer_load_dword v60, v62, s[36:39], s90 offen sc1
    s_add_u32 s49, s49, 1
    s_cmp_gt_u32 s49, 400000
    s_cbranch_scc1 L_end
    s_waitcnt vmcnt(0)
    v_max3_u32 v63, v56, v58, v60
    v_cmp_eq_u32 vcc, -1, v63
    s_cbranch_vccnz CH_re_36
    ds_write_b128 v61, v[56:59] offset:5120
    ds_write_b32 v62, v60 offset:5120
    s_waitcnt lgkmcnt(0)
    s_branch CH_bk_37
CH_nt_42:
    v_add_u32 v61, s92, v0
    v_lshrrev_b32 v62, 2, v0
    v_add_u32 v62, s93, v62
    v_mov_b64 v[8:9], 0
    v_mov_b64 v[10:11], 0
    v_mov_b64 v[12:13], 0
    v_mov_b64 v[14:15], 0
    v_mov_b64 v[16:17], 0
    v_mov_b64 v[18:19], 0
    v_mov_b64 v[20:21], 0
    v_mov_b64 v[22:23], 0
    v_mov_b64 v[48:49], 0
    v_mov_b64 v[50:51], 0
    v_mov_b64 v[52:53], 0
    v_mov_b64 v[54:55], 0
    s_waitcnt vmcnt(0)
    s_branch CH_x0_43
CH_h_40:
    buffer_load_dwordx4 v[32:35], v0, s[28:31], s46 offen offset:0 sc1
    buffer_load_dwordx4 v[36:39], v0, s[28:31], s46 offen offset:1024 sc1
    s_waitcnt vmcnt(3)
    v_mfma_f32_16x16x32_bf16 v[44:47], v[40:43], v[24:27], 0
    s_waitcnt vmcnt(2)
    v_mfma_f32_16x16x32_bf16 v[44:47], v[40:43], v[28:31], v[44:47]
    v_bitop3_b32 v56, v25, v27, v29 bitop3:0x80
    v_bitop3_b32 v57, v24, v26, v28 bitop3:0x80
    v_bitop3_b32 v56, v56, v31, s47 bitop3:0xea
    v_bitop3_b32 v56, v56, v57, v30 bitop3:0x80
    v_and_b32 v56, 1, v56
    v_cmp_ne_u32 vcc, 1, v56
    s_cbranch_vccz CH_ok_45
    buffer_load_dwordx4 v[24:27], v0, s[28:31], s46 offen offset:0 sc1
    buffer_load_dwordx4 v[28:31], v0, s[28:31], s46 offen offset:1024 sc1
    s_add_u32 s49, s49, 1
    s_cmp_gt_u32 s49, 400000
    s_cbranch_scc1 L_end
    s_branch CH_h_41
CH_fp_46:
    buffer_load_dword v41, v40, s[32:35], s98 offen sc1
    s_add_u32 s49, s49, 1
    s_cmp_gt_u32 s49, 400000
    s_cbranch_scc1 L_end
    s_waitcnt vmcnt(0)
    s_branch CH_fb_47
CH_re_48:
    buffer_load_dwordx4 v[24:27], v61, s[28:31], s43 offen sc1
    buffer_load_dword v28, v62, s[28:31], s43 offen sc1
    s_add_u32 s49, s49, 1
    s_cmp_gt_u32 s49, 400000
    s_cbranch_scc1 L_end
    s_waitcnt vmcnt(0)
    v_max3_u32 v63, v24, v26, v28
    v_cmp_eq_u32 vcc, -1, v63
    s_cbranch_vccnz CH_re_48
    ds_write_b128 v61, v[24:27] offset:0
    ds_write_b32 v62, v28 offset:0
    s_waitcnt lgkmcnt(0)
    s_branch CH_bk_49
CH_re_50:
    buffer_load_dwordx4 v[56:59], v61, s[36:39], s90 offen sc1
    buffer_load_dword v60, v62, s[36:39], s90 offen sc1
    s_add_u32 s49, s49, 1
    s_cmp_gt_u32 s49, 400000
    s_cbranch_scc1 L_end
    s_waitcnt vmcnt(0)
    v_max3_u32 v63, v56, v58, v60
    v_cmp_eq_u32 vcc, -1, v63
    s_cbranch_vccnz CH_re_50
    ds_write_b128 v61, v[56:59] offset:5120
    ds_write_b32 v62, v60 offset:5120
    s_waitcnt lgkmcnt(0)
    s_branch CH_bk_51
CH_nt_56:
    v_add_u32 v61, s92, v0
    v_lshrrev_b32 v62, 2, v0
    v_add_u32 v62, s93, v62
    v_mov_b64 v[8:9], 0
    v_mov_b64 v[10:11], 0
    v_mov_b64 v[12:13], 0
    v_mov_b64 v[14:15], 0
    v_mov_b64 v[16:17], 0
    v_mov_b64 v[18:19], 0
    v_mov_b64 v[20:21], 0
    v_mov_b64 v[22:23], 0
    v_mov_b64 v[48:49], 0
    v_mov_b64 v[50:51], 0
    v_mov_b64 v[52:53], 0
    v_mov_b64 v[54:55], 0
    s_waitcnt vmcnt(0)
    s_branch CH_x0_57
CH_h_54:
    buffer_load_dwordx4 v[32:35], v0, s[28:31], s46 offen offset:0 sc1
    buffer_load_dwordx4 v[36:39], v0, s[28:31], s46 offen offset:1024 sc1
    s_waitcnt vmcnt(3)
    v_mfma_f32_16x16x32_bf16 v[44:47], v[40:43], v[24:27], 0
    s_waitcnt vmcnt(2)
    v_mfma_f32_16x16x32_bf16 v[44:47], v[40:43], v[28:31], v[44:47]
    v_bitop3_b32 v56, v25, v27, v29 bitop3:0xfe
    v_bitop3_b32 v57, v24, v26, v28 bitop3:0xfe
    v_bitop3_b32 v56, v56, v31, s47 bitop3:0xa8
    v_bitop3_b32 v56, v56, v57, v30 bitop3:0xfe
    v_and_b32 v56, 1, v56
    v_cmp_ne_u32 vcc, 0, v56
    s_cbranch_vccz CH_ok_59
    buffer_load_dwordx4 v[24:27], v0, s[28:31], s46 offen offset:0 sc1
    buffer_load_dwordx4 v[28:31], v0, s[28:31], s46 offen offset:1024 sc1
    s_add_u32 s49, s49, 1
    s_cmp_gt_u32 s49, 400000
    s_cbranch_scc1 L_end
    s_branch CH_h_55
CH_fp_60:
    buffer_load_dword v41, v40, s[32:35], s98 offen sc1
    s_add_u32 s49, s49, 1
    s_cmp_gt_u32 s49, 400000
    s_cbranch_scc1 L_end
    s_waitcnt vmcnt(0)
    s_branch CH_fb_61
CH_re_62:
    buffer_load_dwordx4 v[24:27], v61, s[28:31], s43 offen sc1
    buffer_load_dword v28, v62, s[28:31], s43 offen sc1
    s_add_u32 s49, s49, 1
    s_cmp_gt_u32 s49, 400000
    s_cbranch_scc1 L_end
    s_waitcnt vmcnt(0)
    v_max3_u32 v63, v24, v26, v28
    v_cmp_eq_u32 vcc, -1, v63
    s_cbranch_vccnz CH_re_62
    ds_write_b128 v61, v[24:27] offset:0
    ds_write_b32 v62, v28 offset:0
    s_waitcnt lgkmcnt(0)
    s_branch CH_bk_63
CH_exit_35:
    s_branch CH_fin_19
CH_slow_18:
.p2align 6
CH_top_78:
    s_waitcnt lgkmcnt(0)
    s_barrier
    ds_read_b128 v[24:27], v0 offset:0
    ds_read_b128 v[28:31], v0 offset:1024
    ds_read_b128 v[32:35], v1 offset:4096
    ds_read_b128 v[36:39], v1 offset:5120
    s_waitcnt lgkmcnt(3)
    v_smfmac_f32_16x16x64_bf16 v[8:11], v[24:27], v[64:71], v2
    ds_read_b128 v[40:43], v1 offset:6144
    ds_read_b128 v[44:47], v1 offset:7168
    v_smfmac_f32_16x16x64_bf16 v[12:15], v[24:27], v[72:79], v2
    v_smfmac_f32_16x16x64_bf16 v[16:19], v[24:27], v[80:87], v2
    v_smfmac_f32_16x16x64_bf16 v[20:23], v[24:27], v[88:95], v2
    s_waitcnt lgkmcnt(2)
    v_smfmac_f32_16x16x64_bf16 v[48:51], v[24:27], v[32:39], v2
    ds_read_b128 v[32:35], v1 offset:8192
    ds_read_b128 v[36:39], v1 offset:9216
    v_smfmac_f32_16x16x64_bf16 v[52:55], v[24:27], v[96:103], v2
    ds_read_b128 v[24:27], v0 offset:2048
    v_smfmac_f32_16x16x64_bf16 v[8:11], v[28:31], v[104:111], v2
    v_smfmac_f32_16x16x64_bf16 v[12:15], v[28:31], v[112:119], v2
    s_waitcnt lgkmcnt(3)
    v_smfmac_f32_16x16x64_bf16 v[16:19], v[28:31], v[40:47], v2
    ds_read_b128 v[40:43], v1 offset:10240
    ds_read_b128 v[44:47], v1 offset:11264
    v_smfmac_f32_16x16x64_bf16 v[20:23], v[28:31], v[120:127], v2
    v_smfmac_f32_16x16x64_bf16 v[48:51], v[28:31], v[128:135], v2
    v_smfmac_f32_16x16x64_bf16 v[52:55], v[28:31], v[136:143], v2
    ds_read_b128 v[28:31], v0 offset:3072
    s_waitcnt lgkmcnt(3)
    v_smfmac_f32_16x16x64_bf16 v[8:11], v[24:27], v[144:151], v2
    v_smfmac_f32_16x16x64_bf16 v[12:15], v[24:27], v[32:39], v2
    ds_read_b128 v[32:35], v1 offset:12288
    ds_read_b128 v[36:39], v1 offset:13312
    v_smfmac_f32_16x16x64_bf16 v[16:19], v[24:27], v[152:159], v2
    v_smfmac_f32_16x16x64_bf16 v[20:23], v[24:27], v[160:167], v2
    v_smfmac_f32_16x16x64_bf16 v[48:51], v[24:27], v[168:175], v2
    s_waitcnt vmcnt(1)
    ds_write_b128 v61, v[56:59] offset:5120
    v_smfmac_f32_16x16x64_bf16 v[52:55], v[24:27], v[176:183], v2
    ds_read_b128 v[24:27], v0 offset:4096
    s_waitcnt vmcnt(0)
    ds_write_b32 v62, v60 offset:5120
    v_max3_u32 v63, v56, v58, v60
    s_waitcnt lgkmcnt(5)
    v_smfmac_f32_16x16x64_bf16 v[8:11], v[28:31], v[40:47], v2
    ds_read_b128 v[40:43], v1 offset:14336
    v_cmp_eq_u32 vcc, -1, v63
    v_smfmac_f32_16x16x64_bf16 v[12:15], v[28:31], v[184:191], v2
    ds_read_b128 v[44:47], v1 offset:15360
    v_smfmac_f32_16x16x64_bf16 v[16:19], v[28:31], v[192:199], v2
    s_cbranch_vccnz CH_re_80
CH_bk_81:
    v_smfmac_f32_16x16x64_bf16 v[20:23], v[28:31], v[200:207], v2
    s_waitcnt lgkmcnt(2)
    s_barrier
    ds_read_b128 v[28:31], v0 offset:5120
    v_smfmac_f32_16x16x64_bf16 v[8:11], v[24:27], v[208:215], v2
    v_smfmac_f32_16x16x64_bf16 v[12:15], v[24:27], v[216:223], v2
    v_smfmac_f32_16x16x64_bf16 v[16:19], v[24:27], v[224:231], v2
    s_add_u32 m0, s63, 8192
    s_add_u32 s60, s42, 8192
    buffer_load_dwordx4 v0, s[32:35], s42 offen offset:0 sc1 lds
    v_smfmac_f32_16x16x64_bf16 v[20:23], v[24:27], v[32:39], v2
    ds_read_b128 v[24:27], v0 offset:6144
    ds_read_b128 v[32:35], v1 offset:16384
    s_waitcnt lgkmcnt(2)
    v_smfmac_f32_16x16x64_bf16 v[8:11], v[28:31], v[232:239], v2
    ds_read_b128 v[36:39], v1 offset:17408
    v_smfmac_f32_16x16x64_bf16 v[12:15], v[28:31], v[240:247], v2
    v_smfmac_f32_16x16x64_bf16 v[16:19], v[28:31], v[248:255], v2
    buffer_load_dwordx4 v0, s[32:35], s42 offen offset:1024 sc1 lds
    v_smfmac_f32_16x16x64_bf16 v[20:23], v[28:31], a[0:7], v2
    ds_read_b128 v[28:31], v0 offset:7168
    s_waitcnt lgkmcnt(3)
    v_smfmac_f32_16x16x64_bf16 v[8:11], v[24:27], v[40:47], v2
    ds_read_b128 v[40:43], v1 offset:18432
    ds_read_b128 v[44:47], v1 offset:19456
    v_smfmac_f32_16x16x64_bf16 v[12:15], v[24:27], a[8:15], v2
    v_smfmac_f32_16x16x64_bf16 v[16:19], v[24:27], a[16:23], v2
    s_add_u32 m0, s64, 2048
    s_add_u32 s42, s42, 524288
    buffer_load_dwordx4 v0, s[32:35], s60 offen offset:0 sc1 lds
    v_smfmac_f32_16x16x64_bf16 v[20:23], v[24:27], a[24:31], v2
    ds_read_b128 v[24:27], v0 offset:8192
    s_waitcnt lgkmcnt(3)
    v_smfmac_f32_16x16x64_bf16 v[8:11], v[28:31], v[32:39], v2
    ds_read_b128 v[32:35], v0 offset:9216
    v_smfmac_f32_16x16x64_bf16 v[12:15], v[28:31], a[32:39], v2
    v_smfmac_f32_16x16x64_bf16 v[16:19], v[28:31], a[40:47], v2
    buffer_load_dwordx4 v0, s[32:35], s60 offen offset:1024 sc1 lds
    v_smfmac_f32_16x16x64_bf16 v[20:23], v[28:31], a[48:55], v2
    ds_read_b128 v[28:31], v0 offset:3072
    s_waitcnt lgkmcnt(2)
    v_smfmac_f32_16x16x64_bf16 v[8:11], v[24:27], a[56:63], v2
    ds_read_b128 v[56:59], v0 offset:18432
    ds_read_b128 v[60:63], v0 offset:19456
    v_smfmac_f32_16x16x64_bf16 v[12:15], v[24:27], v[40:47], v2
    s_waitcnt lgkmcnt(3)
    v_smfmac_f32_16x16x64_bf16 v[8:11], v[32:35], a[64:71], v2
    ds_read_b128 v[40:43], v0 offset:16384
    ds_read_b128 v[44:47], v0 offset:17408
    v_smfmac_f32_16x16x64_bf16 v[12:15], v[32:35], a[72:79], v2
    s_mov_b32 m0, 15360
    s_nop 0
    buffer_load_dwordx4 v0, s[32:35], s98 offen offset:0 sc1 lds
    v_smfmac_f32_16x16x64_bf16 v[16:19], v[24:27], a[80:87], v2
    v_add_f32 v8, v8, v10
    v_smfmac_f32_16x16x64_bf16 v[16:19], v[32:35], a[88:95], v2
    v_add_f32 v9, v9, v11
    v_add_f32 v12, v12, v14
    v_smfmac_f32_16x16x64_bf16 v[20:23], v[24:27], a[96:103], v2
    ds_read_b128 v[24:27], v0 offset:4096
    v_add_f32 v13, v13, v15
    v_cvt_pk_bf16_f32 v8, v8, v9
    v_smfmac_f32_16x16x64_bf16 v[20:23], v[32:35], a[104:111], v2
    s_waitcnt lgkmcnt(5)
    ds_read_b128 v[32:35], v0 offset:5120
    v_cvt_pk_bf16_f32 v9, v12, v13
    v_add_f32 v16, v16, v18
    v_add_f32 v17, v17, v19
    v_smfmac_f32_16x16x64_bf16 v[48:51], v[28:31], a[112:119], v2
    ds_write_b64 v3, v[8:9]
    v_cvt_pk_bf16_f32 v10, v16, v17
    v_add_f32 v20, v20, v22
    v_add_f32 v21, v21, v23
    v_cvt_pk_bf16_f32 v11, v20, v21
    v_smfmac_f32_16x16x64_bf16 v[52:55], v[28:31], a[120:127], v2
    s_waitcnt lgkmcnt(2)
    ds_write_b64 v3, v[10:11] offset:2176
    v_smfmac_f32_16x16x64_bf16 v[48:51], v[24:27], a[128:135], v2
    ds_read_b128 v[28:31], v0 offset:6144
    v_lshrrev_b32 v12, 1, v0
    v_smfmac_f32_16x16x64_bf16 v[52:55], v[24:27], a[136:143], v2
    s_waitcnt lgkmcnt(3)
    ds_read_b128 v[24:27], v0 offset:7168
    v_permlane16_swap_b32 v10, v11
    v_smfmac_f32_16x16x64_bf16 v[48:51], v[32:35], a[144:151], v2
    buffer_store_dwordx2 v[10:11], v12, s[32:35], s96 offen sc1
    s_waitcnt lgkmcnt(2)
    s_barrier
    ds_read_b64_tr_b16 v[12:13], v4 offset:0
    ds_read_b64_tr_b16 v[14:15], v4 offset:32
    v_smfmac_f32_16x16x64_bf16 v[52:55], v[32:35], a[152:159], v2
    s_waitcnt lgkmcnt(3)
    ds_read_b64_tr_b16 v[16:17], v4 offset:1088
    ds_read_b64_tr_b16 v[18:19], v4 offset:1120
    ds_read_b64_tr_b16 v[20:21], v4 offset:2176
    v_smfmac_f32_16x16x64_bf16 v[48:51], v[28:31], a[160:167], v2
    ds_read_b64_tr_b16 v[22:23], v4 offset:2208
    ds_read_b64_tr_b16 v[36:37], v4 offset:3264
    ds_read_b64_tr_b16 v[38:39], v4 offset:3296
    v_smfmac_f32_16x16x64_bf16 v[52:55], v[28:31], a[168:175], v2
    s_waitcnt lgkmcnt(8)
    ds_read_b128 v[32:35], v0 offset:22528
    ds_read_b128 v[28:31], v0 offset:21504
    v_smfmac_f32_16x16x64_bf16 v[48:51], v[24:27], a[176:183], v2
    v_smfmac_f32_16x16x64_bf16 v[52:55], v[24:27], a[184:191], v2
    ds_read_b128 v[24:27], v0 offset:20480
    s_waitcnt lgkmcnt(9)
    v_mfma_f32_16x16x32_bf16 v[8:11], v[40:43], v[12:15], 0
    s_waitcnt lgkmcnt(7)
    v_mfma_f32_16x16x32_bf16 v[8:11], v[44:47], v[16:19], v[8:11]
    ds_read_b128 v[44:47], v0 offset:23552
    v_mfma_f32_16x16x32_bf16 v[40:43], v[56:59], v[12:15], 0
    v_mfma_f32_16x16x32_bf16 v[40:43], v[60:63], v[16:19], v[40:43]
    s_waitcnt lgkmcnt(6)
    ds_read_b128 v[60:63], v0 offset:8192
    v_add_f32_dpp v8, v10, v8 quad_perm:[2,3,2,3] row_mask:0xf bank_mask:0xf
    v_mfma_f32_16x16x32_bf16 v[56:59], v[20:23], v[12:15], 0
    s_waitcnt lgkmcnt(5)
    v_add_f32_dpp v9, v11, v9 quad_perm:[2,3,2,3] row_mask:0xf bank_mask:0xf
    v_max_f32 v10, v8, v9
    v_mfma_f32_16x16x32_bf16 v[56:59], v[36:39], v[16:19], v[56:59]
    s_waitcnt lgkmcnt(2)
    ds_read_b128 v[36:39], v0 offset:9216
    v_add_f32_dpp v40, v42, v40 quad_perm:[2,3,2,3] row_mask:0xf bank_mask:0xf
    v_mfma_f32_16x16x32_bf16 v[20:23], v[24:27], v[12:15], 0
    v_add_f32_dpp v41, v43, v41 quad_perm:[2,3,2,3] row_mask:0xf bank_mask:0xf
    v_max3_f32 v10, v10, v40, v41
    v_mfma_f32_16x16x32_bf16 v[20:23], v[28:31], v[16:19], v[20:23]
    v_add_f32_dpp v56, v58, v56 quad_perm:[2,3,2,3] row_mask:0xf bank_mask:0xf
    v_mfma_f32_16x16x32_bf16 v[24:27], v[32:35], v[12:15], 0
    s_waitcnt lgkmcnt(2)
    v_add_f32_dpp v57, v59, v57 quad_perm:[2,3,2,3] row_mask:0xf bank_mask:0xf
    v_max3_f32 v10, v10, v56, v57
    v_mfma_f32_16x16x32_bf16 v[24:27], v[44:47], v[16:19], v[24:27]
    s_waitcnt lgkmcnt(1)
    v_add_f32_dpp v20, v22, v20 quad_perm:[2,3,2,3] row_mask:0xf bank_mask:0xf
    v_add_f32_dpp v21, v23, v21 quad_perm:[2,3,2,3] row_mask:0xf bank_mask:0xf
    v_smfmac_f32_16x16x64_bf16 v[48:51], v[60:63], a[192:199], v2
    ds_read_b128 v[32:35], v1 offset:0
    v_max3_f32 v10, v10, v20, v21
    v_mov_b32 v17, 0
    s_nop 0
    v_add_f32_dpp v24, v26, v24 quad_perm:[2,3,2,3] row_mask:0xf bank_mask:0xf
    v_add_f32_dpp v25, v27, v25 quad_perm:[2,3,2,3] row_mask:0xf bank_mask:0xf
    v_max3_f32 v10, v10, v24, v25
    v_mov_b32 v11, v10
    v_smfmac_f32_16x16x64_bf16 v[52:55], v[60:63], a[200:207], v2
    s_waitcnt lgkmcnt(1)
    ds_read_b128 v[44:47], v1 offset:1024
    v_permlane32_swap_b32 v10, v11
    v_max_f32 v10, v10, v11
    v_mov_b32 v11, v10
    v_smfmac_f32_16x16x64_bf16 v[48:51], v[36:39], a[208:215], v2
    s_barrier
    v_permlane16_swap_b32 v10, v11
    v_max_f32 v10, v10, v11
    v_mul_f32 v10, s51, v10
    v_fma_f32 v8, v8, s51, -v10
    v_smfmac_f32_16x16x64_bf16 v[52:55], v[36:39], a[216:223], v2
    v_fma_f32 v9, v9, s51, -v10
    v_exp_f32 v8, v8
    v_fma_f32 v40, v40, s51, -v10
    v_exp_f32 v9, v9
    v_fma_f32 v41, v41, s51, -v10
    v_exp_f32 v40, v40
    v_cvt_pk_bf16_f32 v12, v8, v9
    v_fma_f32 v20, v20, s51, -v10
    v_exp_f32 v41, v41
    v_fma_f32 v21, v21, s51, -v10
    v_exp_f32 v20, v20
    v_cvt_pk_bf16_f32 v13, v40, v41
    v_fma_f32 v24, v24, s51, -v10
    v_exp_f32 v21, v21
    v_fma_f32 v25, v25, s51, -v10
    v_exp_f32 v24, v24
    v_cvt_pk_bf16_f32 v14, v20, v21
    v_fma_f32 v56, v56, s51, -v10
    v_exp_f32 v25, v25
    v_mov_b64 v[28:29], s[22:23]
    v_mov_b64 v[30:31], s[22:23]
    v_cvt_pk_bf16_f32 v15, v24, v25
    v_fma_f32 v57, v57, s51, -v10
    v_exp_f32 v56, v56
    v_mfma_f32_16x16x32_bf16 v[60:63], v[28:31], v[12:15], 0
    v_exp_f32 v57, v57
    s_waitcnt lgkmcnt(1)
    v_mfma_f32_16x16x32_bf16 v[32:35], v[32:35], v[12:15], 0
    v_cvt_pk_bf16_f32 v16, v56, v57
    v_add_f32 v48, v48, v50
    s_waitcnt lgkmcnt(0)
    v_mfma_f32_16x16x32_bf16 v[44:47], v[44:47], v[12:15], 0
    v_add_f32 v49, v49, v51
    v_add_f32 v52, v52, v54
    v_mfma_f32_16x16x16_bf16 v[60:63], v[28:29], v[16:17], v[60:63]
    v_add_f32 v53, v53, v55
    v_cvt_pk_bf16_f32 v22, v48, v49
    v_cvt_pk_bf16_f32 v23, v52, v53
    v_mov_b32 v18, 0
    v_mov_b32 v19, v16
    v_mfma_f32_16x16x16_bf16 v[32:35], v[22:23], v[16:17], v[32:35]
    ds_read_b128 v[48:51], v1 offset:20480
    ds_read_b128 v[52:55], v1 offset:21504
    v_mfma_f32_16x16x16_bf16 v[44:47], v[22:23], v[18:19], v[44:47]
    ds_read_b128 v[36:39], v1 offset:24576
    ds_read_b128 v[40:43], v1 offset:25600
    v_rcp_f32 v10, v60
    v_mov_b64 v[12:13], 0
    v_lshrrev_b32 v14, 1, v0
    v_permlane16_swap_b32 v22, v23
    v_pk_mul_f32 v[32:33], v[32:33], v[10:11] op_sel_hi:[1,0]
    v_pk_mul_f32 v[34:35], v[34:35], v[10:11] op_sel_hi:[1,0]
    v_cvt_pk_bf16_f32 v32, v32, v33
    v_cvt_pk_bf16_f32 v33, v34, v35
    v_pk_mul_f32 v[44:45], v[44:45], v[10:11] op_sel_hi:[1,0]
    v_pk_mul_f32 v[46:47], v[46:47], v[10:11] op_sel_hi:[1,0]
    v_cvt_pk_bf16_f32 v34, v44, v45
    v_cvt_pk_bf16_f32 v35, v46, v47
    v_mfma_f32_16x16x16_bf16 v[16:19], v[12:13], v[12:13], 0
    ds_write_b128 v5, v[32:35]
    buffer_store_dwordx2 v[22:23], v14, s[32:35], s97 offen sc1
    v_mfma_f32_16x16x16_bf16 v[20:23], v[12:13], v[12:13], 0
    ds_read_b128 v[56:59], v1 offset:22528
    ds_read_b128 v[60:63], v1 offset:23552
    v_mfma_f32_16x16x16_bf16 v[24:27], v[12:13], v[12:13], 0
    v_mfma_f32_16x16x16_bf16 v[28:31], v[12:13], v[12:13], 0
    v_mfma_f32_16x16x16_bf16 v[8:11], v[12:13], v[12:13], 0
    s_waitcnt lgkmcnt(2)
    s_barrier
    ds_read_b128 v[32:35], v0 offset:10240
    ds_read_b128 v[44:47], v0 offset:11264
    v_lshlrev_b32 v15, 3, v0
    v_bfe_u32 v14, v0, 2, 6
    v_and_or_b32 v14, v15, s94, v14
    s_waitcnt lgkmcnt(1)
    v_smfmac_f32_16x16x64_bf16 v[16:19], v[32:35], v[48:55], v2
    ds_read_b128 v[48:51], v1 offset:26624
    ds_read_b128 v[52:55], v1 offset:27648
    s_waitcnt lgkmcnt(2)
    v_smfmac_f32_16x16x64_bf16 v[16:19], v[44:47], v[56:63], v2
    ds_read_b128 v[56:59], v1 offset:28672
    ds_read_b128 v[60:63], v1 offset:29696
    v_smfmac_f32_16x16x64_bf16 v[20:23], v[32:35], v[36:43], v2
    ds_read_b128 v[36:39], v1 offset:30720
    ds_read_b128 v[40:43], v1 offset:31744
    v_smfmac_f32_16x16x64_bf16 v[20:23], v[44:47], a[224:231], v2
    v_add_f32 v16, v16, v18
    v_add_f32 v17, v17, v19
    v_smfmac_f32_16x16x64_bf16 v[24:27], v[32:35], a[232:239], v2
    v_smfmac_f32_16x16x64_bf16 v[24:27], v[44:47], a[240:247], v2
    s_waitcnt lgkmcnt(4)
    v_add_f32 v20, v20, v22
    v_add_f32 v21, v21, v23
    v_smfmac_f32_16x16x64_bf16 v[28:31], v[32:35], v[48:55], v2
    v_cvt_pk_bf16_f32 v16, v16, v20
    v_cvt_pk_bf16_f32 v17, v17, v21
    v_smfmac_f32_16x16x64_bf16 v[28:31], v[44:47], a[248:255], v2
    s_waitcnt lgkmcnt(2)
    v_and_or_b32 v16, v16, -2, 1
    v_smfmac_f32_16x16x64_bf16 v[8:11], v[32:35], v[56:63], v2
    s_waitcnt lgkmcnt(0)
    buffer_store_dwordx2 v[16:17], v7, s[28:31], 0 offen sc1
    v_add_f32 v24, v24, v26
    v_add_f32 v25, v25, v27
    v_smfmac_f32_16x16x64_bf16 v[8:11], v[44:47], v[36:43], v2
    v_add_f32 v28, v28, v30
    v_add_f32 v29, v29, v31
    s_cmp_eq_u32 s21, 3
    v_cvt_pk_bf16_f32 v24, v24, v28
    v_cvt_pk_bf16_f32 v25, v25, v29
    v_and_or_b32 v24, v24, -2, 1
    buffer_store_dwordx2 v[24:25], v7, s[28:31], s61 offen sc1
    s_nop 0
    v_add_f32 v8, v8, v10
    v_add_f32 v9, v9, v11
    v_cvt_pk_bf16_f32 v8, v8, v9
    v_and_or_b32 v8, v8, -2, 1
    buffer_store_dword v8, v14, s[28:31], s62 offen sc1
    s_cbranch_scc1 CH_h_82
    v_lshrrev_b32 v56, s91, v0
    v_and_b32 v56, 16, v56
    v_lshlrev_b32_e64 v56, v56, s65
    v_cndmask_b32 v40, 0, v56, s[52:53]
    v_cndmask_b32 v41, 0, v56, s[54:55]
    v_cndmask_b32 v42, 0, v56, s[56:57]
    v_cndmask_b32 v43, 0, v56, s[58:59]
    v_mov_b64 v[58:59], -1
    s_mov_b32 s44, s43
    s_add_u32 s43, s43, 0x2000
    s_and_b32 s43, s43, 0x7fff
    s_add_u32 s43, s43, 163840
    s_mov_b32 s49, 0
    s_add_u32 s40, s40, 1
    s_add_u32 s90, s90, 32768
    s_add_u32 s96, s96, 131072
    s_add_u32 s97, s97, 131072
    s_cmp_lg_u32 s95, 0
    s_cbranch_scc1 CH_nt_86
    s_nop 5
    s_cmp_le_u32 s21, 0
    s_cbranch_scc1 CH_d_88
    s_nop 7
    s_cmp_le_u32 s21, 1
    s_cbranch_scc1 CH_d_88
    s_nop 7
CH_d_88:
    buffer_load_dwordx4 v[32:35], v0, s[28:31], s46 offen offset:0 sc1
    buffer_load_dwordx4 v[36:39], v0, s[28:31], s46 offen offset:1024 sc1
    v_add_u32 v61, s92, v0
    v_lshrrev_b32 v62, 2, v0
    v_add_u32 v62, s93, v62
    v_mov_b64 v[8:9], 0
    v_mov_b64 v[10:11], 0
    v_mov_b64 v[12:13], 0
    v_mov_b64 v[14:15], 0
    v_mov_b64 v[48:49], 0
    v_mov_b64 v[50:51], 0
    v_mov_b64 v[52:53], 0
    v_mov_b64 v[54:55], 0
    s_cmp_eq_u32 s21, 2
    s_cselect_b32 s47, 0, 1
    s_nop 15
    buffer_load_dwordx4 v[24:27], v0, s[28:31], s46 offen offset:0 sc1
    buffer_load_dwordx4 v[28:31], v0, s[28:31], s46 offen offset:1024 sc1
CH_h_85:
    s_waitcnt vmcnt(3)
    v_mfma_f32_16x16x32_bf16 v[44:47], v[40:43], v[32:35], 0
    s_waitcnt vmcnt(2)
    v_mfma_f32_16x16x32_bf16 v[44:47], v[40:43], v[36:39], v[44:47]
    v_bitop3_b32 v56, v33, v35, v37 bitop3:0x80
    v_bitop3_b32 v57, v32, v34, v36 bitop3:0x80
    v_bitop3_b32 v56, v56, v39, s47 bitop3:0xea
    v_bitop3_b32 v56, v56, v57, v38 bitop3:0x80
    v_and_b32 v56, 1, v56
    v_cmp_ne_u32 vcc, 1, v56
CH_ok_89:
    s_nop 1
    v_add_f32_dpp v44, v44, v44 row_ror:8 row_mask:0xf bank_mask:0xf
    v_add_f32_dpp v45, v45, v45 row_ror:8 row_mask:0xf bank_mask:0xf
    v_add_f32_dpp v46, v46, v46 row_ror:8 row_mask:0xf bank_mask:0xf
    v_add_f32_dpp v47, v47, v47 row_ror:8 row_mask:0xf bank_mask:0xf
    v_add_f32_dpp v44, v44, v44 row_ror:4 row_mask:0xf bank_mask:0xf
    v_add_f32_dpp v45, v45, v45 row_ror:4 row_mask:0xf bank_mask:0xf
    v_add_f32_dpp v46, v46, v46 row_ror:4 row_mask:0xf bank_mask:0xf
    v_add_f32_dpp v47, v47, v47 row_ror:4 row_mask:0xf bank_mask:0xf
    v_cvt_pk_bf16_f32 v56, v44, v45
    v_cvt_pk_bf16_f32 v57, v46, v47
    v_min_u32 v56, -2, v56
    v_min_u32 v57, -2, v57
    s_cbranch_vccnz CH_h_84
    buffer_store_dwordx2 v[56:57], v6, s[28:31], s43 offen sc1
CH_x0_87:
    s_barrier
    buffer_store_dwordx2 v[56:57], v6, s[36:39], s50 offen sc1
    buffer_store_dwordx2 v[58:59], v6, s[28:31], s44 offen sc1
    s_add_u32 s50, s50, 32768
    v_mov_b64 v[16:17], 0
    v_mov_b64 v[18:19], 0
    v_mov_b64 v[20:21], 0
    v_mov_b64 v[22:23], 0
    s_nop 15
    s_nop 15
    s_nop 15
    s_nop 15
    s_nop 3
    s_branch CH_h_83
CH_h_82:
    v_add_u32 v61, s92, v0
    v_lshrrev_b32 v62, 2, v0
    v_add_u32 v62, s93, v62
    v_mov_b64 v[48:49], 0
    v_mov_b64 v[50:51], 0
    v_mov_b64 v[52:53], 0
    v_mov_b64 v[54:55], 0
    s_mov_b32 s44, s43
    s_add_u32 s43, s43, 0x2000
    s_and_b32 s43, s43, 0x7fff
    s_add_u32 s43, s43, 163840
    s_mov_b32 s49, 0
    s_add_u32 s40, s40, 1
    s_add_u32 s90, s90, 32768
    s_add_u32 s96, s96, 131072
    s_add_u32 s97, s97, 131072
    v_mfma_f32_32x32x2_f32 v[8:23], v48, v48, 0
    v_mfma_f32_32x32x2_f32 v[8:23], v48, v48, v[8:23]
    v_mfma_f32_32x32x2_f32 v[8:23], v48, v48, v[8:23]
    v_mfma_f32_32x32x2_f32 v[8:23], v48, v48, v[8:23]
    v_mfma_f32_32x32x2_f32 v[8:23], v48, v48, v[8:23]
    s_waitcnt vmcnt(0)
    v_and_b32 v40, 48, v0
    ds_read_b32 v41, v40 offset:15360
    s_add_u32 s47, s40, 2
    s_min_u32 s47, s47, 64
    s_add_u32 s47, s47, s99
CH_fb_91:
    s_waitcnt lgkmcnt(0)
    v_cmp_gt_u32 vcc, s47, v41
    s_cbranch_vccnz CH_fp_90
    v_mfma_f32_32x32x2_f32 v[8:23], v48, v48, v[8:23]
    s_barrier
    s_nop 15
    s_nop 15
    s_nop 15
    s_nop 15
    s_nop 15
CH_h_83:
    buffer_load_dwordx4 v[24:27], v61, s[28:31], s43 offen sc1
    buffer_load_dword v28, v62, s[28:31], s43 offen sc1
    s_waitcnt vmcnt(1)
    ds_write_b128 v61, v[24:27] offset:0
    s_waitcnt vmcnt(0)
    ds_write_b32 v62, v28 offset:0
    v_max3_u32 v63, v24, v26, v28
    v_cmp_eq_u32 vcc, -1, v63
    s_cbranch_vccnz CH_re_92
CH_bk_93:
    buffer_load_dwordx4 v[56:59], v61, s[36:39], s90 offen sc1
    buffer_load_dword v60, v62, s[36:39], s90 offen sc1
    s_waitcnt lgkmcnt(0)
    s_barrier
    ds_read_b128 v[24:27], v0 offset:0
    ds_read_b128 v[28:31], v0 offset:1024
    ds_read_b128 v[32:35], v1 offset:4096
    ds_read_b128 v[36:39], v1 offset:5120
    s_waitcnt lgkmcnt(3)
    v_smfmac_f32_16x16x64_bf16 v[8:11], v[24:27], v[64:71], v2
    ds_read_b128 v[40:43], v1 offset:6144
    ds_read_b128 v[44:47], v1 offset:7168
    v_smfmac_f32_16x16x64_bf16 v[12:15], v[24:27], v[72:79], v2
    v_smfmac_f32_16x16x64_bf16 v[16:19], v[24:27], v[80:87], v2
    v_smfmac_f32_16x16x64_bf16 v[20:23], v[24:27], v[88:95], v2
    s_waitcnt lgkmcnt(2)
    v_smfmac_f32_16x16x64_bf16 v[48:51], v[24:27], v[32:39], v2
    ds_read_b128 v[32:35], v1 offset:8192
    ds_read_b128 v[36:39], v1 offset:9216
    v_smfmac_f32_16x16x64_bf16 v[52:55], v[24:27], v[96:103], v2
    ds_read_b128 v[24:27], v0 offset:2048
    v_smfmac_f32_16x16x64_bf16 v[8:11], v[28:31], v[104:111], v2
    v_smfmac_f32_16x16x64_bf16 v[12:15], v[28:31], v[112:119], v2
    s_waitcnt lgkmcnt(3)
    v_smfmac_f32_16x16x64_bf16 v[16:19], v[28:31], v[40:47], v2
    ds_read_b128 v[40:43], v1 offset:10240
    ds_read_b128 v[44:47], v1 offset:11264
    v_smfmac_f32_16x16x64_bf16 v[20:23], v[28:31], v[120:127], v2
    v_smfmac_f32_16x16x64_bf16 v[48:51], v[28:31], v[128:135], v2
    v_smfmac_f32_16x16x64_bf16 v[52:55], v[28:31], v[136:143], v2
    ds_read_b128 v[28:31], v0 offset:3072
    s_waitcnt lgkmcnt(3)
    v_smfmac_f32_16x16x64_bf16 v[8:11], v[24:27], v[144:151], v2
    v_smfmac_f32_16x16x64_bf16 v[12:15], v[24:27], v[32:39], v2
    ds_read_b128 v[32:35], v1 offset:12288
    ds_read_b128 v[36:39], v1 offset:13312
    v_smfmac_f32_16x16x64_bf16 v[16:19], v[24:27], v[152:159], v2
    v_smfmac_f32_16x16x64_bf16 v[20:23], v[24:27], v[160:167], v2
    v_smfmac_f32_16x16x64_bf16 v[48:51], v[24:27], v[168:175], v2
    s_waitcnt vmcnt(1)
    ds_write_b128 v61, v[56:59] offset:5120
    v_smfmac_f32_16x16x64_bf16 v[52:55], v[24:27], v[176:183], v2
    ds_read_b128 v[24:27], v0 offset:4096
    s_waitcnt vmcnt(0)
    ds_write_b32 v62, v60 offset:5120
    v_max3_u32 v63, v56, v58, v60
    s_waitcnt lgkmcnt(5)
    v_smfmac_f32_16x16x64_bf16 v[8:11], v[28:31], v[40:47], v2
    ds_read_b128 v[40:43], v1 offset:14336
    v_cmp_eq_u32 vcc, -1, v63
    v_smfmac_f32_16x16x64_bf16 v[12:15], v[28:31], v[184:191], v2
    ds_read_b128 v[44:47], v1 offset:15360
    v_smfmac_f32_16x16x64_bf16 v[16:19], v[28:31], v[192:199], v2
    s_cbranch_vccnz CH_re_94
CH_bk_95:
    v_smfmac_f32_16x16x64_bf16 v[20:23], v[28:31], v[200:207], v2
    s_waitcnt lgkmcnt(2)
    s_barrier
    ds_read_b128 v[28:31], v0 offset:5120
    v_smfmac_f32_16x16x64_bf16 v[8:11], v[24:27], v[208:215], v2
    v_smfmac_f32_16x16x64_bf16 v[12:15], v[24:27], v[216:223], v2
    v_smfmac_f32_16x16x64_bf16 v[16:19], v[24:27], v[224:231], v2
    s_add_u32 m0, s63, 0
    s_add_u32 s60, s42, 8192
    buffer_load_dwordx4 v0, s[32:35], s42 offen offset:0 sc1 lds
    v_smfmac_f32_16x16x64_bf16 v[20:23], v[24:27], v[32:39], v2
    ds_read_b128 v[24:27], v0 offset:6144
    ds_read_b128 v[32:35], v1 offset:16384
    s_waitcnt lgkmcnt(2)
    v_smfmac_f32_16x16x64_bf16 v[8:11], v[28:31], v[232:239], v2
    ds_read_b128 v[36:39], v1 offset:17408
    v_smfmac_f32_16x16x64_bf16 v[12:15], v[28:31], v[240:247], v2
    v_smfmac_f32_16x16x64_bf16 v[16:19], v[28:31], v[248:255], v2
    buffer_load_dwordx4 v0, s[32:35], s42 offen offset:1024 sc1 lds
    v_smfmac_f32_16x16x64_bf16 v[20:23], v[28:31], a[0:7], v2
    ds_read_b128 v[28:31], v0 offset:7168
    s_waitcnt lgkmcnt(3)
    v_smfmac_f32_16x16x64_bf16 v[8:11], v[24:27], v[40:47], v2
    ds_read_b128 v[40:43], v1 offset:18432
    ds_read_b128 v[44:47], v1 offset:19456
    v_smfmac_f32_16x16x64_bf16 v[12:15], v[24:27], a[8:15], v2
    v_smfmac_f32_16x16x64_bf16 v[16:19], v[24:27], a[16:23], v2
    s_add_u32 m0, s64, 0
    s_add_u32 s42, s42, 524288
    buffer_load_dwordx4 v0, s[32:35], s60 offen offset:0 sc1 lds
    v_smfmac_f32_16x16x64_bf16 v[20:23], v[24:27], a[24:31], v2
    ds_read_b128 v[24:27], v0 offset:8192
    s_waitcnt lgkmcnt(3)
    v_smfmac_f32_16x16x64_bf16 v[8:11], v[28:31], v[32:39], v2
    ds_read_b128 v[32:35], v0 offset:9216
    v_smfmac_f32_16x16x64_bf16 v[12:15], v[28:31], a[32:39], v2
    v_smfmac_f32_16x16x64_bf16 v[16:19], v[28:31], a[40:47], v2
    buffer_load_dwordx4 v0, s[32:35], s60 offen offset:1024 sc1 lds
    v_smfmac_f32_16x16x64_bf16 v[20:23], v[28:31], a[48:55], v2
    ds_read_b128 v[28:31], v0 offset:3072
    s_waitcnt lgkmcnt(2)
    v_smfmac_f32_16x16x64_bf16 v[8:11], v[24:27], a[56:63], v2
    ds_read_b128 v[56:59], v0 offset:26624
    ds_read_b128 v[60:63], v0 offset:27648
    v_smfmac_f32_16x16x64_bf16 v[12:15], v[24:27], v[40:47], v2
    s_waitcnt lgkmcnt(3)
    v_smfmac_f32_16x16x64_bf16 v[8:11], v[32:35], a[64:71], v2
    ds_read_b128 v[40:43], v0 offset:24576
    ds_read_b128 v[44:47], v0 offset:25600
    v_smfmac_f32_16x16x64_bf16 v[12:15], v[32:35], a[72:79], v2
    s_mov_b32 m0, 15360
    s_nop 0
    buffer_load_dwordx4 v0, s[32:35], s98 offen offset:0 sc1 lds
    v_smfmac_f32_16x16x64_bf16 v[16:19], v[24:27], a[80:87], v2
    v_add_f32 v8, v8, v10
    v_smfmac_f32_16x16x64_bf16 v[16:19], v[32:35], a[88:95], v2
    v_add_f32 v9, v9, v11
    v_add_f32 v12, v12, v14
    v_smfmac_f32_16x16x64_bf16 v[20:23], v[24:27], a[96:103], v2
    ds_read_b128 v[24:27], v0 offset:4096
    v_add_f32 v13, v13, v15
    v_cvt_pk_bf16_f32 v8, v8, v9
    v_smfmac_f32_16x16x64_bf16 v[20:23], v[32:35], a[104:111], v2
    s_waitcnt lgkmcnt(5)
    ds_read_b128 v[32:35], v0 offset:5120
    v_cvt_pk_bf16_f32 v9, v12, v13
    v_add_f32 v16, v16, v18
    v_add_f32 v17, v17, v19
    v_smfmac_f32_16x16x64_bf16 v[48:51], v[28:31], a[112:119], v2
    ds_write_b64 v3, v[8:9]
    v_cvt_pk_bf16_f32 v10, v16, v17
    v_add_f32 v20, v20, v22
    v_add_f32 v21, v21, v23
    v_cvt_pk_bf16_f32 v11, v20, v21
    v_smfmac_f32_16x16x64_bf16 v[52:55], v[28:31], a[120:127], v2
    s_waitcnt lgkmcnt(2)
    ds_write_b64 v3, v[10:11] offset:2176
    v_smfmac_f32_16x16x64_bf16 v[48:51], v[24:27], a[128:135], v2
    ds_read_b128 v[28:31], v0 offset:6144
    v_lshrrev_b32 v12, 1, v0
    v_smfmac_f32_16x16x64_bf16 v[52:55], v[24:27], a[136:143], v2
    s_waitcnt lgkmcnt(3)
    ds_read_b128 v[24:27], v0 offset:7168
    v_permlane16_swap_b32 v10, v11
    v_smfmac_f32_16x16x64_bf16 v[48:51], v[32:35], a[144:151], v2
    buffer_store_dwordx2 v[10:11], v12, s[32:35], s96 offen sc1
    s_waitcnt lgkmcnt(2)
    s_barrier
    ds_read_b64_tr_b16 v[12:13], v4 offset:0
    ds_read_b64_tr_b16 v[14:15], v4 offset:32
    v_smfmac_f32_16x16x64_bf16 v[52:55], v[32:35], a[152:159], v2
    s_waitcnt lgkmcnt(3)
    ds_read_b64_tr_b16 v[16:17], v4 offset:1088
    ds_read_b64_tr_b16 v[18:19], v4 offset:1120
    ds_read_b64_tr_b16 v[20:21], v4 offset:2176
    v_smfmac_f32_16x16x64_bf16 v[48:51], v[28:31], a[160:167], v2
    ds_read_b64_tr_b16 v[22:23], v4 offset:2208
    ds_read_b64_tr_b16 v[36:37], v4 offset:3264
    ds_read_b64_tr_b16 v[38:39], v4 offset:3296
    v_smfmac_f32_16x16x64_bf16 v[52:55], v[28:31], a[168:175], v2
    s_waitcnt lgkmcnt(8)
    ds_read_b128 v[32:35], v0 offset:30720
    ds_read_b128 v[28:31], v0 offset:29696
    v_smfmac_f32_16x16x64_bf16 v[48:51], v[24:27], a[176:183], v2
    v_smfmac_f32_16x16x64_bf16 v[52:55], v[24:27], a[184:191], v2
    ds_read_b128 v[24:27], v0 offset:28672
    s_waitcnt lgkmcnt(9)
    v_mfma_f32_16x16x32_bf16 v[8:11], v[40:43], v[12:15], 0
    s_waitcnt lgkmcnt(7)
    v_mfma_f32_16x16x32_bf16 v[8:11], v[44:47], v[16:19], v[8:11]
    ds_read_b128 v[44:47], v0 offset:31744
    v_mfma_f32_16x16x32_bf16 v[40:43], v[56:59], v[12:15], 0
    v_mfma_f32_16x16x32_bf16 v[40:43], v[60:63], v[16:19], v[40:43]
    s_waitcnt lgkmcnt(6)
    ds_read_b128 v[60:63], v0 offset:8192
    v_add_f32_dpp v8, v10, v8 quad_perm:[2,3,2,3] row_mask:0xf bank_mask:0xf
    v_mfma_f32_16x16x32_bf16 v[56:59], v[20:23], v[12:15], 0
    s_waitcnt lgkmcnt(5)
    v_add_f32_dpp v9, v11, v9 quad_perm:[2,3,2,3] row_mask:0xf bank_mask:0xf
    v_max_f32 v10, v8, v9
    v_mfma_f32_16x16x32_bf16 v[56:59], v[36:39], v[16:19], v[56:59]
    s_waitcnt lgkmcnt(2)
    ds_read_b128 v[36:39], v0 offset:9216
    v_add_f32_dpp v40, v42, v40 quad_perm:[2,3,2,3] row_mask:0xf bank_mask:0xf
    v_mfma_f32_16x16x32_bf16 v[20:23], v[24:27], v[12:15], 0
    v_add_f32_dpp v41, v43, v41 quad_perm:[2,3,2,3] row_mask:0xf bank_mask:0xf
    v_max3_f32 v10, v10, v40, v41
    v_mfma_f32_16x16x32_bf16 v[20:23], v[28:31], v[16:19], v[20:23]
    v_add_f32_dpp v56, v58, v56 quad_perm:[2,3,2,3] row_mask:0xf bank_mask:0xf
    v_mfma_f32_16x16x32_bf16 v[24:27], v[32:35], v[12:15], 0
    s_waitcnt lgkmcnt(2)
    v_add_f32_dpp v57, v59, v57 quad_perm:[2,3,2,3] row_mask:0xf bank_mask:0xf
    v_max3_f32 v10, v10, v56, v57
    v_mfma_f32_16x16x32_bf16 v[24:27], v[44:47], v[16:19], v[24:27]
    s_waitcnt lgkmcnt(1)
    v_add_f32_dpp v20, v22, v20 quad_perm:[2,3,2,3] row_mask:0xf bank_mask:0xf
    v_add_f32_dpp v21, v23, v21 quad_perm:[2,3,2,3] row_mask:0xf bank_mask:0xf
    v_smfmac_f32_16x16x64_bf16 v[48:51], v[60:63], a[192:199], v2
    ds_read_b128 v[32:35], v1 offset:2048
    v_max3_f32 v10, v10, v20, v21
    v_mov_b32 v17, 0
    s_nop 0
    v_add_f32_dpp v24, v26, v24 quad_perm:[2,3,2,3] row_mask:0xf bank_mask:0xf
    v_add_f32_dpp v25, v27, v25 quad_perm:[2,3,2,3] row_mask:0xf bank_mask:0xf
    v_max3_f32 v10, v10, v24, v25
    v_mov_b32 v11, v10
    v_smfmac_f32_16x16x64_bf16 v[52:55], v[60:63], a[200:207], v2
    s_waitcnt lgkmcnt(1)
    ds_read_b128 v[44:47], v1 offset:3072
    v_permlane32_swap_b32 v10, v11
    v_max_f32 v10, v10, v11
    v_mov_b32 v11, v10
    v_smfmac_f32_16x16x64_bf16 v[48:51], v[36:39], a[208:215], v2
    s_barrier
    v_permlane16_swap_b32 v10, v11
    v_max_f32 v10, v10, v11
    v_mul_f32 v10, s51, v10
    v_fma_f32 v8, v8, s51, -v10
    v_smfmac_f32_16x16x64_bf16 v[52:55], v[36:39], a[216:223], v2
    v_fma_f32 v9, v9, s51, -v10
    v_exp_f32 v8, v8
    v_fma_f32 v40, v40, s51, -v10
    v_exp_f32 v9, v9
    v_fma_f32 v41, v41, s51, -v10
    v_exp_f32 v40, v40
    v_cvt_pk_bf16_f32 v12, v8, v9
    v_fma_f32 v20, v20, s51, -v10
    v_exp_f32 v41, v41
    v_fma_f32 v21, v21, s51, -v10
    v_exp_f32 v20, v20
    v_cvt_pk_bf16_f32 v13, v40, v41
    v_fma_f32 v24, v24, s51, -v10
    v_exp_f32 v21, v21
    v_fma_f32 v25, v25, s51, -v10
    v_exp_f32 v24, v24
    v_cvt_pk_bf16_f32 v14, v20, v21
    v_fma_f32 v56, v56, s51, -v10
    v_exp_f32 v25, v25
    v_mov_b64 v[28:29], s[22:23]
    v_mov_b64 v[30:31], s[22:23]
    v_cvt_pk_bf16_f32 v15, v24, v25
    v_fma_f32 v57, v57, s51, -v10
    v_exp_f32 v56, v56
    v_mfma_f32_16x16x32_bf16 v[60:63], v[28:31], v[12:15], 0
    v_exp_f32 v57, v57
    s_waitcnt lgkmcnt(1)
    v_mfma_f32_16x16x32_bf16 v[32:35], v[32:35], v[12:15], 0
    v_cvt_pk_bf16_f32 v16, v56, v57
    v_add_f32 v48, v48, v50
    s_waitcnt lgkmcnt(0)
    v_mfma_f32_16x16x32_bf16 v[44:47], v[44:47], v[12:15], 0
    v_add_f32 v49, v49, v51
    v_add_f32 v52, v52, v54
    v_mfma_f32_16x16x16_bf16 v[60:63], v[28:29], v[16:17], v[60:63]
    v_add_f32 v53, v53, v55
    v_cvt_pk_bf16_f32 v22, v48, v49
    v_cvt_pk_bf16_f32 v23, v52, v53
    v_mov_b32 v18, 0
    v_mov_b32 v19, v16
    v_mfma_f32_16x16x16_bf16 v[32:35], v[22:23], v[16:17], v[32:35]
    ds_read_b128 v[48:51], v1 offset:20480
    ds_read_b128 v[52:55], v1 offset:21504
    v_mfma_f32_16x16x16_bf16 v[44:47], v[22:23], v[18:19], v[44:47]
    ds_read_b128 v[36:39], v1 offset:24576
    ds_read_b128 v[40:43], v1 offset:25600
    v_rcp_f32 v10, v60
    v_mov_b64 v[12:13], 0
    v_lshrrev_b32 v14, 1, v0
    v_permlane16_swap_b32 v22, v23
    v_pk_mul_f32 v[32:33], v[32:33], v[10:11] op_sel_hi:[1,0]
    v_pk_mul_f32 v[34:35], v[34:35], v[10:11] op_sel_hi:[1,0]
    v_cvt_pk_bf16_f32 v32, v32, v33
    v_cvt_pk_bf16_f32 v33, v34, v35
    v_pk_mul_f32 v[44:45], v[44:45], v[10:11] op_sel_hi:[1,0]
    v_pk_mul_f32 v[46:47], v[46:47], v[10:11] op_sel_hi:[1,0]
    v_cvt_pk_bf16_f32 v34, v44, v45
    v_cvt_pk_bf16_f32 v35, v46, v47
    v_mfma_f32_16x16x16_bf16 v[16:19], v[12:13], v[12:13], 0
    ds_write_b128 v5, v[32:35]
    buffer_store_dwordx2 v[22:23], v14, s[32:35], s97 offen sc1
    s_cmp_eq_u32 s40, 63
    s_cbranch_scc1 CH_exit_79
    v_mfma_f32_16x16x16_bf16 v[20:23], v[12:13], v[12:13], 0
    ds_read_b128 v[56:59], v1 offset:22528
    ds_read_b128 v[60:63], v1 offset:23552
    v_mfma_f32_16x16x16_bf16 v[24:27], v[12:13], v[12:13], 0
    v_mfma_f32_16x16x16_bf16 v[28:31], v[12:13], v[12:13], 0
    v_mfma_f32_16x16x16_bf16 v[8:11], v[12:13], v[12:13], 0
    s_waitcnt lgkmcnt(2)
    s_barrier
    ds_read_b128 v[32:35], v0 offset:10240
    ds_read_b128 v[44:47], v0 offset:11264
    v_lshlrev_b32 v15, 3, v0
    v_bfe_u32 v14, v0, 2, 6
    v_and_or_b32 v14, v15, s94, v14
    s_waitcnt lgkmcnt(1)
    v_smfmac_f32_16x16x64_bf16 v[16:19], v[32:35], v[48:55], v2
    ds_read_b128 v[48:51], v1 offset:26624
    ds_read_b128 v[52:55], v1 offset:27648
    s_waitcnt lgkmcnt(2)
    v_smfmac_f32_16x16x64_bf16 v[16:19], v[44:47], v[56:63], v2
    ds_read_b128 v[56:59], v1 offset:28672
    ds_read_b128 v[60:63], v1 offset:29696
    v_smfmac_f32_16x16x64_bf16 v[20:23], v[32:35], v[36:43], v2
    ds_read_b128 v[36:39], v1 offset:30720
    ds_read_b128 v[40:43], v1 offset:31744
    v_smfmac_f32_16x16x64_bf16 v[20:23], v[44:47], a[224:231], v2
    v_add_f32 v16, v16, v18
    v_add_f32 v17, v17, v19
    v_smfmac_f32_16x16x64_bf16 v[24:27], v[32:35], a[232:239], v2
    v_smfmac_f32_16x16x64_bf16 v[24:27], v[44:47], a[240:247], v2
    s_waitcnt lgkmcnt(4)
    v_add_f32 v20, v20, v22
    v_add_f32 v21, v21, v23
    v_smfmac_f32_16x16x64_bf16 v[28:31], v[32:35], v[48:55], v2
    v_cvt_pk_bf16_f32 v16, v16, v20
    v_cvt_pk_bf16_f32 v17, v17, v21
    v_smfmac_f32_16x16x64_bf16 v[28:31], v[44:47], a[248:255], v2
    s_waitcnt lgkmcnt(2)
    v_and_or_b32 v16, v16, -2, 0
    v_smfmac_f32_16x16x64_bf16 v[8:11], v[32:35], v[56:63], v2
    s_waitcnt lgkmcnt(0)
    buffer_store_dwordx2 v[16:17], v7, s[28:31], 0 offen sc1
    v_add_f32 v24, v24, v26
    v_add_f32 v25, v25, v27
    v_smfmac_f32_16x16x64_bf16 v[8:11], v[44:47], v[36:43], v2
    v_add_f32 v28, v28, v30
    v_add_f32 v29, v29, v31
    s_cmp_eq_u32 s21, 3
    v_cvt_pk_bf16_f32 v24, v24, v28
    v_cvt_pk_bf16_f32 v25, v25, v29
    v_and_or_b32 v24, v24, -2, 0
    buffer_store_dwordx2 v[24:25], v7, s[28:31], s61 offen sc1
    s_nop 0
    v_add_f32 v8, v8, v10
    v_add_f32 v9, v9, v11
    v_cvt_pk_bf16_f32 v8, v8, v9
    v_and_or_b32 v8, v8, -2, 0
    buffer_store_dword v8, v14, s[28:31], s62 offen sc1
    s_cbranch_scc1 CH_h_96
    v_lshrrev_b32 v56, s91, v0
    v_and_b32 v56, 16, v56
    v_lshlrev_b32_e64 v56, v56, s65
    v_cndmask_b32 v40, 0, v56, s[52:53]
    v_cndmask_b32 v41, 0, v56, s[54:55]
    v_cndmask_b32 v42, 0, v56, s[56:57]
    v_cndmask_b32 v43, 0, v56, s[58:59]
    v_mov_b64 v[58:59], -1
    s_mov_b32 s44, s43
    s_add_u32 s43, s43, 0x2000
    s_and_b32 s43, s43, 0x7fff
    s_add_u32 s43, s43, 163840
    s_mov_b32 s49, 0
    s_add_u32 s40, s40, 1
    s_add_u32 s90, s90, 32768
    s_add_u32 s96, s96, 131072
    s_add_u32 s97, s97, 131072
    s_cmp_lg_u32 s95, 0
    s_cbranch_scc1 CH_nt_100
    s_nop 5
    s_cmp_le_u32 s21, 0
    s_cbranch_scc1 CH_d_102
    s_nop 7
    s_cmp_le_u32 s21, 1
    s_cbranch_scc1 CH_d_102
    s_nop 7
CH_d_102:
    buffer_load_dwordx4 v[32:35], v0, s[28:31], s46 offen offset:0 sc1
    buffer_load_dwordx4 v[36:39], v0, s[28:31], s46 offen offset:1024 sc1
    v_add_u32 v61, s92, v0
    v_lshrrev_b32 v62, 2, v0
    v_add_u32 v62, s93, v62
    v_mov_b64 v[8:9], 0
    v_mov_b64 v[10:11], 0
    v_mov_b64 v[12:13], 0
    v_mov_b64 v[14:15], 0
    v_mov_b64 v[48:49], 0
    v_mov_b64 v[50:51], 0
    v_mov_b64 v[52:53], 0
    v_mov_b64 v[54:55], 0
    s_cmp_eq_u32 s21, 2
    s_cselect_b32 s47, 1, 0
    s_nop 15
    buffer_load_dwordx4 v[24:27], v0, s[28:31], s46 offen offset:0 sc1
    buffer_load_dwordx4 v[28:31], v0, s[28:31], s46 offen offset:1024 sc1
CH_h_99:
    s_waitcnt vmcnt(3)
    v_mfma_f32_16x16x32_bf16 v[44:47], v[40:43], v[32:35], 0
    s_waitcnt vmcnt(2)
    v_mfma_f32_16x16x32_bf16 v[44:47], v[40:43], v[36:39], v[44:47]
    v_bitop3_b32 v56, v33, v35, v37 bitop3:0xfe
    v_bitop3_b32 v57, v32, v34, v36 bitop3:0xfe
    v_bitop3_b32 v56, v56, v39, s47 bitop3:0xa8
    v_bitop3_b32 v56, v56, v57, v38 bitop3:0xfe
    v_and_b32 v56, 1, v56
    v_cmp_ne_u32 vcc, 0, v56
CH_ok_103:
    s_nop 1
    v_add_f32_dpp v44, v44, v44 row_ror:8 row_mask:0xf bank_mask:0xf
    v_add_f32_dpp v45, v45, v45 row_ror:8 row_mask:0xf bank_mask:0xf
    v_add_f32_dpp v46, v46, v46 row_ror:8 row_mask:0xf bank_mask:0xf
    v_add_f32_dpp v47, v47, v47 row_ror:8 row_mask:0xf bank_mask:0xf
    v_add_f32_dpp v44, v44, v44 row_ror:4 row_mask:0xf bank_mask:0xf
    v_add_f32_dpp v45, v45, v45 row_ror:4 row_mask:0xf bank_mask:0xf
    v_add_f32_dpp v46, v46, v46 row_ror:4 row_mask:0xf bank_mask:0xf
    v_add_f32_dpp v47, v47, v47 row_ror:4 row_mask:0xf bank_mask:0xf
    v_cvt_pk_bf16_f32 v56, v44, v45
    v_cvt_pk_bf16_f32 v57, v46, v47
    v_min_u32 v56, -2, v56
    v_min_u32 v57, -2, v57
    s_cbranch_vccnz CH_h_98
    buffer_store_dwordx2 v[56:57], v6, s[28:31], s43 offen sc1
CH_x0_101:
    s_barrier
    buffer_store_dwordx2 v[56:57], v6, s[36:39], s50 offen sc1
    buffer_store_dwordx2 v[58:59], v6, s[28:31], s44 offen sc1
    s_add_u32 s50, s50, 32768
    v_mov_b64 v[16:17], 0
    v_mov_b64 v[18:19], 0
    v_mov_b64 v[20:21], 0
    v_mov_b64 v[22:23], 0
    s_nop 15
    s_nop 15
    s_nop 15
    s_nop 15
    s_nop 3
    s_branch CH_h_97
CH_h_96:
    v_add_u32 v61, s92, v0
    v_lshrrev_b32 v62, 2, v0
    v_add_u32 v62, s93, v62
    v_mov_b64 v[48:49], 0
    v_mov_b64 v[50:51], 0
    v_mov_b64 v[52:53], 0
    v_mov_b64 v[54:55], 0
    s_mov_b32 s44, s43
    s_add_u32 s43, s43, 0x2000
    s_and_b32 s43, s43, 0x7fff
    s_add_u32 s43, s43, 163840
    s_mov_b32 s49, 0
    s_add_u32 s40, s40, 1
    s_add_u32 s90, s90, 32768
    s_add_u32 s96, s96, 131072
    s_add_u32 s97, s97, 131072
    v_mfma_f32_32x32x2_f32 v[8:23], v48, v48, 0
    v_mfma_f32_32x32x2_f32 v[8:23], v48, v48, v[8:23]
    v_mfma_f32_32x32x2_f32 v[8:23], v48, v48, v[8:23]
    v_mfma_f32_32x32x2_f32 v[8:23], v48, v48, v[8:23]
    v_mfma_f32_32x32x2_f32 v[8:23], v48, v48, v[8:23]
    s_waitcnt vmcnt(0)
    v_and_b32 v40, 48, v0
    ds_read_b32 v41, v40 offset:15360
    s_add_u32 s47, s40, 2
    s_min_u32 s47, s47, 64
    s_add_u32 s47, s47, s99
CH_fb_105:
    s_waitcnt lgkmcnt(0)
    v_cmp_gt_u32 vcc, s47, v41
    s_cbranch_vccnz CH_fp_104
    v_mfma_f32_32x32x2_f32 v[8:23], v48, v48, v[8:23]
    s_barrier
    s_nop 15
    s_nop 15
    s_nop 15
    s_nop 15
    s_nop 15
CH_h_97:
    buffer_load_dwordx4 v[24:27], v61, s[28:31], s43 offen sc1
    buffer_load_dword v28, v62, s[28:31], s43 offen sc1
    s_waitcnt vmcnt(1)
    ds_write_b128 v61, v[24:27] offset:0
    s_waitcnt vmcnt(0)
    ds_write_b32 v62, v28 offset:0
    v_max3_u32 v63, v24, v26, v28
    v_cmp_eq_u32 vcc, -1, v63
    s_cbranch_vccnz CH_re_106
CH_bk_107:
    buffer_load_dwordx4 v[56:59], v61, s[36:39], s90 offen sc1
    buffer_load_dword v60, v62, s[36:39], s90 offen sc1
    s_branch CH_top_78
CH_re_80:
    buffer_load_dwordx4 v[56:59], v61, s[36:39], s90 offen sc1
    buffer_load_dword v60, v62, s[36:39], s90 offen sc1
    s_add_u32 s49, s49, 1
    s_cmp_gt_u32 s49, 400000
    s_cbranch_scc1 L_end
    s_waitcnt vmcnt(0)
    v_max3_u32 v63, v56, v58, v60
    v_cmp_eq_u32 vcc, -1, v63
    s_cbranch_vccnz CH_re_80
    ds_write_b128 v61, v[56:59] offset:5120
    ds_write_b32 v62, v60 offset:5120
    s_waitcnt lgkmcnt(0)
    s_branch CH_bk_81
CH_nt_86:
    v_add_u32 v61, s92, v0
    v_lshrrev_b32 v62, 2, v0
    v_add_u32 v62, s93, v62
    v_mov_b64 v[8:9], 0
    v_mov_b64 v[10:11], 0
    v_mov_b64 v[12:13], 0
    v_mov_b64 v[14:15], 0
    v_mov_b64 v[16:17], 0
    v_mov_b64 v[18:19], 0
    v_mov_b64 v[20:21], 0
    v_mov_b64 v[22:23], 0
    v_mov_b64 v[48:49], 0
    v_mov_b64 v[50:51], 0
    v_mov_b64 v[52:53], 0
    v_mov_b64 v[54:55], 0
    s_waitcnt vmcnt(0)
    s_branch CH_x0_87
CH_h_84:
    buffer_load_dwordx4 v[32:35], v0, s[28:31], s46 offen offset:0 sc1
    buffer_load_dwordx4 v[36:39], v0, s[28:31], s46 offen offset:1024 sc1
    s_waitcnt vmcnt(3)
    v_mfma_f32_16x16x32_bf16 v[44:47], v[40:43], v[24:27], 0
    s_waitcnt vmcnt(2)
    v_mfma_f32_16x16x32_bf16 v[44:47], v[40:43], v[28:31], v[44:47]
    v_bitop3_b32 v56, v25, v27, v29 bitop3:0x80
    v_bitop3_b32 v57, v24, v26, v28 bitop3:0x80
    v_bitop3_b32 v56, v56, v31, s47 bitop3:0xea
    v_bitop3_b32 v56, v56, v57, v30 bitop3:0x80
    v_and_b32 v56, 1, v56
    v_cmp_ne_u32 vcc, 1, v56
    s_cbranch_vccz CH_ok_89
    buffer_load_dwordx4 v[24:27], v0, s[28:31], s46 offen offset:0 sc1
    buffer_load_dwordx4 v[28:31], v0, s[28:31], s46 offen offset:1024 sc1
    s_add_u32 s49, s49, 1
    s_cmp_gt_u32 s49, 400000
    s_cbranch_scc1 L_end
    s_branch CH_h_85
CH_fp_90:
    buffer_load_dword v41, v40, s[32:35], s98 offen sc1
    s_add_u32 s49, s49, 1
    s_cmp_gt_u32 s49, 400000
    s_cbranch_scc1 L_end
    s_waitcnt vmcnt(0)
    s_branch CH_fb_91
CH_re_92:
    buffer_load_dwordx4 v[24:27], v61, s[28:31], s43 offen sc1
    buffer_load_dword v28, v62, s[28:31], s43 offen sc1
    s_add_u32 s49, s49, 1
    s_cmp_gt_u32 s49, 400000
    s_cbranch_scc1 L_end
    s_waitcnt vmcnt(0)
    v_max3_u32 v63, v24, v26, v28
    v_cmp_eq_u32 vcc, -1, v63
    s_cbranch_vccnz CH_re_92
    ds_write_b128 v61, v[24:27] offset:0
    ds_write_b32 v62, v28 offset:0
    s_waitcnt lgkmcnt(0)
    s_branch CH_bk_93
CH_re_94:
    buffer_load_dwordx4 v[56:59], v61, s[36:39], s90 offen sc1
    buffer_load_dword v60, v62, s[36:39], s90 offen sc1
    s_add_u32 s49, s49, 1
    s_cmp_gt_u32 s49, 400000
    s_cbranch_scc1 L_end
    s_waitcnt vmcnt(0)
    v_max3_u32 v63, v56, v58, v60
    v_cmp_eq_u32 vcc, -1, v63
    s_cbranch_vccnz CH_re_94
    ds_write_b128 v61, v[56:59] offset:5120
    ds_write_b32 v62, v60 offset:5120
    s_waitcnt lgkmcnt(0)
    s_branch CH_bk_95
CH_nt_100:
    v_add_u32 v61, s92, v0
    v_lshrrev_b32 v62, 2, v0
    v_add_u32 v62, s93, v62
    v_mov_b64 v[8:9], 0
    v_mov_b64 v[10:11], 0
    v_mov_b64 v[12:13], 0
    v_mov_b64 v[14:15], 0
    v_mov_b64 v[16:17], 0
    v_mov_b64 v[18:19], 0
    v_mov_b64 v[20:21], 0
    v_mov_b64 v[22:23], 0
    v_mov_b64 v[48:49], 0
    v_mov_b64 v[50:51], 0
    v_mov_b64 v[52:53], 0
    v_mov_b64 v[54:55], 0
    s_waitcnt vmcnt(0)
    s_branch CH_x0_101
CH_h_98:
    buffer_load_dwordx4 v[32:35], v0, s[28:31], s46 offen offset:0 sc1
    buffer_load_dwordx4 v[36:39], v0, s[28:31], s46 offen offset:1024 sc1
    s_waitcnt vmcnt(3)
    v_mfma_f32_16x16x32_bf16 v[44:47], v[40:43], v[24:27], 0
    s_waitcnt vmcnt(2)
    v_mfma_f32_16x16x32_bf16 v[44:47], v[40:43], v[28:31], v[44:47]
    v_bitop3_b32 v56, v25, v27, v29 bitop3:0xfe
    v_bitop3_b32 v57, v24, v26, v28 bitop3:0xfe
    v_bitop3_b32 v56, v56, v31, s47 bitop3:0xa8
    v_bitop3_b32 v56, v56, v57, v30 bitop3:0xfe
    v_and_b32 v56, 1, v56
    v_cmp_ne_u32 vcc, 0, v56
    s_cbranch_vccz CH_ok_103
    buffer_load_dwordx4 v[24:27], v0, s[28:31], s46 offen offset:0 sc1
    buffer_load_dwordx4 v[28:31], v0, s[28:31], s46 offen offset:1024 sc1
    s_add_u32 s49, s49, 1
    s_cmp_gt_u32 s49, 400000
    s_cbranch_scc1 L_end
    s_branch CH_h_99
CH_fp_104:
    buffer_load_dword v41, v40, s[32:35], s98 offen sc1
    s_add_u32 s49, s49, 1
    s_cmp_gt_u32 s49, 400000
    s_cbranch_scc1 L_end
    s_waitcnt vmcnt(0)
    s_branch CH_fb_105
CH_re_106:
    buffer_load_dwordx4 v[24:27], v61, s[28:31], s43 offen sc1
    buffer_load_dword v28, v62, s[28:31], s43 offen sc1
    s_add_u32 s49, s49, 1
    s_cmp_gt_u32 s49, 400000
    s_cbranch_scc1 L_end
    s_waitcnt vmcnt(0)
    v_max3_u32 v63, v24, v26, v28
    v_cmp_eq_u32 vcc, -1, v63
    s_cbranch_vccnz CH_re_106
    ds_write_b128 v61, v[24:27] offset:0
    ds_write_b32 v62, v28 offset:0
    s_waitcnt lgkmcnt(0)
    s_branch CH_bk_107
CH_exit_79:
CH_fin_19:
    s_waitcnt vmcnt(0) lgkmcnt(0)
    s_nop 15
    s_nop 3
    s_barrier
    v_mov_b64 v[8:9], 0
    s_cmp_lg_u32 s21, 0
    s_cbranch_scc1 CH_z_108
    buffer_store_dwordx2 v[8:9], v6, s[36:39], s50 offen sc1
CH_z_108:
    s_add_u32 s100, s100, 1
    s_cmp_ge_u32 s100, 2
    s_cbranch_scc1 L_end
    s_add_u32 s28, s28, 393216
    s_addc_u32 s29, s29, 0
    s_waitcnt vmcnt(0)
    s_branch CH_layer_15
L_end:
    s_endpgm
L_worker:
    s_sub_u32 s3, s3, 2
    s_lshl_b32 s3, s3, 5
    s_add_u32 s28, s3, s2
    v_readfirstlane_b32 s29, v1
    v_and_b32 v1, 63, v0
    v_lshlrev_b32 v0, 4, v1
    s_load_dwordx2 s[4:5], s[0:1], 96
    s_mov_b32 s6, 268435456
    s_mov_b32 s7, 0x20000
    s_waitcnt lgkmcnt(0)
    s_load_dwordx2 s[8:9], s[0:1], 0
    s_mov_b32 s10, 2621440
    s_mov_b32 s11, 0x20000
    s_waitcnt lgkmcnt(0)
    s_load_dwordx2 s[12:13], s[0:1], 80
    s_mov_b32 s14, 2621440
    s_mov_b32 s15, 0x20000
    s_waitcnt lgkmcnt(0)
    s_load_dwordx2 s[24:25], s[0:1], 88
    s_mov_b32 s26, 256
    s_mov_b32 s27, 0x20000
    s_waitcnt lgkmcnt(0)
    s_mul_i32 s60, s29, 20480
    s_add_u32 s60, s60, 69632
    s_mov_b32 s30, 0
    s_mov_b32 s61, 0
    s_cmp_lg_u32 s28, 191
    s_cbranch_scc1 I_109
    v_mov_b64 v[4:5], 0
    v_mov_b64 v[6:7], 0
    s_lshl_b32 s32, s29, 13
    s_add_u32 s33, s32, 0
    buffer_store_dwordx4 v[4:7], v0, s[4:7], s33 offen sc1
    s_add_u32 s33, s32, 1024
    buffer_store_dwordx4 v[4:7], v0, s[4:7], s33 offen sc1
    s_add_u32 s33, s32, 2048
    buffer_store_dwordx4 v[4:7], v0, s[4:7], s33 offen sc1
    s_add_u32 s33, s32, 3072
    buffer_store_dwordx4 v[4:7], v0, s[4:7], s33 offen sc1
    s_add_u32 s33, s32, 4096
    buffer_store_dwordx4 v[4:7], v0, s[4:7], s33 offen sc1
    s_add_u32 s33, s32, 5120
    buffer_store_dwordx4 v[4:7], v0, s[4:7], s33 offen sc1
    s_add_u32 s33, s32, 6144
    buffer_store_dwordx4 v[4:7], v0, s[4:7], s33 offen sc1
    s_add_u32 s33, s32, 7168
    buffer_store_dwordx4 v[4:7], v0, s[4:7], s33 offen sc1
    s_waitcnt vmcnt(0)
    s_barrier
    v_mov_b32 v8, 1
    buffer_store_dword v8, off, s[24:27], 0 offset:0 sc1
I_109:
    s_mul_i32 s66, s28, 6554
    s_lshr_b32 s66, s66, 16
    s_mul_i32 s67, s66, 10
    s_sub_u32 s67, s28, s67
    s_cmp_ge_u32 s28, 160
    s_cbranch_scc1 R_110
    s_load_dwordx2 s[16:17], s[0:1], 8
    s_mov_b32 s18, 1314816
    s_mov_b32 s19, 0x20000
    s_waitcnt lgkmcnt(0)
    s_load_dwordx2 s[20:21], s[0:1], 16
    s_mov_b32 s22, 1314816
    s_mov_b32 s23, 0x20000
    s_waitcnt lgkmcnt(0)
    s_lshl_b32 s34, s28, 2
    s_add_u32 s34, s34, s29
    s_mul_i32 s35, s34, 13108
    s_lshr_b32 s35, s35, 16
    s_mul_i32 s36, s35, 5
    s_sub_u32 s36, s34, s36
    s_lshr_b32 s37, s35, 1
    s_and_b32 s38, s35, 1
    s_lshl_b32 s38, s38, 8
    s_add_u32 s37, s37, s38
    s_mul_i32 s37, s37, 642
    s_lshl_b32 s38, s36, 7
    s_add_u32 s37, s37, s38
    v_lshlrev_b32 v232, 1, v1
    s_add_u32 s38, s37, 2
    buffer_load_ushort v200, v232, s[16:19], s38 offen
    buffer_load_ushort v216, v232, s[20:23], s38 offen
    s_add_u32 s38, s37, 41090
    buffer_load_ushort v201, v232, s[16:19], s38 offen
    buffer_load_ushort v217, v232, s[20:23], s38 offen
    s_add_u32 s38, s37, 82178
    buffer_load_ushort v202, v232, s[16:19], s38 offen
    buffer_load_ushort v218, v232, s[20:23], s38 offen
    s_add_u32 s38, s37, 123266
    buffer_load_ushort v203, v232, s[16:19], s38 offen
    buffer_load_ushort v219, v232, s[20:23], s38 offen
    s_add_u32 s38, s37, 328706
    buffer_load_ushort v204, v232, s[16:19], s38 offen
    buffer_load_ushort v220, v232, s[20:23], s38 offen
    s_add_u32 s38, s37, 369794
    buffer_load_ushort v205, v232, s[16:19], s38 offen
    buffer_load_ushort v221, v232, s[20:23], s38 offen
    s_add_u32 s38, s37, 410882
    buffer_load_ushort v206, v232, s[16:19], s38 offen
    buffer_load_ushort v222, v232, s[20:23], s38 offen
    s_add_u32 s38, s37, 451970
    buffer_load_ushort v207, v232, s[16:19], s38 offen
    buffer_load_ushort v223, v232, s[20:23], s38 offen
    s_add_u32 s38, s37, 657410
    buffer_load_ushort v208, v232, s[16:19], s38 offen
    buffer_load_ushort v224, v232, s[20:23], s38 offen
    s_add_u32 s38, s37, 698498
    buffer_load_ushort v209, v232, s[16:19], s38 offen
    buffer_load_ushort v225, v232, s[20:23], s38 offen
    s_add_u32 s38, s37, 739586
    buffer_load_ushort v210, v232, s[16:19], s38 offen
    buffer_load_ushort v226, v232, s[20:23], s38 offen
    s_add_u32 s38, s37, 780674
    buffer_load_ushort v211, v232, s[16:19], s38 offen
    buffer_load_ushort v227, v232, s[20:23], s38 offen
    s_add_u32 s38, s37, 986114
    buffer_load_ushort v212, v232, s[16:19], s38 offen
    buffer_load_ushort v228, v232, s[20:23], s38 offen
    s_add_u32 s38, s37, 1027202
    buffer_load_ushort v213, v232, s[16:19], s38 offen
    buffer_load_ushort v229, v232, s[20:23], s38 offen
    s_add_u32 s38, s37, 1068290
    buffer_load_ushort v214, v232, s[16:19], s38 offen
    buffer_load_ushort v230, v232, s[20:23], s38 offen
    s_add_u32 s38, s37, 1109378
    buffer_load_ushort v215, v232, s[16:19], s38 offen
    buffer_load_ushort v231, v232, s[20:23], s38 offen
    s_mul_i32 s62, s35, 20480
    s_lshl_b32 s38, s36, 10
    s_add_u32 s62, s62, s38
    s_add_u32 s62, s62, 8388608
R_110:
    s_mul_i32 s63, s28, 10923
    s_lshr_b32 s63, s63, 16
    s_mul_i32 s65, s63, 6
    s_sub_u32 s65, s28, s65
    s_lshr_b32 s64, s65, 1
    s_and_b32 s65, s65, 1
    s_lshl_b32 s34, s64, 3
    s_add_u32 s34, s34, 48
    s_cmp_eq_u32 s64, 2
    s_cselect_b32 s34, 40, s34
    s_load_dwordx2 s[16:17], s[0:1], s34
    s_mov_b32 s18, 5242880
    s_mov_b32 s19, 0x20000
    s_waitcnt lgkmcnt(0)
    v_bfe_u32 v2, v1, 3, 3
    v_mul_u32_u24 v2, 8192, v2
    v_bfe_u32 v3, v1, 0, 3
    v_lshl_add_u32 v2, v3, 4, v2
    s_mul_i32 s34, s29, 1310720
    s_lshl_b32 s35, s63, 8
    s_add_u32 s34, s34, s35
    s_lshl_b32 s35, s65, 7
    s_add_u32 s34, s34, s35
    s_add_u32 m0, s60, 0
    s_add_u32 s35, s34, 0
    buffer_load_dwordx4 v2, s[16:19], s35 offen lds
    s_add_u32 m0, s60, 1024
    s_add_u32 s35, s34, 65536
    buffer_load_dwordx4 v2, s[16:19], s35 offen lds
    s_add_u32 m0, s60, 2048
    s_add_u32 s35, s34, 131072
    buffer_load_dwordx4 v2, s[16:19], s35 offen lds
    s_add_u32 m0, s60, 3072
    s_add_u32 s35, s34, 196608
    buffer_load_dwordx4 v2, s[16:19], s35 offen lds
    s_add_u32 m0, s60, 4096
    s_add_u32 s35, s34, 262144
    buffer_load_dwordx4 v2, s[16:19], s35 offen lds
    s_add_u32 m0, s60, 5120
    s_add_u32 s35, s34, 327680
    buffer_load_dwordx4 v2, s[16:19], s35 offen lds
    s_add_u32 m0, s60, 6144
    s_add_u32 s35, s34, 393216
    buffer_load_dwordx4 v2, s[16:19], s35 offen lds
    s_add_u32 m0, s60, 7168
    s_add_u32 s35, s34, 458752
    buffer_load_dwordx4 v2, s[16:19], s35 offen lds
    s_add_u32 m0, s60, 8192
    s_add_u32 s35, s34, 524288
    buffer_load_dwordx4 v2, s[16:19], s35 offen lds
    s_add_u32 m0, s60, 9216
    s_add_u32 s35, s34, 589824
    buffer_load_dwordx4 v2, s[16:19], s35 offen lds
    s_add_u32 m0, s60, 10240
    s_add_u32 s35, s34, 655360
    buffer_load_dwordx4 v2, s[16:19], s35 offen lds
    s_add_u32 m0, s60, 11264
    s_add_u32 s35, s34, 720896
    buffer_load_dwordx4 v2, s[16:19], s35 offen lds
    s_add_u32 m0, s60, 12288
    s_add_u32 s35, s34, 786432
    buffer_load_dwordx4 v2, s[16:19], s35 offen lds
    s_add_u32 m0, s60, 13312
    s_add_u32 s35, s34, 851968
    buffer_load_dwordx4 v2, s[16:19], s35 offen lds
    s_add_u32 m0, s60, 14336
    s_add_u32 s35, s34, 917504
    buffer_load_dwordx4 v2, s[16:19], s35 offen lds
    s_add_u32 m0, s60, 15360
    s_add_u32 s35, s34, 983040
    buffer_load_dwordx4 v2, s[16:19], s35 offen lds
    s_add_u32 m0, s60, 16384
    s_add_u32 s35, s34, 1048576
    buffer_load_dwordx4 v2, s[16:19], s35 offen lds
    s_add_u32 m0, s60, 17408
    s_add_u32 s35, s34, 1114112
    buffer_load_dwordx4 v2, s[16:19], s35 offen lds
    s_add_u32 m0, s60, 18432
    s_add_u32 s35, s34, 1179648
    buffer_load_dwordx4 v2, s[16:19], s35 offen lds
    s_add_u32 m0, s60, 19456
    s_add_u32 s35, s34, 1245184
    buffer_load_dwordx4 v2, s[16:19], s35 offen lds
    s_mov_b32 s35, 0x3acccccd
    s_lshl_b32 s34, s67, 6
    s_add_u32 s34, s34, 0
    s_lshr_b32 s34, s34, 1
    s_add_u32 s34, s34, 1
    v_bfe_u32 v5, v1, 1, 4
    v_add_u32 v5, s34, v5
    s_mul_i32 s36, s29, 160
    v_bfe_u32 v4, v1, 5, 1
    v_mul_u32_u24 v4, 8, v4
    v_add_u32 v4, s36, v4
    v_mul_u32_u24 v4, v4, v5
    v_and_b32 v6, 1, v1
    v_mul_u32_u24 v6, 160, v6
    v_add_u32 v4, v4, v6
    v_cvt_f32_u32 v4, v4
    v_cvt_f32_u32 v5, v5
    v_mul_f32 v4, s35, v4
    v_mul_f32 v5, s35, v5
    v_fract_f32 v4, v4
    v_fmamk_f32 v6, v5, 0x0, v4
    v_fmamk_f32 v7, v5, 0x3f800000, v4
    v_cos_f32 v7, v7
    v_cos_f32 v6, v6
    s_nop 0
    v_cvt_pk_bf16_f32 v10, v6, v7
    v_fmamk_f32 v8, v5, 0x40000000, v4
    v_fmamk_f32 v9, v5, 0x40400000, v4
    v_cos_f32 v9, v9
    v_cos_f32 v8, v8
    v_accvgpr_write_b32 a160, v10
    v_cvt_pk_bf16_f32 v10, v8, v9
    v_fmamk_f32 v6, v5, 0x40800000, v4
    v_fmamk_f32 v7, v5, 0x40a00000, v4
    v_cos_f32 v7, v7
    v_cos_f32 v6, v6
    v_accvgpr_write_b32 a161, v10
    v_cvt_pk_bf16_f32 v10, v6, v7
    v_fmamk_f32 v8, v5, 0x40c00000, v4
    v_fmamk_f32 v9, v5, 0x40e00000, v4
    v_cos_f32 v9, v9
    v_cos_f32 v8, v8
    v_accvgpr_write_b32 a162, v10
    v_cvt_pk_bf16_f32 v10, v8, v9
    v_fmamk_f32 v6, v5, 0x41800000, v4
    v_fmamk_f32 v7, v5, 0x41880000, v4
    v_cos_f32 v7, v7
    v_cos_f32 v6, v6
    v_accvgpr_write_b32 a163, v10
    v_cvt_pk_bf16_f32 v10, v6, v7
    v_fmamk_f32 v8, v5, 0x41900000, v4
    v_fmamk_f32 v9, v5, 0x41980000, v4
    v_cos_f32 v9, v9
    v_cos_f32 v8, v8
    v_accvgpr_write_b32 a164, v10
    v_cvt_pk_bf16_f32 v10, v8, v9
    v_fmamk_f32 v6, v5, 0x41a00000, v4
    v_fmamk_f32 v7, v5, 0x41a80000, v4
    v_cos_f32 v7, v7
    v_cos_f32 v6, v6
    v_accvgpr_write_b32 a165, v10
    v_cvt_pk_bf16_f32 v10, v6, v7
    v_fmamk_f32 v8, v5, 0x41b00000, v4
    v_fmamk_f32 v9, v5, 0x41b80000, v4
    v_cos_f32 v9, v9
    v_cos_f32 v8, v8
    v_accvgpr_write_b32 a166, v10
    v_cvt_pk_bf16_f32 v10, v8, v9
    v_fmamk_f32 v6, v5, 0x42000000, v4
    v_fmamk_f32 v7, v5, 0x42040000, v4
    v_cos_f32 v7, v7
    v_cos_f32 v6, v6
    v_accvgpr_write_b32 a167, v10
    v_cvt_pk_bf16_f32 v10, v6, v7
    v_fmamk_f32 v8, v5, 0x42080000, v4
    v_fmamk_f32 v9, v5, 0x420c0000, v4
    v_cos_f32 v9, v9
    v_cos_f32 v8, v8
    v_accvgpr_write_b32 a168, v10
    v_cvt_pk_bf16_f32 v10, v8, v9
    v_fmamk_f32 v6, v5, 0x42100000, v4
    v_fmamk_f32 v7, v5, 0x42140000, v4
    v_cos_f32 v7, v7
    v_cos_f32 v6, v6
    v_accvgpr_write_b32 a169, v10
    v_cvt_pk_bf16_f32 v10, v6, v7
    v_fmamk_f32 v8, v5, 0x42180000, v4
    v_fmamk_f32 v9, v5, 0x421c0000, v4
    v_cos_f32 v9, v9
    v_cos_f32 v8, v8
    v_accvgpr_write_b32 a170, v10
    v_cvt_pk_bf16_f32 v10, v8, v9
    v_fmamk_f32 v6, v5, 0x42400000, v4
    v_fmamk_f32 v7, v5, 0x42440000, v4
    v_cos_f32 v7, v7
    v_cos_f32 v6, v6
    v_accvgpr_write_b32 a171, v10
    v_cvt_pk_bf16_f32 v10, v6, v7
    v_fmamk_f32 v8, v5, 0x42480000, v4
    v_fmamk_f32 v9, v5, 0x424c0000, v4
    v_cos_f32 v9, v9
    v_cos_f32 v8, v8
    v_accvgpr_write_b32 a172, v10
    v_cvt_pk_bf16_f32 v10, v8, v9
    v_fmamk_f32 v6, v5, 0x42500000, v4
    v_fmamk_f32 v7, v5, 0x42540000, v4
    v_cos_f32 v7, v7
    v_cos_f32 v6, v6
    v_accvgpr_write_b32 a173, v10
    v_cvt_pk_bf16_f32 v10, v6, v7
    v_fmamk_f32 v8, v5, 0x42580000, v4
    v_fmamk_f32 v9, v5, 0x425c0000, v4
    v_cos_f32 v9, v9
    v_cos_f32 v8, v8
    v_accvgpr_write_b32 a174, v10
    v_cvt_pk_bf16_f32 v10, v8, v9
    v_fmamk_f32 v6, v5, 0x42800000, v4
    v_fmamk_f32 v7, v5, 0x42820000, v4
    v_cos_f32 v7, v7
    v_cos_f32 v6, v6
    v_accvgpr_write_b32 a175, v10
    v_cvt_pk_bf16_f32 v10, v6, v7
    v_fmamk_f32 v8, v5, 0x42840000, v4
    v_fmamk_f32 v9, v5, 0x42860000, v4
    v_cos_f32 v9, v9
    v_cos_f32 v8, v8
    v_accvgpr_write_b32 a176, v10
    v_cvt_pk_bf16_f32 v10, v8, v9
    v_fmamk_f32 v6, v5, 0x42880000, v4
    v_fmamk_f32 v7, v5, 0x428a0000, v4
    v_cos_f32 v7, v7
    v_cos_f32 v6, v6
    v_accvgpr_write_b32 a177, v10
    v_cvt_pk_bf16_f32 v10, v6, v7
    v_fmamk_f32 v8, v5, 0x428c0000, v4
    v_fmamk_f32 v9, v5, 0x428e0000, v4
    v_cos_f32 v9, v9
    v_cos_f32 v8, v8
    v_accvgpr_write_b32 a178, v10
    v_cvt_pk_bf16_f32 v10, v8, v9
    v_fmamk_f32 v6, v5, 0x42a00000, v4
    v_fmamk_f32 v7, v5, 0x42a20000, v4
    v_cos_f32 v7, v7
    v_cos_f32 v6, v6
    v_accvgpr_write_b32 a179, v10
    v_cvt_pk_bf16_f32 v10, v6, v7
    v_fmamk_f32 v8, v5, 0x42a40000, v4
    v_fmamk_f32 v9, v5, 0x42a60000, v4
    v_cos_f32 v9, v9
    v_cos_f32 v8, v8
    v_accvgpr_write_b32 a180, v10
    v_cvt_pk_bf16_f32 v10, v8, v9
    v_fmamk_f32 v6, v5, 0x42a80000, v4
    v_fmamk_f32 v7, v5, 0x42aa0000, v4
    v_cos_f32 v7, v7
    v_cos_f32 v6, v6
    v_accvgpr_write_b32 a181, v10
    v_cvt_pk_bf16_f32 v10, v6, v7
    v_fmamk_f32 v8, v5, 0x42ac0000, v4
    v_fmamk_f32 v9, v5, 0x42ae0000, v4
    v_cos_f32 v9, v9
    v_cos_f32 v8, v8
    v_accvgpr_write_b32 a182, v10
    v_cvt_pk_bf16_f32 v10, v8, v9
    v_fmamk_f32 v6, v5, 0x42c00000, v4
    v_fmamk_f32 v7, v5, 0x42c20000, v4
    v_cos_f32 v7, v7
    v_cos_f32 v6, v6
    v_accvgpr_write_b32 a183, v10
    v_cvt_pk_bf16_f32 v10, v6, v7
    v_fmamk_f32 v8, v5, 0x42c40000, v4
    v_fmamk_f32 v9, v5, 0x42c60000, v4
    v_cos_f32 v9, v9
    v_cos_f32 v8, v8
    v_accvgpr_write_b32 a184, v10
    v_cvt_pk_bf16_f32 v10, v8, v9
    v_fmamk_f32 v6, v5, 0x42c80000, v4
    v_fmamk_f32 v7, v5, 0x42ca0000, v4
    v_cos_f32 v7, v7
    v_cos_f32 v6, v6
    v_accvgpr_write_b32 a185, v10
    v_cvt_pk_bf16_f32 v10, v6, v7
    v_fmamk_f32 v8, v5, 0x42cc0000, v4
    v_fmamk_f32 v9, v5, 0x42ce0000, v4
    v_cos_f32 v9, v9
    v_cos_f32 v8, v8
    v_accvgpr_write_b32 a186, v10
    v_cvt_pk_bf16_f32 v10, v8, v9
    v_fmamk_f32 v6, v5, 0x42e00000, v4
    v_fmamk_f32 v7, v5, 0x42e20000, v4
    v_cos_f32 v7, v7
    v_cos_f32 v6, v6
    v_accvgpr_write_b32 a187, v10
    v_cvt_pk_bf16_f32 v10, v6, v7
    v_fmamk_f32 v8, v5, 0x42e40000, v4
    v_fmamk_f32 v9, v5, 0x42e60000, v4
    v_cos_f32 v9, v9
    v_cos_f32 v8, v8
    v_accvgpr_write_b32 a188, v10
    v_cvt_pk_bf16_f32 v10, v8, v9
    v_fmamk_f32 v6, v5, 0x42e80000, v4
    v_fmamk_f32 v7, v5, 0x42ea0000, v4
    v_cos_f32 v7, v7
    v_cos_f32 v6, v6
    v_accvgpr_write_b32 a189, v10
    v_cvt_pk_bf16_f32 v10, v6, v7
    v_fmamk_f32 v8, v5, 0x42ec0000, v4
    v_fmamk_f32 v9, v5, 0x42ee0000, v4
    v_cos_f32 v9, v9
    v_cos_f32 v8, v8
    v_accvgpr_write_b32 a190, v10
    v_cvt_pk_bf16_f32 v10, v8, v9
    v_fmamk_f32 v6, v5, 0x43000000, v4
    v_fmamk_f32 v7, v5, 0x43010000, v4
    v_cos_f32 v7, v7
    v_cos_f32 v6, v6
    v_accvgpr_write_b32 a191, v10
    v_cvt_pk_bf16_f32 v10, v6, v7
    v_fmamk_f32 v8, v5, 0x43020000, v4
    v_fmamk_f32 v9, v5, 0x43030000, v4
    v_cos_f32 v9, v9
    v_cos_f32 v8, v8
    v_accvgpr_write_b32 a192, v10
    v_cvt_pk_bf16_f32 v10, v8, v9
    v_fmamk_f32 v6, v5, 0x43040000, v4
    v_fmamk_f32 v7, v5, 0x43050000, v4
    v_cos_f32 v7, v7
    v_cos_f32 v6, v6
    v_accvgpr_write_b32 a193, v10
    v_cvt_pk_bf16_f32 v10, v6, v7
    v_fmamk_f32 v8, v5, 0x43060000, v4
    v_fmamk_f32 v9, v5, 0x43070000, v4
    v_cos_f32 v9, v9
    v_cos_f32 v8, v8
    v_accvgpr_write_b32 a194, v10
    v_cvt_pk_bf16_f32 v10, v8, v9
    v_fmamk_f32 v6, v5, 0x43100000, v4
    v_fmamk_f32 v7, v5, 0x43110000, v4
    v_cos_f32 v7, v7
    v_cos_f32 v6, v6
    v_accvgpr_write_b32 a195, v10
    v_cvt_pk_bf16_f32 v10, v6, v7
    v_fmamk_f32 v8, v5, 0x43120000, v4
    v_fmamk_f32 v9, v5, 0x43130000, v4
    v_cos_f32 v9, v9
    v_cos_f32 v8, v8
    v_accvgpr_write_b32 a196, v10
    v_cvt_pk_bf16_f32 v10, v8, v9
    v_fmamk_f32 v6, v5, 0x43140000, v4
    v_fmamk_f32 v7, v5, 0x43150000, v4
    v_cos_f32 v7, v7
    v_cos_f32 v6, v6
    v_accvgpr_write_b32 a197, v10
    v_cvt_pk_bf16_f32 v10, v6, v7
    v_fmamk_f32 v8, v5, 0x43160000, v4
    v_fmamk_f32 v9, v5, 0x43170000, v4
    v_cos_f32 v9, v9
    v_cos_f32 v8, v8
    v_accvgpr_write_b32 a198, v10
    v_cvt_pk_bf16_f32 v10, v8, v9
    v_accvgpr_write_b32 a199, v10
    s_lshl_b32 s34, s67, 6
    s_add_u32 s34, s34, 32
    s_lshr_b32 s34, s34, 1
    s_add_u32 s34, s34, 1
    v_bfe_u32 v5, v1, 1, 4
    v_add_u32 v5, s34, v5
    s_mul_i32 s36, s29, 160
    v_bfe_u32 v4, v1, 5, 1
    v_mul_u32_u24 v4, 8, v4
    v_add_u32 v4, s36, v4
    v_mul_u32_u24 v4, v4, v5
    v_and_b32 v6, 1, v1
    v_mul_u32_u24 v6, 160, v6
    v_add_u32 v4, v4, v6
    v_cvt_f32_u32 v4, v4
    v_cvt_f32_u32 v5, v5
    v_mul_f32 v4, s35, v4
    v_mul_f32 v5, s35, v5
    v_fract_f32 v4, v4
    v_fmamk_f32 v6, v5, 0x0, v4
    v_fmamk_f32 v7, v5, 0x3f800000, v4
    v_cos_f32 v7, v7
    v_cos_f32 v6, v6
    s_nop 0
    v_cvt_pk_bf16_f32 v10, v6, v7
    v_fmamk_f32 v8, v5, 0x40000000, v4
    v_fmamk_f32 v9, v5, 0x40400000, v4
    v_cos_f32 v9, v9
    v_cos_f32 v8, v8
    v_accvgpr_write_b32 a200, v10
    v_cvt_pk_bf16_f32 v10, v8, v9
    v_fmamk_f32 v6, v5, 0x40800000, v4
    v_fmamk_f32 v7, v5, 0x40a00000, v4
    v_cos_f32 v7, v7
    v_cos_f32 v6, v6
    v_accvgpr_write_b32 a201, v10
    v_cvt_pk_bf16_f32 v10, v6, v7
    v_fmamk_f32 v8, v5, 0x40c00000, v4
    v_fmamk_f32 v9, v5, 0x40e00000, v4
    v_cos_f32 v9, v9
    v_cos_f32 v8, v8
    v_accvgpr_write_b32 a202, v10
    v_cvt_pk_bf16_f32 v10, v8, v9
    v_fmamk_f32 v6, v5, 0x41800000, v4
    v_fmamk_f32 v7, v5, 0x41880000, v4
    v_cos_f32 v7, v7
    v_cos_f32 v6, v6
    v_accvgpr_write_b32 a203, v10
    v_cvt_pk_bf16_f32 v10, v6, v7
    v_fmamk_f32 v8, v5, 0x41900000, v4
    v_fmamk_f32 v9, v5, 0x41980000, v4
    v_cos_f32 v9, v9
    v_cos_f32 v8, v8
    v_accvgpr_write_b32 a204, v10
    v_cvt_pk_bf16_f32 v10, v8, v9
    v_fmamk_f32 v6, v5, 0x41a00000, v4
    v_fmamk_f32 v7, v5, 0x41a80000, v4
    v_cos_f32 v7, v7
    v_cos_f32 v6, v6
    v_accvgpr_write_b32 a205, v10
    v_cvt_pk_bf16_f32 v10, v6, v7
    v_fmamk_f32 v8, v5, 0x41b00000, v4
    v_fmamk_f32 v9, v5, 0x41b80000, v4
    v_cos_f32 v9, v9
    v_cos_f32 v8, v8
    v_accvgpr_write_b32 a206, v10
    v_cvt_pk_bf16_f32 v10, v8, v9
    v_fmamk_f32 v6, v5, 0x42000000, v4
    v_fmamk_f32 v7, v5, 0x42040000, v4
    v_cos_f32 v7, v7
    v_cos_f32 v6, v6
    v_accvgpr_write_b32 a207, v10
    v_cvt_pk_bf16_f32 v10, v6, v7
    v_fmamk_f32 v8, v5, 0x42080000, v4
    v_fmamk_f32 v9, v5, 0x420c0000, v4
    v_cos_f32 v9, v9
    v_cos_f32 v8, v8
    v_accvgpr_write_b32 a208, v10
    v_cvt_pk_bf16_f32 v10, v8, v9
    v_fmamk_f32 v6, v5, 0x42100000, v4
    v_fmamk_f32 v7, v5, 0x42140000, v4
    v_cos_f32 v7, v7
    v_cos_f32 v6, v6
    v_accvgpr_write_b32 a209, v10
    v_cvt_pk_bf16_f32 v10, v6, v7
    v_fmamk_f32 v8, v5, 0x42180000, v4
    v_fmamk_f32 v9, v5, 0x421c0000, v4
    v_cos_f32 v9, v9
    v_cos_f32 v8, v8
    v_accvgpr_write_b32 a210, v10
    v_cvt_pk_bf16_f32 v10, v8, v9
    v_fmamk_f32 v6, v5, 0x42400000, v4
    v_fmamk_f32 v7, v5, 0x42440000, v4
    v_cos_f32 v7, v7
    v_cos_f32 v6, v6
    v_accvgpr_write_b32 a211, v10
    v_cvt_pk_bf16_f32 v10, v6, v7
    v_fmamk_f32 v8, v5, 0x42480000, v4
    v_fmamk_f32 v9, v5, 0x424c0000, v4
    v_cos_f32 v9, v9
    v_cos_f32 v8, v8
    v_accvgpr_write_b32 a212, v10
    v_cvt_pk_bf16_f32 v10, v8, v9
    v_fmamk_f32 v6, v5, 0x42500000, v4
    v_fmamk_f32 v7, v5, 0x42540000, v4
    v_cos_f32 v7, v7
    v_cos_f32 v6, v6
    v_accvgpr_write_b32 a213, v10
    v_cvt_pk_bf16_f32 v10, v6, v7
    v_fmamk_f32 v8, v5, 0x42580000, v4
    v_fmamk_f32 v9, v5, 0x425c0000, v4
    v_cos_f32 v9, v9
    v_cos_f32 v8, v8
    v_accvgpr_write_b32 a214, v10
    v_cvt_pk_bf16_f32 v10, v8, v9
    v_fmamk_f32 v6, v5, 0x42800000, v4
    v_fmamk_f32 v7, v5, 0x42820000, v4
    v_cos_f32 v7, v7
    v_cos_f32 v6, v6
    v_accvgpr_write_b32 a215, v10
    v_cvt_pk_bf16_f32 v10, v6, v7
    v_fmamk_f32 v8, v5, 0x42840000, v4
    v_fmamk_f32 v9, v5, 0x42860000, v4
    v_cos_f32 v9, v9
    v_cos_f32 v8, v8
    v_accvgpr_write_b32 a216, v10
    v_cvt_pk_bf16_f32 v10, v8, v9
    v_fmamk_f32 v6, v5, 0x42880000, v4
    v_fmamk_f32 v7, v5, 0x428a0000, v4
    v_cos_f32 v7, v7
    v_cos_f32 v6, v6
    v_accvgpr_write_b32 a217, v10
    v_cvt_pk_bf16_f32 v10, v6, v7
    v_fmamk_f32 v8, v5, 0x428c0000, v4
    v_fmamk_f32 v9, v5, 0x428e0000, v4
    v_cos_f32 v9, v9
    v_cos_f32 v8, v8
    v_accvgpr_write_b32 a218, v10
    v_cvt_pk_bf16_f32 v10, v8, v9
    v_fmamk_f32 v6, v5, 0x42a00000, v4
    v_fmamk_f32 v7, v5, 0x42a20000, v4
    v_cos_f32 v7, v7
    v_cos_f32 v6, v6
    v_accvgpr_write_b32 a219, v10
    v_cvt_pk_bf16_f32 v10, v6, v7
    v_fmamk_f32 v8, v5, 0x42a40000, v4
    v_fmamk_f32 v9, v5, 0x42a60000, v4
    v_cos_f32 v9, v9
    v_cos_f32 v8, v8
    v_accvgpr_write_b32 a220, v10
    v_cvt_pk_bf16_f32 v10, v8, v9
    v_fmamk_f32 v6, v5, 0x42a80000, v4
    v_fmamk_f32 v7, v5, 0x42aa0000, v4
    v_cos_f32 v7, v7
    v_cos_f32 v6, v6
    v_accvgpr_write_b32 a221, v10
    v_cvt_pk_bf16_f32 v10, v6, v7
    v_fmamk_f32 v8, v5, 0x42ac0000, v4
    v_fmamk_f32 v9, v5, 0x42ae0000, v4
    v_cos_f32 v9, v9
    v_cos_f32 v8, v8
    v_accvgpr_write_b32 a222, v10
    v_cvt_pk_bf16_f32 v10, v8, v9
    v_fmamk_f32 v6, v5, 0x42c00000, v4
    v_fmamk_f32 v7, v5, 0x42c20000, v4
    v_cos_f32 v7, v7
    v_cos_f32 v6, v6
    v_accvgpr_write_b32 a223, v10
    v_cvt_pk_bf16_f32 v10, v6, v7
    v_fmamk_f32 v8, v5, 0x42c40000, v4
    v_fmamk_f32 v9, v5, 0x42c60000, v4
    v_cos_f32 v9, v9
    v_cos_f32 v8, v8
    v_accvgpr_write_b32 a224, v10
    v_cvt_pk_bf16_f32 v10, v8, v9
    v_fmamk_f32 v6, v5, 0x42c80000, v4
    v_fmamk_f32 v7, v5, 0x42ca0000, v4
    v_cos_f32 v7, v7
    v_cos_f32 v6, v6
    v_accvgpr_write_b32 a225, v10
    v_cvt_pk_bf16_f32 v10, v6, v7
    v_fmamk_f32 v8, v5, 0x42cc0000, v4
    v_fmamk_f32 v9, v5, 0x42ce0000, v4
    v_cos_f32 v9, v9
    v_cos_f32 v8, v8
    v_accvgpr_write_b32 a226, v10
    v_cvt_pk_bf16_f32 v10, v8, v9
    v_fmamk_f32 v6, v5, 0x42e00000, v4
    v_fmamk_f32 v7, v5, 0x42e20000, v4
    v_cos_f32 v7, v7
    v_cos_f32 v6, v6
    v_accvgpr_write_b32 a227, v10
    v_cvt_pk_bf16_f32 v10, v6, v7
    v_fmamk_f32 v8, v5, 0x42e40000, v4
    v_fmamk_f32 v9, v5, 0x42e60000, v4
    v_cos_f32 v9, v9
    v_cos_f32 v8, v8
    v_accvgpr_write_b32 a228, v10
    v_cvt_pk_bf16_f32 v10, v8, v9
    v_fmamk_f32 v6, v5, 0x42e80000, v4
    v_fmamk_f32 v7, v5, 0x42ea0000, v4
    v_cos_f32 v7, v7
    v_cos_f32 v6, v6
    v_accvgpr_write_b32 a229, v10
    v_cvt_pk_bf16_f32 v10, v6, v7
    v_fmamk_f32 v8, v5, 0x42ec0000, v4
    v_fmamk_f32 v9, v5, 0x42ee0000, v4
    v_cos_f32 v9, v9
    v_cos_f32 v8, v8
    v_accvgpr_write_b32 a230, v10
    v_cvt_pk_bf16_f32 v10, v8, v9
    v_fmamk_f32 v6, v5, 0x43000000, v4
    v_fmamk_f32 v7, v5, 0x43010000, v4
    v_cos_f32 v7, v7
    v_cos_f32 v6, v6
    v_accvgpr_write_b32 a231, v10
    v_cvt_pk_bf16_f32 v10, v6, v7
    v_fmamk_f32 v8, v5, 0x43020000, v4
    v_fmamk_f32 v9, v5, 0x43030000, v4
    v_cos_f32 v9, v9
    v_cos_f32 v8, v8
    v_accvgpr_write_b32 a232, v10
    v_cvt_pk_bf16_f32 v10, v8, v9
    v_fmamk_f32 v6, v5, 0x43040000, v4
    v_fmamk_f32 v7, v5, 0x43050000, v4
    v_cos_f32 v7, v7
    v_cos_f32 v6, v6
    v_accvgpr_write_b32 a233, v10
    v_cvt_pk_bf16_f32 v10, v6, v7
    v_fmamk_f32 v8, v5, 0x43060000, v4
    v_fmamk_f32 v9, v5, 0x43070000, v4
    v_cos_f32 v9, v9
    v_cos_f32 v8, v8
    v_accvgpr_write_b32 a234, v10
    v_cvt_pk_bf16_f32 v10, v8, v9
    v_fmamk_f32 v6, v5, 0x43100000, v4
    v_fmamk_f32 v7, v5, 0x43110000, v4
    v_cos_f32 v7, v7
    v_cos_f32 v6, v6
    v_accvgpr_write_b32 a235, v10
    v_cvt_pk_bf16_f32 v10, v6, v7
    v_fmamk_f32 v8, v5, 0x43120000, v4
    v_fmamk_f32 v9, v5, 0x43130000, v4
    v_cos_f32 v9, v9
    v_cos_f32 v8, v8
    v_accvgpr_write_b32 a236, v10
    v_cvt_pk_bf16_f32 v10, v8, v9
    v_fmamk_f32 v6, v5, 0x43140000, v4
    v_fmamk_f32 v7, v5, 0x43150000, v4
    v_cos_f32 v7, v7
    v_cos_f32 v6, v6
    v_accvgpr_write_b32 a237, v10
    v_cvt_pk_bf16_f32 v10, v6, v7
    v_fmamk_f32 v8, v5, 0x43160000, v4
    v_fmamk_f32 v9, v5, 0x43170000, v4
    v_cos_f32 v9, v9
    v_cos_f32 v8, v8
    v_accvgpr_write_b32 a238, v10
    v_cvt_pk_bf16_f32 v10, v8, v9
    v_accvgpr_write_b32 a239, v10
    s_waitcnt vmcnt(20)
    s_cmp_ge_u32 s28, 160
    s_cbranch_scc1 R_111
    v_lshl_or_b32 v200, v216, 16, v200
    v_lshl_or_b32 v201, v217, 16, v201
    v_lshl_or_b32 v202, v218, 16, v202
    v_lshl_or_b32 v203, v219, 16, v203
    v_lshl_or_b32 v204, v220, 16, v204
    v_lshl_or_b32 v205, v221, 16, v205
    v_lshl_or_b32 v206, v222, 16, v206
    v_lshl_or_b32 v207, v223, 16, v207
    v_lshl_or_b32 v208, v224, 16, v208
    v_lshl_or_b32 v209, v225, 16, v209
    v_lshl_or_b32 v210, v226, 16, v210
    v_lshl_or_b32 v211, v227, 16, v211
    v_lshl_or_b32 v212, v228, 16, v212
    v_lshl_or_b32 v213, v229, 16, v213
    v_lshl_or_b32 v214, v230, 16, v214
    v_lshl_or_b32 v215, v231, 16, v215
    s_add_u32 s33, s62, 0
    buffer_store_dwordx4 v[200:203], v0, s[4:7], s33 offen sc1
    s_add_u32 s33, s62, 5120
    buffer_store_dwordx4 v[204:207], v0, s[4:7], s33 offen sc1
    s_add_u32 s33, s62, 10240
    buffer_store_dwordx4 v[208:211], v0, s[4:7], s33 offen sc1
    s_add_u32 s33, s62, 15360
    buffer_store_dwordx4 v[212:215], v0, s[4:7], s33 offen sc1
R_111:
    v_mov_b32 v5, 0
    s_mov_b32 s48, 0
P_112:
    buffer_load_dword v4, v5, s[24:27], 0 offen sc1
    s_waitcnt vmcnt(0)
    v_cmp_gt_u32 vcc, 1, v4
    s_cbranch_vccz P_113
    s_add_u32 s48, s48, 1
    s_cmp_gt_u32 s48, 200000
    s_cbranch_scc1 L_end
    s_sleep 1
    s_branch P_112
P_113:
    s_cmp_ge_u32 s28, 160
    s_cbranch_scc1 R_114
    s_waitcnt vmcnt(0)
    s_barrier
    s_cmp_lg_u32 s29, 0
    s_cbranch_scc1 F_115
    s_lshl_b32 s32, s28, 2
    s_add_u32 s32, s32, s29
    s_lshl_b32 s32, s32, 2
    s_add_u32 s32, s32, 0
    v_mov_b32 v4, 1
    s_mov_b64 exec, 1
    buffer_store_dword v4, off, s[4:7], s32 sc1
    s_mov_b64 exec, -1
F_115:
R_114:
    s_cmp_eq_u32 s64, 1
    s_cbranch_scc1 Q_116
    v_bfe_u32 v2, v1, 5, 1
    v_mul_u32_u24 v2, 1024, v2
    v_bfe_u32 v3, v1, 2, 2
    v_lshl_add_u32 v2, v3, 7, v2
    v_bfe_u32 v3, v1, 4, 1
    v_lshl_add_u32 v2, v3, 4, v2
    v_bfe_u32 v3, v1, 1, 1
    v_lshl_add_u32 v2, v3, 3, v2
    v_bfe_u32 v3, v1, 0, 1
    v_lshl_add_u32 v2, v3, 5, v2
    v_add_u32 v2, s60, v2
    s_branch Q_117
Q_116:
    v_bfe_u32 v2, v1, 5, 1
    v_mul_u32_u24 v2, 1024, v2
    v_bfe_u32 v3, v1, 2, 2
    v_lshl_add_u32 v2, v3, 7, v2
    v_bfe_u32 v3, v1, 4, 1
    v_lshl_add_u32 v2, v3, 5, v2
    v_bfe_u32 v3, v1, 0, 2
    v_lshl_add_u32 v2, v3, 3, v2
    v_add_u32 v2, s60, v2
Q_117:
    ds_read_b64_tr_b16 a[0:1], v2 offset:0
    ds_read_b64_tr_b16 a[2:3], v2 offset:512
    ds_read_b64_tr_b16 a[4:5], v2 offset:2048
    ds_read_b64_tr_b16 a[6:7], v2 offset:2560
    ds_read_b64_tr_b16 a[8:9], v2 offset:4096
    ds_read_b64_tr_b16 a[10:11], v2 offset:4608
    ds_read_b64_tr_b16 a[12:13], v2 offset:6144
    ds_read_b64_tr_b16 a[14:15], v2 offset:6656
    ds_read_b64_tr_b16 a[16:17], v2 offset:8192
    ds_read_b64_tr_b16 a[18:19], v2 offset:8704
    ds_read_b64_tr_b16 a[20:21], v2 offset:10240
    ds_read_b64_tr_b16 a[22:23], v2 offset:10752
    ds_read_b64_tr_b16 a[24:25], v2 offset:12288
    ds_read_b64_tr_b16 a[26:27], v2 offset:12800
    ds_read_b64_tr_b16 a[28:29], v2 offset:14336
    ds_read_b64_tr_b16 a[30:31], v2 offset:14848
    ds_read_b64_tr_b16 a[32:33], v2 offset:16384
    ds_read_b64_tr_b16 a[34:35], v2 offset:16896
    ds_read_b64_tr_b16 a[36:37], v2 offset:18432
    ds_read_b64_tr_b16 a[38:39], v2 offset:18944
    ds_read_b64_tr_b16 a[40:41], v2 offset:64
    ds_read_b64_tr_b16 a[42:43], v2 offset:576
    ds_read_b64_tr_b16 a[44:45], v2 offset:2112
    ds_read_b64_tr_b16 a[46:47], v2 offset:2624
    ds_read_b64_tr_b16 a[48:49], v2 offset:4160
    ds_read_b64_tr_b16 a[50:51], v2 offset:4672
    ds_read_b64_tr_b16 a[52:53], v2 offset:6208
    ds_read_b64_tr_b16 a[54:55], v2 offset:6720
    ds_read_b64_tr_b16 a[56:57], v2 offset:8256
    ds_read_b64_tr_b16 a[58:59], v2 offset:8768
    ds_read_b64_tr_b16 a[60:61], v2 offset:10304
    ds_read_b64_tr_b16 a[62:63], v2 offset:10816
    ds_read_b64_tr_b16 a[64:65], v2 offset:12352
    ds_read_b64_tr_b16 a[66:67], v2 offset:12864
    ds_read_b64_tr_b16 a[68:69], v2 offset:14400
    ds_read_b64_tr_b16 a[70:71], v2 offset:14912
    ds_read_b64_tr_b16 a[72:73], v2 offset:16448
    ds_read_b64_tr_b16 a[74:75], v2 offset:16960
    ds_read_b64_tr_b16 a[76:77], v2 offset:18496
    ds_read_b64_tr_b16 a[78:79], v2 offset:19008
    s_waitcnt lgkmcnt(0)
    s_cmp_ge_u32 s28, 190
    s_cbranch_scc1 R_118
    s_mul_i32 s34, s29, 320
    v_bfe_u32 v2, v1, 0, 2
    v_mul_u32_u24 v2, 1280, v2
    v_bfe_u32 v172, v1, 2, 1
    v_mul_u32_u24 v172, 10240, v172
    v_add_u32 v2, v2, v172
    v_bfe_u32 v172, v1, 3, 1
    v_mul_u32_u24 v172, 5120, v172
    v_add_u32 v2, v2, v172
    v_bfe_u32 v172, v1, 4, 1
    v_mul_u32_u24 v172, 20480, v172
    v_add_u32 v2, v2, v172
    v_bfe_u32 v172, v1, 5, 1
    v_lshl_add_u32 v2, v172, 4, v2
    v_add_u32 v2, s34, v2
    s_lshl_b32 s34, s29, 13
    v_add_u32 v4, s34, v0
    s_lshl_b32 s34, s29, 3
    s_add_u32 s34, s34, 65536
    v_bfe_u32 v5, v1, 0, 5
    v_mul_u32_u24 v5, 32, v5
    v_add_u32 v5, s34, v5
    s_lshl_b32 s35, s29, 11
    s_lshl_b32 s36, s29, 8
    s_add_u32 s36, s36, 67584
    s_lshr_b32 s34, s29, 1
    s_lshl_b32 s34, s34, 12
    s_and_b32 s37, s29, 1
    s_lshl_b32 s37, s37, 8
    s_add_u32 s34, s34, s37
    v_bfe_u32 v3, v1, 1, 1
    v_mul_u32_u24 v3, 2048, v3
    v_bfe_u32 v172, v1, 0, 1
    v_lshl_add_u32 v3, v172, 9, v3
    v_bfe_u32 v172, v1, 2, 4
    v_lshl_add_u32 v3, v172, 4, v3
    v_add_u32 v3, s34, v3
    v_bfe_u32 v10, v1, 0, 2
    v_mul_u32_u24 v10, 32, v10
    v_add_u32 v10, s36, v10
    s_lshl_b32 s34, s29, 10
    v_add_u32 v7, s34, v0
    v_bfe_u32 v6, v1, 0, 5
    v_mul_u32_u24 v6, 32, v6
    v_add_u32 v6, 65536, v6
    v_bfe_u32 v9, v1, 0, 2
    v_mul_u32_u24 v9, 4, v9
    v_bfe_u32 v172, v1, 2, 1
    v_lshl_add_u32 v9, v172, 5, v9
    v_bfe_u32 v172, v1, 3, 1
    v_lshl_add_u32 v9, v172, 4, v9
    v_bfe_u32 v172, v1, 4, 1
    v_lshl_add_u32 v9, v172, 6, v9
    v_add_u32 v9, s36, v9
    s_mov_b32 s34, 0x3f803f80
    v_mov_b32 v56, s34
    v_mov_b32 v57, s34
    v_mov_b32 v58, s34
    v_mov_b32 v59, s34
    s_nop 1
    v_mfma_f32_32x32x16_bf16 v[96:111], v[56:59], a[160:163], 0
    v_mfma_f32_32x32x16_bf16 v[112:127], v[56:59], a[200:203], 0
    v_mfma_f32_32x32x16_bf16 v[96:111], v[56:59], a[164:167], v[96:111]
    v_mfma_f32_32x32x16_bf16 v[112:127], v[56:59], a[204:207], v[112:127]
    v_mfma_f32_32x32x16_bf16 v[96:111], v[56:59], a[168:171], v[96:111]
    v_mfma_f32_32x32x16_bf16 v[112:127], v[56:59], a[208:211], v[112:127]
    v_mfma_f32_32x32x16_bf16 v[96:111], v[56:59], a[172:175], v[96:111]
    v_mfma_f32_32x32x16_bf16 v[112:127], v[56:59], a[212:215], v[112:127]
    v_mfma_f32_32x32x16_bf16 v[96:111], v[56:59], a[176:179], v[96:111]
    v_mfma_f32_32x32x16_bf16 v[112:127], v[56:59], a[216:219], v[112:127]
    v_mfma_f32_32x32x16_bf16 v[96:111], v[56:59], a[180:183], v[96:111]
    v_mfma_f32_32x32x16_bf16 v[112:127], v[56:59], a[220:223], v[112:127]
    v_mfma_f32_32x32x16_bf16 v[96:111], v[56:59], a[184:187], v[96:111]
    v_mfma_f32_32x32x16_bf16 v[112:127], v[56:59], a[224:227], v[112:127]
    v_mfma_f32_32x32x16_bf16 v[96:111], v[56:59], a[188:191], v[96:111]
    v_mfma_f32_32x32x16_bf16 v[112:127], v[56:59], a[228:231], v[112:127]
    v_mfma_f32_32x32x16_bf16 v[96:111], v[56:59], a[192:195], v[96:111]
    v_mfma_f32_32x32x16_bf16 v[112:127], v[56:59], a[232:235], v[112:127]
    v_mfma_f32_32x32x16_bf16 v[96:111], v[56:59], a[196:199], v[96:111]
    v_mfma_f32_32x32x16_bf16 v[112:127], v[56:59], a[236:239], v[112:127]
    s_nop 3
    ds_write_b128 v4, v[96:99] offset:32768
    ds_write_b128 v4, v[100:103] offset:33792
    ds_write_b128 v4, v[104:107] offset:34816
    ds_write_b128 v4, v[108:111] offset:35840
    s_nop 3
    ds_write_b128 v4, v[112:115] offset:36864
    ds_write_b128 v4, v[116:119] offset:37888
    ds_write_b128 v4, v[120:123] offset:38912
    ds_write_b128 v4, v[124:127] offset:39936
    s_waitcnt lgkmcnt(0)
    s_barrier
    ds_read_b128 v[96:99], v3 offset:32768
    ds_read_b128 v[100:103], v3 offset:33792
    ds_read_b128 v[104:107], v3 offset:40960
    ds_read_b128 v[108:111], v3 offset:41984
    ds_read_b128 v[112:115], v3 offset:49152
    ds_read_b128 v[116:119], v3 offset:50176
    ds_read_b128 v[120:123], v3 offset:57344
    ds_read_b128 v[124:127], v3 offset:58368
    s_waitcnt lgkmcnt(5)
    v_pk_add_f32 v[96:97], v[96:97], v[104:105]
    v_pk_add_f32 v[98:99], v[98:99], v[106:107]
    s_waitcnt lgkmcnt(4)
    v_pk_add_f32 v[100:101], v[100:101], v[108:109]
    v_pk_add_f32 v[102:103], v[102:103], v[110:111]
    s_waitcnt lgkmcnt(3)
    v_pk_add_f32 v[96:97], v[96:97], v[112:113]
    v_pk_add_f32 v[98:99], v[98:99], v[114:115]
    s_waitcnt lgkmcnt(2)
    v_pk_add_f32 v[100:101], v[100:101], v[116:117]
    v_pk_add_f32 v[102:103], v[102:103], v[118:119]
    s_waitcnt lgkmcnt(1)
    v_pk_add_f32 v[96:97], v[96:97], v[120:121]
    v_pk_add_f32 v[98:99], v[98:99], v[122:123]
    s_waitcnt lgkmcnt(0)
    v_pk_add_f32 v[100:101], v[100:101], v[124:125]
    v_pk_add_f32 v[102:103], v[102:103], v[126:127]
    v_mov_b64 v[154:155], v[96:97]
    v_mov_b64 v[156:157], v[98:99]
    v_mov_b64 v[158:159], v[100:101]
    v_mov_b64 v[160:161], v[102:103]
    s_barrier
    s_mov_b32 s44, s66
    s_mov_b32 s47, 19
    s_mov_b32 s50, 0
    s_mov_b32 s52, 0
    s_lshl_b32 s51, s67, 12
    s_add_u32 s51, s51, 20971520
    s_mov_b32 s58, 40960
    s_mul_i32 s54, s44, 40960
    s_add_u32 s56, s54, s52
    s_add_u32 s54, s54, s50
    s_waitcnt vmcnt(0) lgkmcnt(0)
    buffer_load_dwordx4 v[16:19], v2, s[8:11], s54 offen offset:0
    buffer_load_dwordx4 v[20:23], v2, s[8:11], s54 offen offset:32
    buffer_load_dwordx4 v[24:27], v2, s[8:11], s54 offen offset:64
    buffer_load_dwordx4 v[28:31], v2, s[8:11], s54 offen offset:96
    buffer_load_dwordx4 v[32:35], v2, s[8:11], s54 offen offset:128
    buffer_load_dwordx4 v[36:39], v2, s[8:11], s54 offen offset:160
    buffer_load_dwordx4 v[40:43], v2, s[8:11], s54 offen offset:192
    buffer_load_dwordx4 v[44:47], v2, s[8:11], s54 offen offset:224
    buffer_load_dwordx4 v[48:51], v2, s[8:11], s54 offen offset:256
    buffer_load_dwordx4 v[52:55], v2, s[8:11], s54 offen offset:288
    buffer_load_dword v179, off, s[8:11], 0
G_119:
    s_add_u32 s45, s44, s47
    s_cmp_lt_u32 s45, 64
    s_cbranch_scc0 G_121
    s_mul_i32 s54, s45, 40960
    s_add_u32 s56, s54, s52
    s_add_u32 s54, s54, s50
    s_waitcnt vmcnt(10)
    v_mfma_f32_32x32x16_bf16 v[96:111], v[16:19], a[160:163], 0
    v_mfma_f32_32x32x16_bf16 v[112:127], v[16:19], a[200:203], 0
    buffer_load_dwordx4 v[56:59], v2, s[8:11], s54 offen offset:0
    s_waitcnt vmcnt(10)
    v_mfma_f32_32x32x16_bf16 v[96:111], v[20:23], a[164:167], v[96:111]
    v_mfma_f32_32x32x16_bf16 v[112:127], v[20:23], a[204:207], v[112:127]
    buffer_load_dwordx4 v[60:63], v2, s[8:11], s54 offen offset:32
    s_waitcnt vmcnt(10)
    v_mfma_f32_32x32x16_bf16 v[96:111], v[24:27], a[168:171], v[96:111]
    v_mfma_f32_32x32x16_bf16 v[112:127], v[24:27], a[208:211], v[112:127]
    buffer_load_dwordx4 v[64:67], v2, s[8:11], s54 offen offset:64
    s_waitcnt vmcnt(10)
    v_mfma_f32_32x32x16_bf16 v[96:111], v[28:31], a[172:175], v[96:111]
    v_mfma_f32_32x32x16_bf16 v[112:127], v[28:31], a[212:215], v[112:127]
    buffer_load_dwordx4 v[68:71], v2, s[8:11], s54 offen offset:96
    s_waitcnt vmcnt(10)
    v_mfma_f32_32x32x16_bf16 v[96:111], v[32:35], a[176:179], v[96:111]
    v_mfma_f32_32x32x16_bf16 v[112:127], v[32:35], a[216:219], v[112:127]
    buffer_load_dwordx4 v[72:75], v2, s[8:11], s54 offen offset:128
    s_waitcnt vmcnt(10)
    v_mfma_f32_32x32x16_bf16 v[96:111], v[36:39], a[180:183], v[96:111]
    v_mfma_f32_32x32x16_bf16 v[112:127], v[36:39], a[220:223], v[112:127]
    buffer_load_dwordx4 v[76:79], v2, s[8:11], s54 offen offset:160
    s_waitcnt vmcnt(10)
    v_mfma_f32_32x32x16_bf16 v[96:111], v[40:43], a[184:187], v[96:111]
    v_mfma_f32_32x32x16_bf16 v[112:127], v[40:43], a[224:227], v[112:127]
    buffer_load_dwordx4 v[80:83], v2, s[8:11], s54 offen offset:192
    s_waitcnt vmcnt(10)
    v_mfma_f32_32x32x16_bf16 v[96:111], v[44:47], a[188:191], v[96:111]
    v_mfma_f32_32x32x16_bf16 v[112:127], v[44:47], a[228:231], v[112:127]
    buffer_load_dwordx4 v[84:87], v2, s[8:11], s54 offen offset:224
    s_waitcnt vmcnt(10)
    v_mfma_f32_32x32x16_bf16 v[96:111], v[48:51], a[192:195], v[96:111]
    v_mfma_f32_32x32x16_bf16 v[112:127], v[48:51], a[232:235], v[112:127]
    buffer_load_dwordx4 v[88:91], v2, s[8:11], s54 offen offset:256
    s_waitcnt vmcnt(10)
    v_mfma_f32_32x32x16_bf16 v[96:111], v[52:55], a[196:199], v[96:111]
    v_mfma_f32_32x32x16_bf16 v[112:127], v[52:55], a[236:239], v[112:127]
    buffer_load_dwordx4 v[92:95], v2, s[8:11], s54 offen offset:288
    s_mul_i32 s55, s44, s58
    s_add_u32 s55, s55, s51
    s_nop 0
    ds_write_b128 v4, v[96:99] offset:0
    v_mov_b64 v[128:129], 0
    s_mov_b32 s34, 0x3f803f80
    v_dot2c_f32_bf16 v128, s34, v16
    v_dot2c_f32_bf16 v129, v16, v16
    v_dot2c_f32_bf16 v128, s34, v17
    v_dot2c_f32_bf16 v129, v17, v17
    v_dot2c_f32_bf16 v128, s34, v18
    v_dot2c_f32_bf16 v129, v18, v18
    v_dot2c_f32_bf16 v128, s34, v19
    v_dot2c_f32_bf16 v129, v19, v19
    v_dot2c_f32_bf16 v128, s34, v20
    v_dot2c_f32_bf16 v129, v20, v20
    ds_write_b128 v4, v[100:103] offset:1024
    v_dot2c_f32_bf16 v128, s34, v21
    v_dot2c_f32_bf16 v129, v21, v21
    v_dot2c_f32_bf16 v128, s34, v22
    v_dot2c_f32_bf16 v129, v22, v22
    v_dot2c_f32_bf16 v128, s34, v23
    v_dot2c_f32_bf16 v129, v23, v23
    v_dot2c_f32_bf16 v128, s34, v24
    v_dot2c_f32_bf16 v129, v24, v24
    v_dot2c_f32_bf16 v128, s34, v25
    v_dot2c_f32_bf16 v129, v25, v25
    ds_write_b128 v4, v[104:107] offset:2048
    v_dot2c_f32_bf16 v128, s34, v26
    v_dot2c_f32_bf16 v129, v26, v26
    v_dot2c_f32_bf16 v128, s34, v27
    v_dot2c_f32_bf16 v129, v27, v27
    v_dot2c_f32_bf16 v128, s34, v28
    v_dot2c_f32_bf16 v129, v28, v28
    v_dot2c_f32_bf16 v128, s34, v29
    v_dot2c_f32_bf16 v129, v29, v29
    v_dot2c_f32_bf16 v128, s34, v30
    v_dot2c_f32_bf16 v129, v30, v30
    ds_write_b128 v4, v[108:111] offset:3072
    v_dot2c_f32_bf16 v128, s34, v31
    v_dot2c_f32_bf16 v129, v31, v31
    v_dot2c_f32_bf16 v128, s34, v32
    v_dot2c_f32_bf16 v129, v32, v32
    v_dot2c_f32_bf16 v128, s34, v33
    v_dot2c_f32_bf16 v129, v33, v33
    v_dot2c_f32_bf16 v128, s34, v34
    v_dot2c_f32_bf16 v129, v34, v34
    v_dot2c_f32_bf16 v128, s34, v35
    v_dot2c_f32_bf16 v129, v35, v35
    ds_write_b128 v4, v[112:115] offset:4096
    v_dot2c_f32_bf16 v128, s34, v36
    v_dot2c_f32_bf16 v129, v36, v36
    v_dot2c_f32_bf16 v128, s34, v37
    v_dot2c_f32_bf16 v129, v37, v37
    v_dot2c_f32_bf16 v128, s34, v38
    v_dot2c_f32_bf16 v129, v38, v38
    v_dot2c_f32_bf16 v128, s34, v39
    v_dot2c_f32_bf16 v129, v39, v39
    v_dot2c_f32_bf16 v128, s34, v40
    v_dot2c_f32_bf16 v129, v40, v40
    ds_write_b128 v4, v[116:119] offset:5120
    v_dot2c_f32_bf16 v128, s34, v41
    v_dot2c_f32_bf16 v129, v41, v41
    v_dot2c_f32_bf16 v128, s34, v42
    v_dot2c_f32_bf16 v129, v42, v42
    v_dot2c_f32_bf16 v128, s34, v43
    v_dot2c_f32_bf16 v129, v43, v43
    v_dot2c_f32_bf16 v128, s34, v44
    v_dot2c_f32_bf16 v129, v44, v44
    v_dot2c_f32_bf16 v128, s34, v45
    v_dot2c_f32_bf16 v129, v45, v45
    ds_write_b128 v4, v[120:123] offset:6144
    v_dot2c_f32_bf16 v128, s34, v46
    v_dot2c_f32_bf16 v129, v46, v46
    v_dot2c_f32_bf16 v128, s34, v47
    v_dot2c_f32_bf16 v129, v47, v47
    v_dot2c_f32_bf16 v128, s34, v48
    v_dot2c_f32_bf16 v129, v48, v48
    v_dot2c_f32_bf16 v128, s34, v49
    v_dot2c_f32_bf16 v129, v49, v49
    v_dot2c_f32_bf16 v128, s34, v50
    v_dot2c_f32_bf16 v129, v50, v50
    ds_write_b128 v4, v[124:127] offset:7168
    v_dot2c_f32_bf16 v128, s34, v51
    v_dot2c_f32_bf16 v129, v51, v51
    v_dot2c_f32_bf16 v128, s34, v52
    v_dot2c_f32_bf16 v129, v52, v52
    v_dot2c_f32_bf16 v128, s34, v53
    v_dot2c_f32_bf16 v129, v53, v53
    v_dot2c_f32_bf16 v128, s34, v54
    v_dot2c_f32_bf16 v129, v54, v54
    v_dot2c_f32_bf16 v128, s34, v55
    v_dot2c_f32_bf16 v129, v55, v55
    s_nop 2
    v_mov_b64 v[172:173], v[128:129]
    s_nop 1
    v_permlane32_swap_b32 v128, v172
    v_permlane32_swap_b32 v129, v173
    v_pk_add_f32 v[128:129], v[128:129], v[172:173]
    ds_write_b64 v5, v[128:129] offset:0
    s_waitcnt vmcnt(10)
    s_waitcnt lgkmcnt(0)
    s_barrier
    ds_read_b128 v[130:133], v6 offset:0
    ds_read_b128 v[134:137], v6 offset:16
    ds_read_b128 v[96:99], v3 offset:0
    ds_read_b128 v[100:103], v3 offset:1024
    ds_read_b128 v[104:107], v3 offset:8192
    ds_read_b128 v[108:111], v3 offset:9216
    ds_read_b128 v[112:115], v3 offset:16384
    ds_read_b128 v[116:119], v3 offset:17408
    ds_read_b128 v[120:123], v3 offset:24576
    ds_read_b128 v[124:127], v3 offset:25600
    s_waitcnt lgkmcnt(9)
    v_pk_add_f32 v[130:131], v[130:131], v[132:133]
    s_waitcnt lgkmcnt(8)
    v_pk_add_f32 v[134:135], v[134:135], v[136:137]
    v_pk_add_f32 v[130:131], v[130:131], v[134:135]
    v_mul_f32 v130, 0x3acccccd, v130
    v_mul_f32 v131, 0x3acccccd, v131
    v_fma_f32 v131, -v130, v130, v131
    v_max_f32 v131, 0, v131
    v_add_f32 v131, 0x3727c5ac, v131
    v_rsq_f32 v131, v131
    s_nop 0
    ds_write2_b32 v9, v130, v131 offset0:0 offset1:32
    ds_read_b128 v[138:141], v10 offset:0
    ds_read_b128 v[142:145], v10 offset:16
    ds_read_b128 v[146:149], v10 offset:128
    ds_read_b128 v[150:153], v10 offset:144
    s_waitcnt lgkmcnt(10)
    v_pk_add_f32 v[96:97], v[96:97], v[104:105]
    v_pk_add_f32 v[98:99], v[98:99], v[106:107]
    s_waitcnt lgkmcnt(9)
    v_pk_add_f32 v[100:101], v[100:101], v[108:109]
    v_pk_add_f32 v[102:103], v[102:103], v[110:111]
    s_waitcnt lgkmcnt(8)
    v_pk_add_f32 v[96:97], v[96:97], v[112:113]
    v_pk_add_f32 v[98:99], v[98:99], v[114:115]
    s_waitcnt lgkmcnt(7)
    v_pk_add_f32 v[100:101], v[100:101], v[116:117]
    v_pk_add_f32 v[102:103], v[102:103], v[118:119]
    s_waitcnt lgkmcnt(6)
    v_pk_add_f32 v[96:97], v[96:97], v[120:121]
    v_pk_add_f32 v[98:99], v[98:99], v[122:123]
    s_waitcnt lgkmcnt(5)
    v_pk_add_f32 v[100:101], v[100:101], v[124:125]
    v_pk_add_f32 v[102:103], v[102:103], v[126:127]
    s_waitcnt lgkmcnt(3)
    v_fma_f32 v96, -v138, v154, v96
    s_waitcnt lgkmcnt(1)
    v_mul_f32 v96, v96, v146
    v_fma_f32 v97, -v139, v155, v97
    v_mul_f32 v97, v97, v147
    v_fma_f32 v98, -v140, v156, v98
    v_mul_f32 v98, v98, v148
    v_fma_f32 v99, -v141, v157, v99
    v_mul_f32 v99, v99, v149
    v_fma_f32 v100, -v142, v158, v100
    s_waitcnt lgkmcnt(0)
    v_mul_f32 v100, v100, v150
    v_fma_f32 v101, -v143, v159, v101
    v_mul_f32 v101, v101, v151
    v_fma_f32 v102, -v144, v160, v102
    v_mul_f32 v102, v102, v152
    v_fma_f32 v103, -v145, v161, v103
    v_mul_f32 v103, v103, v153
    v_cvt_pk_bf16_f32 v172, v96, v97
    v_cvt_pk_bf16_f32 v173, v98, v99
    v_cvt_pk_bf16_f32 v174, v100, v101
    v_cvt_pk_bf16_f32 v175, v102, v103
    buffer_store_dwordx4 v[172:175], v7, s[4:7], s55 offen sc1
    s_mov_b32 s44, s45
    s_add_u32 s45, s44, s47
    s_cmp_lt_u32 s45, 64
    s_cbranch_scc0 G_122
    s_mul_i32 s54, s45, 40960
    s_add_u32 s56, s54, s52
    s_add_u32 s54, s54, s50
    s_waitcnt vmcnt(10)
    v_mfma_f32_32x32x16_bf16 v[96:111], v[56:59], a[160:163], 0
    v_mfma_f32_32x32x16_bf16 v[112:127], v[56:59], a[200:203], 0
    buffer_load_dwordx4 v[16:19], v2, s[8:11], s54 offen offset:0
    s_waitcnt vmcnt(10)
    v_mfma_f32_32x32x16_bf16 v[96:111], v[60:63], a[164:167], v[96:111]
    v_mfma_f32_32x32x16_bf16 v[112:127], v[60:63], a[204:207], v[112:127]
    buffer_load_dwordx4 v[20:23], v2, s[8:11], s54 offen offset:32
    s_waitcnt vmcnt(10)
    v_mfma_f32_32x32x16_bf16 v[96:111], v[64:67], a[168:171], v[96:111]
    v_mfma_f32_32x32x16_bf16 v[112:127], v[64:67], a[208:211], v[112:127]
    buffer_load_dwordx4 v[24:27], v2, s[8:11], s54 offen offset:64
    s_waitcnt vmcnt(10)
    v_mfma_f32_32x32x16_bf16 v[96:111], v[68:71], a[172:175], v[96:111]
    v_mfma_f32_32x32x16_bf16 v[112:127], v[68:71], a[212:215], v[112:127]
    buffer_load_dwordx4 v[28:31], v2, s[8:11], s54 offen offset:96
    s_waitcnt vmcnt(10)
    v_mfma_f32_32x32x16_bf16 v[96:111], v[72:75], a[176:179], v[96:111]
    v_mfma_f32_32x32x16_bf16 v[112:127], v[72:75], a[216:219], v[112:127]
    buffer_load_dwordx4 v[32:35], v2, s[8:11], s54 offen offset:128
    s_waitcnt vmcnt(10)
    v_mfma_f32_32x32x16_bf16 v[96:111], v[76:79], a[180:183], v[96:111]
    v_mfma_f32_32x32x16_bf16 v[112:127], v[76:79], a[220:223], v[112:127]
    buffer_load_dwordx4 v[36:39], v2, s[8:11], s54 offen offset:160
    s_waitcnt vmcnt(10)
    v_mfma_f32_32x32x16_bf16 v[96:111], v[80:83], a[184:187], v[96:111]
    v_mfma_f32_32x32x16_bf16 v[112:127], v[80:83], a[224:227], v[112:127]
    buffer_load_dwordx4 v[40:43], v2, s[8:11], s54 offen offset:192
    s_waitcnt vmcnt(10)
    v_mfma_f32_32x32x16_bf16 v[96:111], v[84:87], a[188:191], v[96:111]
    v_mfma_f32_32x32x16_bf16 v[112:127], v[84:87], a[228:231], v[112:127]
    buffer_load_dwordx4 v[44:47], v2, s[8:11], s54 offen offset:224
    s_waitcnt vmcnt(10)
    v_mfma_f32_32x32x16_bf16 v[96:111], v[88:91], a[192:195], v[96:111]
    v_mfma_f32_32x32x16_bf16 v[112:127], v[88:91], a[232:235], v[112:127]
    buffer_load_dwordx4 v[48:51], v2, s[8:11], s54 offen offset:256
    s_waitcnt vmcnt(10)
    v_mfma_f32_32x32x16_bf16 v[96:111], v[92:95], a[196:199], v[96:111]
    v_mfma_f32_32x32x16_bf16 v[112:127], v[92:95], a[236:239], v[112:127]
    buffer_load_dwordx4 v[52:55], v2, s[8:11], s54 offen offset:288
    s_mul_i32 s55, s44, s58
    s_add_u32 s55, s55, s51
    s_nop 0
    ds_write_b128 v4, v[96:99] offset:32768
    v_mov_b64 v[128:129], 0
    s_mov_b32 s34, 0x3f803f80
    v_dot2c_f32_bf16 v128, s34, v56
    v_dot2c_f32_bf16 v129, v56, v56
    v_dot2c_f32_bf16 v128, s34, v57
    v_dot2c_f32_bf16 v129, v57, v57
    v_dot2c_f32_bf16 v128, s34, v58
    v_dot2c_f32_bf16 v129, v58, v58
    v_dot2c_f32_bf16 v128, s34, v59
    v_dot2c_f32_bf16 v129, v59, v59
    v_dot2c_f32_bf16 v128, s34, v60
    v_dot2c_f32_bf16 v129, v60, v60
    ds_write_b128 v4, v[100:103] offset:33792
    v_dot2c_f32_bf16 v128, s34, v61
    v_dot2c_f32_bf16 v129, v61, v61
    v_dot2c_f32_bf16 v128, s34, v62
    v_dot2c_f32_bf16 v129, v62, v62
    v_dot2c_f32_bf16 v128, s34, v63
    v_dot2c_f32_bf16 v129, v63, v63
    v_dot2c_f32_bf16 v128, s34, v64
    v_dot2c_f32_bf16 v129, v64, v64
    v_dot2c_f32_bf16 v128, s34, v65
    v_dot2c_f32_bf16 v129, v65, v65
    ds_write_b128 v4, v[104:107] offset:34816
    v_dot2c_f32_bf16 v128, s34, v66
    v_dot2c_f32_bf16 v129, v66, v66
    v_dot2c_f32_bf16 v128, s34, v67
    v_dot2c_f32_bf16 v129, v67, v67
    v_dot2c_f32_bf16 v128, s34, v68
    v_dot2c_f32_bf16 v129, v68, v68
    v_dot2c_f32_bf16 v128, s34, v69
    v_dot2c_f32_bf16 v129, v69, v69
    v_dot2c_f32_bf16 v128, s34, v70
    v_dot2c_f32_bf16 v129, v70, v70
    ds_write_b128 v4, v[108:111] offset:35840
    v_dot2c_f32_bf16 v128, s34, v71
    v_dot2c_f32_bf16 v129, v71, v71
    v_dot2c_f32_bf16 v128, s34, v72
    v_dot2c_f32_bf16 v129, v72, v72
    v_dot2c_f32_bf16 v128, s34, v73
    v_dot2c_f32_bf16 v129, v73, v73
    v_dot2c_f32_bf16 v128, s34, v74
    v_dot2c_f32_bf16 v129, v74, v74
    v_dot2c_f32_bf16 v128, s34, v75
    v_dot2c_f32_bf16 v129, v75, v75
    ds_write_b128 v4, v[112:115] offset:36864
    v_dot2c_f32_bf16 v128, s34, v76
    v_dot2c_f32_bf16 v129, v76, v76
    v_dot2c_f32_bf16 v128, s34, v77
    v_dot2c_f32_bf16 v129, v77, v77
    v_dot2c_f32_bf16 v128, s34, v78
    v_dot2c_f32_bf16 v129, v78, v78
    v_dot2c_f32_bf16 v128, s34, v79
    v_dot2c_f32_bf16 v129, v79, v79
    v_dot2c_f32_bf16 v128, s34, v80
    v_dot2c_f32_bf16 v129, v80, v80
    ds_write_b128 v4, v[116:119] offset:37888
    v_dot2c_f32_bf16 v128, s34, v81
    v_dot2c_f32_bf16 v129, v81, v81
    v_dot2c_f32_bf16 v128, s34, v82
    v_dot2c_f32_bf16 v129, v82, v82
    v_dot2c_f32_bf16 v128, s34, v83
    v_dot2c_f32_bf16 v129, v83, v83
    v_dot2c_f32_bf16 v128, s34, v84
    v_dot2c_f32_bf16 v129, v84, v84
    v_dot2c_f32_bf16 v128, s34, v85
    v_dot2c_f32_bf16 v129, v85, v85
    ds_write_b128 v4, v[120:123] offset:38912
    v_dot2c_f32_bf16 v128, s34, v86
    v_dot2c_f32_bf16 v129, v86, v86
    v_dot2c_f32_bf16 v128, s34, v87
    v_dot2c_f32_bf16 v129, v87, v87
    v_dot2c_f32_bf16 v128, s34, v88
    v_dot2c_f32_bf16 v129, v88, v88
    v_dot2c_f32_bf16 v128, s34, v89
    v_dot2c_f32_bf16 v129, v89, v89
    v_dot2c_f32_bf16 v128, s34, v90
    v_dot2c_f32_bf16 v129, v90, v90
    ds_write_b128 v4, v[124:127] offset:39936
    v_dot2c_f32_bf16 v128, s34, v91
    v_dot2c_f32_bf16 v129, v91, v91
    v_dot2c_f32_bf16 v128, s34, v92
    v_dot2c_f32_bf16 v129, v92, v92
    v_dot2c_f32_bf16 v128, s34, v93
    v_dot2c_f32_bf16 v129, v93, v93
    v_dot2c_f32_bf16 v128, s34, v94
    v_dot2c_f32_bf16 v129, v94, v94
    v_dot2c_f32_bf16 v128, s34, v95
    v_dot2c_f32_bf16 v129, v95, v95
    s_nop 2
    v_mov_b64 v[172:173], v[128:129]
    s_nop 1
    v_permlane32_swap_b32 v128, v172
    v_permlane32_swap_b32 v129, v173
    v_pk_add_f32 v[128:129], v[128:129], v[172:173]
    ds_write_b64 v5, v[128:129] offset:1024
    s_waitcnt vmcnt(10)
    s_waitcnt lgkmcnt(0)
    s_barrier
    ds_read_b128 v[130:133], v6 offset:1024
    ds_read_b128 v[134:137], v6 offset:1040
    ds_read_b128 v[96:99], v3 offset:32768
    ds_read_b128 v[100:103], v3 offset:33792
    ds_read_b128 v[104:107], v3 offset:40960
    ds_read_b128 v[108:111], v3 offset:41984
    ds_read_b128 v[112:115], v3 offset:49152
    ds_read_b128 v[116:119], v3 offset:50176
    ds_read_b128 v[120:123], v3 offset:57344
    ds_read_b128 v[124:127], v3 offset:58368
    s_waitcnt lgkmcnt(9)
    v_pk_add_f32 v[130:131], v[130:131], v[132:133]
    s_waitcnt lgkmcnt(8)
    v_pk_add_f32 v[134:135], v[134:135], v[136:137]
    v_pk_add_f32 v[130:131], v[130:131], v[134:135]
    v_mul_f32 v130, 0x3acccccd, v130
    v_mul_f32 v131, 0x3acccccd, v131
    v_fma_f32 v131, -v130, v130, v131
    v_max_f32 v131, 0, v131
    v_add_f32 v131, 0x3727c5ac, v131
    v_rsq_f32 v131, v131
    s_nop 0
    ds_write2_b32 v9, v130, v131 offset0:0 offset1:32
    ds_read_b128 v[138:141], v10 offset:0
    ds_read_b128 v[142:145], v10 offset:16
    ds_read_b128 v[146:149], v10 offset:128
    ds_read_b128 v[150:153], v10 offset:144
    s_waitcnt lgkmcnt(10)
    v_pk_add_f32 v[96:97], v[96:97], v[104:105]
    v_pk_add_f32 v[98:99], v[98:99], v[106:107]
    s_waitcnt lgkmcnt(9)
    v_pk_add_f32 v[100:101], v[100:101], v[108:109]
    v_pk_add_f32 v[102:103], v[102:103], v[110:111]
    s_waitcnt lgkmcnt(8)
    v_pk_add_f32 v[96:97], v[96:97], v[112:113]
    v_pk_add_f32 v[98:99], v[98:99], v[114:115]
    s_waitcnt lgkmcnt(7)
    v_pk_add_f32 v[100:101], v[100:101], v[116:117]
    v_pk_add_f32 v[102:103], v[102:103], v[118:119]
    s_waitcnt lgkmcnt(6)
    v_pk_add_f32 v[96:97], v[96:97], v[120:121]
    v_pk_add_f32 v[98:99], v[98:99], v[122:123]
    s_waitcnt lgkmcnt(5)
    v_pk_add_f32 v[100:101], v[100:101], v[124:125]
    v_pk_add_f32 v[102:103], v[102:103], v[126:127]
    s_waitcnt lgkmcnt(3)
    v_fma_f32 v96, -v138, v154, v96
    s_waitcnt lgkmcnt(1)
    v_mul_f32 v96, v96, v146
    v_fma_f32 v97, -v139, v155, v97
    v_mul_f32 v97, v97, v147
    v_fma_f32 v98, -v140, v156, v98
    v_mul_f32 v98, v98, v148
    v_fma_f32 v99, -v141, v157, v99
    v_mul_f32 v99, v99, v149
    v_fma_f32 v100, -v142, v158, v100
    s_waitcnt lgkmcnt(0)
    v_mul_f32 v100, v100, v150
    v_fma_f32 v101, -v143, v159, v101
    v_mul_f32 v101, v101, v151
    v_fma_f32 v102, -v144, v160, v102
    v_mul_f32 v102, v102, v152
    v_fma_f32 v103, -v145, v161, v103
    v_mul_f32 v103, v103, v153
    v_cvt_pk_bf16_f32 v172, v96, v97
    v_cvt_pk_bf16_f32 v173, v98, v99
    v_cvt_pk_bf16_f32 v174, v100, v101
    v_cvt_pk_bf16_f32 v175, v102, v103
    buffer_store_dwordx4 v[172:175], v7, s[4:7], s55 offen sc1
    s_mov_b32 s44, s45
    s_branch G_119
G_121:
    s_waitcnt vmcnt(10)
    v_mfma_f32_32x32x16_bf16 v[96:111], v[16:19], a[160:163], 0
    v_mfma_f32_32x32x16_bf16 v[112:127], v[16:19], a[200:203], 0
    s_waitcnt vmcnt(9)
    v_mfma_f32_32x32x16_bf16 v[96:111], v[20:23], a[164:167], v[96:111]
    v_mfma_f32_32x32x16_bf16 v[112:127], v[20:23], a[204:207], v[112:127]
    s_waitcnt vmcnt(8)
    v_mfma_f32_32x32x16_bf16 v[96:111], v[24:27], a[168:171], v[96:111]
    v_mfma_f32_32x32x16_bf16 v[112:127], v[24:27], a[208:211], v[112:127]
    s_waitcnt vmcnt(7)
    v_mfma_f32_32x32x16_bf16 v[96:111], v[28:31], a[172:175], v[96:111]
    v_mfma_f32_32x32x16_bf16 v[112:127], v[28:31], a[212:215], v[112:127]
    s_waitcnt vmcnt(6)
    v_mfma_f32_32x32x16_bf16 v[96:111], v[32:35], a[176:179], v[96:111]
    v_mfma_f32_32x32x16_bf16 v[112:127], v[32:35], a[216:219], v[112:127]
    s_waitcnt vmcnt(5)
    v_mfma_f32_32x32x16_bf16 v[96:111], v[36:39], a[180:183], v[96:111]
    v_mfma_f32_32x32x16_bf16 v[112:127], v[36:39], a[220:223], v[112:127]
    s_waitcnt vmcnt(4)
    v_mfma_f32_32x32x16_bf16 v[96:111], v[40:43], a[184:187], v[96:111]
    v_mfma_f32_32x32x16_bf16 v[112:127], v[40:43], a[224:227], v[112:127]
    s_waitcnt vmcnt(3)
    v_mfma_f32_32x32x16_bf16 v[96:111], v[44:47], a[188:191], v[96:111]
    v_mfma_f32_32x32x16_bf16 v[112:127], v[44:47], a[228:231], v[112:127]
    s_waitcnt vmcnt(2)
    v_mfma_f32_32x32x16_bf16 v[96:111], v[48:51], a[192:195], v[96:111]
    v_mfma_f32_32x32x16_bf16 v[112:127], v[48:51], a[232:235], v[112:127]
    s_waitcnt vmcnt(1)
    v_mfma_f32_32x32x16_bf16 v[96:111], v[52:55], a[196:199], v[96:111]
    v_mfma_f32_32x32x16_bf16 v[112:127], v[52:55], a[236:239], v[112:127]
    s_mul_i32 s55, s44, s58
    s_add_u32 s55, s55, s51
    s_nop 1
    ds_write_b128 v4, v[96:99] offset:0
    v_mov_b64 v[128:129], 0
    s_mov_b32 s34, 0x3f803f80
    v_dot2c_f32_bf16 v128, s34, v16
    v_dot2c_f32_bf16 v129, v16, v16
    v_dot2c_f32_bf16 v128, s34, v17
    v_dot2c_f32_bf16 v129, v17, v17
    v_dot2c_f32_bf16 v128, s34, v18
    v_dot2c_f32_bf16 v129, v18, v18
    v_dot2c_f32_bf16 v128, s34, v19
    v_dot2c_f32_bf16 v129, v19, v19
    v_dot2c_f32_bf16 v128, s34, v20
    v_dot2c_f32_bf16 v129, v20, v20
    ds_write_b128 v4, v[100:103] offset:1024
    v_dot2c_f32_bf16 v128, s34, v21
    v_dot2c_f32_bf16 v129, v21, v21
    v_dot2c_f32_bf16 v128, s34, v22
    v_dot2c_f32_bf16 v129, v22, v22
    v_dot2c_f32_bf16 v128, s34, v23
    v_dot2c_f32_bf16 v129, v23, v23
    v_dot2c_f32_bf16 v128, s34, v24
    v_dot2c_f32_bf16 v129, v24, v24
    v_dot2c_f32_bf16 v128, s34, v25
    v_dot2c_f32_bf16 v129, v25, v25
    ds_write_b128 v4, v[104:107] offset:2048
    v_dot2c_f32_bf16 v128, s34, v26
    v_dot2c_f32_bf16 v129, v26, v26
    v_dot2c_f32_bf16 v128, s34, v27
    v_dot2c_f32_bf16 v129, v27, v27
    v_dot2c_f32_bf16 v128, s34, v28
    v_dot2c_f32_bf16 v129, v28, v28
    v_dot2c_f32_bf16 v128, s34, v29
    v_dot2c_f32_bf16 v129, v29, v29
    v_dot2c_f32_bf16 v128, s34, v30
    v_dot2c_f32_bf16 v129, v30, v30
    ds_write_b128 v4, v[108:111] offset:3072
    v_dot2c_f32_bf16 v128, s34, v31
    v_dot2c_f32_bf16 v129, v31, v31
    v_dot2c_f32_bf16 v128, s34, v32
    v_dot2c_f32_bf16 v129, v32, v32
    v_dot2c_f32_bf16 v128, s34, v33
    v_dot2c_f32_bf16 v129, v33, v33
    v_dot2c_f32_bf16 v128, s34, v34
    v_dot2c_f32_bf16 v129, v34, v34
    v_dot2c_f32_bf16 v128, s34, v35
    v_dot2c_f32_bf16 v129, v35, v35
    ds_write_b128 v4, v[112:115] offset:4096
    v_dot2c_f32_bf16 v128, s34, v36
    v_dot2c_f32_bf16 v129, v36, v36
    v_dot2c_f32_bf16 v128, s34, v37
    v_dot2c_f32_bf16 v129, v37, v37
    v_dot2c_f32_bf16 v128, s34, v38
    v_dot2c_f32_bf16 v129, v38, v38
    v_dot2c_f32_bf16 v128, s34, v39
    v_dot2c_f32_bf16 v129, v39, v39
    v_dot2c_f32_bf16 v128, s34, v40
    v_dot2c_f32_bf16 v129, v40, v40
    ds_write_b128 v4, v[116:119] offset:5120
    v_dot2c_f32_bf16 v128, s34, v41
    v_dot2c_f32_bf16 v129, v41, v41
    v_dot2c_f32_bf16 v128, s34, v42
    v_dot2c_f32_bf16 v129, v42, v42
    v_dot2c_f32_bf16 v128, s34, v43
    v_dot2c_f32_bf16 v129, v43, v43
    v_dot2c_f32_bf16 v128, s34, v44
    v_dot2c_f32_bf16 v129, v44, v44
    v_dot2c_f32_bf16 v128, s34, v45
    v_dot2c_f32_bf16 v129, v45, v45
    ds_write_b128 v4, v[120:123] offset:6144
    v_dot2c_f32_bf16 v128, s34, v46
    v_dot2c_f32_bf16 v129, v46, v46
    v_dot2c_f32_bf16 v128, s34, v47
    v_dot2c_f32_bf16 v129, v47, v47
    v_dot2c_f32_bf16 v128, s34, v48
    v_dot2c_f32_bf16 v129, v48, v48
    v_dot2c_f32_bf16 v128, s34, v49
    v_dot2c_f32_bf16 v129, v49, v49
    v_dot2c_f32_bf16 v128, s34, v50
    v_dot2c_f32_bf16 v129, v50, v50
    ds_write_b128 v4, v[124:127] offset:7168
    v_dot2c_f32_bf16 v128, s34, v51
    v_dot2c_f32_bf16 v129, v51, v51
    v_dot2c_f32_bf16 v128, s34, v52
    v_dot2c_f32_bf16 v129, v52, v52
    v_dot2c_f32_bf16 v128, s34, v53
    v_dot2c_f32_bf16 v129, v53, v53
    v_dot2c_f32_bf16 v128, s34, v54
    v_dot2c_f32_bf16 v129, v54, v54
    v_dot2c_f32_bf16 v128, s34, v55
    v_dot2c_f32_bf16 v129, v55, v55
    s_nop 2
    v_mov_b64 v[172:173], v[128:129]
    s_nop 1
    v_permlane32_swap_b32 v128, v172
    v_permlane32_swap_b32 v129, v173
    v_pk_add_f32 v[128:129], v[128:129], v[172:173]
    ds_write_b64 v5, v[128:129] offset:0
    s_waitcnt vmcnt(0)
    s_waitcnt lgkmcnt(0)
    s_barrier
    ds_read_b128 v[130:133], v6 offset:0
    ds_read_b128 v[134:137], v6 offset:16
    ds_read_b128 v[96:99], v3 offset:0
    ds_read_b128 v[100:103], v3 offset:1024
    ds_read_b128 v[104:107], v3 offset:8192
    ds_read_b128 v[108:111], v3 offset:9216
    ds_read_b128 v[112:115], v3 offset:16384
    ds_read_b128 v[116:119], v3 offset:17408
    ds_read_b128 v[120:123], v3 offset:24576
    ds_read_b128 v[124:127], v3 offset:25600
    s_waitcnt lgkmcnt(9)
    v_pk_add_f32 v[130:131], v[130:131], v[132:133]
    s_waitcnt lgkmcnt(8)
    v_pk_add_f32 v[134:135], v[134:135], v[136:137]
    v_pk_add_f32 v[130:131], v[130:131], v[134:135]
    v_mul_f32 v130, 0x3acccccd, v130
    v_mul_f32 v131, 0x3acccccd, v131
    v_fma_f32 v131, -v130, v130, v131
    v_max_f32 v131, 0, v131
    v_add_f32 v131, 0x3727c5ac, v131
    v_rsq_f32 v131, v131
    s_nop 0
    ds_write2_b32 v9, v130, v131 offset0:0 offset1:32
    ds_read_b128 v[138:141], v10 offset:0
    ds_read_b128 v[142:145], v10 offset:16
    ds_read_b128 v[146:149], v10 offset:128
    ds_read_b128 v[150:153], v10 offset:144
    s_waitcnt lgkmcnt(10)
    v_pk_add_f32 v[96:97], v[96:97], v[104:105]
    v_pk_add_f32 v[98:99], v[98:99], v[106:107]
    s_waitcnt lgkmcnt(9)
    v_pk_add_f32 v[100:101], v[100:101], v[108:109]
    v_pk_add_f32 v[102:103], v[102:103], v[110:111]
    s_waitcnt lgkmcnt(8)
    v_pk_add_f32 v[96:97], v[96:97], v[112:113]
    v_pk_add_f32 v[98:99], v[98:99], v[114:115]
    s_waitcnt lgkmcnt(7)
    v_pk_add_f32 v[100:101], v[100:101], v[116:117]
    v_pk_add_f32 v[102:103], v[102:103], v[118:119]
    s_waitcnt lgkmcnt(6)
    v_pk_add_f32 v[96:97], v[96:97], v[120:121]
    v_pk_add_f32 v[98:99], v[98:99], v[122:123]
    s_waitcnt lgkmcnt(5)
    v_pk_add_f32 v[100:101], v[100:101], v[124:125]
    v_pk_add_f32 v[102:103], v[102:103], v[126:127]
    s_waitcnt lgkmcnt(3)
    v_fma_f32 v96, -v138, v154, v96
    s_waitcnt lgkmcnt(1)
    v_mul_f32 v96, v96, v146
    v_fma_f32 v97, -v139, v155, v97
    v_mul_f32 v97, v97, v147
    v_fma_f32 v98, -v140, v156, v98
    v_mul_f32 v98, v98, v148
    v_fma_f32 v99, -v141, v157, v99
    v_mul_f32 v99, v99, v149
    v_fma_f32 v100, -v142, v158, v100
    s_waitcnt lgkmcnt(0)
    v_mul_f32 v100, v100, v150
    v_fma_f32 v101, -v143, v159, v101
    v_mul_f32 v101, v101, v151
    v_fma_f32 v102, -v144, v160, v102
    v_mul_f32 v102, v102, v152
    v_fma_f32 v103, -v145, v161, v103
    v_mul_f32 v103, v103, v153
    v_cvt_pk_bf16_f32 v172, v96, v97
    v_cvt_pk_bf16_f32 v173, v98, v99
    v_cvt_pk_bf16_f32 v174, v100, v101
    v_cvt_pk_bf16_f32 v175, v102, v103
    buffer_store_dwordx4 v[172:175], v7, s[4:7], s55 offen sc1
    s_branch G_120
G_122:
    s_waitcnt vmcnt(10)
    v_mfma_f32_32x32x16_bf16 v[96:111], v[56:59], a[160:163], 0
    v_mfma_f32_32x32x16_bf16 v[112:127], v[56:59], a[200:203], 0
    s_waitcnt vmcnt(9)
    v_mfma_f32_32x32x16_bf16 v[96:111], v[60:63], a[164:167], v[96:111]
    v_mfma_f32_32x32x16_bf16 v[112:127], v[60:63], a[204:207], v[112:127]
    s_waitcnt vmcnt(8)
    v_mfma_f32_32x32x16_bf16 v[96:111], v[64:67], a[168:171], v[96:111]
    v_mfma_f32_32x32x16_bf16 v[112:127], v[64:67], a[208:211], v[112:127]
    s_waitcnt vmcnt(7)
    v_mfma_f32_32x32x16_bf16 v[96:111], v[68:71], a[172:175], v[96:111]
    v_mfma_f32_32x32x16_bf16 v[112:127], v[68:71], a[212:215], v[112:127]
    s_waitcnt vmcnt(6)
    v_mfma_f32_32x32x16_bf16 v[96:111], v[72:75], a[176:179], v[96:111]
    v_mfma_f32_32x32x16_bf16 v[112:127], v[72:75], a[216:219], v[112:127]
    s_waitcnt vmcnt(5)
    v_mfma_f32_32x32x16_bf16 v[96:111], v[76:79], a[180:183], v[96:111]
    v_mfma_f32_32x32x16_bf16 v[112:127], v[76:79], a[220:223], v[112:127]
    s_waitcnt vmcnt(4)
    v_mfma_f32_32x32x16_bf16 v[96:111], v[80:83], a[184:187], v[96:111]
    v_mfma_f32_32x32x16_bf16 v[112:127], v[80:83], a[224:227], v[112:127]
    s_waitcnt vmcnt(3)
    v_mfma_f32_32x32x16_bf16 v[96:111], v[84:87], a[188:191], v[96:111]
    v_mfma_f32_32x32x16_bf16 v[112:127], v[84:87], a[228:231], v[112:127]
    s_waitcnt vmcnt(2)
    v_mfma_f32_32x32x16_bf16 v[96:111], v[88:91], a[192:195], v[96:111]
    v_mfma_f32_32x32x16_bf16 v[112:127], v[88:91], a[232:235], v[112:127]
    s_waitcnt vmcnt(1)
    v_mfma_f32_32x32x16_bf16 v[96:111], v[92:95], a[196:199], v[96:111]
    v_mfma_f32_32x32x16_bf16 v[112:127], v[92:95], a[236:239], v[112:127]
    s_mul_i32 s55, s44, s58
    s_add_u32 s55, s55, s51
    s_nop 1
    ds_write_b128 v4, v[96:99] offset:32768
    v_mov_b64 v[128:129], 0
    s_mov_b32 s34, 0x3f803f80
    v_dot2c_f32_bf16 v128, s34, v56
    v_dot2c_f32_bf16 v129, v56, v56
    v_dot2c_f32_bf16 v128, s34, v57
    v_dot2c_f32_bf16 v129, v57, v57
    v_dot2c_f32_bf16 v128, s34, v58
    v_dot2c_f32_bf16 v129, v58, v58
    v_dot2c_f32_bf16 v128, s34, v59
    v_dot2c_f32_bf16 v129, v59, v59
    v_dot2c_f32_bf16 v128, s34, v60
    v_dot2c_f32_bf16 v129, v60, v60
    ds_write_b128 v4, v[100:103] offset:33792
    v_dot2c_f32_bf16 v128, s34, v61
    v_dot2c_f32_bf16 v129, v61, v61
    v_dot2c_f32_bf16 v128, s34, v62
    v_dot2c_f32_bf16 v129, v62, v62
    v_dot2c_f32_bf16 v128, s34, v63
    v_dot2c_f32_bf16 v129, v63, v63
    v_dot2c_f32_bf16 v128, s34, v64
    v_dot2c_f32_bf16 v129, v64, v64
    v_dot2c_f32_bf16 v128, s34, v65
    v_dot2c_f32_bf16 v129, v65, v65
    ds_write_b128 v4, v[104:107] offset:34816
    v_dot2c_f32_bf16 v128, s34, v66
    v_dot2c_f32_bf16 v129, v66, v66
    v_dot2c_f32_bf16 v128, s34, v67
    v_dot2c_f32_bf16 v129, v67, v67
    v_dot2c_f32_bf16 v128, s34, v68
    v_dot2c_f32_bf16 v129, v68, v68
    v_dot2c_f32_bf16 v128, s34, v69
    v_dot2c_f32_bf16 v129, v69, v69
    v_dot2c_f32_bf16 v128, s34, v70
    v_dot2c_f32_bf16 v129, v70, v70
    ds_write_b128 v4, v[108:111] offset:35840
    v_dot2c_f32_bf16 v128, s34, v71
    v_dot2c_f32_bf16 v129, v71, v71
    v_dot2c_f32_bf16 v128, s34, v72
    v_dot2c_f32_bf16 v129, v72, v72
    v_dot2c_f32_bf16 v128, s34, v73
    v_dot2c_f32_bf16 v129, v73, v73
    v_dot2c_f32_bf16 v128, s34, v74
    v_dot2c_f32_bf16 v129, v74, v74
    v_dot2c_f32_bf16 v128, s34, v75
    v_dot2c_f32_bf16 v129, v75, v75
    ds_write_b128 v4, v[112:115] offset:36864
    v_dot2c_f32_bf16 v128, s34, v76
    v_dot2c_f32_bf16 v129, v76, v76
    v_dot2c_f32_bf16 v128, s34, v77
    v_dot2c_f32_bf16 v129, v77, v77
    v_dot2c_f32_bf16 v128, s34, v78
    v_dot2c_f32_bf16 v129, v78, v78
    v_dot2c_f32_bf16 v128, s34, v79
    v_dot2c_f32_bf16 v129, v79, v79
    v_dot2c_f32_bf16 v128, s34, v80
    v_dot2c_f32_bf16 v129, v80, v80
    ds_write_b128 v4, v[116:119] offset:37888
    v_dot2c_f32_bf16 v128, s34, v81
    v_dot2c_f32_bf16 v129, v81, v81
    v_dot2c_f32_bf16 v128, s34, v82
    v_dot2c_f32_bf16 v129, v82, v82
    v_dot2c_f32_bf16 v128, s34, v83
    v_dot2c_f32_bf16 v129, v83, v83
    v_dot2c_f32_bf16 v128, s34, v84
    v_dot2c_f32_bf16 v129, v84, v84
    v_dot2c_f32_bf16 v128, s34, v85
    v_dot2c_f32_bf16 v129, v85, v85
    ds_write_b128 v4, v[120:123] offset:38912
    v_dot2c_f32_bf16 v128, s34, v86
    v_dot2c_f32_bf16 v129, v86, v86
    v_dot2c_f32_bf16 v128, s34, v87
    v_dot2c_f32_bf16 v129, v87, v87
    v_dot2c_f32_bf16 v128, s34, v88
    v_dot2c_f32_bf16 v129, v88, v88
    v_dot2c_f32_bf16 v128, s34, v89
    v_dot2c_f32_bf16 v129, v89, v89
    v_dot2c_f32_bf16 v128, s34, v90
    v_dot2c_f32_bf16 v129, v90, v90
    ds_write_b128 v4, v[124:127] offset:39936
    v_dot2c_f32_bf16 v128, s34, v91
    v_dot2c_f32_bf16 v129, v91, v91
    v_dot2c_f32_bf16 v128, s34, v92
    v_dot2c_f32_bf16 v129, v92, v92
    v_dot2c_f32_bf16 v128, s34, v93
    v_dot2c_f32_bf16 v129, v93, v93
    v_dot2c_f32_bf16 v128, s34, v94
    v_dot2c_f32_bf16 v129, v94, v94
    v_dot2c_f32_bf16 v128, s34, v95
    v_dot2c_f32_bf16 v129, v95, v95
    s_nop 2
    v_mov_b64 v[172:173], v[128:129]
    s_nop 1
    v_permlane32_swap_b32 v128, v172
    v_permlane32_swap_b32 v129, v173
    v_pk_add_f32 v[128:129], v[128:129], v[172:173]
    ds_write_b64 v5, v[128:129] offset:1024
    s_waitcnt vmcnt(0)
    s_waitcnt lgkmcnt(0)
    s_barrier
    ds_read_b128 v[130:133], v6 offset:1024
    ds_read_b128 v[134:137], v6 offset:1040
    ds_read_b128 v[96:99], v3 offset:32768
    ds_read_b128 v[100:103], v3 offset:33792
    ds_read_b128 v[104:107], v3 offset:40960
    ds_read_b128 v[108:111], v3 offset:41984
    ds_read_b128 v[112:115], v3 offset:49152
    ds_read_b128 v[116:119], v3 offset:50176
    ds_read_b128 v[120:123], v3 offset:57344
    ds_read_b128 v[124:127], v3 offset:58368
    s_waitcnt lgkmcnt(9)
    v_pk_add_f32 v[130:131], v[130:131], v[132:133]
    s_waitcnt lgkmcnt(8)
    v_pk_add_f32 v[134:135], v[134:135], v[136:137]
    v_pk_add_f32 v[130:131], v[130:131], v[134:135]
    v_mul_f32 v130, 0x3acccccd, v130
    v_mul_f32 v131, 0x3acccccd, v131
    v_fma_f32 v131, -v130, v130, v131
    v_max_f32 v131, 0, v131
    v_add_f32 v131, 0x3727c5ac, v131
    v_rsq_f32 v131, v131
    s_nop 0
    ds_write2_b32 v9, v130, v131 offset0:0 offset1:32
    ds_read_b128 v[138:141], v10 offset:0
    ds_read_b128 v[142:145], v10 offset:16
    ds_read_b128 v[146:149], v10 offset:128
    ds_read_b128 v[150:153], v10 offset:144
    s_waitcnt lgkmcnt(10)
    v_pk_add_f32 v[96:97], v[96:97], v[104:105]
    v_pk_add_f32 v[98:99], v[98:99], v[106:107]
    s_waitcnt lgkmcnt(9)
    v_pk_add_f32 v[100:101], v[100:101], v[108:109]
    v_pk_add_f32 v[102:103], v[102:103], v[110:111]
    s_waitcnt lgkmcnt(8)
    v_pk_add_f32 v[96:97], v[96:97], v[112:113]
    v_pk_add_f32 v[98:99], v[98:99], v[114:115]
    s_waitcnt lgkmcnt(7)
    v_pk_add_f32 v[100:101], v[100:101], v[116:117]
    v_pk_add_f32 v[102:103], v[102:103], v[118:119]
    s_waitcnt lgkmcnt(6)
    v_pk_add_f32 v[96:97], v[96:97], v[120:121]
    v_pk_add_f32 v[98:99], v[98:99], v[122:123]
    s_waitcnt lgkmcnt(5)
    v_pk_add_f32 v[100:101], v[100:101], v[124:125]
    v_pk_add_f32 v[102:103], v[102:103], v[126:127]
    s_waitcnt lgkmcnt(3)
    v_fma_f32 v96, -v138, v154, v96
    s_waitcnt lgkmcnt(1)
    v_mul_f32 v96, v96, v146
    v_fma_f32 v97, -v139, v155, v97
    v_mul_f32 v97, v97, v147
    v_fma_f32 v98, -v140, v156, v98
    v_mul_f32 v98, v98, v148
    v_fma_f32 v99, -v141, v157, v99
    v_mul_f32 v99, v99, v149
    v_fma_f32 v100, -v142, v158, v100
    s_waitcnt lgkmcnt(0)
    v_mul_f32 v100, v100, v150
    v_fma_f32 v101, -v143, v159, v101
    v_mul_f32 v101, v101, v151
    v_fma_f32 v102, -v144, v160, v102
    v_mul_f32 v102, v102, v152
    v_fma_f32 v103, -v145, v161, v103
    v_mul_f32 v103, v103, v153
    v_cvt_pk_bf16_f32 v172, v96, v97
    v_cvt_pk_bf16_f32 v173, v98, v99
    v_cvt_pk_bf16_f32 v174, v100, v101
    v_cvt_pk_bf16_f32 v175, v102, v103
    buffer_store_dwordx4 v[172:175], v7, s[4:7], s55 offen sc1
G_120:
    s_waitcnt vmcnt(0)
    s_barrier
    s_cmp_lg_u32 s29, 0
    s_cbranch_scc1 F_123
    s_lshl_b32 s32, s28, 2
    s_add_u32 s32, s32, s29
    s_lshl_b32 s32, s32, 2
    s_add_u32 s32, s32, 4096
    v_mov_b32 v172, 1
    s_mov_b64 exec, 1
    buffer_store_dword v172, off, s[4:7], s32 sc1
    s_mov_b64 exec, -1
F_123:
R_118:
    s_cmp_lt_u32 s28, 160
    s_cbranch_scc1 R_124
    v_mov_b64 v[4:5], -1
    v_mov_b64 v[6:7], -1
    s_sub_u32 s34, s28, 160
    s_lshl_b32 s34, s34, 2
    s_add_u32 s34, s34, s29
    s_lshl_b32 s34, s34, 14
    s_add_u32 s35, s34, 2097152
    buffer_store_dwordx4 v[4:7], v0, s[4:7], s35 offen sc1
    s_add_u32 s35, s34, 2098176
    buffer_store_dwordx4 v[4:7], v0, s[4:7], s35 offen sc1
    s_add_u32 s35, s34, 2099200
    buffer_store_dwordx4 v[4:7], v0, s[4:7], s35 offen sc1
    s_add_u32 s35, s34, 2100224
    buffer_store_dwordx4 v[4:7], v0, s[4:7], s35 offen sc1
    s_add_u32 s35, s34, 2101248
    buffer_store_dwordx4 v[4:7], v0, s[4:7], s35 offen sc1
    s_add_u32 s35, s34, 2105344
    buffer_store_dwordx4 v[4:7], v0, s[4:7], s35 offen sc1
    s_add_u32 s35, s34, 2106368
    buffer_store_dwordx4 v[4:7], v0, s[4:7], s35 offen sc1
    s_add_u32 s35, s34, 2107392
    buffer_store_dwordx4 v[4:7], v0, s[4:7], s35 offen sc1
    s_add_u32 s35, s34, 2108416
    buffer_store_dwordx4 v[4:7], v0, s[4:7], s35 offen sc1
    s_add_u32 s35, s34, 2109440
    buffer_store_dwordx4 v[4:7], v0, s[4:7], s35 offen sc1
    s_add_u32 s35, s34, 6291456
    buffer_store_dwordx4 v[4:7], v0, s[4:7], s35 offen sc1
    s_add_u32 s35, s34, 6292480
    buffer_store_dwordx4 v[4:7], v0, s[4:7], s35 offen sc1
    s_add_u32 s35, s34, 6293504
    buffer_store_dwordx4 v[4:7], v0, s[4:7], s35 offen sc1
    s_add_u32 s35, s34, 6294528
    buffer_store_dwordx4 v[4:7], v0, s[4:7], s35 offen sc1
    s_add_u32 s35, s34, 6295552
    buffer_store_dwordx4 v[4:7], v0, s[4:7], s35 offen sc1
    s_add_u32 s35, s34, 6299648
    buffer_store_dwordx4 v[4:7], v0, s[4:7], s35 offen sc1
    s_add_u32 s35, s34, 6300672
    buffer_store_dwordx4 v[4:7], v0, s[4:7], s35 offen sc1
    s_add_u32 s35, s34, 6301696
    buffer_store_dwordx4 v[4:7], v0, s[4:7], s35 offen sc1
    s_add_u32 s35, s34, 6302720
    buffer_store_dwordx4 v[4:7], v0, s[4:7], s35 offen sc1
    s_add_u32 s35, s34, 6303744
    buffer_store_dwordx4 v[4:7], v0, s[4:7], s35 offen sc1
    s_waitcnt vmcnt(0)
    s_barrier
    s_cmp_lg_u32 s29, 0
    s_cbranch_scc1 F_125
    s_lshl_b32 s32, s28, 2
    s_add_u32 s32, s32, s29
    s_lshl_b32 s32, s32, 2
    s_add_u32 s32, s32, 28672
    v_mov_b32 v8, 1
    s_mov_b64 exec, 1
    buffer_store_dword v8, off, s[4:7], s32 sc1
    s_mov_b64 exec, -1
F_125:
R_124:
    s_mov_b32 s35, 0x3acccccd
    s_lshl_b32 s34, s67, 6
    s_add_u32 s34, s34, 0
    v_bfe_u32 v5, v1, 0, 2
    v_bfe_u32 v6, v1, 2, 1
    v_lshl_add_u32 v5, v6, 3, v5
    v_bfe_u32 v6, v1, 3, 1
    v_lshl_add_u32 v5, v6, 2, v5
    v_bfe_u32 v6, v1, 4, 1
    v_lshl_add_u32 v5, v6, 4, v5
    v_add_u32 v5, s34, v5
    s_mul_i32 s36, s29, 80
    s_add_u32 s36, s36, 1
    v_bfe_u32 v4, v1, 5, 1
    v_mul_u32_u24 v4, 4, v4
    v_add_u32 v4, s36, v4
    v_mul_u32_u24 v4, v4, v5
    v_cvt_f32_u32 v4, v4
    v_cvt_f32_u32 v5, v5
    v_mul_f32 v4, s35, v4
    v_mul_f32 v5, s35, v5
    v_fract_f32 v4, v4
    v_fmamk_f32 v6, v5, 0x0, v4
    v_sin_f32 v7, -v6
    v_cos_f32 v6, v6
    s_nop 0
    v_cvt_pk_bf16_f32 v10, v6, v7
    v_fmamk_f32 v8, v5, 0x3f800000, v4
    v_sin_f32 v9, -v8
    v_cos_f32 v8, v8
    v_accvgpr_write_b32 a80, v10
    v_cvt_pk_bf16_f32 v10, v8, v9
    v_fmamk_f32 v6, v5, 0x40000000, v4
    v_sin_f32 v7, -v6
    v_cos_f32 v6, v6
    v_accvgpr_write_b32 a81, v10
    v_cvt_pk_bf16_f32 v10, v6, v7
    v_fmamk_f32 v8, v5, 0x40400000, v4
    v_sin_f32 v9, -v8
    v_cos_f32 v8, v8
    v_accvgpr_write_b32 a82, v10
    v_cvt_pk_bf16_f32 v10, v8, v9
    v_fmamk_f32 v6, v5, 0x41000000, v4
    v_sin_f32 v7, -v6
    v_cos_f32 v6, v6
    v_accvgpr_write_b32 a83, v10
    v_cvt_pk_bf16_f32 v10, v6, v7
    v_fmamk_f32 v8, v5, 0x41100000, v4
    v_sin_f32 v9, -v8
    v_cos_f32 v8, v8
    v_accvgpr_write_b32 a84, v10
    v_cvt_pk_bf16_f32 v10, v8, v9
    v_fmamk_f32 v6, v5, 0x41200000, v4
    v_sin_f32 v7, -v6
    v_cos_f32 v6, v6
    v_accvgpr_write_b32 a85, v10
    v_cvt_pk_bf16_f32 v10, v6, v7
    v_fmamk_f32 v8, v5, 0x41300000, v4
    v_sin_f32 v9, -v8
    v_cos_f32 v8, v8
    v_accvgpr_write_b32 a86, v10
    v_cvt_pk_bf16_f32 v10, v8, v9
    v_fmamk_f32 v6, v5, 0x41800000, v4
    v_sin_f32 v7, -v6
    v_cos_f32 v6, v6
    v_accvgpr_write_b32 a87, v10
    v_cvt_pk_bf16_f32 v10, v6, v7
    v_fmamk_f32 v8, v5, 0x41880000, v4
    v_sin_f32 v9, -v8
    v_cos_f32 v8, v8
    v_accvgpr_write_b32 a88, v10
    v_cvt_pk_bf16_f32 v10, v8, v9
    v_fmamk_f32 v6, v5, 0x41900000, v4
    v_sin_f32 v7, -v6
    v_cos_f32 v6, v6
    v_accvgpr_write_b32 a89, v10
    v_cvt_pk_bf16_f32 v10, v6, v7
    v_fmamk_f32 v8, v5, 0x41980000, v4
    v_sin_f32 v9, -v8
    v_cos_f32 v8, v8
    v_accvgpr_write_b32 a90, v10
    v_cvt_pk_bf16_f32 v10, v8, v9
    v_fmamk_f32 v6, v5, 0x41c00000, v4
    v_sin_f32 v7, -v6
    v_cos_f32 v6, v6
    v_accvgpr_write_b32 a91, v10
    v_cvt_pk_bf16_f32 v10, v6, v7
    v_fmamk_f32 v8, v5, 0x41c80000, v4
    v_sin_f32 v9, -v8
    v_cos_f32 v8, v8
    v_accvgpr_write_b32 a92, v10
    v_cvt_pk_bf16_f32 v10, v8, v9
    v_fmamk_f32 v6, v5, 0x41d00000, v4
    v_sin_f32 v7, -v6
    v_cos_f32 v6, v6
    v_accvgpr_write_b32 a93, v10
    v_cvt_pk_bf16_f32 v10, v6, v7
    v_fmamk_f32 v8, v5, 0x41d80000, v4
    v_sin_f32 v9, -v8
    v_cos_f32 v8, v8
    v_accvgpr_write_b32 a94, v10
    v_cvt_pk_bf16_f32 v10, v8, v9
    v_fmamk_f32 v6, v5, 0x42000000, v4
    v_sin_f32 v7, -v6
    v_cos_f32 v6, v6
    v_accvgpr_write_b32 a95, v10
    v_cvt_pk_bf16_f32 v10, v6, v7
    v_fmamk_f32 v8, v5, 0x42040000, v4
    v_sin_f32 v9, -v8
    v_cos_f32 v8, v8
    v_accvgpr_write_b32 a96, v10
    v_cvt_pk_bf16_f32 v10, v8, v9
    v_fmamk_f32 v6, v5, 0x42080000, v4
    v_sin_f32 v7, -v6
    v_cos_f32 v6, v6
    v_accvgpr_write_b32 a97, v10
    v_cvt_pk_bf16_f32 v10, v6, v7
    v_fmamk_f32 v8, v5, 0x420c0000, v4
    v_sin_f32 v9, -v8
    v_cos_f32 v8, v8
    v_accvgpr_write_b32 a98, v10
    v_cvt_pk_bf16_f32 v10, v8, v9
    v_fmamk_f32 v6, v5, 0x42200000, v4
    v_sin_f32 v7, -v6
    v_cos_f32 v6, v6
    v_accvgpr_write_b32 a99, v10
    v_cvt_pk_bf16_f32 v10, v6, v7
    v_fmamk_f32 v8, v5, 0x42240000, v4
    v_sin_f32 v9, -v8
    v_cos_f32 v8, v8
    v_accvgpr_write_b32 a100, v10
    v_cvt_pk_bf16_f32 v10, v8, v9
    v_fmamk_f32 v6, v5, 0x42280000, v4
    v_sin_f32 v7, -v6
    v_cos_f32 v6, v6
    v_accvgpr_write_b32 a101, v10
    v_cvt_pk_bf16_f32 v10, v6, v7
    v_fmamk_f32 v8, v5, 0x422c0000, v4
    v_sin_f32 v9, -v8
    v_cos_f32 v8, v8
    v_accvgpr_write_b32 a102, v10
    v_cvt_pk_bf16_f32 v10, v8, v9
    v_fmamk_f32 v6, v5, 0x42400000, v4
    v_sin_f32 v7, -v6
    v_cos_f32 v6, v6
    v_accvgpr_write_b32 a103, v10
    v_cvt_pk_bf16_f32 v10, v6, v7
    v_fmamk_f32 v8, v5, 0x42440000, v4
    v_sin_f32 v9, -v8
    v_cos_f32 v8, v8
    v_accvgpr_write_b32 a104, v10
    v_cvt_pk_bf16_f32 v10, v8, v9
    v_fmamk_f32 v6, v5, 0x42480000, v4
    v_sin_f32 v7, -v6
    v_cos_f32 v6, v6
    v_accvgpr_write_b32 a105, v10
    v_cvt_pk_bf16_f32 v10, v6, v7
    v_fmamk_f32 v8, v5, 0x424c0000, v4
    v_sin_f32 v9, -v8
    v_cos_f32 v8, v8
    v_accvgpr_write_b32 a106, v10
    v_cvt_pk_bf16_f32 v10, v8, v9
    v_fmamk_f32 v6, v5, 0x42600000, v4
    v_sin_f32 v7, -v6
    v_cos_f32 v6, v6
    v_accvgpr_write_b32 a107, v10
    v_cvt_pk_bf16_f32 v10, v6, v7
    v_fmamk_f32 v8, v5, 0x42640000, v4
    v_sin_f32 v9, -v8
    v_cos_f32 v8, v8
    v_accvgpr_write_b32 a108, v10
    v_cvt_pk_bf16_f32 v10, v8, v9
    v_fmamk_f32 v6, v5, 0x42680000, v4
    v_sin_f32 v7, -v6
    v_cos_f32 v6, v6
    v_accvgpr_write_b32 a109, v10
    v_cvt_pk_bf16_f32 v10, v6, v7
    v_fmamk_f32 v8, v5, 0x426c0000, v4
    v_sin_f32 v9, -v8
    v_cos_f32 v8, v8
    v_accvgpr_write_b32 a110, v10
    v_cvt_pk_bf16_f32 v10, v8, v9
    v_fmamk_f32 v6, v5, 0x42800000, v4
    v_sin_f32 v7, -v6
    v_cos_f32 v6, v6
    v_accvgpr_write_b32 a111, v10
    v_cvt_pk_bf16_f32 v10, v6, v7
    v_fmamk_f32 v8, v5, 0x42820000, v4
    v_sin_f32 v9, -v8
    v_cos_f32 v8, v8
    v_accvgpr_write_b32 a112, v10
    v_cvt_pk_bf16_f32 v10, v8, v9
    v_fmamk_f32 v6, v5, 0x42840000, v4
    v_sin_f32 v7, -v6
    v_cos_f32 v6, v6
    v_accvgpr_write_b32 a113, v10
    v_cvt_pk_bf16_f32 v10, v6, v7
    v_fmamk_f32 v8, v5, 0x42860000, v4
    v_sin_f32 v9, -v8
    v_cos_f32 v8, v8
    v_accvgpr_write_b32 a114, v10
    v_cvt_pk_bf16_f32 v10, v8, v9
    v_fmamk_f32 v6, v5, 0x42900000, v4
    v_sin_f32 v7, -v6
    v_cos_f32 v6, v6
    v_accvgpr_write_b32 a115, v10
    v_cvt_pk_bf16_f32 v10, v6, v7
    v_fmamk_f32 v8, v5, 0x42920000, v4
    v_sin_f32 v9, -v8
    v_cos_f32 v8, v8
    v_accvgpr_write_b32 a116, v10
    v_cvt_pk_bf16_f32 v10, v8, v9
    v_fmamk_f32 v6, v5, 0x42940000, v4
    v_sin_f32 v7, -v6
    v_cos_f32 v6, v6
    v_accvgpr_write_b32 a117, v10
    v_cvt_pk_bf16_f32 v10, v6, v7
    v_fmamk_f32 v8, v5, 0x42960000, v4
    v_sin_f32 v9, -v8
    v_cos_f32 v8, v8
    v_accvgpr_write_b32 a118, v10
    v_cvt_pk_bf16_f32 v10, v8, v9
    v_accvgpr_write_b32 a119, v10
    s_lshl_b32 s34, s67, 6
    s_add_u32 s34, s34, 32
    v_bfe_u32 v5, v1, 0, 2
    v_bfe_u32 v6, v1, 2, 1
    v_lshl_add_u32 v5, v6, 3, v5
    v_bfe_u32 v6, v1, 3, 1
    v_lshl_add_u32 v5, v6, 2, v5
    v_bfe_u32 v6, v1, 4, 1
    v_lshl_add_u32 v5, v6, 4, v5
    v_add_u32 v5, s34, v5
    s_mul_i32 s36, s29, 80
    s_add_u32 s36, s36, 1
    v_bfe_u32 v4, v1, 5, 1
    v_mul_u32_u24 v4, 4, v4
    v_add_u32 v4, s36, v4
    v_mul_u32_u24 v4, v4, v5
    v_cvt_f32_u32 v4, v4
    v_cvt_f32_u32 v5, v5
    v_mul_f32 v4, s35, v4
    v_mul_f32 v5, s35, v5
    v_fract_f32 v4, v4
    v_fmamk_f32 v6, v5, 0x0, v4
    v_sin_f32 v7, -v6
    v_cos_f32 v6, v6
    s_nop 0
    v_cvt_pk_bf16_f32 v10, v6, v7
    v_fmamk_f32 v8, v5, 0x3f800000, v4
    v_sin_f32 v9, -v8
    v_cos_f32 v8, v8
    v_accvgpr_write_b32 a120, v10
    v_cvt_pk_bf16_f32 v10, v8, v9
    v_fmamk_f32 v6, v5, 0x40000000, v4
    v_sin_f32 v7, -v6
    v_cos_f32 v6, v6
    v_accvgpr_write_b32 a121, v10
    v_cvt_pk_bf16_f32 v10, v6, v7
    v_fmamk_f32 v8, v5, 0x40400000, v4
    v_sin_f32 v9, -v8
    v_cos_f32 v8, v8
    v_accvgpr_write_b32 a122, v10
    v_cvt_pk_bf16_f32 v10, v8, v9
    v_fmamk_f32 v6, v5, 0x41000000, v4
    v_sin_f32 v7, -v6
    v_cos_f32 v6, v6
    v_accvgpr_write_b32 a123, v10
    v_cvt_pk_bf16_f32 v10, v6, v7
    v_fmamk_f32 v8, v5, 0x41100000, v4
    v_sin_f32 v9, -v8
    v_cos_f32 v8, v8
    v_accvgpr_write_b32 a124, v10
    v_cvt_pk_bf16_f32 v10, v8, v9
    v_fmamk_f32 v6, v5, 0x41200000, v4
    v_sin_f32 v7, -v6
    v_cos_f32 v6, v6
    v_accvgpr_write_b32 a125, v10
    v_cvt_pk_bf16_f32 v10, v6, v7
    v_fmamk_f32 v8, v5, 0x41300000, v4
    v_sin_f32 v9, -v8
    v_cos_f32 v8, v8
    v_accvgpr_write_b32 a126, v10
    v_cvt_pk_bf16_f32 v10, v8, v9
    v_fmamk_f32 v6, v5, 0x41800000, v4
    v_sin_f32 v7, -v6
    v_cos_f32 v6, v6
    v_accvgpr_write_b32 a127, v10
    v_cvt_pk_bf16_f32 v10, v6, v7
    v_fmamk_f32 v8, v5, 0x41880000, v4
    v_sin_f32 v9, -v8
    v_cos_f32 v8, v8
    v_accvgpr_write_b32 a128, v10
    v_cvt_pk_bf16_f32 v10, v8, v9
    v_fmamk_f32 v6, v5, 0x41900000, v4
    v_sin_f32 v7, -v6
    v_cos_f32 v6, v6
    v_accvgpr_write_b32 a129, v10
    v_cvt_pk_bf16_f32 v10, v6, v7
    v_fmamk_f32 v8, v5, 0x41980000, v4
    v_sin_f32 v9, -v8
    v_cos_f32 v8, v8
    v_accvgpr_write_b32 a130, v10
    v_cvt_pk_bf16_f32 v10, v8, v9
    v_fmamk_f32 v6, v5, 0x41c00000, v4
    v_sin_f32 v7, -v6
    v_cos_f32 v6, v6
    v_accvgpr_write_b32 a131, v10
    v_cvt_pk_bf16_f32 v10, v6, v7
    v_fmamk_f32 v8, v5, 0x41c80000, v4
    v_sin_f32 v9, -v8
    v_cos_f32 v8, v8
    v_accvgpr_write_b32 a132, v10
    v_cvt_pk_bf16_f32 v10, v8, v9
    v_fmamk_f32 v6, v5, 0x41d00000, v4
    v_sin_f32 v7, -v6
    v_cos_f32 v6, v6
    v_accvgpr_write_b32 a133, v10
    v_cvt_pk_bf16_f32 v10, v6, v7
    v_fmamk_f32 v8, v5, 0x41d80000, v4
    v_sin_f32 v9, -v8
    v_cos_f32 v8, v8
    v_accvgpr_write_b32 a134, v10
    v_cvt_pk_bf16_f32 v10, v8, v9
    v_fmamk_f32 v6, v5, 0x42000000, v4
    v_sin_f32 v7, -v6
    v_cos_f32 v6, v6
    v_accvgpr_write_b32 a135, v10
    v_cvt_pk_bf16_f32 v10, v6, v7
    v_fmamk_f32 v8, v5, 0x42040000, v4
    v_sin_f32 v9, -v8
    v_cos_f32 v8, v8
    v_accvgpr_write_b32 a136, v10
    v_cvt_pk_bf16_f32 v10, v8, v9
    v_fmamk_f32 v6, v5, 0x42080000, v4
    v_sin_f32 v7, -v6
    v_cos_f32 v6, v6
    v_accvgpr_write_b32 a137, v10
    v_cvt_pk_bf16_f32 v10, v6, v7
    v_fmamk_f32 v8, v5, 0x420c0000, v4
    v_sin_f32 v9, -v8
    v_cos_f32 v8, v8
    v_accvgpr_write_b32 a138, v10
    v_cvt_pk_bf16_f32 v10, v8, v9
    v_fmamk_f32 v6, v5, 0x42200000, v4
    v_sin_f32 v7, -v6
    v_cos_f32 v6, v6
    v_accvgpr_write_b32 a139, v10
    v_cvt_pk_bf16_f32 v10, v6, v7
    v_fmamk_f32 v8, v5, 0x42240000, v4
    v_sin_f32 v9, -v8
    v_cos_f32 v8, v8
    v_accvgpr_write_b32 a140, v10
    v_cvt_pk_bf16_f32 v10, v8, v9
    v_fmamk_f32 v6, v5, 0x42280000, v4
    v_sin_f32 v7, -v6
    v_cos_f32 v6, v6
    v_accvgpr_write_b32 a141, v10
    v_cvt_pk_bf16_f32 v10, v6, v7
    v_fmamk_f32 v8, v5, 0x422c0000, v4
    v_sin_f32 v9, -v8
    v_cos_f32 v8, v8
    v_accvgpr_write_b32 a142, v10
    v_cvt_pk_bf16_f32 v10, v8, v9
    v_fmamk_f32 v6, v5, 0x42400000, v4
    v_sin_f32 v7, -v6
    v_cos_f32 v6, v6
    v_accvgpr_write_b32 a143, v10
    v_cvt_pk_bf16_f32 v10, v6, v7
    v_fmamk_f32 v8, v5, 0x42440000, v4
    v_sin_f32 v9, -v8
    v_cos_f32 v8, v8
    v_accvgpr_write_b32 a144, v10
    v_cvt_pk_bf16_f32 v10, v8, v9
    v_fmamk_f32 v6, v5, 0x42480000, v4
    v_sin_f32 v7, -v6
    v_cos_f32 v6, v6
    v_accvgpr_write_b32 a145, v10
    v_cvt_pk_bf16_f32 v10, v6, v7
    v_fmamk_f32 v8, v5, 0x424c0000, v4
    v_sin_f32 v9, -v8
    v_cos_f32 v8, v8
    v_accvgpr_write_b32 a146, v10
    v_cvt_pk_bf16_f32 v10, v8, v9
    v_fmamk_f32 v6, v5, 0x42600000, v4
    v_sin_f32 v7, -v6
    v_cos_f32 v6, v6
    v_accvgpr_write_b32 a147, v10
    v_cvt_pk_bf16_f32 v10, v6, v7
    v_fmamk_f32 v8, v5, 0x42640000, v4
    v_sin_f32 v9, -v8
    v_cos_f32 v8, v8
    v_accvgpr_write_b32 a148, v10
    v_cvt_pk_bf16_f32 v10, v8, v9
    v_fmamk_f32 v6, v5, 0x42680000, v4
    v_sin_f32 v7, -v6
    v_cos_f32 v6, v6
    v_accvgpr_write_b32 a149, v10
    v_cvt_pk_bf16_f32 v10, v6, v7
    v_fmamk_f32 v8, v5, 0x426c0000, v4
    v_sin_f32 v9, -v8
    v_cos_f32 v8, v8
    v_accvgpr_write_b32 a150, v10
    v_cvt_pk_bf16_f32 v10, v8, v9
    v_fmamk_f32 v6, v5, 0x42800000, v4
    v_sin_f32 v7, -v6
    v_cos_f32 v6, v6
    v_accvgpr_write_b32 a151, v10
    v_cvt_pk_bf16_f32 v10, v6, v7
    v_fmamk_f32 v8, v5, 0x42820000, v4
    v_sin_f32 v9, -v8
    v_cos_f32 v8, v8
    v_accvgpr_write_b32 a152, v10
    v_cvt_pk_bf16_f32 v10, v8, v9
    v_fmamk_f32 v6, v5, 0x42840000, v4
    v_sin_f32 v7, -v6
    v_cos_f32 v6, v6
    v_accvgpr_write_b32 a153, v10
    v_cvt_pk_bf16_f32 v10, v6, v7
    v_fmamk_f32 v8, v5, 0x42860000, v4
    v_sin_f32 v9, -v8
    v_cos_f32 v8, v8
    v_accvgpr_write_b32 a154, v10
    v_cvt_pk_bf16_f32 v10, v8, v9
    v_fmamk_f32 v6, v5, 0x42900000, v4
    v_sin_f32 v7, -v6
    v_cos_f32 v6, v6
    v_accvgpr_write_b32 a155, v10
    v_cvt_pk_bf16_f32 v10, v6, v7
    v_fmamk_f32 v8, v5, 0x42920000, v4
    v_sin_f32 v9, -v8
    v_cos_f32 v8, v8
    v_accvgpr_write_b32 a156, v10
    v_cvt_pk_bf16_f32 v10, v8, v9
    v_fmamk_f32 v6, v5, 0x42940000, v4
    v_sin_f32 v7, -v6
    v_cos_f32 v6, v6
    v_accvgpr_write_b32 a157, v10
    v_cvt_pk_bf16_f32 v10, v6, v7
    v_fmamk_f32 v8, v5, 0x42960000, v4
    v_sin_f32 v9, -v8
    v_cos_f32 v8, v8
    v_accvgpr_write_b32 a158, v10
    v_cvt_pk_bf16_f32 v10, v8, v9
    v_accvgpr_write_b32 a159, v10
    s_waitcnt vmcnt(0) lgkmcnt(0)
LAYER_126:
    s_cmp_ge_u32 s28, 160
    s_cbranch_scc1 R_127
    s_and_b32 s40, s29, 1
    s_lshr_b32 s41, s29, 1
    v_add_u32 v6, 0, v1
    v_min_u32 v6, 159, v6
    v_lshlrev_b32 v6, 4, v6
    v_add_u32 v7, 64, v1
    v_min_u32 v7, 159, v7
    v_lshlrev_b32 v7, 4, v7
    v_add_u32 v8, 128, v1
    v_min_u32 v8, 159, v8
    v_lshlrev_b32 v8, 4, v8
    s_mov_b32 s32, 0
    s_mov_b32 s48, 0
P_128:
    buffer_load_dword v2, v6, s[4:7], s32 offen sc1
    buffer_load_dword v3, v7, s[4:7], s32 offen sc1
    buffer_load_dword v4, v8, s[4:7], s32 offen sc1
    s_waitcnt vmcnt(0)
    v_min_u32 v2, v2, v3
    v_min_u32 v2, v2, v4
    v_cmp_gt_u32 vcc, 1, v2
    s_cbranch_vccz P_129
    s_add_u32 s48, s48, 1
    s_cmp_gt_u32 s48, 200000
    s_cbranch_scc1 L_end
    s_sleep 1
    s_branch P_128
P_129:
    s_lshl_b32 s34, s28, 1
    s_add_u32 s42, s34, s41
    s_lshl_b32 s34, s42, 4
    s_mul_i32 s35, s40, 1310720
    s_add_u32 s34, s34, s35
    s_add_u32 s34, s34, 8388608
    v_bfe_u32 v2, v1, 0, 5
    v_mul_u32_u24 v2, 40960, v2
    v_bfe_u32 v3, v1, 5, 1
    v_mul_u32_u24 v3, 20480, v3
    v_add_u32 v2, v2, v3
    s_add_u32 s35, s34, 0
    buffer_load_dwordx4 v[216:219], v2, s[4:7], s35 offen sc1
    s_add_u32 s35, s34, 5120
    buffer_load_dwordx4 v[220:223], v2, s[4:7], s35 offen sc1
    s_add_u32 s35, s34, 10240
    buffer_load_dwordx4 v[224:227], v2, s[4:7], s35 offen sc1
    s_add_u32 s35, s34, 15360
    buffer_load_dwordx4 v[228:231], v2, s[4:7], s35 offen sc1
    s_lshl_b32 s34, s40, 5
    v_bfe_u32 v3, v1, 0, 5
    v_add_u32 v3, s34, v3
    v_bfe_u32 v4, v1, 5, 1
    v_mul_u32_u24 v4, 4, v4
    v_bfe_u32 v5, v1, 0, 5
    v_add_u32 v7, 0, v4
    v_mul_u32_u24 v7, v7, v3
    v_cvt_f32_u32 v7, v7
    v_cvt_f32_u32 v8, v3
    v_mul_f32 v7, 0x3c800000, v7
    v_mul_f32 v8, 0x3c800000, v8
    v_fmamk_f32 v10, v8, 0x0, v7
    v_sin_f32 v12, v10
    v_cos_f32 v10, v10
    v_fmamk_f32 v11, v8, 0x3f800000, v7
    v_sin_f32 v13, v11
    v_cos_f32 v11, v11
    v_cvt_pk_bf16_f32 v32, v12, v13
    v_cvt_pk_bf16_f32 v16, v10, v11
    v_xor_b32 v48, 0x80008000, v32
    v_fmamk_f32 v10, v8, 0x40000000, v7
    v_sin_f32 v12, v10
    v_cos_f32 v10, v10
    v_fmamk_f32 v11, v8, 0x40400000, v7
    v_sin_f32 v13, v11
    v_cos_f32 v11, v11
    v_cvt_pk_bf16_f32 v33, v12, v13
    v_cvt_pk_bf16_f32 v17, v10, v11
    v_xor_b32 v49, 0x80008000, v33
    v_fmamk_f32 v10, v8, 0x41000000, v7
    v_sin_f32 v12, v10
    v_cos_f32 v10, v10
    v_fmamk_f32 v11, v8, 0x41100000, v7
    v_sin_f32 v13, v11
    v_cos_f32 v11, v11
    v_cvt_pk_bf16_f32 v34, v12, v13
    v_cvt_pk_bf16_f32 v18, v10, v11
    v_xor_b32 v50, 0x80008000, v34
    v_fmamk_f32 v10, v8, 0x41200000, v7
    v_sin_f32 v12, v10
    v_cos_f32 v10, v10
    v_fmamk_f32 v11, v8, 0x41300000, v7
    v_sin_f32 v13, v11
    v_cos_f32 v11, v11
    v_cvt_pk_bf16_f32 v35, v12, v13
    v_cvt_pk_bf16_f32 v19, v10, v11
    v_xor_b32 v51, 0x80008000, v35
    v_fmamk_f32 v10, v8, 0x41800000, v7
    v_sin_f32 v12, v10
    v_cos_f32 v10, v10
    v_fmamk_f32 v11, v8, 0x41880000, v7
    v_sin_f32 v13, v11
    v_cos_f32 v11, v11
    v_cvt_pk_bf16_f32 v36, v12, v13
    v_cvt_pk_bf16_f32 v20, v10, v11
    v_xor_b32 v52, 0x80008000, v36
    v_fmamk_f32 v10, v8, 0x41900000, v7
    v_sin_f32 v12, v10
    v_cos_f32 v10, v10
    v_fmamk_f32 v11, v8, 0x41980000, v7
    v_sin_f32 v13, v11
    v_cos_f32 v11, v11
    v_cvt_pk_bf16_f32 v37, v12, v13
    v_cvt_pk_bf16_f32 v21, v10, v11
    v_xor_b32 v53, 0x80008000, v37
    v_fmamk_f32 v10, v8, 0x41c00000, v7
    v_sin_f32 v12, v10
    v_cos_f32 v10, v10
    v_fmamk_f32 v11, v8, 0x41c80000, v7
    v_sin_f32 v13, v11
    v_cos_f32 v11, v11
    v_cvt_pk_bf16_f32 v38, v12, v13
    v_cvt_pk_bf16_f32 v22, v10, v11
    v_xor_b32 v54, 0x80008000, v38
    v_fmamk_f32 v10, v8, 0x41d00000, v7
    v_sin_f32 v12, v10
    v_cos_f32 v10, v10
    v_fmamk_f32 v11, v8, 0x41d80000, v7
    v_sin_f32 v13, v11
    v_cos_f32 v11, v11
    v_cvt_pk_bf16_f32 v39, v12, v13
    v_cvt_pk_bf16_f32 v23, v10, v11
    v_xor_b32 v55, 0x80008000, v39
    v_fmamk_f32 v10, v8, 0x42000000, v7
    v_sin_f32 v12, v10
    v_cos_f32 v10, v10
    v_fmamk_f32 v11, v8, 0x42040000, v7
    v_sin_f32 v13, v11
    v_cos_f32 v11, v11
    v_cvt_pk_bf16_f32 v40, v12, v13
    v_cvt_pk_bf16_f32 v24, v10, v11
    v_xor_b32 v56, 0x80008000, v40
    v_fmamk_f32 v10, v8, 0x42080000, v7
    v_sin_f32 v12, v10
    v_cos_f32 v10, v10
    v_fmamk_f32 v11, v8, 0x420c0000, v7
    v_sin_f32 v13, v11
    v_cos_f32 v11, v11
    v_cvt_pk_bf16_f32 v41, v12, v13
    v_cvt_pk_bf16_f32 v25, v10, v11
    v_xor_b32 v57, 0x80008000, v41
    v_fmamk_f32 v10, v8, 0x42200000, v7
    v_sin_f32 v12, v10
    v_cos_f32 v10, v10
    v_fmamk_f32 v11, v8, 0x42240000, v7
    v_sin_f32 v13, v11
    v_cos_f32 v11, v11
    v_cvt_pk_bf16_f32 v42, v12, v13
    v_cvt_pk_bf16_f32 v26, v10, v11
    v_xor_b32 v58, 0x80008000, v42
    v_fmamk_f32 v10, v8, 0x42280000, v7
    v_sin_f32 v12, v10
    v_cos_f32 v10, v10
    v_fmamk_f32 v11, v8, 0x422c0000, v7
    v_sin_f32 v13, v11
    v_cos_f32 v11, v11
    v_cvt_pk_bf16_f32 v43, v12, v13
    v_cvt_pk_bf16_f32 v27, v10, v11
    v_xor_b32 v59, 0x80008000, v43
    v_fmamk_f32 v10, v8, 0x42400000, v7
    v_sin_f32 v12, v10
    v_cos_f32 v10, v10
    v_fmamk_f32 v11, v8, 0x42440000, v7
    v_sin_f32 v13, v11
    v_cos_f32 v11, v11
    v_cvt_pk_bf16_f32 v44, v12, v13
    v_cvt_pk_bf16_f32 v28, v10, v11
    v_xor_b32 v60, 0x80008000, v44
    v_fmamk_f32 v10, v8, 0x42480000, v7
    v_sin_f32 v12, v10
    v_cos_f32 v10, v10
    v_fmamk_f32 v11, v8, 0x424c0000, v7
    v_sin_f32 v13, v11
    v_cos_f32 v11, v11
    v_cvt_pk_bf16_f32 v45, v12, v13
    v_cvt_pk_bf16_f32 v29, v10, v11
    v_xor_b32 v61, 0x80008000, v45
    v_fmamk_f32 v10, v8, 0x42600000, v7
    v_sin_f32 v12, v10
    v_cos_f32 v10, v10
    v_fmamk_f32 v11, v8, 0x42640000, v7
    v_sin_f32 v13, v11
    v_cos_f32 v11, v11
    v_cvt_pk_bf16_f32 v46, v12, v13
    v_cvt_pk_bf16_f32 v30, v10, v11
    v_xor_b32 v62, 0x80008000, v46
    v_fmamk_f32 v10, v8, 0x42680000, v7
    v_sin_f32 v12, v10
    v_cos_f32 v10, v10
    v_fmamk_f32 v11, v8, 0x426c0000, v7
    v_sin_f32 v13, v11
    v_cos_f32 v11, v11
    v_cvt_pk_bf16_f32 v47, v12, v13
    v_cvt_pk_bf16_f32 v31, v10, v11
    v_xor_b32 v63, 0x80008000, v47
    v_add_u32 v7, 0, v4
    v_mul_u32_u24 v7, v7, v5
    v_cvt_f32_u32 v7, v7
    v_cvt_f32_u32 v8, v5
    v_mul_f32 v7, 0x3d000000, v7
    v_mul_f32 v8, 0x3d000000, v8
    v_fmamk_f32 v10, v8, 0x0, v7
    v_sin_f32 v12, v10
    v_cos_f32 v10, v10
    v_fmamk_f32 v11, v8, 0x3f800000, v7
    v_sin_f32 v13, v11
    v_cos_f32 v11, v11
    v_cvt_pk_bf16_f32 v72, v12, v13
    v_cvt_pk_bf16_f32 v64, v10, v11
    v_xor_b32 v80, 0x80008000, v72
    v_fmamk_f32 v10, v8, 0x40000000, v7
    v_sin_f32 v12, v10
    v_cos_f32 v10, v10
    v_fmamk_f32 v11, v8, 0x40400000, v7
    v_sin_f32 v13, v11
    v_cos_f32 v11, v11
    v_cvt_pk_bf16_f32 v73, v12, v13
    v_cvt_pk_bf16_f32 v65, v10, v11
    v_xor_b32 v81, 0x80008000, v73
    v_fmamk_f32 v10, v8, 0x41000000, v7
    v_sin_f32 v12, v10
    v_cos_f32 v10, v10
    v_fmamk_f32 v11, v8, 0x41100000, v7
    v_sin_f32 v13, v11
    v_cos_f32 v11, v11
    v_cvt_pk_bf16_f32 v74, v12, v13
    v_cvt_pk_bf16_f32 v66, v10, v11
    v_xor_b32 v82, 0x80008000, v74
    v_fmamk_f32 v10, v8, 0x41200000, v7
    v_sin_f32 v12, v10
    v_cos_f32 v10, v10
    v_fmamk_f32 v11, v8, 0x41300000, v7
    v_sin_f32 v13, v11
    v_cos_f32 v11, v11
    v_cvt_pk_bf16_f32 v75, v12, v13
    v_cvt_pk_bf16_f32 v67, v10, v11
    v_xor_b32 v83, 0x80008000, v75
    v_fmamk_f32 v10, v8, 0x41800000, v7
    v_sin_f32 v12, v10
    v_cos_f32 v10, v10
    v_fmamk_f32 v11, v8, 0x41880000, v7
    v_sin_f32 v13, v11
    v_cos_f32 v11, v11
    v_cvt_pk_bf16_f32 v76, v12, v13
    v_cvt_pk_bf16_f32 v68, v10, v11
    v_xor_b32 v84, 0x80008000, v76
    v_fmamk_f32 v10, v8, 0x41900000, v7
    v_sin_f32 v12, v10
    v_cos_f32 v10, v10
    v_fmamk_f32 v11, v8, 0x41980000, v7
    v_sin_f32 v13, v11
    v_cos_f32 v11, v11
    v_cvt_pk_bf16_f32 v77, v12, v13
    v_cvt_pk_bf16_f32 v69, v10, v11
    v_xor_b32 v85, 0x80008000, v77
    v_fmamk_f32 v10, v8, 0x41c00000, v7
    v_sin_f32 v12, v10
    v_cos_f32 v10, v10
    v_fmamk_f32 v11, v8, 0x41c80000, v7
    v_sin_f32 v13, v11
    v_cos_f32 v11, v11
    v_cvt_pk_bf16_f32 v78, v12, v13
    v_cvt_pk_bf16_f32 v70, v10, v11
    v_xor_b32 v86, 0x80008000, v78
    v_fmamk_f32 v10, v8, 0x41d00000, v7
    v_sin_f32 v12, v10
    v_cos_f32 v10, v10
    v_fmamk_f32 v11, v8, 0x41d80000, v7
    v_sin_f32 v13, v11
    v_cos_f32 v11, v11
    v_cvt_pk_bf16_f32 v79, v12, v13
    v_cvt_pk_bf16_f32 v71, v10, v11
    v_xor_b32 v87, 0x80008000, v79
    v_add_u32 v7, 0, v4
    v_mul_u32_u24 v7, v7, v3
    v_cvt_f32_u32 v7, v7
    v_cvt_f32_u32 v8, v3
    v_mul_f32 v7, 0x3a000000, v7
    v_mul_f32 v8, 0x3a000000, v8
    v_fmamk_f32 v88, v8, 0x0, v7
    v_sin_f32 v104, v88
    v_cos_f32 v88, v88
    v_fmamk_f32 v89, v8, 0x3f800000, v7
    v_sin_f32 v105, v89
    v_cos_f32 v89, v89
    v_fmamk_f32 v90, v8, 0x40000000, v7
    v_sin_f32 v106, v90
    v_cos_f32 v90, v90
    v_fmamk_f32 v91, v8, 0x40400000, v7
    v_sin_f32 v107, v91
    v_cos_f32 v91, v91
    v_fmamk_f32 v92, v8, 0x41000000, v7
    v_sin_f32 v108, v92
    v_cos_f32 v92, v92
    v_fmamk_f32 v93, v8, 0x41100000, v7
    v_sin_f32 v109, v93
    v_cos_f32 v93, v93
    v_fmamk_f32 v94, v8, 0x41200000, v7
    v_sin_f32 v110, v94
    v_cos_f32 v94, v94
    v_fmamk_f32 v95, v8, 0x41300000, v7
    v_sin_f32 v111, v95
    v_cos_f32 v95, v95
    v_fmamk_f32 v96, v8, 0x41800000, v7
    v_sin_f32 v112, v96
    v_cos_f32 v96, v96
    v_fmamk_f32 v97, v8, 0x41880000, v7
    v_sin_f32 v113, v97
    v_cos_f32 v97, v97
    v_fmamk_f32 v98, v8, 0x41900000, v7
    v_sin_f32 v114, v98
    v_cos_f32 v98, v98
    v_fmamk_f32 v99, v8, 0x41980000, v7
    v_sin_f32 v115, v99
    v_cos_f32 v99, v99
    v_fmamk_f32 v100, v8, 0x41c00000, v7
    v_sin_f32 v116, v100
    v_cos_f32 v100, v100
    v_fmamk_f32 v101, v8, 0x41c80000, v7
    v_sin_f32 v117, v101
    v_cos_f32 v101, v101
    v_fmamk_f32 v102, v8, 0x41d00000, v7
    v_sin_f32 v118, v102
    v_cos_f32 v102, v102
    v_fmamk_f32 v103, v8, 0x41d80000, v7
    v_sin_f32 v119, v103
    v_cos_f32 v103, v103
    v_add_u32 v7, s34, v4
    v_mul_u32_u24 v7, v7, v5
    v_cvt_f32_u32 v7, v7
    v_cvt_f32_u32 v8, v5
    v_mul_f32 v7, 0x3a000000, v7
    v_mul_f32 v8, 0x3a000000, v8
    v_fmamk_f32 v120, v8, 0x0, v7
    v_sin_f32 v136, v120
    v_cos_f32 v120, v120
    v_fmamk_f32 v121, v8, 0x3f800000, v7
    v_sin_f32 v137, v121
    v_cos_f32 v121, v121
    v_fmamk_f32 v122, v8, 0x40000000, v7
    v_sin_f32 v138, v122
    v_cos_f32 v122, v122
    v_fmamk_f32 v123, v8, 0x40400000, v7
    v_sin_f32 v139, v123
    v_cos_f32 v123, v123
    v_fmamk_f32 v124, v8, 0x41000000, v7
    v_sin_f32 v140, v124
    v_cos_f32 v124, v124
    v_fmamk_f32 v125, v8, 0x41100000, v7
    v_sin_f32 v141, v125
    v_cos_f32 v125, v125
    v_fmamk_f32 v126, v8, 0x41200000, v7
    v_sin_f32 v142, v126
    v_cos_f32 v126, v126
    v_fmamk_f32 v127, v8, 0x41300000, v7
    v_sin_f32 v143, v127
    v_cos_f32 v127, v127
    v_fmamk_f32 v128, v8, 0x41800000, v7
    v_sin_f32 v144, v128
    v_cos_f32 v128, v128
    v_fmamk_f32 v129, v8, 0x41880000, v7
    v_sin_f32 v145, v129
    v_cos_f32 v129, v129
    v_fmamk_f32 v130, v8, 0x41900000, v7
    v_sin_f32 v146, v130
    v_cos_f32 v130, v130
    v_fmamk_f32 v131, v8, 0x41980000, v7
    v_sin_f32 v147, v131
    v_cos_f32 v131, v131
    v_fmamk_f32 v132, v8, 0x41c00000, v7
    v_sin_f32 v148, v132
    v_cos_f32 v132, v132
    v_fmamk_f32 v133, v8, 0x41c80000, v7
    v_sin_f32 v149, v133
    v_cos_f32 v133, v133
    v_fmamk_f32 v134, v8, 0x41d00000, v7
    v_sin_f32 v150, v134
    v_cos_f32 v134, v134
    v_fmamk_f32 v135, v8, 0x41d80000, v7
    v_sin_f32 v151, v135
    v_cos_f32 v135, v135
    s_mov_b32 s36, 0x35cccccd
    s_cmp_eq_u32 s42, 319
    s_cselect_b32 s35, 0x354ccccd, s36
    s_waitcnt vmcnt(3)
    v_lshlrev_b32 v152, 16, v216
    v_and_b32 v168, 0xffff0000, v216
    v_mul_f32 v152, s35, v152
    v_mul_f32 v168, s35, v168
    v_lshlrev_b32 v153, 16, v217
    v_and_b32 v169, 0xffff0000, v217
    v_mul_f32 v153, s35, v153
    v_mul_f32 v169, s35, v169
    v_lshlrev_b32 v154, 16, v218
    v_and_b32 v170, 0xffff0000, v218
    v_mul_f32 v154, s35, v154
    v_mul_f32 v170, s35, v170
    v_lshlrev_b32 v155, 16, v219
    v_and_b32 v171, 0xffff0000, v219
    v_mul_f32 v155, s35, v155
    v_mul_f32 v171, s35, v171
    s_waitcnt vmcnt(2)
    v_lshlrev_b32 v156, 16, v220
    v_and_b32 v172, 0xffff0000, v220
    v_mul_f32 v156, s35, v156
    v_mul_f32 v172, s35, v172
    v_lshlrev_b32 v157, 16, v221
    v_and_b32 v173, 0xffff0000, v221
    v_mul_f32 v157, s35, v157
    v_mul_f32 v173, s35, v173
    v_lshlrev_b32 v158, 16, v222
    v_and_b32 v174, 0xffff0000, v222
    v_mul_f32 v158, s35, v158
    v_mul_f32 v174, s35, v174
    v_lshlrev_b32 v159, 16, v223
    v_and_b32 v175, 0xffff0000, v223
    v_mul_f32 v159, s35, v159
    v_mul_f32 v175, s35, v175
    s_waitcnt vmcnt(1)
    v_lshlrev_b32 v160, 16, v224
    v_and_b32 v176, 0xffff0000, v224
    v_mul_f32 v160, s35, v160
    v_mul_f32 v176, s35, v176
    v_lshlrev_b32 v161, 16, v225
    v_and_b32 v177, 0xffff0000, v225
    v_mul_f32 v161, s35, v161
    v_mul_f32 v177, s35, v177
    v_lshlrev_b32 v162, 16, v226
    v_and_b32 v178, 0xffff0000, v226
    v_mul_f32 v162, s35, v162
    v_mul_f32 v178, s35, v178
    v_lshlrev_b32 v163, 16, v227
    v_and_b32 v179, 0xffff0000, v227
    v_mul_f32 v163, s35, v163
    v_mul_f32 v179, s35, v179
    s_waitcnt vmcnt(0)
    v_lshlrev_b32 v164, 16, v228
    v_and_b32 v180, 0xffff0000, v228
    v_mul_f32 v164, s35, v164
    v_mul_f32 v180, s35, v180
    v_lshlrev_b32 v165, 16, v229
    v_and_b32 v181, 0xffff0000, v229
    v_mul_f32 v165, s35, v165
    v_mul_f32 v181, s35, v181
    v_lshlrev_b32 v166, 16, v230
    v_and_b32 v182, 0xffff0000, v230
    v_mul_f32 v166, s35, v166
    v_mul_f32 v182, s35, v182
    v_lshlrev_b32 v167, 16, v231
    v_and_b32 v183, 0xffff0000, v231
    v_mul_f32 v167, s35, v167
    v_mul_f32 v183, s35, v183
    v_bfe_u32 v2, v1, 4, 2
    v_mul_u32_u24 v2, 64, v2
    v_xor_b32 v2, v2, v0
    v_and_b32 v2, 255, v2
    v_bfe_u32 v8, v1, 4, 2
    v_mul_u32_u24 v8, 40960, v8
    v_add_u32 v2, v2, v8
    s_lshl_b32 s34, s41, 7
    v_bfe_u32 v3, v1, 4, 1
    v_mul_u32_u24 v3, 32, v3
    v_bfe_u32 v7, v1, 0, 2
    v_lshl_add_u32 v3, v7, 3, v3
    v_add_u32 v3, s34, v3
    v_bfe_u32 v8, v1, 2, 2
    v_mul_u32_u24 v8, 64, v8
    v_xor_b32 v3, v3, v8
    v_bfe_u32 v8, v1, 5, 1
    v_mul_u32_u24 v8, 1024, v8
    v_bfe_u32 v7, v1, 2, 2
    v_lshl_add_u32 v8, v7, 8, v8
    v_add_u32 v3, v3, v8
    v_xor_b32 v6, 64, v3
    s_cmp_lg_u32 s30, 0
    s_cbranch_scc1 F2_130
    v_add_u32 v12, 0, v1
    v_min_u32 v12, 189, v12
    v_lshlrev_b32 v12, 4, v12
    v_add_u32 v13, 64, v1
    v_min_u32 v13, 189, v13
    v_lshlrev_b32 v13, 4, v13
    v_add_u32 v14, 128, v1
    v_min_u32 v14, 189, v14
    v_lshlrev_b32 v14, 4, v14
    s_mov_b32 s32, 4096
    s_mov_b32 s48, 0
P_132:
    buffer_load_dword v8, v12, s[4:7], s32 offen sc1
    buffer_load_dword v9, v13, s[4:7], s32 offen sc1
    buffer_load_dword v10, v14, s[4:7], s32 offen sc1
    s_waitcnt vmcnt(0)
    v_min_u32 v8, v8, v9
    v_min_u32 v8, v8, v10
    v_cmp_gt_u32 vcc, 1, v8
    s_cbranch_vccz P_133
    s_add_u32 s48, s48, 1
    s_cmp_gt_u32 s48, 200000
    s_cbranch_scc1 L_end
    s_sleep 1
    s_branch P_132
P_133:
    s_branch F2_131
F2_130:
    v_add_u32 v12, 0, v1
    v_min_u32 v12, 19, v12
    v_lshlrev_b32 v12, 4, v12
    s_mov_b32 s32, 6336
    s_mov_b32 s48, 0
P_134:
    buffer_load_dword v8, v12, s[4:7], s32 offen sc1
    s_waitcnt vmcnt(0)
    v_cmp_gt_u32 vcc, 2, v8
    s_cbranch_vccz P_135
    s_add_u32 s48, s48, 1
    s_cmp_gt_u32 s48, 200000
    s_cbranch_scc1 L_end
    s_sleep 1
    s_branch P_134
P_135:
F2_131:
    s_mul_i32 s34, s30, 3145728
    s_add_u32 s34, s34, 20971520
    s_lshl_b32 s35, s28, 8
    s_mul_i32 s36, s29, 655360
    s_add_u32 s43, s35, s36
    s_add_u32 s34, s34, s43
    s_lshl_b32 s35, s29, 12
    s_add_u32 m0, s35, 0
    s_add_u32 s36, s34, 0
    buffer_load_dwordx4 v2, s[4:7], s36 offen sc1 lds
    s_add_u32 m0, s35, 1024
    s_add_u32 s36, s34, 163840
    buffer_load_dwordx4 v2, s[4:7], s36 offen sc1 lds
    s_add_u32 m0, s35, 2048
    s_add_u32 s36, s34, 327680
    buffer_load_dwordx4 v2, s[4:7], s36 offen sc1 lds
    s_add_u32 m0, s35, 3072
    s_add_u32 s36, s34, 491520
    buffer_load_dwordx4 v2, s[4:7], s36 offen sc1 lds
    s_lshl_b32 s34, s29, 12
    s_add_u32 s34, s34, 16384
    v_add_u32 v4, s34, v0
    s_lshl_b32 s34, s41, 13
    s_add_u32 s34, s34, 16384
    v_bfe_u32 v7, v1, 0, 2
    v_mul_u32_u24 v7, 16, v7
    v_bfe_u32 v8, v1, 2, 1
    v_lshl_add_u32 v7, v8, 7, v7
    v_bfe_u32 v8, v1, 3, 1
    v_lshl_add_u32 v7, v8, 6, v7
    v_bfe_u32 v8, v1, 4, 2
    v_lshl_add_u32 v7, v8, 8, v7
    v_add_u32 v7, s34, v7
    s_lshl_b32 s34, s41, 7
    v_bfe_u32 v5, v1, 5, 1
    v_mul_u32_u24 v5, 16, v5
    v_add_u32 v5, s34, v5
    v_bfe_u32 v9, v1, 0, 3
    v_mul_u32_u24 v9, 16, v9
    v_xor_b32 v5, v5, v9
    s_lshl_b32 s34, s40, 13
    s_add_u32 s34, s34, 32768
    v_bfe_u32 v9, v1, 0, 5
    v_mul_u32_u24 v9, 256, v9
    v_add_u32 v9, s34, v9
    v_add_u32 v5, v5, v9
    s_waitcnt vmcnt(0)
    s_barrier
    ds_read_b64_tr_b16 v[216:217], v3 offset:0
    ds_read_b64_tr_b16 v[232:233], v6 offset:0
    ds_read_b64_tr_b16 v[218:219], v3 offset:2048
    ds_read_b64_tr_b16 v[234:235], v6 offset:2048
    ds_read_b64_tr_b16 v[220:221], v3 offset:4096
    ds_read_b64_tr_b16 v[236:237], v6 offset:4096
    ds_read_b64_tr_b16 v[222:223], v3 offset:6144
    ds_read_b64_tr_b16 v[238:239], v6 offset:6144
    ds_read_b64_tr_b16 v[224:225], v3 offset:8192
    ds_read_b64_tr_b16 v[240:241], v6 offset:8192
    ds_read_b64_tr_b16 v[226:227], v3 offset:10240
    ds_read_b64_tr_b16 v[242:243], v6 offset:10240
    ds_read_b64_tr_b16 v[228:229], v3 offset:12288
    ds_read_b64_tr_b16 v[244:245], v6 offset:12288
    ds_read_b64_tr_b16 v[230:231], v3 offset:14336
    ds_read_b64_tr_b16 v[246:247], v6 offset:14336
    s_waitcnt lgkmcnt(13)
    v_mfma_f32_32x32x16_bf16 v[184:199], v[216:219], v[16:19], 0
    s_waitcnt lgkmcnt(12)
    v_mfma_f32_32x32x16_bf16 v[200:215], v[232:235], v[16:19], 0
    v_mfma_f32_32x32x16_bf16 v[184:199], v[232:235], v[32:35], v[184:199]
    v_mfma_f32_32x32x16_bf16 v[200:215], v[216:219], v[48:51], v[200:215]
    s_waitcnt lgkmcnt(9)
    v_mfma_f32_32x32x16_bf16 v[184:199], v[220:223], v[20:23], v[184:199]
    s_waitcnt lgkmcnt(8)
    v_mfma_f32_32x32x16_bf16 v[200:215], v[236:239], v[20:23], v[200:215]
    v_mfma_f32_32x32x16_bf16 v[184:199], v[236:239], v[36:39], v[184:199]
    v_mfma_f32_32x32x16_bf16 v[200:215], v[220:223], v[52:55], v[200:215]
    s_waitcnt lgkmcnt(5)
    v_mfma_f32_32x32x16_bf16 v[184:199], v[224:227], v[24:27], v[184:199]
    s_waitcnt lgkmcnt(4)
    v_mfma_f32_32x32x16_bf16 v[200:215], v[240:243], v[24:27], v[200:215]
    v_mfma_f32_32x32x16_bf16 v[184:199], v[240:243], v[40:43], v[184:199]
    v_mfma_f32_32x32x16_bf16 v[200:215], v[224:227], v[56:59], v[200:215]
    s_waitcnt lgkmcnt(1)
    v_mfma_f32_32x32x16_bf16 v[184:199], v[228:231], v[28:31], v[184:199]
    s_waitcnt lgkmcnt(0)
    v_mfma_f32_32x32x16_bf16 v[200:215], v[244:247], v[28:31], v[200:215]
    v_mfma_f32_32x32x16_bf16 v[184:199], v[244:247], v[44:47], v[184:199]
    v_mfma_f32_32x32x16_bf16 v[200:215], v[228:231], v[60:63], v[200:215]
    s_nop 3
    v_mul_f32 v10, v184, v88
    s_nop 6
    v_mul_f32 v12, v200, v88
    v_fma_f32 v10, v200, v104, v10
    v_fma_f32 v12, -v184, v104, v12
    v_mul_f32 v11, v185, v89
    v_mul_f32 v13, v201, v89
    v_fma_f32 v11, v201, v105, v11
    v_fma_f32 v13, -v185, v105, v13
    v_cvt_pk_bf16_f32 v216, v10, v11
    v_cvt_pk_bf16_f32 v232, v12, v13
    v_mul_f32 v10, v186, v90
    v_mul_f32 v12, v202, v90
    v_fma_f32 v10, v202, v106, v10
    v_fma_f32 v12, -v186, v106, v12
    v_mul_f32 v11, v187, v91
    v_mul_f32 v13, v203, v91
    v_fma_f32 v11, v203, v107, v11
    v_fma_f32 v13, -v187, v107, v13
    v_cvt_pk_bf16_f32 v217, v10, v11
    v_cvt_pk_bf16_f32 v233, v12, v13
    v_mul_f32 v10, v188, v92
    v_mul_f32 v12, v204, v92
    v_fma_f32 v10, v204, v108, v10
    v_fma_f32 v12, -v188, v108, v12
    v_mul_f32 v11, v189, v93
    v_mul_f32 v13, v205, v93
    v_fma_f32 v11, v205, v109, v11
    v_fma_f32 v13, -v189, v109, v13
    v_cvt_pk_bf16_f32 v218, v10, v11
    v_cvt_pk_bf16_f32 v234, v12, v13
    v_mul_f32 v10, v190, v94
    v_mul_f32 v12, v206, v94
    v_fma_f32 v10, v206, v110, v10
    v_fma_f32 v12, -v190, v110, v12
    v_mul_f32 v11, v191, v95
    v_mul_f32 v13, v207, v95
    v_fma_f32 v11, v207, v111, v11
    v_fma_f32 v13, -v191, v111, v13
    v_cvt_pk_bf16_f32 v219, v10, v11
    v_cvt_pk_bf16_f32 v235, v12, v13
    v_mul_f32 v10, v192, v96
    v_mul_f32 v12, v208, v96
    v_fma_f32 v10, v208, v112, v10
    v_fma_f32 v12, -v192, v112, v12
    v_mul_f32 v11, v193, v97
    v_mul_f32 v13, v209, v97
    v_fma_f32 v11, v209, v113, v11
    v_fma_f32 v13, -v193, v113, v13
    v_cvt_pk_bf16_f32 v220, v10, v11
    v_cvt_pk_bf16_f32 v236, v12, v13
    v_mul_f32 v10, v194, v98
    v_mul_f32 v12, v210, v98
    v_fma_f32 v10, v210, v114, v10
    v_fma_f32 v12, -v194, v114, v12
    v_mul_f32 v11, v195, v99
    v_mul_f32 v13, v211, v99
    v_fma_f32 v11, v211, v115, v11
    v_fma_f32 v13, -v195, v115, v13
    v_cvt_pk_bf16_f32 v221, v10, v11
    v_cvt_pk_bf16_f32 v237, v12, v13
    v_mul_f32 v10, v196, v100
    v_mul_f32 v12, v212, v100
    v_fma_f32 v10, v212, v116, v10
    v_fma_f32 v12, -v196, v116, v12
    v_mul_f32 v11, v197, v101
    v_mul_f32 v13, v213, v101
    v_fma_f32 v11, v213, v117, v11
    v_fma_f32 v13, -v197, v117, v13
    v_cvt_pk_bf16_f32 v222, v10, v11
    v_cvt_pk_bf16_f32 v238, v12, v13
    v_mul_f32 v10, v198, v102
    v_mul_f32 v12, v214, v102
    v_fma_f32 v10, v214, v118, v10
    v_fma_f32 v12, -v198, v118, v12
    v_mul_f32 v11, v199, v103
    v_mul_f32 v13, v215, v103
    v_fma_f32 v11, v215, v119, v11
    v_fma_f32 v13, -v199, v119, v13
    v_cvt_pk_bf16_f32 v223, v10, v11
    v_cvt_pk_bf16_f32 v239, v12, v13
    v_mfma_f32_32x32x16_bf16 v[184:199], v[64:67], v[216:219], 0
    v_mfma_f32_32x32x16_bf16 v[200:215], v[64:67], v[232:235], 0
    v_mfma_f32_32x32x16_bf16 v[184:199], v[72:75], v[232:235], v[184:199]
    v_mfma_f32_32x32x16_bf16 v[200:215], v[80:83], v[216:219], v[200:215]
    v_mfma_f32_32x32x16_bf16 v[184:199], v[68:71], v[220:223], v[184:199]
    v_mfma_f32_32x32x16_bf16 v[200:215], v[68:71], v[236:239], v[200:215]
    v_mfma_f32_32x32x16_bf16 v[184:199], v[76:79], v[236:239], v[184:199]
    v_mfma_f32_32x32x16_bf16 v[200:215], v[84:87], v[220:223], v[200:215]
    s_nop 3
    v_mul_f32 v10, v184, v152
    s_nop 6
    v_mul_f32 v12, v200, v152
    v_fma_f32 v10, -v200, v168, v10
    v_fma_f32 v12, v184, v168, v12
    v_mul_f32 v11, v185, v153
    v_mul_f32 v13, v201, v153
    v_fma_f32 v11, -v201, v169, v11
    v_fma_f32 v13, v185, v169, v13
    v_cvt_pk_bf16_f32 v216, v10, v11
    v_cvt_pk_bf16_f32 v232, v12, v13
    v_mul_f32 v10, v186, v154
    v_mul_f32 v12, v202, v154
    v_fma_f32 v10, -v202, v170, v10
    v_fma_f32 v12, v186, v170, v12
    v_mul_f32 v11, v187, v155
    v_mul_f32 v13, v203, v155
    v_fma_f32 v11, -v203, v171, v11
    v_fma_f32 v13, v187, v171, v13
    v_cvt_pk_bf16_f32 v217, v10, v11
    v_cvt_pk_bf16_f32 v233, v12, v13
    v_mul_f32 v10, v188, v156
    v_mul_f32 v12, v204, v156
    v_fma_f32 v10, -v204, v172, v10
    v_fma_f32 v12, v188, v172, v12
    v_mul_f32 v11, v189, v157
    v_mul_f32 v13, v205, v157
    v_fma_f32 v11, -v205, v173, v11
    v_fma_f32 v13, v189, v173, v13
    v_cvt_pk_bf16_f32 v218, v10, v11
    v_cvt_pk_bf16_f32 v234, v12, v13
    v_mul_f32 v10, v190, v158
    v_mul_f32 v12, v206, v158
    v_fma_f32 v10, -v206, v174, v10
    v_fma_f32 v12, v190, v174, v12
    v_mul_f32 v11, v191, v159
    v_mul_f32 v13, v207, v159
    v_fma_f32 v11, -v207, v175, v11
    v_fma_f32 v13, v191, v175, v13
    v_cvt_pk_bf16_f32 v219, v10, v11
    v_cvt_pk_bf16_f32 v235, v12, v13
    v_mul_f32 v10, v192, v160
    v_mul_f32 v12, v208, v160
    v_fma_f32 v10, -v208, v176, v10
    v_fma_f32 v12, v192, v176, v12
    v_mul_f32 v11, v193, v161
    v_mul_f32 v13, v209, v161
    v_fma_f32 v11, -v209, v177, v11
    v_fma_f32 v13, v193, v177, v13
    v_cvt_pk_bf16_f32 v220, v10, v11
    v_cvt_pk_bf16_f32 v236, v12, v13
    v_mul_f32 v10, v194, v162
    v_mul_f32 v12, v210, v162
    v_fma_f32 v10, -v210, v178, v10
    v_fma_f32 v12, v194, v178, v12
    v_mul_f32 v11, v195, v163
    v_mul_f32 v13, v211, v163
    v_fma_f32 v11, -v211, v179, v11
    v_fma_f32 v13, v195, v179, v13
    v_cvt_pk_bf16_f32 v221, v10, v11
    v_cvt_pk_bf16_f32 v237, v12, v13
    v_mul_f32 v10, v196, v164
    v_mul_f32 v12, v212, v164
    v_fma_f32 v10, -v212, v180, v10
    v_fma_f32 v12, v196, v180, v12
    v_mul_f32 v11, v197, v165
    v_mul_f32 v13, v213, v165
    v_fma_f32 v11, -v213, v181, v11
    v_fma_f32 v13, v197, v181, v13
    v_cvt_pk_bf16_f32 v222, v10, v11
    v_cvt_pk_bf16_f32 v238, v12, v13
    v_mul_f32 v10, v198, v166
    v_mul_f32 v12, v214, v166
    v_fma_f32 v10, -v214, v182, v10
    v_fma_f32 v12, v198, v182, v12
    v_mul_f32 v11, v199, v167
    v_mul_f32 v13, v215, v167
    v_fma_f32 v11, -v215, v183, v11
    v_fma_f32 v13, v199, v183, v13
    v_cvt_pk_bf16_f32 v223, v10, v11
    v_cvt_pk_bf16_f32 v239, v12, v13
    v_mfma_f32_32x32x16_bf16 v[184:199], v[216:219], v[64:67], 0
    v_mfma_f32_32x32x16_bf16 v[200:215], v[232:235], v[64:67], 0
    v_mfma_f32_32x32x16_bf16 v[184:199], v[232:235], v[80:83], v[184:199]
    v_mfma_f32_32x32x16_bf16 v[200:215], v[216:219], v[72:75], v[200:215]
    v_mfma_f32_32x32x16_bf16 v[184:199], v[220:223], v[68:71], v[184:199]
    v_mfma_f32_32x32x16_bf16 v[200:215], v[236:239], v[68:71], v[200:215]
    v_mfma_f32_32x32x16_bf16 v[184:199], v[236:239], v[84:87], v[184:199]
    v_mfma_f32_32x32x16_bf16 v[200:215], v[220:223], v[76:79], v[200:215]
    s_nop 3
    v_mul_f32 v10, v184, v120
    s_nop 6
    v_mul_f32 v12, v200, v120
    v_fma_f32 v10, -v200, v136, v10
    v_fma_f32 v12, v184, v136, v12
    v_mul_f32 v11, v185, v121
    v_mul_f32 v13, v201, v121
    v_fma_f32 v11, -v201, v137, v11
    v_fma_f32 v13, v185, v137, v13
    v_cvt_pk_bf16_f32 v216, v10, v11
    v_cvt_pk_bf16_f32 v232, v12, v13
    v_mul_f32 v10, v186, v122
    v_mul_f32 v12, v202, v122
    v_fma_f32 v10, -v202, v138, v10
    v_fma_f32 v12, v186, v138, v12
    v_mul_f32 v11, v187, v123
    v_mul_f32 v13, v203, v123
    v_fma_f32 v11, -v203, v139, v11
    v_fma_f32 v13, v187, v139, v13
    v_cvt_pk_bf16_f32 v217, v10, v11
    v_cvt_pk_bf16_f32 v233, v12, v13
    v_mul_f32 v10, v188, v124
    v_mul_f32 v12, v204, v124
    v_fma_f32 v10, -v204, v140, v10
    v_fma_f32 v12, v188, v140, v12
    v_mul_f32 v11, v189, v125
    v_mul_f32 v13, v205, v125
    v_fma_f32 v11, -v205, v141, v11
    v_fma_f32 v13, v189, v141, v13
    v_cvt_pk_bf16_f32 v218, v10, v11
    v_cvt_pk_bf16_f32 v234, v12, v13
    v_mul_f32 v10, v190, v126
    v_mul_f32 v12, v206, v126
    v_fma_f32 v10, -v206, v142, v10
    v_fma_f32 v12, v190, v142, v12
    v_mul_f32 v11, v191, v127
    v_mul_f32 v13, v207, v127
    v_fma_f32 v11, -v207, v143, v11
    v_fma_f32 v13, v191, v143, v13
    v_cvt_pk_bf16_f32 v219, v10, v11
    v_cvt_pk_bf16_f32 v235, v12, v13
    v_mul_f32 v10, v192, v128
    v_mul_f32 v12, v208, v128
    v_fma_f32 v10, -v208, v144, v10
    v_fma_f32 v12, v192, v144, v12
    v_mul_f32 v11, v193, v129
    v_mul_f32 v13, v209, v129
    v_fma_f32 v11, -v209, v145, v11
    v_fma_f32 v13, v193, v145, v13
    v_cvt_pk_bf16_f32 v220, v10, v11
    v_cvt_pk_bf16_f32 v236, v12, v13
    v_mul_f32 v10, v194, v130
    v_mul_f32 v12, v210, v130
    v_fma_f32 v10, -v210, v146, v10
    v_fma_f32 v12, v194, v146, v12
    v_mul_f32 v11, v195, v131
    v_mul_f32 v13, v211, v131
    v_fma_f32 v11, -v211, v147, v11
    v_fma_f32 v13, v195, v147, v13
    v_cvt_pk_bf16_f32 v221, v10, v11
    v_cvt_pk_bf16_f32 v237, v12, v13
    v_mul_f32 v10, v196, v132
    v_mul_f32 v12, v212, v132
    v_fma_f32 v10, -v212, v148, v10
    v_fma_f32 v12, v196, v148, v12
    v_mul_f32 v11, v197, v133
    v_mul_f32 v13, v213, v133
    v_fma_f32 v11, -v213, v149, v11
    v_fma_f32 v13, v197, v149, v13
    v_cvt_pk_bf16_f32 v222, v10, v11
    v_cvt_pk_bf16_f32 v238, v12, v13
    v_mul_f32 v10, v198, v134
    v_mul_f32 v12, v214, v134
    v_fma_f32 v10, -v214, v150, v10
    v_fma_f32 v12, v198, v150, v12
    v_mul_f32 v11, v199, v135
    v_mul_f32 v13, v215, v135
    v_fma_f32 v11, -v215, v151, v11
    v_fma_f32 v13, v199, v151, v13
    v_cvt_pk_bf16_f32 v223, v10, v11
    v_cvt_pk_bf16_f32 v239, v12, v13
    ds_write_b128 v4, v[216:219] offset:0
    ds_write_b128 v4, v[220:223] offset:1024
    ds_write_b128 v4, v[232:235] offset:2048
    ds_write_b128 v4, v[236:239] offset:3072
    s_waitcnt lgkmcnt(0)
    s_barrier
    ds_read_b128 v[216:219], v7 offset:0
    ds_read_b128 v[232:235], v7 offset:2048
    ds_read_b128 v[220:223], v7 offset:1024
    ds_read_b128 v[236:239], v7 offset:3072
    ds_read_b128 v[224:227], v7 offset:4096
    ds_read_b128 v[240:243], v7 offset:6144
    ds_read_b128 v[228:231], v7 offset:5120
    ds_read_b128 v[244:247], v7 offset:7168
    s_waitcnt lgkmcnt(7)
    v_mfma_f32_32x32x16_bf16 v[184:199], v[216:219], v[16:19], 0
    s_waitcnt lgkmcnt(6)
    v_mfma_f32_32x32x16_bf16 v[200:215], v[232:235], v[16:19], 0
    v_mfma_f32_32x32x16_bf16 v[184:199], v[232:235], v[48:51], v[184:199]
    v_mfma_f32_32x32x16_bf16 v[200:215], v[216:219], v[32:35], v[200:215]
    s_waitcnt lgkmcnt(5)
    v_mfma_f32_32x32x16_bf16 v[184:199], v[220:223], v[20:23], v[184:199]
    s_waitcnt lgkmcnt(4)
    v_mfma_f32_32x32x16_bf16 v[200:215], v[236:239], v[20:23], v[200:215]
    v_mfma_f32_32x32x16_bf16 v[184:199], v[236:239], v[52:55], v[184:199]
    v_mfma_f32_32x32x16_bf16 v[200:215], v[220:223], v[36:39], v[200:215]
    s_waitcnt lgkmcnt(3)
    v_mfma_f32_32x32x16_bf16 v[184:199], v[224:227], v[24:27], v[184:199]
    s_waitcnt lgkmcnt(2)
    v_mfma_f32_32x32x16_bf16 v[200:215], v[240:243], v[24:27], v[200:215]
    v_mfma_f32_32x32x16_bf16 v[184:199], v[240:243], v[56:59], v[184:199]
    v_mfma_f32_32x32x16_bf16 v[200:215], v[224:227], v[40:43], v[200:215]
    s_waitcnt lgkmcnt(1)
    v_mfma_f32_32x32x16_bf16 v[184:199], v[228:231], v[28:31], v[184:199]
    s_waitcnt lgkmcnt(0)
    v_mfma_f32_32x32x16_bf16 v[200:215], v[244:247], v[28:31], v[200:215]
    v_mfma_f32_32x32x16_bf16 v[184:199], v[244:247], v[60:63], v[184:199]
    v_mfma_f32_32x32x16_bf16 v[200:215], v[228:231], v[44:47], v[200:215]
    v_bfe_u32 v2, v1, 4, 2
    v_mul_u32_u24 v2, 16, v2
    v_xor_b32 v2, v2, v0
    s_lshl_b32 s34, s29, 12
    s_add_u32 s34, s34, 32768
    v_add_u32 v2, s34, v2
    v_xor_b32 v6, 64, v2
    v_bfe_u32 v3, v1, 4, 2
    v_mul_u32_u24 v3, 40960, v3
    v_bfe_u32 v8, v1, 0, 4
    v_lshl_add_u32 v3, v8, 4, v3
    v_cvt_pk_bf16_f32 v216, v184, v185
    v_cvt_pk_bf16_f32 v217, v186, v187
    v_cvt_pk_bf16_f32 v218, v188, v189
    v_cvt_pk_bf16_f32 v219, v190, v191
    v_xor_b32 v10, 0, v5
    ds_write_b128 v10, v[216:219]
    v_cvt_pk_bf16_f32 v220, v192, v193
    v_cvt_pk_bf16_f32 v221, v194, v195
    v_cvt_pk_bf16_f32 v222, v196, v197
    v_cvt_pk_bf16_f32 v223, v198, v199
    v_xor_b32 v11, 32, v5
    ds_write_b128 v11, v[220:223]
    v_cvt_pk_bf16_f32 v224, v200, v201
    v_cvt_pk_bf16_f32 v225, v202, v203
    v_cvt_pk_bf16_f32 v226, v204, v205
    v_cvt_pk_bf16_f32 v227, v206, v207
    v_xor_b32 v12, 64, v5
    ds_write_b128 v12, v[224:227]
    v_cvt_pk_bf16_f32 v228, v208, v209
    v_cvt_pk_bf16_f32 v229, v210, v211
    v_cvt_pk_bf16_f32 v230, v212, v213
    v_cvt_pk_bf16_f32 v231, v214, v215
    v_xor_b32 v13, 96, v5
    ds_write_b128 v13, v[228:231]
    s_mul_i32 s34, s30, 3145728
    s_add_u32 s34, s34, 27262976
    s_add_u32 s34, s34, s43
    s_waitcnt lgkmcnt(0)
    s_barrier
    ds_read_b128 v[232:235], v2 offset:0
    ds_read_b128 v[236:239], v6 offset:1024
    ds_read_b128 v[240:243], v2 offset:2048
    ds_read_b128 v[244:247], v6 offset:3072
    s_add_u32 s36, s34, 0
    s_waitcnt lgkmcnt(3)
    buffer_store_dwordx4 v[232:235], v3, s[4:7], s36 offen sc1
    s_add_u32 s36, s34, 163840
    s_waitcnt lgkmcnt(2)
    buffer_store_dwordx4 v[236:239], v3, s[4:7], s36 offen sc1
    s_add_u32 s36, s34, 327680
    s_waitcnt lgkmcnt(1)
    buffer_store_dwordx4 v[240:243], v3, s[4:7], s36 offen sc1
    s_add_u32 s36, s34, 491520
    s_waitcnt lgkmcnt(0)
    buffer_store_dwordx4 v[244:247], v3, s[4:7], s36 offen sc1
    s_add_u32 s57, s30, 1
    s_waitcnt vmcnt(0)
    s_barrier
    s_cmp_lg_u32 s29, 0
    s_cbranch_scc1 F_136
    s_lshl_b32 s32, s28, 2
    s_add_u32 s32, s32, s29
    s_lshl_b32 s32, s32, 2
    s_add_u32 s32, s32, 8192
    v_mov_b32 v8, s57
    s_mov_b64 exec, 1
    buffer_store_dword v8, off, s[4:7], s32 sc1
    s_mov_b64 exec, -1
F_136:
R_127:
    s_cmp_ge_u32 s28, 190
    s_cbranch_scc1 R_137
    s_mov_b32 s44, s66
    s_mov_b32 s47, 19
    s_mul_i32 s50, s30, 3145728
    s_add_u32 s50, s50, 27262976
    s_mul_i32 s34, s29, 10240
    s_add_u32 s50, s50, s34
    s_mul_i32 s51, s30, 6291456
    s_add_u32 s51, s51, 11534336
    s_lshl_b32 s34, s67, 12
    s_add_u32 s51, s51, s34
    s_add_u32 s52, s34, 14680064
    s_mov_b32 s58, 40960
    v_bfe_u32 v2, v1, 5, 1
    v_mul_u32_u24 v2, 512, v2
    v_bfe_u32 v172, v1, 2, 2
    v_lshl_add_u32 v2, v172, 6, v2
    v_bfe_u32 v172, v1, 4, 1
    v_lshl_add_u32 v2, v172, 5, v2
    v_bfe_u32 v172, v1, 0, 1
    v_lshl_add_u32 v2, v172, 4, v2
    v_bfe_u32 v172, v1, 1, 1
    v_lshl_add_u32 v2, v172, 3, v2
    v_add_u32 v2, s60, v2
    s_lshl_b32 s34, s29, 13
    v_add_u32 v4, s34, v0
    s_lshl_b32 s34, s29, 3
    s_add_u32 s34, s34, 65536
    v_bfe_u32 v5, v1, 0, 5
    v_mul_u32_u24 v5, 32, v5
    v_add_u32 v5, s34, v5
    s_lshl_b32 s35, s29, 11
    s_lshl_b32 s36, s29, 8
    s_add_u32 s36, s36, 67584
    v_add_u32 v3, s35, v0
    s_lshl_b32 s34, s29, 10
    v_add_u32 v7, s34, v0
    v_bfe_u32 v6, v1, 0, 5
    v_mul_u32_u24 v6, 32, v6
    v_add_u32 v6, 65536, v6
    s_lshl_b32 s34, s29, 5
    v_bfe_u32 v8, v1, 0, 2
    v_mul_u32_u24 v8, 1280, v8
    v_bfe_u32 v172, v1, 2, 1
    v_mul_u32_u24 v172, 10240, v172
    v_add_u32 v8, v8, v172
    v_bfe_u32 v172, v1, 3, 1
    v_mul_u32_u24 v172, 5120, v172
    v_add_u32 v8, v8, v172
    v_bfe_u32 v172, v1, 4, 1
    v_mul_u32_u24 v172, 20480, v172
    v_add_u32 v8, v8, v172
    v_bfe_u32 v172, v1, 5, 1
    v_lshl_add_u32 v8, v172, 4, v8
    v_add_u32 v8, s34, v8
    s_add_u32 s57, s30, 1
    s_mul_i32 s37, s29, 40
    v_add_u32 v176, 0, v1
    v_min_u32 v176, 39, v176
    v_lshlrev_b32 v176, 4, v176
    s_lshl_b32 s32, s37, 4
    s_add_u32 s32, s32, 8192
    s_mov_b32 s48, 0
P_140:
    buffer_load_dword v172, v176, s[4:7], s32 offen sc1
    s_waitcnt vmcnt(0)
    v_cmp_gt_u32 vcc, s57, v172
    s_cbranch_vccz P_141
    s_add_u32 s48, s48, 1
    s_cmp_gt_u32 s48, 200000
    s_cbranch_scc1 L_end
    s_sleep 1
    s_branch P_140
P_141:
    s_cmp_lg_u32 s30, 0
    s_cbranch_scc1 F3_138
    s_lshl_b32 s52, s67, 7
    s_mul_i32 s54, s44, 40960
    s_add_u32 s56, s54, s52
    s_add_u32 s54, s54, s50
    s_waitcnt vmcnt(0) lgkmcnt(0)
    s_add_u32 m0, s60, 0
    s_nop 0
    buffer_load_dwordx4 v0, s[4:7], s54 offen offset:0 sc1 lds
    buffer_load_dwordx4 v0, s[4:7], s54 offen offset:1024 sc1 lds
    buffer_load_dwordx4 v0, s[4:7], s54 offen offset:2048 sc1 lds
    buffer_load_dwordx4 v0, s[4:7], s54 offen offset:3072 sc1 lds
    s_add_u32 s54, s54, 4096
    s_add_u32 m0, s60, 4096
    s_nop 0
    buffer_load_dwordx4 v0, s[4:7], s54 offen offset:0 sc1 lds
    buffer_load_dwordx4 v0, s[4:7], s54 offen offset:1024 sc1 lds
    buffer_load_dwordx4 v0, s[4:7], s54 offen offset:2048 sc1 lds
    buffer_load_dwordx4 v0, s[4:7], s54 offen offset:3072 sc1 lds
    s_add_u32 s54, s54, 4096
    s_add_u32 m0, s60, 8192
    s_nop 0
    buffer_load_dwordx4 v0, s[4:7], s54 offen offset:0 sc1 lds
    buffer_load_dwordx4 v0, s[4:7], s54 offen offset:1024 sc1 lds
    buffer_load_dwordx4 v[164:167], v8, s[8:11], s56 offen
    buffer_load_dword v179, off, s[8:11], 0
G_142:
    s_add_u32 s45, s44, s47
    s_cmp_lt_u32 s45, 64
    s_cbranch_scc0 G_144
    s_mul_i32 s54, s45, 40960
    s_add_u32 s56, s54, s52
    s_add_u32 s54, s54, s50
    s_waitcnt vmcnt(1)
    ds_read_b64_tr_b16 v[16:17], v2 offset:0
    ds_read_b64_tr_b16 v[18:19], v2 offset:256
    ds_read_b64_tr_b16 v[20:21], v2 offset:1024
    ds_read_b64_tr_b16 v[22:23], v2 offset:1280
    ds_read_b64_tr_b16 v[24:25], v2 offset:2048
    ds_read_b64_tr_b16 v[26:27], v2 offset:2304
    ds_read_b64_tr_b16 v[28:29], v2 offset:3072
    ds_read_b64_tr_b16 v[30:31], v2 offset:3328
    ds_read_b64_tr_b16 v[32:33], v2 offset:4096
    ds_read_b64_tr_b16 v[34:35], v2 offset:4352
    ds_read_b64_tr_b16 v[36:37], v2 offset:5120
    ds_read_b64_tr_b16 v[38:39], v2 offset:5376
    ds_read_b64_tr_b16 v[40:41], v2 offset:6144
    ds_read_b64_tr_b16 v[42:43], v2 offset:6400
    ds_read_b64_tr_b16 v[44:45], v2 offset:7168
    ds_read_b64_tr_b16 v[46:47], v2 offset:7424
    ds_read_b64_tr_b16 v[48:49], v2 offset:8192
    ds_read_b64_tr_b16 v[50:51], v2 offset:8448
    ds_read_b64_tr_b16 v[52:53], v2 offset:9216
    ds_read_b64_tr_b16 v[54:55], v2 offset:9472
    s_waitcnt lgkmcnt(15)
    v_mfma_f32_32x32x16_bf16 v[96:111], a[80:83], v[16:19], 0
    v_mfma_f32_32x32x16_bf16 v[112:127], a[120:123], v[16:19], 0
    s_add_u32 m0, s60, 10240
    s_nop 0
    buffer_load_dwordx4 v0, s[4:7], s54 offen offset:0 sc1 lds
    v_mfma_f32_32x32x16_bf16 v[96:111], a[84:87], v[20:23], v[96:111]
    v_mfma_f32_32x32x16_bf16 v[112:127], a[124:127], v[20:23], v[112:127]
    buffer_load_dwordx4 v0, s[4:7], s54 offen offset:1024 sc1 lds
    s_waitcnt lgkmcnt(14)
    v_mfma_f32_32x32x16_bf16 v[96:111], a[88:91], v[24:27], v[96:111]
    v_mfma_f32_32x32x16_bf16 v[112:127], a[128:131], v[24:27], v[112:127]
    buffer_load_dwordx4 v0, s[4:7], s54 offen offset:2048 sc1 lds
    s_waitcnt lgkmcnt(12)
    v_mfma_f32_32x32x16_bf16 v[96:111], a[92:95], v[28:31], v[96:111]
    v_mfma_f32_32x32x16_bf16 v[112:127], a[132:135], v[28:31], v[112:127]
    buffer_load_dwordx4 v0, s[4:7], s54 offen offset:3072 sc1 lds
    s_waitcnt lgkmcnt(10)
    v_mfma_f32_32x32x16_bf16 v[96:111], a[96:99], v[32:35], v[96:111]
    v_mfma_f32_32x32x16_bf16 v[112:127], a[136:139], v[32:35], v[112:127]
    s_add_u32 s54, s54, 4096
    s_add_u32 m0, s60, 14336
    s_nop 0
    buffer_load_dwordx4 v0, s[4:7], s54 offen offset:0 sc1 lds
    s_waitcnt lgkmcnt(8)
    v_mfma_f32_32x32x16_bf16 v[96:111], a[100:103], v[36:39], v[96:111]
    v_mfma_f32_32x32x16_bf16 v[112:127], a[140:143], v[36:39], v[112:127]
    buffer_load_dwordx4 v0, s[4:7], s54 offen offset:1024 sc1 lds
    s_waitcnt lgkmcnt(6)
    v_mfma_f32_32x32x16_bf16 v[96:111], a[104:107], v[40:43], v[96:111]
    v_mfma_f32_32x32x16_bf16 v[112:127], a[144:147], v[40:43], v[112:127]
    buffer_load_dwordx4 v0, s[4:7], s54 offen offset:2048 sc1 lds
    s_waitcnt lgkmcnt(4)
    v_mfma_f32_32x32x16_bf16 v[96:111], a[108:111], v[44:47], v[96:111]
    v_mfma_f32_32x32x16_bf16 v[112:127], a[148:151], v[44:47], v[112:127]
    buffer_load_dwordx4 v0, s[4:7], s54 offen offset:3072 sc1 lds
    s_waitcnt lgkmcnt(2)
    v_mfma_f32_32x32x16_bf16 v[96:111], a[112:115], v[48:51], v[96:111]
    v_mfma_f32_32x32x16_bf16 v[112:127], a[152:155], v[48:51], v[112:127]
    s_add_u32 s54, s54, 4096
    s_add_u32 m0, s60, 18432
    s_nop 0
    buffer_load_dwordx4 v0, s[4:7], s54 offen offset:0 sc1 lds
    s_waitcnt lgkmcnt(0)
    v_mfma_f32_32x32x16_bf16 v[96:111], a[116:119], v[52:55], v[96:111]
    v_mfma_f32_32x32x16_bf16 v[112:127], a[156:159], v[52:55], v[112:127]
    buffer_load_dwordx4 v0, s[4:7], s54 offen offset:1024 sc1 lds
    buffer_load_dwordx4 v[168:171], v8, s[8:11], s56 offen
    s_mul_i32 s55, s44, s58
    s_add_u32 s55, s55, s51
    ds_write_b128 v4, v[96:99] offset:0
    ds_write_b128 v4, v[100:103] offset:1024
    ds_write_b128 v4, v[104:107] offset:2048
    ds_write_b128 v4, v[108:111] offset:3072
    s_nop 3
    ds_write_b128 v4, v[112:115] offset:4096
    ds_write_b128 v4, v[116:119] offset:5120
    ds_write_b128 v4, v[120:123] offset:6144
    ds_write_b128 v4, v[124:127] offset:7168
    s_waitcnt vmcnt(11)
    s_waitcnt lgkmcnt(0)
    s_barrier
    ds_read_b128 v[96:99], v3 offset:0
    ds_read_b128 v[100:103], v3 offset:1024
    ds_read_b128 v[104:107], v3 offset:8192
    ds_read_b128 v[108:111], v3 offset:9216
    ds_read_b128 v[112:115], v3 offset:16384
    ds_read_b128 v[116:119], v3 offset:17408
    ds_read_b128 v[120:123], v3 offset:24576
    ds_read_b128 v[124:127], v3 offset:25600
    s_waitcnt lgkmcnt(5)
    v_pk_add_f32 v[96:97], v[96:97], v[104:105]
    v_pk_add_f32 v[98:99], v[98:99], v[106:107]
    s_waitcnt lgkmcnt(4)
    v_pk_add_f32 v[100:101], v[100:101], v[108:109]
    v_pk_add_f32 v[102:103], v[102:103], v[110:111]
    s_waitcnt lgkmcnt(3)
    v_pk_add_f32 v[96:97], v[96:97], v[112:113]
    v_pk_add_f32 v[98:99], v[98:99], v[114:115]
    s_waitcnt lgkmcnt(2)
    v_pk_add_f32 v[100:101], v[100:101], v[116:117]
    v_pk_add_f32 v[102:103], v[102:103], v[118:119]
    s_waitcnt lgkmcnt(1)
    v_pk_add_f32 v[96:97], v[96:97], v[120:121]
    v_pk_add_f32 v[98:99], v[98:99], v[122:123]
    s_waitcnt lgkmcnt(0)
    v_pk_add_f32 v[100:101], v[100:101], v[124:125]
    v_pk_add_f32 v[102:103], v[102:103], v[126:127]
    v_cvt_pk_bf16_f32 v172, v96, v97
    v_cvt_pk_bf16_f32 v173, v98, v99
    v_cvt_pk_bf16_f32 v174, v100, v101
    v_cvt_pk_bf16_f32 v175, v102, v103
    v_lshlrev_b32 v96, 16, v172
    v_lshlrev_b32 v97, 16, v164
    v_and_b32 v98, 0xffff0000, v172
    v_and_b32 v99, 0xffff0000, v164
    v_add_f32 v96, v96, v97
    v_add_f32 v98, v98, v99
    v_cvt_pk_bf16_f32 v172, v96, v98
    v_lshlrev_b32 v96, 16, v173
    v_lshlrev_b32 v97, 16, v165
    v_and_b32 v98, 0xffff0000, v173
    v_and_b32 v99, 0xffff0000, v165
    v_add_f32 v96, v96, v97
    v_add_f32 v98, v98, v99
    v_cvt_pk_bf16_f32 v173, v96, v98
    v_lshlrev_b32 v96, 16, v174
    v_lshlrev_b32 v97, 16, v166
    v_and_b32 v98, 0xffff0000, v174
    v_and_b32 v99, 0xffff0000, v166
    v_add_f32 v96, v96, v97
    v_add_f32 v98, v98, v99
    v_cvt_pk_bf16_f32 v174, v96, v98
    v_lshlrev_b32 v96, 16, v175
    v_lshlrev_b32 v97, 16, v167
    v_and_b32 v98, 0xffff0000, v175
    v_and_b32 v99, 0xffff0000, v167
    v_add_f32 v96, v96, v97
    v_add_f32 v98, v98, v99
    v_cvt_pk_bf16_f32 v175, v96, v98
    buffer_store_dwordx4 v[172:175], v7, s[4:7], s55 offen sc1
    s_mov_b32 s44, s45
    s_add_u32 s45, s44, s47
    s_cmp_lt_u32 s45, 64
    s_cbranch_scc0 G_145
    s_mul_i32 s54, s45, 40960
    s_add_u32 s56, s54, s52
    s_add_u32 s54, s54, s50
    s_waitcnt vmcnt(1)
    ds_read_b64_tr_b16 v[56:57], v2 offset:10240
    ds_read_b64_tr_b16 v[58:59], v2 offset:10496
    ds_read_b64_tr_b16 v[60:61], v2 offset:11264
    ds_read_b64_tr_b16 v[62:63], v2 offset:11520
    ds_read_b64_tr_b16 v[64:65], v2 offset:12288
    ds_read_b64_tr_b16 v[66:67], v2 offset:12544
    ds_read_b64_tr_b16 v[68:69], v2 offset:13312
    ds_read_b64_tr_b16 v[70:71], v2 offset:13568
    ds_read_b64_tr_b16 v[72:73], v2 offset:14336
    ds_read_b64_tr_b16 v[74:75], v2 offset:14592
    ds_read_b64_tr_b16 v[76:77], v2 offset:15360
    ds_read_b64_tr_b16 v[78:79], v2 offset:15616
    ds_read_b64_tr_b16 v[80:81], v2 offset:16384
    ds_read_b64_tr_b16 v[82:83], v2 offset:16640
    ds_read_b64_tr_b16 v[84:85], v2 offset:17408
    ds_read_b64_tr_b16 v[86:87], v2 offset:17664
    ds_read_b64_tr_b16 v[88:89], v2 offset:18432
    ds_read_b64_tr_b16 v[90:91], v2 offset:18688
    ds_read_b64_tr_b16 v[92:93], v2 offset:19456
    ds_read_b64_tr_b16 v[94:95], v2 offset:19712
    s_waitcnt lgkmcnt(15)
    v_mfma_f32_32x32x16_bf16 v[96:111], a[80:83], v[56:59], 0
    v_mfma_f32_32x32x16_bf16 v[112:127], a[120:123], v[56:59], 0
    s_add_u32 m0, s60, 0
    s_nop 0
    buffer_load_dwordx4 v0, s[4:7], s54 offen offset:0 sc1 lds
    v_mfma_f32_32x32x16_bf16 v[96:111], a[84:87], v[60:63], v[96:111]
    v_mfma_f32_32x32x16_bf16 v[112:127], a[124:127], v[60:63], v[112:127]
    buffer_load_dwordx4 v0, s[4:7], s54 offen offset:1024 sc1 lds
    s_waitcnt lgkmcnt(14)
    v_mfma_f32_32x32x16_bf16 v[96:111], a[88:91], v[64:67], v[96:111]
    v_mfma_f32_32x32x16_bf16 v[112:127], a[128:131], v[64:67], v[112:127]
    buffer_load_dwordx4 v0, s[4:7], s54 offen offset:2048 sc1 lds
    s_waitcnt lgkmcnt(12)
    v_mfma_f32_32x32x16_bf16 v[96:111], a[92:95], v[68:71], v[96:111]
    v_mfma_f32_32x32x16_bf16 v[112:127], a[132:135], v[68:71], v[112:127]
    buffer_load_dwordx4 v0, s[4:7], s54 offen offset:3072 sc1 lds
    s_waitcnt lgkmcnt(10)
    v_mfma_f32_32x32x16_bf16 v[96:111], a[96:99], v[72:75], v[96:111]
    v_mfma_f32_32x32x16_bf16 v[112:127], a[136:139], v[72:75], v[112:127]
    s_add_u32 s54, s54, 4096
    s_add_u32 m0, s60, 4096
    s_nop 0
    buffer_load_dwordx4 v0, s[4:7], s54 offen offset:0 sc1 lds
    s_waitcnt lgkmcnt(8)
    v_mfma_f32_32x32x16_bf16 v[96:111], a[100:103], v[76:79], v[96:111]
    v_mfma_f32_32x32x16_bf16 v[112:127], a[140:143], v[76:79], v[112:127]
    buffer_load_dwordx4 v0, s[4:7], s54 offen offset:1024 sc1 lds
    s_waitcnt lgkmcnt(6)
    v_mfma_f32_32x32x16_bf16 v[96:111], a[104:107], v[80:83], v[96:111]
    v_mfma_f32_32x32x16_bf16 v[112:127], a[144:147], v[80:83], v[112:127]
    buffer_load_dwordx4 v0, s[4:7], s54 offen offset:2048 sc1 lds
    s_waitcnt lgkmcnt(4)
    v_mfma_f32_32x32x16_bf16 v[96:111], a[108:111], v[84:87], v[96:111]
    v_mfma_f32_32x32x16_bf16 v[112:127], a[148:151], v[84:87], v[112:127]
    buffer_load_dwordx4 v0, s[4:7], s54 offen offset:3072 sc1 lds
    s_waitcnt lgkmcnt(2)
    v_mfma_f32_32x32x16_bf16 v[96:111], a[112:115], v[88:91], v[96:111]
    v_mfma_f32_32x32x16_bf16 v[112:127], a[152:155], v[88:91], v[112:127]
    s_add_u32 s54, s54, 4096
    s_add_u32 m0, s60, 8192
    s_nop 0
    buffer_load_dwordx4 v0, s[4:7], s54 offen offset:0 sc1 lds
    s_waitcnt lgkmcnt(0)
    v_mfma_f32_32x32x16_bf16 v[96:111], a[116:119], v[92:95], v[96:111]
    v_mfma_f32_32x32x16_bf16 v[112:127], a[156:159], v[92:95], v[112:127]
    buffer_load_dwordx4 v0, s[4:7], s54 offen offset:1024 sc1 lds
    buffer_load_dwordx4 v[164:167], v8, s[8:11], s56 offen
    s_mul_i32 s55, s44, s58
    s_add_u32 s55, s55, s51
    ds_write_b128 v4, v[96:99] offset:32768
    ds_write_b128 v4, v[100:103] offset:33792
    ds_write_b128 v4, v[104:107] offset:34816
    ds_write_b128 v4, v[108:111] offset:35840
    s_nop 3
    ds_write_b128 v4, v[112:115] offset:36864
    ds_write_b128 v4, v[116:119] offset:37888
    ds_write_b128 v4, v[120:123] offset:38912
    ds_write_b128 v4, v[124:127] offset:39936
    s_waitcnt vmcnt(11)
    s_waitcnt lgkmcnt(0)
    s_barrier
    ds_read_b128 v[96:99], v3 offset:32768
    ds_read_b128 v[100:103], v3 offset:33792
    ds_read_b128 v[104:107], v3 offset:40960
    ds_read_b128 v[108:111], v3 offset:41984
    ds_read_b128 v[112:115], v3 offset:49152
    ds_read_b128 v[116:119], v3 offset:50176
    ds_read_b128 v[120:123], v3 offset:57344
    ds_read_b128 v[124:127], v3 offset:58368
    s_waitcnt lgkmcnt(5)
    v_pk_add_f32 v[96:97], v[96:97], v[104:105]
    v_pk_add_f32 v[98:99], v[98:99], v[106:107]
    s_waitcnt lgkmcnt(4)
    v_pk_add_f32 v[100:101], v[100:101], v[108:109]
    v_pk_add_f32 v[102:103], v[102:103], v[110:111]
    s_waitcnt lgkmcnt(3)
    v_pk_add_f32 v[96:97], v[96:97], v[112:113]
    v_pk_add_f32 v[98:99], v[98:99], v[114:115]
    s_waitcnt lgkmcnt(2)
    v_pk_add_f32 v[100:101], v[100:101], v[116:117]
    v_pk_add_f32 v[102:103], v[102:103], v[118:119]
    s_waitcnt lgkmcnt(1)
    v_pk_add_f32 v[96:97], v[96:97], v[120:121]
    v_pk_add_f32 v[98:99], v[98:99], v[122:123]
    s_waitcnt lgkmcnt(0)
    v_pk_add_f32 v[100:101], v[100:101], v[124:125]
    v_pk_add_f32 v[102:103], v[102:103], v[126:127]
    v_cvt_pk_bf16_f32 v172, v96, v97
    v_cvt_pk_bf16_f32 v173, v98, v99
    v_cvt_pk_bf16_f32 v174, v100, v101
    v_cvt_pk_bf16_f32 v175, v102, v103
    v_lshlrev_b32 v96, 16, v172
    v_lshlrev_b32 v97, 16, v168
    v_and_b32 v98, 0xffff0000, v172
    v_and_b32 v99, 0xffff0000, v168
    v_add_f32 v96, v96, v97
    v_add_f32 v98, v98, v99
    v_cvt_pk_bf16_f32 v172, v96, v98
    v_lshlrev_b32 v96, 16, v173
    v_lshlrev_b32 v97, 16, v169
    v_and_b32 v98, 0xffff0000, v173
    v_and_b32 v99, 0xffff0000, v169
    v_add_f32 v96, v96, v97
    v_add_f32 v98, v98, v99
    v_cvt_pk_bf16_f32 v173, v96, v98
    v_lshlrev_b32 v96, 16, v174
    v_lshlrev_b32 v97, 16, v170
    v_and_b32 v98, 0xffff0000, v174
    v_and_b32 v99, 0xffff0000, v170
    v_add_f32 v96, v96, v97
    v_add_f32 v98, v98, v99
    v_cvt_pk_bf16_f32 v174, v96, v98
    v_lshlrev_b32 v96, 16, v175
    v_lshlrev_b32 v97, 16, v171
    v_and_b32 v98, 0xffff0000, v175
    v_and_b32 v99, 0xffff0000, v171
    v_add_f32 v96, v96, v97
    v_add_f32 v98, v98, v99
    v_cvt_pk_bf16_f32 v175, v96, v98
    buffer_store_dwordx4 v[172:175], v7, s[4:7], s55 offen sc1
    s_mov_b32 s44, s45
    s_branch G_142
G_144:
    s_waitcnt vmcnt(1)
    ds_read_b64_tr_b16 v[16:17], v2 offset:0
    ds_read_b64_tr_b16 v[18:19], v2 offset:256
    ds_read_b64_tr_b16 v[20:21], v2 offset:1024
    ds_read_b64_tr_b16 v[22:23], v2 offset:1280
    ds_read_b64_tr_b16 v[24:25], v2 offset:2048
    ds_read_b64_tr_b16 v[26:27], v2 offset:2304
    ds_read_b64_tr_b16 v[28:29], v2 offset:3072
    ds_read_b64_tr_b16 v[30:31], v2 offset:3328
    ds_read_b64_tr_b16 v[32:33], v2 offset:4096
    ds_read_b64_tr_b16 v[34:35], v2 offset:4352
    ds_read_b64_tr_b16 v[36:37], v2 offset:5120
    ds_read_b64_tr_b16 v[38:39], v2 offset:5376
    ds_read_b64_tr_b16 v[40:41], v2 offset:6144
    ds_read_b64_tr_b16 v[42:43], v2 offset:6400
    ds_read_b64_tr_b16 v[44:45], v2 offset:7168
    ds_read_b64_tr_b16 v[46:47], v2 offset:7424
    ds_read_b64_tr_b16 v[48:49], v2 offset:8192
    ds_read_b64_tr_b16 v[50:51], v2 offset:8448
    ds_read_b64_tr_b16 v[52:53], v2 offset:9216
    ds_read_b64_tr_b16 v[54:55], v2 offset:9472
    s_waitcnt lgkmcnt(15)
    v_mfma_f32_32x32x16_bf16 v[96:111], a[80:83], v[16:19], 0
    v_mfma_f32_32x32x16_bf16 v[112:127], a[120:123], v[16:19], 0
    v_mfma_f32_32x32x16_bf16 v[96:111], a[84:87], v[20:23], v[96:111]
    v_mfma_f32_32x32x16_bf16 v[112:127], a[124:127], v[20:23], v[112:127]
    s_waitcnt lgkmcnt(14)
    v_mfma_f32_32x32x16_bf16 v[96:111], a[88:91], v[24:27], v[96:111]
    v_mfma_f32_32x32x16_bf16 v[112:127], a[128:131], v[24:27], v[112:127]
    s_waitcnt lgkmcnt(12)
    v_mfma_f32_32x32x16_bf16 v[96:111], a[92:95], v[28:31], v[96:111]
    v_mfma_f32_32x32x16_bf16 v[112:127], a[132:135], v[28:31], v[112:127]
    s_waitcnt lgkmcnt(10)
    v_mfma_f32_32x32x16_bf16 v[96:111], a[96:99], v[32:35], v[96:111]
    v_mfma_f32_32x32x16_bf16 v[112:127], a[136:139], v[32:35], v[112:127]
    s_waitcnt lgkmcnt(8)
    v_mfma_f32_32x32x16_bf16 v[96:111], a[100:103], v[36:39], v[96:111]
    v_mfma_f32_32x32x16_bf16 v[112:127], a[140:143], v[36:39], v[112:127]
    s_waitcnt lgkmcnt(6)
    v_mfma_f32_32x32x16_bf16 v[96:111], a[104:107], v[40:43], v[96:111]
    v_mfma_f32_32x32x16_bf16 v[112:127], a[144:147], v[40:43], v[112:127]
    s_waitcnt lgkmcnt(4)
    v_mfma_f32_32x32x16_bf16 v[96:111], a[108:111], v[44:47], v[96:111]
    v_mfma_f32_32x32x16_bf16 v[112:127], a[148:151], v[44:47], v[112:127]
    s_waitcnt lgkmcnt(2)
    v_mfma_f32_32x32x16_bf16 v[96:111], a[112:115], v[48:51], v[96:111]
    v_mfma_f32_32x32x16_bf16 v[112:127], a[152:155], v[48:51], v[112:127]
    s_waitcnt lgkmcnt(0)
    v_mfma_f32_32x32x16_bf16 v[96:111], a[116:119], v[52:55], v[96:111]
    v_mfma_f32_32x32x16_bf16 v[112:127], a[156:159], v[52:55], v[112:127]
    s_mul_i32 s55, s44, s58
    s_add_u32 s55, s55, s51
    s_nop 1
    ds_write_b128 v4, v[96:99] offset:0
    ds_write_b128 v4, v[100:103] offset:1024
    ds_write_b128 v4, v[104:107] offset:2048
    ds_write_b128 v4, v[108:111] offset:3072
    s_nop 3
    ds_write_b128 v4, v[112:115] offset:4096
    ds_write_b128 v4, v[116:119] offset:5120
    ds_write_b128 v4, v[120:123] offset:6144
    ds_write_b128 v4, v[124:127] offset:7168
    s_waitcnt vmcnt(0)
    s_waitcnt lgkmcnt(0)
    s_barrier
    ds_read_b128 v[96:99], v3 offset:0
    ds_read_b128 v[100:103], v3 offset:1024
    ds_read_b128 v[104:107], v3 offset:8192
    ds_read_b128 v[108:111], v3 offset:9216
    ds_read_b128 v[112:115], v3 offset:16384
    ds_read_b128 v[116:119], v3 offset:17408
    ds_read_b128 v[120:123], v3 offset:24576
    ds_read_b128 v[124:127], v3 offset:25600
    s_waitcnt lgkmcnt(5)
    v_pk_add_f32 v[96:97], v[96:97], v[104:105]
    v_pk_add_f32 v[98:99], v[98:99], v[106:107]
    s_waitcnt lgkmcnt(4)
    v_pk_add_f32 v[100:101], v[100:101], v[108:109]
    v_pk_add_f32 v[102:103], v[102:103], v[110:111]
    s_waitcnt lgkmcnt(3)
    v_pk_add_f32 v[96:97], v[96:97], v[112:113]
    v_pk_add_f32 v[98:99], v[98:99], v[114:115]
    s_waitcnt lgkmcnt(2)
    v_pk_add_f32 v[100:101], v[100:101], v[116:117]
    v_pk_add_f32 v[102:103], v[102:103], v[118:119]
    s_waitcnt lgkmcnt(1)
    v_pk_add_f32 v[96:97], v[96:97], v[120:121]
    v_pk_add_f32 v[98:99], v[98:99], v[122:123]
    s_waitcnt lgkmcnt(0)
    v_pk_add_f32 v[100:101], v[100:101], v[124:125]
    v_pk_add_f32 v[102:103], v[102:103], v[126:127]
    v_cvt_pk_bf16_f32 v172, v96, v97
    v_cvt_pk_bf16_f32 v173, v98, v99
    v_cvt_pk_bf16_f32 v174, v100, v101
    v_cvt_pk_bf16_f32 v175, v102, v103
    v_lshlrev_b32 v96, 16, v172
    v_lshlrev_b32 v97, 16, v164
    v_and_b32 v98, 0xffff0000, v172
    v_and_b32 v99, 0xffff0000, v164
    v_add_f32 v96, v96, v97
    v_add_f32 v98, v98, v99
    v_cvt_pk_bf16_f32 v172, v96, v98
    v_lshlrev_b32 v96, 16, v173
    v_lshlrev_b32 v97, 16, v165
    v_and_b32 v98, 0xffff0000, v173
    v_and_b32 v99, 0xffff0000, v165
    v_add_f32 v96, v96, v97
    v_add_f32 v98, v98, v99
    v_cvt_pk_bf16_f32 v173, v96, v98
    v_lshlrev_b32 v96, 16, v174
    v_lshlrev_b32 v97, 16, v166
    v_and_b32 v98, 0xffff0000, v174
    v_and_b32 v99, 0xffff0000, v166
    v_add_f32 v96, v96, v97
    v_add_f32 v98, v98, v99
    v_cvt_pk_bf16_f32 v174, v96, v98
    v_lshlrev_b32 v96, 16, v175
    v_lshlrev_b32 v97, 16, v167
    v_and_b32 v98, 0xffff0000, v175
    v_and_b32 v99, 0xffff0000, v167
    v_add_f32 v96, v96, v97
    v_add_f32 v98, v98, v99
    v_cvt_pk_bf16_f32 v175, v96, v98
    buffer_store_dwordx4 v[172:175], v7, s[4:7], s55 offen sc1
    s_branch G_143
G_145:
    s_waitcnt vmcnt(1)
    ds_read_b64_tr_b16 v[56:57], v2 offset:10240
    ds_read_b64_tr_b16 v[58:59], v2 offset:10496
    ds_read_b64_tr_b16 v[60:61], v2 offset:11264
    ds_read_b64_tr_b16 v[62:63], v2 offset:11520
    ds_read_b64_tr_b16 v[64:65], v2 offset:12288
    ds_read_b64_tr_b16 v[66:67], v2 offset:12544
    ds_read_b64_tr_b16 v[68:69], v2 offset:13312
    ds_read_b64_tr_b16 v[70:71], v2 offset:13568
    ds_read_b64_tr_b16 v[72:73], v2 offset:14336
    ds_read_b64_tr_b16 v[74:75], v2 offset:14592
    ds_read_b64_tr_b16 v[76:77], v2 offset:15360
    ds_read_b64_tr_b16 v[78:79], v2 offset:15616
    ds_read_b64_tr_b16 v[80:81], v2 offset:16384
    ds_read_b64_tr_b16 v[82:83], v2 offset:16640
    ds_read_b64_tr_b16 v[84:85], v2 offset:17408
    ds_read_b64_tr_b16 v[86:87], v2 offset:17664
    ds_read_b64_tr_b16 v[88:89], v2 offset:18432
    ds_read_b64_tr_b16 v[90:91], v2 offset:18688
    ds_read_b64_tr_b16 v[92:93], v2 offset:19456
    ds_read_b64_tr_b16 v[94:95], v2 offset:19712
    s_waitcnt lgkmcnt(15)
    v_mfma_f32_32x32x16_bf16 v[96:111], a[80:83], v[56:59], 0
    v_mfma_f32_32x32x16_bf16 v[112:127], a[120:123], v[56:59], 0
    v_mfma_f32_32x32x16_bf16 v[96:111], a[84:87], v[60:63], v[96:111]
    v_mfma_f32_32x32x16_bf16 v[112:127], a[124:127], v[60:63], v[112:127]
    s_waitcnt lgkmcnt(14)
    v_mfma_f32_32x32x16_bf16 v[96:111], a[88:91], v[64:67], v[96:111]
    v_mfma_f32_32x32x16_bf16 v[112:127], a[128:131], v[64:67], v[112:127]
    s_waitcnt lgkmcnt(12)
    v_mfma_f32_32x32x16_bf16 v[96:111], a[92:95], v[68:71], v[96:111]
    v_mfma_f32_32x32x16_bf16 v[112:127], a[132:135], v[68:71], v[112:127]
    s_waitcnt lgkmcnt(10)
    v_mfma_f32_32x32x16_bf16 v[96:111], a[96:99], v[72:75], v[96:111]
    v_mfma_f32_32x32x16_bf16 v[112:127], a[136:139], v[72:75], v[112:127]
    s_waitcnt lgkmcnt(8)
    v_mfma_f32_32x32x16_bf16 v[96:111], a[100:103], v[76:79], v[96:111]
    v_mfma_f32_32x32x16_bf16 v[112:127], a[140:143], v[76:79], v[112:127]
    s_waitcnt lgkmcnt(6)
    v_mfma_f32_32x32x16_bf16 v[96:111], a[104:107], v[80:83], v[96:111]
    v_mfma_f32_32x32x16_bf16 v[112:127], a[144:147], v[80:83], v[112:127]
    s_waitcnt lgkmcnt(4)
    v_mfma_f32_32x32x16_bf16 v[96:111], a[108:111], v[84:87], v[96:111]
    v_mfma_f32_32x32x16_bf16 v[112:127], a[148:151], v[84:87], v[112:127]
    s_waitcnt lgkmcnt(2)
    v_mfma_f32_32x32x16_bf16 v[96:111], a[112:115], v[88:91], v[96:111]
    v_mfma_f32_32x32x16_bf16 v[112:127], a[152:155], v[88:91], v[112:127]
    s_waitcnt lgkmcnt(0)
    v_mfma_f32_32x32x16_bf16 v[96:111], a[116:119], v[92:95], v[96:111]
    v_mfma_f32_32x32x16_bf16 v[112:127], a[156:159], v[92:95], v[112:127]
    s_mul_i32 s55, s44, s58
    s_add_u32 s55, s55, s51
    s_nop 1
    ds_write_b128 v4, v[96:99] offset:32768
    ds_write_b128 v4, v[100:103] offset:33792
    ds_write_b128 v4, v[104:107] offset:34816
    ds_write_b128 v4, v[108:111] offset:35840
    s_nop 3
    ds_write_b128 v4, v[112:115] offset:36864
    ds_write_b128 v4, v[116:119] offset:37888
    ds_write_b128 v4, v[120:123] offset:38912
    ds_write_b128 v4, v[124:127] offset:39936
    s_waitcnt vmcnt(0)
    s_waitcnt lgkmcnt(0)
    s_barrier
    ds_read_b128 v[96:99], v3 offset:32768
    ds_read_b128 v[100:103], v3 offset:33792
    ds_read_b128 v[104:107], v3 offset:40960
    ds_read_b128 v[108:111], v3 offset:41984
    ds_read_b128 v[112:115], v3 offset:49152
    ds_read_b128 v[116:119], v3 offset:50176
    ds_read_b128 v[120:123], v3 offset:57344
    ds_read_b128 v[124:127], v3 offset:58368
    s_waitcnt lgkmcnt(5)
    v_pk_add_f32 v[96:97], v[96:97], v[104:105]
    v_pk_add_f32 v[98:99], v[98:99], v[106:107]
    s_waitcnt lgkmcnt(4)
    v_pk_add_f32 v[100:101], v[100:101], v[108:109]
    v_pk_add_f32 v[102:103], v[102:103], v[110:111]
    s_waitcnt lgkmcnt(3)
    v_pk_add_f32 v[96:97], v[96:97], v[112:113]
    v_pk_add_f32 v[98:99], v[98:99], v[114:115]
    s_waitcnt lgkmcnt(2)
    v_pk_add_f32 v[100:101], v[100:101], v[116:117]
    v_pk_add_f32 v[102:103], v[102:103], v[118:119]
    s_waitcnt lgkmcnt(1)
    v_pk_add_f32 v[96:97], v[96:97], v[120:121]
    v_pk_add_f32 v[98:99], v[98:99], v[122:123]
    s_waitcnt lgkmcnt(0)
    v_pk_add_f32 v[100:101], v[100:101], v[124:125]
    v_pk_add_f32 v[102:103], v[102:103], v[126:127]
    v_cvt_pk_bf16_f32 v172, v96, v97
    v_cvt_pk_bf16_f32 v173, v98, v99
    v_cvt_pk_bf16_f32 v174, v100, v101
    v_cvt_pk_bf16_f32 v175, v102, v103
    v_lshlrev_b32 v96, 16, v172
    v_lshlrev_b32 v97, 16, v168
    v_and_b32 v98, 0xffff0000, v172
    v_and_b32 v99, 0xffff0000, v168
    v_add_f32 v96, v96, v97
    v_add_f32 v98, v98, v99
    v_cvt_pk_bf16_f32 v172, v96, v98
    v_lshlrev_b32 v96, 16, v173
    v_lshlrev_b32 v97, 16, v169
    v_and_b32 v98, 0xffff0000, v173
    v_and_b32 v99, 0xffff0000, v169
    v_add_f32 v96, v96, v97
    v_add_f32 v98, v98, v99
    v_cvt_pk_bf16_f32 v173, v96, v98
    v_lshlrev_b32 v96, 16, v174
    v_lshlrev_b32 v97, 16, v170
    v_and_b32 v98, 0xffff0000, v174
    v_and_b32 v99, 0xffff0000, v170
    v_add_f32 v96, v96, v97
    v_add_f32 v98, v98, v99
    v_cvt_pk_bf16_f32 v174, v96, v98
    v_lshlrev_b32 v96, 16, v175
    v_lshlrev_b32 v97, 16, v171
    v_and_b32 v98, 0xffff0000, v175
    v_and_b32 v99, 0xffff0000, v171
    v_add_f32 v96, v96, v97
    v_add_f32 v98, v98, v99
    v_cvt_pk_bf16_f32 v175, v96, v98
    buffer_store_dwordx4 v[172:175], v7, s[4:7], s55 offen sc1
G_143:
    s_branch F3_139
F3_138:
    s_mul_i32 s54, s44, 40960
    s_add_u32 s56, s54, s52
    s_add_u32 s54, s54, s50
    s_waitcnt vmcnt(0) lgkmcnt(0)
    s_add_u32 m0, s60, 0
    s_nop 0
    buffer_load_dwordx4 v0, s[4:7], s54 offen offset:0 sc1 lds
    buffer_load_dwordx4 v0, s[4:7], s54 offen offset:1024 sc1 lds
    buffer_load_dwordx4 v0, s[4:7], s54 offen offset:2048 sc1 lds
    buffer_load_dwordx4 v0, s[4:7], s54 offen offset:3072 sc1 lds
    s_add_u32 s54, s54, 4096
    s_add_u32 m0, s60, 4096
    s_nop 0
    buffer_load_dwordx4 v0, s[4:7], s54 offen offset:0 sc1 lds
    buffer_load_dwordx4 v0, s[4:7], s54 offen offset:1024 sc1 lds
    buffer_load_dwordx4 v0, s[4:7], s54 offen offset:2048 sc1 lds
    buffer_load_dwordx4 v0, s[4:7], s54 offen offset:3072 sc1 lds
    s_add_u32 s54, s54, 4096
    s_add_u32 m0, s60, 8192
    s_nop 0
    buffer_load_dwordx4 v0, s[4:7], s54 offen offset:0 sc1 lds
    buffer_load_dwordx4 v0, s[4:7], s54 offen offset:1024 sc1 lds
    buffer_load_dwordx4 v[164:167], v7, s[4:7], s56 offen sc1
    buffer_load_dword v179, off, s[8:11], 0
G_146:
    s_add_u32 s45, s44, s47
    s_cmp_lt_u32 s45, 64
    s_cbranch_scc0 G_148
    s_mul_i32 s54, s45, 40960
    s_add_u32 s56, s54, s52
    s_add_u32 s54, s54, s50
    s_waitcnt vmcnt(1)
    ds_read_b64_tr_b16 v[16:17], v2 offset:0
    ds_read_b64_tr_b16 v[18:19], v2 offset:256
    ds_read_b64_tr_b16 v[20:21], v2 offset:1024
    ds_read_b64_tr_b16 v[22:23], v2 offset:1280
    ds_read_b64_tr_b16 v[24:25], v2 offset:2048
    ds_read_b64_tr_b16 v[26:27], v2 offset:2304
    ds_read_b64_tr_b16 v[28:29], v2 offset:3072
    ds_read_b64_tr_b16 v[30:31], v2 offset:3328
    ds_read_b64_tr_b16 v[32:33], v2 offset:4096
    ds_read_b64_tr_b16 v[34:35], v2 offset:4352
    ds_read_b64_tr_b16 v[36:37], v2 offset:5120
    ds_read_b64_tr_b16 v[38:39], v2 offset:5376
    ds_read_b64_tr_b16 v[40:41], v2 offset:6144
    ds_read_b64_tr_b16 v[42:43], v2 offset:6400
    ds_read_b64_tr_b16 v[44:45], v2 offset:7168
    ds_read_b64_tr_b16 v[46:47], v2 offset:7424
    ds_read_b64_tr_b16 v[48:49], v2 offset:8192
    ds_read_b64_tr_b16 v[50:51], v2 offset:8448
    ds_read_b64_tr_b16 v[52:53], v2 offset:9216
    ds_read_b64_tr_b16 v[54:55], v2 offset:9472
    s_waitcnt lgkmcnt(15)
    v_mfma_f32_32x32x16_bf16 v[96:111], a[80:83], v[16:19], 0
    v_mfma_f32_32x32x16_bf16 v[112:127], a[120:123], v[16:19], 0
    s_add_u32 m0, s60, 10240
    s_nop 0
    buffer_load_dwordx4 v0, s[4:7], s54 offen offset:0 sc1 lds
    v_mfma_f32_32x32x16_bf16 v[96:111], a[84:87], v[20:23], v[96:111]
    v_mfma_f32_32x32x16_bf16 v[112:127], a[124:127], v[20:23], v[112:127]
    buffer_load_dwordx4 v0, s[4:7], s54 offen offset:1024 sc1 lds
    s_waitcnt lgkmcnt(14)
    v_mfma_f32_32x32x16_bf16 v[96:111], a[88:91], v[24:27], v[96:111]
    v_mfma_f32_32x32x16_bf16 v[112:127], a[128:131], v[24:27], v[112:127]
    buffer_load_dwordx4 v0, s[4:7], s54 offen offset:2048 sc1 lds
    s_waitcnt lgkmcnt(12)
    v_mfma_f32_32x32x16_bf16 v[96:111], a[92:95], v[28:31], v[96:111]
    v_mfma_f32_32x32x16_bf16 v[112:127], a[132:135], v[28:31], v[112:127]
    buffer_load_dwordx4 v0, s[4:7], s54 offen offset:3072 sc1 lds
    s_waitcnt lgkmcnt(10)
    v_mfma_f32_32x32x16_bf16 v[96:111], a[96:99], v[32:35], v[96:111]
    v_mfma_f32_32x32x16_bf16 v[112:127], a[136:139], v[32:35], v[112:127]
    s_add_u32 s54, s54, 4096
    s_add_u32 m0, s60, 14336
    s_nop 0
    buffer_load_dwordx4 v0, s[4:7], s54 offen offset:0 sc1 lds
    s_waitcnt lgkmcnt(8)
    v_mfma_f32_32x32x16_bf16 v[96:111], a[100:103], v[36:39], v[96:111]
    v_mfma_f32_32x32x16_bf16 v[112:127], a[140:143], v[36:39], v[112:127]
    buffer_load_dwordx4 v0, s[4:7], s54 offen offset:1024 sc1 lds
    s_waitcnt lgkmcnt(6)
    v_mfma_f32_32x32x16_bf16 v[96:111], a[104:107], v[40:43], v[96:111]
    v_mfma_f32_32x32x16_bf16 v[112:127], a[144:147], v[40:43], v[112:127]
    buffer_load_dwordx4 v0, s[4:7], s54 offen offset:2048 sc1 lds
    s_waitcnt lgkmcnt(4)
    v_mfma_f32_32x32x16_bf16 v[96:111], a[108:111], v[44:47], v[96:111]
    v_mfma_f32_32x32x16_bf16 v[112:127], a[148:151], v[44:47], v[112:127]
    buffer_load_dwordx4 v0, s[4:7], s54 offen offset:3072 sc1 lds
    s_waitcnt lgkmcnt(2)
    v_mfma_f32_32x32x16_bf16 v[96:111], a[112:115], v[48:51], v[96:111]
    v_mfma_f32_32x32x16_bf16 v[112:127], a[152:155], v[48:51], v[112:127]
    s_add_u32 s54, s54, 4096
    s_add_u32 m0, s60, 18432
    s_nop 0
    buffer_load_dwordx4 v0, s[4:7], s54 offen offset:0 sc1 lds
    s_waitcnt lgkmcnt(0)
    v_mfma_f32_32x32x16_bf16 v[96:111], a[116:119], v[52:55], v[96:111]
    v_mfma_f32_32x32x16_bf16 v[112:127], a[156:159], v[52:55], v[112:127]
    buffer_load_dwordx4 v0, s[4:7], s54 offen offset:1024 sc1 lds
    buffer_load_dwordx4 v[168:171], v7, s[4:7], s56 offen sc1
    s_mul_i32 s55, s44, s58
    s_add_u32 s55, s55, s51
    ds_write_b128 v4, v[96:99] offset:0
    ds_write_b128 v4, v[100:103] offset:1024
    ds_write_b128 v4, v[104:107] offset:2048
    ds_write_b128 v4, v[108:111] offset:3072
    s_nop 3
    ds_write_b128 v4, v[112:115] offset:4096
    ds_write_b128 v4, v[116:119] offset:5120
    ds_write_b128 v4, v[120:123] offset:6144
    ds_write_b128 v4, v[124:127] offset:7168
    s_waitcnt vmcnt(11)
    s_waitcnt lgkmcnt(0)
    s_barrier
    ds_read_b128 v[96:99], v3 offset:0
    ds_read_b128 v[100:103], v3 offset:1024
    ds_read_b128 v[104:107], v3 offset:8192
    ds_read_b128 v[108:111], v3 offset:9216
    ds_read_b128 v[112:115], v3 offset:16384
    ds_read_b128 v[116:119], v3 offset:17408
    ds_read_b128 v[120:123], v3 offset:24576
    ds_read_b128 v[124:127], v3 offset:25600
    s_waitcnt lgkmcnt(5)
    v_pk_add_f32 v[96:97], v[96:97], v[104:105]
    v_pk_add_f32 v[98:99], v[98:99], v[106:107]
    s_waitcnt lgkmcnt(4)
    v_pk_add_f32 v[100:101], v[100:101], v[108:109]
    v_pk_add_f32 v[102:103], v[102:103], v[110:111]
    s_waitcnt lgkmcnt(3)
    v_pk_add_f32 v[96:97], v[96:97], v[112:113]
    v_pk_add_f32 v[98:99], v[98:99], v[114:115]
    s_waitcnt lgkmcnt(2)
    v_pk_add_f32 v[100:101], v[100:101], v[116:117]
    v_pk_add_f32 v[102:103], v[102:103], v[118:119]
    s_waitcnt lgkmcnt(1)
    v_pk_add_f32 v[96:97], v[96:97], v[120:121]
    v_pk_add_f32 v[98:99], v[98:99], v[122:123]
    s_waitcnt lgkmcnt(0)
    v_pk_add_f32 v[100:101], v[100:101], v[124:125]
    v_pk_add_f32 v[102:103], v[102:103], v[126:127]
    v_cvt_pk_bf16_f32 v172, v96, v97
    v_cvt_pk_bf16_f32 v173, v98, v99
    v_cvt_pk_bf16_f32 v174, v100, v101
    v_cvt_pk_bf16_f32 v175, v102, v103
    v_lshlrev_b32 v96, 16, v172
    v_lshlrev_b32 v97, 16, v164
    v_and_b32 v98, 0xffff0000, v172
    v_and_b32 v99, 0xffff0000, v164
    v_add_f32 v96, v96, v97
    v_add_f32 v98, v98, v99
    v_cvt_pk_bf16_f32 v172, v96, v98
    v_lshlrev_b32 v96, 16, v173
    v_lshlrev_b32 v97, 16, v165
    v_and_b32 v98, 0xffff0000, v173
    v_and_b32 v99, 0xffff0000, v165
    v_add_f32 v96, v96, v97
    v_add_f32 v98, v98, v99
    v_cvt_pk_bf16_f32 v173, v96, v98
    v_lshlrev_b32 v96, 16, v174
    v_lshlrev_b32 v97, 16, v166
    v_and_b32 v98, 0xffff0000, v174
    v_and_b32 v99, 0xffff0000, v166
    v_add_f32 v96, v96, v97
    v_add_f32 v98, v98, v99
    v_cvt_pk_bf16_f32 v174, v96, v98
    v_lshlrev_b32 v96, 16, v175
    v_lshlrev_b32 v97, 16, v167
    v_and_b32 v98, 0xffff0000, v175
    v_and_b32 v99, 0xffff0000, v167
    v_add_f32 v96, v96, v97
    v_add_f32 v98, v98, v99
    v_cvt_pk_bf16_f32 v175, v96, v98
    buffer_store_dwordx4 v[172:175], v7, s[4:7], s55 offen sc1
    s_mov_b32 s44, s45
    s_add_u32 s45, s44, s47
    s_cmp_lt_u32 s45, 64
    s_cbranch_scc0 G_149
    s_mul_i32 s54, s45, 40960
    s_add_u32 s56, s54, s52
    s_add_u32 s54, s54, s50
    s_waitcnt vmcnt(1)
    ds_read_b64_tr_b16 v[56:57], v2 offset:10240
    ds_read_b64_tr_b16 v[58:59], v2 offset:10496
    ds_read_b64_tr_b16 v[60:61], v2 offset:11264
    ds_read_b64_tr_b16 v[62:63], v2 offset:11520
    ds_read_b64_tr_b16 v[64:65], v2 offset:12288
    ds_read_b64_tr_b16 v[66:67], v2 offset:12544
    ds_read_b64_tr_b16 v[68:69], v2 offset:13312
    ds_read_b64_tr_b16 v[70:71], v2 offset:13568
    ds_read_b64_tr_b16 v[72:73], v2 offset:14336
    ds_read_b64_tr_b16 v[74:75], v2 offset:14592
    ds_read_b64_tr_b16 v[76:77], v2 offset:15360
    ds_read_b64_tr_b16 v[78:79], v2 offset:15616
    ds_read_b64_tr_b16 v[80:81], v2 offset:16384
    ds_read_b64_tr_b16 v[82:83], v2 offset:16640
    ds_read_b64_tr_b16 v[84:85], v2 offset:17408
    ds_read_b64_tr_b16 v[86:87], v2 offset:17664
    ds_read_b64_tr_b16 v[88:89], v2 offset:18432
    ds_read_b64_tr_b16 v[90:91], v2 offset:18688
    ds_read_b64_tr_b16 v[92:93], v2 offset:19456
    ds_read_b64_tr_b16 v[94:95], v2 offset:19712
    s_waitcnt lgkmcnt(15)
    v_mfma_f32_32x32x16_bf16 v[96:111], a[80:83], v[56:59], 0
    v_mfma_f32_32x32x16_bf16 v[112:127], a[120:123], v[56:59], 0
    s_add_u32 m0, s60, 0
    s_nop 0
    buffer_load_dwordx4 v0, s[4:7], s54 offen offset:0 sc1 lds
    v_mfma_f32_32x32x16_bf16 v[96:111], a[84:87], v[60:63], v[96:111]
    v_mfma_f32_32x32x16_bf16 v[112:127], a[124:127], v[60:63], v[112:127]
    buffer_load_dwordx4 v0, s[4:7], s54 offen offset:1024 sc1 lds
    s_waitcnt lgkmcnt(14)
    v_mfma_f32_32x32x16_bf16 v[96:111], a[88:91], v[64:67], v[96:111]
    v_mfma_f32_32x32x16_bf16 v[112:127], a[128:131], v[64:67], v[112:127]
    buffer_load_dwordx4 v0, s[4:7], s54 offen offset:2048 sc1 lds
    s_waitcnt lgkmcnt(12)
    v_mfma_f32_32x32x16_bf16 v[96:111], a[92:95], v[68:71], v[96:111]
    v_mfma_f32_32x32x16_bf16 v[112:127], a[132:135], v[68:71], v[112:127]
    buffer_load_dwordx4 v0, s[4:7], s54 offen offset:3072 sc1 lds
    s_waitcnt lgkmcnt(10)
    v_mfma_f32_32x32x16_bf16 v[96:111], a[96:99], v[72:75], v[96:111]
    v_mfma_f32_32x32x16_bf16 v[112:127], a[136:139], v[72:75], v[112:127]
    s_add_u32 s54, s54, 4096
    s_add_u32 m0, s60, 4096
    s_nop 0
    buffer_load_dwordx4 v0, s[4:7], s54 offen offset:0 sc1 lds
    s_waitcnt lgkmcnt(8)
    v_mfma_f32_32x32x16_bf16 v[96:111], a[100:103], v[76:79], v[96:111]
    v_mfma_f32_32x32x16_bf16 v[112:127], a[140:143], v[76:79], v[112:127]
    buffer_load_dwordx4 v0, s[4:7], s54 offen offset:1024 sc1 lds
    s_waitcnt lgkmcnt(6)
    v_mfma_f32_32x32x16_bf16 v[96:111], a[104:107], v[80:83], v[96:111]
    v_mfma_f32_32x32x16_bf16 v[112:127], a[144:147], v[80:83], v[112:127]
    buffer_load_dwordx4 v0, s[4:7], s54 offen offset:2048 sc1 lds
    s_waitcnt lgkmcnt(4)
    v_mfma_f32_32x32x16_bf16 v[96:111], a[108:111], v[84:87], v[96:111]
    v_mfma_f32_32x32x16_bf16 v[112:127], a[148:151], v[84:87], v[112:127]
    buffer_load_dwordx4 v0, s[4:7], s54 offen offset:3072 sc1 lds
    s_waitcnt lgkmcnt(2)
    v_mfma_f32_32x32x16_bf16 v[96:111], a[112:115], v[88:91], v[96:111]
    v_mfma_f32_32x32x16_bf16 v[112:127], a[152:155], v[88:91], v[112:127]
    s_add_u32 s54, s54, 4096
    s_add_u32 m0, s60, 8192
    s_nop 0
    buffer_load_dwordx4 v0, s[4:7], s54 offen offset:0 sc1 lds
    s_waitcnt lgkmcnt(0)
    v_mfma_f32_32x32x16_bf16 v[96:111], a[116:119], v[92:95], v[96:111]
    v_mfma_f32_32x32x16_bf16 v[112:127], a[156:159], v[92:95], v[112:127]
    buffer_load_dwordx4 v0, s[4:7], s54 offen offset:1024 sc1 lds
    buffer_load_dwordx4 v[164:167], v7, s[4:7], s56 offen sc1
    s_mul_i32 s55, s44, s58
    s_add_u32 s55, s55, s51
    ds_write_b128 v4, v[96:99] offset:32768
    ds_write_b128 v4, v[100:103] offset:33792
    ds_write_b128 v4, v[104:107] offset:34816
    ds_write_b128 v4, v[108:111] offset:35840
    s_nop 3
    ds_write_b128 v4, v[112:115] offset:36864
    ds_write_b128 v4, v[116:119] offset:37888
    ds_write_b128 v4, v[120:123] offset:38912
    ds_write_b128 v4, v[124:127] offset:39936
    s_waitcnt vmcnt(11)
    s_waitcnt lgkmcnt(0)
    s_barrier
    ds_read_b128 v[96:99], v3 offset:32768
    ds_read_b128 v[100:103], v3 offset:33792
    ds_read_b128 v[104:107], v3 offset:40960
    ds_read_b128 v[108:111], v3 offset:41984
    ds_read_b128 v[112:115], v3 offset:49152
    ds_read_b128 v[116:119], v3 offset:50176
    ds_read_b128 v[120:123], v3 offset:57344
    ds_read_b128 v[124:127], v3 offset:58368
    s_waitcnt lgkmcnt(5)
    v_pk_add_f32 v[96:97], v[96:97], v[104:105]
    v_pk_add_f32 v[98:99], v[98:99], v[106:107]
    s_waitcnt lgkmcnt(4)
    v_pk_add_f32 v[100:101], v[100:101], v[108:109]
    v_pk_add_f32 v[102:103], v[102:103], v[110:111]
    s_waitcnt lgkmcnt(3)
    v_pk_add_f32 v[96:97], v[96:97], v[112:113]
    v_pk_add_f32 v[98:99], v[98:99], v[114:115]
    s_waitcnt lgkmcnt(2)
    v_pk_add_f32 v[100:101], v[100:101], v[116:117]
    v_pk_add_f32 v[102:103], v[102:103], v[118:119]
    s_waitcnt lgkmcnt(1)
    v_pk_add_f32 v[96:97], v[96:97], v[120:121]
    v_pk_add_f32 v[98:99], v[98:99], v[122:123]
    s_waitcnt lgkmcnt(0)
    v_pk_add_f32 v[100:101], v[100:101], v[124:125]
    v_pk_add_f32 v[102:103], v[102:103], v[126:127]
    v_cvt_pk_bf16_f32 v172, v96, v97
    v_cvt_pk_bf16_f32 v173, v98, v99
    v_cvt_pk_bf16_f32 v174, v100, v101
    v_cvt_pk_bf16_f32 v175, v102, v103
    v_lshlrev_b32 v96, 16, v172
    v_lshlrev_b32 v97, 16, v168
    v_and_b32 v98, 0xffff0000, v172
    v_and_b32 v99, 0xffff0000, v168
    v_add_f32 v96, v96, v97
    v_add_f32 v98, v98, v99
    v_cvt_pk_bf16_f32 v172, v96, v98
    v_lshlrev_b32 v96, 16, v173
    v_lshlrev_b32 v97, 16, v169
    v_and_b32 v98, 0xffff0000, v173
    v_and_b32 v99, 0xffff0000, v169
    v_add_f32 v96, v96, v97
    v_add_f32 v98, v98, v99
    v_cvt_pk_bf16_f32 v173, v96, v98
    v_lshlrev_b32 v96, 16, v174
    v_lshlrev_b32 v97, 16, v170
    v_and_b32 v98, 0xffff0000, v174
    v_and_b32 v99, 0xffff0000, v170
    v_add_f32 v96, v96, v97
    v_add_f32 v98, v98, v99
    v_cvt_pk_bf16_f32 v174, v96, v98
    v_lshlrev_b32 v96, 16, v175
    v_lshlrev_b32 v97, 16, v171
    v_and_b32 v98, 0xffff0000, v175
    v_and_b32 v99, 0xffff0000, v171
    v_add_f32 v96, v96, v97
    v_add_f32 v98, v98, v99
    v_cvt_pk_bf16_f32 v175, v96, v98
    buffer_store_dwordx4 v[172:175], v7, s[4:7], s55 offen sc1
    s_mov_b32 s44, s45
    s_branch G_146
G_148:
    s_waitcnt vmcnt(1)
    ds_read_b64_tr_b16 v[16:17], v2 offset:0
    ds_read_b64_tr_b16 v[18:19], v2 offset:256
    ds_read_b64_tr_b16 v[20:21], v2 offset:1024
    ds_read_b64_tr_b16 v[22:23], v2 offset:1280
    ds_read_b64_tr_b16 v[24:25], v2 offset:2048
    ds_read_b64_tr_b16 v[26:27], v2 offset:2304
    ds_read_b64_tr_b16 v[28:29], v2 offset:3072
    ds_read_b64_tr_b16 v[30:31], v2 offset:3328
    ds_read_b64_tr_b16 v[32:33], v2 offset:4096
    ds_read_b64_tr_b16 v[34:35], v2 offset:4352
    ds_read_b64_tr_b16 v[36:37], v2 offset:5120
    ds_read_b64_tr_b16 v[38:39], v2 offset:5376
    ds_read_b64_tr_b16 v[40:41], v2 offset:6144
    ds_read_b64_tr_b16 v[42:43], v2 offset:6400
    ds_read_b64_tr_b16 v[44:45], v2 offset:7168
    ds_read_b64_tr_b16 v[46:47], v2 offset:7424
    ds_read_b64_tr_b16 v[48:49], v2 offset:8192
    ds_read_b64_tr_b16 v[50:51], v2 offset:8448
    ds_read_b64_tr_b16 v[52:53], v2 offset:9216
    ds_read_b64_tr_b16 v[54:55], v2 offset:9472
    s_waitcnt lgkmcnt(15)
    v_mfma_f32_32x32x16_bf16 v[96:111], a[80:83], v[16:19], 0
    v_mfma_f32_32x32x16_bf16 v[112:127], a[120:123], v[16:19], 0
    v_mfma_f32_32x32x16_bf16 v[96:111], a[84:87], v[20:23], v[96:111]
    v_mfma_f32_32x32x16_bf16 v[112:127], a[124:127], v[20:23], v[112:127]
    s_waitcnt lgkmcnt(14)
    v_mfma_f32_32x32x16_bf16 v[96:111], a[88:91], v[24:27], v[96:111]
    v_mfma_f32_32x32x16_bf16 v[112:127], a[128:131], v[24:27], v[112:127]
    s_waitcnt lgkmcnt(12)
    v_mfma_f32_32x32x16_bf16 v[96:111], a[92:95], v[28:31], v[96:111]
    v_mfma_f32_32x32x16_bf16 v[112:127], a[132:135], v[28:31], v[112:127]
    s_waitcnt lgkmcnt(10)
    v_mfma_f32_32x32x16_bf16 v[96:111], a[96:99], v[32:35], v[96:111]
    v_mfma_f32_32x32x16_bf16 v[112:127], a[136:139], v[32:35], v[112:127]
    s_waitcnt lgkmcnt(8)
    v_mfma_f32_32x32x16_bf16 v[96:111], a[100:103], v[36:39], v[96:111]
    v_mfma_f32_32x32x16_bf16 v[112:127], a[140:143], v[36:39], v[112:127]
    s_waitcnt lgkmcnt(6)
    v_mfma_f32_32x32x16_bf16 v[96:111], a[104:107], v[40:43], v[96:111]
    v_mfma_f32_32x32x16_bf16 v[112:127], a[144:147], v[40:43], v[112:127]
    s_waitcnt lgkmcnt(4)
    v_mfma_f32_32x32x16_bf16 v[96:111], a[108:111], v[44:47], v[96:111]
    v_mfma_f32_32x32x16_bf16 v[112:127], a[148:151], v[44:47], v[112:127]
    s_waitcnt lgkmcnt(2)
    v_mfma_f32_32x32x16_bf16 v[96:111], a[112:115], v[48:51], v[96:111]
    v_mfma_f32_32x32x16_bf16 v[112:127], a[152:155], v[48:51], v[112:127]
    s_waitcnt lgkmcnt(0)
    v_mfma_f32_32x32x16_bf16 v[96:111], a[116:119], v[52:55], v[96:111]
    v_mfma_f32_32x32x16_bf16 v[112:127], a[156:159], v[52:55], v[112:127]
    s_mul_i32 s55, s44, s58
    s_add_u32 s55, s55, s51
    s_nop 1
    ds_write_b128 v4, v[96:99] offset:0
    ds_write_b128 v4, v[100:103] offset:1024
    ds_write_b128 v4, v[104:107] offset:2048
    ds_write_b128 v4, v[108:111] offset:3072
    s_nop 3
    ds_write_b128 v4, v[112:115] offset:4096
    ds_write_b128 v4, v[116:119] offset:5120
    ds_write_b128 v4, v[120:123] offset:6144
    ds_write_b128 v4, v[124:127] offset:7168
    s_waitcnt vmcnt(0)
    s_waitcnt lgkmcnt(0)
    s_barrier
    ds_read_b128 v[96:99], v3 offset:0
    ds_read_b128 v[100:103], v3 offset:1024
    ds_read_b128 v[104:107], v3 offset:8192
    ds_read_b128 v[108:111], v3 offset:9216
    ds_read_b128 v[112:115], v3 offset:16384
    ds_read_b128 v[116:119], v3 offset:17408
    ds_read_b128 v[120:123], v3 offset:24576
    ds_read_b128 v[124:127], v3 offset:25600
    s_waitcnt lgkmcnt(5)
    v_pk_add_f32 v[96:97], v[96:97], v[104:105]
    v_pk_add_f32 v[98:99], v[98:99], v[106:107]
    s_waitcnt lgkmcnt(4)
    v_pk_add_f32 v[100:101], v[100:101], v[108:109]
    v_pk_add_f32 v[102:103], v[102:103], v[110:111]
    s_waitcnt lgkmcnt(3)
    v_pk_add_f32 v[96:97], v[96:97], v[112:113]
    v_pk_add_f32 v[98:99], v[98:99], v[114:115]
    s_waitcnt lgkmcnt(2)
    v_pk_add_f32 v[100:101], v[100:101], v[116:117]
    v_pk_add_f32 v[102:103], v[102:103], v[118:119]
    s_waitcnt lgkmcnt(1)
    v_pk_add_f32 v[96:97], v[96:97], v[120:121]
    v_pk_add_f32 v[98:99], v[98:99], v[122:123]
    s_waitcnt lgkmcnt(0)
    v_pk_add_f32 v[100:101], v[100:101], v[124:125]
    v_pk_add_f32 v[102:103], v[102:103], v[126:127]
    v_cvt_pk_bf16_f32 v172, v96, v97
    v_cvt_pk_bf16_f32 v173, v98, v99
    v_cvt_pk_bf16_f32 v174, v100, v101
    v_cvt_pk_bf16_f32 v175, v102, v103
    v_lshlrev_b32 v96, 16, v172
    v_lshlrev_b32 v97, 16, v164
    v_and_b32 v98, 0xffff0000, v172
    v_and_b32 v99, 0xffff0000, v164
    v_add_f32 v96, v96, v97
    v_add_f32 v98, v98, v99
    v_cvt_pk_bf16_f32 v172, v96, v98
    v_lshlrev_b32 v96, 16, v173
    v_lshlrev_b32 v97, 16, v165
    v_and_b32 v98, 0xffff0000, v173
    v_and_b32 v99, 0xffff0000, v165
    v_add_f32 v96, v96, v97
    v_add_f32 v98, v98, v99
    v_cvt_pk_bf16_f32 v173, v96, v98
    v_lshlrev_b32 v96, 16, v174
    v_lshlrev_b32 v97, 16, v166
    v_and_b32 v98, 0xffff0000, v174
    v_and_b32 v99, 0xffff0000, v166
    v_add_f32 v96, v96, v97
    v_add_f32 v98, v98, v99
    v_cvt_pk_bf16_f32 v174, v96, v98
    v_lshlrev_b32 v96, 16, v175
    v_lshlrev_b32 v97, 16, v167
    v_and_b32 v98, 0xffff0000, v175
    v_and_b32 v99, 0xffff0000, v167
    v_add_f32 v96, v96, v97
    v_add_f32 v98, v98, v99
    v_cvt_pk_bf16_f32 v175, v96, v98
    buffer_store_dwordx4 v[172:175], v7, s[4:7], s55 offen sc1
    s_branch G_147
G_149:
    s_waitcnt vmcnt(1)
    ds_read_b64_tr_b16 v[56:57], v2 offset:10240
    ds_read_b64_tr_b16 v[58:59], v2 offset:10496
    ds_read_b64_tr_b16 v[60:61], v2 offset:11264
    ds_read_b64_tr_b16 v[62:63], v2 offset:11520
    ds_read_b64_tr_b16 v[64:65], v2 offset:12288
    ds_read_b64_tr_b16 v[66:67], v2 offset:12544
    ds_read_b64_tr_b16 v[68:69], v2 offset:13312
    ds_read_b64_tr_b16 v[70:71], v2 offset:13568
    ds_read_b64_tr_b16 v[72:73], v2 offset:14336
    ds_read_b64_tr_b16 v[74:75], v2 offset:14592
    ds_read_b64_tr_b16 v[76:77], v2 offset:15360
    ds_read_b64_tr_b16 v[78:79], v2 offset:15616
    ds_read_b64_tr_b16 v[80:81], v2 offset:16384
    ds_read_b64_tr_b16 v[82:83], v2 offset:16640
    ds_read_b64_tr_b16 v[84:85], v2 offset:17408
    ds_read_b64_tr_b16 v[86:87], v2 offset:17664
    ds_read_b64_tr_b16 v[88:89], v2 offset:18432
    ds_read_b64_tr_b16 v[90:91], v2 offset:18688
    ds_read_b64_tr_b16 v[92:93], v2 offset:19456
    ds_read_b64_tr_b16 v[94:95], v2 offset:19712
    s_waitcnt lgkmcnt(15)
    v_mfma_f32_32x32x16_bf16 v[96:111], a[80:83], v[56:59], 0
    v_mfma_f32_32x32x16_bf16 v[112:127], a[120:123], v[56:59], 0
    v_mfma_f32_32x32x16_bf16 v[96:111], a[84:87], v[60:63], v[96:111]
    v_mfma_f32_32x32x16_bf16 v[112:127], a[124:127], v[60:63], v[112:127]
    s_waitcnt lgkmcnt(14)
    v_mfma_f32_32x32x16_bf16 v[96:111], a[88:91], v[64:67], v[96:111]
    v_mfma_f32_32x32x16_bf16 v[112:127], a[128:131], v[64:67], v[112:127]
    s_waitcnt lgkmcnt(12)
    v_mfma_f32_32x32x16_bf16 v[96:111], a[92:95], v[68:71], v[96:111]
    v_mfma_f32_32x32x16_bf16 v[112:127], a[132:135], v[68:71], v[112:127]
    s_waitcnt lgkmcnt(10)
    v_mfma_f32_32x32x16_bf16 v[96:111], a[96:99], v[72:75], v[96:111]
    v_mfma_f32_32x32x16_bf16 v[112:127], a[136:139], v[72:75], v[112:127]
    s_waitcnt lgkmcnt(8)
    v_mfma_f32_32x32x16_bf16 v[96:111], a[100:103], v[76:79], v[96:111]
    v_mfma_f32_32x32x16_bf16 v[112:127], a[140:143], v[76:79], v[112:127]
    s_waitcnt lgkmcnt(6)
    v_mfma_f32_32x32x16_bf16 v[96:111], a[104:107], v[80:83], v[96:111]
    v_mfma_f32_32x32x16_bf16 v[112:127], a[144:147], v[80:83], v[112:127]
    s_waitcnt lgkmcnt(4)
    v_mfma_f32_32x32x16_bf16 v[96:111], a[108:111], v[84:87], v[96:111]
    v_mfma_f32_32x32x16_bf16 v[112:127], a[148:151], v[84:87], v[112:127]
    s_waitcnt lgkmcnt(2)
    v_mfma_f32_32x32x16_bf16 v[96:111], a[112:115], v[88:91], v[96:111]
    v_mfma_f32_32x32x16_bf16 v[112:127], a[152:155], v[88:91], v[112:127]
    s_waitcnt lgkmcnt(0)
    v_mfma_f32_32x32x16_bf16 v[96:111], a[116:119], v[92:95], v[96:111]
    v_mfma_f32_32x32x16_bf16 v[112:127], a[156:159], v[92:95], v[112:127]
    s_mul_i32 s55, s44, s58
    s_add_u32 s55, s55, s51
    s_nop 1
    ds_write_b128 v4, v[96:99] offset:32768
    ds_write_b128 v4, v[100:103] offset:33792
    ds_write_b128 v4, v[104:107] offset:34816
    ds_write_b128 v4, v[108:111] offset:35840
    s_nop 3
    ds_write_b128 v4, v[112:115] offset:36864
    ds_write_b128 v4, v[116:119] offset:37888
    ds_write_b128 v4, v[120:123] offset:38912
    ds_write_b128 v4, v[124:127] offset:39936
    s_waitcnt vmcnt(0)
    s_waitcnt lgkmcnt(0)
    s_barrier
    ds_read_b128 v[96:99], v3 offset:32768
    ds_read_b128 v[100:103], v3 offset:33792
    ds_read_b128 v[104:107], v3 offset:40960
    ds_read_b128 v[108:111], v3 offset:41984
    ds_read_b128 v[112:115], v3 offset:49152
    ds_read_b128 v[116:119], v3 offset:50176
    ds_read_b128 v[120:123], v3 offset:57344
    ds_read_b128 v[124:127], v3 offset:58368
    s_waitcnt lgkmcnt(5)
    v_pk_add_f32 v[96:97], v[96:97], v[104:105]
    v_pk_add_f32 v[98:99], v[98:99], v[106:107]
    s_waitcnt lgkmcnt(4)
    v_pk_add_f32 v[100:101], v[100:101], v[108:109]
    v_pk_add_f32 v[102:103], v[102:103], v[110:111]
    s_waitcnt lgkmcnt(3)
    v_pk_add_f32 v[96:97], v[96:97], v[112:113]
    v_pk_add_f32 v[98:99], v[98:99], v[114:115]
    s_waitcnt lgkmcnt(2)
    v_pk_add_f32 v[100:101], v[100:101], v[116:117]
    v_pk_add_f32 v[102:103], v[102:103], v[118:119]
    s_waitcnt lgkmcnt(1)
    v_pk_add_f32 v[96:97], v[96:97], v[120:121]
    v_pk_add_f32 v[98:99], v[98:99], v[122:123]
    s_waitcnt lgkmcnt(0)
    v_pk_add_f32 v[100:101], v[100:101], v[124:125]
    v_pk_add_f32 v[102:103], v[102:103], v[126:127]
    v_cvt_pk_bf16_f32 v172, v96, v97
    v_cvt_pk_bf16_f32 v173, v98, v99
    v_cvt_pk_bf16_f32 v174, v100, v101
    v_cvt_pk_bf16_f32 v175, v102, v103
    v_lshlrev_b32 v96, 16, v172
    v_lshlrev_b32 v97, 16, v168
    v_and_b32 v98, 0xffff0000, v172
    v_and_b32 v99, 0xffff0000, v168
    v_add_f32 v96, v96, v97
    v_add_f32 v98, v98, v99
    v_cvt_pk_bf16_f32 v172, v96, v98
    v_lshlrev_b32 v96, 16, v173
    v_lshlrev_b32 v97, 16, v169
    v_and_b32 v98, 0xffff0000, v173
    v_and_b32 v99, 0xffff0000, v169
    v_add_f32 v96, v96, v97
    v_add_f32 v98, v98, v99
    v_cvt_pk_bf16_f32 v173, v96, v98
    v_lshlrev_b32 v96, 16, v174
    v_lshlrev_b32 v97, 16, v170
    v_and_b32 v98, 0xffff0000, v174
    v_and_b32 v99, 0xffff0000, v170
    v_add_f32 v96, v96, v97
    v_add_f32 v98, v98, v99
    v_cvt_pk_bf16_f32 v174, v96, v98
    v_lshlrev_b32 v96, 16, v175
    v_lshlrev_b32 v97, 16, v171
    v_and_b32 v98, 0xffff0000, v175
    v_and_b32 v99, 0xffff0000, v171
    v_add_f32 v96, v96, v97
    v_add_f32 v98, v98, v99
    v_cvt_pk_bf16_f32 v175, v96, v98
    buffer_store_dwordx4 v[172:175], v7, s[4:7], s55 offen sc1
G_147:
F3_139:
    s_waitcnt vmcnt(0)
    s_barrier
    s_cmp_lg_u32 s29, 0
    s_cbranch_scc1 F_150
    s_lshl_b32 s32, s28, 2
    s_add_u32 s32, s32, s29
    s_lshl_b32 s32, s32, 2
    s_add_u32 s32, s32, 12288
    v_mov_b32 v172, s57
    s_mov_b64 exec, 1
    buffer_store_dword v172, off, s[4:7], s32 sc1
    s_mov_b64 exec, -1
F_150:
R_137:
    s_mov_b32 s44, 0
    s_mov_b32 s47, 1
    s_mul_i32 s50, s30, 6291456
    s_add_u32 s50, s50, 11534336
    s_mul_i32 s34, s29, 10240
    s_add_u32 s50, s50, s34
    s_mov_b32 s49, s61
    s_cmp_eq_u32 s64, 1
    s_cbranch_scc1 G1_151
    s_cmp_eq_u32 s64, 2
    s_cbranch_scc1 G1_152
    s_mul_i32 s51, s30, 34603008
    s_add_u32 s51, s51, 117440512
    s_lshl_b32 s34, s63, 14
    s_lshl_b32 s35, s65, 10
    s_mov_b32 s58, 524288
    s_add_u32 s51, s51, s34
    s_add_u32 s51, s51, s35
    s_lshl_b32 s34, s29, 13
    v_add_u32 v4, s34, v0
    s_lshl_b32 s34, s29, 3
    s_add_u32 s34, s34, 65536
    v_bfe_u32 v5, v1, 0, 5
    v_mul_u32_u24 v5, 32, v5
    v_add_u32 v5, s34, v5
    s_lshl_b32 s35, s29, 11
    s_lshl_b32 s36, s29, 8
    s_add_u32 s36, s36, 67584
    v_bfe_u32 v3, v1, 1, 1
    v_mul_u32_u24 v3, 512, v3
    v_bfe_u32 v172, v1, 0, 1
    v_lshl_add_u32 v3, v172, 4, v3
    v_bfe_u32 v172, v1, 4, 1
    v_lshl_add_u32 v3, v172, 5, v3
    v_bfe_u32 v172, v1, 5, 1
    v_lshl_add_u32 v3, v172, 7, v3
    v_bfe_u32 v172, v1, 2, 1
    v_lshl_add_u32 v3, v172, 6, v3
    v_bfe_u32 v172, v1, 3, 1
    v_lshl_add_u32 v3, v172, 8, v3
    v_add_u32 v3, s35, v3
    v_bfe_u32 v6, v1, 0, 1
    v_mul_u32_u24 v6, 32, v6
    v_bfe_u32 v172, v1, 4, 1
    v_lshl_add_u32 v6, v172, 6, v6
    v_bfe_u32 v172, v1, 5, 1
    v_lshl_add_u32 v6, v172, 8, v6
    v_bfe_u32 v172, v1, 2, 1
    v_lshl_add_u32 v6, v172, 7, v6
    v_bfe_u32 v172, v1, 3, 1
    v_lshl_add_u32 v6, v172, 9, v6
    v_add_u32 v6, 65536, v6
    s_lshl_b32 s34, s29, 8
    v_bfe_u32 v7, v1, 4, 2
    v_mul_u32_u24 v7, 2048, v7
    v_bfe_u32 v172, v1, 0, 4
    v_lshl_add_u32 v7, v172, 4, v7
    v_add_u32 v7, s34, v7
    s_branch G1_154
G1_151:
    s_mul_i32 s51, s30, 34603008
    s_add_u32 s51, s51, 117448704
    s_lshl_b32 s34, s63, 14
    s_lshl_b32 s35, s65, 12
    s_mov_b32 s58, 524288
    s_add_u32 s51, s51, s34
    s_add_u32 s51, s51, s35
    s_lshl_b32 s34, s29, 13
    v_add_u32 v4, s34, v0
    s_lshl_b32 s34, s29, 3
    s_add_u32 s34, s34, 65536
    v_bfe_u32 v5, v1, 0, 5
    v_mul_u32_u24 v5, 32, v5
    v_add_u32 v5, s34, v5
    s_lshl_b32 s35, s29, 11
    s_lshl_b32 s36, s29, 8
    s_add_u32 s36, s36, 67584
    v_add_u32 v3, s35, v0
    s_lshr_b32 s34, s29, 1
    s_lshl_b32 s34, s34, 11
    s_and_b32 s37, s29, 1
    s_lshl_b32 s38, s37, 9
    s_add_u32 s34, s34, s38
    v_bfe_u32 v7, v1, 4, 1
    v_mul_u32_u24 v7, 1024, v7
    v_bfe_u32 v172, v1, 5, 1
    v_lshl_add_u32 v7, v172, 8, v7
    v_bfe_u32 v172, v1, 0, 4
    v_lshl_add_u32 v7, v172, 4, v7
    v_add_u32 v7, s34, v7
    s_lshl_b32 s37, s37, 6
    s_add_u32 s37, s37, s36
    v_bfe_u32 v10, v1, 5, 1
    v_mul_u32_u24 v10, 32, v10
    v_add_u32 v10, s37, v10
    v_bfe_u32 v6, v1, 0, 5
    v_mul_u32_u24 v6, 32, v6
    v_add_u32 v6, 65536, v6
    v_bfe_u32 v9, v1, 0, 2
    v_mul_u32_u24 v9, 4, v9
    v_bfe_u32 v172, v1, 2, 1
    v_lshl_add_u32 v9, v172, 5, v9
    v_bfe_u32 v172, v1, 3, 1
    v_lshl_add_u32 v9, v172, 4, v9
    v_bfe_u32 v172, v1, 4, 1
    v_lshl_add_u32 v9, v172, 6, v9
    v_add_u32 v9, s36, v9
    s_mov_b32 s34, 0x3f803f80
    v_mov_b32 v56, s34
    v_mov_b32 v57, s34
    v_mov_b32 v58, s34
    v_mov_b32 v59, s34
    s_nop 1
    v_mfma_f32_32x32x16_bf16 v[96:111], v[56:59], a[0:3], 0
    v_mfma_f32_32x32x16_bf16 v[112:127], v[56:59], a[40:43], 0
    v_mfma_f32_32x32x16_bf16 v[96:111], v[56:59], a[4:7], v[96:111]
    v_mfma_f32_32x32x16_bf16 v[112:127], v[56:59], a[44:47], v[112:127]
    v_mfma_f32_32x32x16_bf16 v[96:111], v[56:59], a[8:11], v[96:111]
    v_mfma_f32_32x32x16_bf16 v[112:127], v[56:59], a[48:51], v[112:127]
    v_mfma_f32_32x32x16_bf16 v[96:111], v[56:59], a[12:15], v[96:111]
    v_mfma_f32_32x32x16_bf16 v[112:127], v[56:59], a[52:55], v[112:127]
    v_mfma_f32_32x32x16_bf16 v[96:111], v[56:59], a[16:19], v[96:111]
    v_mfma_f32_32x32x16_bf16 v[112:127], v[56:59], a[56:59], v[112:127]
    v_mfma_f32_32x32x16_bf16 v[96:111], v[56:59], a[20:23], v[96:111]
    v_mfma_f32_32x32x16_bf16 v[112:127], v[56:59], a[60:63], v[112:127]
    v_mfma_f32_32x32x16_bf16 v[96:111], v[56:59], a[24:27], v[96:111]
    v_mfma_f32_32x32x16_bf16 v[112:127], v[56:59], a[64:67], v[112:127]
    v_mfma_f32_32x32x16_bf16 v[96:111], v[56:59], a[28:31], v[96:111]
    v_mfma_f32_32x32x16_bf16 v[112:127], v[56:59], a[68:71], v[112:127]
    v_mfma_f32_32x32x16_bf16 v[96:111], v[56:59], a[32:35], v[96:111]
    v_mfma_f32_32x32x16_bf16 v[112:127], v[56:59], a[72:75], v[112:127]
    v_mfma_f32_32x32x16_bf16 v[96:111], v[56:59], a[36:39], v[96:111]
    v_mfma_f32_32x32x16_bf16 v[112:127], v[56:59], a[76:79], v[112:127]
    s_nop 3
    ds_write_b128 v4, v[96:99] offset:32768
    ds_write_b128 v4, v[100:103] offset:33792
    ds_write_b128 v4, v[104:107] offset:34816
    ds_write_b128 v4, v[108:111] offset:35840
    s_nop 3
    ds_write_b128 v4, v[112:115] offset:36864
    ds_write_b128 v4, v[116:119] offset:37888
    ds_write_b128 v4, v[120:123] offset:38912
    ds_write_b128 v4, v[124:127] offset:39936
    s_waitcnt lgkmcnt(0)
    s_barrier
    ds_read_b128 v[96:99], v3 offset:32768
    ds_read_b128 v[100:103], v3 offset:33792
    ds_read_b128 v[104:107], v3 offset:40960
    ds_read_b128 v[108:111], v3 offset:41984
    ds_read_b128 v[112:115], v3 offset:49152
    ds_read_b128 v[116:119], v3 offset:50176
    ds_read_b128 v[120:123], v3 offset:57344
    ds_read_b128 v[124:127], v3 offset:58368
    s_waitcnt lgkmcnt(5)
    v_pk_add_f32 v[96:97], v[96:97], v[104:105]
    v_pk_add_f32 v[98:99], v[98:99], v[106:107]
    s_waitcnt lgkmcnt(4)
    v_pk_add_f32 v[100:101], v[100:101], v[108:109]
    v_pk_add_f32 v[102:103], v[102:103], v[110:111]
    s_waitcnt lgkmcnt(3)
    v_pk_add_f32 v[96:97], v[96:97], v[112:113]
    v_pk_add_f32 v[98:99], v[98:99], v[114:115]
    s_waitcnt lgkmcnt(2)
    v_pk_add_f32 v[100:101], v[100:101], v[116:117]
    v_pk_add_f32 v[102:103], v[102:103], v[118:119]
    s_waitcnt lgkmcnt(1)
    v_pk_add_f32 v[96:97], v[96:97], v[120:121]
    v_pk_add_f32 v[98:99], v[98:99], v[122:123]
    s_waitcnt lgkmcnt(0)
    v_pk_add_f32 v[100:101], v[100:101], v[124:125]
    v_pk_add_f32 v[102:103], v[102:103], v[126:127]
    v_mov_b64 v[154:155], v[96:97]
    v_mov_b64 v[156:157], v[98:99]
    v_mov_b64 v[158:159], v[100:101]
    v_mov_b64 v[160:161], v[102:103]
    s_barrier
    s_add_u32 s57, s30, 1
    v_add_u32 v176, 0, v1
    v_min_u32 v176, 189, v176
    v_lshlrev_b32 v176, 4, v176
    v_add_u32 v177, 64, v1
    v_min_u32 v177, 189, v177
    v_lshlrev_b32 v177, 4, v177
    v_add_u32 v178, 128, v1
    v_min_u32 v178, 189, v178
    v_lshlrev_b32 v178, 4, v178
    s_mov_b32 s32, 12288
    s_mov_b32 s48, 0
P_155:
    buffer_load_dword v172, v176, s[4:7], s32 offen sc1
    buffer_load_dword v173, v177, s[4:7], s32 offen sc1
    buffer_load_dword v174, v178, s[4:7], s32 offen sc1
    s_waitcnt vmcnt(0)
    v_min_u32 v172, v172, v173
    v_min_u32 v172, v172, v174
    v_cmp_gt_u32 vcc, s57, v172
    s_cbranch_vccz P_156
    s_add_u32 s48, s48, 1
    s_cmp_gt_u32 s48, 200000
    s_cbranch_scc1 L_end
    s_sleep 1
    s_branch P_155
P_156:
    s_mul_i32 s54, s44, 40960
    s_add_u32 s56, s54, s52
    s_add_u32 s54, s54, s50
    s_waitcnt vmcnt(0) lgkmcnt(0)
    buffer_load_dwordx4 v[16:19], v0, s[4:7], s54 offen offset:0 sc1
    buffer_load_dwordx4 v[20:23], v0, s[4:7], s54 offen offset:1024 sc1
    buffer_load_dwordx4 v[24:27], v0, s[4:7], s54 offen offset:2048 sc1
    buffer_load_dwordx4 v[28:31], v0, s[4:7], s54 offen offset:3072 sc1
    s_add_u32 s54, s54, 4096
    buffer_load_dwordx4 v[32:35], v0, s[4:7], s54 offen offset:0 sc1
    buffer_load_dwordx4 v[36:39], v0, s[4:7], s54 offen offset:1024 sc1
    buffer_load_dwordx4 v[40:43], v0, s[4:7], s54 offen offset:2048 sc1
    buffer_load_dwordx4 v[44:47], v0, s[4:7], s54 offen offset:3072 sc1
    s_add_u32 s54, s54, 4096
    buffer_load_dwordx4 v[48:51], v0, s[4:7], s54 offen offset:0 sc1
    buffer_load_dwordx4 v[52:55], v0, s[4:7], s54 offen offset:1024 sc1
    buffer_load_dword v179, off, s[8:11], 0
G_157:
    s_add_u32 s45, s44, s47
    s_cmp_lt_u32 s45, 64
    s_cbranch_scc0 G_159
    s_mul_i32 s54, s45, 40960
    s_add_u32 s56, s54, s52
    s_add_u32 s54, s54, s50
    s_waitcnt vmcnt(10)
    v_mfma_f32_32x32x16_bf16 v[96:111], v[16:19], a[0:3], 0
    v_mfma_f32_32x32x16_bf16 v[112:127], v[16:19], a[40:43], 0
    buffer_load_dwordx4 v[56:59], v0, s[4:7], s54 offen offset:0 sc1
    s_waitcnt vmcnt(10)
    v_mfma_f32_32x32x16_bf16 v[96:111], v[20:23], a[4:7], v[96:111]
    v_mfma_f32_32x32x16_bf16 v[112:127], v[20:23], a[44:47], v[112:127]
    buffer_load_dwordx4 v[60:63], v0, s[4:7], s54 offen offset:1024 sc1
    s_waitcnt vmcnt(10)
    v_mfma_f32_32x32x16_bf16 v[96:111], v[24:27], a[8:11], v[96:111]
    v_mfma_f32_32x32x16_bf16 v[112:127], v[24:27], a[48:51], v[112:127]
    buffer_load_dwordx4 v[64:67], v0, s[4:7], s54 offen offset:2048 sc1
    s_waitcnt vmcnt(10)
    v_mfma_f32_32x32x16_bf16 v[96:111], v[28:31], a[12:15], v[96:111]
    v_mfma_f32_32x32x16_bf16 v[112:127], v[28:31], a[52:55], v[112:127]
    buffer_load_dwordx4 v[68:71], v0, s[4:7], s54 offen offset:3072 sc1
    s_waitcnt vmcnt(10)
    v_mfma_f32_32x32x16_bf16 v[96:111], v[32:35], a[16:19], v[96:111]
    v_mfma_f32_32x32x16_bf16 v[112:127], v[32:35], a[56:59], v[112:127]
    s_add_u32 s54, s54, 4096
    buffer_load_dwordx4 v[72:75], v0, s[4:7], s54 offen offset:0 sc1
    s_waitcnt vmcnt(10)
    v_mfma_f32_32x32x16_bf16 v[96:111], v[36:39], a[20:23], v[96:111]
    v_mfma_f32_32x32x16_bf16 v[112:127], v[36:39], a[60:63], v[112:127]
    buffer_load_dwordx4 v[76:79], v0, s[4:7], s54 offen offset:1024 sc1
    s_waitcnt vmcnt(10)
    v_mfma_f32_32x32x16_bf16 v[96:111], v[40:43], a[24:27], v[96:111]
    v_mfma_f32_32x32x16_bf16 v[112:127], v[40:43], a[64:67], v[112:127]
    buffer_load_dwordx4 v[80:83], v0, s[4:7], s54 offen offset:2048 sc1
    s_waitcnt vmcnt(10)
    v_mfma_f32_32x32x16_bf16 v[96:111], v[44:47], a[28:31], v[96:111]
    v_mfma_f32_32x32x16_bf16 v[112:127], v[44:47], a[68:71], v[112:127]
    buffer_load_dwordx4 v[84:87], v0, s[4:7], s54 offen offset:3072 sc1
    s_waitcnt vmcnt(10)
    v_mfma_f32_32x32x16_bf16 v[96:111], v[48:51], a[32:35], v[96:111]
    v_mfma_f32_32x32x16_bf16 v[112:127], v[48:51], a[72:75], v[112:127]
    s_add_u32 s54, s54, 4096
    buffer_load_dwordx4 v[88:91], v0, s[4:7], s54 offen offset:0 sc1
    s_waitcnt vmcnt(10)
    v_mfma_f32_32x32x16_bf16 v[96:111], v[52:55], a[36:39], v[96:111]
    v_mfma_f32_32x32x16_bf16 v[112:127], v[52:55], a[76:79], v[112:127]
    buffer_load_dwordx4 v[92:95], v0, s[4:7], s54 offen offset:1024 sc1
    s_mul_i32 s55, s44, s58
    s_add_u32 s55, s55, s51
    s_nop 0
    ds_write_b128 v4, v[96:99] offset:0
    v_mov_b64 v[128:129], 0
    s_mov_b32 s34, 0x3f803f80
    v_dot2c_f32_bf16 v128, s34, v16
    v_dot2c_f32_bf16 v129, v16, v16
    v_dot2c_f32_bf16 v128, s34, v17
    v_dot2c_f32_bf16 v129, v17, v17
    v_dot2c_f32_bf16 v128, s34, v18
    v_dot2c_f32_bf16 v129, v18, v18
    v_dot2c_f32_bf16 v128, s34, v19
    v_dot2c_f32_bf16 v129, v19, v19
    v_dot2c_f32_bf16 v128, s34, v20
    v_dot2c_f32_bf16 v129, v20, v20
    ds_write_b128 v4, v[100:103] offset:1024
    v_dot2c_f32_bf16 v128, s34, v21
    v_dot2c_f32_bf16 v129, v21, v21
    v_dot2c_f32_bf16 v128, s34, v22
    v_dot2c_f32_bf16 v129, v22, v22
    v_dot2c_f32_bf16 v128, s34, v23
    v_dot2c_f32_bf16 v129, v23, v23
    v_dot2c_f32_bf16 v128, s34, v24
    v_dot2c_f32_bf16 v129, v24, v24
    v_dot2c_f32_bf16 v128, s34, v25
    v_dot2c_f32_bf16 v129, v25, v25
    ds_write_b128 v4, v[104:107] offset:2048
    v_dot2c_f32_bf16 v128, s34, v26
    v_dot2c_f32_bf16 v129, v26, v26
    v_dot2c_f32_bf16 v128, s34, v27
    v_dot2c_f32_bf16 v129, v27, v27
    v_dot2c_f32_bf16 v128, s34, v28
    v_dot2c_f32_bf16 v129, v28, v28
    v_dot2c_f32_bf16 v128, s34, v29
    v_dot2c_f32_bf16 v129, v29, v29
    v_dot2c_f32_bf16 v128, s34, v30
    v_dot2c_f32_bf16 v129, v30, v30
    ds_write_b128 v4, v[108:111] offset:3072
    v_dot2c_f32_bf16 v128, s34, v31
    v_dot2c_f32_bf16 v129, v31, v31
    v_dot2c_f32_bf16 v128, s34, v32
    v_dot2c_f32_bf16 v129, v32, v32
    v_dot2c_f32_bf16 v128, s34, v33
    v_dot2c_f32_bf16 v129, v33, v33
    v_dot2c_f32_bf16 v128, s34, v34
    v_dot2c_f32_bf16 v129, v34, v34
    v_dot2c_f32_bf16 v128, s34, v35
    v_dot2c_f32_bf16 v129, v35, v35
    ds_write_b128 v4, v[112:115] offset:4096
    v_dot2c_f32_bf16 v128, s34, v36
    v_dot2c_f32_bf16 v129, v36, v36
    v_dot2c_f32_bf16 v128, s34, v37
    v_dot2c_f32_bf16 v129, v37, v37
    v_dot2c_f32_bf16 v128, s34, v38
    v_dot2c_f32_bf16 v129, v38, v38
    v_dot2c_f32_bf16 v128, s34, v39
    v_dot2c_f32_bf16 v129, v39, v39
    v_dot2c_f32_bf16 v128, s34, v40
    v_dot2c_f32_bf16 v129, v40, v40
    ds_write_b128 v4, v[116:119] offset:5120
    v_dot2c_f32_bf16 v128, s34, v41
    v_dot2c_f32_bf16 v129, v41, v41
    v_dot2c_f32_bf16 v128, s34, v42
    v_dot2c_f32_bf16 v129, v42, v42
    v_dot2c_f32_bf16 v128, s34, v43
    v_dot2c_f32_bf16 v129, v43, v43
    v_dot2c_f32_bf16 v128, s34, v44
    v_dot2c_f32_bf16 v129, v44, v44
    v_dot2c_f32_bf16 v128, s34, v45
    v_dot2c_f32_bf16 v129, v45, v45
    ds_write_b128 v4, v[120:123] offset:6144
    v_dot2c_f32_bf16 v128, s34, v46
    v_dot2c_f32_bf16 v129, v46, v46
    v_dot2c_f32_bf16 v128, s34, v47
    v_dot2c_f32_bf16 v129, v47, v47
    v_dot2c_f32_bf16 v128, s34, v48
    v_dot2c_f32_bf16 v129, v48, v48
    v_dot2c_f32_bf16 v128, s34, v49
    v_dot2c_f32_bf16 v129, v49, v49
    v_dot2c_f32_bf16 v128, s34, v50
    v_dot2c_f32_bf16 v129, v50, v50
    ds_write_b128 v4, v[124:127] offset:7168
    v_dot2c_f32_bf16 v128, s34, v51
    v_dot2c_f32_bf16 v129, v51, v51
    v_dot2c_f32_bf16 v128, s34, v52
    v_dot2c_f32_bf16 v129, v52, v52
    v_dot2c_f32_bf16 v128, s34, v53
    v_dot2c_f32_bf16 v129, v53, v53
    v_dot2c_f32_bf16 v128, s34, v54
    v_dot2c_f32_bf16 v129, v54, v54
    v_dot2c_f32_bf16 v128, s34, v55
    v_dot2c_f32_bf16 v129, v55, v55
    s_nop 2
    v_mov_b64 v[172:173], v[128:129]
    s_nop 1
    v_permlane32_swap_b32 v128, v172
    v_permlane32_swap_b32 v129, v173
    v_pk_add_f32 v[128:129], v[128:129], v[172:173]
    ds_write_b64 v5, v[128:129] offset:0
    s_waitcnt vmcnt(10)
    s_waitcnt lgkmcnt(0)
    s_barrier
    s_cmp_lg_u32 s29, 0
    s_cbranch_scc1 F_161
    s_lshl_b32 s32, s28, 2
    s_add_u32 s32, s32, s29
    s_lshl_b32 s32, s32, 2
    s_add_u32 s32, s32, 16384
    v_mov_b32 v178, s49
    s_mov_b64 exec, 1
    buffer_store_dword v178, off, s[4:7], s32 sc1
    s_mov_b64 exec, -1
F_161:
    s_add_u32 s49, s49, 1
    ds_read_b128 v[130:133], v6 offset:0
    ds_read_b128 v[134:137], v6 offset:16
    ds_read_b128 v[96:99], v3 offset:0
    ds_read_b128 v[100:103], v3 offset:1024
    ds_read_b128 v[104:107], v3 offset:8192
    ds_read_b128 v[108:111], v3 offset:9216
    ds_read_b128 v[112:115], v3 offset:16384
    ds_read_b128 v[116:119], v3 offset:17408
    ds_read_b128 v[120:123], v3 offset:24576
    ds_read_b128 v[124:127], v3 offset:25600
    s_waitcnt lgkmcnt(9)
    v_pk_add_f32 v[130:131], v[130:131], v[132:133]
    s_waitcnt lgkmcnt(8)
    v_pk_add_f32 v[134:135], v[134:135], v[136:137]
    v_pk_add_f32 v[130:131], v[130:131], v[134:135]
    v_mul_f32 v130, 0x3acccccd, v130
    v_mul_f32 v131, 0x3acccccd, v131
    v_fma_f32 v131, -v130, v130, v131
    v_max_f32 v131, 0, v131
    v_add_f32 v131, 0x3727c5ac, v131
    v_rsq_f32 v131, v131
    s_nop 0
    ds_write2_b32 v9, v130, v131 offset0:0 offset1:32
    ds_read_b128 v[138:141], v10 offset:0
    ds_read_b128 v[142:145], v10 offset:16
    ds_read_b128 v[146:149], v10 offset:128
    ds_read_b128 v[150:153], v10 offset:144
    s_waitcnt lgkmcnt(10)
    v_pk_add_f32 v[96:97], v[96:97], v[104:105]
    v_pk_add_f32 v[98:99], v[98:99], v[106:107]
    s_waitcnt lgkmcnt(9)
    v_pk_add_f32 v[100:101], v[100:101], v[108:109]
    v_pk_add_f32 v[102:103], v[102:103], v[110:111]
    s_waitcnt lgkmcnt(8)
    v_pk_add_f32 v[96:97], v[96:97], v[112:113]
    v_pk_add_f32 v[98:99], v[98:99], v[114:115]
    s_waitcnt lgkmcnt(7)
    v_pk_add_f32 v[100:101], v[100:101], v[116:117]
    v_pk_add_f32 v[102:103], v[102:103], v[118:119]
    s_waitcnt lgkmcnt(6)
    v_pk_add_f32 v[96:97], v[96:97], v[120:121]
    v_pk_add_f32 v[98:99], v[98:99], v[122:123]
    s_waitcnt lgkmcnt(5)
    v_pk_add_f32 v[100:101], v[100:101], v[124:125]
    v_pk_add_f32 v[102:103], v[102:103], v[126:127]
    s_waitcnt lgkmcnt(3)
    v_fma_f32 v96, -v138, v154, v96
    s_waitcnt lgkmcnt(1)
    v_mul_f32 v96, v96, v146
    v_fma_f32 v97, -v139, v155, v97
    v_mul_f32 v97, v97, v147
    v_fma_f32 v98, -v140, v156, v98
    v_mul_f32 v98, v98, v148
    v_fma_f32 v99, -v141, v157, v99
    v_mul_f32 v99, v99, v149
    v_fma_f32 v100, -v142, v158, v100
    s_waitcnt lgkmcnt(0)
    v_mul_f32 v100, v100, v150
    v_fma_f32 v101, -v143, v159, v101
    v_mul_f32 v101, v101, v151
    v_fma_f32 v102, -v144, v160, v102
    v_mul_f32 v102, v102, v152
    v_fma_f32 v103, -v145, v161, v103
    v_mul_f32 v103, v103, v153
    v_cvt_pk_bf16_f32 v172, v96, v97
    v_cvt_pk_bf16_f32 v173, v98, v99
    v_cvt_pk_bf16_f32 v174, v100, v101
    v_cvt_pk_bf16_f32 v175, v102, v103
    buffer_store_dwordx4 v[172:175], v7, s[4:7], s55 offen sc1
    s_mov_b32 s44, s45
    s_add_u32 s45, s44, s47
    s_cmp_lt_u32 s45, 64
    s_cbranch_scc0 G_160
    s_mul_i32 s54, s45, 40960
    s_add_u32 s56, s54, s52
    s_add_u32 s54, s54, s50
    s_waitcnt vmcnt(10)
    v_mfma_f32_32x32x16_bf16 v[96:111], v[56:59], a[0:3], 0
    v_mfma_f32_32x32x16_bf16 v[112:127], v[56:59], a[40:43], 0
    buffer_load_dwordx4 v[16:19], v0, s[4:7], s54 offen offset:0 sc1
    s_waitcnt vmcnt(10)
    v_mfma_f32_32x32x16_bf16 v[96:111], v[60:63], a[4:7], v[96:111]
    v_mfma_f32_32x32x16_bf16 v[112:127], v[60:63], a[44:47], v[112:127]
    buffer_load_dwordx4 v[20:23], v0, s[4:7], s54 offen offset:1024 sc1
    s_waitcnt vmcnt(10)
    v_mfma_f32_32x32x16_bf16 v[96:111], v[64:67], a[8:11], v[96:111]
    v_mfma_f32_32x32x16_bf16 v[112:127], v[64:67], a[48:51], v[112:127]
    buffer_load_dwordx4 v[24:27], v0, s[4:7], s54 offen offset:2048 sc1
    s_waitcnt vmcnt(10)
    v_mfma_f32_32x32x16_bf16 v[96:111], v[68:71], a[12:15], v[96:111]
    v_mfma_f32_32x32x16_bf16 v[112:127], v[68:71], a[52:55], v[112:127]
    buffer_load_dwordx4 v[28:31], v0, s[4:7], s54 offen offset:3072 sc1
    s_waitcnt vmcnt(10)
    v_mfma_f32_32x32x16_bf16 v[96:111], v[72:75], a[16:19], v[96:111]
    v_mfma_f32_32x32x16_bf16 v[112:127], v[72:75], a[56:59], v[112:127]
    s_add_u32 s54, s54, 4096
    buffer_load_dwordx4 v[32:35], v0, s[4:7], s54 offen offset:0 sc1
    s_waitcnt vmcnt(10)
    v_mfma_f32_32x32x16_bf16 v[96:111], v[76:79], a[20:23], v[96:111]
    v_mfma_f32_32x32x16_bf16 v[112:127], v[76:79], a[60:63], v[112:127]
    buffer_load_dwordx4 v[36:39], v0, s[4:7], s54 offen offset:1024 sc1
    s_waitcnt vmcnt(10)
    v_mfma_f32_32x32x16_bf16 v[96:111], v[80:83], a[24:27], v[96:111]
    v_mfma_f32_32x32x16_bf16 v[112:127], v[80:83], a[64:67], v[112:127]
    buffer_load_dwordx4 v[40:43], v0, s[4:7], s54 offen offset:2048 sc1
    s_waitcnt vmcnt(10)
    v_mfma_f32_32x32x16_bf16 v[96:111], v[84:87], a[28:31], v[96:111]
    v_mfma_f32_32x32x16_bf16 v[112:127], v[84:87], a[68:71], v[112:127]
    buffer_load_dwordx4 v[44:47], v0, s[4:7], s54 offen offset:3072 sc1
    s_waitcnt vmcnt(10)
    v_mfma_f32_32x32x16_bf16 v[96:111], v[88:91], a[32:35], v[96:111]
    v_mfma_f32_32x32x16_bf16 v[112:127], v[88:91], a[72:75], v[112:127]
    s_add_u32 s54, s54, 4096
    buffer_load_dwordx4 v[48:51], v0, s[4:7], s54 offen offset:0 sc1
    s_waitcnt vmcnt(10)
    v_mfma_f32_32x32x16_bf16 v[96:111], v[92:95], a[36:39], v[96:111]
    v_mfma_f32_32x32x16_bf16 v[112:127], v[92:95], a[76:79], v[112:127]
    buffer_load_dwordx4 v[52:55], v0, s[4:7], s54 offen offset:1024 sc1
    s_mul_i32 s55, s44, s58
    s_add_u32 s55, s55, s51
    s_nop 0
    ds_write_b128 v4, v[96:99] offset:32768
    v_mov_b64 v[128:129], 0
    s_mov_b32 s34, 0x3f803f80
    v_dot2c_f32_bf16 v128, s34, v56
    v_dot2c_f32_bf16 v129, v56, v56
    v_dot2c_f32_bf16 v128, s34, v57
    v_dot2c_f32_bf16 v129, v57, v57
    v_dot2c_f32_bf16 v128, s34, v58
    v_dot2c_f32_bf16 v129, v58, v58
    v_dot2c_f32_bf16 v128, s34, v59
    v_dot2c_f32_bf16 v129, v59, v59
    v_dot2c_f32_bf16 v128, s34, v60
    v_dot2c_f32_bf16 v129, v60, v60
    ds_write_b128 v4, v[100:103] offset:33792
    v_dot2c_f32_bf16 v128, s34, v61
    v_dot2c_f32_bf16 v129, v61, v61
    v_dot2c_f32_bf16 v128, s34, v62
    v_dot2c_f32_bf16 v129, v62, v62
    v_dot2c_f32_bf16 v128, s34, v63
    v_dot2c_f32_bf16 v129, v63, v63
    v_dot2c_f32_bf16 v128, s34, v64
    v_dot2c_f32_bf16 v129, v64, v64
    v_dot2c_f32_bf16 v128, s34, v65
    v_dot2c_f32_bf16 v129, v65, v65
    ds_write_b128 v4, v[104:107] offset:34816
    v_dot2c_f32_bf16 v128, s34, v66
    v_dot2c_f32_bf16 v129, v66, v66
    v_dot2c_f32_bf16 v128, s34, v67
    v_dot2c_f32_bf16 v129, v67, v67
    v_dot2c_f32_bf16 v128, s34, v68
    v_dot2c_f32_bf16 v129, v68, v68
    v_dot2c_f32_bf16 v128, s34, v69
    v_dot2c_f32_bf16 v129, v69, v69
    v_dot2c_f32_bf16 v128, s34, v70
    v_dot2c_f32_bf16 v129, v70, v70
    ds_write_b128 v4, v[108:111] offset:35840
    v_dot2c_f32_bf16 v128, s34, v71
    v_dot2c_f32_bf16 v129, v71, v71
    v_dot2c_f32_bf16 v128, s34, v72
    v_dot2c_f32_bf16 v129, v72, v72
    v_dot2c_f32_bf16 v128, s34, v73
    v_dot2c_f32_bf16 v129, v73, v73
    v_dot2c_f32_bf16 v128, s34, v74
    v_dot2c_f32_bf16 v129, v74, v74
    v_dot2c_f32_bf16 v128, s34, v75
    v_dot2c_f32_bf16 v129, v75, v75
    ds_write_b128 v4, v[112:115] offset:36864
    v_dot2c_f32_bf16 v128, s34, v76
    v_dot2c_f32_bf16 v129, v76, v76
    v_dot2c_f32_bf16 v128, s34, v77
    v_dot2c_f32_bf16 v129, v77, v77
    v_dot2c_f32_bf16 v128, s34, v78
    v_dot2c_f32_bf16 v129, v78, v78
    v_dot2c_f32_bf16 v128, s34, v79
    v_dot2c_f32_bf16 v129, v79, v79
    v_dot2c_f32_bf16 v128, s34, v80
    v_dot2c_f32_bf16 v129, v80, v80
    ds_write_b128 v4, v[116:119] offset:37888
    v_dot2c_f32_bf16 v128, s34, v81
    v_dot2c_f32_bf16 v129, v81, v81
    v_dot2c_f32_bf16 v128, s34, v82
    v_dot2c_f32_bf16 v129, v82, v82
    v_dot2c_f32_bf16 v128, s34, v83
    v_dot2c_f32_bf16 v129, v83, v83
    v_dot2c_f32_bf16 v128, s34, v84
    v_dot2c_f32_bf16 v129, v84, v84
    v_dot2c_f32_bf16 v128, s34, v85
    v_dot2c_f32_bf16 v129, v85, v85
    ds_write_b128 v4, v[120:123] offset:38912
    v_dot2c_f32_bf16 v128, s34, v86
    v_dot2c_f32_bf16 v129, v86, v86
    v_dot2c_f32_bf16 v128, s34, v87
    v_dot2c_f32_bf16 v129, v87, v87
    v_dot2c_f32_bf16 v128, s34, v88
    v_dot2c_f32_bf16 v129, v88, v88
    v_dot2c_f32_bf16 v128, s34, v89
    v_dot2c_f32_bf16 v129, v89, v89
    v_dot2c_f32_bf16 v128, s34, v90
    v_dot2c_f32_bf16 v129, v90, v90
    ds_write_b128 v4, v[124:127] offset:39936
    v_dot2c_f32_bf16 v128, s34, v91
    v_dot2c_f32_bf16 v129, v91, v91
    v_dot2c_f32_bf16 v128, s34, v92
    v_dot2c_f32_bf16 v129, v92, v92
    v_dot2c_f32_bf16 v128, s34, v93
    v_dot2c_f32_bf16 v129, v93, v93
    v_dot2c_f32_bf16 v128, s34, v94
    v_dot2c_f32_bf16 v129, v94, v94
    v_dot2c_f32_bf16 v128, s34, v95
    v_dot2c_f32_bf16 v129, v95, v95
    s_nop 2
    v_mov_b64 v[172:173], v[128:129]
    s_nop 1
    v_permlane32_swap_b32 v128, v172
    v_permlane32_swap_b32 v129, v173
    v_pk_add_f32 v[128:129], v[128:129], v[172:173]
    ds_write_b64 v5, v[128:129] offset:1024
    s_waitcnt vmcnt(10)
    s_waitcnt lgkmcnt(0)
    s_barrier
    s_cmp_lg_u32 s29, 0
    s_cbranch_scc1 F_162
    s_lshl_b32 s32, s28, 2
    s_add_u32 s32, s32, s29
    s_lshl_b32 s32, s32, 2
    s_add_u32 s32, s32, 16384
    v_mov_b32 v178, s49
    s_mov_b64 exec, 1
    buffer_store_dword v178, off, s[4:7], s32 sc1
    s_mov_b64 exec, -1
F_162:
    s_add_u32 s49, s49, 1
    ds_read_b128 v[130:133], v6 offset:1024
    ds_read_b128 v[134:137], v6 offset:1040
    ds_read_b128 v[96:99], v3 offset:32768
    ds_read_b128 v[100:103], v3 offset:33792
    ds_read_b128 v[104:107], v3 offset:40960
    ds_read_b128 v[108:111], v3 offset:41984
    ds_read_b128 v[112:115], v3 offset:49152
    ds_read_b128 v[116:119], v3 offset:50176
    ds_read_b128 v[120:123], v3 offset:57344
    ds_read_b128 v[124:127], v3 offset:58368
    s_waitcnt lgkmcnt(9)
    v_pk_add_f32 v[130:131], v[130:131], v[132:133]
    s_waitcnt lgkmcnt(8)
    v_pk_add_f32 v[134:135], v[134:135], v[136:137]
    v_pk_add_f32 v[130:131], v[130:131], v[134:135]
    v_mul_f32 v130, 0x3acccccd, v130
    v_mul_f32 v131, 0x3acccccd, v131
    v_fma_f32 v131, -v130, v130, v131
    v_max_f32 v131, 0, v131
    v_add_f32 v131, 0x3727c5ac, v131
    v_rsq_f32 v131, v131
    s_nop 0
    ds_write2_b32 v9, v130, v131 offset0:0 offset1:32
    ds_read_b128 v[138:141], v10 offset:0
    ds_read_b128 v[142:145], v10 offset:16
    ds_read_b128 v[146:149], v10 offset:128
    ds_read_b128 v[150:153], v10 offset:144
    s_waitcnt lgkmcnt(10)
    v_pk_add_f32 v[96:97], v[96:97], v[104:105]
    v_pk_add_f32 v[98:99], v[98:99], v[106:107]
    s_waitcnt lgkmcnt(9)
    v_pk_add_f32 v[100:101], v[100:101], v[108:109]
    v_pk_add_f32 v[102:103], v[102:103], v[110:111]
    s_waitcnt lgkmcnt(8)
    v_pk_add_f32 v[96:97], v[96:97], v[112:113]
    v_pk_add_f32 v[98:99], v[98:99], v[114:115]
    s_waitcnt lgkmcnt(7)
    v_pk_add_f32 v[100:101], v[100:101], v[116:117]
    v_pk_add_f32 v[102:103], v[102:103], v[118:119]
    s_waitcnt lgkmcnt(6)
    v_pk_add_f32 v[96:97], v[96:97], v[120:121]
    v_pk_add_f32 v[98:99], v[98:99], v[122:123]
    s_waitcnt lgkmcnt(5)
    v_pk_add_f32 v[100:101], v[100:101], v[124:125]
    v_pk_add_f32 v[102:103], v[102:103], v[126:127]
    s_waitcnt lgkmcnt(3)
    v_fma_f32 v96, -v138, v154, v96
    s_waitcnt lgkmcnt(1)
    v_mul_f32 v96, v96, v146
    v_fma_f32 v97, -v139, v155, v97
    v_mul_f32 v97, v97, v147
    v_fma_f32 v98, -v140, v156, v98
    v_mul_f32 v98, v98, v148
    v_fma_f32 v99, -v141, v157, v99
    v_mul_f32 v99, v99, v149
    v_fma_f32 v100, -v142, v158, v100
    s_waitcnt lgkmcnt(0)
    v_mul_f32 v100, v100, v150
    v_fma_f32 v101, -v143, v159, v101
    v_mul_f32 v101, v101, v151
    v_fma_f32 v102, -v144, v160, v102
    v_mul_f32 v102, v102, v152
    v_fma_f32 v103, -v145, v161, v103
    v_mul_f32 v103, v103, v153
    v_cvt_pk_bf16_f32 v172, v96, v97
    v_cvt_pk_bf16_f32 v173, v98, v99
    v_cvt_pk_bf16_f32 v174, v100, v101
    v_cvt_pk_bf16_f32 v175, v102, v103
    buffer_store_dwordx4 v[172:175], v7, s[4:7], s55 offen sc1
    s_mov_b32 s44, s45
    s_branch G_157
G_159:
    s_waitcnt vmcnt(10)
    v_mfma_f32_32x32x16_bf16 v[96:111], v[16:19], a[0:3], 0
    v_mfma_f32_32x32x16_bf16 v[112:127], v[16:19], a[40:43], 0
    s_waitcnt vmcnt(9)
    v_mfma_f32_32x32x16_bf16 v[96:111], v[20:23], a[4:7], v[96:111]
    v_mfma_f32_32x32x16_bf16 v[112:127], v[20:23], a[44:47], v[112:127]
    s_waitcnt vmcnt(8)
    v_mfma_f32_32x32x16_bf16 v[96:111], v[24:27], a[8:11], v[96:111]
    v_mfma_f32_32x32x16_bf16 v[112:127], v[24:27], a[48:51], v[112:127]
    s_waitcnt vmcnt(7)
    v_mfma_f32_32x32x16_bf16 v[96:111], v[28:31], a[12:15], v[96:111]
    v_mfma_f32_32x32x16_bf16 v[112:127], v[28:31], a[52:55], v[112:127]
    s_waitcnt vmcnt(6)
    v_mfma_f32_32x32x16_bf16 v[96:111], v[32:35], a[16:19], v[96:111]
    v_mfma_f32_32x32x16_bf16 v[112:127], v[32:35], a[56:59], v[112:127]
    s_waitcnt vmcnt(5)
    v_mfma_f32_32x32x16_bf16 v[96:111], v[36:39], a[20:23], v[96:111]
    v_mfma_f32_32x32x16_bf16 v[112:127], v[36:39], a[60:63], v[112:127]
    s_waitcnt vmcnt(4)
    v_mfma_f32_32x32x16_bf16 v[96:111], v[40:43], a[24:27], v[96:111]
    v_mfma_f32_32x32x16_bf16 v[112:127], v[40:43], a[64:67], v[112:127]
    s_waitcnt vmcnt(3)
    v_mfma_f32_32x32x16_bf16 v[96:111], v[44:47], a[28:31], v[96:111]
    v_mfma_f32_32x32x16_bf16 v[112:127], v[44:47], a[68:71], v[112:127]
    s_waitcnt vmcnt(2)
    v_mfma_f32_32x32x16_bf16 v[96:111], v[48:51], a[32:35], v[96:111]
    v_mfma_f32_32x32x16_bf16 v[112:127], v[48:51], a[72:75], v[112:127]
    s_waitcnt vmcnt(1)
    v_mfma_f32_32x32x16_bf16 v[96:111], v[52:55], a[36:39], v[96:111]
    v_mfma_f32_32x32x16_bf16 v[112:127], v[52:55], a[76:79], v[112:127]
    s_mul_i32 s55, s44, s58
    s_add_u32 s55, s55, s51
    s_nop 1
    ds_write_b128 v4, v[96:99] offset:0
    v_mov_b64 v[128:129], 0
    s_mov_b32 s34, 0x3f803f80
    v_dot2c_f32_bf16 v128, s34, v16
    v_dot2c_f32_bf16 v129, v16, v16
    v_dot2c_f32_bf16 v128, s34, v17
    v_dot2c_f32_bf16 v129, v17, v17
    v_dot2c_f32_bf16 v128, s34, v18
    v_dot2c_f32_bf16 v129, v18, v18
    v_dot2c_f32_bf16 v128, s34, v19
    v_dot2c_f32_bf16 v129, v19, v19
    v_dot2c_f32_bf16 v128, s34, v20
    v_dot2c_f32_bf16 v129, v20, v20
    ds_write_b128 v4, v[100:103] offset:1024
    v_dot2c_f32_bf16 v128, s34, v21
    v_dot2c_f32_bf16 v129, v21, v21
    v_dot2c_f32_bf16 v128, s34, v22
    v_dot2c_f32_bf16 v129, v22, v22
    v_dot2c_f32_bf16 v128, s34, v23
    v_dot2c_f32_bf16 v129, v23, v23
    v_dot2c_f32_bf16 v128, s34, v24
    v_dot2c_f32_bf16 v129, v24, v24
    v_dot2c_f32_bf16 v128, s34, v25
    v_dot2c_f32_bf16 v129, v25, v25
    ds_write_b128 v4, v[104:107] offset:2048
    v_dot2c_f32_bf16 v128, s34, v26
    v_dot2c_f32_bf16 v129, v26, v26
    v_dot2c_f32_bf16 v128, s34, v27
    v_dot2c_f32_bf16 v129, v27, v27
    v_dot2c_f32_bf16 v128, s34, v28
    v_dot2c_f32_bf16 v129, v28, v28
    v_dot2c_f32_bf16 v128, s34, v29
    v_dot2c_f32_bf16 v129, v29, v29
    v_dot2c_f32_bf16 v128, s34, v30
    v_dot2c_f32_bf16 v129, v30, v30
    ds_write_b128 v4, v[108:111] offset:3072
    v_dot2c_f32_bf16 v128, s34, v31
    v_dot2c_f32_bf16 v129, v31, v31
    v_dot2c_f32_bf16 v128, s34, v32
    v_dot2c_f32_bf16 v129, v32, v32
    v_dot2c_f32_bf16 v128, s34, v33
    v_dot2c_f32_bf16 v129, v33, v33
    v_dot2c_f32_bf16 v128, s34, v34
    v_dot2c_f32_bf16 v129, v34, v34
    v_dot2c_f32_bf16 v128, s34, v35
    v_dot2c_f32_bf16 v129, v35, v35
    ds_write_b128 v4, v[112:115] offset:4096
    v_dot2c_f32_bf16 v128, s34, v36
    v_dot2c_f32_bf16 v129, v36, v36
    v_dot2c_f32_bf16 v128, s34, v37
    v_dot2c_f32_bf16 v129, v37, v37
    v_dot2c_f32_bf16 v128, s34, v38
    v_dot2c_f32_bf16 v129, v38, v38
    v_dot2c_f32_bf16 v128, s34, v39
    v_dot2c_f32_bf16 v129, v39, v39
    v_dot2c_f32_bf16 v128, s34, v40
    v_dot2c_f32_bf16 v129, v40, v40
    ds_write_b128 v4, v[116:119] offset:5120
    v_dot2c_f32_bf16 v128, s34, v41
    v_dot2c_f32_bf16 v129, v41, v41
    v_dot2c_f32_bf16 v128, s34, v42
    v_dot2c_f32_bf16 v129, v42, v42
    v_dot2c_f32_bf16 v128, s34, v43
    v_dot2c_f32_bf16 v129, v43, v43
    v_dot2c_f32_bf16 v128, s34, v44
    v_dot2c_f32_bf16 v129, v44, v44
    v_dot2c_f32_bf16 v128, s34, v45
    v_dot2c_f32_bf16 v129, v45, v45
    ds_write_b128 v4, v[120:123] offset:6144
    v_dot2c_f32_bf16 v128, s34, v46
    v_dot2c_f32_bf16 v129, v46, v46
    v_dot2c_f32_bf16 v128, s34, v47
    v_dot2c_f32_bf16 v129, v47, v47
    v_dot2c_f32_bf16 v128, s34, v48
    v_dot2c_f32_bf16 v129, v48, v48
    v_dot2c_f32_bf16 v128, s34, v49
    v_dot2c_f32_bf16 v129, v49, v49
    v_dot2c_f32_bf16 v128, s34, v50
    v_dot2c_f32_bf16 v129, v50, v50
    ds_write_b128 v4, v[124:127] offset:7168
    v_dot2c_f32_bf16 v128, s34, v51
    v_dot2c_f32_bf16 v129, v51, v51
    v_dot2c_f32_bf16 v128, s34, v52
    v_dot2c_f32_bf16 v129, v52, v52
    v_dot2c_f32_bf16 v128, s34, v53
    v_dot2c_f32_bf16 v129, v53, v53
    v_dot2c_f32_bf16 v128, s34, v54
    v_dot2c_f32_bf16 v129, v54, v54
    v_dot2c_f32_bf16 v128, s34, v55
    v_dot2c_f32_bf16 v129, v55, v55
    s_nop 2
    v_mov_b64 v[172:173], v[128:129]
    s_nop 1
    v_permlane32_swap_b32 v128, v172
    v_permlane32_swap_b32 v129, v173
    v_pk_add_f32 v[128:129], v[128:129], v[172:173]
    ds_write_b64 v5, v[128:129] offset:0
    s_waitcnt vmcnt(0)
    s_waitcnt lgkmcnt(0)
    s_barrier
    s_cmp_lg_u32 s29, 0
    s_cbranch_scc1 F_163
    s_lshl_b32 s32, s28, 2
    s_add_u32 s32, s32, s29
    s_lshl_b32 s32, s32, 2
    s_add_u32 s32, s32, 16384
    v_mov_b32 v178, s49
    s_mov_b64 exec, 1
    buffer_store_dword v178, off, s[4:7], s32 sc1
    s_mov_b64 exec, -1
F_163:
    s_add_u32 s49, s49, 1
    ds_read_b128 v[130:133], v6 offset:0
    ds_read_b128 v[134:137], v6 offset:16
    ds_read_b128 v[96:99], v3 offset:0
    ds_read_b128 v[100:103], v3 offset:1024
    ds_read_b128 v[104:107], v3 offset:8192
    ds_read_b128 v[108:111], v3 offset:9216
    ds_read_b128 v[112:115], v3 offset:16384
    ds_read_b128 v[116:119], v3 offset:17408
    ds_read_b128 v[120:123], v3 offset:24576
    ds_read_b128 v[124:127], v3 offset:25600
    s_waitcnt lgkmcnt(9)
    v_pk_add_f32 v[130:131], v[130:131], v[132:133]
    s_waitcnt lgkmcnt(8)
    v_pk_add_f32 v[134:135], v[134:135], v[136:137]
    v_pk_add_f32 v[130:131], v[130:131], v[134:135]
    v_mul_f32 v130, 0x3acccccd, v130
    v_mul_f32 v131, 0x3acccccd, v131
    v_fma_f32 v131, -v130, v130, v131
    v_max_f32 v131, 0, v131
    v_add_f32 v131, 0x3727c5ac, v131
    v_rsq_f32 v131, v131
    s_nop 0
    ds_write2_b32 v9, v130, v131 offset0:0 offset1:32
    ds_read_b128 v[138:141], v10 offset:0
    ds_read_b128 v[142:145], v10 offset:16
    ds_read_b128 v[146:149], v10 offset:128
    ds_read_b128 v[150:153], v10 offset:144
    s_waitcnt lgkmcnt(10)
    v_pk_add_f32 v[96:97], v[96:97], v[104:105]
    v_pk_add_f32 v[98:99], v[98:99], v[106:107]
    s_waitcnt lgkmcnt(9)
    v_pk_add_f32 v[100:101], v[100:101], v[108:109]
    v_pk_add_f32 v[102:103], v[102:103], v[110:111]
    s_waitcnt lgkmcnt(8)
    v_pk_add_f32 v[96:97], v[96:97], v[112:113]
    v_pk_add_f32 v[98:99], v[98:99], v[114:115]
    s_waitcnt lgkmcnt(7)
    v_pk_add_f32 v[100:101], v[100:101], v[116:117]
    v_pk_add_f32 v[102:103], v[102:103], v[118:119]
    s_waitcnt lgkmcnt(6)
    v_pk_add_f32 v[96:97], v[96:97], v[120:121]
    v_pk_add_f32 v[98:99], v[98:99], v[122:123]
    s_waitcnt lgkmcnt(5)
    v_pk_add_f32 v[100:101], v[100:101], v[124:125]
    v_pk_add_f32 v[102:103], v[102:103], v[126:127]
    s_waitcnt lgkmcnt(3)
    v_fma_f32 v96, -v138, v154, v96
    s_waitcnt lgkmcnt(1)
    v_mul_f32 v96, v96, v146
    v_fma_f32 v97, -v139, v155, v97
    v_mul_f32 v97, v97, v147
    v_fma_f32 v98, -v140, v156, v98
    v_mul_f32 v98, v98, v148
    v_fma_f32 v99, -v141, v157, v99
    v_mul_f32 v99, v99, v149
    v_fma_f32 v100, -v142, v158, v100
    s_waitcnt lgkmcnt(0)
    v_mul_f32 v100, v100, v150
    v_fma_f32 v101, -v143, v159, v101
    v_mul_f32 v101, v101, v151
    v_fma_f32 v102, -v144, v160, v102
    v_mul_f32 v102, v102, v152
    v_fma_f32 v103, -v145, v161, v103
    v_mul_f32 v103, v103, v153
    v_cvt_pk_bf16_f32 v172, v96, v97
    v_cvt_pk_bf16_f32 v173, v98, v99
    v_cvt_pk_bf16_f32 v174, v100, v101
    v_cvt_pk_bf16_f32 v175, v102, v103
    buffer_store_dwordx4 v[172:175], v7, s[4:7], s55 offen sc1
    s_branch G_158
G_160:
    s_waitcnt vmcnt(10)
    v_mfma_f32_32x32x16_bf16 v[96:111], v[56:59], a[0:3], 0
    v_mfma_f32_32x32x16_bf16 v[112:127], v[56:59], a[40:43], 0
    s_waitcnt vmcnt(9)
    v_mfma_f32_32x32x16_bf16 v[96:111], v[60:63], a[4:7], v[96:111]
    v_mfma_f32_32x32x16_bf16 v[112:127], v[60:63], a[44:47], v[112:127]
    s_waitcnt vmcnt(8)
    v_mfma_f32_32x32x16_bf16 v[96:111], v[64:67], a[8:11], v[96:111]
    v_mfma_f32_32x32x16_bf16 v[112:127], v[64:67], a[48:51], v[112:127]
    s_waitcnt vmcnt(7)
    v_mfma_f32_32x32x16_bf16 v[96:111], v[68:71], a[12:15], v[96:111]
    v_mfma_f32_32x32x16_bf16 v[112:127], v[68:71], a[52:55], v[112:127]
    s_waitcnt vmcnt(6)
    v_mfma_f32_32x32x16_bf16 v[96:111], v[72:75], a[16:19], v[96:111]
    v_mfma_f32_32x32x16_bf16 v[112:127], v[72:75], a[56:59], v[112:127]
    s_waitcnt vmcnt(5)
    v_mfma_f32_32x32x16_bf16 v[96:111], v[76:79], a[20:23], v[96:111]
    v_mfma_f32_32x32x16_bf16 v[112:127], v[76:79], a[60:63], v[112:127]
    s_waitcnt vmcnt(4)
    v_mfma_f32_32x32x16_bf16 v[96:111], v[80:83], a[24:27], v[96:111]
    v_mfma_f32_32x32x16_bf16 v[112:127], v[80:83], a[64:67], v[112:127]
    s_waitcnt vmcnt(3)
    v_mfma_f32_32x32x16_bf16 v[96:111], v[84:87], a[28:31], v[96:111]
    v_mfma_f32_32x32x16_bf16 v[112:127], v[84:87], a[68:71], v[112:127]
    s_waitcnt vmcnt(2)
    v_mfma_f32_32x32x16_bf16 v[96:111], v[88:91], a[32:35], v[96:111]
    v_mfma_f32_32x32x16_bf16 v[112:127], v[88:91], a[72:75], v[112:127]
    s_waitcnt vmcnt(1)
    v_mfma_f32_32x32x16_bf16 v[96:111], v[92:95], a[36:39], v[96:111]
    v_mfma_f32_32x32x16_bf16 v[112:127], v[92:95], a[76:79], v[112:127]
    s_mul_i32 s55, s44, s58
    s_add_u32 s55, s55, s51
    s_nop 1
    ds_write_b128 v4, v[96:99] offset:32768
    v_mov_b64 v[128:129], 0
    s_mov_b32 s34, 0x3f803f80
    v_dot2c_f32_bf16 v128, s34, v56
    v_dot2c_f32_bf16 v129, v56, v56
    v_dot2c_f32_bf16 v128, s34, v57
    v_dot2c_f32_bf16 v129, v57, v57
    v_dot2c_f32_bf16 v128, s34, v58
    v_dot2c_f32_bf16 v129, v58, v58
    v_dot2c_f32_bf16 v128, s34, v59
    v_dot2c_f32_bf16 v129, v59, v59
    v_dot2c_f32_bf16 v128, s34, v60
    v_dot2c_f32_bf16 v129, v60, v60
    ds_write_b128 v4, v[100:103] offset:33792
    v_dot2c_f32_bf16 v128, s34, v61
    v_dot2c_f32_bf16 v129, v61, v61
    v_dot2c_f32_bf16 v128, s34, v62
    v_dot2c_f32_bf16 v129, v62, v62
    v_dot2c_f32_bf16 v128, s34, v63
    v_dot2c_f32_bf16 v129, v63, v63
    v_dot2c_f32_bf16 v128, s34, v64
    v_dot2c_f32_bf16 v129, v64, v64
    v_dot2c_f32_bf16 v128, s34, v65
    v_dot2c_f32_bf16 v129, v65, v65
    ds_write_b128 v4, v[104:107] offset:34816
    v_dot2c_f32_bf16 v128, s34, v66
    v_dot2c_f32_bf16 v129, v66, v66
    v_dot2c_f32_bf16 v128, s34, v67
    v_dot2c_f32_bf16 v129, v67, v67
    v_dot2c_f32_bf16 v128, s34, v68
    v_dot2c_f32_bf16 v129, v68, v68
    v_dot2c_f32_bf16 v128, s34, v69
    v_dot2c_f32_bf16 v129, v69, v69
    v_dot2c_f32_bf16 v128, s34, v70
    v_dot2c_f32_bf16 v129, v70, v70
    ds_write_b128 v4, v[108:111] offset:35840
    v_dot2c_f32_bf16 v128, s34, v71
    v_dot2c_f32_bf16 v129, v71, v71
    v_dot2c_f32_bf16 v128, s34, v72
    v_dot2c_f32_bf16 v129, v72, v72
    v_dot2c_f32_bf16 v128, s34, v73
    v_dot2c_f32_bf16 v129, v73, v73
    v_dot2c_f32_bf16 v128, s34, v74
    v_dot2c_f32_bf16 v129, v74, v74
    v_dot2c_f32_bf16 v128, s34, v75
    v_dot2c_f32_bf16 v129, v75, v75
    ds_write_b128 v4, v[112:115] offset:36864
    v_dot2c_f32_bf16 v128, s34, v76
    v_dot2c_f32_bf16 v129, v76, v76
    v_dot2c_f32_bf16 v128, s34, v77
    v_dot2c_f32_bf16 v129, v77, v77
    v_dot2c_f32_bf16 v128, s34, v78
    v_dot2c_f32_bf16 v129, v78, v78
    v_dot2c_f32_bf16 v128, s34, v79
    v_dot2c_f32_bf16 v129, v79, v79
    v_dot2c_f32_bf16 v128, s34, v80
    v_dot2c_f32_bf16 v129, v80, v80
    ds_write_b128 v4, v[116:119] offset:37888
    v_dot2c_f32_bf16 v128, s34, v81
    v_dot2c_f32_bf16 v129, v81, v81
    v_dot2c_f32_bf16 v128, s34, v82
    v_dot2c_f32_bf16 v129, v82, v82
    v_dot2c_f32_bf16 v128, s34, v83
    v_dot2c_f32_bf16 v129, v83, v83
    v_dot2c_f32_bf16 v128, s34, v84
    v_dot2c_f32_bf16 v129, v84, v84
    v_dot2c_f32_bf16 v128, s34, v85
    v_dot2c_f32_bf16 v129, v85, v85
    ds_write_b128 v4, v[120:123] offset:38912
    v_dot2c_f32_bf16 v128, s34, v86
    v_dot2c_f32_bf16 v129, v86, v86
    v_dot2c_f32_bf16 v128, s34, v87
    v_dot2c_f32_bf16 v129, v87, v87
    v_dot2c_f32_bf16 v128, s34, v88
    v_dot2c_f32_bf16 v129, v88, v88
    v_dot2c_f32_bf16 v128, s34, v89
    v_dot2c_f32_bf16 v129, v89, v89
    v_dot2c_f32_bf16 v128, s34, v90
    v_dot2c_f32_bf16 v129, v90, v90
    ds_write_b128 v4, v[124:127] offset:39936
    v_dot2c_f32_bf16 v128, s34, v91
    v_dot2c_f32_bf16 v129, v91, v91
    v_dot2c_f32_bf16 v128, s34, v92
    v_dot2c_f32_bf16 v129, v92, v92
    v_dot2c_f32_bf16 v128, s34, v93
    v_dot2c_f32_bf16 v129, v93, v93
    v_dot2c_f32_bf16 v128, s34, v94
    v_dot2c_f32_bf16 v129, v94, v94
    v_dot2c_f32_bf16 v128, s34, v95
    v_dot2c_f32_bf16 v129, v95, v95
    s_nop 2
    v_mov_b64 v[172:173], v[128:129]
    s_nop 1
    v_permlane32_swap_b32 v128, v172
    v_permlane32_swap_b32 v129, v173
    v_pk_add_f32 v[128:129], v[128:129], v[172:173]
    ds_write_b64 v5, v[128:129] offset:1024
    s_waitcnt vmcnt(0)
    s_waitcnt lgkmcnt(0)
    s_barrier
    s_cmp_lg_u32 s29, 0
    s_cbranch_scc1 F_164
    s_lshl_b32 s32, s28, 2
    s_add_u32 s32, s32, s29
    s_lshl_b32 s32, s32, 2
    s_add_u32 s32, s32, 16384
    v_mov_b32 v178, s49
    s_mov_b64 exec, 1
    buffer_store_dword v178, off, s[4:7], s32 sc1
    s_mov_b64 exec, -1
F_164:
    s_add_u32 s49, s49, 1
    ds_read_b128 v[130:133], v6 offset:1024
    ds_read_b128 v[134:137], v6 offset:1040
    ds_read_b128 v[96:99], v3 offset:32768
    ds_read_b128 v[100:103], v3 offset:33792
    ds_read_b128 v[104:107], v3 offset:40960
    ds_read_b128 v[108:111], v3 offset:41984
    ds_read_b128 v[112:115], v3 offset:49152
    ds_read_b128 v[116:119], v3 offset:50176
    ds_read_b128 v[120:123], v3 offset:57344
    ds_read_b128 v[124:127], v3 offset:58368
    s_waitcnt lgkmcnt(9)
    v_pk_add_f32 v[130:131], v[130:131], v[132:133]
    s_waitcnt lgkmcnt(8)
    v_pk_add_f32 v[134:135], v[134:135], v[136:137]
    v_pk_add_f32 v[130:131], v[130:131], v[134:135]
    v_mul_f32 v130, 0x3acccccd, v130
    v_mul_f32 v131, 0x3acccccd, v131
    v_fma_f32 v131, -v130, v130, v131
    v_max_f32 v131, 0, v131
    v_add_f32 v131, 0x3727c5ac, v131
    v_rsq_f32 v131, v131
    s_nop 0
    ds_write2_b32 v9, v130, v131 offset0:0 offset1:32
    ds_read_b128 v[138:141], v10 offset:0
    ds_read_b128 v[142:145], v10 offset:16
    ds_read_b128 v[146:149], v10 offset:128
    ds_read_b128 v[150:153], v10 offset:144
    s_waitcnt lgkmcnt(10)
    v_pk_add_f32 v[96:97], v[96:97], v[104:105]
    v_pk_add_f32 v[98:99], v[98:99], v[106:107]
    s_waitcnt lgkmcnt(9)
    v_pk_add_f32 v[100:101], v[100:101], v[108:109]
    v_pk_add_f32 v[102:103], v[102:103], v[110:111]
    s_waitcnt lgkmcnt(8)
    v_pk_add_f32 v[96:97], v[96:97], v[112:113]
    v_pk_add_f32 v[98:99], v[98:99], v[114:115]
    s_waitcnt lgkmcnt(7)
    v_pk_add_f32 v[100:101], v[100:101], v[116:117]
    v_pk_add_f32 v[102:103], v[102:103], v[118:119]
    s_waitcnt lgkmcnt(6)
    v_pk_add_f32 v[96:97], v[96:97], v[120:121]
    v_pk_add_f32 v[98:99], v[98:99], v[122:123]
    s_waitcnt lgkmcnt(5)
    v_pk_add_f32 v[100:101], v[100:101], v[124:125]
    v_pk_add_f32 v[102:103], v[102:103], v[126:127]
    s_waitcnt lgkmcnt(3)
    v_fma_f32 v96, -v138, v154, v96
    s_waitcnt lgkmcnt(1)
    v_mul_f32 v96, v96, v146
    v_fma_f32 v97, -v139, v155, v97
    v_mul_f32 v97, v97, v147
    v_fma_f32 v98, -v140, v156, v98
    v_mul_f32 v98, v98, v148
    v_fma_f32 v99, -v141, v157, v99
    v_mul_f32 v99, v99, v149
    v_fma_f32 v100, -v142, v158, v100
    s_waitcnt lgkmcnt(0)
    v_mul_f32 v100, v100, v150
    v_fma_f32 v101, -v143, v159, v101
    v_mul_f32 v101, v101, v151
    v_fma_f32 v102, -v144, v160, v102
    v_mul_f32 v102, v102, v152
    v_fma_f32 v103, -v145, v161, v103
    v_mul_f32 v103, v103, v153
    v_cvt_pk_bf16_f32 v172, v96, v97
    v_cvt_pk_bf16_f32 v173, v98, v99
    v_cvt_pk_bf16_f32 v174, v100, v101
    v_cvt_pk_bf16_f32 v175, v102, v103
    buffer_store_dwordx4 v[172:175], v7, s[4:7], s55 offen sc1
G_158:
    s_branch G1_153
G1_152:
    s_mul_i32 s51, s30, 16777216
    s_add_u32 s51, s51, 33554432
    s_lshl_b32 s34, s63, 13
    s_lshl_b32 s35, s65, 12
    s_mov_b32 s58, 262144
    s_add_u32 s51, s51, s34
    s_add_u32 s51, s51, s35
    s_lshl_b32 s34, s29, 13
    v_add_u32 v4, s34, v0
    s_lshl_b32 s34, s29, 3
    s_add_u32 s34, s34, 65536
    v_bfe_u32 v5, v1, 0, 5
    v_mul_u32_u24 v5, 32, v5
    v_add_u32 v5, s34, v5
    s_lshl_b32 s35, s29, 11
    s_lshl_b32 s36, s29, 8
    s_add_u32 s36, s36, 67584
    v_add_u32 v3, s35, v0
    s_lshl_b32 s34, s29, 10
    v_add_u32 v7, s34, v0
    v_bfe_u32 v6, v1, 0, 5
    v_mul_u32_u24 v6, 32, v6
    v_add_u32 v6, 65536, v6
G1_154:
    s_mov_b32 s34, 0x3f803f80
    v_mov_b32 v56, s34
    v_mov_b32 v57, s34
    v_mov_b32 v58, s34
    v_mov_b32 v59, s34
    s_nop 1
    v_mfma_f32_32x32x16_bf16 v[96:111], a[0:3], v[56:59], 0
    v_mfma_f32_32x32x16_bf16 v[112:127], a[40:43], v[56:59], 0
    v_mfma_f32_32x32x16_bf16 v[96:111], a[4:7], v[56:59], v[96:111]
    v_mfma_f32_32x32x16_bf16 v[112:127], a[44:47], v[56:59], v[112:127]
    v_mfma_f32_32x32x16_bf16 v[96:111], a[8:11], v[56:59], v[96:111]
    v_mfma_f32_32x32x16_bf16 v[112:127], a[48:51], v[56:59], v[112:127]
    v_mfma_f32_32x32x16_bf16 v[96:111], a[12:15], v[56:59], v[96:111]
    v_mfma_f32_32x32x16_bf16 v[112:127], a[52:55], v[56:59], v[112:127]
    v_mfma_f32_32x32x16_bf16 v[96:111], a[16:19], v[56:59], v[96:111]
    v_mfma_f32_32x32x16_bf16 v[112:127], a[56:59], v[56:59], v[112:127]
    v_mfma_f32_32x32x16_bf16 v[96:111], a[20:23], v[56:59], v[96:111]
    v_mfma_f32_32x32x16_bf16 v[112:127], a[60:63], v[56:59], v[112:127]
    v_mfma_f32_32x32x16_bf16 v[96:111], a[24:27], v[56:59], v[96:111]
    v_mfma_f32_32x32x16_bf16 v[112:127], a[64:67], v[56:59], v[112:127]
    v_mfma_f32_32x32x16_bf16 v[96:111], a[28:31], v[56:59], v[96:111]
    v_mfma_f32_32x32x16_bf16 v[112:127], a[68:71], v[56:59], v[112:127]
    v_mfma_f32_32x32x16_bf16 v[96:111], a[32:35], v[56:59], v[96:111]
    v_mfma_f32_32x32x16_bf16 v[112:127], a[72:75], v[56:59], v[112:127]
    v_mfma_f32_32x32x16_bf16 v[96:111], a[36:39], v[56:59], v[96:111]
    v_mfma_f32_32x32x16_bf16 v[112:127], a[76:79], v[56:59], v[112:127]
    s_nop 3
    ds_write_b128 v4, v[96:99] offset:32768
    ds_write_b128 v4, v[100:103] offset:33792
    ds_write_b128 v4, v[104:107] offset:34816
    ds_write_b128 v4, v[108:111] offset:35840
    s_nop 3
    ds_write_b128 v4, v[112:115] offset:36864
    ds_write_b128 v4, v[116:119] offset:37888
    ds_write_b128 v4, v[120:123] offset:38912
    ds_write_b128 v4, v[124:127] offset:39936
    s_waitcnt lgkmcnt(0)
    s_barrier
    ds_read_b128 v[96:99], v3 offset:32768
    ds_read_b128 v[100:103], v3 offset:33792
    ds_read_b128 v[104:107], v3 offset:40960
    ds_read_b128 v[108:111], v3 offset:41984
    ds_read_b128 v[112:115], v3 offset:49152
    ds_read_b128 v[116:119], v3 offset:50176
    ds_read_b128 v[120:123], v3 offset:57344
    ds_read_b128 v[124:127], v3 offset:58368
    s_waitcnt lgkmcnt(5)
    v_pk_add_f32 v[96:97], v[96:97], v[104:105]
    v_pk_add_f32 v[98:99], v[98:99], v[106:107]
    s_waitcnt lgkmcnt(4)
    v_pk_add_f32 v[100:101], v[100:101], v[108:109]
    v_pk_add_f32 v[102:103], v[102:103], v[110:111]
    s_waitcnt lgkmcnt(3)
    v_pk_add_f32 v[96:97], v[96:97], v[112:113]
    v_pk_add_f32 v[98:99], v[98:99], v[114:115]
    s_waitcnt lgkmcnt(2)
    v_pk_add_f32 v[100:101], v[100:101], v[116:117]
    v_pk_add_f32 v[102:103], v[102:103], v[118:119]
    s_waitcnt lgkmcnt(1)
    v_pk_add_f32 v[96:97], v[96:97], v[120:121]
    v_pk_add_f32 v[98:99], v[98:99], v[122:123]
    s_waitcnt lgkmcnt(0)
    v_pk_add_f32 v[100:101], v[100:101], v[124:125]
    v_pk_add_f32 v[102:103], v[102:103], v[126:127]
    v_mov_b64 v[154:155], v[96:97]
    v_mov_b64 v[156:157], v[98:99]
    v_mov_b64 v[158:159], v[100:101]
    v_mov_b64 v[160:161], v[102:103]
    s_barrier
    s_add_u32 s57, s30, 1
    v_add_u32 v176, 0, v1
    v_min_u32 v176, 189, v176
    v_lshlrev_b32 v176, 4, v176
    v_add_u32 v177, 64, v1
    v_min_u32 v177, 189, v177
    v_lshlrev_b32 v177, 4, v177
    v_add_u32 v178, 128, v1
    v_min_u32 v178, 189, v178
    v_lshlrev_b32 v178, 4, v178
    s_mov_b32 s32, 12288
    s_mov_b32 s48, 0
P_165:
    buffer_load_dword v172, v176, s[4:7], s32 offen sc1
    buffer_load_dword v173, v177, s[4:7], s32 offen sc1
    buffer_load_dword v174, v178, s[4:7], s32 offen sc1
    s_waitcnt vmcnt(0)
    v_min_u32 v172, v172, v173
    v_min_u32 v172, v172, v174
    v_cmp_gt_u32 vcc, s57, v172
    s_cbranch_vccz P_166
    s_add_u32 s48, s48, 1
    s_cmp_gt_u32 s48, 200000
    s_cbranch_scc1 L_end
    s_sleep 1
    s_branch P_165
P_166:
    s_mul_i32 s54, s44, 40960
    s_add_u32 s56, s54, s52
    s_add_u32 s54, s54, s50
    s_waitcnt vmcnt(0) lgkmcnt(0)
    buffer_load_dwordx4 v[16:19], v0, s[4:7], s54 offen offset:0 sc1
    buffer_load_dwordx4 v[20:23], v0, s[4:7], s54 offen offset:1024 sc1
    buffer_load_dwordx4 v[24:27], v0, s[4:7], s54 offen offset:2048 sc1
    buffer_load_dwordx4 v[28:31], v0, s[4:7], s54 offen offset:3072 sc1
    s_add_u32 s54, s54, 4096
    buffer_load_dwordx4 v[32:35], v0, s[4:7], s54 offen offset:0 sc1
    buffer_load_dwordx4 v[36:39], v0, s[4:7], s54 offen offset:1024 sc1
    buffer_load_dwordx4 v[40:43], v0, s[4:7], s54 offen offset:2048 sc1
    buffer_load_dwordx4 v[44:47], v0, s[4:7], s54 offen offset:3072 sc1
    s_add_u32 s54, s54, 4096
    buffer_load_dwordx4 v[48:51], v0, s[4:7], s54 offen offset:0 sc1
    buffer_load_dwordx4 v[52:55], v0, s[4:7], s54 offen offset:1024 sc1
    buffer_load_dword v179, off, s[8:11], 0
G_167:
    s_add_u32 s45, s44, s47
    s_cmp_lt_u32 s45, 64
    s_cbranch_scc0 G_169
    s_mul_i32 s54, s45, 40960
    s_add_u32 s56, s54, s52
    s_add_u32 s54, s54, s50
    s_waitcnt vmcnt(10)
    v_mfma_f32_32x32x16_bf16 v[96:111], a[0:3], v[16:19], 0
    v_mfma_f32_32x32x16_bf16 v[112:127], a[40:43], v[16:19], 0
    buffer_load_dwordx4 v[56:59], v0, s[4:7], s54 offen offset:0 sc1
    s_waitcnt vmcnt(10)
    v_mfma_f32_32x32x16_bf16 v[96:111], a[4:7], v[20:23], v[96:111]
    v_mfma_f32_32x32x16_bf16 v[112:127], a[44:47], v[20:23], v[112:127]
    buffer_load_dwordx4 v[60:63], v0, s[4:7], s54 offen offset:1024 sc1
    s_waitcnt vmcnt(10)
    v_mfma_f32_32x32x16_bf16 v[96:111], a[8:11], v[24:27], v[96:111]
    v_mfma_f32_32x32x16_bf16 v[112:127], a[48:51], v[24:27], v[112:127]
    buffer_load_dwordx4 v[64:67], v0, s[4:7], s54 offen offset:2048 sc1
    s_waitcnt vmcnt(10)
    v_mfma_f32_32x32x16_bf16 v[96:111], a[12:15], v[28:31], v[96:111]
    v_mfma_f32_32x32x16_bf16 v[112:127], a[52:55], v[28:31], v[112:127]
    buffer_load_dwordx4 v[68:71], v0, s[4:7], s54 offen offset:3072 sc1
    s_waitcnt vmcnt(10)
    v_mfma_f32_32x32x16_bf16 v[96:111], a[16:19], v[32:35], v[96:111]
    v_mfma_f32_32x32x16_bf16 v[112:127], a[56:59], v[32:35], v[112:127]
    s_add_u32 s54, s54, 4096
    buffer_load_dwordx4 v[72:75], v0, s[4:7], s54 offen offset:0 sc1
    s_waitcnt vmcnt(10)
    v_mfma_f32_32x32x16_bf16 v[96:111], a[20:23], v[36:39], v[96:111]
    v_mfma_f32_32x32x16_bf16 v[112:127], a[60:63], v[36:39], v[112:127]
    buffer_load_dwordx4 v[76:79], v0, s[4:7], s54 offen offset:1024 sc1
    s_waitcnt vmcnt(10)
    v_mfma_f32_32x32x16_bf16 v[96:111], a[24:27], v[40:43], v[96:111]
    v_mfma_f32_32x32x16_bf16 v[112:127], a[64:67], v[40:43], v[112:127]
    buffer_load_dwordx4 v[80:83], v0, s[4:7], s54 offen offset:2048 sc1
    s_waitcnt vmcnt(10)
    v_mfma_f32_32x32x16_bf16 v[96:111], a[28:31], v[44:47], v[96:111]
    v_mfma_f32_32x32x16_bf16 v[112:127], a[68:71], v[44:47], v[112:127]
    buffer_load_dwordx4 v[84:87], v0, s[4:7], s54 offen offset:3072 sc1
    s_waitcnt vmcnt(10)
    v_mfma_f32_32x32x16_bf16 v[96:111], a[32:35], v[48:51], v[96:111]
    v_mfma_f32_32x32x16_bf16 v[112:127], a[72:75], v[48:51], v[112:127]
    s_add_u32 s54, s54, 4096
    buffer_load_dwordx4 v[88:91], v0, s[4:7], s54 offen offset:0 sc1
    s_waitcnt vmcnt(10)
    v_mfma_f32_32x32x16_bf16 v[96:111], a[36:39], v[52:55], v[96:111]
    v_mfma_f32_32x32x16_bf16 v[112:127], a[76:79], v[52:55], v[112:127]
    buffer_load_dwordx4 v[92:95], v0, s[4:7], s54 offen offset:1024 sc1
    s_mul_i32 s55, s44, s58
    s_add_u32 s55, s55, s51
    s_nop 0
    ds_write_b128 v4, v[96:99] offset:0
    v_mov_b64 v[128:129], 0
    s_mov_b32 s34, 0x3f803f80
    v_dot2c_f32_bf16 v128, s34, v16
    v_dot2c_f32_bf16 v129, v16, v16
    v_dot2c_f32_bf16 v128, s34, v17
    v_dot2c_f32_bf16 v129, v17, v17
    v_dot2c_f32_bf16 v128, s34, v18
    v_dot2c_f32_bf16 v129, v18, v18
    v_dot2c_f32_bf16 v128, s34, v19
    v_dot2c_f32_bf16 v129, v19, v19
    v_dot2c_f32_bf16 v128, s34, v20
    v_dot2c_f32_bf16 v129, v20, v20
    ds_write_b128 v4, v[100:103] offset:1024
    v_dot2c_f32_bf16 v128, s34, v21
    v_dot2c_f32_bf16 v129, v21, v21
    v_dot2c_f32_bf16 v128, s34, v22
    v_dot2c_f32_bf16 v129, v22, v22
    v_dot2c_f32_bf16 v128, s34, v23
    v_dot2c_f32_bf16 v129, v23, v23
    v_dot2c_f32_bf16 v128, s34, v24
    v_dot2c_f32_bf16 v129, v24, v24
    v_dot2c_f32_bf16 v128, s34, v25
    v_dot2c_f32_bf16 v129, v25, v25
    ds_write_b128 v4, v[104:107] offset:2048
    v_dot2c_f32_bf16 v128, s34, v26
    v_dot2c_f32_bf16 v129, v26, v26
    v_dot2c_f32_bf16 v128, s34, v27
    v_dot2c_f32_bf16 v129, v27, v27
    v_dot2c_f32_bf16 v128, s34, v28
    v_dot2c_f32_bf16 v129, v28, v28
    v_dot2c_f32_bf16 v128, s34, v29
    v_dot2c_f32_bf16 v129, v29, v29
    v_dot2c_f32_bf16 v128, s34, v30
    v_dot2c_f32_bf16 v129, v30, v30
    ds_write_b128 v4, v[108:111] offset:3072
    v_dot2c_f32_bf16 v128, s34, v31
    v_dot2c_f32_bf16 v129, v31, v31
    v_dot2c_f32_bf16 v128, s34, v32
    v_dot2c_f32_bf16 v129, v32, v32
    v_dot2c_f32_bf16 v128, s34, v33
    v_dot2c_f32_bf16 v129, v33, v33
    v_dot2c_f32_bf16 v128, s34, v34
    v_dot2c_f32_bf16 v129, v34, v34
    v_dot2c_f32_bf16 v128, s34, v35
    v_dot2c_f32_bf16 v129, v35, v35
    ds_write_b128 v4, v[112:115] offset:4096
    v_dot2c_f32_bf16 v128, s34, v36
    v_dot2c_f32_bf16 v129, v36, v36
    v_dot2c_f32_bf16 v128, s34, v37
    v_dot2c_f32_bf16 v129, v37, v37
    v_dot2c_f32_bf16 v128, s34, v38
    v_dot2c_f32_bf16 v129, v38, v38
    v_dot2c_f32_bf16 v128, s34, v39
    v_dot2c_f32_bf16 v129, v39, v39
    v_dot2c_f32_bf16 v128, s34, v40
    v_dot2c_f32_bf16 v129, v40, v40
    ds_write_b128 v4, v[116:119] offset:5120
    v_dot2c_f32_bf16 v128, s34, v41
    v_dot2c_f32_bf16 v129, v41, v41
    v_dot2c_f32_bf16 v128, s34, v42
    v_dot2c_f32_bf16 v129, v42, v42
    v_dot2c_f32_bf16 v128, s34, v43
    v_dot2c_f32_bf16 v129, v43, v43
    v_dot2c_f32_bf16 v128, s34, v44
    v_dot2c_f32_bf16 v129, v44, v44
    v_dot2c_f32_bf16 v128, s34, v45
    v_dot2c_f32_bf16 v129, v45, v45
    ds_write_b128 v4, v[120:123] offset:6144
    v_dot2c_f32_bf16 v128, s34, v46
    v_dot2c_f32_bf16 v129, v46, v46
    v_dot2c_f32_bf16 v128, s34, v47
    v_dot2c_f32_bf16 v129, v47, v47
    v_dot2c_f32_bf16 v128, s34, v48
    v_dot2c_f32_bf16 v129, v48, v48
    v_dot2c_f32_bf16 v128, s34, v49
    v_dot2c_f32_bf16 v129, v49, v49
    v_dot2c_f32_bf16 v128, s34, v50
    v_dot2c_f32_bf16 v129, v50, v50
    ds_write_b128 v4, v[124:127] offset:7168
    v_dot2c_f32_bf16 v128, s34, v51
    v_dot2c_f32_bf16 v129, v51, v51
    v_dot2c_f32_bf16 v128, s34, v52
    v_dot2c_f32_bf16 v129, v52, v52
    v_dot2c_f32_bf16 v128, s34, v53
    v_dot2c_f32_bf16 v129, v53, v53
    v_dot2c_f32_bf16 v128, s34, v54
    v_dot2c_f32_bf16 v129, v54, v54
    v_dot2c_f32_bf16 v128, s34, v55
    v_dot2c_f32_bf16 v129, v55, v55
    s_nop 2
    v_mov_b64 v[172:173], v[128:129]
    s_nop 1
    v_permlane32_swap_b32 v128, v172
    v_permlane32_swap_b32 v129, v173
    v_pk_add_f32 v[128:129], v[128:129], v[172:173]
    ds_write_b64 v5, v[128:129] offset:0
    s_waitcnt vmcnt(10)
    s_waitcnt lgkmcnt(0)
    s_barrier
    s_cmp_lg_u32 s29, 0
    s_cbranch_scc1 F_171
    s_lshl_b32 s32, s28, 2
    s_add_u32 s32, s32, s29
    s_lshl_b32 s32, s32, 2
    s_add_u32 s32, s32, 16384
    v_mov_b32 v178, s49
    s_mov_b64 exec, 1
    buffer_store_dword v178, off, s[4:7], s32 sc1
    s_mov_b64 exec, -1
F_171:
    s_add_u32 s49, s49, 1
    ds_read_b128 v[130:133], v6 offset:0
    ds_read_b128 v[134:137], v6 offset:16
    ds_read_b128 v[96:99], v3 offset:0
    ds_read_b128 v[100:103], v3 offset:1024
    ds_read_b128 v[104:107], v3 offset:8192
    ds_read_b128 v[108:111], v3 offset:9216
    ds_read_b128 v[112:115], v3 offset:16384
    ds_read_b128 v[116:119], v3 offset:17408
    ds_read_b128 v[120:123], v3 offset:24576
    ds_read_b128 v[124:127], v3 offset:25600
    s_waitcnt lgkmcnt(9)
    v_pk_add_f32 v[130:131], v[130:131], v[132:133]
    s_waitcnt lgkmcnt(8)
    v_pk_add_f32 v[134:135], v[134:135], v[136:137]
    v_pk_add_f32 v[130:131], v[130:131], v[134:135]
    v_mul_f32 v130, 0x3acccccd, v130
    v_mul_f32 v131, 0x3acccccd, v131
    v_fma_f32 v131, -v130, v130, v131
    v_max_f32 v131, 0, v131
    v_add_f32 v131, 0x3727c5ac, v131
    v_rsq_f32 v131, v131
    s_waitcnt lgkmcnt(5)
    v_pk_add_f32 v[96:97], v[96:97], v[104:105]
    v_pk_add_f32 v[98:99], v[98:99], v[106:107]
    s_waitcnt lgkmcnt(4)
    v_pk_add_f32 v[100:101], v[100:101], v[108:109]
    v_pk_add_f32 v[102:103], v[102:103], v[110:111]
    s_waitcnt lgkmcnt(3)
    v_pk_add_f32 v[96:97], v[96:97], v[112:113]
    v_pk_add_f32 v[98:99], v[98:99], v[114:115]
    s_waitcnt lgkmcnt(2)
    v_pk_add_f32 v[100:101], v[100:101], v[116:117]
    v_pk_add_f32 v[102:103], v[102:103], v[118:119]
    s_waitcnt lgkmcnt(1)
    v_pk_add_f32 v[96:97], v[96:97], v[120:121]
    v_pk_add_f32 v[98:99], v[98:99], v[122:123]
    s_waitcnt lgkmcnt(0)
    v_pk_add_f32 v[100:101], v[100:101], v[124:125]
    v_pk_add_f32 v[102:103], v[102:103], v[126:127]
    v_fma_f32 v96, -v130, v154, v96
    v_mul_f32 v96, v96, v131
    v_fma_f32 v97, -v130, v155, v97
    v_mul_f32 v97, v97, v131
    v_fma_f32 v98, -v130, v156, v98
    v_mul_f32 v98, v98, v131
    v_fma_f32 v99, -v130, v157, v99
    v_mul_f32 v99, v99, v131
    v_fma_f32 v100, -v130, v158, v100
    v_mul_f32 v100, v100, v131
    v_fma_f32 v101, -v130, v159, v101
    v_mul_f32 v101, v101, v131
    v_fma_f32 v102, -v130, v160, v102
    v_mul_f32 v102, v102, v131
    v_fma_f32 v103, -v130, v161, v103
    v_mul_f32 v103, v103, v131
    v_cvt_pk_bf16_f32 v172, v96, v97
    v_cvt_pk_bf16_f32 v173, v98, v99
    v_cvt_pk_bf16_f32 v174, v100, v101
    v_cvt_pk_bf16_f32 v175, v102, v103
    buffer_store_dwordx4 v[172:175], v7, s[4:7], s55 offen sc1
    s_mov_b32 s44, s45
    s_add_u32 s45, s44, s47
    s_cmp_lt_u32 s45, 64
    s_cbranch_scc0 G_170
    s_mul_i32 s54, s45, 40960
    s_add_u32 s56, s54, s52
    s_add_u32 s54, s54, s50
    s_waitcnt vmcnt(10)
    v_mfma_f32_32x32x16_bf16 v[96:111], a[0:3], v[56:59], 0
    v_mfma_f32_32x32x16_bf16 v[112:127], a[40:43], v[56:59], 0
    buffer_load_dwordx4 v[16:19], v0, s[4:7], s54 offen offset:0 sc1
    s_waitcnt vmcnt(10)
    v_mfma_f32_32x32x16_bf16 v[96:111], a[4:7], v[60:63], v[96:111]
    v_mfma_f32_32x32x16_bf16 v[112:127], a[44:47], v[60:63], v[112:127]
    buffer_load_dwordx4 v[20:23], v0, s[4:7], s54 offen offset:1024 sc1
    s_waitcnt vmcnt(10)
    v_mfma_f32_32x32x16_bf16 v[96:111], a[8:11], v[64:67], v[96:111]
    v_mfma_f32_32x32x16_bf16 v[112:127], a[48:51], v[64:67], v[112:127]
    buffer_load_dwordx4 v[24:27], v0, s[4:7], s54 offen offset:2048 sc1
    s_waitcnt vmcnt(10)
    v_mfma_f32_32x32x16_bf16 v[96:111], a[12:15], v[68:71], v[96:111]
    v_mfma_f32_32x32x16_bf16 v[112:127], a[52:55], v[68:71], v[112:127]
    buffer_load_dwordx4 v[28:31], v0, s[4:7], s54 offen offset:3072 sc1
    s_waitcnt vmcnt(10)
    v_mfma_f32_32x32x16_bf16 v[96:111], a[16:19], v[72:75], v[96:111]
    v_mfma_f32_32x32x16_bf16 v[112:127], a[56:59], v[72:75], v[112:127]
    s_add_u32 s54, s54, 4096
    buffer_load_dwordx4 v[32:35], v0, s[4:7], s54 offen offset:0 sc1
    s_waitcnt vmcnt(10)
    v_mfma_f32_32x32x16_bf16 v[96:111], a[20:23], v[76:79], v[96:111]
    v_mfma_f32_32x32x16_bf16 v[112:127], a[60:63], v[76:79], v[112:127]
    buffer_load_dwordx4 v[36:39], v0, s[4:7], s54 offen offset:1024 sc1
    s_waitcnt vmcnt(10)
    v_mfma_f32_32x32x16_bf16 v[96:111], a[24:27], v[80:83], v[96:111]
    v_mfma_f32_32x32x16_bf16 v[112:127], a[64:67], v[80:83], v[112:127]
    buffer_load_dwordx4 v[40:43], v0, s[4:7], s54 offen offset:2048 sc1
    s_waitcnt vmcnt(10)
    v_mfma_f32_32x32x16_bf16 v[96:111], a[28:31], v[84:87], v[96:111]
    v_mfma_f32_32x32x16_bf16 v[112:127], a[68:71], v[84:87], v[112:127]
    buffer_load_dwordx4 v[44:47], v0, s[4:7], s54 offen offset:3072 sc1
    s_waitcnt vmcnt(10)
    v_mfma_f32_32x32x16_bf16 v[96:111], a[32:35], v[88:91], v[96:111]
    v_mfma_f32_32x32x16_bf16 v[112:127], a[72:75], v[88:91], v[112:127]
    s_add_u32 s54, s54, 4096
    buffer_load_dwordx4 v[48:51], v0, s[4:7], s54 offen offset:0 sc1
    s_waitcnt vmcnt(10)
    v_mfma_f32_32x32x16_bf16 v[96:111], a[36:39], v[92:95], v[96:111]
    v_mfma_f32_32x32x16_bf16 v[112:127], a[76:79], v[92:95], v[112:127]
    buffer_load_dwordx4 v[52:55], v0, s[4:7], s54 offen offset:1024 sc1
    s_mul_i32 s55, s44, s58
    s_add_u32 s55, s55, s51
    s_nop 0
    ds_write_b128 v4, v[96:99] offset:32768
    v_mov_b64 v[128:129], 0
    s_mov_b32 s34, 0x3f803f80
    v_dot2c_f32_bf16 v128, s34, v56
    v_dot2c_f32_bf16 v129, v56, v56
    v_dot2c_f32_bf16 v128, s34, v57
    v_dot2c_f32_bf16 v129, v57, v57
    v_dot2c_f32_bf16 v128, s34, v58
    v_dot2c_f32_bf16 v129, v58, v58
    v_dot2c_f32_bf16 v128, s34, v59
    v_dot2c_f32_bf16 v129, v59, v59
    v_dot2c_f32_bf16 v128, s34, v60
    v_dot2c_f32_bf16 v129, v60, v60
    ds_write_b128 v4, v[100:103] offset:33792
    v_dot2c_f32_bf16 v128, s34, v61
    v_dot2c_f32_bf16 v129, v61, v61
    v_dot2c_f32_bf16 v128, s34, v62
    v_dot2c_f32_bf16 v129, v62, v62
    v_dot2c_f32_bf16 v128, s34, v63
    v_dot2c_f32_bf16 v129, v63, v63
    v_dot2c_f32_bf16 v128, s34, v64
    v_dot2c_f32_bf16 v129, v64, v64
    v_dot2c_f32_bf16 v128, s34, v65
    v_dot2c_f32_bf16 v129, v65, v65
    ds_write_b128 v4, v[104:107] offset:34816
    v_dot2c_f32_bf16 v128, s34, v66
    v_dot2c_f32_bf16 v129, v66, v66
    v_dot2c_f32_bf16 v128, s34, v67
    v_dot2c_f32_bf16 v129, v67, v67
    v_dot2c_f32_bf16 v128, s34, v68
    v_dot2c_f32_bf16 v129, v68, v68
    v_dot2c_f32_bf16 v128, s34, v69
    v_dot2c_f32_bf16 v129, v69, v69
    v_dot2c_f32_bf16 v128, s34, v70
    v_dot2c_f32_bf16 v129, v70, v70
    ds_write_b128 v4, v[108:111] offset:35840
    v_dot2c_f32_bf16 v128, s34, v71
    v_dot2c_f32_bf16 v129, v71, v71
    v_dot2c_f32_bf16 v128, s34, v72
    v_dot2c_f32_bf16 v129, v72, v72
    v_dot2c_f32_bf16 v128, s34, v73
    v_dot2c_f32_bf16 v129, v73, v73
    v_dot2c_f32_bf16 v128, s34, v74
    v_dot2c_f32_bf16 v129, v74, v74
    v_dot2c_f32_bf16 v128, s34, v75
    v_dot2c_f32_bf16 v129, v75, v75
    ds_write_b128 v4, v[112:115] offset:36864
    v_dot2c_f32_bf16 v128, s34, v76
    v_dot2c_f32_bf16 v129, v76, v76
    v_dot2c_f32_bf16 v128, s34, v77
    v_dot2c_f32_bf16 v129, v77, v77
    v_dot2c_f32_bf16 v128, s34, v78
    v_dot2c_f32_bf16 v129, v78, v78
    v_dot2c_f32_bf16 v128, s34, v79
    v_dot2c_f32_bf16 v129, v79, v79
    v_dot2c_f32_bf16 v128, s34, v80
    v_dot2c_f32_bf16 v129, v80, v80
    ds_write_b128 v4, v[116:119] offset:37888
    v_dot2c_f32_bf16 v128, s34, v81
    v_dot2c_f32_bf16 v129, v81, v81
    v_dot2c_f32_bf16 v128, s34, v82
    v_dot2c_f32_bf16 v129, v82, v82
    v_dot2c_f32_bf16 v128, s34, v83
    v_dot2c_f32_bf16 v129, v83, v83
    v_dot2c_f32_bf16 v128, s34, v84
    v_dot2c_f32_bf16 v129, v84, v84
    v_dot2c_f32_bf16 v128, s34, v85
    v_dot2c_f32_bf16 v129, v85, v85
    ds_write_b128 v4, v[120:123] offset:38912
    v_dot2c_f32_bf16 v128, s34, v86
    v_dot2c_f32_bf16 v129, v86, v86
    v_dot2c_f32_bf16 v128, s34, v87
    v_dot2c_f32_bf16 v129, v87, v87
    v_dot2c_f32_bf16 v128, s34, v88
    v_dot2c_f32_bf16 v129, v88, v88
    v_dot2c_f32_bf16 v128, s34, v89
    v_dot2c_f32_bf16 v129, v89, v89
    v_dot2c_f32_bf16 v128, s34, v90
    v_dot2c_f32_bf16 v129, v90, v90
    ds_write_b128 v4, v[124:127] offset:39936
    v_dot2c_f32_bf16 v128, s34, v91
    v_dot2c_f32_bf16 v129, v91, v91
    v_dot2c_f32_bf16 v128, s34, v92
    v_dot2c_f32_bf16 v129, v92, v92
    v_dot2c_f32_bf16 v128, s34, v93
    v_dot2c_f32_bf16 v129, v93, v93
    v_dot2c_f32_bf16 v128, s34, v94
    v_dot2c_f32_bf16 v129, v94, v94
    v_dot2c_f32_bf16 v128, s34, v95
    v_dot2c_f32_bf16 v129, v95, v95
    s_nop 2
    v_mov_b64 v[172:173], v[128:129]
    s_nop 1
    v_permlane32_swap_b32 v128, v172
    v_permlane32_swap_b32 v129, v173
    v_pk_add_f32 v[128:129], v[128:129], v[172:173]
    ds_write_b64 v5, v[128:129] offset:1024
    s_waitcnt vmcnt(10)
    s_waitcnt lgkmcnt(0)
    s_barrier
    s_cmp_lg_u32 s29, 0
    s_cbranch_scc1 F_172
    s_lshl_b32 s32, s28, 2
    s_add_u32 s32, s32, s29
    s_lshl_b32 s32, s32, 2
    s_add_u32 s32, s32, 16384
    v_mov_b32 v178, s49
    s_mov_b64 exec, 1
    buffer_store_dword v178, off, s[4:7], s32 sc1
    s_mov_b64 exec, -1
F_172:
    s_add_u32 s49, s49, 1
    ds_read_b128 v[130:133], v6 offset:1024
    ds_read_b128 v[134:137], v6 offset:1040
    ds_read_b128 v[96:99], v3 offset:32768
    ds_read_b128 v[100:103], v3 offset:33792
    ds_read_b128 v[104:107], v3 offset:40960
    ds_read_b128 v[108:111], v3 offset:41984
    ds_read_b128 v[112:115], v3 offset:49152
    ds_read_b128 v[116:119], v3 offset:50176
    ds_read_b128 v[120:123], v3 offset:57344
    ds_read_b128 v[124:127], v3 offset:58368
    s_waitcnt lgkmcnt(9)
    v_pk_add_f32 v[130:131], v[130:131], v[132:133]
    s_waitcnt lgkmcnt(8)
    v_pk_add_f32 v[134:135], v[134:135], v[136:137]
    v_pk_add_f32 v[130:131], v[130:131], v[134:135]
    v_mul_f32 v130, 0x3acccccd, v130
    v_mul_f32 v131, 0x3acccccd, v131
    v_fma_f32 v131, -v130, v130, v131
    v_max_f32 v131, 0, v131
    v_add_f32 v131, 0x3727c5ac, v131
    v_rsq_f32 v131, v131
    s_waitcnt lgkmcnt(5)
    v_pk_add_f32 v[96:97], v[96:97], v[104:105]
    v_pk_add_f32 v[98:99], v[98:99], v[106:107]
    s_waitcnt lgkmcnt(4)
    v_pk_add_f32 v[100:101], v[100:101], v[108:109]
    v_pk_add_f32 v[102:103], v[102:103], v[110:111]
    s_waitcnt lgkmcnt(3)
    v_pk_add_f32 v[96:97], v[96:97], v[112:113]
    v_pk_add_f32 v[98:99], v[98:99], v[114:115]
    s_waitcnt lgkmcnt(2)
    v_pk_add_f32 v[100:101], v[100:101], v[116:117]
    v_pk_add_f32 v[102:103], v[102:103], v[118:119]
    s_waitcnt lgkmcnt(1)
    v_pk_add_f32 v[96:97], v[96:97], v[120:121]
    v_pk_add_f32 v[98:99], v[98:99], v[122:123]
    s_waitcnt lgkmcnt(0)
    v_pk_add_f32 v[100:101], v[100:101], v[124:125]
    v_pk_add_f32 v[102:103], v[102:103], v[126:127]
    v_fma_f32 v96, -v130, v154, v96
    v_mul_f32 v96, v96, v131
    v_fma_f32 v97, -v130, v155, v97
    v_mul_f32 v97, v97, v131
    v_fma_f32 v98, -v130, v156, v98
    v_mul_f32 v98, v98, v131
    v_fma_f32 v99, -v130, v157, v99
    v_mul_f32 v99, v99, v131
    v_fma_f32 v100, -v130, v158, v100
    v_mul_f32 v100, v100, v131
    v_fma_f32 v101, -v130, v159, v101
    v_mul_f32 v101, v101, v131
    v_fma_f32 v102, -v130, v160, v102
    v_mul_f32 v102, v102, v131
    v_fma_f32 v103, -v130, v161, v103
    v_mul_f32 v103, v103, v131
    v_cvt_pk_bf16_f32 v172, v96, v97
    v_cvt_pk_bf16_f32 v173, v98, v99
    v_cvt_pk_bf16_f32 v174, v100, v101
    v_cvt_pk_bf16_f32 v175, v102, v103
    buffer_store_dwordx4 v[172:175], v7, s[4:7], s55 offen sc1
    s_mov_b32 s44, s45
    s_branch G_167
G_169:
    s_waitcnt vmcnt(10)
    v_mfma_f32_32x32x16_bf16 v[96:111], a[0:3], v[16:19], 0
    v_mfma_f32_32x32x16_bf16 v[112:127], a[40:43], v[16:19], 0
    s_waitcnt vmcnt(9)
    v_mfma_f32_32x32x16_bf16 v[96:111], a[4:7], v[20:23], v[96:111]
    v_mfma_f32_32x32x16_bf16 v[112:127], a[44:47], v[20:23], v[112:127]
    s_waitcnt vmcnt(8)
    v_mfma_f32_32x32x16_bf16 v[96:111], a[8:11], v[24:27], v[96:111]
    v_mfma_f32_32x32x16_bf16 v[112:127], a[48:51], v[24:27], v[112:127]
    s_waitcnt vmcnt(7)
    v_mfma_f32_32x32x16_bf16 v[96:111], a[12:15], v[28:31], v[96:111]
    v_mfma_f32_32x32x16_bf16 v[112:127], a[52:55], v[28:31], v[112:127]
    s_waitcnt vmcnt(6)
    v_mfma_f32_32x32x16_bf16 v[96:111], a[16:19], v[32:35], v[96:111]
    v_mfma_f32_32x32x16_bf16 v[112:127], a[56:59], v[32:35], v[112:127]
    s_waitcnt vmcnt(5)
    v_mfma_f32_32x32x16_bf16 v[96:111], a[20:23], v[36:39], v[96:111]
    v_mfma_f32_32x32x16_bf16 v[112:127], a[60:63], v[36:39], v[112:127]
    s_waitcnt vmcnt(4)
    v_mfma_f32_32x32x16_bf16 v[96:111], a[24:27], v[40:43], v[96:111]
    v_mfma_f32_32x32x16_bf16 v[112:127], a[64:67], v[40:43], v[112:127]
    s_waitcnt vmcnt(3)
    v_mfma_f32_32x32x16_bf16 v[96:111], a[28:31], v[44:47], v[96:111]
    v_mfma_f32_32x32x16_bf16 v[112:127], a[68:71], v[44:47], v[112:127]
    s_waitcnt vmcnt(2)
    v_mfma_f32_32x32x16_bf16 v[96:111], a[32:35], v[48:51], v[96:111]
    v_mfma_f32_32x32x16_bf16 v[112:127], a[72:75], v[48:51], v[112:127]
    s_waitcnt vmcnt(1)
    v_mfma_f32_32x32x16_bf16 v[96:111], a[36:39], v[52:55], v[96:111]
    v_mfma_f32_32x32x16_bf16 v[112:127], a[76:79], v[52:55], v[112:127]
    s_mul_i32 s55, s44, s58
    s_add_u32 s55, s55, s51
    s_nop 1
    ds_write_b128 v4, v[96:99] offset:0
    v_mov_b64 v[128:129], 0
    s_mov_b32 s34, 0x3f803f80
    v_dot2c_f32_bf16 v128, s34, v16
    v_dot2c_f32_bf16 v129, v16, v16
    v_dot2c_f32_bf16 v128, s34, v17
    v_dot2c_f32_bf16 v129, v17, v17
    v_dot2c_f32_bf16 v128, s34, v18
    v_dot2c_f32_bf16 v129, v18, v18
    v_dot2c_f32_bf16 v128, s34, v19
    v_dot2c_f32_bf16 v129, v19, v19
    v_dot2c_f32_bf16 v128, s34, v20
    v_dot2c_f32_bf16 v129, v20, v20
    ds_write_b128 v4, v[100:103] offset:1024
    v_dot2c_f32_bf16 v128, s34, v21
    v_dot2c_f32_bf16 v129, v21, v21
    v_dot2c_f32_bf16 v128, s34, v22
    v_dot2c_f32_bf16 v129, v22, v22
    v_dot2c_f32_bf16 v128, s34, v23
    v_dot2c_f32_bf16 v129, v23, v23
    v_dot2c_f32_bf16 v128, s34, v24
    v_dot2c_f32_bf16 v129, v24, v24
    v_dot2c_f32_bf16 v128, s34, v25
    v_dot2c_f32_bf16 v129, v25, v25
    ds_write_b128 v4, v[104:107] offset:2048
    v_dot2c_f32_bf16 v128, s34, v26
    v_dot2c_f32_bf16 v129, v26, v26
    v_dot2c_f32_bf16 v128, s34, v27
    v_dot2c_f32_bf16 v129, v27, v27
    v_dot2c_f32_bf16 v128, s34, v28
    v_dot2c_f32_bf16 v129, v28, v28
    v_dot2c_f32_bf16 v128, s34, v29
    v_dot2c_f32_bf16 v129, v29, v29
    v_dot2c_f32_bf16 v128, s34, v30
    v_dot2c_f32_bf16 v129, v30, v30
    ds_write_b128 v4, v[108:111] offset:3072
    v_dot2c_f32_bf16 v128, s34, v31
    v_dot2c_f32_bf16 v129, v31, v31
    v_dot2c_f32_bf16 v128, s34, v32
    v_dot2c_f32_bf16 v129, v32, v32
    v_dot2c_f32_bf16 v128, s34, v33
    v_dot2c_f32_bf16 v129, v33, v33
    v_dot2c_f32_bf16 v128, s34, v34
    v_dot2c_f32_bf16 v129, v34, v34
    v_dot2c_f32_bf16 v128, s34, v35
    v_dot2c_f32_bf16 v129, v35, v35
    ds_write_b128 v4, v[112:115] offset:4096
    v_dot2c_f32_bf16 v128, s34, v36
    v_dot2c_f32_bf16 v129, v36, v36
    v_dot2c_f32_bf16 v128, s34, v37
    v_dot2c_f32_bf16 v129, v37, v37
    v_dot2c_f32_bf16 v128, s34, v38
    v_dot2c_f32_bf16 v129, v38, v38
    v_dot2c_f32_bf16 v128, s34, v39
    v_dot2c_f32_bf16 v129, v39, v39
    v_dot2c_f32_bf16 v128, s34, v40
    v_dot2c_f32_bf16 v129, v40, v40
    ds_write_b128 v4, v[116:119] offset:5120
    v_dot2c_f32_bf16 v128, s34, v41
    v_dot2c_f32_bf16 v129, v41, v41
    v_dot2c_f32_bf16 v128, s34, v42
    v_dot2c_f32_bf16 v129, v42, v42
    v_dot2c_f32_bf16 v128, s34, v43
    v_dot2c_f32_bf16 v129, v43, v43
    v_dot2c_f32_bf16 v128, s34, v44
    v_dot2c_f32_bf16 v129, v44, v44
    v_dot2c_f32_bf16 v128, s34, v45
    v_dot2c_f32_bf16 v129, v45, v45
    ds_write_b128 v4, v[120:123] offset:6144
    v_dot2c_f32_bf16 v128, s34, v46
    v_dot2c_f32_bf16 v129, v46, v46
    v_dot2c_f32_bf16 v128, s34, v47
    v_dot2c_f32_bf16 v129, v47, v47
    v_dot2c_f32_bf16 v128, s34, v48
    v_dot2c_f32_bf16 v129, v48, v48
    v_dot2c_f32_bf16 v128, s34, v49
    v_dot2c_f32_bf16 v129, v49, v49
    v_dot2c_f32_bf16 v128, s34, v50
    v_dot2c_f32_bf16 v129, v50, v50
    ds_write_b128 v4, v[124:127] offset:7168
    v_dot2c_f32_bf16 v128, s34, v51
    v_dot2c_f32_bf16 v129, v51, v51
    v_dot2c_f32_bf16 v128, s34, v52
    v_dot2c_f32_bf16 v129, v52, v52
    v_dot2c_f32_bf16 v128, s34, v53
    v_dot2c_f32_bf16 v129, v53, v53
    v_dot2c_f32_bf16 v128, s34, v54
    v_dot2c_f32_bf16 v129, v54, v54
    v_dot2c_f32_bf16 v128, s34, v55
    v_dot2c_f32_bf16 v129, v55, v55
    s_nop 2
    v_mov_b64 v[172:173], v[128:129]
    s_nop 1
    v_permlane32_swap_b32 v128, v172
    v_permlane32_swap_b32 v129, v173
    v_pk_add_f32 v[128:129], v[128:129], v[172:173]
    ds_write_b64 v5, v[128:129] offset:0
    s_waitcnt vmcnt(0)
    s_waitcnt lgkmcnt(0)
    s_barrier
    s_cmp_lg_u32 s29, 0
    s_cbranch_scc1 F_173
    s_lshl_b32 s32, s28, 2
    s_add_u32 s32, s32, s29
    s_lshl_b32 s32, s32, 2
    s_add_u32 s32, s32, 16384
    v_mov_b32 v178, s49
    s_mov_b64 exec, 1
    buffer_store_dword v178, off, s[4:7], s32 sc1
    s_mov_b64 exec, -1
F_173:
    s_add_u32 s49, s49, 1
    ds_read_b128 v[130:133], v6 offset:0
    ds_read_b128 v[134:137], v6 offset:16
    ds_read_b128 v[96:99], v3 offset:0
    ds_read_b128 v[100:103], v3 offset:1024
    ds_read_b128 v[104:107], v3 offset:8192
    ds_read_b128 v[108:111], v3 offset:9216
    ds_read_b128 v[112:115], v3 offset:16384
    ds_read_b128 v[116:119], v3 offset:17408
    ds_read_b128 v[120:123], v3 offset:24576
    ds_read_b128 v[124:127], v3 offset:25600
    s_waitcnt lgkmcnt(9)
    v_pk_add_f32 v[130:131], v[130:131], v[132:133]
    s_waitcnt lgkmcnt(8)
    v_pk_add_f32 v[134:135], v[134:135], v[136:137]
    v_pk_add_f32 v[130:131], v[130:131], v[134:135]
    v_mul_f32 v130, 0x3acccccd, v130
    v_mul_f32 v131, 0x3acccccd, v131
    v_fma_f32 v131, -v130, v130, v131
    v_max_f32 v131, 0, v131
    v_add_f32 v131, 0x3727c5ac, v131
    v_rsq_f32 v131, v131
    s_waitcnt lgkmcnt(5)
    v_pk_add_f32 v[96:97], v[96:97], v[104:105]
    v_pk_add_f32 v[98:99], v[98:99], v[106:107]
    s_waitcnt lgkmcnt(4)
    v_pk_add_f32 v[100:101], v[100:101], v[108:109]
    v_pk_add_f32 v[102:103], v[102:103], v[110:111]
    s_waitcnt lgkmcnt(3)
    v_pk_add_f32 v[96:97], v[96:97], v[112:113]
    v_pk_add_f32 v[98:99], v[98:99], v[114:115]
    s_waitcnt lgkmcnt(2)
    v_pk_add_f32 v[100:101], v[100:101], v[116:117]
    v_pk_add_f32 v[102:103], v[102:103], v[118:119]
    s_waitcnt lgkmcnt(1)
    v_pk_add_f32 v[96:97], v[96:97], v[120:121]
    v_pk_add_f32 v[98:99], v[98:99], v[122:123]
    s_waitcnt lgkmcnt(0)
    v_pk_add_f32 v[100:101], v[100:101], v[124:125]
    v_pk_add_f32 v[102:103], v[102:103], v[126:127]
    v_fma_f32 v96, -v130, v154, v96
    v_mul_f32 v96, v96, v131
    v_fma_f32 v97, -v130, v155, v97
    v_mul_f32 v97, v97, v131
    v_fma_f32 v98, -v130, v156, v98
    v_mul_f32 v98, v98, v131
    v_fma_f32 v99, -v130, v157, v99
    v_mul_f32 v99, v99, v131
    v_fma_f32 v100, -v130, v158, v100
    v_mul_f32 v100, v100, v131
    v_fma_f32 v101, -v130, v159, v101
    v_mul_f32 v101, v101, v131
    v_fma_f32 v102, -v130, v160, v102
    v_mul_f32 v102, v102, v131
    v_fma_f32 v103, -v130, v161, v103
    v_mul_f32 v103, v103, v131
    v_cvt_pk_bf16_f32 v172, v96, v97
    v_cvt_pk_bf16_f32 v173, v98, v99
    v_cvt_pk_bf16_f32 v174, v100, v101
    v_cvt_pk_bf16_f32 v175, v102, v103
    buffer_store_dwordx4 v[172:175], v7, s[4:7], s55 offen sc1
    s_branch G_168
G_170:
    s_waitcnt vmcnt(10)
    v_mfma_f32_32x32x16_bf16 v[96:111], a[0:3], v[56:59], 0
    v_mfma_f32_32x32x16_bf16 v[112:127], a[40:43], v[56:59], 0
    s_waitcnt vmcnt(9)
    v_mfma_f32_32x32x16_bf16 v[96:111], a[4:7], v[60:63], v[96:111]
    v_mfma_f32_32x32x16_bf16 v[112:127], a[44:47], v[60:63], v[112:127]
    s_waitcnt vmcnt(8)
    v_mfma_f32_32x32x16_bf16 v[96:111], a[8:11], v[64:67], v[96:111]
    v_mfma_f32_32x32x16_bf16 v[112:127], a[48:51], v[64:67], v[112:127]
    s_waitcnt vmcnt(7)
    v_mfma_f32_32x32x16_bf16 v[96:111], a[12:15], v[68:71], v[96:111]
    v_mfma_f32_32x32x16_bf16 v[112:127], a[52:55], v[68:71], v[112:127]
    s_waitcnt vmcnt(6)
    v_mfma_f32_32x32x16_bf16 v[96:111], a[16:19], v[72:75], v[96:111]
    v_mfma_f32_32x32x16_bf16 v[112:127], a[56:59], v[72:75], v[112:127]
    s_waitcnt vmcnt(5)
    v_mfma_f32_32x32x16_bf16 v[96:111], a[20:23], v[76:79], v[96:111]
    v_mfma_f32_32x32x16_bf16 v[112:127], a[60:63], v[76:79], v[112:127]
    s_waitcnt vmcnt(4)
    v_mfma_f32_32x32x16_bf16 v[96:111], a[24:27], v[80:83], v[96:111]
    v_mfma_f32_32x32x16_bf16 v[112:127], a[64:67], v[80:83], v[112:127]
    s_waitcnt vmcnt(3)
    v_mfma_f32_32x32x16_bf16 v[96:111], a[28:31], v[84:87], v[96:111]
    v_mfma_f32_32x32x16_bf16 v[112:127], a[68:71], v[84:87], v[112:127]
    s_waitcnt vmcnt(2)
    v_mfma_f32_32x32x16_bf16 v[96:111], a[32:35], v[88:91], v[96:111]
    v_mfma_f32_32x32x16_bf16 v[112:127], a[72:75], v[88:91], v[112:127]
    s_waitcnt vmcnt(1)
    v_mfma_f32_32x32x16_bf16 v[96:111], a[36:39], v[92:95], v[96:111]
    v_mfma_f32_32x32x16_bf16 v[112:127], a[76:79], v[92:95], v[112:127]
    s_mul_i32 s55, s44, s58
    s_add_u32 s55, s55, s51
    s_nop 1
    ds_write_b128 v4, v[96:99] offset:32768
    v_mov_b64 v[128:129], 0
    s_mov_b32 s34, 0x3f803f80
    v_dot2c_f32_bf16 v128, s34, v56
    v_dot2c_f32_bf16 v129, v56, v56
    v_dot2c_f32_bf16 v128, s34, v57
    v_dot2c_f32_bf16 v129, v57, v57
    v_dot2c_f32_bf16 v128, s34, v58
    v_dot2c_f32_bf16 v129, v58, v58
    v_dot2c_f32_bf16 v128, s34, v59
    v_dot2c_f32_bf16 v129, v59, v59
    v_dot2c_f32_bf16 v128, s34, v60
    v_dot2c_f32_bf16 v129, v60, v60
    ds_write_b128 v4, v[100:103] offset:33792
    v_dot2c_f32_bf16 v128, s34, v61
    v_dot2c_f32_bf16 v129, v61, v61
    v_dot2c_f32_bf16 v128, s34, v62
    v_dot2c_f32_bf16 v129, v62, v62
    v_dot2c_f32_bf16 v128, s34, v63
    v_dot2c_f32_bf16 v129, v63, v63
    v_dot2c_f32_bf16 v128, s34, v64
    v_dot2c_f32_bf16 v129, v64, v64
    v_dot2c_f32_bf16 v128, s34, v65
    v_dot2c_f32_bf16 v129, v65, v65
    ds_write_b128 v4, v[104:107] offset:34816
    v_dot2c_f32_bf16 v128, s34, v66
    v_dot2c_f32_bf16 v129, v66, v66
    v_dot2c_f32_bf16 v128, s34, v67
    v_dot2c_f32_bf16 v129, v67, v67
    v_dot2c_f32_bf16 v128, s34, v68
    v_dot2c_f32_bf16 v129, v68, v68
    v_dot2c_f32_bf16 v128, s34, v69
    v_dot2c_f32_bf16 v129, v69, v69
    v_dot2c_f32_bf16 v128, s34, v70
    v_dot2c_f32_bf16 v129, v70, v70
    ds_write_b128 v4, v[108:111] offset:35840
    v_dot2c_f32_bf16 v128, s34, v71
    v_dot2c_f32_bf16 v129, v71, v71
    v_dot2c_f32_bf16 v128, s34, v72
    v_dot2c_f32_bf16 v129, v72, v72
    v_dot2c_f32_bf16 v128, s34, v73
    v_dot2c_f32_bf16 v129, v73, v73
    v_dot2c_f32_bf16 v128, s34, v74
    v_dot2c_f32_bf16 v129, v74, v74
    v_dot2c_f32_bf16 v128, s34, v75
    v_dot2c_f32_bf16 v129, v75, v75
    ds_write_b128 v4, v[112:115] offset:36864
    v_dot2c_f32_bf16 v128, s34, v76
    v_dot2c_f32_bf16 v129, v76, v76
    v_dot2c_f32_bf16 v128, s34, v77
    v_dot2c_f32_bf16 v129, v77, v77
    v_dot2c_f32_bf16 v128, s34, v78
    v_dot2c_f32_bf16 v129, v78, v78
    v_dot2c_f32_bf16 v128, s34, v79
    v_dot2c_f32_bf16 v129, v79, v79
    v_dot2c_f32_bf16 v128, s34, v80
    v_dot2c_f32_bf16 v129, v80, v80
    ds_write_b128 v4, v[116:119] offset:37888
    v_dot2c_f32_bf16 v128, s34, v81
    v_dot2c_f32_bf16 v129, v81, v81
    v_dot2c_f32_bf16 v128, s34, v82
    v_dot2c_f32_bf16 v129, v82, v82
    v_dot2c_f32_bf16 v128, s34, v83
    v_dot2c_f32_bf16 v129, v83, v83
    v_dot2c_f32_bf16 v128, s34, v84
    v_dot2c_f32_bf16 v129, v84, v84
    v_dot2c_f32_bf16 v128, s34, v85
    v_dot2c_f32_bf16 v129, v85, v85
    ds_write_b128 v4, v[120:123] offset:38912
    v_dot2c_f32_bf16 v128, s34, v86
    v_dot2c_f32_bf16 v129, v86, v86
    v_dot2c_f32_bf16 v128, s34, v87
    v_dot2c_f32_bf16 v129, v87, v87
    v_dot2c_f32_bf16 v128, s34, v88
    v_dot2c_f32_bf16 v129, v88, v88
    v_dot2c_f32_bf16 v128, s34, v89
    v_dot2c_f32_bf16 v129, v89, v89
    v_dot2c_f32_bf16 v128, s34, v90
    v_dot2c_f32_bf16 v129, v90, v90
    ds_write_b128 v4, v[124:127] offset:39936
    v_dot2c_f32_bf16 v128, s34, v91
    v_dot2c_f32_bf16 v129, v91, v91
    v_dot2c_f32_bf16 v128, s34, v92
    v_dot2c_f32_bf16 v129, v92, v92
    v_dot2c_f32_bf16 v128, s34, v93
    v_dot2c_f32_bf16 v129, v93, v93
    v_dot2c_f32_bf16 v128, s34, v94
    v_dot2c_f32_bf16 v129, v94, v94
    v_dot2c_f32_bf16 v128, s34, v95
    v_dot2c_f32_bf16 v129, v95, v95
    s_nop 2
    v_mov_b64 v[172:173], v[128:129]
    s_nop 1
    v_permlane32_swap_b32 v128, v172
    v_permlane32_swap_b32 v129, v173
    v_pk_add_f32 v[128:129], v[128:129], v[172:173]
    ds_write_b64 v5, v[128:129] offset:1024
    s_waitcnt vmcnt(0)
    s_waitcnt lgkmcnt(0)
    s_barrier
    s_cmp_lg_u32 s29, 0
    s_cbranch_scc1 F_174
    s_lshl_b32 s32, s28, 2
    s_add_u32 s32, s32, s29
    s_lshl_b32 s32, s32, 2
    s_add_u32 s32, s32, 16384
    v_mov_b32 v178, s49
    s_mov_b64 exec, 1
    buffer_store_dword v178, off, s[4:7], s32 sc1
    s_mov_b64 exec, -1
F_174:
    s_add_u32 s49, s49, 1
    ds_read_b128 v[130:133], v6 offset:1024
    ds_read_b128 v[134:137], v6 offset:1040
    ds_read_b128 v[96:99], v3 offset:32768
    ds_read_b128 v[100:103], v3 offset:33792
    ds_read_b128 v[104:107], v3 offset:40960
    ds_read_b128 v[108:111], v3 offset:41984
    ds_read_b128 v[112:115], v3 offset:49152
    ds_read_b128 v[116:119], v3 offset:50176
    ds_read_b128 v[120:123], v3 offset:57344
    ds_read_b128 v[124:127], v3 offset:58368
    s_waitcnt lgkmcnt(9)
    v_pk_add_f32 v[130:131], v[130:131], v[132:133]
    s_waitcnt lgkmcnt(8)
    v_pk_add_f32 v[134:135], v[134:135], v[136:137]
    v_pk_add_f32 v[130:131], v[130:131], v[134:135]
    v_mul_f32 v130, 0x3acccccd, v130
    v_mul_f32 v131, 0x3acccccd, v131
    v_fma_f32 v131, -v130, v130, v131
    v_max_f32 v131, 0, v131
    v_add_f32 v131, 0x3727c5ac, v131
    v_rsq_f32 v131, v131
    s_waitcnt lgkmcnt(5)
    v_pk_add_f32 v[96:97], v[96:97], v[104:105]
    v_pk_add_f32 v[98:99], v[98:99], v[106:107]
    s_waitcnt lgkmcnt(4)
    v_pk_add_f32 v[100:101], v[100:101], v[108:109]
    v_pk_add_f32 v[102:103], v[102:103], v[110:111]
    s_waitcnt lgkmcnt(3)
    v_pk_add_f32 v[96:97], v[96:97], v[112:113]
    v_pk_add_f32 v[98:99], v[98:99], v[114:115]
    s_waitcnt lgkmcnt(2)
    v_pk_add_f32 v[100:101], v[100:101], v[116:117]
    v_pk_add_f32 v[102:103], v[102:103], v[118:119]
    s_waitcnt lgkmcnt(1)
    v_pk_add_f32 v[96:97], v[96:97], v[120:121]
    v_pk_add_f32 v[98:99], v[98:99], v[122:123]
    s_waitcnt lgkmcnt(0)
    v_pk_add_f32 v[100:101], v[100:101], v[124:125]
    v_pk_add_f32 v[102:103], v[102:103], v[126:127]
    v_fma_f32 v96, -v130, v154, v96
    v_mul_f32 v96, v96, v131
    v_fma_f32 v97, -v130, v155, v97
    v_mul_f32 v97, v97, v131
    v_fma_f32 v98, -v130, v156, v98
    v_mul_f32 v98, v98, v131
    v_fma_f32 v99, -v130, v157, v99
    v_mul_f32 v99, v99, v131
    v_fma_f32 v100, -v130, v158, v100
    v_mul_f32 v100, v100, v131
    v_fma_f32 v101, -v130, v159, v101
    v_mul_f32 v101, v101, v131
    v_fma_f32 v102, -v130, v160, v102
    v_mul_f32 v102, v102, v131
    v_fma_f32 v103, -v130, v161, v103
    v_mul_f32 v103, v103, v131
    v_cvt_pk_bf16_f32 v172, v96, v97
    v_cvt_pk_bf16_f32 v173, v98, v99
    v_cvt_pk_bf16_f32 v174, v100, v101
    v_cvt_pk_bf16_f32 v175, v102, v103
    buffer_store_dwordx4 v[172:175], v7, s[4:7], s55 offen sc1
G_168:
G1_153:
    s_waitcnt vmcnt(0)
    s_barrier
    s_cmp_lg_u32 s29, 0
    s_cbranch_scc1 F_175
    s_lshl_b32 s32, s28, 2
    s_add_u32 s32, s32, s29
    s_lshl_b32 s32, s32, 2
    s_add_u32 s32, s32, 16384
    v_mov_b32 v172, s49
    s_mov_b64 exec, 1
    buffer_store_dword v172, off, s[4:7], s32 sc1
    s_mov_b64 exec, -1
F_175:
    s_cmp_lt_u32 s28, 160
    s_cbranch_scc1 R_176
    s_sub_u32 s40, s28, 160
    v_bfe_u32 v2, v1, 1, 1
    v_mul_u32_u24 v2, 2048, v2
    v_bfe_u32 v8, v1, 3, 1
    v_lshl_add_u32 v2, v8, 12, v2
    v_bfe_u32 v8, v1, 2, 1
    v_lshl_add_u32 v2, v8, 6, v2
    v_bfe_u32 v8, v1, 4, 1
    v_lshl_add_u32 v2, v8, 7, v2
    v_bfe_u32 v8, v1, 5, 1
    v_lshl_add_u32 v2, v8, 5, v2
    v_bfe_u32 v8, v1, 0, 1
    v_lshl_add_u32 v2, v8, 4, v2
    v_bfe_u32 v3, v1, 4, 1
    v_mul_u32_u24 v3, 1024, v3
    v_bfe_u32 v8, v1, 5, 1
    v_lshl_add_u32 v3, v8, 8, v3
    v_bfe_u32 v8, v1, 0, 2
    v_lshl_add_u32 v3, v8, 4, v3
    v_bfe_u32 v8, v1, 2, 1
    v_lshl_add_u32 v3, v8, 7, v3
    v_bfe_u32 v8, v1, 3, 1
    v_lshl_add_u32 v3, v8, 6, v3
    v_bfe_u32 v4, v1, 0, 1
    v_mul_u32_u24 v4, 256, v4
    v_bfe_u32 v8, v1, 5, 1
    v_lshl_add_u32 v4, v8, 7, v4
    v_bfe_u32 v8, v1, 2, 2
    v_lshl_add_u32 v4, v8, 3, v4
    v_add_u32 v4, s60, v4
    s_mov_b32 m0, s60
    v_bfe_u32 v5, v1, 0, 2
    v_mul_u32_u24 v5, 8, v5
    v_bfe_u32 v8, v1, 2, 1
    v_lshl_add_u32 v5, v8, 6, v5
    v_bfe_u32 v8, v1, 3, 1
    v_lshl_add_u32 v5, v8, 5, v5
    v_bfe_u32 v8, v1, 4, 2
    v_lshl_add_u32 v5, v8, 7, v5
    v_add_u32 v5, 2048, v5
    v_bfe_u32 v6, v1, 4, 1
    v_mul_u32_u24 v6, 131072, v6
    v_bfe_u32 v8, v1, 5, 1
    v_lshl_add_u32 v6, v8, 8, v6
    v_bfe_u32 v8, v1, 0, 4
    v_lshl_add_u32 v6, v8, 4, v6
    v_bfe_u32 v9, v1, 0, 2
    v_bfe_u32 v8, v1, 2, 1
    v_lshl_add_u32 v9, v8, 3, v9
    v_bfe_u32 v8, v1, 3, 1
    v_lshl_add_u32 v9, v8, 2, v9
    v_bfe_u32 v8, v1, 4, 1
    v_lshl_add_u32 v9, v8, 4, v9
    v_bfe_u32 v10, v1, 5, 1
    v_mul_u32_u24 v10, 8, v10
    v_sub_u32 v9, v9, v10
    v_mov_b32 v10, 0xf149f2ca
    v_cmp_gt_i32 vcc, 0, v9
    s_nop 1
    v_cndmask_b32 v152, 0, v10, vcc
    v_cmp_gt_i32 vcc, 1, v9
    s_nop 1
    v_cndmask_b32 v153, 0, v10, vcc
    v_cmp_gt_i32 vcc, 2, v9
    s_nop 1
    v_cndmask_b32 v154, 0, v10, vcc
    v_cmp_gt_i32 vcc, 3, v9
    s_nop 1
    v_cndmask_b32 v155, 0, v10, vcc
    v_cmp_gt_i32 vcc, 4, v9
    s_nop 1
    v_cndmask_b32 v156, 0, v10, vcc
    v_cmp_gt_i32 vcc, 5, v9
    s_nop 1
    v_cndmask_b32 v157, 0, v10, vcc
    v_cmp_gt_i32 vcc, 6, v9
    s_nop 1
    v_cndmask_b32 v158, 0, v10, vcc
    v_cmp_gt_i32 vcc, 7, v9
    s_nop 1
    v_cndmask_b32 v159, 0, v10, vcc
    v_cmp_gt_i32 vcc, 16, v9
    s_nop 1
    v_cndmask_b32 v160, 0, v10, vcc
    v_cmp_gt_i32 vcc, 17, v9
    s_nop 1
    v_cndmask_b32 v161, 0, v10, vcc
    v_cmp_gt_i32 vcc, 18, v9
    s_nop 1
    v_cndmask_b32 v162, 0, v10, vcc
    v_cmp_gt_i32 vcc, 19, v9
    s_nop 1
    v_cndmask_b32 v163, 0, v10, vcc
    v_cmp_gt_i32 vcc, 20, v9
    s_nop 1
    v_cndmask_b32 v164, 0, v10, vcc
    v_cmp_gt_i32 vcc, 21, v9
    s_nop 1
    v_cndmask_b32 v165, 0, v10, vcc
    v_cmp_gt_i32 vcc, 22, v9
    s_nop 1
    v_cndmask_b32 v166, 0, v10, vcc
    v_cmp_gt_i32 vcc, 23, v9
    s_nop 1
    v_cndmask_b32 v167, 0, v10, vcc
    v_mov_b32 v9, 4
    s_mov_b32 s48, 0
P_177:
    buffer_load_dword v8, v9, s[24:27], 0 offen sc1
    s_waitcnt vmcnt(0)
    v_cmp_gt_u32 vcc, 1, v8
    s_cbranch_vccz P_178
    s_add_u32 s48, s48, 1
    s_cmp_gt_u32 s48, 200000
    s_cbranch_scc1 L_end
    s_sleep 1
    s_branch P_177
P_178:
    v_readfirstlane_b32 s34, v8
    s_nop 0
    s_and_b32 s34, s34, 2
    s_lshl_b32 s34, s34, 12
    s_lshr_b32 s35, s40, 3
    s_lshl_b32 s35, s35, 9
    s_add_u32 s34, s34, s35
    s_and_b32 s35, s40, 1
    s_lshl_b32 s35, s35, 8
    s_add_u32 s34, s34, s35
    s_bfe_u32 s35, s40, 0x20001
    s_lshl_b32 s35, s35, 6
    s_add_u32 s34, s34, s35
    v_bfe_u32 v7, v1, 0, 1
    v_mul_u32_u24 v7, 16384, v7
    v_add_u32 v7, s34, v7
    v_add_u32 v12, 0, v1
    v_min_u32 v12, 31, v12
    v_lshlrev_b32 v12, 4, v12
    s_mov_b32 s32, 31232
    s_mov_b32 s48, 0
P_179:
    buffer_load_dword v8, v12, s[4:7], s32 offen sc1
    s_waitcnt vmcnt(0)
    v_cmp_gt_u32 vcc, 1, v8
    s_cbranch_vccz P_180
    s_add_u32 s48, s48, 1
    s_cmp_gt_u32 s48, 200000
    s_cbranch_scc1 L_end
    s_sleep 1
    s_branch P_179
P_180:
    s_add_u32 s57, s61, 64
    s_mul_i32 s37, s40, 6
    v_add_u32 v12, 0, v1
    v_min_u32 v12, 5, v12
    v_lshlrev_b32 v12, 4, v12
    s_lshl_b32 s32, s37, 4
    s_add_u32 s32, s32, 16384
    s_mov_b32 s48, 0
P_181:
    buffer_load_dword v8, v12, s[4:7], s32 offen sc1
    s_waitcnt vmcnt(0)
    v_cmp_gt_u32 vcc, s57, v8
    s_cbranch_vccz P_182
    s_add_u32 s48, s48, 1
    s_cmp_gt_u32 s48, 200000
    s_cbranch_scc1 L_end
    s_sleep 1
    s_branch P_181
P_182:
    s_mov_b32 s44, s29
    s_add_u32 s49, s61, 1
    s_mov_b32 s68, 0x3e0293ee
    s_waitcnt vmcnt(0) lgkmcnt(0)
AT_183:
    s_lshl_b32 s34, s44, 5
    s_add_u32 s34, s34, s40
    s_mul_i32 s35, s30, 16777216
    s_add_u32 s35, s35, 33554432
    s_lshl_b32 s36, s34, 13
    s_add_u32 s35, s35, s36
    s_mul_i32 s37, s30, 34603008
    s_add_u32 s37, s37, 117440512
    s_lshl_b32 s36, s34, 14
    s_add_u32 s37, s37, s36
    buffer_load_dwordx4 v[16:19], v0, s[4:7], s35 offen offset:0 sc1
    buffer_load_dwordx4 v[48:51], v2, s[4:7], s37 offen offset:0 sc1
    buffer_load_dwordx4 v[20:23], v0, s[4:7], s35 offen offset:1024 sc1
    buffer_load_dwordx4 v[52:55], v2, s[4:7], s37 offen offset:256 sc1
    buffer_load_dwordx4 v[24:27], v0, s[4:7], s35 offen offset:2048 sc1
    buffer_load_dwordx4 v[56:59], v2, s[4:7], s37 offen offset:512 sc1
    buffer_load_dwordx4 v[28:31], v0, s[4:7], s35 offen offset:3072 sc1
    buffer_load_dwordx4 v[60:63], v2, s[4:7], s37 offen offset:768 sc1
    s_add_u32 s35, s35, 4096
    buffer_load_dwordx4 v[32:35], v0, s[4:7], s35 offen offset:0 sc1
    buffer_load_dwordx4 v[64:67], v2, s[4:7], s37 offen offset:1024 sc1
    buffer_load_dwordx4 v[36:39], v0, s[4:7], s35 offen offset:1024 sc1
    buffer_load_dwordx4 v[68:71], v2, s[4:7], s37 offen offset:1280 sc1
    buffer_load_dwordx4 v[40:43], v0, s[4:7], s35 offen offset:2048 sc1
    buffer_load_dwordx4 v[72:75], v2, s[4:7], s37 offen offset:1536 sc1
    buffer_load_dwordx4 v[44:47], v0, s[4:7], s35 offen offset:3072 sc1
    buffer_load_dwordx4 v[76:79], v2, s[4:7], s37 offen offset:1792 sc1
    s_add_u32 s37, s37, 8192
    buffer_load_dwordx4 v[80:83], v3, s[4:7], s37 offen offset:0 sc1
    buffer_load_dwordx4 v[84:87], v3, s[4:7], s37 offen offset:512 sc1
    buffer_load_dwordx4 v[88:91], v3, s[4:7], s37 offen offset:2048 sc1
    buffer_load_dwordx4 v[92:95], v3, s[4:7], s37 offen offset:2560 sc1
    s_add_u32 s37, s37, 4096
    buffer_load_dwordx4 v[96:99], v3, s[4:7], s37 offen offset:0 sc1
    buffer_load_dwordx4 v[100:103], v3, s[4:7], s37 offen offset:512 sc1
    buffer_load_dwordx4 v[104:107], v3, s[4:7], s37 offen offset:2048 sc1
    buffer_load_dwordx4 v[108:111], v3, s[4:7], s37 offen offset:2560 sc1
    s_waitcnt vmcnt(22)
    v_mfma_f32_32x32x16_bf16 v[168:183], v[48:51], v[16:19], v[152:167]
    s_waitcnt vmcnt(20)
    v_mfma_f32_32x32x16_bf16 v[168:183], v[52:55], v[20:23], v[168:183]
    s_waitcnt vmcnt(18)
    v_mfma_f32_32x32x16_bf16 v[168:183], v[56:59], v[24:27], v[168:183]
    s_waitcnt vmcnt(16)
    v_mfma_f32_32x32x16_bf16 v[168:183], v[60:63], v[28:31], v[168:183]
    s_waitcnt vmcnt(14)
    v_mfma_f32_32x32x16_bf16 v[168:183], v[64:67], v[32:35], v[168:183]
    s_waitcnt vmcnt(12)
    v_mfma_f32_32x32x16_bf16 v[168:183], v[68:71], v[36:39], v[168:183]
    s_waitcnt vmcnt(10)
    v_mfma_f32_32x32x16_bf16 v[168:183], v[72:75], v[40:43], v[168:183]
    s_waitcnt vmcnt(8)
    v_mfma_f32_32x32x16_bf16 v[168:183], v[76:79], v[44:47], v[168:183]
    s_mul_i32 s35, s30, 4194304
    s_add_u32 s35, s35, 2097152
    s_lshl_b32 s36, s44, 15
    s_add_u32 s35, s35, s36
    s_mov_b32 s48, 0
P_184:
    buffer_load_dword v8, v7, s[4:7], s35 offen sc1
    s_waitcnt vmcnt(0)
    v_cmp_eq_u32 vcc, -1, v8
    s_cbranch_vccz P_185
    s_add_u32 s48, s48, 1
    s_cmp_gt_u32 s48, 200000
    s_cbranch_scc1 L_end
    s_sleep 1
    s_branch P_184
P_185:
    s_mul_i32 s35, s30, 8388608
    s_add_u32 s35, s35, 100663296
    s_lshl_b32 s36, s34, 12
    s_add_u32 s35, s35, s36
    buffer_load_dwordx4 v0, s[4:7], s35 offen offset:0 sc1 lds
    buffer_load_dwordx4 v0, s[4:7], s35 offen offset:1024 sc1 lds
    buffer_load_dwordx2 v[144:145], v5, s[4:7], s35 offen offset:0 sc1
    buffer_load_dwordx2 v[146:147], v5, s[4:7], s35 offen offset:512 sc1
    buffer_load_dwordx2 v[148:149], v5, s[4:7], s35 offen offset:1024 sc1
    buffer_load_dwordx2 v[150:151], v5, s[4:7], s35 offen offset:1536 sc1
    v_max3_f32 v8, v168, v169, v170
    v_max3_f32 v8, v8, v171, v172
    v_max3_f32 v8, v8, v173, v174
    v_max3_f32 v8, v8, v175, v176
    v_max3_f32 v8, v8, v177, v178
    v_max3_f32 v8, v8, v179, v180
    v_max3_f32 v8, v8, v181, v182
    v_max_f32 v8, v8, v183
    s_waitcnt vmcnt(4)
    ds_read_b64_tr_b16 v[112:113], v4 offset:0
    ds_read_b64_tr_b16 v[114:115], v4 offset:32
    ds_read_b64_tr_b16 v[116:117], v4 offset:64
    ds_read_b64_tr_b16 v[118:119], v4 offset:96
    ds_read_b64_tr_b16 v[120:121], v4 offset:512
    ds_read_b64_tr_b16 v[122:123], v4 offset:544
    ds_read_b64_tr_b16 v[124:125], v4 offset:576
    ds_read_b64_tr_b16 v[126:127], v4 offset:608
    ds_read_b64_tr_b16 v[128:129], v4 offset:1024
    ds_read_b64_tr_b16 v[130:131], v4 offset:1056
    ds_read_b64_tr_b16 v[132:133], v4 offset:1088
    ds_read_b64_tr_b16 v[134:135], v4 offset:1120
    ds_read_b64_tr_b16 v[136:137], v4 offset:1536
    ds_read_b64_tr_b16 v[138:139], v4 offset:1568
    ds_read_b64_tr_b16 v[140:141], v4 offset:1600
    ds_read_b64_tr_b16 v[142:143], v4 offset:1632
    s_waitcnt lgkmcnt(14)
    v_mfma_f32_32x32x16_bf16 v[184:199], v[112:115], v[16:19], 0
    s_waitcnt lgkmcnt(12)
    v_mfma_f32_32x32x16_bf16 v[184:199], v[116:119], v[20:23], v[184:199]
    s_waitcnt lgkmcnt(10)
    v_mfma_f32_32x32x16_bf16 v[184:199], v[120:123], v[24:27], v[184:199]
    s_waitcnt lgkmcnt(8)
    v_mfma_f32_32x32x16_bf16 v[184:199], v[124:127], v[28:31], v[184:199]
    s_waitcnt lgkmcnt(6)
    v_mfma_f32_32x32x16_bf16 v[184:199], v[128:131], v[32:35], v[184:199]
    s_waitcnt lgkmcnt(4)
    v_mfma_f32_32x32x16_bf16 v[184:199], v[132:135], v[36:39], v[184:199]
    s_waitcnt lgkmcnt(2)
    v_mfma_f32_32x32x16_bf16 v[184:199], v[136:139], v[40:43], v[184:199]
    s_waitcnt lgkmcnt(0)
    v_mfma_f32_32x32x16_bf16 v[184:199], v[140:143], v[44:47], v[184:199]
    s_nop 11
    v_max3_f32 v8, v8, v184, v185
    v_max3_f32 v8, v8, v186, v187
    v_mov_b32 v9, v8
    s_nop 1
    v_permlane32_swap_b32 v8, v9
    v_max_f32 v8, v8, v9
    v_mul_f32 v8, s68, v8
    v_fma_f32 v168, v168, s68, -v8
    v_fma_f32 v169, v169, s68, -v8
    v_fma_f32 v170, v170, s68, -v8
    v_fma_f32 v171, v171, s68, -v8
    v_fma_f32 v172, v172, s68, -v8
    v_fma_f32 v173, v173, s68, -v8
    v_fma_f32 v174, v174, s68, -v8
    v_fma_f32 v175, v175, s68, -v8
    v_fma_f32 v176, v176, s68, -v8
    v_fma_f32 v177, v177, s68, -v8
    v_fma_f32 v178, v178, s68, -v8
    v_fma_f32 v179, v179, s68, -v8
    v_fma_f32 v180, v180, s68, -v8
    v_fma_f32 v181, v181, s68, -v8
    v_fma_f32 v182, v182, s68, -v8
    v_fma_f32 v183, v183, s68, -v8
    v_fma_f32 v184, v184, s68, -v8
    v_fma_f32 v185, v185, s68, -v8
    v_fma_f32 v186, v186, s68, -v8
    v_fma_f32 v187, v187, s68, -v8
    v_exp_f32 v168, v168
    v_exp_f32 v169, v169
    v_exp_f32 v170, v170
    v_exp_f32 v171, v171
    v_exp_f32 v172, v172
    v_exp_f32 v173, v173
    v_exp_f32 v174, v174
    v_exp_f32 v175, v175
    v_exp_f32 v176, v176
    v_exp_f32 v177, v177
    v_exp_f32 v178, v178
    v_exp_f32 v179, v179
    v_exp_f32 v180, v180
    v_exp_f32 v181, v181
    v_exp_f32 v182, v182
    v_exp_f32 v183, v183
    v_exp_f32 v184, v184
    v_exp_f32 v185, v185
    v_exp_f32 v186, v186
    v_exp_f32 v187, v187
    v_pk_add_f32 v[8:9], v[168:169], v[170:171]
    v_pk_add_f32 v[8:9], v[8:9], v[172:173]
    v_pk_add_f32 v[8:9], v[8:9], v[174:175]
    v_pk_add_f32 v[8:9], v[8:9], v[176:177]
    v_pk_add_f32 v[8:9], v[8:9], v[178:179]
    v_pk_add_f32 v[8:9], v[8:9], v[180:181]
    v_pk_add_f32 v[8:9], v[8:9], v[182:183]
    v_pk_add_f32 v[8:9], v[8:9], v[184:185]
    v_pk_add_f32 v[8:9], v[8:9], v[186:187]
    v_add_f32 v8, v8, v9
    v_mov_b32 v9, v8
    s_nop 1
    v_permlane32_swap_b32 v8, v9
    v_add_f32 v8, v8, v9
    v_rcp_f32 v8, v8
    s_nop 0
    v_pk_mul_f32 v[168:169], v[168:169], v[8:9] op_sel_hi:[1,0]
    s_nop 0
    v_cvt_pk_bf16_f32 v188, v168, v169
    v_pk_mul_f32 v[170:171], v[170:171], v[8:9] op_sel_hi:[1,0]
    s_nop 0
    v_cvt_pk_bf16_f32 v189, v170, v171
    v_pk_mul_f32 v[172:173], v[172:173], v[8:9] op_sel_hi:[1,0]
    s_nop 0
    v_cvt_pk_bf16_f32 v190, v172, v173
    v_pk_mul_f32 v[174:175], v[174:175], v[8:9] op_sel_hi:[1,0]
    s_nop 0
    v_cvt_pk_bf16_f32 v191, v174, v175
    v_pk_mul_f32 v[176:177], v[176:177], v[8:9] op_sel_hi:[1,0]
    s_nop 0
    v_cvt_pk_bf16_f32 v192, v176, v177
    v_pk_mul_f32 v[178:179], v[178:179], v[8:9] op_sel_hi:[1,0]
    s_nop 0
    v_cvt_pk_bf16_f32 v193, v178, v179
    v_pk_mul_f32 v[180:181], v[180:181], v[8:9] op_sel_hi:[1,0]
    s_nop 0
    v_cvt_pk_bf16_f32 v194, v180, v181
    v_pk_mul_f32 v[182:183], v[182:183], v[8:9] op_sel_hi:[1,0]
    s_nop 0
    v_cvt_pk_bf16_f32 v195, v182, v183
    v_pk_mul_f32 v[184:185], v[184:185], v[8:9] op_sel_hi:[1,0]
    s_nop 0
    v_cvt_pk_bf16_f32 v196, v184, v185
    v_pk_mul_f32 v[186:187], v[186:187], v[8:9] op_sel_hi:[1,0]
    s_nop 0
    v_cvt_pk_bf16_f32 v197, v186, v187
    s_waitcnt vmcnt(3)
    s_nop 0
    v_mfma_f32_32x32x8_bf16 v[16:31], v[144:145], v[196:197], 0
    s_waitcnt vmcnt(2)
    v_mfma_f32_32x32x8_bf16 v[32:47], v[146:147], v[196:197], 0
    s_waitcnt vmcnt(1)
    v_mfma_f32_32x32x8_bf16 v[48:63], v[148:149], v[196:197], 0
    s_waitcnt vmcnt(0)
    v_mfma_f32_32x32x8_bf16 v[64:79], v[150:151], v[196:197], 0
    v_mfma_f32_32x32x16_bf16 v[16:31], v[80:83], v[188:191], v[16:31]
    v_mfma_f32_32x32x16_bf16 v[16:31], v[84:87], v[192:195], v[16:31]
    v_mfma_f32_32x32x16_bf16 v[32:47], v[88:91], v[188:191], v[32:47]
    v_mfma_f32_32x32x16_bf16 v[32:47], v[92:95], v[192:195], v[32:47]
    v_mfma_f32_32x32x16_bf16 v[48:63], v[96:99], v[188:191], v[48:63]
    v_mfma_f32_32x32x16_bf16 v[48:63], v[100:103], v[192:195], v[48:63]
    v_mfma_f32_32x32x16_bf16 v[64:79], v[104:107], v[188:191], v[64:79]
    v_mfma_f32_32x32x16_bf16 v[64:79], v[108:111], v[192:195], v[64:79]
    s_mul_i32 s35, s30, 16777216
    s_add_u32 s35, s35, 67108864
    s_lshl_b32 s36, s44, 18
    s_add_u32 s35, s35, s36
    s_lshl_b32 s36, s40, 12
    s_add_u32 s35, s35, s36
    v_cvt_pk_bf16_f32 v112, v16, v17
    v_cvt_pk_bf16_f32 v113, v18, v19
    v_cvt_pk_bf16_f32 v114, v20, v21
    v_cvt_pk_bf16_f32 v115, v22, v23
    buffer_store_dwordx4 v[112:115], v6, s[4:7], s35 offen offset:0 sc1
    v_cvt_pk_bf16_f32 v116, v24, v25
    v_cvt_pk_bf16_f32 v117, v26, v27
    v_cvt_pk_bf16_f32 v118, v28, v29
    v_cvt_pk_bf16_f32 v119, v30, v31
    buffer_store_dwordx4 v[116:119], v6, s[4:7], s35 offen offset:512 sc1
    v_cvt_pk_bf16_f32 v120, v32, v33
    v_cvt_pk_bf16_f32 v121, v34, v35
    v_cvt_pk_bf16_f32 v122, v36, v37
    v_cvt_pk_bf16_f32 v123, v38, v39
    buffer_store_dwordx4 v[120:123], v6, s[4:7], s35 offen offset:1024 sc1
    v_cvt_pk_bf16_f32 v124, v40, v41
    v_cvt_pk_bf16_f32 v125, v42, v43
    v_cvt_pk_bf16_f32 v126, v44, v45
    v_cvt_pk_bf16_f32 v127, v46, v47
    buffer_store_dwordx4 v[124:127], v6, s[4:7], s35 offen offset:1536 sc1
    v_cvt_pk_bf16_f32 v128, v48, v49
    v_cvt_pk_bf16_f32 v129, v50, v51
    v_cvt_pk_bf16_f32 v130, v52, v53
    v_cvt_pk_bf16_f32 v131, v54, v55
    buffer_store_dwordx4 v[128:131], v6, s[4:7], s35 offen offset:2048 sc1
    v_cvt_pk_bf16_f32 v132, v56, v57
    v_cvt_pk_bf16_f32 v133, v58, v59
    v_cvt_pk_bf16_f32 v134, v60, v61
    v_cvt_pk_bf16_f32 v135, v62, v63
    buffer_store_dwordx4 v[132:135], v6, s[4:7], s35 offen offset:2560 sc1
    v_cvt_pk_bf16_f32 v136, v64, v65
    v_cvt_pk_bf16_f32 v137, v66, v67
    v_cvt_pk_bf16_f32 v138, v68, v69
    v_cvt_pk_bf16_f32 v139, v70, v71
    buffer_store_dwordx4 v[136:139], v6, s[4:7], s35 offen offset:3072 sc1
    v_cvt_pk_bf16_f32 v140, v72, v73
    v_cvt_pk_bf16_f32 v141, v74, v75
    v_cvt_pk_bf16_f32 v142, v76, v77
    v_cvt_pk_bf16_f32 v143, v78, v79
    buffer_store_dwordx4 v[140:143], v6, s[4:7], s35 offen offset:3584 sc1
    s_waitcnt vmcnt(0)
    s_lshl_b32 s32, s28, 2
    s_add_u32 s32, s32, s29
    s_lshl_b32 s32, s32, 2
    s_add_u32 s32, s32, 20480
    v_mov_b32 v8, s49
    s_mov_b64 exec, 1
    buffer_store_dword v8, off, s[4:7], s32 sc1
    s_mov_b64 exec, -1
F_186:
    s_add_u32 s49, s49, 1
    s_add_u32 s44, s44, 4
    s_cmp_lt_u32 s44, 64
    s_cbranch_scc1 AT_183
R_176:
    s_cmp_ge_u32 s28, 140
    s_cbranch_scc1 R_187
    s_mul_i32 s68, s28, 3277
    s_lshr_b32 s68, s68, 16
    s_mul_i32 s69, s68, 20
    s_sub_u32 s69, s28, s69
    s_load_dwordx2 s[16:17], s[0:1], 64
    s_mov_b32 s18, 5242880
    s_mov_b32 s19, 0x20000
    s_waitcnt lgkmcnt(0)
    v_bfe_u32 v2, v1, 2, 4
    v_mul_u32_u24 v2, 1280, v2
    v_bfe_u32 v8, v1, 0, 2
    v_lshl_add_u32 v2, v8, 4, v2
    v_bfe_u32 v3, v1, 4, 2
    v_mul_u32_u24 v3, 512, v3
    v_bfe_u32 v8, v1, 2, 2
    v_lshl_add_u32 v3, v8, 6, v3
    v_bfe_u32 v8, v1, 0, 2
    v_lshl_add_u32 v3, v8, 4, v3
    v_add_u32 v3, s60, v3
    s_mul_i32 s34, s29, 1310720
    s_lshl_b32 s35, s69, 6
    s_add_u32 s34, s34, s35
    s_add_u32 m0, s60, 0
    s_add_u32 s35, s34, 0
    buffer_load_dwordx4 v2, s[16:19], s35 offen lds
    s_add_u32 m0, s60, 1024
    s_add_u32 s35, s34, 20480
    buffer_load_dwordx4 v2, s[16:19], s35 offen lds
    s_add_u32 m0, s60, 2048
    s_add_u32 s35, s34, 40960
    buffer_load_dwordx4 v2, s[16:19], s35 offen lds
    s_add_u32 m0, s60, 3072
    s_add_u32 s35, s34, 61440
    buffer_load_dwordx4 v2, s[16:19], s35 offen lds
    s_add_u32 m0, s60, 4096
    s_add_u32 s35, s34, 81920
    buffer_load_dwordx4 v2, s[16:19], s35 offen lds
    s_add_u32 m0, s60, 5120
    s_add_u32 s35, s34, 102400
    buffer_load_dwordx4 v2, s[16:19], s35 offen lds
    s_add_u32 m0, s60, 6144
    s_add_u32 s35, s34, 122880
    buffer_load_dwordx4 v2, s[16:19], s35 offen lds
    s_add_u32 m0, s60, 7168
    s_add_u32 s35, s34, 143360
    buffer_load_dwordx4 v2, s[16:19], s35 offen lds
    s_add_u32 m0, s60, 8192
    s_add_u32 s35, s34, 163840
    buffer_load_dwordx4 v2, s[16:19], s35 offen lds
    s_add_u32 m0, s60, 9216
    s_add_u32 s35, s34, 184320
    buffer_load_dwordx4 v2, s[16:19], s35 offen lds
    s_add_u32 m0, s60, 10240
    s_add_u32 s35, s34, 204800
    buffer_load_dwordx4 v2, s[16:19], s35 offen lds
    s_add_u32 m0, s60, 11264
    s_add_u32 s35, s34, 225280
    buffer_load_dwordx4 v2, s[16:19], s35 offen lds
    s_add_u32 m0, s60, 12288
    s_add_u32 s35, s34, 245760
    buffer_load_dwordx4 v2, s[16:19], s35 offen lds
    s_add_u32 m0, s60, 13312
    s_add_u32 s35, s34, 266240
    buffer_load_dwordx4 v2, s[16:19], s35 offen lds
    s_add_u32 m0, s60, 14336
    s_add_u32 s35, s34, 286720
    buffer_load_dwordx4 v2, s[16:19], s35 offen lds
    s_add_u32 m0, s60, 15360
    s_add_u32 s35, s34, 307200
    buffer_load_dwordx4 v2, s[16:19], s35 offen lds
    s_waitcnt vmcnt(0)
    ds_read_b64_tr_b16 v[96:97], v3 offset:0
    ds_read_b64_tr_b16 v[98:99], v3 offset:256
    ds_read_b64_tr_b16 v[100:101], v3 offset:8
    ds_read_b64_tr_b16 v[102:103], v3 offset:264
    ds_read_b64_tr_b16 v[104:105], v3 offset:2048
    ds_read_b64_tr_b16 v[106:107], v3 offset:2304
    ds_read_b64_tr_b16 v[108:109], v3 offset:2056
    ds_read_b64_tr_b16 v[110:111], v3 offset:2312
    ds_read_b64_tr_b16 v[112:113], v3 offset:4096
    ds_read_b64_tr_b16 v[114:115], v3 offset:4352
    ds_read_b64_tr_b16 v[116:117], v3 offset:4104
    ds_read_b64_tr_b16 v[118:119], v3 offset:4360
    ds_read_b64_tr_b16 v[120:121], v3 offset:6144
    ds_read_b64_tr_b16 v[122:123], v3 offset:6400
    ds_read_b64_tr_b16 v[124:125], v3 offset:6152
    ds_read_b64_tr_b16 v[126:127], v3 offset:6408
    ds_read_b64_tr_b16 v[128:129], v3 offset:8192
    ds_read_b64_tr_b16 v[130:131], v3 offset:8448
    ds_read_b64_tr_b16 v[132:133], v3 offset:8200
    ds_read_b64_tr_b16 v[134:135], v3 offset:8456
    ds_read_b64_tr_b16 v[136:137], v3 offset:10240
    ds_read_b64_tr_b16 v[138:139], v3 offset:10496
    ds_read_b64_tr_b16 v[140:141], v3 offset:10248
    ds_read_b64_tr_b16 v[142:143], v3 offset:10504
    ds_read_b64_tr_b16 v[144:145], v3 offset:12288
    ds_read_b64_tr_b16 v[146:147], v3 offset:12544
    ds_read_b64_tr_b16 v[148:149], v3 offset:12296
    ds_read_b64_tr_b16 v[150:151], v3 offset:12552
    ds_read_b64_tr_b16 v[152:153], v3 offset:14336
    ds_read_b64_tr_b16 v[154:155], v3 offset:14592
    ds_read_b64_tr_b16 v[156:157], v3 offset:14344
    ds_read_b64_tr_b16 v[158:159], v3 offset:14600
    s_waitcnt lgkmcnt(0)
    s_add_u32 m0, s60, 0
    s_add_u32 s35, s34, 327680
    buffer_load_dwordx4 v2, s[16:19], s35 offen lds
    s_add_u32 m0, s60, 1024
    s_add_u32 s35, s34, 348160
    buffer_load_dwordx4 v2, s[16:19], s35 offen lds
    s_add_u32 m0, s60, 2048
    s_add_u32 s35, s34, 368640
    buffer_load_dwordx4 v2, s[16:19], s35 offen lds
    s_add_u32 m0, s60, 3072
    s_add_u32 s35, s34, 389120
    buffer_load_dwordx4 v2, s[16:19], s35 offen lds
    s_add_u32 m0, s60, 4096
    s_add_u32 s35, s34, 409600
    buffer_load_dwordx4 v2, s[16:19], s35 offen lds
    s_add_u32 m0, s60, 5120
    s_add_u32 s35, s34, 430080
    buffer_load_dwordx4 v2, s[16:19], s35 offen lds
    s_add_u32 m0, s60, 6144
    s_add_u32 s35, s34, 450560
    buffer_load_dwordx4 v2, s[16:19], s35 offen lds
    s_add_u32 m0, s60, 7168
    s_add_u32 s35, s34, 471040
    buffer_load_dwordx4 v2, s[16:19], s35 offen lds
    s_add_u32 m0, s60, 8192
    s_add_u32 s35, s34, 491520
    buffer_load_dwordx4 v2, s[16:19], s35 offen lds
    s_add_u32 m0, s60, 9216
    s_add_u32 s35, s34, 512000
    buffer_load_dwordx4 v2, s[16:19], s35 offen lds
    s_add_u32 m0, s60, 10240
    s_add_u32 s35, s34, 532480
    buffer_load_dwordx4 v2, s[16:19], s35 offen lds
    s_add_u32 m0, s60, 11264
    s_add_u32 s35, s34, 552960
    buffer_load_dwordx4 v2, s[16:19], s35 offen lds
    s_add_u32 m0, s60, 12288
    s_add_u32 s35, s34, 573440
    buffer_load_dwordx4 v2, s[16:19], s35 offen lds
    s_add_u32 m0, s60, 13312
    s_add_u32 s35, s34, 593920
    buffer_load_dwordx4 v2, s[16:19], s35 offen lds
    s_add_u32 m0, s60, 14336
    s_add_u32 s35, s34, 614400
    buffer_load_dwordx4 v2, s[16:19], s35 offen lds
    s_add_u32 m0, s60, 15360
    s_add_u32 s35, s34, 634880
    buffer_load_dwordx4 v2, s[16:19], s35 offen lds
    s_waitcnt vmcnt(0)
    ds_read_b64_tr_b16 v[160:161], v3 offset:0
    ds_read_b64_tr_b16 v[162:163], v3 offset:256
    ds_read_b64_tr_b16 v[164:165], v3 offset:8
    ds_read_b64_tr_b16 v[166:167], v3 offset:264
    ds_read_b64_tr_b16 v[168:169], v3 offset:2048
    ds_read_b64_tr_b16 v[170:171], v3 offset:2304
    ds_read_b64_tr_b16 v[172:173], v3 offset:2056
    ds_read_b64_tr_b16 v[174:175], v3 offset:2312
    ds_read_b64_tr_b16 v[176:177], v3 offset:4096
    ds_read_b64_tr_b16 v[178:179], v3 offset:4352
    ds_read_b64_tr_b16 v[180:181], v3 offset:4104
    ds_read_b64_tr_b16 v[182:183], v3 offset:4360
    ds_read_b64_tr_b16 v[184:185], v3 offset:6144
    ds_read_b64_tr_b16 v[186:187], v3 offset:6400
    ds_read_b64_tr_b16 v[188:189], v3 offset:6152
    ds_read_b64_tr_b16 v[190:191], v3 offset:6408
    ds_read_b64_tr_b16 v[192:193], v3 offset:8192
    ds_read_b64_tr_b16 v[194:195], v3 offset:8448
    ds_read_b64_tr_b16 v[196:197], v3 offset:8200
    ds_read_b64_tr_b16 v[198:199], v3 offset:8456
    ds_read_b64_tr_b16 v[200:201], v3 offset:10240
    ds_read_b64_tr_b16 v[202:203], v3 offset:10496
    ds_read_b64_tr_b16 v[204:205], v3 offset:10248
    ds_read_b64_tr_b16 v[206:207], v3 offset:10504
    ds_read_b64_tr_b16 v[208:209], v3 offset:12288
    ds_read_b64_tr_b16 v[210:211], v3 offset:12544
    ds_read_b64_tr_b16 v[212:213], v3 offset:12296
    ds_read_b64_tr_b16 v[214:215], v3 offset:12552
    ds_read_b64_tr_b16 v[216:217], v3 offset:14336
    ds_read_b64_tr_b16 v[218:219], v3 offset:14592
    ds_read_b64_tr_b16 v[220:221], v3 offset:14344
    ds_read_b64_tr_b16 v[222:223], v3 offset:14600
    s_waitcnt lgkmcnt(0)
    s_add_u32 m0, s60, 0
    s_add_u32 s35, s34, 655360
    buffer_load_dwordx4 v2, s[16:19], s35 offen lds
    s_add_u32 m0, s60, 1024
    s_add_u32 s35, s34, 675840
    buffer_load_dwordx4 v2, s[16:19], s35 offen lds
    s_add_u32 m0, s60, 2048
    s_add_u32 s35, s34, 696320
    buffer_load_dwordx4 v2, s[16:19], s35 offen lds
    s_add_u32 m0, s60, 3072
    s_add_u32 s35, s34, 716800
    buffer_load_dwordx4 v2, s[16:19], s35 offen lds
    s_add_u32 m0, s60, 4096
    s_add_u32 s35, s34, 737280
    buffer_load_dwordx4 v2, s[16:19], s35 offen lds
    s_add_u32 m0, s60, 5120
    s_add_u32 s35, s34, 757760
    buffer_load_dwordx4 v2, s[16:19], s35 offen lds
    s_add_u32 m0, s60, 6144
    s_add_u32 s35, s34, 778240
    buffer_load_dwordx4 v2, s[16:19], s35 offen lds
    s_add_u32 m0, s60, 7168
    s_add_u32 s35, s34, 798720
    buffer_load_dwordx4 v2, s[16:19], s35 offen lds
    s_add_u32 m0, s60, 8192
    s_add_u32 s35, s34, 819200
    buffer_load_dwordx4 v2, s[16:19], s35 offen lds
    s_add_u32 m0, s60, 9216
    s_add_u32 s35, s34, 839680
    buffer_load_dwordx4 v2, s[16:19], s35 offen lds
    s_add_u32 m0, s60, 10240
    s_add_u32 s35, s34, 860160
    buffer_load_dwordx4 v2, s[16:19], s35 offen lds
    s_add_u32 m0, s60, 11264
    s_add_u32 s35, s34, 880640
    buffer_load_dwordx4 v2, s[16:19], s35 offen lds
    s_add_u32 m0, s60, 12288
    s_add_u32 s35, s34, 901120
    buffer_load_dwordx4 v2, s[16:19], s35 offen lds
    s_add_u32 m0, s60, 13312
    s_add_u32 s35, s34, 921600
    buffer_load_dwordx4 v2, s[16:19], s35 offen lds
    s_add_u32 m0, s60, 14336
    s_add_u32 s35, s34, 942080
    buffer_load_dwordx4 v2, s[16:19], s35 offen lds
    s_add_u32 m0, s60, 15360
    s_add_u32 s35, s34, 962560
    buffer_load_dwordx4 v2, s[16:19], s35 offen lds
    s_waitcnt vmcnt(0)
    ds_read_b64_tr_b16 v[224:225], v3 offset:0
    ds_read_b64_tr_b16 v[226:227], v3 offset:256
    ds_read_b64_tr_b16 v[228:229], v3 offset:8
    ds_read_b64_tr_b16 v[230:231], v3 offset:264
    ds_read_b64_tr_b16 v[232:233], v3 offset:2048
    ds_read_b64_tr_b16 v[234:235], v3 offset:2304
    ds_read_b64_tr_b16 v[236:237], v3 offset:2056
    ds_read_b64_tr_b16 v[238:239], v3 offset:2312
    ds_read_b64_tr_b16 v[240:241], v3 offset:4096
    ds_read_b64_tr_b16 v[242:243], v3 offset:4352
    ds_read_b64_tr_b16 v[244:245], v3 offset:4104
    ds_read_b64_tr_b16 v[246:247], v3 offset:4360
    ds_read_b64_tr_b16 v[248:249], v3 offset:6144
    ds_read_b64_tr_b16 v[250:251], v3 offset:6400
    ds_read_b64_tr_b16 v[252:253], v3 offset:6152
    ds_read_b64_tr_b16 v[254:255], v3 offset:6408
    ds_read_b64_tr_b16 a[160:161], v3 offset:8192
    ds_read_b64_tr_b16 a[162:163], v3 offset:8448
    ds_read_b64_tr_b16 a[164:165], v3 offset:8200
    ds_read_b64_tr_b16 a[166:167], v3 offset:8456
    ds_read_b64_tr_b16 a[168:169], v3 offset:10240
    ds_read_b64_tr_b16 a[170:171], v3 offset:10496
    ds_read_b64_tr_b16 a[172:173], v3 offset:10248
    ds_read_b64_tr_b16 a[174:175], v3 offset:10504
    ds_read_b64_tr_b16 a[176:177], v3 offset:12288
    ds_read_b64_tr_b16 a[178:179], v3 offset:12544
    ds_read_b64_tr_b16 a[180:181], v3 offset:12296
    ds_read_b64_tr_b16 a[182:183], v3 offset:12552
    ds_read_b64_tr_b16 a[184:185], v3 offset:14336
    ds_read_b64_tr_b16 a[186:187], v3 offset:14592
    ds_read_b64_tr_b16 a[188:189], v3 offset:14344
    ds_read_b64_tr_b16 a[190:191], v3 offset:14600
    s_waitcnt lgkmcnt(0)
    s_add_u32 m0, s60, 0
    s_add_u32 s35, s34, 983040
    buffer_load_dwordx4 v2, s[16:19], s35 offen lds
    s_add_u32 m0, s60, 1024
    s_add_u32 s35, s34, 1003520
    buffer_load_dwordx4 v2, s[16:19], s35 offen lds
    s_add_u32 m0, s60, 2048
    s_add_u32 s35, s34, 1024000
    buffer_load_dwordx4 v2, s[16:19], s35 offen lds
    s_add_u32 m0, s60, 3072
    s_add_u32 s35, s34, 1044480
    buffer_load_dwordx4 v2, s[16:19], s35 offen lds
    s_add_u32 m0, s60, 4096
    s_add_u32 s35, s34, 1064960
    buffer_load_dwordx4 v2, s[16:19], s35 offen lds
    s_add_u32 m0, s60, 5120
    s_add_u32 s35, s34, 1085440
    buffer_load_dwordx4 v2, s[16:19], s35 offen lds
    s_add_u32 m0, s60, 6144
    s_add_u32 s35, s34, 1105920
    buffer_load_dwordx4 v2, s[16:19], s35 offen lds
    s_add_u32 m0, s60, 7168
    s_add_u32 s35, s34, 1126400
    buffer_load_dwordx4 v2, s[16:19], s35 offen lds
    s_add_u32 m0, s60, 8192
    s_add_u32 s35, s34, 1146880
    buffer_load_dwordx4 v2, s[16:19], s35 offen lds
    s_add_u32 m0, s60, 9216
    s_add_u32 s35, s34, 1167360
    buffer_load_dwordx4 v2, s[16:19], s35 offen lds
    s_add_u32 m0, s60, 10240
    s_add_u32 s35, s34, 1187840
    buffer_load_dwordx4 v2, s[16:19], s35 offen lds
    s_add_u32 m0, s60, 11264
    s_add_u32 s35, s34, 1208320
    buffer_load_dwordx4 v2, s[16:19], s35 offen lds
    s_add_u32 m0, s60, 12288
    s_add_u32 s35, s34, 1228800
    buffer_load_dwordx4 v2, s[16:19], s35 offen lds
    s_add_u32 m0, s60, 13312
    s_add_u32 s35, s34, 1249280
    buffer_load_dwordx4 v2, s[16:19], s35 offen lds
    s_add_u32 m0, s60, 14336
    s_add_u32 s35, s34, 1269760
    buffer_load_dwordx4 v2, s[16:19], s35 offen lds
    s_add_u32 m0, s60, 15360
    s_add_u32 s35, s34, 1290240
    buffer_load_dwordx4 v2, s[16:19], s35 offen lds
    s_waitcnt vmcnt(0)
    ds_read_b64_tr_b16 a[192:193], v3 offset:0
    ds_read_b64_tr_b16 a[194:195], v3 offset:256
    ds_read_b64_tr_b16 a[196:197], v3 offset:8
    ds_read_b64_tr_b16 a[198:199], v3 offset:264
    ds_read_b64_tr_b16 a[200:201], v3 offset:2048
    ds_read_b64_tr_b16 a[202:203], v3 offset:2304
    ds_read_b64_tr_b16 a[204:205], v3 offset:2056
    ds_read_b64_tr_b16 a[206:207], v3 offset:2312
    ds_read_b64_tr_b16 a[208:209], v3 offset:4096
    ds_read_b64_tr_b16 a[210:211], v3 offset:4352
    ds_read_b64_tr_b16 a[212:213], v3 offset:4104
    ds_read_b64_tr_b16 a[214:215], v3 offset:4360
    ds_read_b64_tr_b16 a[216:217], v3 offset:6144
    ds_read_b64_tr_b16 a[218:219], v3 offset:6400
    ds_read_b64_tr_b16 a[220:221], v3 offset:6152
    ds_read_b64_tr_b16 a[222:223], v3 offset:6408
    ds_read_b64_tr_b16 a[224:225], v3 offset:8192
    ds_read_b64_tr_b16 a[226:227], v3 offset:8448
    ds_read_b64_tr_b16 a[228:229], v3 offset:8200
    ds_read_b64_tr_b16 a[230:231], v3 offset:8456
    ds_read_b64_tr_b16 a[232:233], v3 offset:10240
    ds_read_b64_tr_b16 a[234:235], v3 offset:10496
    ds_read_b64_tr_b16 a[236:237], v3 offset:10248
    ds_read_b64_tr_b16 a[238:239], v3 offset:10504
    ds_read_b64_tr_b16 a[240:241], v3 offset:12288
    ds_read_b64_tr_b16 a[242:243], v3 offset:12544
    ds_read_b64_tr_b16 a[244:245], v3 offset:12296
    ds_read_b64_tr_b16 a[246:247], v3 offset:12552
    ds_read_b64_tr_b16 a[248:249], v3 offset:14336
    ds_read_b64_tr_b16 a[250:251], v3 offset:14592
    ds_read_b64_tr_b16 a[252:253], v3 offset:14344
    ds_read_b64_tr_b16 a[254:255], v3 offset:14600
    s_waitcnt lgkmcnt(0)
    v_bfe_u32 v4, v1, 4, 2
    v_mul_u32_u24 v4, 512, v4
    v_bfe_u32 v8, v1, 0, 4
    v_lshl_add_u32 v4, v8, 4, v4
    v_bfe_u32 v5, v1, 0, 2
    v_mul_u32_u24 v5, 1280, v5
    v_bfe_u32 v8, v1, 2, 1
    v_mul_u32_u24 v8, 10240, v8
    v_add_u32 v5, v5, v8
    v_bfe_u32 v8, v1, 3, 1
    v_mul_u32_u24 v8, 5120, v8
    v_add_u32 v5, v5, v8
    v_bfe_u32 v8, v1, 4, 2
    v_lshl_add_u32 v5, v8, 4, v5
    s_lshl_b32 s34, s29, 7
    s_add_u32 s34, s34, 23040
    v_bfe_u32 v6, v1, 0, 3
    v_mul_u32_u24 v6, 16, v6
    v_add_u32 v6, s34, v6
    s_lshl_b32 s34, s29, 11
    v_add_u32 v7, s34, v0
    s_mov_b32 s44, s68
    s_mov_b32 s49, 1
    s_mov_b32 s56, 0
    s_waitcnt vmcnt(0) lgkmcnt(0)
G4_188:
    s_lshr_b32 s40, s44, 1
    s_and_b32 s41, s44, 1
    s_mul_i32 s42, s40, 40960
    s_lshl_b32 s34, s69, 11
    s_add_u32 s43, s42, s34
    s_lshl_b32 s34, s41, 8
    s_add_u32 s43, s43, s34
    s_mul_i32 s34, s30, 6291456
    s_add_u32 s34, s34, 11534336
    s_add_u32 s34, s34, s43
    buffer_load_dwordx4 v[24:27], v4, s[4:7], s34 offen sc1
    s_lshr_b32 s57, s40, 2
    s_add_u32 s57, s57, s61
    s_add_u32 s57, s57, 1
    s_and_b32 s34, s40, 3
    s_lshl_b32 s34, s34, 2
    s_mov_b32 s48, 0
P_192:
    buffer_load_dword v8, v6, s[4:7], s34 offen sc1
    s_waitcnt vmcnt(0)
    v_cmp_gt_u32 vcc, s57, v8
    s_cbranch_vccz P_193
    s_add_u32 s48, s48, 1
    s_cmp_gt_u32 s48, 200000
    s_cbranch_scc1 L_end
    s_sleep 1
    s_branch P_192
P_193:
    s_mul_i32 s54, s30, 16777216
    s_add_u32 s54, s54, 67108864
    s_lshl_b32 s34, s44, 17
    s_add_u32 s54, s54, s34
    s_lshl_b32 s34, s29, 15
    s_add_u32 s54, s54, s34
    buffer_load_dwordx4 v[32:35], v0, s[4:7], s54 offen offset:0 sc1
    buffer_load_dwordx4 v[36:39], v0, s[4:7], s54 offen offset:1024 sc1
    buffer_load_dwordx4 v[40:43], v0, s[4:7], s54 offen offset:2048 sc1
    buffer_load_dwordx4 v[44:47], v0, s[4:7], s54 offen offset:3072 sc1
    s_add_u32 s54, s54, 4096
    buffer_load_dwordx4 v[48:51], v0, s[4:7], s54 offen offset:0 sc1
    buffer_load_dwordx4 v[52:55], v0, s[4:7], s54 offen offset:1024 sc1
    buffer_load_dwordx4 v[56:59], v0, s[4:7], s54 offen offset:2048 sc1
    buffer_load_dwordx4 v[60:63], v0, s[4:7], s54 offen offset:3072 sc1
    s_add_u32 s54, s54, 4096
    buffer_load_dwordx4 v[64:67], v0, s[4:7], s54 offen offset:0 sc1
    buffer_load_dwordx4 v[68:71], v0, s[4:7], s54 offen offset:1024 sc1
    buffer_load_dwordx4 v[72:75], v0, s[4:7], s54 offen offset:2048 sc1
    buffer_load_dwordx4 v[76:79], v0, s[4:7], s54 offen offset:3072 sc1
    s_add_u32 s54, s54, 4096
    buffer_load_dwordx4 v[80:83], v0, s[4:7], s54 offen offset:0 sc1
    buffer_load_dwordx4 v[84:87], v0, s[4:7], s54 offen offset:1024 sc1
    buffer_load_dwordx4 v[88:91], v0, s[4:7], s54 offen offset:2048 sc1
    buffer_load_dwordx4 v[92:95], v0, s[4:7], s54 offen offset:3072 sc1
    s_waitcnt vmcnt(15)
    v_mfma_f32_16x16x32_bf16 v[16:19], v[96:99], v[32:35], 0
    v_mfma_f32_16x16x32_bf16 v[20:23], v[100:103], v[32:35], 0
    s_add_u32 s54, s54, 4096
    buffer_load_dwordx4 v[32:35], v0, s[4:7], s54 offen offset:0 sc1
    s_waitcnt vmcnt(15)
    v_mfma_f32_16x16x32_bf16 v[16:19], v[104:107], v[36:39], v[16:19]
    v_mfma_f32_16x16x32_bf16 v[20:23], v[108:111], v[36:39], v[20:23]
    buffer_load_dwordx4 v[36:39], v0, s[4:7], s54 offen offset:1024 sc1
    s_waitcnt vmcnt(15)
    v_mfma_f32_16x16x32_bf16 v[16:19], v[112:115], v[40:43], v[16:19]
    v_mfma_f32_16x16x32_bf16 v[20:23], v[116:119], v[40:43], v[20:23]
    buffer_load_dwordx4 v[40:43], v0, s[4:7], s54 offen offset:2048 sc1
    s_waitcnt vmcnt(15)
    v_mfma_f32_16x16x32_bf16 v[16:19], v[120:123], v[44:47], v[16:19]
    v_mfma_f32_16x16x32_bf16 v[20:23], v[124:127], v[44:47], v[20:23]
    buffer_load_dwordx4 v[44:47], v0, s[4:7], s54 offen offset:3072 sc1
    s_waitcnt vmcnt(15)
    v_mfma_f32_16x16x32_bf16 v[16:19], v[128:131], v[48:51], v[16:19]
    v_mfma_f32_16x16x32_bf16 v[20:23], v[132:135], v[48:51], v[20:23]
    s_add_u32 s54, s54, 4096
    buffer_load_dwordx4 v[48:51], v0, s[4:7], s54 offen offset:0 sc1
    s_waitcnt vmcnt(15)
    v_mfma_f32_16x16x32_bf16 v[16:19], v[136:139], v[52:55], v[16:19]
    v_mfma_f32_16x16x32_bf16 v[20:23], v[140:143], v[52:55], v[20:23]
    buffer_load_dwordx4 v[52:55], v0, s[4:7], s54 offen offset:1024 sc1
    s_waitcnt vmcnt(15)
    v_mfma_f32_16x16x32_bf16 v[16:19], v[144:147], v[56:59], v[16:19]
    v_mfma_f32_16x16x32_bf16 v[20:23], v[148:151], v[56:59], v[20:23]
    buffer_load_dwordx4 v[56:59], v0, s[4:7], s54 offen offset:2048 sc1
    s_waitcnt vmcnt(15)
    v_mfma_f32_16x16x32_bf16 v[16:19], v[152:155], v[60:63], v[16:19]
    v_mfma_f32_16x16x32_bf16 v[20:23], v[156:159], v[60:63], v[20:23]
    buffer_load_dwordx4 v[60:63], v0, s[4:7], s54 offen offset:3072 sc1
    s_waitcnt vmcnt(15)
    v_mfma_f32_16x16x32_bf16 v[16:19], v[160:163], v[64:67], v[16:19]
    v_mfma_f32_16x16x32_bf16 v[20:23], v[164:167], v[64:67], v[20:23]
    s_add_u32 s54, s54, 4096
    buffer_load_dwordx4 v[64:67], v0, s[4:7], s54 offen offset:0 sc1
    s_waitcnt vmcnt(15)
    v_mfma_f32_16x16x32_bf16 v[16:19], v[168:171], v[68:71], v[16:19]
    v_mfma_f32_16x16x32_bf16 v[20:23], v[172:175], v[68:71], v[20:23]
    buffer_load_dwordx4 v[68:71], v0, s[4:7], s54 offen offset:1024 sc1
    s_waitcnt vmcnt(15)
    v_mfma_f32_16x16x32_bf16 v[16:19], v[176:179], v[72:75], v[16:19]
    v_mfma_f32_16x16x32_bf16 v[20:23], v[180:183], v[72:75], v[20:23]
    buffer_load_dwordx4 v[72:75], v0, s[4:7], s54 offen offset:2048 sc1
    s_waitcnt vmcnt(15)
    v_mfma_f32_16x16x32_bf16 v[16:19], v[184:187], v[76:79], v[16:19]
    v_mfma_f32_16x16x32_bf16 v[20:23], v[188:191], v[76:79], v[20:23]
    buffer_load_dwordx4 v[76:79], v0, s[4:7], s54 offen offset:3072 sc1
    s_waitcnt vmcnt(15)
    v_mfma_f32_16x16x32_bf16 v[16:19], v[192:195], v[80:83], v[16:19]
    v_mfma_f32_16x16x32_bf16 v[20:23], v[196:199], v[80:83], v[20:23]
    s_add_u32 s54, s54, 4096
    buffer_load_dwordx4 v[80:83], v0, s[4:7], s54 offen offset:0 sc1
    s_waitcnt vmcnt(15)
    v_mfma_f32_16x16x32_bf16 v[16:19], v[200:203], v[84:87], v[16:19]
    v_mfma_f32_16x16x32_bf16 v[20:23], v[204:207], v[84:87], v[20:23]
    buffer_load_dwordx4 v[84:87], v0, s[4:7], s54 offen offset:1024 sc1
    s_waitcnt vmcnt(15)
    v_mfma_f32_16x16x32_bf16 v[16:19], v[208:211], v[88:91], v[16:19]
    v_mfma_f32_16x16x32_bf16 v[20:23], v[212:215], v[88:91], v[20:23]
    buffer_load_dwordx4 v[88:91], v0, s[4:7], s54 offen offset:2048 sc1
    s_waitcnt vmcnt(15)
    v_mfma_f32_16x16x32_bf16 v[16:19], v[216:219], v[92:95], v[16:19]
    v_mfma_f32_16x16x32_bf16 v[20:23], v[220:223], v[92:95], v[20:23]
    buffer_load_dwordx4 v[92:95], v0, s[4:7], s54 offen offset:3072 sc1
    s_waitcnt vmcnt(15)
    v_mfma_f32_16x16x32_bf16 v[16:19], v[224:227], v[32:35], v[16:19]
    v_mfma_f32_16x16x32_bf16 v[20:23], v[228:231], v[32:35], v[20:23]
    s_waitcnt vmcnt(14)
    v_mfma_f32_16x16x32_bf16 v[16:19], v[232:235], v[36:39], v[16:19]
    v_mfma_f32_16x16x32_bf16 v[20:23], v[236:239], v[36:39], v[20:23]
    s_waitcnt vmcnt(13)
    v_mfma_f32_16x16x32_bf16 v[16:19], v[240:243], v[40:43], v[16:19]
    v_mfma_f32_16x16x32_bf16 v[20:23], v[244:247], v[40:43], v[20:23]
    s_waitcnt vmcnt(12)
    v_mfma_f32_16x16x32_bf16 v[16:19], v[248:251], v[44:47], v[16:19]
    v_mfma_f32_16x16x32_bf16 v[20:23], v[252:255], v[44:47], v[20:23]
    s_waitcnt vmcnt(11)
    v_mfma_f32_16x16x32_bf16 v[16:19], a[160:163], v[48:51], v[16:19]
    v_mfma_f32_16x16x32_bf16 v[20:23], a[164:167], v[48:51], v[20:23]
    s_waitcnt vmcnt(10)
    v_mfma_f32_16x16x32_bf16 v[16:19], a[168:171], v[52:55], v[16:19]
    v_mfma_f32_16x16x32_bf16 v[20:23], a[172:175], v[52:55], v[20:23]
    s_waitcnt vmcnt(9)
    v_mfma_f32_16x16x32_bf16 v[16:19], a[176:179], v[56:59], v[16:19]
    v_mfma_f32_16x16x32_bf16 v[20:23], a[180:183], v[56:59], v[20:23]
    s_waitcnt vmcnt(8)
    v_mfma_f32_16x16x32_bf16 v[16:19], a[184:187], v[60:63], v[16:19]
    v_mfma_f32_16x16x32_bf16 v[20:23], a[188:191], v[60:63], v[20:23]
    s_waitcnt vmcnt(7)
    v_mfma_f32_16x16x32_bf16 v[16:19], a[192:195], v[64:67], v[16:19]
    v_mfma_f32_16x16x32_bf16 v[20:23], a[196:199], v[64:67], v[20:23]
    s_waitcnt vmcnt(6)
    v_mfma_f32_16x16x32_bf16 v[16:19], a[200:203], v[68:71], v[16:19]
    v_mfma_f32_16x16x32_bf16 v[20:23], a[204:207], v[68:71], v[20:23]
    s_waitcnt vmcnt(5)
    v_mfma_f32_16x16x32_bf16 v[16:19], a[208:211], v[72:75], v[16:19]
    v_mfma_f32_16x16x32_bf16 v[20:23], a[212:215], v[72:75], v[20:23]
    s_waitcnt vmcnt(4)
    v_mfma_f32_16x16x32_bf16 v[16:19], a[216:219], v[76:79], v[16:19]
    v_mfma_f32_16x16x32_bf16 v[20:23], a[220:223], v[76:79], v[20:23]
    s_waitcnt vmcnt(3)
    v_mfma_f32_16x16x32_bf16 v[16:19], a[224:227], v[80:83], v[16:19]
    v_mfma_f32_16x16x32_bf16 v[20:23], a[228:231], v[80:83], v[20:23]
    s_waitcnt vmcnt(2)
    v_mfma_f32_16x16x32_bf16 v[16:19], a[232:235], v[84:87], v[16:19]
    v_mfma_f32_16x16x32_bf16 v[20:23], a[236:239], v[84:87], v[20:23]
    s_waitcnt vmcnt(1)
    v_mfma_f32_16x16x32_bf16 v[16:19], a[240:243], v[88:91], v[16:19]
    v_mfma_f32_16x16x32_bf16 v[20:23], a[244:247], v[88:91], v[20:23]
    s_waitcnt vmcnt(0)
    v_mfma_f32_16x16x32_bf16 v[16:19], a[248:251], v[92:95], v[16:19]
    v_mfma_f32_16x16x32_bf16 v[20:23], a[252:255], v[92:95], v[20:23]
    v_add_u32 v8, s56, v7
    s_nop 2
    ds_write_b128 v8, v[16:19]
    s_nop 2
    ds_write_b128 v8, v[20:23] offset:1024
    s_waitcnt lgkmcnt(0)
    s_barrier
    s_cmp_lg_u32 s29, 0
    s_cbranch_scc1 G4_189
    ds_read_b128 v[32:35], v8 offset:2048
    ds_read_b128 v[36:39], v8 offset:3072
    ds_read_b128 v[40:43], v8 offset:4096
    ds_read_b128 v[44:47], v8 offset:5120
    ds_read_b128 v[48:51], v8 offset:6144
    ds_read_b128 v[52:55], v8 offset:7168
    s_waitcnt lgkmcnt(5)
    v_pk_add_f32 v[16:17], v[16:17], v[32:33]
    v_pk_add_f32 v[18:19], v[18:19], v[34:35]
    s_waitcnt lgkmcnt(4)
    v_pk_add_f32 v[20:21], v[20:21], v[36:37]
    v_pk_add_f32 v[22:23], v[22:23], v[38:39]
    s_waitcnt lgkmcnt(3)
    v_pk_add_f32 v[16:17], v[16:17], v[40:41]
    v_pk_add_f32 v[18:19], v[18:19], v[42:43]
    s_waitcnt lgkmcnt(2)
    v_pk_add_f32 v[20:21], v[20:21], v[44:45]
    v_pk_add_f32 v[22:23], v[22:23], v[46:47]
    s_waitcnt lgkmcnt(1)
    v_pk_add_f32 v[16:17], v[16:17], v[48:49]
    v_pk_add_f32 v[18:19], v[18:19], v[50:51]
    s_waitcnt lgkmcnt(0)
    v_pk_add_f32 v[20:21], v[20:21], v[52:53]
    v_pk_add_f32 v[22:23], v[22:23], v[54:55]
    v_cvt_pk_bf16_f32 v56, v16, v17
    v_cvt_pk_bf16_f32 v57, v18, v19
    v_cvt_pk_bf16_f32 v58, v20, v21
    v_cvt_pk_bf16_f32 v59, v22, v23
    v_lshlrev_b32 v32, 16, v56
    v_lshlrev_b32 v33, 16, v24
    v_and_b32 v34, 0xffff0000, v56
    v_and_b32 v35, 0xffff0000, v24
    v_add_f32 v32, v32, v33
    v_add_f32 v34, v34, v35
    v_cvt_pk_bf16_f32 v56, v32, v34
    v_lshlrev_b32 v32, 16, v57
    v_lshlrev_b32 v33, 16, v25
    v_and_b32 v34, 0xffff0000, v57
    v_and_b32 v35, 0xffff0000, v25
    v_add_f32 v32, v32, v33
    v_add_f32 v34, v34, v35
    v_cvt_pk_bf16_f32 v57, v32, v34
    v_lshlrev_b32 v32, 16, v58
    v_lshlrev_b32 v33, 16, v26
    v_and_b32 v34, 0xffff0000, v58
    v_and_b32 v35, 0xffff0000, v26
    v_add_f32 v32, v32, v33
    v_add_f32 v34, v34, v35
    v_cvt_pk_bf16_f32 v58, v32, v34
    v_lshlrev_b32 v32, 16, v59
    v_lshlrev_b32 v33, 16, v27
    v_and_b32 v34, 0xffff0000, v59
    v_and_b32 v35, 0xffff0000, v27
    v_add_f32 v32, v32, v33
    v_add_f32 v34, v34, v35
    v_cvt_pk_bf16_f32 v59, v32, v34
    s_cmp_lg_u32 s30, 0
    s_cbranch_scc1 G4_190
    s_add_u32 s34, s43, 14680064
    buffer_store_dwordx4 v[56:59], v4, s[4:7], s34 offen sc1
    s_waitcnt vmcnt(0)
    s_cmp_lg_u32 s29, 0
    s_cbranch_scc1 F_194
    s_lshl_b32 s32, s28, 2
    s_add_u32 s32, s32, s29
    s_lshl_b32 s32, s32, 2
    s_add_u32 s32, s32, 24576
    v_mov_b32 v8, s49
    s_mov_b64 exec, 1
    buffer_store_dword v8, off, s[4:7], s32 sc1
    s_mov_b64 exec, -1
F_194:
    s_branch G4_189
G4_190:
    s_mul_i32 s34, s41, 20480
    s_add_u32 s34, s34, s42
    s_lshl_b32 s35, s69, 6
    s_add_u32 s34, s34, s35
    buffer_store_dwordx4 v[56:59], v5, s[12:15], s34 offen
G4_189:
    s_xor_b32 s56, s56, 8192
    s_add_u32 s49, s49, 1
    s_add_u32 s44, s44, 7
    s_cmp_lt_u32 s44, 128
    s_cbranch_scc1 G4_188
    s_waitcnt vmcnt(0)
    s_barrier
R_187:
    s_cmp_lg_u32 s30, 0
    s_cbranch_scc1 L_end
    s_cmp_lt_u32 s28, 140
    s_cbranch_scc1 R_195
    s_cmp_ge_u32 s28, 160
    s_cbranch_scc1 R_195
    s_lshl_b32 s34, s29, 13
    v_add_u32 v4, s34, v0
    s_lshl_b32 s34, s29, 3
    s_add_u32 s34, s34, 65536
    v_bfe_u32 v5, v1, 0, 5
    v_mul_u32_u24 v5, 32, v5
    v_add_u32 v5, s34, v5
    s_lshl_b32 s35, s29, 11
    s_lshl_b32 s36, s29, 8
    s_add_u32 s36, s36, 67584
    s_lshr_b32 s34, s29, 1
    s_lshl_b32 s34, s34, 12
    s_and_b32 s37, s29, 1
    s_lshl_b32 s37, s37, 8
    s_add_u32 s34, s34, s37
    v_bfe_u32 v3, v1, 1, 1
    v_mul_u32_u24 v3, 2048, v3
    v_bfe_u32 v172, v1, 0, 1
    v_lshl_add_u32 v3, v172, 9, v3
    v_bfe_u32 v172, v1, 2, 4
    v_lshl_add_u32 v3, v172, 4, v3
    v_add_u32 v3, s34, v3
    v_bfe_u32 v10, v1, 0, 2
    v_mul_u32_u24 v10, 32, v10
    v_add_u32 v10, s36, v10
    s_lshl_b32 s34, s29, 10
    v_add_u32 v7, s34, v0
    v_bfe_u32 v6, v1, 0, 5
    v_mul_u32_u24 v6, 32, v6
    v_add_u32 v6, 65536, v6
    v_bfe_u32 v9, v1, 0, 2
    v_mul_u32_u24 v9, 4, v9
    v_bfe_u32 v172, v1, 2, 1
    v_lshl_add_u32 v9, v172, 5, v9
    v_bfe_u32 v172, v1, 3, 1
    v_lshl_add_u32 v9, v172, 4, v9
    v_bfe_u32 v172, v1, 4, 1
    v_lshl_add_u32 v9, v172, 6, v9
    v_add_u32 v9, s36, v9
    s_mov_b32 s34, 0x3f803f80
    v_mov_b32 v56, s34
    v_mov_b32 v57, s34
    v_mov_b32 v58, s34
    v_mov_b32 v59, s34
    s_nop 1
    v_mfma_f32_32x32x16_bf16 v[96:111], v[56:59], a[160:163], 0
    v_mfma_f32_32x32x16_bf16 v[112:127], v[56:59], a[200:203], 0
    v_mfma_f32_32x32x16_bf16 v[96:111], v[56:59], a[164:167], v[96:111]
    v_mfma_f32_32x32x16_bf16 v[112:127], v[56:59], a[204:207], v[112:127]
    v_mfma_f32_32x32x16_bf16 v[96:111], v[56:59], a[168:171], v[96:111]
    v_mfma_f32_32x32x16_bf16 v[112:127], v[56:59], a[208:211], v[112:127]
    v_mfma_f32_32x32x16_bf16 v[96:111], v[56:59], a[172:175], v[96:111]
    v_mfma_f32_32x32x16_bf16 v[112:127], v[56:59], a[212:215], v[112:127]
    v_mfma_f32_32x32x16_bf16 v[96:111], v[56:59], a[176:179], v[96:111]
    v_mfma_f32_32x32x16_bf16 v[112:127], v[56:59], a[216:219], v[112:127]
    v_mfma_f32_32x32x16_bf16 v[96:111], v[56:59], a[180:183], v[96:111]
    v_mfma_f32_32x32x16_bf16 v[112:127], v[56:59], a[220:223], v[112:127]
    v_mfma_f32_32x32x16_bf16 v[96:111], v[56:59], a[184:187], v[96:111]
    v_mfma_f32_32x32x16_bf16 v[112:127], v[56:59], a[224:227], v[112:127]
    v_mfma_f32_32x32x16_bf16 v[96:111], v[56:59], a[188:191], v[96:111]
    v_mfma_f32_32x32x16_bf16 v[112:127], v[56:59], a[228:231], v[112:127]
    v_mfma_f32_32x32x16_bf16 v[96:111], v[56:59], a[192:195], v[96:111]
    v_mfma_f32_32x32x16_bf16 v[112:127], v[56:59], a[232:235], v[112:127]
    v_mfma_f32_32x32x16_bf16 v[96:111], v[56:59], a[196:199], v[96:111]
    v_mfma_f32_32x32x16_bf16 v[112:127], v[56:59], a[236:239], v[112:127]
    s_nop 3
    ds_write_b128 v4, v[96:99] offset:32768
    ds_write_b128 v4, v[100:103] offset:33792
    ds_write_b128 v4, v[104:107] offset:34816
    ds_write_b128 v4, v[108:111] offset:35840
    s_nop 3
    ds_write_b128 v4, v[112:115] offset:36864
    ds_write_b128 v4, v[116:119] offset:37888
    ds_write_b128 v4, v[120:123] offset:38912
    ds_write_b128 v4, v[124:127] offset:39936
    s_waitcnt lgkmcnt(0)
    s_barrier
    ds_read_b128 v[96:99], v3 offset:32768
    ds_read_b128 v[100:103], v3 offset:33792
    ds_read_b128 v[104:107], v3 offset:40960
    ds_read_b128 v[108:111], v3 offset:41984
    ds_read_b128 v[112:115], v3 offset:49152
    ds_read_b128 v[116:119], v3 offset:50176
    ds_read_b128 v[120:123], v3 offset:57344
    ds_read_b128 v[124:127], v3 offset:58368
    s_waitcnt lgkmcnt(5)
    v_pk_add_f32 v[96:97], v[96:97], v[104:105]
    v_pk_add_f32 v[98:99], v[98:99], v[106:107]
    s_waitcnt lgkmcnt(4)
    v_pk_add_f32 v[100:101], v[100:101], v[108:109]
    v_pk_add_f32 v[102:103], v[102:103], v[110:111]
    s_waitcnt lgkmcnt(3)
    v_pk_add_f32 v[96:97], v[96:97], v[112:113]
    v_pk_add_f32 v[98:99], v[98:99], v[114:115]
    s_waitcnt lgkmcnt(2)
    v_pk_add_f32 v[100:101], v[100:101], v[116:117]
    v_pk_add_f32 v[102:103], v[102:103], v[118:119]
    s_waitcnt lgkmcnt(1)
    v_pk_add_f32 v[96:97], v[96:97], v[120:121]
    v_pk_add_f32 v[98:99], v[98:99], v[122:123]
    s_waitcnt lgkmcnt(0)
    v_pk_add_f32 v[100:101], v[100:101], v[124:125]
    v_pk_add_f32 v[102:103], v[102:103], v[126:127]
    v_mov_b64 v[154:155], v[96:97]
    v_mov_b64 v[156:157], v[98:99]
    v_mov_b64 v[158:159], v[100:101]
    v_mov_b64 v[160:161], v[102:103]
    s_barrier
    s_sub_u32 s44, s66, 14
    s_mov_b32 s47, 2
    s_mul_i32 s50, s29, 10240
    s_add_u32 s50, s50, 14680064
    s_mov_b32 s52, 0
    s_lshl_b32 s51, s67, 12
    s_add_u32 s51, s51, 24117248
    s_mov_b32 s58, 40960
    s_waitcnt vmcnt(0) lgkmcnt(0)
G_196:
    s_lshl_b32 s37, s44, 1
    s_add_u32 s37, s37, 0
    s_mul_i32 s38, s37, 9363
    s_lshr_b32 s38, s38, 16
    s_mul_i32 s39, s38, 7
    s_sub_u32 s39, s37, s39
    s_add_u32 s57, s38, 1
    s_mul_i32 s39, s39, 20
    v_add_u32 v176, 0, v1
    v_min_u32 v176, 19, v176
    v_lshlrev_b32 v176, 4, v176
    s_lshl_b32 s32, s39, 4
    s_add_u32 s32, s32, 24576
    s_mov_b32 s48, 0
P_198:
    buffer_load_dword v172, v176, s[4:7], s32 offen sc1
    s_waitcnt vmcnt(0)
    v_cmp_gt_u32 vcc, s57, v172
    s_cbranch_vccz P_199
    s_add_u32 s48, s48, 1
    s_cmp_gt_u32 s48, 200000
    s_cbranch_scc1 L_end
    s_sleep 1
    s_branch P_198
P_199:
    s_lshl_b32 s37, s44, 1
    s_add_u32 s37, s37, 1
    s_mul_i32 s38, s37, 9363
    s_lshr_b32 s38, s38, 16
    s_mul_i32 s39, s38, 7
    s_sub_u32 s39, s37, s39
    s_add_u32 s57, s38, 1
    s_mul_i32 s39, s39, 20
    v_add_u32 v176, 0, v1
    v_min_u32 v176, 19, v176
    v_lshlrev_b32 v176, 4, v176
    s_lshl_b32 s32, s39, 4
    s_add_u32 s32, s32, 24576
    s_mov_b32 s48, 0
P_200:
    buffer_load_dword v172, v176, s[4:7], s32 offen sc1
    s_waitcnt vmcnt(0)
    v_cmp_gt_u32 vcc, s57, v172
    s_cbranch_vccz P_201
    s_add_u32 s48, s48, 1
    s_cmp_gt_u32 s48, 200000
    s_cbranch_scc1 L_end
    s_sleep 1
    s_branch P_200
P_201:
    s_mul_i32 s54, s44, 40960
    s_add_u32 s56, s54, s52
    s_add_u32 s54, s54, s50
    buffer_load_dwordx4 v[16:19], v0, s[4:7], s54 offen offset:0 sc1
    buffer_load_dwordx4 v[20:23], v0, s[4:7], s54 offen offset:1024 sc1
    buffer_load_dwordx4 v[24:27], v0, s[4:7], s54 offen offset:2048 sc1
    buffer_load_dwordx4 v[28:31], v0, s[4:7], s54 offen offset:3072 sc1
    s_add_u32 s54, s54, 4096
    buffer_load_dwordx4 v[32:35], v0, s[4:7], s54 offen offset:0 sc1
    buffer_load_dwordx4 v[36:39], v0, s[4:7], s54 offen offset:1024 sc1
    buffer_load_dwordx4 v[40:43], v0, s[4:7], s54 offen offset:2048 sc1
    buffer_load_dwordx4 v[44:47], v0, s[4:7], s54 offen offset:3072 sc1
    s_add_u32 s54, s54, 4096
    buffer_load_dwordx4 v[48:51], v0, s[4:7], s54 offen offset:0 sc1
    buffer_load_dwordx4 v[52:55], v0, s[4:7], s54 offen offset:1024 sc1
    s_waitcnt vmcnt(9)
    v_mfma_f32_32x32x16_bf16 v[96:111], v[16:19], a[160:163], 0
    v_mfma_f32_32x32x16_bf16 v[112:127], v[16:19], a[200:203], 0
    s_waitcnt vmcnt(8)
    v_mfma_f32_32x32x16_bf16 v[96:111], v[20:23], a[164:167], v[96:111]
    v_mfma_f32_32x32x16_bf16 v[112:127], v[20:23], a[204:207], v[112:127]
    s_waitcnt vmcnt(7)
    v_mfma_f32_32x32x16_bf16 v[96:111], v[24:27], a[168:171], v[96:111]
    v_mfma_f32_32x32x16_bf16 v[112:127], v[24:27], a[208:211], v[112:127]
    s_waitcnt vmcnt(6)
    v_mfma_f32_32x32x16_bf16 v[96:111], v[28:31], a[172:175], v[96:111]
    v_mfma_f32_32x32x16_bf16 v[112:127], v[28:31], a[212:215], v[112:127]
    s_waitcnt vmcnt(5)
    v_mfma_f32_32x32x16_bf16 v[96:111], v[32:35], a[176:179], v[96:111]
    v_mfma_f32_32x32x16_bf16 v[112:127], v[32:35], a[216:219], v[112:127]
    s_waitcnt vmcnt(4)
    v_mfma_f32_32x32x16_bf16 v[96:111], v[36:39], a[180:183], v[96:111]
    v_mfma_f32_32x32x16_bf16 v[112:127], v[36:39], a[220:223], v[112:127]
    s_waitcnt vmcnt(3)
    v_mfma_f32_32x32x16_bf16 v[96:111], v[40:43], a[184:187], v[96:111]
    v_mfma_f32_32x32x16_bf16 v[112:127], v[40:43], a[224:227], v[112:127]
    s_waitcnt vmcnt(2)
    v_mfma_f32_32x32x16_bf16 v[96:111], v[44:47], a[188:191], v[96:111]
    v_mfma_f32_32x32x16_bf16 v[112:127], v[44:47], a[228:231], v[112:127]
    s_waitcnt vmcnt(1)
    v_mfma_f32_32x32x16_bf16 v[96:111], v[48:51], a[192:195], v[96:111]
    v_mfma_f32_32x32x16_bf16 v[112:127], v[48:51], a[232:235], v[112:127]
    s_waitcnt vmcnt(0)
    v_mfma_f32_32x32x16_bf16 v[96:111], v[52:55], a[196:199], v[96:111]
    v_mfma_f32_32x32x16_bf16 v[112:127], v[52:55], a[236:239], v[112:127]
    s_mul_i32 s55, s44, s58
    s_add_u32 s55, s55, s51
    s_nop 1
    ds_write_b128 v4, v[96:99] offset:0
    v_mov_b64 v[128:129], 0
    s_mov_b32 s34, 0x3f803f80
    v_dot2c_f32_bf16 v128, s34, v16
    v_dot2c_f32_bf16 v129, v16, v16
    v_dot2c_f32_bf16 v128, s34, v17
    v_dot2c_f32_bf16 v129, v17, v17
    v_dot2c_f32_bf16 v128, s34, v18
    v_dot2c_f32_bf16 v129, v18, v18
    v_dot2c_f32_bf16 v128, s34, v19
    v_dot2c_f32_bf16 v129, v19, v19
    v_dot2c_f32_bf16 v128, s34, v20
    v_dot2c_f32_bf16 v129, v20, v20
    ds_write_b128 v4, v[100:103] offset:1024
    v_dot2c_f32_bf16 v128, s34, v21
    v_dot2c_f32_bf16 v129, v21, v21
    v_dot2c_f32_bf16 v128, s34, v22
    v_dot2c_f32_bf16 v129, v22, v22
    v_dot2c_f32_bf16 v128, s34, v23
    v_dot2c_f32_bf16 v129, v23, v23
    v_dot2c_f32_bf16 v128, s34, v24
    v_dot2c_f32_bf16 v129, v24, v24
    v_dot2c_f32_bf16 v128, s34, v25
    v_dot2c_f32_bf16 v129, v25, v25
    ds_write_b128 v4, v[104:107] offset:2048
    v_dot2c_f32_bf16 v128, s34, v26
    v_dot2c_f32_bf16 v129, v26, v26
    v_dot2c_f32_bf16 v128, s34, v27
    v_dot2c_f32_bf16 v129, v27, v27
    v_dot2c_f32_bf16 v128, s34, v28
    v_dot2c_f32_bf16 v129, v28, v28
    v_dot2c_f32_bf16 v128, s34, v29
    v_dot2c_f32_bf16 v129, v29, v29
    v_dot2c_f32_bf16 v128, s34, v30
    v_dot2c_f32_bf16 v129, v30, v30
    ds_write_b128 v4, v[108:111] offset:3072
    v_dot2c_f32_bf16 v128, s34, v31
    v_dot2c_f32_bf16 v129, v31, v31
    v_dot2c_f32_bf16 v128, s34, v32
    v_dot2c_f32_bf16 v129, v32, v32
    v_dot2c_f32_bf16 v128, s34, v33
    v_dot2c_f32_bf16 v129, v33, v33
    v_dot2c_f32_bf16 v128, s34, v34
    v_dot2c_f32_bf16 v129, v34, v34
    v_dot2c_f32_bf16 v128, s34, v35
    v_dot2c_f32_bf16 v129, v35, v35
    ds_write_b128 v4, v[112:115] offset:4096
    v_dot2c_f32_bf16 v128, s34, v36
    v_dot2c_f32_bf16 v129, v36, v36
    v_dot2c_f32_bf16 v128, s34, v37
    v_dot2c_f32_bf16 v129, v37, v37
    v_dot2c_f32_bf16 v128, s34, v38
    v_dot2c_f32_bf16 v129, v38, v38
    v_dot2c_f32_bf16 v128, s34, v39
    v_dot2c_f32_bf16 v129, v39, v39
    v_dot2c_f32_bf16 v128, s34, v40
    v_dot2c_f32_bf16 v129, v40, v40
    ds_write_b128 v4, v[116:119] offset:5120
    v_dot2c_f32_bf16 v128, s34, v41
    v_dot2c_f32_bf16 v129, v41, v41
    v_dot2c_f32_bf16 v128, s34, v42
    v_dot2c_f32_bf16 v129, v42, v42
    v_dot2c_f32_bf16 v128, s34, v43
    v_dot2c_f32_bf16 v129, v43, v43
    v_dot2c_f32_bf16 v128, s34, v44
    v_dot2c_f32_bf16 v129, v44, v44
    v_dot2c_f32_bf16 v128, s34, v45
    v_dot2c_f32_bf16 v129, v45, v45
    ds_write_b128 v4, v[120:123] offset:6144
    v_dot2c_f32_bf16 v128, s34, v46
    v_dot2c_f32_bf16 v129, v46, v46
    v_dot2c_f32_bf16 v128, s34, v47
    v_dot2c_f32_bf16 v129, v47, v47
    v_dot2c_f32_bf16 v128, s34, v48
    v_dot2c_f32_bf16 v129, v48, v48
    v_dot2c_f32_bf16 v128, s34, v49
    v_dot2c_f32_bf16 v129, v49, v49
    v_dot2c_f32_bf16 v128, s34, v50
    v_dot2c_f32_bf16 v129, v50, v50
    ds_write_b128 v4, v[124:127] offset:7168
    v_dot2c_f32_bf16 v128, s34, v51
    v_dot2c_f32_bf16 v129, v51, v51
    v_dot2c_f32_bf16 v128, s34, v52
    v_dot2c_f32_bf16 v129, v52, v52
    v_dot2c_f32_bf16 v128, s34, v53
    v_dot2c_f32_bf16 v129, v53, v53
    v_dot2c_f32_bf16 v128, s34, v54
    v_dot2c_f32_bf16 v129, v54, v54
    v_dot2c_f32_bf16 v128, s34, v55
    v_dot2c_f32_bf16 v129, v55, v55
    s_nop 2
    v_mov_b64 v[172:173], v[128:129]
    s_nop 1
    v_permlane32_swap_b32 v128, v172
    v_permlane32_swap_b32 v129, v173
    v_pk_add_f32 v[128:129], v[128:129], v[172:173]
    ds_write_b64 v5, v[128:129] offset:0
    s_waitcnt lgkmcnt(0)
    s_barrier
    ds_read_b128 v[130:133], v6 offset:0
    ds_read_b128 v[134:137], v6 offset:16
    ds_read_b128 v[96:99], v3 offset:0
    ds_read_b128 v[100:103], v3 offset:1024
    ds_read_b128 v[104:107], v3 offset:8192
    ds_read_b128 v[108:111], v3 offset:9216
    ds_read_b128 v[112:115], v3 offset:16384
    ds_read_b128 v[116:119], v3 offset:17408
    ds_read_b128 v[120:123], v3 offset:24576
    ds_read_b128 v[124:127], v3 offset:25600
    s_waitcnt lgkmcnt(9)
    v_pk_add_f32 v[130:131], v[130:131], v[132:133]
    s_waitcnt lgkmcnt(8)
    v_pk_add_f32 v[134:135], v[134:135], v[136:137]
    v_pk_add_f32 v[130:131], v[130:131], v[134:135]
    v_mul_f32 v130, 0x3acccccd, v130
    v_mul_f32 v131, 0x3acccccd, v131
    v_fma_f32 v131, -v130, v130, v131
    v_max_f32 v131, 0, v131
    v_add_f32 v131, 0x3727c5ac, v131
    v_rsq_f32 v131, v131
    s_nop 0
    ds_write2_b32 v9, v130, v131 offset0:0 offset1:32
    ds_read_b128 v[138:141], v10 offset:0
    ds_read_b128 v[142:145], v10 offset:16
    ds_read_b128 v[146:149], v10 offset:128
    ds_read_b128 v[150:153], v10 offset:144
    s_waitcnt lgkmcnt(10)
    v_pk_add_f32 v[96:97], v[96:97], v[104:105]
    v_pk_add_f32 v[98:99], v[98:99], v[106:107]
    s_waitcnt lgkmcnt(9)
    v_pk_add_f32 v[100:101], v[100:101], v[108:109]
    v_pk_add_f32 v[102:103], v[102:103], v[110:111]
    s_waitcnt lgkmcnt(8)
    v_pk_add_f32 v[96:97], v[96:97], v[112:113]
    v_pk_add_f32 v[98:99], v[98:99], v[114:115]
    s_waitcnt lgkmcnt(7)
    v_pk_add_f32 v[100:101], v[100:101], v[116:117]
    v_pk_add_f32 v[102:103], v[102:103], v[118:119]
    s_waitcnt lgkmcnt(6)
    v_pk_add_f32 v[96:97], v[96:97], v[120:121]
    v_pk_add_f32 v[98:99], v[98:99], v[122:123]
    s_waitcnt lgkmcnt(5)
    v_pk_add_f32 v[100:101], v[100:101], v[124:125]
    v_pk_add_f32 v[102:103], v[102:103], v[126:127]
    s_waitcnt lgkmcnt(3)
    v_fma_f32 v96, -v138, v154, v96
    s_waitcnt lgkmcnt(1)
    v_mul_f32 v96, v96, v146
    v_fma_f32 v97, -v139, v155, v97
    v_mul_f32 v97, v97, v147
    v_fma_f32 v98, -v140, v156, v98
    v_mul_f32 v98, v98, v148
    v_fma_f32 v99, -v141, v157, v99
    v_mul_f32 v99, v99, v149
    v_fma_f32 v100, -v142, v158, v100
    s_waitcnt lgkmcnt(0)
    v_mul_f32 v100, v100, v150
    v_fma_f32 v101, -v143, v159, v101
    v_mul_f32 v101, v101, v151
    v_fma_f32 v102, -v144, v160, v102
    v_mul_f32 v102, v102, v152
    v_fma_f32 v103, -v145, v161, v103
    v_mul_f32 v103, v103, v153
    v_cvt_pk_bf16_f32 v172, v96, v97
    v_cvt_pk_bf16_f32 v173, v98, v99
    v_cvt_pk_bf16_f32 v174, v100, v101
    v_cvt_pk_bf16_f32 v175, v102, v103
    buffer_store_dwordx4 v[172:175], v7, s[4:7], s55 offen sc1
    s_add_u32 s44, s44, s47
    s_cmp_lt_u32 s44, 64
    s_cbranch_scc0 G_197
    s_lshl_b32 s37, s44, 1
    s_add_u32 s37, s37, 0
    s_mul_i32 s38, s37, 9363
    s_lshr_b32 s38, s38, 16
    s_mul_i32 s39, s38, 7
    s_sub_u32 s39, s37, s39
    s_add_u32 s57, s38, 1
    s_mul_i32 s39, s39, 20
    v_add_u32 v176, 0, v1
    v_min_u32 v176, 19, v176
    v_lshlrev_b32 v176, 4, v176
    s_lshl_b32 s32, s39, 4
    s_add_u32 s32, s32, 24576
    s_mov_b32 s48, 0
P_202:
    buffer_load_dword v172, v176, s[4:7], s32 offen sc1
    s_waitcnt vmcnt(0)
    v_cmp_gt_u32 vcc, s57, v172
    s_cbranch_vccz P_203
    s_add_u32 s48, s48, 1
    s_cmp_gt_u32 s48, 200000
    s_cbranch_scc1 L_end
    s_sleep 1
    s_branch P_202
P_203:
    s_lshl_b32 s37, s44, 1
    s_add_u32 s37, s37, 1
    s_mul_i32 s38, s37, 9363
    s_lshr_b32 s38, s38, 16
    s_mul_i32 s39, s38, 7
    s_sub_u32 s39, s37, s39
    s_add_u32 s57, s38, 1
    s_mul_i32 s39, s39, 20
    v_add_u32 v176, 0, v1
    v_min_u32 v176, 19, v176
    v_lshlrev_b32 v176, 4, v176
    s_lshl_b32 s32, s39, 4
    s_add_u32 s32, s32, 24576
    s_mov_b32 s48, 0
P_204:
    buffer_load_dword v172, v176, s[4:7], s32 offen sc1
    s_waitcnt vmcnt(0)
    v_cmp_gt_u32 vcc, s57, v172
    s_cbranch_vccz P_205
    s_add_u32 s48, s48, 1
    s_cmp_gt_u32 s48, 200000
    s_cbranch_scc1 L_end
    s_sleep 1
    s_branch P_204
P_205:
    s_mul_i32 s54, s44, 40960
    s_add_u32 s56, s54, s52
    s_add_u32 s54, s54, s50
    buffer_load_dwordx4 v[56:59], v0, s[4:7], s54 offen offset:0 sc1
    buffer_load_dwordx4 v[60:63], v0, s[4:7], s54 offen offset:1024 sc1
    buffer_load_dwordx4 v[64:67], v0, s[4:7], s54 offen offset:2048 sc1
    buffer_load_dwordx4 v[68:71], v0, s[4:7], s54 offen offset:3072 sc1
    s_add_u32 s54, s54, 4096
    buffer_load_dwordx4 v[72:75], v0, s[4:7], s54 offen offset:0 sc1
    buffer_load_dwordx4 v[76:79], v0, s[4:7], s54 offen offset:1024 sc1
    buffer_load_dwordx4 v[80:83], v0, s[4:7], s54 offen offset:2048 sc1
    buffer_load_dwordx4 v[84:87], v0, s[4:7], s54 offen offset:3072 sc1
    s_add_u32 s54, s54, 4096
    buffer_load_dwordx4 v[88:91], v0, s[4:7], s54 offen offset:0 sc1
    buffer_load_dwordx4 v[92:95], v0, s[4:7], s54 offen offset:1024 sc1
    s_waitcnt vmcnt(9)
    v_mfma_f32_32x32x16_bf16 v[96:111], v[56:59], a[160:163], 0
    v_mfma_f32_32x32x16_bf16 v[112:127], v[56:59], a[200:203], 0
    s_waitcnt vmcnt(8)
    v_mfma_f32_32x32x16_bf16 v[96:111], v[60:63], a[164:167], v[96:111]
    v_mfma_f32_32x32x16_bf16 v[112:127], v[60:63], a[204:207], v[112:127]
    s_waitcnt vmcnt(7)
    v_mfma_f32_32x32x16_bf16 v[96:111], v[64:67], a[168:171], v[96:111]
    v_mfma_f32_32x32x16_bf16 v[112:127], v[64:67], a[208:211], v[112:127]
    s_waitcnt vmcnt(6)
    v_mfma_f32_32x32x16_bf16 v[96:111], v[68:71], a[172:175], v[96:111]
    v_mfma_f32_32x32x16_bf16 v[112:127], v[68:71], a[212:215], v[112:127]
    s_waitcnt vmcnt(5)
    v_mfma_f32_32x32x16_bf16 v[96:111], v[72:75], a[176:179], v[96:111]
    v_mfma_f32_32x32x16_bf16 v[112:127], v[72:75], a[216:219], v[112:127]
    s_waitcnt vmcnt(4)
    v_mfma_f32_32x32x16_bf16 v[96:111], v[76:79], a[180:183], v[96:111]
    v_mfma_f32_32x32x16_bf16 v[112:127], v[76:79], a[220:223], v[112:127]
    s_waitcnt vmcnt(3)
    v_mfma_f32_32x32x16_bf16 v[96:111], v[80:83], a[184:187], v[96:111]
    v_mfma_f32_32x32x16_bf16 v[112:127], v[80:83], a[224:227], v[112:127]
    s_waitcnt vmcnt(2)
    v_mfma_f32_32x32x16_bf16 v[96:111], v[84:87], a[188:191], v[96:111]
    v_mfma_f32_32x32x16_bf16 v[112:127], v[84:87], a[228:231], v[112:127]
    s_waitcnt vmcnt(1)
    v_mfma_f32_32x32x16_bf16 v[96:111], v[88:91], a[192:195], v[96:111]
    v_mfma_f32_32x32x16_bf16 v[112:127], v[88:91], a[232:235], v[112:127]
    s_waitcnt vmcnt(0)
    v_mfma_f32_32x32x16_bf16 v[96:111], v[92:95], a[196:199], v[96:111]
    v_mfma_f32_32x32x16_bf16 v[112:127], v[92:95], a[236:239], v[112:127]
    s_mul_i32 s55, s44, s58
    s_add_u32 s55, s55, s51
    s_nop 1
    ds_write_b128 v4, v[96:99] offset:32768
    v_mov_b64 v[128:129], 0
    s_mov_b32 s34, 0x3f803f80
    v_dot2c_f32_bf16 v128, s34, v56
    v_dot2c_f32_bf16 v129, v56, v56
    v_dot2c_f32_bf16 v128, s34, v57
    v_dot2c_f32_bf16 v129, v57, v57
    v_dot2c_f32_bf16 v128, s34, v58
    v_dot2c_f32_bf16 v129, v58, v58
    v_dot2c_f32_bf16 v128, s34, v59
    v_dot2c_f32_bf16 v129, v59, v59
    v_dot2c_f32_bf16 v128, s34, v60
    v_dot2c_f32_bf16 v129, v60, v60
    ds_write_b128 v4, v[100:103] offset:33792
    v_dot2c_f32_bf16 v128, s34, v61
    v_dot2c_f32_bf16 v129, v61, v61
    v_dot2c_f32_bf16 v128, s34, v62
    v_dot2c_f32_bf16 v129, v62, v62
    v_dot2c_f32_bf16 v128, s34, v63
    v_dot2c_f32_bf16 v129, v63, v63
    v_dot2c_f32_bf16 v128, s34, v64
    v_dot2c_f32_bf16 v129, v64, v64
    v_dot2c_f32_bf16 v128, s34, v65
    v_dot2c_f32_bf16 v129, v65, v65
    ds_write_b128 v4, v[104:107] offset:34816
    v_dot2c_f32_bf16 v128, s34, v66
    v_dot2c_f32_bf16 v129, v66, v66
    v_dot2c_f32_bf16 v128, s34, v67
    v_dot2c_f32_bf16 v129, v67, v67
    v_dot2c_f32_bf16 v128, s34, v68
    v_dot2c_f32_bf16 v129, v68, v68
    v_dot2c_f32_bf16 v128, s34, v69
    v_dot2c_f32_bf16 v129, v69, v69
    v_dot2c_f32_bf16 v128, s34, v70
    v_dot2c_f32_bf16 v129, v70, v70
    ds_write_b128 v4, v[108:111] offset:35840
    v_dot2c_f32_bf16 v128, s34, v71
    v_dot2c_f32_bf16 v129, v71, v71
    v_dot2c_f32_bf16 v128, s34, v72
    v_dot2c_f32_bf16 v129, v72, v72
    v_dot2c_f32_bf16 v128, s34, v73
    v_dot2c_f32_bf16 v129, v73, v73
    v_dot2c_f32_bf16 v128, s34, v74
    v_dot2c_f32_bf16 v129, v74, v74
    v_dot2c_f32_bf16 v128, s34, v75
    v_dot2c_f32_bf16 v129, v75, v75
    ds_write_b128 v4, v[112:115] offset:36864
    v_dot2c_f32_bf16 v128, s34, v76
    v_dot2c_f32_bf16 v129, v76, v76
    v_dot2c_f32_bf16 v128, s34, v77
    v_dot2c_f32_bf16 v129, v77, v77
    v_dot2c_f32_bf16 v128, s34, v78
    v_dot2c_f32_bf16 v129, v78, v78
    v_dot2c_f32_bf16 v128, s34, v79
    v_dot2c_f32_bf16 v129, v79, v79
    v_dot2c_f32_bf16 v128, s34, v80
    v_dot2c_f32_bf16 v129, v80, v80
    ds_write_b128 v4, v[116:119] offset:37888
    v_dot2c_f32_bf16 v128, s34, v81
    v_dot2c_f32_bf16 v129, v81, v81
    v_dot2c_f32_bf16 v128, s34, v82
    v_dot2c_f32_bf16 v129, v82, v82
    v_dot2c_f32_bf16 v128, s34, v83
    v_dot2c_f32_bf16 v129, v83, v83
    v_dot2c_f32_bf16 v128, s34, v84
    v_dot2c_f32_bf16 v129, v84, v84
    v_dot2c_f32_bf16 v128, s34, v85
    v_dot2c_f32_bf16 v129, v85, v85
    ds_write_b128 v4, v[120:123] offset:38912
    v_dot2c_f32_bf16 v128, s34, v86
    v_dot2c_f32_bf16 v129, v86, v86
    v_dot2c_f32_bf16 v128, s34, v87
    v_dot2c_f32_bf16 v129, v87, v87
    v_dot2c_f32_bf16 v128, s34, v88
    v_dot2c_f32_bf16 v129, v88, v88
    v_dot2c_f32_bf16 v128, s34, v89
    v_dot2c_f32_bf16 v129, v89, v89
    v_dot2c_f32_bf16 v128, s34, v90
    v_dot2c_f32_bf16 v129, v90, v90
    ds_write_b128 v4, v[124:127] offset:39936
    v_dot2c_f32_bf16 v128, s34, v91
    v_dot2c_f32_bf16 v129, v91, v91
    v_dot2c_f32_bf16 v128, s34, v92
    v_dot2c_f32_bf16 v129, v92, v92
    v_dot2c_f32_bf16 v128, s34, v93
    v_dot2c_f32_bf16 v129, v93, v93
    v_dot2c_f32_bf16 v128, s34, v94
    v_dot2c_f32_bf16 v129, v94, v94
    v_dot2c_f32_bf16 v128, s34, v95
    v_dot2c_f32_bf16 v129, v95, v95
    s_nop 2
    v_mov_b64 v[172:173], v[128:129]
    s_nop 1
    v_permlane32_swap_b32 v128, v172
    v_permlane32_swap_b32 v129, v173
    v_pk_add_f32 v[128:129], v[128:129], v[172:173]
    ds_write_b64 v5, v[128:129] offset:1024
    s_waitcnt lgkmcnt(0)
    s_barrier
    ds_read_b128 v[130:133], v6 offset:1024
    ds_read_b128 v[134:137], v6 offset:1040
    ds_read_b128 v[96:99], v3 offset:32768
    ds_read_b128 v[100:103], v3 offset:33792
    ds_read_b128 v[104:107], v3 offset:40960
    ds_read_b128 v[108:111], v3 offset:41984
    ds_read_b128 v[112:115], v3 offset:49152
    ds_read_b128 v[116:119], v3 offset:50176
    ds_read_b128 v[120:123], v3 offset:57344
    ds_read_b128 v[124:127], v3 offset:58368
    s_waitcnt lgkmcnt(9)
    v_pk_add_f32 v[130:131], v[130:131], v[132:133]
    s_waitcnt lgkmcnt(8)
    v_pk_add_f32 v[134:135], v[134:135], v[136:137]
    v_pk_add_f32 v[130:131], v[130:131], v[134:135]
    v_mul_f32 v130, 0x3acccccd, v130
    v_mul_f32 v131, 0x3acccccd, v131
    v_fma_f32 v131, -v130, v130, v131
    v_max_f32 v131, 0, v131
    v_add_f32 v131, 0x3727c5ac, v131
    v_rsq_f32 v131, v131
    s_nop 0
    ds_write2_b32 v9, v130, v131 offset0:0 offset1:32
    ds_read_b128 v[138:141], v10 offset:0
    ds_read_b128 v[142:145], v10 offset:16
    ds_read_b128 v[146:149], v10 offset:128
    ds_read_b128 v[150:153], v10 offset:144
    s_waitcnt lgkmcnt(10)
    v_pk_add_f32 v[96:97], v[96:97], v[104:105]
    v_pk_add_f32 v[98:99], v[98:99], v[106:107]
    s_waitcnt lgkmcnt(9)
    v_pk_add_f32 v[100:101], v[100:101], v[108:109]
    v_pk_add_f32 v[102:103], v[102:103], v[110:111]
    s_waitcnt lgkmcnt(8)
    v_pk_add_f32 v[96:97], v[96:97], v[112:113]
    v_pk_add_f32 v[98:99], v[98:99], v[114:115]
    s_waitcnt lgkmcnt(7)
    v_pk_add_f32 v[100:101], v[100:101], v[116:117]
    v_pk_add_f32 v[102:103], v[102:103], v[118:119]
    s_waitcnt lgkmcnt(6)
    v_pk_add_f32 v[96:97], v[96:97], v[120:121]
    v_pk_add_f32 v[98:99], v[98:99], v[122:123]
    s_waitcnt lgkmcnt(5)
    v_pk_add_f32 v[100:101], v[100:101], v[124:125]
    v_pk_add_f32 v[102:103], v[102:103], v[126:127]
    s_waitcnt lgkmcnt(3)
    v_fma_f32 v96, -v138, v154, v96
    s_waitcnt lgkmcnt(1)
    v_mul_f32 v96, v96, v146
    v_fma_f32 v97, -v139, v155, v97
    v_mul_f32 v97, v97, v147
    v_fma_f32 v98, -v140, v156, v98
    v_mul_f32 v98, v98, v148
    v_fma_f32 v99, -v141, v157, v99
    v_mul_f32 v99, v99, v149
    v_fma_f32 v100, -v142, v158, v100
    s_waitcnt lgkmcnt(0)
    v_mul_f32 v100, v100, v150
    v_fma_f32 v101, -v143, v159, v101
    v_mul_f32 v101, v101, v151
    v_fma_f32 v102, -v144, v160, v102
    v_mul_f32 v102, v102, v152
    v_fma_f32 v103, -v145, v161, v103
    v_mul_f32 v103, v103, v153
    v_cvt_pk_bf16_f32 v172, v96, v97
    v_cvt_pk_bf16_f32 v173, v98, v99
    v_cvt_pk_bf16_f32 v174, v100, v101
    v_cvt_pk_bf16_f32 v175, v102, v103
    buffer_store_dwordx4 v[172:175], v7, s[4:7], s55 offen sc1
    s_add_u32 s44, s44, s47
    s_cmp_lt_u32 s44, 64
    s_cbranch_scc1 G_196
G_197:
    s_waitcnt vmcnt(0)
    s_barrier
    s_cmp_lg_u32 s29, 0
    s_cbranch_scc1 F_206
    s_lshl_b32 s32, s28, 2
    s_add_u32 s32, s32, s29
    s_lshl_b32 s32, s32, 2
    s_add_u32 s32, s32, 4096
    v_mov_b32 v172, 2
    s_mov_b64 exec, 1
    buffer_store_dword v172, off, s[4:7], s32 sc1
    s_mov_b64 exec, -1
F_206:
R_195:
    s_mov_b32 s30, 1
    s_mov_b32 s61, 64
    s_waitcnt vmcnt(0) lgkmcnt(0)
    s_branch LAYER_126

s_endpgm
.section .rodata,"a"
.p2align 6
.amdhsa_kernel interleave_layers__spectral_gfnet__memory_aug_recurrent_mem_tr__prompt_kernel
  .amdhsa_next_free_vgpr 512
  .amdhsa_next_free_sgpr 102
  .amdhsa_accum_offset 256
  .amdhsa_group_segment_fixed_size 0
  .amdhsa_kernarg_size 104
  .amdhsa_user_sgpr_count 2
  .amdhsa_user_sgpr_kernarg_segment_ptr 1
  .amdhsa_system_sgpr_workgroup_id_x 1
  .amdhsa_float_denorm_mode_32 3
.end_amdhsa_kernel
```

```asm
; @launch grid=(256,1,1) block=(256,1,1) lds=163840
.amdgcn_target "amdgcn-amd-amdhsa--gfx950"
.text
.globl interleave_layers__spectral_gfnet__memory_aug_recurrent_mem_tr__prompt_kernel
.p2align 8
.type interleave_layers__spectral_gfnet__memory_aug_recurrent_mem_tr__prompt_kernel,@function
interleave_layers__spectral_gfnet__memory_aug_recurrent_mem_tr__prompt_kernel:
    s_cmp_ge_u32 s2, 256
    s_cbranch_scc1 L_end0
    v_lshrrev_b32 v1, 6, v0
    s_and_b32 s3, s2, 7
    s_lshr_b32 s2, s2, 3
    s_cmp_ge_u32 s3, 2
    s_cbranch_scc1 L_worker0
    s_mov_b32 s19, s3
    s_mov_b32 s20, s2
    v_readfirstlane_b32 s21, v1
    s_branch L_chain
L_worker0:
    s_branch L_worker
L_end0:
    s_endpgm
L_chain:
    s_load_dwordx2 s[32:33], s[0:1], 96
    s_mov_b32 s34, 268435456
    s_mov_b32 s35, 0x20000
    s_load_dwordx2 s[36:37], s[0:1], 96
    s_mov_b32 s38, 268435456
    s_mov_b32 s39, 0x20000
    s_load_dwordx2 s[28:29], s[0:1], 96
    s_mov_b32 s30, 196608
    s_mov_b32 s31, 0x20000
    s_load_dwordx2 s[4:5], s[0:1], 88
    s_mov_b32 s6, 256
    s_mov_b32 s7, 0x20000
    v_and_b32 v12, 63, v0
    v_lshrrev_b32 v13, 4, v12
    v_and_b32 v14, 15, v12
    v_lshlrev_b32 v0, 4, v12
    s_lshl_b32 s64, s21, 15
    s_add_u32 s64, s64, 32768
    v_add_u32 v1, s64, v0
    v_bfe_u32 v8, v14, 1, 1
    v_mul_u32_u24 v8, 0xAAAA, v8
    v_add_u32 v2, 0x4444, v8
    s_mul_i32 s47, s21, 544
    s_add_u32 s47, s47, 10240
    v_lshrrev_b32 v8, 1, v13
    v_and_b32 v9, 1, v13
    v_lshlrev_b32 v10, 3, v12
    v_lshl_add_u32 v10, v8, 5, v10
    v_add_u32 v3, s47, v10
    v_mul_u32_u24 v10, 544, v8
    v_and_b32 v11, 3, v14
    v_lshl_add_u32 v10, v11, 7, v10
    v_bfe_u32 v11, v14, 1, 1
    v_lshl_add_u32 v10, v11, 5, v10
    v_lshl_add_u32 v10, v9, 6, v10
    v_lshrrev_b32 v4, 2, v14
    v_lshl_add_u32 v10, v4, 3, v10
    v_add_u32 v4, 10240, v10
    s_lshl_b32 s47, s21, 9
    s_add_u32 s47, s47, 10240
    v_mul_u32_u24 v10, 2080, v11
    v_and_b32 v11, 13, v14
    v_lshl_add_u32 v11, v9, 1, v11
    v_lshl_add_u32 v11, v8, 4, v11
    v_lshl_add_u32 v11, v11, 4, v10
    v_add_u32 v5, s47, v11
    s_lshl_b32 s47, s21, 14
    s_lshl_b32 s48, s20, 6
    s_add_u32 s47, s47, s48
    v_lshrrev_b32 v8, 3, v12
    v_and_b32 v9, 7, v12
    v_lshlrev_b32 v9, 3, v9
    v_lshl_add_u32 v8, v8, 11, v9
    v_add_u32 v7, s47, v8
    v_and_b32 v8, 1, v14
    v_lshlrev_b32 v8, 3, v8
    v_lshl_add_u32 v9, v13, 4, v8
    v_and_b32 v8, 2, v14
    v_lshl_add_u32 v9, v8, 4, v9
    v_lshrrev_b32 v11, 3, v14
    s_cmp_ge_u32 s21, 2
    s_cbranch_scc1 CH_s_1
    s_lshl_b32 s46, s21, 16
    s_lshl_b32 s47, s20, 11
    s_add_u32 s46, s46, s47
    s_lshl_b32 s47, s21, 11
    s_lshr_b32 s48, s20, 3
    s_lshl_b32 s48, s48, 9
    s_add_u32 s47, s47, s48
    s_and_b32 s48, s20, 1
    s_lshl_b32 s48, s48, 8
    s_add_u32 s47, s47, s48
    s_bfe_u32 s48, s20, 0x20001
    s_lshl_b32 s48, s48, 6
    s_add_u32 s47, s47, s48
    v_bfe_u32 v10, v14, 2, 1
    v_or_b32 v10, v10, v8
    s_mov_b32 s91, 0
    s_mov_b32 s95, 0
    s_branch CH_s_2
CH_s_1:
    s_and_b32 s48, s20, 15
    s_lshl_b32 s46, s48, 11
    s_add_u32 s46, s46, 131072
    s_lshl_b32 s47, s48, 6
    s_add_u32 s47, s47, 4096
    v_and_b32 v10, 3, v14
    s_mov_b32 s91, 2
    s_and_b32 s95, s20, 16
CH_s_2:
    v_add_u32 v9, s47, v9
    v_lshl_add_u32 v10, v11, 2, v10
    v_and_b32 v8, 0x2c, v12
    v_or_b32 v8, s95, v8
    v_cmp_eq_u32 vcc, 0, v8
    v_mov_b32 v11, 1073741824
    s_nop 0
    v_cndmask_b32 v6, v11, v9, vcc
    v_cmp_eq_u32 s[52:53], 0, v10
    v_cmp_eq_u32 s[54:55], 1, v10
    v_cmp_eq_u32 s[56:57], 2, v10
    v_cmp_eq_u32 s[58:59], 3, v10
    s_lshl_b32 s47, s19, 5
    s_add_u32 s47, s47, s20
    s_lshl_b32 s47, s47, 2
    s_add_u32 s47, s47, s21
    s_mul_i32 s45, s47, 143360
    s_lshl_b32 s63, s21, 11
    s_add_u32 s63, s63, 16384
    s_mov_b32 s51, 0x3e0293ee
    s_mov_b32 s61, 65536
    s_lshl_b32 s47, s21, 13
    s_lshl_b32 s48, s20, 6
    s_add_u32 s47, s47, s48
    s_add_u32 s62, s47, 131072
    s_mov_b32 s94, 0xfffff800
    s_mov_b32 s65, 0x3f80
    s_mov_b32 s22, 0x3f803f80
    s_mov_b32 s23, 0x3f803f80
    s_lshl_b32 s92, s21, 10
    s_lshl_b32 s93, s21, 8
    s_add_u32 s93, s93, 4096
    s_waitcnt lgkmcnt(0)
    v_mov_b64 v[8:9], 0
    v_mov_b64 v[10:11], 0
    v_mov_b64 v[12:13], -1
    v_mov_b64 v[14:15], -1
    s_lshr_b32 s47, s21, 1
    s_lshl_b32 s47, s47, 1
    s_add_u32 s47, s47, s19
    s_mul_i32 s47, s47, 196608
    s_lshl_b32 s48, s20, 10
    s_add_u32 s47, s47, s48
    s_add_u32 s47, s47, 65536
    s_bitcmp1_b32 s21, 0
    s_cbranch_scc1 CH_i_3
    s_add_u32 s48, s47, 0
    buffer_store_dwordx4 v[8:11], v0, s[32:35], s48 offen sc1
    s_add_u32 s48, s47, 32768
    buffer_store_dwordx4 v[8:11], v0, s[32:35], s48 offen sc1
    s_add_u32 s48, s47, 65536
    buffer_store_dwordx4 v[8:11], v0, s[32:35], s48 offen sc1
    s_branch CH_i_4
CH_i_3:
    s_add_u32 s48, s47, 98304
    buffer_store_dwordx4 v[8:11], v0, s[32:35], s48 offen sc1
    s_add_u32 s48, s47, 131072
    buffer_store_dwordx4 v[8:11], v0, s[32:35], s48 offen sc1
    s_add_u32 s48, s47, 163840
    buffer_store_dwordx4 v[12:15], v0, s[32:35], s48 offen sc1
CH_i_4:
    s_waitcnt vmcnt(0)
    s_barrier
    s_getreg_b32 s101, hwreg(HW_REG_XCC_ID, 0, 3)
    s_mul_i32 s101, s101, 6
    s_cmp_lg_u32 s21, 0
    s_cbranch_scc1 CH_i_5
    s_lshl_b64 s[66:67], 1, s101
    s_or_b32 s67, s67, 0x10000
    v_mov_b64 v[8:9], s[66:67]
    s_lshl_b32 s47, s19, 3
    s_mov_b64 exec, 1
    buffer_atomic_add_x2 v[8:9], off, s[4:7], s47 offset:128
    s_mov_b64 exec, -1
CH_i_5:
    s_waitcnt vmcnt(0)
    s_load_dwordx2 s[4:5], s[0:1], 40
    s_mov_b32 s6, 5242880
    s_mov_b32 s7, 0x20000
    s_load_dwordx2 s[8:9], s[0:1], 48
    s_mov_b32 s10, 5242880
    s_mov_b32 s11, 0x20000
    s_load_dwordx2 s[12:13], s[0:1], 56
    s_mov_b32 s14, 5242880
    s_mov_b32 s15, 0x20000
    s_load_dwordx2 s[24:25], s[0:1], 64
    s_mov_b32 s26, 5242880
    s_mov_b32 s27, 0x20000
    v_lshrrev_b32 v8, 4, v0
    v_bfe_u32 v9, v8, 4, 2
    v_mul_u32_u24 v9, 8192, v9
    v_bfe_u32 v10, v8, 4, 2
    v_mul_u32_u24 v10, 1280, v10
    v_xor_b32 v20, 0, v0
    v_and_b32 v20, 255, v20
    v_add_u32 v40, v9, v20
    v_add_u32 v44, v10, v20
    v_xor_b32 v20, 64, v0
    v_and_b32 v20, 255, v20
    v_add_u32 v41, v9, v20
    v_add_u32 v45, v10, v20
    v_xor_b32 v20, 128, v0
    v_and_b32 v20, 255, v20
    v_add_u32 v42, v9, v20
    v_add_u32 v46, v10, v20
    v_xor_b32 v20, 192, v0
    v_and_b32 v20, 255, v20
    v_add_u32 v43, v9, v20
    v_add_u32 v47, v10, v20
    v_bfe_u32 v11, v8, 3, 3
    v_mul_u32_u24 v11, 1280, v11
    v_bfe_u32 v20, v8, 0, 3
    v_lshl_add_u32 v11, v20, 4, v11
    s_lshl_b32 s47, s21, 6
    v_bfe_u32 v18, v8, 3, 1
    v_mul_u32_u24 v18, 128, v18
    v_bfe_u32 v20, v8, 2, 1
    v_lshl_add_u32 v18, v20, 6, v18
    v_xor_b32 v18, s47, v18
    v_bfe_u32 v12, v8, 3, 1
    v_mul_u32_u24 v12, 2048, v12
    v_bfe_u32 v20, v8, 2, 1
    v_lshl_add_u32 v12, v20, 10, v12
    v_bfe_u32 v20, v8, 4, 1
    v_lshl_add_u32 v12, v20, 9, v12
    v_bfe_u32 v20, v8, 0, 2
    v_lshl_add_u32 v12, v20, 3, v12
    v_add_u32 v12, v12, v18
    v_bfe_u32 v18, v8, 3, 1
    v_mul_u32_u24 v18, 128, v18
    v_bfe_u32 v20, v8, 4, 1
    v_lshl_add_u32 v18, v20, 6, v18
    v_xor_b32 v18, s47, v18
    v_bfe_u32 v13, v8, 3, 1
    v_mul_u32_u24 v13, 2048, v13
    v_bfe_u32 v20, v8, 4, 1
    v_lshl_add_u32 v13, v20, 10, v13
    v_bfe_u32 v20, v8, 2, 1
    v_lshl_add_u32 v13, v20, 8, v13
    v_bfe_u32 v20, v8, 0, 2
    v_lshl_add_u32 v13, v20, 3, v13
    v_add_u32 v13, v13, v18
    v_bfe_u32 v18, v8, 5, 1
    v_mul_u32_u24 v18, 128, v18
    v_bfe_u32 v20, v8, 3, 1
    v_lshl_add_u32 v18, v20, 6, v18
    v_xor_b32 v18, s47, v18
    v_bfe_u32 v14, v8, 5, 1
    v_mul_u32_u24 v14, 2048, v14
    v_bfe_u32 v20, v8, 3, 1
    v_lshl_add_u32 v14, v20, 10, v14
    v_bfe_u32 v20, v8, 2, 1
    v_lshl_add_u32 v14, v20, 8, v14
    v_bfe_u32 v20, v8, 0, 2
    v_lshl_add_u32 v14, v20, 4, v14
    v_add_u32 v14, v14, v18
    s_lshl_b32 s47, s21, 5
    v_bfe_u32 v15, v8, 4, 1
    v_mul_u32_u24 v15, 2048, v15
    v_bfe_u32 v20, v8, 5, 1
    v_lshl_add_u32 v15, v20, 10, v15
    v_bfe_u32 v20, v8, 3, 1
    v_lshl_add_u32 v15, v20, 9, v15
    v_bfe_u32 v20, v8, 2, 1
    v_lshl_add_u32 v15, v20, 7, v15
    v_bfe_u32 v20, v8, 0, 2
    v_lshl_add_u32 v15, v20, 3, v15
    v_add_u32 v15, s47, v15
    v_bfe_u32 v16, v8, 4, 1
    v_bfe_u32 v17, v8, 5, 1
    s_lshl_b32 s47, s20, 8
    s_lshl_b32 s48, s21, 17
    s_add_u32 s47, s47, s48
    s_mul_i32 s48, s19, 2621440
    s_add_u32 s66, s47, s48
    s_sub_u32 s67, s47, s48
    s_add_u32 s67, s67, 2621440
    s_mul_i32 s47, s20, 163840
    s_mul_i32 s48, s19, 640
    s_add_u32 s47, s47, s48
    s_mul_i32 s48, s21, 20480
    s_add_u32 s68, s47, s48
    s_add_u32 s69, s68, s48
    s_add_u32 s69, s69, 512
    s_lshl_b32 s70, s21, 13
    s_waitcnt lgkmcnt(0)
    s_add_u32 m0, s64, 4096
    s_add_u32 s47, s66, 0
    buffer_load_dwordx4 v40, s[4:7], s47 offen  lds
    s_add_u32 m0, s64, 5120
    s_add_u32 s47, s66, 32768
    buffer_load_dwordx4 v41, s[4:7], s47 offen  lds
    s_add_u32 m0, s64, 6144
    s_add_u32 s47, s66, 65536
    buffer_load_dwordx4 v42, s[4:7], s47 offen  lds
    s_add_u32 m0, s64, 7168
    s_add_u32 s47, s66, 98304
    buffer_load_dwordx4 v43, s[4:7], s47 offen  lds
    s_add_u32 m0, s64, 8192
    s_add_u32 s47, s66, 524288
    buffer_load_dwordx4 v40, s[4:7], s47 offen  lds
    s_add_u32 m0, s64, 9216
    s_add_u32 s47, s66, 557056
    buffer_load_dwordx4 v41, s[4:7], s47 offen  lds
    s_add_u32 m0, s64, 10240
    s_add_u32 s47, s66, 589824
    buffer_load_dwordx4 v42, s[4:7], s47 offen  lds
    s_add_u32 m0, s64, 11264
    s_add_u32 s47, s66, 622592
    buffer_load_dwordx4 v43, s[4:7], s47 offen  lds
    s_add_u32 m0, s64, 12288
    s_add_u32 s47, s66, 2097152
    buffer_load_dwordx4 v40, s[4:7], s47 offen  lds
    s_add_u32 m0, s64, 13312
    s_add_u32 s47, s66, 2129920
    buffer_load_dwordx4 v41, s[4:7], s47 offen  lds
    s_add_u32 m0, s64, 14336
    s_add_u32 s47, s66, 2162688
    buffer_load_dwordx4 v42, s[4:7], s47 offen  lds
    s_add_u32 m0, s64, 15360
    s_add_u32 s47, s66, 2195456
    buffer_load_dwordx4 v43, s[4:7], s47 offen  lds
    s_add_u32 m0, s64, 16384
    s_add_u32 s47, s67, 0
    buffer_load_dwordx4 v40, s[4:7], s47 offen  lds
    s_add_u32 m0, s64, 17408
    s_add_u32 s47, s67, 32768
    buffer_load_dwordx4 v41, s[4:7], s47 offen  lds
    s_add_u32 m0, s64, 18432
    s_add_u32 s47, s67, 65536
    buffer_load_dwordx4 v42, s[4:7], s47 offen  lds
    s_add_u32 m0, s64, 19456
    s_add_u32 s47, s67, 98304
    buffer_load_dwordx4 v43, s[4:7], s47 offen  lds
    s_add_u32 m0, s64, 20480
    s_add_u32 s47, s67, 2097152
    buffer_load_dwordx4 v40, s[4:7], s47 offen  lds
    s_add_u32 m0, s64, 21504
    s_add_u32 s47, s67, 2129920
    buffer_load_dwordx4 v41, s[4:7], s47 offen  lds
    s_add_u32 m0, s64, 22528
    s_add_u32 s47, s67, 2162688
    buffer_load_dwordx4 v42, s[4:7], s47 offen  lds
    s_add_u32 m0, s64, 23552
    s_add_u32 s47, s67, 2195456
    buffer_load_dwordx4 v43, s[4:7], s47 offen  lds
    v_lshl_add_u32 v18, v17, 15, v12
    v_add_u32 v18, 32768, v18
    v_add_u32 v19, 65536, v18
    s_waitcnt vmcnt(16)
    s_barrier
    ds_read_b64_tr_b16 v[64:65], v18 offset:4096
    ds_read_b64_tr_b16 v[66:67], v18 offset:4352
    ds_read_b64_tr_b16 v[68:69], v19 offset:4096
    ds_read_b64_tr_b16 v[70:71], v19 offset:4352
    ds_read_b64_tr_b16 v[72:73], v18 offset:4128
    ds_read_b64_tr_b16 v[74:75], v18 offset:4384
    ds_read_b64_tr_b16 v[76:77], v19 offset:4128
    ds_read_b64_tr_b16 v[78:79], v19 offset:4384
    s_add_u32 m0, s64, 24576
    s_add_u32 s47, s66, 0
    buffer_load_dwordx4 v40, s[8:11], s47 offen  lds
    s_add_u32 m0, s64, 25600
    s_add_u32 s47, s66, 32768
    buffer_load_dwordx4 v41, s[8:11], s47 offen  lds
    s_add_u32 m0, s64, 26624
    s_add_u32 s47, s66, 65536
    buffer_load_dwordx4 v42, s[8:11], s47 offen  lds
    s_add_u32 m0, s64, 27648
    s_add_u32 s47, s66, 98304
    buffer_load_dwordx4 v43, s[8:11], s47 offen  lds
    s_waitcnt lgkmcnt(0)
    v_lshl_add_u32 v18, v17, 15, v12
    v_add_u32 v18, 32768, v18
    v_add_u32 v19, 65536, v18
    s_waitcnt vmcnt(16)
    s_barrier
    ds_read_b64_tr_b16 v[104:105], v18 offset:8192
    ds_read_b64_tr_b16 v[106:107], v18 offset:8448
    ds_read_b64_tr_b16 v[108:109], v19 offset:8192
    ds_read_b64_tr_b16 v[110:111], v19 offset:8448
    ds_read_b64_tr_b16 v[112:113], v18 offset:8224
    ds_read_b64_tr_b16 v[114:115], v18 offset:8480
    ds_read_b64_tr_b16 v[116:117], v19 offset:8224
    ds_read_b64_tr_b16 v[118:119], v19 offset:8480
    s_add_u32 m0, s64, 4096
    s_add_u32 s47, s66, 1048576
    buffer_load_dwordx4 v40, s[8:11], s47 offen  lds
    s_add_u32 m0, s64, 5120
    s_add_u32 s47, s66, 1081344
    buffer_load_dwordx4 v41, s[8:11], s47 offen  lds
    s_add_u32 m0, s64, 6144
    s_add_u32 s47, s66, 1114112
    buffer_load_dwordx4 v42, s[8:11], s47 offen  lds
    s_add_u32 m0, s64, 7168
    s_add_u32 s47, s66, 1146880
    buffer_load_dwordx4 v43, s[8:11], s47 offen  lds
    s_waitcnt lgkmcnt(0)
    v_lshl_add_u32 v18, v17, 15, v13
    v_add_u32 v18, 32768, v18
    v_add_u32 v19, 65536, v18
    s_waitcnt vmcnt(16)
    s_barrier
    ds_read_b64_tr_b16 v[208:209], v18 offset:12288
    ds_read_b64_tr_b16 v[210:211], v18 offset:12800
    ds_read_b64_tr_b16 v[212:213], v19 offset:12288
    ds_read_b64_tr_b16 v[214:215], v19 offset:12800
    ds_read_b64_tr_b16 v[216:217], v18 offset:12320
    ds_read_b64_tr_b16 v[218:219], v18 offset:12832
    ds_read_b64_tr_b16 v[220:221], v19 offset:12320
    ds_read_b64_tr_b16 v[222:223], v19 offset:12832
    s_add_u32 m0, s64, 8192
    s_add_u32 s47, s66, 1572864
    buffer_load_dwordx4 v40, s[8:11], s47 offen  lds
    s_add_u32 m0, s64, 9216
    s_add_u32 s47, s66, 1605632
    buffer_load_dwordx4 v41, s[8:11], s47 offen  lds
    s_add_u32 m0, s64, 10240
    s_add_u32 s47, s66, 1638400
    buffer_load_dwordx4 v42, s[8:11], s47 offen  lds
    s_add_u32 m0, s64, 11264
    s_add_u32 s47, s66, 1671168
    buffer_load_dwordx4 v43, s[8:11], s47 offen  lds
    s_waitcnt lgkmcnt(0)
    v_lshl_add_u32 v18, v17, 15, v12
    v_add_u32 v18, 32768, v18
    v_add_u32 v19, 65536, v18
    s_waitcnt vmcnt(16)
    s_barrier
    ds_read_b64_tr_b16 v[232:233], v18 offset:16384
    ds_read_b64_tr_b16 v[234:235], v18 offset:16640
    ds_read_b64_tr_b16 v[236:237], v19 offset:16384
    ds_read_b64_tr_b16 v[238:239], v19 offset:16640
    ds_read_b64_tr_b16 v[240:241], v18 offset:16416
    ds_read_b64_tr_b16 v[242:243], v18 offset:16672
    ds_read_b64_tr_b16 v[244:245], v19 offset:16416
    ds_read_b64_tr_b16 v[246:247], v19 offset:16672
    s_add_u32 m0, s64, 12288
    s_add_u32 s47, s67, 0
    buffer_load_dwordx4 v40, s[8:11], s47 offen  lds
    s_add_u32 m0, s64, 13312
    s_add_u32 s47, s67, 32768
    buffer_load_dwordx4 v41, s[8:11], s47 offen  lds
    s_add_u32 m0, s64, 14336
    s_add_u32 s47, s67, 65536
    buffer_load_dwordx4 v42, s[8:11], s47 offen  lds
    s_add_u32 m0, s64, 15360
    s_add_u32 s47, s67, 98304
    buffer_load_dwordx4 v43, s[8:11], s47 offen  lds
    s_waitcnt lgkmcnt(0)
    v_lshl_add_u32 v18, v17, 15, v13
    v_add_u32 v18, 32768, v18
    v_add_u32 v19, 65536, v18
    s_waitcnt vmcnt(16)
    s_barrier
    ds_read_b64_tr_b16 a[64:65], v18 offset:20480
    ds_read_b64_tr_b16 a[66:67], v18 offset:20992
    ds_read_b64_tr_b16 a[68:69], v19 offset:20480
    ds_read_b64_tr_b16 a[70:71], v19 offset:20992
    ds_read_b64_tr_b16 a[72:73], v18 offset:20512
    ds_read_b64_tr_b16 a[74:75], v18 offset:21024
    ds_read_b64_tr_b16 a[76:77], v19 offset:20512
    ds_read_b64_tr_b16 a[78:79], v19 offset:21024
    s_add_u32 m0, s64, 16384
    s_add_u32 s47, s67, 524288
    buffer_load_dwordx4 v40, s[8:11], s47 offen  lds
    s_add_u32 m0, s64, 17408
    s_add_u32 s47, s67, 557056
    buffer_load_dwordx4 v41, s[8:11], s47 offen  lds
    s_add_u32 m0, s64, 18432
    s_add_u32 s47, s67, 589824
    buffer_load_dwordx4 v42, s[8:11], s47 offen  lds
    s_add_u32 m0, s64, 19456
    s_add_u32 s47, s67, 622592
    buffer_load_dwordx4 v43, s[8:11], s47 offen  lds
    s_waitcnt lgkmcnt(0)
    v_lshl_add_u32 v18, v17, 15, v12
    v_add_u32 v18, 32768, v18
    v_add_u32 v19, 65536, v18
    s_waitcnt vmcnt(16)
    s_barrier
    ds_read_b64_tr_b16 v[80:81], v18 offset:24576
    ds_read_b64_tr_b16 v[82:83], v18 offset:24832
    ds_read_b64_tr_b16 v[84:85], v19 offset:24576
    ds_read_b64_tr_b16 v[86:87], v19 offset:24832
    ds_read_b64_tr_b16 v[88:89], v18 offset:24608
    ds_read_b64_tr_b16 v[90:91], v18 offset:24864
    ds_read_b64_tr_b16 v[92:93], v19 offset:24608
    ds_read_b64_tr_b16 v[94:95], v19 offset:24864
    s_add_u32 m0, s64, 20480
    s_add_u32 s47, s67, 1048576
    buffer_load_dwordx4 v40, s[8:11], s47 offen  lds
    s_add_u32 m0, s64, 21504
    s_add_u32 s47, s67, 1081344
    buffer_load_dwordx4 v41, s[8:11], s47 offen  lds
    s_add_u32 m0, s64, 22528
    s_add_u32 s47, s67, 1114112
    buffer_load_dwordx4 v42, s[8:11], s47 offen  lds
    s_add_u32 m0, s64, 23552
    s_add_u32 s47, s67, 1146880
    buffer_load_dwordx4 v43, s[8:11], s47 offen  lds
    s_waitcnt lgkmcnt(0)
    v_lshl_add_u32 v18, v17, 15, v12
    v_add_u32 v18, 32768, v18
    v_add_u32 v19, 65536, v18
    s_waitcnt vmcnt(16)
    s_barrier
    ds_read_b64_tr_b16 v[152:153], v18 offset:4096
    ds_read_b64_tr_b16 v[154:155], v18 offset:4352
    ds_read_b64_tr_b16 v[156:157], v19 offset:4096
    ds_read_b64_tr_b16 v[158:159], v19 offset:4352
    ds_read_b64_tr_b16 v[160:161], v18 offset:4128
    ds_read_b64_tr_b16 v[162:163], v18 offset:4384
    ds_read_b64_tr_b16 v[164:165], v19 offset:4128
    ds_read_b64_tr_b16 v[166:167], v19 offset:4384
    s_add_u32 m0, s64, 24576
    s_add_u32 s47, s67, 1572864
    buffer_load_dwordx4 v40, s[8:11], s47 offen  lds
    s_add_u32 m0, s64, 25600
    s_add_u32 s47, s67, 1605632
    buffer_load_dwordx4 v41, s[8:11], s47 offen  lds
    s_add_u32 m0, s64, 26624
    s_add_u32 s47, s67, 1638400
    buffer_load_dwordx4 v42, s[8:11], s47 offen  lds
    s_add_u32 m0, s64, 27648
    s_add_u32 s47, s67, 1671168
    buffer_load_dwordx4 v43, s[8:11], s47 offen  lds
    s_waitcnt lgkmcnt(0)
    v_lshl_add_u32 v18, v17, 15, v12
    v_add_u32 v18, 32768, v18
    v_add_u32 v19, 65536, v18
    s_waitcnt vmcnt(16)
    s_barrier
    ds_read_b64_tr_b16 v[192:193], v18 offset:8192
    ds_read_b64_tr_b16 v[194:195], v18 offset:8448
    ds_read_b64_tr_b16 v[196:197], v19 offset:8192
    ds_read_b64_tr_b16 v[198:199], v19 offset:8448
    ds_read_b64_tr_b16 v[200:201], v18 offset:8224
    ds_read_b64_tr_b16 v[202:203], v18 offset:8480
    ds_read_b64_tr_b16 v[204:205], v19 offset:8224
    ds_read_b64_tr_b16 v[206:207], v19 offset:8480
    s_add_u32 m0, s64, 4096
    s_add_u32 s47, s67, 2097152
    buffer_load_dwordx4 v40, s[8:11], s47 offen  lds
    s_add_u32 m0, s64, 5120
    s_add_u32 s47, s67, 2129920
    buffer_load_dwordx4 v41, s[8:11], s47 offen  lds
    s_add_u32 m0, s64, 6144
    s_add_u32 s47, s67, 2162688
    buffer_load_dwordx4 v42, s[8:11], s47 offen  lds
    s_add_u32 m0, s64, 7168
    s_add_u32 s47, s67, 2195456
    buffer_load_dwordx4 v43, s[8:11], s47 offen  lds
    s_waitcnt lgkmcnt(0)
    v_lshl_add_u32 v18, v17, 15, v12
    v_add_u32 v18, 32768, v18
    v_add_u32 v19, 65536, v18
    s_waitcnt vmcnt(16)
    s_barrier
    ds_read_b64_tr_b16 v[248:249], v18 offset:12288
    ds_read_b64_tr_b16 v[250:251], v18 offset:12544
    ds_read_b64_tr_b16 v[252:253], v19 offset:12288
    ds_read_b64_tr_b16 v[254:255], v19 offset:12544
    ds_read_b64_tr_b16 a[0:1], v18 offset:12320
    ds_read_b64_tr_b16 a[2:3], v18 offset:12576
    ds_read_b64_tr_b16 a[4:5], v19 offset:12320
    ds_read_b64_tr_b16 a[6:7], v19 offset:12576
    s_add_u32 m0, s64, 8192
    s_add_u32 s47, s66, 524288
    buffer_load_dwordx4 v40, s[12:15], s47 offen  lds
    s_add_u32 m0, s64, 9216
    s_add_u32 s47, s66, 557056
    buffer_load_dwordx4 v41, s[12:15], s47 offen  lds
    s_add_u32 m0, s64, 10240
    s_add_u32 s47, s66, 589824
    buffer_load_dwordx4 v42, s[12:15], s47 offen  lds
    s_add_u32 m0, s64, 11264
    s_add_u32 s47, s66, 622592
    buffer_load_dwordx4 v43, s[12:15], s47 offen  lds
    s_waitcnt lgkmcnt(0)
    v_lshl_add_u32 v18, v17, 15, v12
    v_add_u32 v18, 32768, v18
    v_add_u32 v19, 65536, v18
    s_waitcnt vmcnt(16)
    s_barrier
    ds_read_b64_tr_b16 a[16:17], v18 offset:16384
    ds_read_b64_tr_b16 a[18:19], v18 offset:16640
    ds_read_b64_tr_b16 a[20:21], v19 offset:16384
    ds_read_b64_tr_b16 a[22:23], v19 offset:16640
    ds_read_b64_tr_b16 a[24:25], v18 offset:16416
    ds_read_b64_tr_b16 a[26:27], v18 offset:16672
    ds_read_b64_tr_b16 a[28:29], v19 offset:16416
    ds_read_b64_tr_b16 a[30:31], v19 offset:16672
    s_add_u32 m0, s64, 12288
    s_add_u32 s47, s66, 1048576
    buffer_load_dwordx4 v40, s[12:15], s47 offen  lds
    s_add_u32 m0, s64, 13312
    s_add_u32 s47, s66, 1081344
    buffer_load_dwordx4 v41, s[12:15], s47 offen  lds
    s_add_u32 m0, s64, 14336
    s_add_u32 s47, s66, 1114112
    buffer_load_dwordx4 v42, s[12:15], s47 offen  lds
    s_add_u32 m0, s64, 15360
    s_add_u32 s47, s66, 1146880
    buffer_load_dwordx4 v43, s[12:15], s47 offen  lds
    s_waitcnt lgkmcnt(0)
    v_lshl_add_u32 v18, v17, 15, v12
    v_add_u32 v18, 32768, v18
    v_add_u32 v19, 65536, v18
    s_waitcnt vmcnt(16)
    s_barrier
    ds_read_b64_tr_b16 a[40:41], v18 offset:20480
    ds_read_b64_tr_b16 a[42:43], v18 offset:20736
    ds_read_b64_tr_b16 a[44:45], v19 offset:20480
    ds_read_b64_tr_b16 a[46:47], v19 offset:20736
    ds_read_b64_tr_b16 a[48:49], v18 offset:20512
    ds_read_b64_tr_b16 a[50:51], v18 offset:20768
    ds_read_b64_tr_b16 a[52:53], v19 offset:20512
    ds_read_b64_tr_b16 a[54:55], v19 offset:20768
    s_add_u32 m0, s64, 16384
    s_add_u32 s47, s66, 1572864
    buffer_load_dwordx4 v40, s[12:15], s47 offen  lds
    s_add_u32 m0, s64, 17408
    s_add_u32 s47, s66, 1605632
    buffer_load_dwordx4 v41, s[12:15], s47 offen  lds
    s_add_u32 m0, s64, 18432
    s_add_u32 s47, s66, 1638400
    buffer_load_dwordx4 v42, s[12:15], s47 offen  lds
    s_add_u32 m0, s64, 19456
    s_add_u32 s47, s66, 1671168
    buffer_load_dwordx4 v43, s[12:15], s47 offen  lds
    s_waitcnt lgkmcnt(0)
    v_lshl_add_u32 v18, v17, 15, v12
    v_add_u32 v18, 32768, v18
    v_add_u32 v19, 65536, v18
    s_waitcnt vmcnt(16)
    s_barrier
    ds_read_b64_tr_b16 a[80:81], v18 offset:24576
    ds_read_b64_tr_b16 a[82:83], v18 offset:24832
    ds_read_b64_tr_b16 a[84:85], v19 offset:24576
    ds_read_b64_tr_b16 a[86:87], v19 offset:24832
    ds_read_b64_tr_b16 a[96:97], v18 offset:24608
    ds_read_b64_tr_b16 a[98:99], v18 offset:24864
    ds_read_b64_tr_b16 a[100:101], v19 offset:24608
    ds_read_b64_tr_b16 a[102:103], v19 offset:24864
    s_add_u32 m0, s64, 20480
    s_add_u32 s47, s66, 2097152
    buffer_load_dwordx4 v40, s[12:15], s47 offen  lds
    s_add_u32 m0, s64, 21504
    s_add_u32 s47, s66, 2129920
    buffer_load_dwordx4 v41, s[12:15], s47 offen  lds
    s_add_u32 m0, s64, 22528
    s_add_u32 s47, s66, 2162688
    buffer_load_dwordx4 v42, s[12:15], s47 offen  lds
    s_add_u32 m0, s64, 23552
    s_add_u32 s47, s66, 2195456
    buffer_load_dwordx4 v43, s[12:15], s47 offen  lds
    s_waitcnt lgkmcnt(0)
    v_lshl_add_u32 v18, v17, 15, v13
    v_add_u32 v18, 32768, v18
    v_add_u32 v19, 65536, v18
    s_waitcnt vmcnt(16)
    s_barrier
    ds_read_b64_tr_b16 a[88:89], v18 offset:4096
    ds_read_b64_tr_b16 a[90:91], v18 offset:4608
    ds_read_b64_tr_b16 a[92:93], v19 offset:4096
    ds_read_b64_tr_b16 a[94:95], v19 offset:4608
    ds_read_b64_tr_b16 a[104:105], v18 offset:4128
    ds_read_b64_tr_b16 a[106:107], v18 offset:4640
    ds_read_b64_tr_b16 a[108:109], v19 offset:4128
    ds_read_b64_tr_b16 a[110:111], v19 offset:4640
    s_add_u32 m0, s64, 24576
    s_add_u32 s47, s67, 0
    buffer_load_dwordx4 v40, s[12:15], s47 offen  lds
    s_add_u32 m0, s64, 25600
    s_add_u32 s47, s67, 32768
    buffer_load_dwordx4 v41, s[12:15], s47 offen  lds
    s_add_u32 m0, s64, 26624
    s_add_u32 s47, s67, 65536
    buffer_load_dwordx4 v42, s[12:15], s47 offen  lds
    s_add_u32 m0, s64, 27648
    s_add_u32 s47, s67, 98304
    buffer_load_dwordx4 v43, s[12:15], s47 offen  lds
    s_waitcnt lgkmcnt(0)
    v_lshl_add_u32 v18, v17, 15, v12
    v_add_u32 v18, 32768, v18
    v_add_u32 v19, 65536, v18
    s_waitcnt vmcnt(16)
    s_barrier
    ds_read_b64_tr_b16 v[128:129], v18 offset:8192
    ds_read_b64_tr_b16 v[130:131], v18 offset:8448
    ds_read_b64_tr_b16 v[132:133], v19 offset:8192
    ds_read_b64_tr_b16 v[134:135], v19 offset:8448
    ds_read_b64_tr_b16 v[136:137], v18 offset:8224
    ds_read_b64_tr_b16 v[138:139], v18 offset:8480
    ds_read_b64_tr_b16 v[140:141], v19 offset:8224
    ds_read_b64_tr_b16 v[142:143], v19 offset:8480
    s_add_u32 m0, s64, 4096
    s_add_u32 s47, s67, 524288
    buffer_load_dwordx4 v40, s[12:15], s47 offen  lds
    s_add_u32 m0, s64, 5120
    s_add_u32 s47, s67, 557056
    buffer_load_dwordx4 v41, s[12:15], s47 offen  lds
    s_add_u32 m0, s64, 6144
    s_add_u32 s47, s67, 589824
    buffer_load_dwordx4 v42, s[12:15], s47 offen  lds
    s_add_u32 m0, s64, 7168
    s_add_u32 s47, s67, 622592
    buffer_load_dwordx4 v43, s[12:15], s47 offen  lds
    s_waitcnt lgkmcnt(0)
    v_lshl_add_u32 v18, v17, 15, v12
    v_add_u32 v18, 32768, v18
    v_add_u32 v19, 65536, v18
    s_waitcnt vmcnt(16)
    s_barrier
    ds_read_b64_tr_b16 v[168:169], v18 offset:12288
    ds_read_b64_tr_b16 v[170:171], v18 offset:12544
    ds_read_b64_tr_b16 v[172:173], v19 offset:12288
    ds_read_b64_tr_b16 v[174:175], v19 offset:12544
    ds_read_b64_tr_b16 v[176:177], v18 offset:12320
    ds_read_b64_tr_b16 v[178:179], v18 offset:12576
    ds_read_b64_tr_b16 v[180:181], v19 offset:12320
    ds_read_b64_tr_b16 v[182:183], v19 offset:12576
    s_add_u32 m0, s64, 8192
    s_add_u32 s47, s67, 1048576
    buffer_load_dwordx4 v40, s[12:15], s47 offen  lds
    s_add_u32 m0, s64, 9216
    s_add_u32 s47, s67, 1081344
    buffer_load_dwordx4 v41, s[12:15], s47 offen  lds
    s_add_u32 m0, s64, 10240
    s_add_u32 s47, s67, 1114112
    buffer_load_dwordx4 v42, s[12:15], s47 offen  lds
    s_add_u32 m0, s64, 11264
    s_add_u32 s47, s67, 1146880
    buffer_load_dwordx4 v43, s[12:15], s47 offen  lds
    s_waitcnt lgkmcnt(0)
    v_lshl_add_u32 v18, v17, 15, v12
    v_add_u32 v18, 32768, v18
    v_add_u32 v19, 65536, v18
    s_waitcnt vmcnt(16)
    s_barrier
    ds_read_b64_tr_b16 a[112:113], v18 offset:16384
    ds_read_b64_tr_b16 a[114:115], v18 offset:16640
    ds_read_b64_tr_b16 a[116:117], v19 offset:16384
    ds_read_b64_tr_b16 a[118:119], v19 offset:16640
    ds_read_b64_tr_b16 a[120:121], v18 offset:16416
    ds_read_b64_tr_b16 a[122:123], v18 offset:16672
    ds_read_b64_tr_b16 a[124:125], v19 offset:16416
    ds_read_b64_tr_b16 a[126:127], v19 offset:16672
    s_add_u32 m0, s64, 12288
    s_add_u32 s47, s67, 1572864
    buffer_load_dwordx4 v40, s[12:15], s47 offen  lds
    s_add_u32 m0, s64, 13312
    s_add_u32 s47, s67, 1605632
    buffer_load_dwordx4 v41, s[12:15], s47 offen  lds
    s_add_u32 m0, s64, 14336
    s_add_u32 s47, s67, 1638400
    buffer_load_dwordx4 v42, s[12:15], s47 offen  lds
    s_add_u32 m0, s64, 15360
    s_add_u32 s47, s67, 1671168
    buffer_load_dwordx4 v43, s[12:15], s47 offen  lds
    s_waitcnt lgkmcnt(0)
    v_lshl_add_u32 v18, v17, 15, v13
    v_add_u32 v18, 32768, v18
    v_add_u32 v19, 65536, v18
    s_waitcnt vmcnt(16)
    s_barrier
    ds_read_b64_tr_b16 a[128:129], v18 offset:20480
    ds_read_b64_tr_b16 a[130:131], v18 offset:20992
    ds_read_b64_tr_b16 a[132:133], v19 offset:20480
    ds_read_b64_tr_b16 a[134:135], v19 offset:20992
    ds_read_b64_tr_b16 a[136:137], v18 offset:20512
    ds_read_b64_tr_b16 a[138:139], v18 offset:21024
    ds_read_b64_tr_b16 a[140:141], v19 offset:20512
    ds_read_b64_tr_b16 a[142:143], v19 offset:21024
    s_add_u32 m0, s64, 16384
    s_add_u32 s47, s67, 2097152
    buffer_load_dwordx4 v40, s[12:15], s47 offen  lds
    s_add_u32 m0, s64, 17408
    s_add_u32 s47, s67, 2129920
    buffer_load_dwordx4 v41, s[12:15], s47 offen  lds
    s_add_u32 m0, s64, 18432
    s_add_u32 s47, s67, 2162688
    buffer_load_dwordx4 v42, s[12:15], s47 offen  lds
    s_add_u32 m0, s64, 19456
    s_add_u32 s47, s67, 2195456
    buffer_load_dwordx4 v43, s[12:15], s47 offen  lds
    s_waitcnt lgkmcnt(0)
    v_lshl_add_u32 v18, v17, 15, v12
    v_add_u32 v18, 32768, v18
    v_add_u32 v19, 65536, v18
    s_waitcnt vmcnt(16)
    s_barrier
    ds_read_b64_tr_b16 a[144:145], v18 offset:24576
    ds_read_b64_tr_b16 a[146:147], v18 offset:24832
    ds_read_b64_tr_b16 a[148:149], v19 offset:24576
    ds_read_b64_tr_b16 a[150:151], v19 offset:24832
    ds_read_b64_tr_b16 a[152:153], v18 offset:24608
    ds_read_b64_tr_b16 a[154:155], v18 offset:24864
    ds_read_b64_tr_b16 a[156:157], v19 offset:24608
    ds_read_b64_tr_b16 a[158:159], v19 offset:24864
    s_add_u32 m0, s64, 20480
    s_add_u32 s47, s68, 82176
    buffer_load_dwordx4 v44, s[24:27], s47 offen  lds
    s_add_u32 m0, s64, 21504
    s_add_u32 s47, s68, 87296
    buffer_load_dwordx4 v45, s[24:27], s47 offen  lds
    s_add_u32 m0, s64, 22528
    s_add_u32 s47, s68, 92416
    buffer_load_dwordx4 v46, s[24:27], s47 offen  lds
    s_add_u32 m0, s64, 23552
    s_add_u32 s47, s68, 97536
    buffer_load_dwordx4 v47, s[24:27], s47 offen  lds
    s_waitcnt lgkmcnt(0)
    v_lshl_add_u32 v18, v17, 15, v12
    v_add_u32 v18, 32768, v18
    v_add_u32 v19, 65536, v18
    s_waitcnt vmcnt(16)
    s_barrier
    ds_read_b64_tr_b16 a[160:161], v18 offset:4096
    ds_read_b64_tr_b16 a[162:163], v18 offset:4352
    ds_read_b64_tr_b16 a[164:165], v19 offset:4096
    ds_read_b64_tr_b16 a[166:167], v19 offset:4352
    ds_read_b64_tr_b16 a[168:169], v18 offset:4128
    ds_read_b64_tr_b16 a[170:171], v18 offset:4384
    ds_read_b64_tr_b16 a[172:173], v19 offset:4128
    ds_read_b64_tr_b16 a[174:175], v19 offset:4384
    s_add_u32 m0, s64, 24576
    s_add_u32 s47, s66, 0
    buffer_load_dwordx4 v40, s[12:15], s47 offen  lds
    s_add_u32 m0, s64, 25600
    s_add_u32 s47, s66, 32768
    buffer_load_dwordx4 v41, s[12:15], s47 offen  lds
    s_add_u32 m0, s64, 26624
    s_add_u32 s47, s66, 65536
    buffer_load_dwordx4 v42, s[12:15], s47 offen  lds
    s_add_u32 m0, s64, 27648
    s_add_u32 s47, s66, 98304
    buffer_load_dwordx4 v43, s[12:15], s47 offen  lds
    s_waitcnt lgkmcnt(0)
    v_lshl_add_u32 v18, v17, 15, v12
    v_add_u32 v18, 32768, v18
    v_add_u32 v19, 65536, v18
    s_waitcnt vmcnt(16)
    s_barrier
    ds_read_b64_tr_b16 a[176:177], v18 offset:8192
    ds_read_b64_tr_b16 a[178:179], v18 offset:8448
    ds_read_b64_tr_b16 a[180:181], v19 offset:8192
    ds_read_b64_tr_b16 a[182:183], v19 offset:8448
    ds_read_b64_tr_b16 a[184:185], v18 offset:8224
    ds_read_b64_tr_b16 a[186:187], v18 offset:8480
    ds_read_b64_tr_b16 a[188:189], v19 offset:8224
    ds_read_b64_tr_b16 a[190:191], v19 offset:8480
    s_add_u32 m0, s64, 28672
    s_add_u32 s47, s66, 524288
    buffer_load_dwordx4 v40, s[8:11], s47 offen  lds
    s_add_u32 m0, s64, 29696
    s_add_u32 s47, s66, 557056
    buffer_load_dwordx4 v41, s[8:11], s47 offen  lds
    s_add_u32 m0, s64, 30720
    s_add_u32 s47, s66, 589824
    buffer_load_dwordx4 v42, s[8:11], s47 offen  lds
    s_add_u32 m0, s64, 31744
    s_add_u32 s47, s66, 622592
    buffer_load_dwordx4 v43, s[8:11], s47 offen  lds
    s_waitcnt lgkmcnt(0)
    v_lshl_add_u32 v18, v17, 15, v12
    v_add_u32 v18, 32768, v18
    v_add_u32 v19, 65536, v18
    s_waitcnt vmcnt(16)
    s_barrier
    ds_read_b64_tr_b16 a[192:193], v18 offset:12288
    ds_read_b64_tr_b16 a[194:195], v18 offset:12544
    ds_read_b64_tr_b16 a[196:197], v19 offset:12288
    ds_read_b64_tr_b16 a[198:199], v19 offset:12544
    ds_read_b64_tr_b16 a[200:201], v18 offset:12320
    ds_read_b64_tr_b16 a[202:203], v18 offset:12576
    ds_read_b64_tr_b16 a[204:205], v19 offset:12320
    ds_read_b64_tr_b16 a[206:207], v19 offset:12576
    s_add_u32 m0, s70, 0
    s_add_u32 s47, s66, 1048576
    buffer_load_dwordx4 v40, s[4:7], s47 offen  lds
    s_add_u32 m0, s70, 1024
    s_add_u32 s47, s66, 1081344
    buffer_load_dwordx4 v41, s[4:7], s47 offen  lds
    s_add_u32 m0, s70, 2048
    s_add_u32 s47, s66, 1114112
    buffer_load_dwordx4 v42, s[4:7], s47 offen  lds
    s_add_u32 m0, s70, 3072
    s_add_u32 s47, s66, 1146880
    buffer_load_dwordx4 v43, s[4:7], s47 offen  lds
    s_waitcnt lgkmcnt(0)
    v_lshl_add_u32 v18, v17, 15, v13
    v_add_u32 v18, 32768, v18
    v_add_u32 v19, 65536, v18
    s_waitcnt vmcnt(16)
    s_barrier
    ds_read_b64_tr_b16 a[208:209], v18 offset:16384
    ds_read_b64_tr_b16 a[210:211], v18 offset:16896
    ds_read_b64_tr_b16 a[212:213], v19 offset:16384
    ds_read_b64_tr_b16 a[214:215], v19 offset:16896
    ds_read_b64_tr_b16 a[216:217], v18 offset:16416
    ds_read_b64_tr_b16 a[218:219], v18 offset:16928
    ds_read_b64_tr_b16 a[220:221], v19 offset:16416
    ds_read_b64_tr_b16 a[222:223], v19 offset:16928
    s_add_u32 m0, s64, 12288
    s_add_u32 s47, s66, 1572864
    buffer_load_dwordx4 v40, s[4:7], s47 offen  lds
    s_add_u32 m0, s64, 13312
    s_add_u32 s47, s66, 1605632
    buffer_load_dwordx4 v41, s[4:7], s47 offen  lds
    s_add_u32 m0, s64, 14336
    s_add_u32 s47, s66, 1638400
    buffer_load_dwordx4 v42, s[4:7], s47 offen  lds
    s_add_u32 m0, s64, 15360
    s_add_u32 s47, s66, 1671168
    buffer_load_dwordx4 v43, s[4:7], s47 offen  lds
    s_waitcnt lgkmcnt(0)
    v_lshl_add_u32 v18, v16, 15, v14
    v_add_u32 v18, 32768, v18
    v_add_u32 v19, 65536, v18
    s_waitcnt vmcnt(16)
    s_barrier
    ds_read_b64_tr_b16 a[240:241], v18 offset:20480
    ds_read_b64_tr_b16 a[242:243], v18 offset:20992
    ds_read_b64_tr_b16 a[244:245], v19 offset:20480
    ds_read_b64_tr_b16 a[246:247], v19 offset:20992
    ds_read_b64_tr_b16 a[248:249], v18 offset:20488
    ds_read_b64_tr_b16 a[250:251], v18 offset:21000
    ds_read_b64_tr_b16 a[252:253], v19 offset:20488
    ds_read_b64_tr_b16 a[254:255], v19 offset:21000
    s_add_u32 m0, s64, 16384
    s_add_u32 s47, s66, 2097152
    buffer_load_dwordx4 v40, s[8:11], s47 offen  lds
    s_add_u32 m0, s64, 17408
    s_add_u32 s47, s66, 2129920
    buffer_load_dwordx4 v41, s[8:11], s47 offen  lds
    s_add_u32 m0, s64, 18432
    s_add_u32 s47, s66, 2162688
    buffer_load_dwordx4 v42, s[8:11], s47 offen  lds
    s_add_u32 m0, s64, 19456
    s_add_u32 s47, s66, 2195456
    buffer_load_dwordx4 v43, s[8:11], s47 offen  lds
    s_waitcnt lgkmcnt(0)
    v_lshl_add_u32 v18, v17, 15, v12
    v_add_u32 v18, 32768, v18
    v_add_u32 v19, 65536, v18
    s_waitcnt vmcnt(16)
    s_barrier
    ds_read_b64_tr_b16 v[24:25], v18 offset:24576
    ds_read_b64_tr_b16 v[26:27], v18 offset:24832
    ds_read_b64_tr_b16 v[28:29], v19 offset:24576
    ds_read_b64_tr_b16 v[30:31], v19 offset:24832
    ds_read_b64_tr_b16 v[96:97], v18 offset:24608
    ds_read_b64_tr_b16 v[98:99], v18 offset:24864
    ds_read_b64_tr_b16 v[100:101], v19 offset:24608
    ds_read_b64_tr_b16 v[102:103], v19 offset:24864
    s_add_u32 m0, s64, 20480
    s_add_u32 s47, s67, 524288
    buffer_load_dwordx4 v40, s[4:7], s47 offen  lds
    s_add_u32 m0, s64, 21504
    s_add_u32 s47, s67, 557056
    buffer_load_dwordx4 v41, s[4:7], s47 offen  lds
    s_add_u32 m0, s64, 22528
    s_add_u32 s47, s67, 589824
    buffer_load_dwordx4 v42, s[4:7], s47 offen  lds
    s_add_u32 m0, s64, 23552
    s_add_u32 s47, s67, 622592
    buffer_load_dwordx4 v43, s[4:7], s47 offen  lds
    s_waitcnt lgkmcnt(6)
    ds_write_b128 v1, v[24:27] offset:4096
    s_waitcnt lgkmcnt(5)
    ds_write_b128 v1, v[28:31] offset:5120
    s_waitcnt lgkmcnt(0)
    v_lshl_add_u32 v18, v17, 15, v12
    v_add_u32 v18, 32768, v18
    v_add_u32 v19, 65536, v18
    s_waitcnt vmcnt(16)
    s_barrier
    ds_read_b64_tr_b16 v[24:25], v18 offset:28672
    ds_read_b64_tr_b16 v[26:27], v18 offset:28928
    ds_read_b64_tr_b16 v[28:29], v19 offset:28672
    ds_read_b64_tr_b16 v[30:31], v19 offset:28928
    ds_read_b64_tr_b16 v[120:121], v18 offset:28704
    ds_read_b64_tr_b16 v[122:123], v18 offset:28960
    ds_read_b64_tr_b16 v[124:125], v19 offset:28704
    ds_read_b64_tr_b16 v[126:127], v19 offset:28960
    s_add_u32 m0, s64, 24576
    s_add_u32 s47, s67, 1048576
    buffer_load_dwordx4 v40, s[4:7], s47 offen  lds
    s_add_u32 m0, s64, 25600
    s_add_u32 s47, s67, 1081344
    buffer_load_dwordx4 v41, s[4:7], s47 offen  lds
    s_add_u32 m0, s64, 26624
    s_add_u32 s47, s67, 1114112
    buffer_load_dwordx4 v42, s[4:7], s47 offen  lds
    s_add_u32 m0, s64, 27648
    s_add_u32 s47, s67, 1146880
    buffer_load_dwordx4 v43, s[4:7], s47 offen  lds
    s_waitcnt lgkmcnt(6)
    ds_write_b128 v1, v[24:27] offset:6144
    s_waitcnt lgkmcnt(5)
    ds_write_b128 v1, v[28:31] offset:7168
    s_waitcnt lgkmcnt(0)
    v_lshl_add_u32 v18, v17, 13, v12
    v_add_u32 v18, 0, v18
    v_add_u32 v19, 16384, v18
    s_waitcnt vmcnt(16)
    s_barrier
    ds_read_b64_tr_b16 v[144:145], v18 offset:0
    ds_read_b64_tr_b16 v[146:147], v18 offset:256
    ds_read_b64_tr_b16 v[148:149], v19 offset:0
    ds_read_b64_tr_b16 v[150:151], v19 offset:256
    ds_read_b64_tr_b16 v[32:33], v18 offset:32
    ds_read_b64_tr_b16 v[34:35], v18 offset:288
    ds_read_b64_tr_b16 v[36:37], v19 offset:32
    ds_read_b64_tr_b16 v[38:39], v19 offset:288
    s_add_u32 m0, s64, 28672
    s_add_u32 s47, s67, 1572864
    buffer_load_dwordx4 v40, s[4:7], s47 offen  lds
    s_add_u32 m0, s64, 29696
    s_add_u32 s47, s67, 1605632
    buffer_load_dwordx4 v41, s[4:7], s47 offen  lds
    s_add_u32 m0, s64, 30720
    s_add_u32 s47, s67, 1638400
    buffer_load_dwordx4 v42, s[4:7], s47 offen  lds
    s_add_u32 m0, s64, 31744
    s_add_u32 s47, s67, 1671168
    buffer_load_dwordx4 v43, s[4:7], s47 offen  lds
    s_waitcnt lgkmcnt(2)
    ds_write_b128 v1, v[32:35] offset:8192
    s_waitcnt lgkmcnt(1)
    ds_write_b128 v1, v[36:39] offset:9216
    s_waitcnt lgkmcnt(0)
    v_lshl_add_u32 v18, v17, 15, v12
    v_add_u32 v18, 32768, v18
    v_add_u32 v19, 65536, v18
    s_waitcnt vmcnt(16)
    s_barrier
    ds_read_b64_tr_b16 v[24:25], v18 offset:12288
    ds_read_b64_tr_b16 v[26:27], v18 offset:12544
    ds_read_b64_tr_b16 v[28:29], v19 offset:12288
    ds_read_b64_tr_b16 v[30:31], v19 offset:12544
    ds_read_b64_tr_b16 v[184:185], v18 offset:12320
    ds_read_b64_tr_b16 v[186:187], v18 offset:12576
    ds_read_b64_tr_b16 v[188:189], v19 offset:12320
    ds_read_b64_tr_b16 v[190:191], v19 offset:12576
    s_add_u32 m0, s70, 4096
    s_add_u32 s47, s68, 81920
    buffer_load_dwordx4 v44, s[24:27], s47 offen  lds
    s_add_u32 m0, s70, 5120
    s_add_u32 s47, s68, 87040
    buffer_load_dwordx4 v45, s[24:27], s47 offen  lds
    s_add_u32 m0, s70, 6144
    s_add_u32 s47, s68, 92160
    buffer_load_dwordx4 v46, s[24:27], s47 offen  lds
    s_add_u32 m0, s70, 7168
    s_add_u32 s47, s68, 97280
    buffer_load_dwordx4 v47, s[24:27], s47 offen  lds
    s_waitcnt lgkmcnt(6)
    ds_write_b128 v1, v[24:27] offset:10240
    s_waitcnt lgkmcnt(5)
    ds_write_b128 v1, v[28:31] offset:11264
    s_waitcnt lgkmcnt(0)
    v_lshl_add_u32 v18, v17, 15, v13
    v_add_u32 v18, 32768, v18
    v_add_u32 v19, 65536, v18
    s_waitcnt vmcnt(16)
    s_barrier
    ds_read_b64_tr_b16 v[224:225], v18 offset:16384
    ds_read_b64_tr_b16 v[226:227], v18 offset:16896
    ds_read_b64_tr_b16 v[228:229], v19 offset:16384
    ds_read_b64_tr_b16 v[230:231], v19 offset:16896
    ds_read_b64_tr_b16 v[32:33], v18 offset:16416
    ds_read_b64_tr_b16 v[34:35], v18 offset:16928
    ds_read_b64_tr_b16 v[36:37], v19 offset:16416
    ds_read_b64_tr_b16 v[38:39], v19 offset:16928
    s_add_u32 m0, s64, 0
    s_add_u32 s47, s68, 0
    buffer_load_dwordx4 v44, s[24:27], s47 offen  lds
    s_add_u32 m0, s64, 1024
    s_add_u32 s47, s68, 5120
    buffer_load_dwordx4 v45, s[24:27], s47 offen  lds
    s_add_u32 m0, s64, 2048
    s_add_u32 s47, s68, 10240
    buffer_load_dwordx4 v46, s[24:27], s47 offen  lds
    s_add_u32 m0, s64, 3072
    s_add_u32 s47, s68, 15360
    buffer_load_dwordx4 v47, s[24:27], s47 offen  lds
    s_waitcnt lgkmcnt(2)
    ds_write_b128 v1, v[32:35] offset:12288
    s_waitcnt lgkmcnt(1)
    ds_write_b128 v1, v[36:39] offset:13312
    s_waitcnt lgkmcnt(0)
    v_lshl_add_u32 v18, v17, 15, v12
    v_add_u32 v18, 32768, v18
    v_add_u32 v19, 65536, v18
    s_waitcnt vmcnt(16)
    s_barrier
    ds_read_b64_tr_b16 v[24:25], v18 offset:20480
    ds_read_b64_tr_b16 v[26:27], v18 offset:20736
    ds_read_b64_tr_b16 v[28:29], v19 offset:20480
    ds_read_b64_tr_b16 v[30:31], v19 offset:20736
    ds_read_b64_tr_b16 a[8:9], v18 offset:20512
    ds_read_b64_tr_b16 a[10:11], v18 offset:20768
    ds_read_b64_tr_b16 a[12:13], v19 offset:20512
    ds_read_b64_tr_b16 a[14:15], v19 offset:20768
    s_add_u32 m0, s70, 0
    s_add_u32 s47, s68, 256
    buffer_load_dwordx4 v44, s[24:27], s47 offen  lds
    s_add_u32 m0, s70, 1024
    s_add_u32 s47, s68, 5376
    buffer_load_dwordx4 v45, s[24:27], s47 offen  lds
    s_add_u32 m0, s70, 2048
    s_add_u32 s47, s68, 10496
    buffer_load_dwordx4 v46, s[24:27], s47 offen  lds
    s_add_u32 m0, s70, 3072
    s_add_u32 s47, s68, 15616
    buffer_load_dwordx4 v47, s[24:27], s47 offen  lds
    s_waitcnt lgkmcnt(6)
    ds_write_b128 v1, v[24:27] offset:14336
    s_waitcnt lgkmcnt(5)
    ds_write_b128 v1, v[28:31] offset:15360
    s_waitcnt lgkmcnt(0)
    v_lshl_add_u32 v18, v17, 15, v12
    v_add_u32 v18, 32768, v18
    v_add_u32 v19, 65536, v18
    s_waitcnt vmcnt(16)
    s_barrier
    ds_read_b64_tr_b16 v[24:25], v18 offset:24576
    ds_read_b64_tr_b16 v[26:27], v18 offset:24832
    ds_read_b64_tr_b16 v[28:29], v19 offset:24576
    ds_read_b64_tr_b16 v[30:31], v19 offset:24832
    ds_read_b64_tr_b16 a[32:33], v18 offset:24608
    ds_read_b64_tr_b16 a[34:35], v18 offset:24864
    ds_read_b64_tr_b16 a[36:37], v19 offset:24608
    ds_read_b64_tr_b16 a[38:39], v19 offset:24864
    s_waitcnt lgkmcnt(6)
    ds_write_b128 v1, v[24:27] offset:16384
    s_waitcnt lgkmcnt(5)
    ds_write_b128 v1, v[28:31] offset:17408
    s_waitcnt lgkmcnt(0)
    v_lshl_add_u32 v18, v17, 15, v12
    v_add_u32 v18, 32768, v18
    v_add_u32 v19, 65536, v18
    s_waitcnt vmcnt(12)
    s_barrier
    ds_read_b64_tr_b16 a[56:57], v18 offset:28672
    ds_read_b64_tr_b16 a[58:59], v18 offset:28928
    ds_read_b64_tr_b16 a[60:61], v19 offset:28672
    ds_read_b64_tr_b16 a[62:63], v19 offset:28928
    ds_read_b64_tr_b16 v[32:33], v18 offset:28704
    ds_read_b64_tr_b16 v[34:35], v18 offset:28960
    ds_read_b64_tr_b16 v[36:37], v19 offset:28704
    ds_read_b64_tr_b16 v[38:39], v19 offset:28960
    s_waitcnt lgkmcnt(2)
    ds_write_b128 v1, v[32:35] offset:18432
    s_waitcnt lgkmcnt(1)
    ds_write_b128 v1, v[36:39] offset:19456
    s_waitcnt lgkmcnt(0)
    v_lshl_add_u32 v18, v16, 13, v14
    v_add_u32 v18, 0, v18
    v_add_u32 v19, 16384, v18
    s_waitcnt vmcnt(8)
    s_barrier
    ds_read_b64_tr_b16 v[24:25], v18 offset:4096
    ds_read_b64_tr_b16 v[26:27], v18 offset:4608
    ds_read_b64_tr_b16 v[28:29], v19 offset:4096
    ds_read_b64_tr_b16 v[30:31], v19 offset:4608
    ds_read_b64_tr_b16 a[224:225], v18 offset:4104
    ds_read_b64_tr_b16 a[226:227], v18 offset:4616
    ds_read_b64_tr_b16 a[228:229], v19 offset:4104
    ds_read_b64_tr_b16 a[230:231], v19 offset:4616
    s_waitcnt lgkmcnt(6)
    ds_write_b128 v1, v[24:27] offset:22528
    s_waitcnt lgkmcnt(5)
    ds_write_b128 v1, v[28:31] offset:23552
    s_waitcnt lgkmcnt(0)
    v_lshl_add_u32 v18, v16, 15, v14
    v_add_u32 v18, 32768, v18
    v_add_u32 v19, 65536, v18
    s_waitcnt vmcnt(4)
    s_barrier
    ds_read_b64_tr_b16 v[24:25], v18 offset:0
    ds_read_b64_tr_b16 v[26:27], v18 offset:512
    ds_read_b64_tr_b16 v[28:29], v19 offset:0
    ds_read_b64_tr_b16 v[30:31], v19 offset:512
    ds_read_b64_tr_b16 v[32:33], v18 offset:8
    ds_read_b64_tr_b16 v[34:35], v18 offset:520
    ds_read_b64_tr_b16 v[36:37], v19 offset:8
    ds_read_b64_tr_b16 v[38:39], v19 offset:520
    s_add_u32 m0, s70, 4096
    s_add_u32 s47, s69, 0
    buffer_load_dwordx4 v11, s[24:27], s47 offen  lds
    s_add_u32 m0, s70, 5120
    s_add_u32 s47, s69, 10240
    buffer_load_dwordx4 v11, s[24:27], s47 offen  lds
    s_add_u32 m0, s70, 6144
    s_add_u32 s47, s69, 20480
    buffer_load_dwordx4 v11, s[24:27], s47 offen  lds
    s_add_u32 m0, s70, 7168
    s_add_u32 s47, s69, 30720
    buffer_load_dwordx4 v11, s[24:27], s47 offen  lds
    s_waitcnt lgkmcnt(6)
    ds_write_b128 v1, v[24:27] offset:20480
    s_waitcnt lgkmcnt(5)
    ds_write_b128 v1, v[28:31] offset:21504
    s_waitcnt lgkmcnt(4)
    ds_write_b128 v1, v[32:35] offset:24576
    s_waitcnt lgkmcnt(3)
    ds_write_b128 v1, v[36:39] offset:25600
    s_waitcnt lgkmcnt(0)
    v_lshl_add_u32 v18, v16, 13, v14
    v_add_u32 v18, 0, v18
    v_add_u32 v19, 16384, v18
    s_waitcnt vmcnt(4)
    s_barrier
    ds_read_b64_tr_b16 a[232:233], v18 offset:0
    ds_read_b64_tr_b16 a[234:235], v18 offset:512
    ds_read_b64_tr_b16 a[236:237], v19 offset:0
    ds_read_b64_tr_b16 a[238:239], v19 offset:512
    ds_read_b64_tr_b16 v[32:33], v18 offset:8
    ds_read_b64_tr_b16 v[34:35], v18 offset:520
    ds_read_b64_tr_b16 v[36:37], v19 offset:8
    ds_read_b64_tr_b16 v[38:39], v19 offset:520
    s_waitcnt lgkmcnt(2)
    ds_write_b128 v1, v[32:35] offset:26624
    s_waitcnt lgkmcnt(1)
    ds_write_b128 v1, v[36:39] offset:27648
    s_waitcnt lgkmcnt(0)
    v_add_u32 v18, 0, v15
    v_add_u32 v19, 16384, v18
    s_waitcnt vmcnt(0)
    s_barrier
    ds_read_b64_tr_b16 v[24:25], v18 offset:4096
    ds_read_b64_tr_b16 v[26:27], v18 offset:4352
    ds_read_b64_tr_b16 v[28:29], v18 offset:12288
    ds_read_b64_tr_b16 v[30:31], v18 offset:12544
    ds_read_b64_tr_b16 v[32:33], v19 offset:4096
    ds_read_b64_tr_b16 v[34:35], v19 offset:4352
    ds_read_b64_tr_b16 v[36:37], v19 offset:12288
    ds_read_b64_tr_b16 v[38:39], v19 offset:12544
    s_waitcnt lgkmcnt(6)
    ds_write_b128 v1, v[24:27] offset:28672
    s_waitcnt lgkmcnt(5)
    ds_write_b128 v1, v[28:31] offset:29696
    s_waitcnt lgkmcnt(4)
    ds_write_b128 v1, v[32:35] offset:30720
    s_waitcnt lgkmcnt(3)
    ds_write_b128 v1, v[36:39] offset:31744
    s_waitcnt lgkmcnt(0)
    s_load_dwordx2 s[4:5], s[0:1], 88
    s_mov_b32 s6, 256
    s_mov_b32 s7, 0x20000
    s_load_dwordx2 s[8:9], s[0:1], 32
    s_mov_b32 s10, 10240
    s_mov_b32 s11, 0x20000
    s_waitcnt lgkmcnt(0)
    s_or_b32 s47, s19, s20
    s_or_b32 s47, s47, s21
    s_cmp_lg_u32 s47, 0
    s_cbranch_scc1 CH_np_6
    v_bfe_u32 v8, v0, 2, 6
    v_mov_b32 v9, -1
    s_mov_b32 s74, -1
    s_mov_b32 s75, -1
    s_mov_b32 s47, 2103296
    s_memtime s[66:67]
    s_waitcnt lgkmcnt(0)
    buffer_store_dword v9, v8, s[36:39], s47 offen sc1
    s_waitcnt vmcnt(0)
    s_memtime s[68:69]
    s_waitcnt lgkmcnt(0)
    s_sub_u32 s70, s68, s66
    s_min_u32 s74, s74, s70
    s_mov_b32 s47, 2111488
    s_memtime s[66:67]
    s_waitcnt lgkmcnt(0)
    buffer_store_dword v9, v8, s[36:39], s47 offen sc1
    s_waitcnt vmcnt(0)
    s_memtime s[68:69]
    s_waitcnt lgkmcnt(0)
    s_sub_u32 s70, s68, s66
    s_min_u32 s75, s75, s70
    s_mov_b32 s47, 2103296
    s_memtime s[66:67]
    s_waitcnt lgkmcnt(0)
    buffer_store_dword v9, v8, s[36:39], s47 offen sc1
    s_waitcnt vmcnt(0)
    s_memtime s[68:69]
    s_waitcnt lgkmcnt(0)
    s_sub_u32 s70, s68, s66
    s_min_u32 s74, s74, s70
    s_mov_b32 s47, 2111488
    s_memtime s[66:67]
    s_waitcnt lgkmcnt(0)
    buffer_store_dword v9, v8, s[36:39], s47 offen sc1
    s_waitcnt vmcnt(0)
    s_memtime s[68:69]
    s_waitcnt lgkmcnt(0)
    s_sub_u32 s70, s68, s66
    s_min_u32 s75, s75, s70
    s_mov_b32 s47, 2103296
    s_memtime s[66:67]
    s_waitcnt lgkmcnt(0)
    buffer_store_dword v9, v8, s[36:39], s47 offen sc1
    s_waitcnt vmcnt(0)
    s_memtime s[68:69]
    s_waitcnt lgkmcnt(0)
    s_sub_u32 s70, s68, s66
    s_min_u32 s74, s74, s70
    s_mov_b32 s47, 2111488
    s_memtime s[66:67]
    s_waitcnt lgkmcnt(0)
    buffer_store_dword v9, v8, s[36:39], s47 offen sc1
    s_waitcnt vmcnt(0)
    s_memtime s[68:69]
    s_waitcnt lgkmcnt(0)
    s_sub_u32 s70, s68, s66
    s_min_u32 s75, s75, s70
    s_mov_b32 s47, 2103296
    s_memtime s[66:67]
    s_waitcnt lgkmcnt(0)
    buffer_store_dword v9, v8, s[36:39], s47 offen sc1
    s_waitcnt vmcnt(0)
    s_memtime s[68:69]
    s_waitcnt lgkmcnt(0)
    s_sub_u32 s70, s68, s66
    s_min_u32 s74, s74, s70
    s_mov_b32 s47, 2111488
    s_memtime s[66:67]
    s_waitcnt lgkmcnt(0)
    buffer_store_dword v9, v8, s[36:39], s47 offen sc1
    s_waitcnt vmcnt(0)
    s_memtime s[68:69]
    s_waitcnt lgkmcnt(0)
    s_sub_u32 s70, s68, s66
    s_min_u32 s75, s75, s70
    s_cmp_lt_u32 s75, s74
    s_cselect_b32 s47, 3, 1
    v_mov_b32 v9, s47
    buffer_store_dword v9, off, s[4:7], 0 offset:4 sc1
CH_np_6:
    s_lshl_b32 s47, s19, 3
    v_mov_b32 v8, 132
    s_mov_b32 s49, 0
CP_7:
    buffer_load_dword v9, v8, s[4:7], s47 offen sc1
    s_waitcnt vmcnt(0)
    v_cmp_gt_u32 vcc, 2097152, v9
    s_cbranch_vccz CP_8
    s_add_u32 s49, s49, 1
    s_cmp_gt_u32 s49, 400000
    s_cbranch_scc1 L_end
    s_sleep 1
    s_branch CP_7
CP_8:
    buffer_load_dwordx2 v[8:9], off, s[4:7], s47 offset:128 sc1
    s_waitcnt vmcnt(0)
    v_readfirstlane_b32 s66, v8
    v_readfirstlane_b32 s67, v9
    s_nop 0
    s_lshr_b64 s[66:67], s[66:67], s101
    s_and_b32 s101, s66, 63
    v_mov_b32 v8, 4
    s_mov_b32 s49, 0
CP_9:
    buffer_load_dword v9, v8, s[4:7], 0 offen sc1
    s_waitcnt vmcnt(0)
    v_cmp_gt_u32 vcc, 1, v9
    s_cbranch_vccz CP_10
    s_add_u32 s49, s49, 1
    s_cmp_gt_u32 s49, 400000
    s_cbranch_scc1 L_end
    s_sleep 1
    s_branch CP_9
CP_10:
    v_readfirstlane_b32 s41, v9
    s_nop 0
    s_and_b32 s41, s41, 2
    s_lshl_b32 s41, s41, 12
    v_bfe_u32 v8, v0, 2, 3
    v_add_u32 v8, 8, v8
    s_mov_b32 s49, 0
CP_11:
    buffer_load_dword v9, v8, s[4:7], 0 offen sc1
    s_waitcnt vmcnt(0)
    v_cmp_gt_u32 vcc, 1, v9
    s_cbranch_vccz CP_12
    s_add_u32 s49, s49, 1
    s_cmp_gt_u32 s49, 400000
    s_cbranch_scc1 L_end
    s_sleep 1
    s_branch CP_11
CP_12:
    v_and_b32 v8, 511, v0
    v_lshlrev_b32 v8, 3, v8
    s_mov_b32 s47, 1241088
    s_mov_b32 s49, 0
CP_13:
    buffer_load_dword v9, v8, s[32:35], s47 offen sc1
    s_waitcnt vmcnt(0)
    v_cmp_gt_u32 vcc, 1, v9
    s_cbranch_vccz CP_14
    s_add_u32 s49, s49, 1
    s_cmp_gt_u32 s49, 400000
    s_cbranch_scc1 L_end
    s_sleep 1
    s_branch CP_13
CP_14:
    s_mul_i32 s47, s19, 196608
    s_add_u32 s47, s47, 65536
    s_add_u32 s28, s28, s47
    s_addc_u32 s29, s29, 0
    s_mul_i32 s98, s20, 768
    s_add_u32 s98, s98, 1146880
    s_lshl_b32 s47, s20, 1
    s_add_u32 s47, s47, s19
    s_lshl_b32 s47, s47, 7
    s_add_u32 s47, s47, 1220608
    s_cmp_eq_u32 s21, 0
    s_cselect_b32 s18, s47, 1073741824
    s_mov_b32 s100, 0
    s_barrier
CH_layer_15:
    s_mul_i32 s42, s100, 34603008
    s_add_u32 s42, s42, 117440512
    s_mul_i32 s50, s100, 4194304
    s_add_u32 s50, s50, 2097152
    s_mul_i32 s96, s100, 8388608
    s_add_u32 s96, s96, 100663296
    s_lshl_b32 s47, s20, 14
    s_lshl_b32 s48, s21, 11
    s_add_u32 s47, s47, s48
    s_add_u32 s42, s42, s47
    s_lshr_b32 s47, s47, 2
    s_add_u32 s96, s96, s47
    s_add_u32 s97, s96, 2048
    s_cmp_eq_u32 s19, 0
    s_cselect_b32 s96, s96, 1073741824
    s_cselect_b32 s97, 1073741824, s97
    s_lshl_b32 s47, s19, 14
    s_add_u32 s47, s47, s41
    s_add_u32 s50, s50, s47
    s_xor_b32 s90, s50, 0x4000
    s_sub_u32 s90, s90, 32768
    s_mov_b32 s40, 0
    s_mov_b32 s43, 163840
    s_lshl_b32 s99, s100, 6
    v_lshrrev_b32 v8, 4, v0
    s_lshl_b32 s47, s21, 7
    v_bfe_u32 v9, v8, 2, 2
    v_mul_u32_u24 v9, 2560, v9
    v_bfe_u32 v11, v8, 0, 1
    v_mul_u32_u24 v11, 1280, v11
    v_add_u32 v9, v9, v11
    v_bfe_u32 v11, v8, 4, 2
    v_lshl_add_u32 v9, v11, 5, v9
    v_bfe_u32 v11, v8, 1, 1
    v_lshl_add_u32 v9, v11, 4, v9
    v_add_u32 v9, s47, v9
    s_lshl_b32 s47, s21, 5
    s_add_u32 s47, s47, 512
    v_bfe_u32 v10, v8, 4, 2
    v_mul_u32_u24 v10, 2560, v10
    v_bfe_u32 v11, v8, 2, 1
    v_mul_u32_u24 v11, 1280, v11
    v_add_u32 v10, v10, v11
    v_bfe_u32 v11, v8, 3, 1
    v_lshl_add_u32 v10, v11, 4, v10
    v_bfe_u32 v11, v8, 0, 2
    v_lshl_add_u32 v10, v11, 2, v10
    v_add_u32 v10, s47, v10
    s_mov_b32 s66, 0x05040100
    s_mov_b32 s67, 0x07060302
    s_xor_b32 s47, s19, 0
    s_mul_i32 s47, s47, 640
    buffer_load_dwordx4 v[12:15], v9, s[8:11], s47 offen
    buffer_load_dword v28, v10, s[8:11], s47 offen
    s_waitcnt vmcnt(1)
    v_perm_b32 v24, v14, v12, s66
    v_perm_b32 v25, v14, v12, s67
    v_perm_b32 v26, v15, v13, s66
    v_perm_b32 v27, v15, v13, s67
    v_min_u32 v24, -2, v24
    v_min_u32 v26, -2, v26
    s_waitcnt vmcnt(0)
    v_min_u32 v28, -2, v28
    s_xor_b32 s47, s19, 1
    s_mul_i32 s47, s47, 640
    buffer_load_dwordx4 v[12:15], v9, s[8:11], s47 offen
    buffer_load_dword v60, v10, s[8:11], s47 offen
    s_waitcnt vmcnt(1)
    v_perm_b32 v56, v14, v12, s66
    v_perm_b32 v57, v14, v12, s67
    v_perm_b32 v58, v15, v13, s66
    v_perm_b32 v59, v15, v13, s67
    v_min_u32 v56, -2, v56
    v_min_u32 v58, -2, v58
    s_waitcnt vmcnt(0)
    v_min_u32 v60, -2, v60
    v_add_u32 v61, s92, v0
    v_lshrrev_b32 v62, 2, v0
    v_add_u32 v62, s93, v62
    ds_write_b128 v61, v[24:27] offset:0
    ds_write_b32 v62, v28 offset:0
    v_and_b32 v8, 0x180, v0
    s_add_u32 s47, s99, 2
    s_mov_b32 s49, 0
CP_16:
    buffer_load_dword v9, v8, s[32:35], s98 offen sc1
    s_waitcnt vmcnt(0)
    v_cmp_gt_u32 vcc, s47, v9
    s_cbranch_vccz CP_17
    s_add_u32 s49, s49, 1
    s_cmp_gt_u32 s49, 400000
    s_cbranch_scc1 L_end
    s_sleep 1
    s_branch CP_16
CP_17:
    s_add_u32 m0, s63, 0
    s_add_u32 s60, s42, 8192
    buffer_load_dwordx4 v0, s[32:35], s42 offen offset:0 sc1 lds
    buffer_load_dwordx4 v0, s[32:35], s42 offen offset:1024 sc1 lds
    s_add_u32 m0, s64, 0
    s_add_u32 s42, s42, 524288
    buffer_load_dwordx4 v0, s[32:35], s60 offen offset:0 sc1 lds
    buffer_load_dwordx4 v0, s[32:35], s60 offen offset:1024 sc1 lds
    s_mov_b32 m0, 15360
    s_mov_b32 exec_hi, 0
    buffer_load_dwordx4 v0, s[32:35], s98 offen offset:0 sc1 lds
    s_mov_b32 exec_hi, -1
    v_mov_b64 v[8:9], 0
    v_mov_b64 v[10:11], 0
    v_mov_b64 v[12:13], 0
    v_mov_b64 v[14:15], 0
    v_mov_b64 v[16:17], 0
    v_mov_b64 v[18:19], 0
    v_mov_b64 v[20:21], 0
    v_mov_b64 v[22:23], 0
    v_mov_b64 v[48:49], 0
    v_mov_b64 v[50:51], 0
    v_mov_b64 v[52:53], 0
    v_mov_b64 v[54:55], 0
    s_mov_b32 s49, 0
    s_waitcnt vmcnt(0) lgkmcnt(0)
    s_cmp_lg_u32 s101, 32
    s_cbranch_scc1 CH_slow_18
.p2align 6
CH_top_34:
    s_waitcnt lgkmcnt(0)
    s_barrier
    ds_read_b128 v[24:27], v0 offset:0
    ds_read_b128 v[28:31], v0 offset:1024
    ds_read_b128 v[32:35], v1 offset:4096
    ds_read_b128 v[36:39], v1 offset:5120
    s_waitcnt lgkmcnt(3)
    v_smfmac_f32_16x16x64_bf16 v[8:11], v[24:27], v[64:71], v2
    ds_read_b128 v[40:43], v1 offset:6144
    ds_read_b128 v[44:47], v1 offset:7168
    v_smfmac_f32_16x16x64_bf16 v[12:15], v[24:27], v[72:79], v2
    v_smfmac_f32_16x16x64_bf16 v[16:19], v[24:27], v[80:87], v2
    v_smfmac_f32_16x16x64_bf16 v[20:23], v[24:27], v[88:95], v2
    s_waitcnt lgkmcnt(2)
    v_smfmac_f32_16x16x64_bf16 v[48:51], v[24:27], v[32:39], v2
    ds_read_b128 v[32:35], v1 offset:8192
    ds_read_b128 v[36:39], v1 offset:9216
    v_smfmac_f32_16x16x64_bf16 v[52:55], v[24:27], v[96:103], v2
    ds_read_b128 v[24:27], v0 offset:2048
    v_smfmac_f32_16x16x64_bf16 v[8:11], v[28:31], v[104:111], v2
    v_smfmac_f32_16x16x64_bf16 v[12:15], v[28:31], v[112:119], v2
    s_waitcnt lgkmcnt(3)
    v_smfmac_f32_16x16x64_bf16 v[16:19], v[28:31], v[40:47], v2
    ds_read_b128 v[40:43], v1 offset:10240
    ds_read_b128 v[44:47], v1 offset:11264
    v_smfmac_f32_16x16x64_bf16 v[20:23], v[28:31], v[120:127], v2
    v_smfmac_f32_16x16x64_bf16 v[48:51], v[28:31], v[128:135], v2
    v_smfmac_f32_16x16x64_bf16 v[52:55], v[28:31], v[136:143], v2
    ds_read_b128 v[28:31], v0 offset:3072
    s_waitcnt lgkmcnt(3)
    v_smfmac_f32_16x16x64_bf16 v[8:11], v[24:27], v[144:151], v2
    v_smfmac_f32_16x16x64_bf16 v[12:15], v[24:27], v[32:39], v2
    ds_read_b128 v[32:35], v1 offset:12288
    ds_read_b128 v[36:39], v1 offset:13312
    v_smfmac_f32_16x16x64_bf16 v[16:19], v[24:27], v[152:159], v2
    v_smfmac_f32_16x16x64_bf16 v[20:23], v[24:27], v[160:167], v2
    v_smfmac_f32_16x16x64_bf16 v[48:51], v[24:27], v[168:175], v2
    s_waitcnt vmcnt(1)
    ds_write_b128 v61, v[56:59] offset:5120
    v_smfmac_f32_16x16x64_bf16 v[52:55], v[24:27], v[176:183], v2
    ds_read_b128 v[24:27], v0 offset:4096
    s_waitcnt vmcnt(0)
    ds_write_b32 v62, v60 offset:5120
    v_max3_u32 v63, v56, v58, v60
    s_waitcnt lgkmcnt(5)
    v_smfmac_f32_16x16x64_bf16 v[8:11], v[28:31], v[40:47], v2
    ds_read_b128 v[40:43], v1 offset:14336
    v_cmp_eq_u32 vcc, -1, v63
    v_smfmac_f32_16x16x64_bf16 v[12:15], v[28:31], v[184:191], v2
    ds_read_b128 v[44:47], v1 offset:15360
    v_smfmac_f32_16x16x64_bf16 v[16:19], v[28:31], v[192:199], v2
    s_cbranch_vccnz CH_re_36
CH_bk_37:
    v_smfmac_f32_16x16x64_bf16 v[20:23], v[28:31], v[200:207], v2
    s_waitcnt lgkmcnt(2)
    s_barrier
    ds_read_b128 v[28:31], v0 offset:5120
    v_smfmac_f32_16x16x64_bf16 v[8:11], v[24:27], v[208:215], v2
    s_add_u32 s48, s40, s99
    v_mov_b32 v56, s48
    v_smfmac_f32_16x16x64_bf16 v[12:15], v[24:27], v[216:223], v2
    buffer_store_dword v56, off, s[32:35], s18 sc1
    v_smfmac_f32_16x16x64_bf16 v[16:19], v[24:27], v[224:231], v2
    s_add_u32 m0, s63, 8192
    s_add_u32 s60, s42, 8192
    buffer_load_dwordx4 v0, s[32:35], s42 offen offset:0 sc1 lds
    v_smfmac_f32_16x16x64_bf16 v[20:23], v[24:27], v[32:39], v2
    ds_read_b128 v[24:27], v0 offset:6144
    ds_read_b128 v[32:35], v1 offset:16384
    s_waitcnt lgkmcnt(2)
    v_smfmac_f32_16x16x64_bf16 v[8:11], v[28:31], v[232:239], v2
    ds_read_b128 v[36:39], v1 offset:17408
    v_smfmac_f32_16x16x64_bf16 v[12:15], v[28:31], v[240:247], v2
    v_smfmac_f32_16x16x64_bf16 v[16:19], v[28:31], v[248:255], v2
    buffer_load_dwordx4 v0, s[32:35], s42 offen offset:1024 sc1 lds
    v_smfmac_f32_16x16x64_bf16 v[20:23], v[28:31], a[0:7], v2
    ds_read_b128 v[28:31], v0 offset:7168
    s_waitcnt lgkmcnt(3)
    v_smfmac_f32_16x16x64_bf16 v[8:11], v[24:27], v[40:47], v2
    ds_read_b128 v[40:43], v1 offset:18432
    ds_read_b128 v[44:47], v1 offset:19456
    v_smfmac_f32_16x16x64_bf16 v[12:15], v[24:27], a[8:15], v2
    v_smfmac_f32_16x16x64_bf16 v[16:19], v[24:27], a[16:23], v2
    s_add_u32 m0, s64, 2048
    s_add_u32 s42, s42, 524288
    buffer_load_dwordx4 v0, s[32:35], s60 offen offset:0 sc1 lds
    v_smfmac_f32_16x16x64_bf16 v[20:23], v[24:27], a[24:31], v2
    ds_read_b128 v[24:27], v0 offset:8192
    s_waitcnt lgkmcnt(3)
    v_smfmac_f32_16x16x64_bf16 v[8:11], v[28:31], v[32:39], v2
    ds_read_b128 v[32:35], v0 offset:9216
    v_smfmac_f32_16x16x64_bf16 v[12:15], v[28:31], a[32:39], v2
    v_smfmac_f32_16x16x64_bf16 v[16:19], v[28:31], a[40:47], v2
    buffer_load_dwordx4 v0, s[32:35], s60 offen offset:1024 sc1 lds
    v_smfmac_f32_16x16x64_bf16 v[20:23], v[28:31], a[48:55], v2
    ds_read_b128 v[28:31], v0 offset:3072
    s_waitcnt lgkmcnt(2)
    v_smfmac_f32_16x16x64_bf16 v[8:11], v[24:27], a[56:63], v2
    ds_read_b128 v[56:59], v0 offset:18432
    ds_read_b128 v[60:63], v0 offset:19456
    v_smfmac_f32_16x16x64_bf16 v[12:15], v[24:27], v[40:47], v2
    s_waitcnt lgkmcnt(3)
    v_smfmac_f32_16x16x64_bf16 v[8:11], v[32:35], a[64:71], v2
    ds_read_b128 v[40:43], v0 offset:16384
    ds_read_b128 v[44:47], v0 offset:17408
    v_smfmac_f32_16x16x64_bf16 v[12:15], v[32:35], a[72:79], v2
    s_mov_b32 m0, 15360
    s_mov_b32 exec_hi, 0
    buffer_load_dwordx4 v0, s[32:35], s98 offen offset:0 sc1 lds
    s_mov_b32 exec_hi, -1
    v_smfmac_f32_16x16x64_bf16 v[16:19], v[24:27], a[80:87], v2
    v_add_f32 v8, v8, v10
    v_smfmac_f32_16x16x64_bf16 v[16:19], v[32:35], a[88:95], v2
    v_add_f32 v9, v9, v11
    v_add_f32 v12, v12, v14
    v_smfmac_f32_16x16x64_bf16 v[20:23], v[24:27], a[96:103], v2
    ds_read_b128 v[24:27], v0 offset:4096
    v_add_f32 v13, v13, v15
    v_cvt_pk_bf16_f32 v8, v8, v9
    v_smfmac_f32_16x16x64_bf16 v[20:23], v[32:35], a[104:111], v2
    s_waitcnt lgkmcnt(5)
    ds_read_b128 v[32:35], v0 offset:5120
    v_cvt_pk_bf16_f32 v9, v12, v13
    v_add_f32 v16, v16, v18
    v_add_f32 v17, v17, v19
    v_smfmac_f32_16x16x64_bf16 v[48:51], v[28:31], a[112:119], v2
    ds_write_b64 v3, v[8:9]
    v_cvt_pk_bf16_f32 v10, v16, v17
    v_add_f32 v20, v20, v22
    v_add_f32 v21, v21, v23
    v_cvt_pk_bf16_f32 v11, v20, v21
    v_smfmac_f32_16x16x64_bf16 v[52:55], v[28:31], a[120:127], v2
    s_waitcnt lgkmcnt(2)
    ds_write_b64 v3, v[10:11] offset:2176
    v_smfmac_f32_16x16x64_bf16 v[48:51], v[24:27], a[128:135], v2
    ds_read_b128 v[28:31], v0 offset:6144
    v_lshrrev_b32 v12, 1, v0
    v_smfmac_f32_16x16x64_bf16 v[52:55], v[24:27], a[136:143], v2
    s_waitcnt lgkmcnt(3)
    ds_read_b128 v[24:27], v0 offset:7168
    v_permlane16_swap_b32 v10, v11
    v_smfmac_f32_16x16x64_bf16 v[48:51], v[32:35], a[144:151], v2
    buffer_store_dwordx2 v[10:11], v12, s[32:35], s96 offen sc1
    s_waitcnt lgkmcnt(2)
    s_barrier
    ds_read_b64_tr_b16 v[12:13], v4 offset:0
    ds_read_b64_tr_b16 v[14:15], v4 offset:32
    v_smfmac_f32_16x16x64_bf16 v[52:55], v[32:35], a[152:159], v2
    s_waitcnt lgkmcnt(3)
    ds_read_b64_tr_b16 v[16:17], v4 offset:1088
    ds_read_b64_tr_b16 v[18:19], v4 offset:1120
    ds_read_b64_tr_b16 v[20:21], v4 offset:2176
    v_smfmac_f32_16x16x64_bf16 v[48:51], v[28:31], a[160:167], v2
    ds_read_b64_tr_b16 v[22:23], v4 offset:2208
    ds_read_b64_tr_b16 v[36:37], v4 offset:3264
    ds_read_b64_tr_b16 v[38:39], v4 offset:3296
    v_smfmac_f32_16x16x64_bf16 v[52:55], v[28:31], a[168:175], v2
    s_waitcnt lgkmcnt(8)
    ds_read_b128 v[32:35], v0 offset:22528
    ds_read_b128 v[28:31], v0 offset:21504
    v_smfmac_f32_16x16x64_bf16 v[48:51], v[24:27], a[176:183], v2
    v_smfmac_f32_16x16x64_bf16 v[52:55], v[24:27], a[184:191], v2
    ds_read_b128 v[24:27], v0 offset:20480
    s_waitcnt lgkmcnt(9)
    v_mfma_f32_16x16x32_bf16 v[8:11], v[40:43], v[12:15], 0
    s_waitcnt lgkmcnt(7)
    v_mfma_f32_16x16x32_bf16 v[8:11], v[44:47], v[16:19], v[8:11]
    ds_read_b128 v[44:47], v0 offset:23552
    v_mfma_f32_16x16x32_bf16 v[40:43], v[56:59], v[12:15], 0
    v_mfma_f32_16x16x32_bf16 v[40:43], v[60:63], v[16:19], v[40:43]
    s_waitcnt lgkmcnt(6)
    ds_read_b128 v[60:63], v0 offset:8192
    v_add_f32_dpp v8, v10, v8 quad_perm:[2,3,2,3] row_mask:0xf bank_mask:0xf
    v_mfma_f32_16x16x32_bf16 v[56:59], v[20:23], v[12:15], 0
    s_waitcnt lgkmcnt(5)
    v_add_f32_dpp v9, v11, v9 quad_perm:[2,3,2,3] row_mask:0xf bank_mask:0xf
    v_max_f32 v10, v8, v9
    v_mfma_f32_16x16x32_bf16 v[56:59], v[36:39], v[16:19], v[56:59]
    s_waitcnt lgkmcnt(2)
    ds_read_b128 v[36:39], v0 offset:9216
    v_add_f32_dpp v40, v42, v40 quad_perm:[2,3,2,3] row_mask:0xf bank_mask:0xf
    v_mfma_f32_16x16x32_bf16 v[20:23], v[24:27], v[12:15], 0
    v_add_f32_dpp v41, v43, v41 quad_perm:[2,3,2,3] row_mask:0xf bank_mask:0xf
    v_max3_f32 v10, v10, v40, v41
    v_mfma_f32_16x16x32_bf16 v[20:23], v[28:31], v[16:19], v[20:23]
    v_add_f32_dpp v56, v58, v56 quad_perm:[2,3,2,3] row_mask:0xf bank_mask:0xf
    v_mfma_f32_16x16x32_bf16 v[24:27], v[32:35], v[12:15], 0
    s_waitcnt lgkmcnt(2)
    v_add_f32_dpp v57, v59, v57 quad_perm:[2,3,2,3] row_mask:0xf bank_mask:0xf
    v_max3_f32 v10, v10, v56, v57
    v_mfma_f32_16x16x32_bf16 v[24:27], v[44:47], v[16:19], v[24:27]
    s_waitcnt lgkmcnt(1)
    v_add_f32_dpp v20, v22, v20 quad_perm:[2,3,2,3] row_mask:0xf bank_mask:0xf
    v_add_f32_dpp v21, v23, v21 quad_perm:[2,3,2,3] row_mask:0xf bank_mask:0xf
    v_smfmac_f32_16x16x64_bf16 v[48:51], v[60:63], a[192:199], v2
    ds_read_b128 v[32:35], v1 offset:0
    v_max3_f32 v10, v10, v20, v21
    v_mov_b32 v17, 0
    s_nop 0
    v_add_f32_dpp v24, v26, v24 quad_perm:[2,3,2,3] row_mask:0xf bank_mask:0xf
    v_add_f32_dpp v25, v27, v25 quad_perm:[2,3,2,3] row_mask:0xf bank_mask:0xf
    v_max3_f32 v10, v10, v24, v25
    v_mov_b32 v11, v10
    v_smfmac_f32_16x16x64_bf16 v[52:55], v[60:63], a[200:207], v2
    s_waitcnt lgkmcnt(1)
    ds_read_b128 v[44:47], v1 offset:1024
    v_permlane32_swap_b32 v10, v11
    v_max_f32 v10, v10, v11
    v_mov_b32 v11, v10
    v_smfmac_f32_16x16x64_bf16 v[48:51], v[36:39], a[208:215], v2
    s_barrier
    v_permlane16_swap_b32 v10, v11
    v_max_f32 v10, v10, v11
    v_mul_f32 v10, s51, v10
    v_fma_f32 v8, v8, s51, -v10
    v_smfmac_f32_16x16x64_bf16 v[52:55], v[36:39], a[216:223], v2
    v_fma_f32 v9, v9, s51, -v10
    v_exp_f32 v8, v8
    v_fma_f32 v40, v40, s51, -v10
    v_exp_f32 v9, v9
    v_fma_f32 v41, v41, s51, -v10
    v_exp_f32 v40, v40
    v_cvt_pk_bf16_f32 v12, v8, v9
    v_fma_f32 v20, v20, s51, -v10
    v_exp_f32 v41, v41
    v_fma_f32 v21, v21, s51, -v10
    v_exp_f32 v20, v20
    v_cvt_pk_bf16_f32 v13, v40, v41
    v_fma_f32 v24, v24, s51, -v10
    v_exp_f32 v21, v21
    v_fma_f32 v25, v25, s51, -v10
    v_exp_f32 v24, v24
    v_cvt_pk_bf16_f32 v14, v20, v21
    v_fma_f32 v56, v56, s51, -v10
    v_exp_f32 v25, v25
    v_mov_b64 v[28:29], s[22:23]
    v_mov_b64 v[30:31], s[22:23]
    v_cvt_pk_bf16_f32 v15, v24, v25
    v_fma_f32 v57, v57, s51, -v10
    v_exp_f32 v56, v56
    v_mfma_f32_16x16x32_bf16 v[60:63], v[28:31], v[12:15], 0
    v_exp_f32 v57, v57
    s_waitcnt lgkmcnt(1)
    v_mfma_f32_16x16x32_bf16 v[32:35], v[32:35], v[12:15], 0
    v_cvt_pk_bf16_f32 v16, v56, v57
    v_add_f32 v48, v48, v50
    s_waitcnt lgkmcnt(0)
    v_mfma_f32_16x16x32_bf16 v[44:47], v[44:47], v[12:15], 0
    v_add_f32 v49, v49, v51
    v_add_f32 v52, v52, v54
    v_mfma_f32_16x16x16_bf16 v[60:63], v[28:29], v[16:17], v[60:63]
    v_add_f32 v53, v53, v55
    v_cvt_pk_bf16_f32 v22, v48, v49
    v_cvt_pk_bf16_f32 v23, v52, v53
    v_mov_b32 v18, 0
    v_mov_b32 v19, v16
    v_mfma_f32_16x16x16_bf16 v[32:35], v[22:23], v[16:17], v[32:35]
    ds_read_b128 v[48:51], v1 offset:20480
    ds_read_b128 v[52:55], v1 offset:21504
    v_mfma_f32_16x16x16_bf16 v[44:47], v[22:23], v[18:19], v[44:47]
    ds_read_b128 v[36:39], v1 offset:24576
    ds_read_b128 v[40:43], v1 offset:25600
    v_rcp_f32 v10, v60
    v_mov_b64 v[12:13], 0
    v_lshrrev_b32 v14, 1, v0
    v_permlane16_swap_b32 v22, v23
    v_pk_mul_f32 v[32:33], v[32:33], v[10:11] op_sel_hi:[1,0]
    v_pk_mul_f32 v[34:35], v[34:35], v[10:11] op_sel_hi:[1,0]
    v_cvt_pk_bf16_f32 v32, v32, v33
    v_cvt_pk_bf16_f32 v33, v34, v35
    v_pk_mul_f32 v[44:45], v[44:45], v[10:11] op_sel_hi:[1,0]
    v_pk_mul_f32 v[46:47], v[46:47], v[10:11] op_sel_hi:[1,0]
    v_cvt_pk_bf16_f32 v34, v44, v45
    v_cvt_pk_bf16_f32 v35, v46, v47
    v_mfma_f32_16x16x16_bf16 v[16:19], v[12:13], v[12:13], 0
    ds_write_b128 v5, v[32:35]
    buffer_store_dwordx2 v[22:23], v14, s[32:35], s97 offen sc1
    v_mfma_f32_16x16x16_bf16 v[20:23], v[12:13], v[12:13], 0
    ds_read_b128 v[56:59], v1 offset:22528
    ds_read_b128 v[60:63], v1 offset:23552
    v_mfma_f32_16x16x16_bf16 v[24:27], v[12:13], v[12:13], 0
    v_mfma_f32_16x16x16_bf16 v[28:31], v[12:13], v[12:13], 0
    v_mfma_f32_16x16x16_bf16 v[8:11], v[12:13], v[12:13], 0
    s_waitcnt lgkmcnt(2)
    s_barrier
    ds_read_b128 v[32:35], v0 offset:10240
    ds_read_b128 v[44:47], v0 offset:11264
    v_lshlrev_b32 v15, 3, v0
    v_bfe_u32 v14, v0, 2, 6
    v_and_or_b32 v14, v15, s94, v14
    s_waitcnt lgkmcnt(1)
    v_smfmac_f32_16x16x64_bf16 v[16:19], v[32:35], v[48:55], v2
    ds_read_b128 v[48:51], v1 offset:26624
    ds_read_b128 v[52:55], v1 offset:27648
    s_waitcnt lgkmcnt(2)
    v_smfmac_f32_16x16x64_bf16 v[16:19], v[44:47], v[56:63], v2
    ds_read_b128 v[56:59], v1 offset:28672
    ds_read_b128 v[60:63], v1 offset:29696
    v_smfmac_f32_16x16x64_bf16 v[20:23], v[32:35], v[36:43], v2
    ds_read_b128 v[36:39], v1 offset:30720
    ds_read_b128 v[40:43], v1 offset:31744
    v_smfmac_f32_16x16x64_bf16 v[20:23], v[44:47], a[224:231], v2
    v_add_f32 v16, v16, v18
    v_add_f32 v17, v17, v19
    v_smfmac_f32_16x16x64_bf16 v[24:27], v[32:35], a[232:239], v2
    v_smfmac_f32_16x16x64_bf16 v[24:27], v[44:47], a[240:247], v2
    s_waitcnt lgkmcnt(4)
    v_add_f32 v20, v20, v22
    v_add_f32 v21, v21, v23
    v_smfmac_f32_16x16x64_bf16 v[28:31], v[32:35], v[48:55], v2
    v_cvt_pk_bf16_f32 v16, v16, v20
    v_cvt_pk_bf16_f32 v17, v17, v21
    v_smfmac_f32_16x16x64_bf16 v[28:31], v[44:47], a[248:255], v2
    s_waitcnt lgkmcnt(2)
    v_and_or_b32 v16, v16, -2, 1
    v_smfmac_f32_16x16x64_bf16 v[8:11], v[32:35], v[56:63], v2
    s_waitcnt lgkmcnt(0)
    buffer_store_dwordx2 v[16:17], v7, s[28:31], 0 offen
    v_add_f32 v24, v24, v26
    v_add_f32 v25, v25, v27
    v_smfmac_f32_16x16x64_bf16 v[8:11], v[44:47], v[36:43], v2
    v_add_f32 v28, v28, v30
    v_add_f32 v29, v29, v31
    s_cmp_eq_u32 s21, 3
    v_cvt_pk_bf16_f32 v24, v24, v28
    v_cvt_pk_bf16_f32 v25, v25, v29
    v_and_or_b32 v24, v24, -2, 1
    buffer_store_dwordx2 v[24:25], v7, s[28:31], s61 offen
    s_nop 0
    v_add_f32 v8, v8, v10
    v_add_f32 v9, v9, v11
    v_cvt_pk_bf16_f32 v8, v8, v9
    v_and_or_b32 v8, v8, -2, 1
    buffer_store_dword v8, v14, s[28:31], s62 offen
    s_cbranch_scc1 CH_h_38
    v_lshrrev_b32 v56, s91, v0
    v_and_b32 v56, 16, v56
    v_lshlrev_b32_e64 v56, v56, s65
    v_cndmask_b32 v40, 0, v56, s[52:53]
    v_cndmask_b32 v41, 0, v56, s[54:55]
    v_cndmask_b32 v42, 0, v56, s[56:57]
    v_cndmask_b32 v43, 0, v56, s[58:59]
    v_mov_b64 v[58:59], -1
    s_mov_b32 s44, s43
    s_add_u32 s43, s43, 0x2000
    s_and_b32 s43, s43, 0x7fff
    s_add_u32 s43, s43, 163840
    s_mov_b32 s49, 0
    s_add_u32 s40, s40, 1
    s_add_u32 s90, s90, 32768
    s_add_u32 s96, s96, 131072
    s_add_u32 s97, s97, 131072
    s_cmp_eq_u32 s40, 63
    s_cselect_b32 s42, 1073741824, s42
    s_cmp_lg_u32 s95, 0
    s_cbranch_scc1 CH_nt_42
    s_nop 5
    s_cmp_le_u32 s21, 0
    s_cbranch_scc1 CH_d_44
    s_nop 7
    s_cmp_le_u32 s21, 1
    s_cbranch_scc1 CH_d_44
    s_nop 7
CH_d_44:
    buffer_load_dwordx4 v[32:35], v0, s[28:31], s46 offen offset:0 sc1
    buffer_load_dwordx4 v[36:39], v0, s[28:31], s46 offen offset:1024 sc1
    v_add_u32 v61, s92, v0
    v_lshrrev_b32 v62, 2, v0
    v_add_u32 v62, s93, v62
    v_mov_b64 v[8:9], 0
    v_mov_b64 v[10:11], 0
    v_mov_b64 v[12:13], 0
    v_mov_b64 v[14:15], 0
    v_mov_b64 v[48:49], 0
    v_mov_b64 v[50:51], 0
    v_mov_b64 v[52:53], 0
    v_mov_b64 v[54:55], 0
    s_cmp_eq_u32 s21, 2
    s_cselect_b32 s47, 0, 1
    s_nop 15
    buffer_load_dwordx4 v[24:27], v0, s[28:31], s46 offen offset:0 sc1
    buffer_load_dwordx4 v[28:31], v0, s[28:31], s46 offen offset:1024 sc1
CH_h_41:
    s_waitcnt vmcnt(3)
    v_mfma_f32_16x16x32_bf16 v[44:47], v[40:43], v[32:35], 0
    s_waitcnt vmcnt(2)
    v_mfma_f32_16x16x32_bf16 v[44:47], v[40:43], v[36:39], v[44:47]
    v_bitop3_b32 v56, v33, v35, v37 bitop3:0x80
    v_bitop3_b32 v57, v32, v34, v36 bitop3:0x80
    v_bitop3_b32 v56, v56, v39, s47 bitop3:0xea
    v_bitop3_b32 v56, v56, v57, v38 bitop3:0x80
    v_and_b32 v56, 1, v56
    v_cmp_ne_u32 vcc, 1, v56
CH_ok_45:
    s_nop 1
    v_add_f32_dpp v44, v44, v44 row_ror:8 row_mask:0xf bank_mask:0xf
    v_add_f32_dpp v45, v45, v45 row_ror:8 row_mask:0xf bank_mask:0xf
    v_add_f32_dpp v46, v46, v46 row_ror:8 row_mask:0xf bank_mask:0xf
    v_add_f32_dpp v47, v47, v47 row_ror:8 row_mask:0xf bank_mask:0xf
    v_add_f32_dpp v44, v44, v44 row_ror:4 row_mask:0xf bank_mask:0xf
    v_add_f32_dpp v45, v45, v45 row_ror:4 row_mask:0xf bank_mask:0xf
    v_add_f32_dpp v46, v46, v46 row_ror:4 row_mask:0xf bank_mask:0xf
    v_add_f32_dpp v47, v47, v47 row_ror:4 row_mask:0xf bank_mask:0xf
    v_cvt_pk_bf16_f32 v56, v44, v45
    v_cvt_pk_bf16_f32 v57, v46, v47
    v_min_u32 v56, -2, v56
    v_min_u32 v57, -2, v57
    s_cbranch_vccnz CH_h_40
    buffer_store_dwordx2 v[56:57], v6, s[28:31], s43 offen
CH_x0_43:
    s_barrier
    buffer_store_dwordx2 v[56:57], v6, s[36:39], s50 offen sc1
    buffer_store_dwordx2 v[58:59], v6, s[28:31], s44 offen
    s_add_u32 s50, s50, 32768
    v_mov_b64 v[16:17], 0
    v_mov_b64 v[18:19], 0
    v_mov_b64 v[20:21], 0
    v_mov_b64 v[22:23], 0
    s_nop 15
    s_nop 15
    s_nop 15
    s_nop 15
    s_nop 3
    s_branch CH_h_39
CH_h_38:
    v_add_u32 v61, s92, v0
    v_lshrrev_b32 v62, 2, v0
    v_add_u32 v62, s93, v62
    v_mov_b64 v[48:49], 0
    v_mov_b64 v[50:51], 0
    v_mov_b64 v[52:53], 0
    v_mov_b64 v[54:55], 0
    s_mov_b32 s44, s43
    s_add_u32 s43, s43, 0x2000
    s_and_b32 s43, s43, 0x7fff
    s_add_u32 s43, s43, 163840
    s_mov_b32 s49, 0
    s_add_u32 s40, s40, 1
    s_add_u32 s90, s90, 32768
    s_add_u32 s96, s96, 131072
    s_add_u32 s97, s97, 131072
    s_cmp_eq_u32 s40, 63
    s_cselect_b32 s42, 1073741824, s42
    v_mfma_f32_32x32x2_f32 v[8:23], v48, v48, 0
    v_mfma_f32_32x32x2_f32 v[8:23], v48, v48, v[8:23]
    v_mfma_f32_32x32x2_f32 v[8:23], v48, v48, v[8:23]
    v_mfma_f32_32x32x2_f32 v[8:23], v48, v48, v[8:23]
    v_mfma_f32_32x32x2_f32 v[8:23], v48, v48, v[8:23]
    s_waitcnt vmcnt(0)
    v_and_b32 v40, 0x180, v0
    ds_read_b32 v41, v40 offset:15360
    s_add_u32 s47, s40, 2
    s_min_u32 s47, s47, 64
    s_add_u32 s47, s47, s99
CH_fb_47:
    s_waitcnt lgkmcnt(0)
    v_cmp_gt_u32 vcc, s47, v41
    s_cbranch_vccnz CH_fp_46
    v_mfma_f32_32x32x2_f32 v[8:23], v48, v48, v[8:23]
    s_barrier
    s_nop 15
    s_nop 15
    s_nop 15
    s_nop 15
    s_nop 15
CH_h_39:
    buffer_load_dwordx4 v[24:27], v61, s[28:31], s43 offen sc1
    buffer_load_dword v28, v62, s[28:31], s43 offen sc1
    s_waitcnt vmcnt(1)
    ds_write_b128 v61, v[24:27] offset:0
    s_waitcnt vmcnt(0)
    ds_write_b32 v62, v28 offset:0
    v_max3_u32 v63, v24, v26, v28
    v_cmp_eq_u32 vcc, -1, v63
    s_cbranch_vccnz CH_re_48
CH_bk_49:
    buffer_load_dwordx4 v[56:59], v61, s[36:39], s90 offen sc1
    buffer_load_dword v60, v62, s[36:39], s90 offen sc1
    s_waitcnt lgkmcnt(0)
    s_barrier
    ds_read_b128 v[24:27], v0 offset:0
    ds_read_b128 v[28:31], v0 offset:1024
    ds_read_b128 v[32:35], v1 offset:4096
    ds_read_b128 v[36:39], v1 offset:5120
    s_waitcnt lgkmcnt(3)
    v_smfmac_f32_16x16x64_bf16 v[8:11], v[24:27], v[64:71], v2
    ds_read_b128 v[40:43], v1 offset:6144
    ds_read_b128 v[44:47], v1 offset:7168
    v_smfmac_f32_16x16x64_bf16 v[12:15], v[24:27], v[72:79], v2
    v_smfmac_f32_16x16x64_bf16 v[16:19], v[24:27], v[80:87], v2
    v_smfmac_f32_16x16x64_bf16 v[20:23], v[24:27], v[88:95], v2
    s_waitcnt lgkmcnt(2)
    v_smfmac_f32_16x16x64_bf16 v[48:51], v[24:27], v[32:39], v2
    ds_read_b128 v[32:35], v1 offset:8192
    ds_read_b128 v[36:39], v1 offset:9216
    v_smfmac_f32_16x16x64_bf16 v[52:55], v[24:27], v[96:103], v2
    ds_read_b128 v[24:27], v0 offset:2048
    v_smfmac_f32_16x16x64_bf16 v[8:11], v[28:31], v[104:111], v2
    v_smfmac_f32_16x16x64_bf16 v[12:15], v[28:31], v[112:119], v2
    s_waitcnt lgkmcnt(3)
    v_smfmac_f32_16x16x64_bf16 v[16:19], v[28:31], v[40:47], v2
    ds_read_b128 v[40:43], v1 offset:10240
    ds_read_b128 v[44:47], v1 offset:11264
    v_smfmac_f32_16x16x64_bf16 v[20:23], v[28:31], v[120:127], v2
    v_smfmac_f32_16x16x64_bf16 v[48:51], v[28:31], v[128:135], v2
    v_smfmac_f32_16x16x64_bf16 v[52:55], v[28:31], v[136:143], v2
    ds_read_b128 v[28:31], v0 offset:3072
    s_waitcnt lgkmcnt(3)
    v_smfmac_f32_16x16x64_bf16 v[8:11], v[24:27], v[144:151], v2
    v_smfmac_f32_16x16x64_bf16 v[12:15], v[24:27], v[32:39], v2
    ds_read_b128 v[32:35], v1 offset:12288
    ds_read_b128 v[36:39], v1 offset:13312
    v_smfmac_f32_16x16x64_bf16 v[16:19], v[24:27], v[152:159], v2
    v_smfmac_f32_16x16x64_bf16 v[20:23], v[24:27], v[160:167], v2
    v_smfmac_f32_16x16x64_bf16 v[48:51], v[24:27], v[168:175], v2
    s_waitcnt vmcnt(1)
    ds_write_b128 v61, v[56:59] offset:5120
    v_smfmac_f32_16x16x64_bf16 v[52:55], v[24:27], v[176:183], v2
    ds_read_b128 v[24:27], v0 offset:4096
    s_waitcnt vmcnt(0)
    ds_write_b32 v62, v60 offset:5120
    v_max3_u32 v63, v56, v58, v60
    s_waitcnt lgkmcnt(5)
    v_smfmac_f32_16x16x64_bf16 v[8:11], v[28:31], v[40:47], v2
    ds_read_b128 v[40:43], v1 offset:14336
    v_cmp_eq_u32 vcc, -1, v63
    v_smfmac_f32_16x16x64_bf16 v[12:15], v[28:31], v[184:191], v2
    ds_read_b128 v[44:47], v1 offset:15360
    v_smfmac_f32_16x16x64_bf16 v[16:19], v[28:31], v[192:199], v2
    s_cbranch_vccnz CH_re_50
CH_bk_51:
    v_smfmac_f32_16x16x64_bf16 v[20:23], v[28:31], v[200:207], v2
    s_waitcnt lgkmcnt(2)
    s_barrier
    ds_read_b128 v[28:31], v0 offset:5120
    v_smfmac_f32_16x16x64_bf16 v[8:11], v[24:27], v[208:215], v2
    s_add_u32 s48, s40, s99
    v_mov_b32 v56, s48
    v_smfmac_f32_16x16x64_bf16 v[12:15], v[24:27], v[216:223], v2
    buffer_store_dword v56, off, s[32:35], s18 sc1
    v_smfmac_f32_16x16x64_bf16 v[16:19], v[24:27], v[224:231], v2
    s_add_u32 m0, s63, 0
    s_add_u32 s60, s42, 8192
    buffer_load_dwordx4 v0, s[32:35], s42 offen offset:0 sc1 lds
    v_smfmac_f32_16x16x64_bf16 v[20:23], v[24:27], v[32:39], v2
    ds_read_b128 v[24:27], v0 offset:6144
    ds_read_b128 v[32:35], v1 offset:16384
    s_waitcnt lgkmcnt(2)
    v_smfmac_f32_16x16x64_bf16 v[8:11], v[28:31], v[232:239], v2
    ds_read_b128 v[36:39], v1 offset:17408
    v_smfmac_f32_16x16x64_bf16 v[12:15], v[28:31], v[240:247], v2
    v_smfmac_f32_16x16x64_bf16 v[16:19], v[28:31], v[248:255], v2
    buffer_load_dwordx4 v0, s[32:35], s42 offen offset:1024 sc1 lds
    v_smfmac_f32_16x16x64_bf16 v[20:23], v[28:31], a[0:7], v2
    ds_read_b128 v[28:31], v0 offset:7168
    s_waitcnt lgkmcnt(3)
    v_smfmac_f32_16x16x64_bf16 v[8:11], v[24:27], v[40:47], v2
    ds_read_b128 v[40:43], v1 offset:18432
    ds_read_b128 v[44:47], v1 offset:19456
    v_smfmac_f32_16x16x64_bf16 v[12:15], v[24:27], a[8:15], v2
    v_smfmac_f32_16x16x64_bf16 v[16:19], v[24:27], a[16:23], v2
    s_add_u32 m0, s64, 0
    s_add_u32 s42, s42, 524288
    buffer_load_dwordx4 v0, s[32:35], s60 offen offset:0 sc1 lds
    v_smfmac_f32_16x16x64_bf16 v[20:23], v[24:27], a[24:31], v2
    ds_read_b128 v[24:27], v0 offset:8192
    s_waitcnt lgkmcnt(3)
    v_smfmac_f32_16x16x64_bf16 v[8:11], v[28:31], v[32:39], v2
    ds_read_b128 v[32:35], v0 offset:9216
    v_smfmac_f32_16x16x64_bf16 v[12:15], v[28:31], a[32:39], v2
    v_smfmac_f32_16x16x64_bf16 v[16:19], v[28:31], a[40:47], v2
    buffer_load_dwordx4 v0, s[32:35], s60 offen offset:1024 sc1 lds
    v_smfmac_f32_16x16x64_bf16 v[20:23], v[28:31], a[48:55], v2
    ds_read_b128 v[28:31], v0 offset:3072
    s_waitcnt lgkmcnt(2)
    v_smfmac_f32_16x16x64_bf16 v[8:11], v[24:27], a[56:63], v2
    ds_read_b128 v[56:59], v0 offset:26624
    ds_read_b128 v[60:63], v0 offset:27648
    v_smfmac_f32_16x16x64_bf16 v[12:15], v[24:27], v[40:47], v2
    s_waitcnt lgkmcnt(3)
    v_smfmac_f32_16x16x64_bf16 v[8:11], v[32:35], a[64:71], v2
    ds_read_b128 v[40:43], v0 offset:24576
    ds_read_b128 v[44:47], v0 offset:25600
    v_smfmac_f32_16x16x64_bf16 v[12:15], v[32:35], a[72:79], v2
    s_mov_b32 m0, 15360
    s_mov_b32 exec_hi, 0
    buffer_load_dwordx4 v0, s[32:35], s98 offen offset:0 sc1 lds
    s_mov_b32 exec_hi, -1
    v_smfmac_f32_16x16x64_bf16 v[16:19], v[24:27], a[80:87], v2
    v_add_f32 v8, v8, v10
    v_smfmac_f32_16x16x64_bf16 v[16:19], v[32:35], a[88:95], v2
    v_add_f32 v9, v9, v11
    v_add_f32 v12, v12, v14
    v_smfmac_f32_16x16x64_bf16 v[20:23], v[24:27], a[96:103], v2
    ds_read_b128 v[24:27], v0 offset:4096
    v_add_f32 v13, v13, v15
    v_cvt_pk_bf16_f32 v8, v8, v9
    v_smfmac_f32_16x16x64_bf16 v[20:23], v[32:35], a[104:111], v2
    s_waitcnt lgkmcnt(5)
    ds_read_b128 v[32:35], v0 offset:5120
    v_cvt_pk_bf16_f32 v9, v12, v13
    v_add_f32 v16, v16, v18
    v_add_f32 v17, v17, v19
    v_smfmac_f32_16x16x64_bf16 v[48:51], v[28:31], a[112:119], v2
    ds_write_b64 v3, v[8:9]
    v_cvt_pk_bf16_f32 v10, v16, v17
    v_add_f32 v20, v20, v22
    v_add_f32 v21, v21, v23
    v_cvt_pk_bf16_f32 v11, v20, v21
    v_smfmac_f32_16x16x64_bf16 v[52:55], v[28:31], a[120:127], v2
    s_waitcnt lgkmcnt(2)
    ds_write_b64 v3, v[10:11] offset:2176
    v_smfmac_f32_16x16x64_bf16 v[48:51], v[24:27], a[128:135], v2
    ds_read_b128 v[28:31], v0 offset:6144
    v_lshrrev_b32 v12, 1, v0
    v_smfmac_f32_16x16x64_bf16 v[52:55], v[24:27], a[136:143], v2
    s_waitcnt lgkmcnt(3)
    ds_read_b128 v[24:27], v0 offset:7168
    v_permlane16_swap_b32 v10, v11
    v_smfmac_f32_16x16x64_bf16 v[48:51], v[32:35], a[144:151], v2
    buffer_store_dwordx2 v[10:11], v12, s[32:35], s96 offen sc1
    s_waitcnt lgkmcnt(2)
    s_barrier
    ds_read_b64_tr_b16 v[12:13], v4 offset:0
    ds_read_b64_tr_b16 v[14:15], v4 offset:32
    v_smfmac_f32_16x16x64_bf16 v[52:55], v[32:35], a[152:159], v2
    s_waitcnt lgkmcnt(3)
    ds_read_b64_tr_b16 v[16:17], v4 offset:1088
    ds_read_b64_tr_b16 v[18:19], v4 offset:1120
    ds_read_b64_tr_b16 v[20:21], v4 offset:2176
    v_smfmac_f32_16x16x64_bf16 v[48:51], v[28:31], a[160:167], v2
    ds_read_b64_tr_b16 v[22:23], v4 offset:2208
    ds_read_b64_tr_b16 v[36:37], v4 offset:3264
    ds_read_b64_tr_b16 v[38:39], v4 offset:3296
    v_smfmac_f32_16x16x64_bf16 v[52:55], v[28:31], a[168:175], v2
    s_waitcnt lgkmcnt(8)
    ds_read_b128 v[32:35], v0 offset:30720
    ds_read_b128 v[28:31], v0 offset:29696
    v_smfmac_f32_16x16x64_bf16 v[48:51], v[24:27], a[176:183], v2
    v_smfmac_f32_16x16x64_bf16 v[52:55], v[24:27], a[184:191], v2
    ds_read_b128 v[24:27], v0 offset:28672
    s_waitcnt lgkmcnt(9)
    v_mfma_f32_16x16x32_bf16 v[8:11], v[40:43], v[12:15], 0
    s_waitcnt lgkmcnt(7)
    v_mfma_f32_16x16x32_bf16 v[8:11], v[44:47], v[16:19], v[8:11]
    ds_read_b128 v[44:47], v0 offset:31744
    v_mfma_f32_16x16x32_bf16 v[40:43], v[56:59], v[12:15], 0
    v_mfma_f32_16x16x32_bf16 v[40:43], v[60:63], v[16:19], v[40:43]
    s_waitcnt lgkmcnt(6)
    ds_read_b128 v[60:63], v0 offset:8192
    v_add_f32_dpp v8, v10, v8 quad_perm:[2,3,2,3] row_mask:0xf bank_mask:0xf
    v_mfma_f32_16x16x32_bf16 v[56:59], v[20:23], v[12:15], 0
    s_waitcnt lgkmcnt(5)
    v_add_f32_dpp v9, v11, v9 quad_perm:[2,3,2,3] row_mask:0xf bank_mask:0xf
    v_max_f32 v10, v8, v9
    v_mfma_f32_16x16x32_bf16 v[56:59], v[36:39], v[16:19], v[56:59]
    s_waitcnt lgkmcnt(2)
    ds_read_b128 v[36:39], v0 offset:9216
    v_add_f32_dpp v40, v42, v40 quad_perm:[2,3,2,3] row_mask:0xf bank_mask:0xf
    v_mfma_f32_16x16x32_bf16 v[20:23], v[24:27], v[12:15], 0
    v_add_f32_dpp v41, v43, v41 quad_perm:[2,3,2,3] row_mask:0xf bank_mask:0xf
    v_max3_f32 v10, v10, v40, v41
    v_mfma_f32_16x16x32_bf16 v[20:23], v[28:31], v[16:19], v[20:23]
    v_add_f32_dpp v56, v58, v56 quad_perm:[2,3,2,3] row_mask:0xf bank_mask:0xf
    v_mfma_f32_16x16x32_bf16 v[24:27], v[32:35], v[12:15], 0
    s_waitcnt lgkmcnt(2)
    v_add_f32_dpp v57, v59, v57 quad_perm:[2,3,2,3] row_mask:0xf bank_mask:0xf
    v_max3_f32 v10, v10, v56, v57
    v_mfma_f32_16x16x32_bf16 v[24:27], v[44:47], v[16:19], v[24:27]
    s_waitcnt lgkmcnt(1)
    v_add_f32_dpp v20, v22, v20 quad_perm:[2,3,2,3] row_mask:0xf bank_mask:0xf
    v_add_f32_dpp v21, v23, v21 quad_perm:[2,3,2,3] row_mask:0xf bank_mask:0xf
    v_smfmac_f32_16x16x64_bf16 v[48:51], v[60:63], a[192:199], v2
    ds_read_b128 v[32:35], v1 offset:2048
    v_max3_f32 v10, v10, v20, v21
    v_mov_b32 v17, 0
    s_nop 0
    v_add_f32_dpp v24, v26, v24 quad_perm:[2,3,2,3] row_mask:0xf bank_mask:0xf
    v_add_f32_dpp v25, v27, v25 quad_perm:[2,3,2,3] row_mask:0xf bank_mask:0xf
    v_max3_f32 v10, v10, v24, v25
    v_mov_b32 v11, v10
    v_smfmac_f32_16x16x64_bf16 v[52:55], v[60:63], a[200:207], v2
    s_waitcnt lgkmcnt(1)
    ds_read_b128 v[44:47], v1 offset:3072
    v_permlane32_swap_b32 v10, v11
    v_max_f32 v10, v10, v11
    v_mov_b32 v11, v10
    v_smfmac_f32_16x16x64_bf16 v[48:51], v[36:39], a[208:215], v2
    s_barrier
    v_permlane16_swap_b32 v10, v11
    v_max_f32 v10, v10, v11
    v_mul_f32 v10, s51, v10
    v_fma_f32 v8, v8, s51, -v10
    v_smfmac_f32_16x16x64_bf16 v[52:55], v[36:39], a[216:223], v2
    v_fma_f32 v9, v9, s51, -v10
    v_exp_f32 v8, v8
    v_fma_f32 v40, v40, s51, -v10
    v_exp_f32 v9, v9
    v_fma_f32 v41, v41, s51, -v10
    v_exp_f32 v40, v40
    v_cvt_pk_bf16_f32 v12, v8, v9
    v_fma_f32 v20, v20, s51, -v10
    v_exp_f32 v41, v41
    v_fma_f32 v21, v21, s51, -v10
    v_exp_f32 v20, v20
    v_cvt_pk_bf16_f32 v13, v40, v41
    v_fma_f32 v24, v24, s51, -v10
    v_exp_f32 v21, v21
    v_fma_f32 v25, v25, s51, -v10
    v_exp_f32 v24, v24
    v_cvt_pk_bf16_f32 v14, v20, v21
    v_fma_f32 v56, v56, s51, -v10
    v_exp_f32 v25, v25
    v_mov_b64 v[28:29], s[22:23]
    v_mov_b64 v[30:31], s[22:23]
    v_cvt_pk_bf16_f32 v15, v24, v25
    v_fma_f32 v57, v57, s51, -v10
    v_exp_f32 v56, v56
    v_mfma_f32_16x16x32_bf16 v[60:63], v[28:31], v[12:15], 0
    v_exp_f32 v57, v57
    s_waitcnt lgkmcnt(1)
    v_mfma_f32_16x16x32_bf16 v[32:35], v[32:35], v[12:15], 0
    v_cvt_pk_bf16_f32 v16, v56, v57
    v_add_f32 v48, v48, v50
    s_waitcnt lgkmcnt(0)
    v_mfma_f32_16x16x32_bf16 v[44:47], v[44:47], v[12:15], 0
    v_add_f32 v49, v49, v51
    v_add_f32 v52, v52, v54
    v_mfma_f32_16x16x16_bf16 v[60:63], v[28:29], v[16:17], v[60:63]
    v_add_f32 v53, v53, v55
    v_cvt_pk_bf16_f32 v22, v48, v49
    v_cvt_pk_bf16_f32 v23, v52, v53
    v_mov_b32 v18, 0
    v_mov_b32 v19, v16
    v_mfma_f32_16x16x16_bf16 v[32:35], v[22:23], v[16:17], v[32:35]
    ds_read_b128 v[48:51], v1 offset:20480
    ds_read_b128 v[52:55], v1 offset:21504
    v_mfma_f32_16x16x16_bf16 v[44:47], v[22:23], v[18:19], v[44:47]
    ds_read_b128 v[36:39], v1 offset:24576
    ds_read_b128 v[40:43], v1 offset:25600
    v_rcp_f32 v10, v60
    v_mov_b64 v[12:13], 0
    v_lshrrev_b32 v14, 1, v0
    v_permlane16_swap_b32 v22, v23
    v_pk_mul_f32 v[32:33], v[32:33], v[10:11] op_sel_hi:[1,0]
    v_pk_mul_f32 v[34:35], v[34:35], v[10:11] op_sel_hi:[1,0]
    v_cvt_pk_bf16_f32 v32, v32, v33
    v_cvt_pk_bf16_f32 v33, v34, v35
    v_pk_mul_f32 v[44:45], v[44:45], v[10:11] op_sel_hi:[1,0]
    v_pk_mul_f32 v[46:47], v[46:47], v[10:11] op_sel_hi:[1,0]
    v_cvt_pk_bf16_f32 v34, v44, v45
    v_cvt_pk_bf16_f32 v35, v46, v47
    v_mfma_f32_16x16x16_bf16 v[16:19], v[12:13], v[12:13], 0
    ds_write_b128 v5, v[32:35]
    buffer_store_dwordx2 v[22:23], v14, s[32:35], s97 offen sc1
    s_cmp_eq_u32 s40, 63
    s_cbranch_scc1 CH_exit_35
    v_mfma_f32_16x16x16_bf16 v[20:23], v[12:13], v[12:13], 0
    ds_read_b128 v[56:59], v1 offset:22528
    ds_read_b128 v[60:63], v1 offset:23552
    v_mfma_f32_16x16x16_bf16 v[24:27], v[12:13], v[12:13], 0
    v_mfma_f32_16x16x16_bf16 v[28:31], v[12:13], v[12:13], 0
    v_mfma_f32_16x16x16_bf16 v[8:11], v[12:13], v[12:13], 0
    s_waitcnt lgkmcnt(2)
    s_barrier
    ds_read_b128 v[32:35], v0 offset:10240
    ds_read_b128 v[44:47], v0 offset:11264
    v_lshlrev_b32 v15, 3, v0
    v_bfe_u32 v14, v0, 2, 6
    v_and_or_b32 v14, v15, s94, v14
    s_waitcnt lgkmcnt(1)
    v_smfmac_f32_16x16x64_bf16 v[16:19], v[32:35], v[48:55], v2
    ds_read_b128 v[48:51], v1 offset:26624
    ds_read_b128 v[52:55], v1 offset:27648
    s_waitcnt lgkmcnt(2)
    v_smfmac_f32_16x16x64_bf16 v[16:19], v[44:47], v[56:63], v2
    ds_read_b128 v[56:59], v1 offset:28672
    ds_read_b128 v[60:63], v1 offset:29696
    v_smfmac_f32_16x16x64_bf16 v[20:23], v[32:35], v[36:43], v2
    ds_read_b128 v[36:39], v1 offset:30720
    ds_read_b128 v[40:43], v1 offset:31744
    v_smfmac_f32_16x16x64_bf16 v[20:23], v[44:47], a[224:231], v2
    v_add_f32 v16, v16, v18
    v_add_f32 v17, v17, v19
    v_smfmac_f32_16x16x64_bf16 v[24:27], v[32:35], a[232:239], v2
    v_smfmac_f32_16x16x64_bf16 v[24:27], v[44:47], a[240:247], v2
    s_waitcnt lgkmcnt(4)
    v_add_f32 v20, v20, v22
    v_add_f32 v21, v21, v23
    v_smfmac_f32_16x16x64_bf16 v[28:31], v[32:35], v[48:55], v2
    v_cvt_pk_bf16_f32 v16, v16, v20
    v_cvt_pk_bf16_f32 v17, v17, v21
    v_smfmac_f32_16x16x64_bf16 v[28:31], v[44:47], a[248:255], v2
    s_waitcnt lgkmcnt(2)
    v_and_or_b32 v16, v16, -2, 0
    v_smfmac_f32_16x16x64_bf16 v[8:11], v[32:35], v[56:63], v2
    s_waitcnt lgkmcnt(0)
    buffer_store_dwordx2 v[16:17], v7, s[28:31], 0 offen
    v_add_f32 v24, v24, v26
    v_add_f32 v25, v25, v27
    v_smfmac_f32_16x16x64_bf16 v[8:11], v[44:47], v[36:43], v2
    v_add_f32 v28, v28, v30
    v_add_f32 v29, v29, v31
    s_cmp_eq_u32 s21, 3
    v_cvt_pk_bf16_f32 v24, v24, v28
    v_cvt_pk_bf16_f32 v25, v25, v29
    v_and_or_b32 v24, v24, -2, 0
    buffer_store_dwordx2 v[24:25], v7, s[28:31], s61 offen
    s_nop 0
    v_add_f32 v8, v8, v10
    v_add_f32 v9, v9, v11
    v_cvt_pk_bf16_f32 v8, v8, v9
    v_and_or_b32 v8, v8, -2, 0
    buffer_store_dword v8, v14, s[28:31], s62 offen
    s_cbranch_scc1 CH_h_52
    v_lshrrev_b32 v56, s91, v0
    v_and_b32 v56, 16, v56
    v_lshlrev_b32_e64 v56, v56, s65
    v_cndmask_b32 v40, 0, v56, s[52:53]
    v_cndmask_b32 v41, 0, v56, s[54:55]
    v_cndmask_b32 v42, 0, v56, s[56:57]
    v_cndmask_b32 v43, 0, v56, s[58:59]
    v_mov_b64 v[58:59], -1
    s_mov_b32 s44, s43
    s_add_u32 s43, s43, 0x2000
    s_and_b32 s43, s43, 0x7fff
    s_add_u32 s43, s43, 163840
    s_mov_b32 s49, 0
    s_add_u32 s40, s40, 1
    s_add_u32 s90, s90, 32768
    s_add_u32 s96, s96, 131072
    s_add_u32 s97, s97, 131072
    s_cmp_lg_u32 s95, 0
    s_cbranch_scc1 CH_nt_56
    s_nop 5
    s_cmp_le_u32 s21, 0
    s_cbranch_scc1 CH_d_58
    s_nop 7
    s_cmp_le_u32 s21, 1
    s_cbranch_scc1 CH_d_58
    s_nop 7
CH_d_58:
    buffer_load_dwordx4 v[32:35], v0, s[28:31], s46 offen offset:0 sc1
    buffer_load_dwordx4 v[36:39], v0, s[28:31], s46 offen offset:1024 sc1
    v_add_u32 v61, s92, v0
    v_lshrrev_b32 v62, 2, v0
    v_add_u32 v62, s93, v62
    v_mov_b64 v[8:9], 0
    v_mov_b64 v[10:11], 0
    v_mov_b64 v[12:13], 0
    v_mov_b64 v[14:15], 0
    v_mov_b64 v[48:49], 0
    v_mov_b64 v[50:51], 0
    v_mov_b64 v[52:53], 0
    v_mov_b64 v[54:55], 0
    s_cmp_eq_u32 s21, 2
    s_cselect_b32 s47, 1, 0
    s_nop 15
    buffer_load_dwordx4 v[24:27], v0, s[28:31], s46 offen offset:0 sc1
    buffer_load_dwordx4 v[28:31], v0, s[28:31], s46 offen offset:1024 sc1
CH_h_55:
    s_waitcnt vmcnt(3)
    v_mfma_f32_16x16x32_bf16 v[44:47], v[40:43], v[32:35], 0
    s_waitcnt vmcnt(2)
    v_mfma_f32_16x16x32_bf16 v[44:47], v[40:43], v[36:39], v[44:47]
    v_bitop3_b32 v56, v33, v35, v37 bitop3:0xfe
    v_bitop3_b32 v57, v32, v34, v36 bitop3:0xfe
    v_bitop3_b32 v56, v56, v39, s47 bitop3:0xa8
    v_bitop3_b32 v56, v56, v57, v38 bitop3:0xfe
    v_and_b32 v56, 1, v56
    v_cmp_ne_u32 vcc, 0, v56
CH_ok_59:
    s_nop 1
    v_add_f32_dpp v44, v44, v44 row_ror:8 row_mask:0xf bank_mask:0xf
    v_add_f32_dpp v45, v45, v45 row_ror:8 row_mask:0xf bank_mask:0xf
    v_add_f32_dpp v46, v46, v46 row_ror:8 row_mask:0xf bank_mask:0xf
    v_add_f32_dpp v47, v47, v47 row_ror:8 row_mask:0xf bank_mask:0xf
    v_add_f32_dpp v44, v44, v44 row_ror:4 row_mask:0xf bank_mask:0xf
    v_add_f32_dpp v45, v45, v45 row_ror:4 row_mask:0xf bank_mask:0xf
    v_add_f32_dpp v46, v46, v46 row_ror:4 row_mask:0xf bank_mask:0xf
    v_add_f32_dpp v47, v47, v47 row_ror:4 row_mask:0xf bank_mask:0xf
    v_cvt_pk_bf16_f32 v56, v44, v45
    v_cvt_pk_bf16_f32 v57, v46, v47
    v_min_u32 v56, -2, v56
    v_min_u32 v57, -2, v57
    s_cbranch_vccnz CH_h_54
    buffer_store_dwordx2 v[56:57], v6, s[28:31], s43 offen
CH_x0_57:
    s_barrier
    buffer_store_dwordx2 v[56:57], v6, s[36:39], s50 offen sc1
    buffer_store_dwordx2 v[58:59], v6, s[28:31], s44 offen
    s_add_u32 s50, s50, 32768
    v_mov_b64 v[16:17], 0
    v_mov_b64 v[18:19], 0
    v_mov_b64 v[20:21], 0
    v_mov_b64 v[22:23], 0
    s_nop 15
    s_nop 15
    s_nop 15
    s_nop 15
    s_nop 3
    s_branch CH_h_53
CH_h_52:
    v_add_u32 v61, s92, v0
    v_lshrrev_b32 v62, 2, v0
    v_add_u32 v62, s93, v62
    v_mov_b64 v[48:49], 0
    v_mov_b64 v[50:51], 0
    v_mov_b64 v[52:53], 0
    v_mov_b64 v[54:55], 0
    s_mov_b32 s44, s43
    s_add_u32 s43, s43, 0x2000
    s_and_b32 s43, s43, 0x7fff
    s_add_u32 s43, s43, 163840
    s_mov_b32 s49, 0
    s_add_u32 s40, s40, 1
    s_add_u32 s90, s90, 32768
    s_add_u32 s96, s96, 131072
    s_add_u32 s97, s97, 131072
    v_mfma_f32_32x32x2_f32 v[8:23], v48, v48, 0
    v_mfma_f32_32x32x2_f32 v[8:23], v48, v48, v[8:23]
    v_mfma_f32_32x32x2_f32 v[8:23], v48, v48, v[8:23]
    v_mfma_f32_32x32x2_f32 v[8:23], v48, v48, v[8:23]
    v_mfma_f32_32x32x2_f32 v[8:23], v48, v48, v[8:23]
    s_waitcnt vmcnt(0)
    v_and_b32 v40, 0x180, v0
    ds_read_b32 v41, v40 offset:15360
    s_add_u32 s47, s40, 2
    s_min_u32 s47, s47, 64
    s_add_u32 s47, s47, s99
CH_fb_61:
    s_waitcnt lgkmcnt(0)
    v_cmp_gt_u32 vcc, s47, v41
    s_cbranch_vccnz CH_fp_60
    v_mfma_f32_32x32x2_f32 v[8:23], v48, v48, v[8:23]
    s_barrier
    s_nop 15
    s_nop 15
    s_nop 15
    s_nop 15
    s_nop 15
CH_h_53:
    buffer_load_dwordx4 v[24:27], v61, s[28:31], s43 offen sc1
    buffer_load_dword v28, v62, s[28:31], s43 offen sc1
    s_waitcnt vmcnt(1)
    ds_write_b128 v61, v[24:27] offset:0
    s_waitcnt vmcnt(0)
    ds_write_b32 v62, v28 offset:0
    v_max3_u32 v63, v24, v26, v28
    v_cmp_eq_u32 vcc, -1, v63
    s_cbranch_vccnz CH_re_62
CH_bk_63:
    buffer_load_dwordx4 v[56:59], v61, s[36:39], s90 offen sc1
    buffer_load_dword v60, v62, s[36:39], s90 offen sc1
    s_branch CH_top_34
CH_re_36:
    buffer_load_dwordx4 v[56:59], v61, s[36:39], s90 offen sc1
    buffer_load_dword v60, v62, s[36:39], s90 offen sc1
    s_add_u32 s49, s49, 1
    s_cmp_gt_u32 s49, 400000
    s_cbranch_scc1 L_end
    s_waitcnt vmcnt(0)
    v_max3_u32 v63, v56, v58, v60
    v_cmp_eq_u32 vcc, -1, v63
    s_cbranch_vccnz CH_re_36
    ds_write_b128 v61, v[56:59] offset:5120
    ds_write_b32 v62, v60 offset:5120
    s_waitcnt lgkmcnt(0)
    s_branch CH_bk_37
CH_nt_42:
    v_add_u32 v61, s92, v0
    v_lshrrev_b32 v62, 2, v0
    v_add_u32 v62, s93, v62
    v_mov_b64 v[8:9], 0
    v_mov_b64 v[10:11], 0
    v_mov_b64 v[12:13], 0
    v_mov_b64 v[14:15], 0
    v_mov_b64 v[16:17], 0
    v_mov_b64 v[18:19], 0
    v_mov_b64 v[20:21], 0
    v_mov_b64 v[22:23], 0
    v_mov_b64 v[48:49], 0
    v_mov_b64 v[50:51], 0
    v_mov_b64 v[52:53], 0
    v_mov_b64 v[54:55], 0
    s_waitcnt vmcnt(0)
    s_branch CH_x0_43
CH_h_40:
    buffer_load_dwordx4 v[32:35], v0, s[28:31], s46 offen offset:0 sc1
    buffer_load_dwordx4 v[36:39], v0, s[28:31], s46 offen offset:1024 sc1
    s_waitcnt vmcnt(3)
    v_mfma_f32_16x16x32_bf16 v[44:47], v[40:43], v[24:27], 0
    s_waitcnt vmcnt(2)
    v_mfma_f32_16x16x32_bf16 v[44:47], v[40:43], v[28:31], v[44:47]
    v_bitop3_b32 v56, v25, v27, v29 bitop3:0x80
    v_bitop3_b32 v57, v24, v26, v28 bitop3:0x80
    v_bitop3_b32 v56, v56, v31, s47 bitop3:0xea
    v_bitop3_b32 v56, v56, v57, v30 bitop3:0x80
    v_and_b32 v56, 1, v56
    v_cmp_ne_u32 vcc, 1, v56
    s_cbranch_vccz CH_ok_45
    buffer_load_dwordx4 v[24:27], v0, s[28:31], s46 offen offset:0 sc1
    buffer_load_dwordx4 v[28:31], v0, s[28:31], s46 offen offset:1024 sc1
    s_add_u32 s49, s49, 1
    s_cmp_gt_u32 s49, 400000
    s_cbranch_scc1 L_end
    s_branch CH_h_41
CH_fp_46:
    buffer_load_dword v41, v40, s[32:35], s98 offen sc1
    s_add_u32 s49, s49, 1
    s_cmp_gt_u32 s49, 400000
    s_cbranch_scc1 L_end
    s_waitcnt vmcnt(0)
    s_branch CH_fb_47
CH_re_48:
    buffer_load_dwordx4 v[24:27], v61, s[28:31], s43 offen sc1
    buffer_load_dword v28, v62, s[28:31], s43 offen sc1
    s_add_u32 s49, s49, 1
    s_cmp_gt_u32 s49, 400000
    s_cbranch_scc1 L_end
    s_waitcnt vmcnt(0)
    v_max3_u32 v63, v24, v26, v28
    v_cmp_eq_u32 vcc, -1, v63
    s_cbranch_vccnz CH_re_48
    ds_write_b128 v61, v[24:27] offset:0
    ds_write_b32 v62, v28 offset:0
    s_waitcnt lgkmcnt(0)
    s_branch CH_bk_49
CH_re_50:
    buffer_load_dwordx4 v[56:59], v61, s[36:39], s90 offen sc1
    buffer_load_dword v60, v62, s[36:39], s90 offen sc1
    s_add_u32 s49, s49, 1
    s_cmp_gt_u32 s49, 400000
    s_cbranch_scc1 L_end
    s_waitcnt vmcnt(0)
    v_max3_u32 v63, v56, v58, v60
    v_cmp_eq_u32 vcc, -1, v63
    s_cbranch_vccnz CH_re_50
    ds_write_b128 v61, v[56:59] offset:5120
    ds_write_b32 v62, v60 offset:5120
    s_waitcnt lgkmcnt(0)
    s_branch CH_bk_51
CH_nt_56:
    v_add_u32 v61, s92, v0
    v_lshrrev_b32 v62, 2, v0
    v_add_u32 v62, s93, v62
    v_mov_b64 v[8:9], 0
    v_mov_b64 v[10:11], 0
    v_mov_b64 v[12:13], 0
    v_mov_b64 v[14:15], 0
    v_mov_b64 v[16:17], 0
    v_mov_b64 v[18:19], 0
    v_mov_b64 v[20:21], 0
    v_mov_b64 v[22:23], 0
    v_mov_b64 v[48:49], 0
    v_mov_b64 v[50:51], 0
    v_mov_b64 v[52:53], 0
    v_mov_b64 v[54:55], 0
    s_waitcnt vmcnt(0)
    s_branch CH_x0_57
CH_h_54:
    buffer_load_dwordx4 v[32:35], v0, s[28:31], s46 offen offset:0 sc1
    buffer_load_dwordx4 v[36:39], v0, s[28:31], s46 offen offset:1024 sc1
    s_waitcnt vmcnt(3)
    v_mfma_f32_16x16x32_bf16 v[44:47], v[40:43], v[24:27], 0
    s_waitcnt vmcnt(2)
    v_mfma_f32_16x16x32_bf16 v[44:47], v[40:43], v[28:31], v[44:47]
    v_bitop3_b32 v56, v25, v27, v29 bitop3:0xfe
    v_bitop3_b32 v57, v24, v26, v28 bitop3:0xfe
    v_bitop3_b32 v56, v56, v31, s47 bitop3:0xa8
    v_bitop3_b32 v56, v56, v57, v30 bitop3:0xfe
    v_and_b32 v56, 1, v56
    v_cmp_ne_u32 vcc, 0, v56
    s_cbranch_vccz CH_ok_59
    buffer_load_dwordx4 v[24:27], v0, s[28:31], s46 offen offset:0 sc1
    buffer_load_dwordx4 v[28:31], v0, s[28:31], s46 offen offset:1024 sc1
    s_add_u32 s49, s49, 1
    s_cmp_gt_u32 s49, 400000
    s_cbranch_scc1 L_end
    s_branch CH_h_55
CH_fp_60:
    buffer_load_dword v41, v40, s[32:35], s98 offen sc1
    s_add_u32 s49, s49, 1
    s_cmp_gt_u32 s49, 400000
    s_cbranch_scc1 L_end
    s_waitcnt vmcnt(0)
    s_branch CH_fb_61
CH_re_62:
    buffer_load_dwordx4 v[24:27], v61, s[28:31], s43 offen sc1
    buffer_load_dword v28, v62, s[28:31], s43 offen sc1
    s_add_u32 s49, s49, 1
    s_cmp_gt_u32 s49, 400000
    s_cbranch_scc1 L_end
    s_waitcnt vmcnt(0)
    v_max3_u32 v63, v24, v26, v28
    v_cmp_eq_u32 vcc, -1, v63
    s_cbranch_vccnz CH_re_62
    ds_write_b128 v61, v[24:27] offset:0
    ds_write_b32 v62, v28 offset:0
    s_waitcnt lgkmcnt(0)
    s_branch CH_bk_63
CH_exit_35:
    s_branch CH_fin_19
CH_slow_18:
.p2align 6
CH_top_78:
    s_waitcnt lgkmcnt(0)
    s_barrier
    ds_read_b128 v[24:27], v0 offset:0
    ds_read_b128 v[28:31], v0 offset:1024
    ds_read_b128 v[32:35], v1 offset:4096
    ds_read_b128 v[36:39], v1 offset:5120
    s_waitcnt lgkmcnt(3)
    v_smfmac_f32_16x16x64_bf16 v[8:11], v[24:27], v[64:71], v2
    ds_read_b128 v[40:43], v1 offset:6144
    ds_read_b128 v[44:47], v1 offset:7168
    v_smfmac_f32_16x16x64_bf16 v[12:15], v[24:27], v[72:79], v2
    v_smfmac_f32_16x16x64_bf16 v[16:19], v[24:27], v[80:87], v2
    v_smfmac_f32_16x16x64_bf16 v[20:23], v[24:27], v[88:95], v2
    s_waitcnt lgkmcnt(2)
    v_smfmac_f32_16x16x64_bf16 v[48:51], v[24:27], v[32:39], v2
    ds_read_b128 v[32:35], v1 offset:8192
    ds_read_b128 v[36:39], v1 offset:9216
    v_smfmac_f32_16x16x64_bf16 v[52:55], v[24:27], v[96:103], v2
    ds_read_b128 v[24:27], v0 offset:2048
    v_smfmac_f32_16x16x64_bf16 v[8:11], v[28:31], v[104:111], v2
    v_smfmac_f32_16x16x64_bf16 v[12:15], v[28:31], v[112:119], v2
    s_waitcnt lgkmcnt(3)
    v_smfmac_f32_16x16x64_bf16 v[16:19], v[28:31], v[40:47], v2
    ds_read_b128 v[40:43], v1 offset:10240
    ds_read_b128 v[44:47], v1 offset:11264
    v_smfmac_f32_16x16x64_bf16 v[20:23], v[28:31], v[120:127], v2
    v_smfmac_f32_16x16x64_bf16 v[48:51], v[28:31], v[128:135], v2
    v_smfmac_f32_16x16x64_bf16 v[52:55], v[28:31], v[136:143], v2
    ds_read_b128 v[28:31], v0 offset:3072
    s_waitcnt lgkmcnt(3)
    v_smfmac_f32_16x16x64_bf16 v[8:11], v[24:27], v[144:151], v2
    v_smfmac_f32_16x16x64_bf16 v[12:15], v[24:27], v[32:39], v2
    ds_read_b128 v[32:35], v1 offset:12288
    ds_read_b128 v[36:39], v1 offset:13312
    v_smfmac_f32_16x16x64_bf16 v[16:19], v[24:27], v[152:159], v2
    v_smfmac_f32_16x16x64_bf16 v[20:23], v[24:27], v[160:167], v2
    v_smfmac_f32_16x16x64_bf16 v[48:51], v[24:27], v[168:175], v2
    s_waitcnt vmcnt(1)
    ds_write_b128 v61, v[56:59] offset:5120
    v_smfmac_f32_16x16x64_bf16 v[52:55], v[24:27], v[176:183], v2
    ds_read_b128 v[24:27], v0 offset:4096
    s_waitcnt vmcnt(0)
    ds_write_b32 v62, v60 offset:5120
    v_max3_u32 v63, v56, v58, v60
    s_waitcnt lgkmcnt(5)
    v_smfmac_f32_16x16x64_bf16 v[8:11], v[28:31], v[40:47], v2
    ds_read_b128 v[40:43], v1 offset:14336
    v_cmp_eq_u32 vcc, -1, v63
    v_smfmac_f32_16x16x64_bf16 v[12:15], v[28:31], v[184:191], v2
    ds_read_b128 v[44:47], v1 offset:15360
    v_smfmac_f32_16x16x64_bf16 v[16:19], v[28:31], v[192:199], v2
    s_cbranch_vccnz CH_re_80
CH_bk_81:
    v_smfmac_f32_16x16x64_bf16 v[20:23], v[28:31], v[200:207], v2
    s_waitcnt lgkmcnt(2)
    s_barrier
    ds_read_b128 v[28:31], v0 offset:5120
    v_smfmac_f32_16x16x64_bf16 v[8:11], v[24:27], v[208:215], v2
    s_add_u32 s48, s40, s99
    v_mov_b32 v56, s48
    v_smfmac_f32_16x16x64_bf16 v[12:15], v[24:27], v[216:223], v2
    buffer_store_dword v56, off, s[32:35], s18 sc1
    v_smfmac_f32_16x16x64_bf16 v[16:19], v[24:27], v[224:231], v2
    s_add_u32 m0, s63, 8192
    s_add_u32 s60, s42, 8192
    buffer_load_dwordx4 v0, s[32:35], s42 offen offset:0 sc1 lds
    v_smfmac_f32_16x16x64_bf16 v[20:23], v[24:27], v[32:39], v2
    ds_read_b128 v[24:27], v0 offset:6144
    ds_read_b128 v[32:35], v1 offset:16384
    s_waitcnt lgkmcnt(2)
    v_smfmac_f32_16x16x64_bf16 v[8:11], v[28:31], v[232:239], v2
    ds_read_b128 v[36:39], v1 offset:17408
    v_smfmac_f32_16x16x64_bf16 v[12:15], v[28:31], v[240:247], v2
    v_smfmac_f32_16x16x64_bf16 v[16:19], v[28:31], v[248:255], v2
    buffer_load_dwordx4 v0, s[32:35], s42 offen offset:1024 sc1 lds
    v_smfmac_f32_16x16x64_bf16 v[20:23], v[28:31], a[0:7], v2
    ds_read_b128 v[28:31], v0 offset:7168
    s_waitcnt lgkmcnt(3)
    v_smfmac_f32_16x16x64_bf16 v[8:11], v[24:27], v[40:47], v2
    ds_read_b128 v[40:43], v1 offset:18432
    ds_read_b128 v[44:47], v1 offset:19456
    v_smfmac_f32_16x16x64_bf16 v[12:15], v[24:27], a[8:15], v2
    v_smfmac_f32_16x16x64_bf16 v[16:19], v[24:27], a[16:23], v2
    s_add_u32 m0, s64, 2048
    s_add_u32 s42, s42, 524288
    buffer_load_dwordx4 v0, s[32:35], s60 offen offset:0 sc1 lds
    v_smfmac_f32_16x16x64_bf16 v[20:23], v[24:27], a[24:31], v2
    ds_read_b128 v[24:27], v0 offset:8192
    s_waitcnt lgkmcnt(3)
    v_smfmac_f32_16x16x64_bf16 v[8:11], v[28:31], v[32:39], v2
    ds_read_b128 v[32:35], v0 offset:9216
    v_smfmac_f32_16x16x64_bf16 v[12:15], v[28:31], a[32:39], v2
    v_smfmac_f32_16x16x64_bf16 v[16:19], v[28:31], a[40:47], v2
    buffer_load_dwordx4 v0, s[32:35], s60 offen offset:1024 sc1 lds
    v_smfmac_f32_16x16x64_bf16 v[20:23], v[28:31], a[48:55], v2
    ds_read_b128 v[28:31], v0 offset:3072
    s_waitcnt lgkmcnt(2)
    v_smfmac_f32_16x16x64_bf16 v[8:11], v[24:27], a[56:63], v2
    ds_read_b128 v[56:59], v0 offset:18432
    ds_read_b128 v[60:63], v0 offset:19456
    v_smfmac_f32_16x16x64_bf16 v[12:15], v[24:27], v[40:47], v2
    s_waitcnt lgkmcnt(3)
    v_smfmac_f32_16x16x64_bf16 v[8:11], v[32:35], a[64:71], v2
    ds_read_b128 v[40:43], v0 offset:16384
    ds_read_b128 v[44:47], v0 offset:17408
    v_smfmac_f32_16x16x64_bf16 v[12:15], v[32:35], a[72:79], v2
    s_mov_b32 m0, 15360
    s_mov_b32 exec_hi, 0
    buffer_load_dwordx4 v0, s[32:35], s98 offen offset:0 sc1 lds
    s_mov_b32 exec_hi, -1
    v_smfmac_f32_16x16x64_bf16 v[16:19], v[24:27], a[80:87], v2
    v_add_f32 v8, v8, v10
    v_smfmac_f32_16x16x64_bf16 v[16:19], v[32:35], a[88:95], v2
    v_add_f32 v9, v9, v11
    v_add_f32 v12, v12, v14
    v_smfmac_f32_16x16x64_bf16 v[20:23], v[24:27], a[96:103], v2
    ds_read_b128 v[24:27], v0 offset:4096
    v_add_f32 v13, v13, v15
    v_cvt_pk_bf16_f32 v8, v8, v9
    v_smfmac_f32_16x16x64_bf16 v[20:23], v[32:35], a[104:111], v2
    s_waitcnt lgkmcnt(5)
    ds_read_b128 v[32:35], v0 offset:5120
    v_cvt_pk_bf16_f32 v9, v12, v13
    v_add_f32 v16, v16, v18
    v_add_f32 v17, v17, v19
    v_smfmac_f32_16x16x64_bf16 v[48:51], v[28:31], a[112:119], v2
    ds_write_b64 v3, v[8:9]
    v_cvt_pk_bf16_f32 v10, v16, v17
    v_add_f32 v20, v20, v22
    v_add_f32 v21, v21, v23
    v_cvt_pk_bf16_f32 v11, v20, v21
    v_smfmac_f32_16x16x64_bf16 v[52:55], v[28:31], a[120:127], v2
    s_waitcnt lgkmcnt(2)
    ds_write_b64 v3, v[10:11] offset:2176
    v_smfmac_f32_16x16x64_bf16 v[48:51], v[24:27], a[128:135], v2
    ds_read_b128 v[28:31], v0 offset:6144
    v_lshrrev_b32 v12, 1, v0
    v_smfmac_f32_16x16x64_bf16 v[52:55], v[24:27], a[136:143], v2
    s_waitcnt lgkmcnt(3)
    ds_read_b128 v[24:27], v0 offset:7168
    v_permlane16_swap_b32 v10, v11
    v_smfmac_f32_16x16x64_bf16 v[48:51], v[32:35], a[144:151], v2
    buffer_store_dwordx2 v[10:11], v12, s[32:35], s96 offen sc1
    s_waitcnt lgkmcnt(2)
    s_barrier
    ds_read_b64_tr_b16 v[12:13], v4 offset:0
    ds_read_b64_tr_b16 v[14:15], v4 offset:32
    v_smfmac_f32_16x16x64_bf16 v[52:55], v[32:35], a[152:159], v2
    s_waitcnt lgkmcnt(3)
    ds_read_b64_tr_b16 v[16:17], v4 offset:1088
    ds_read_b64_tr_b16 v[18:19], v4 offset:1120
    ds_read_b64_tr_b16 v[20:21], v4 offset:2176
    v_smfmac_f32_16x16x64_bf16 v[48:51], v[28:31], a[160:167], v2
    ds_read_b64_tr_b16 v[22:23], v4 offset:2208
    ds_read_b64_tr_b16 v[36:37], v4 offset:3264
    ds_read_b64_tr_b16 v[38:39], v4 offset:3296
    v_smfmac_f32_16x16x64_bf16 v[52:55], v[28:31], a[168:175], v2
    s_waitcnt lgkmcnt(8)
    ds_read_b128 v[32:35], v0 offset:22528
    ds_read_b128 v[28:31], v0 offset:21504
    v_smfmac_f32_16x16x64_bf16 v[48:51], v[24:27], a[176:183], v2
    v_smfmac_f32_16x16x64_bf16 v[52:55], v[24:27], a[184:191], v2
    ds_read_b128 v[24:27], v0 offset:20480
    s_waitcnt lgkmcnt(9)
    v_mfma_f32_16x16x32_bf16 v[8:11], v[40:43], v[12:15], 0
    s_waitcnt lgkmcnt(7)
    v_mfma_f32_16x16x32_bf16 v[8:11], v[44:47], v[16:19], v[8:11]
    ds_read_b128 v[44:47], v0 offset:23552
    v_mfma_f32_16x16x32_bf16 v[40:43], v[56:59], v[12:15], 0
    v_mfma_f32_16x16x32_bf16 v[40:43], v[60:63], v[16:19], v[40:43]
    s_waitcnt lgkmcnt(6)
    ds_read_b128 v[60:63], v0 offset:8192
    v_add_f32_dpp v8, v10, v8 quad_perm:[2,3,2,3] row_mask:0xf bank_mask:0xf
    v_mfma_f32_16x16x32_bf16 v[56:59], v[20:23], v[12:15], 0
    s_waitcnt lgkmcnt(5)
    v_add_f32_dpp v9, v11, v9 quad_perm:[2,3,2,3] row_mask:0xf bank_mask:0xf
    v_max_f32 v10, v8, v9
    v_mfma_f32_16x16x32_bf16 v[56:59], v[36:39], v[16:19], v[56:59]
    s_waitcnt lgkmcnt(2)
    ds_read_b128 v[36:39], v0 offset:9216
    v_add_f32_dpp v40, v42, v40 quad_perm:[2,3,2,3] row_mask:0xf bank_mask:0xf
    v_mfma_f32_16x16x32_bf16 v[20:23], v[24:27], v[12:15], 0
    v_add_f32_dpp v41, v43, v41 quad_perm:[2,3,2,3] row_mask:0xf bank_mask:0xf
    v_max3_f32 v10, v10, v40, v41
    v_mfma_f32_16x16x32_bf16 v[20:23], v[28:31], v[16:19], v[20:23]
    v_add_f32_dpp v56, v58, v56 quad_perm:[2,3,2,3] row_mask:0xf bank_mask:0xf
    v_mfma_f32_16x16x32_bf16 v[24:27], v[32:35], v[12:15], 0
    s_waitcnt lgkmcnt(2)
    v_add_f32_dpp v57, v59, v57 quad_perm:[2,3,2,3] row_mask:0xf bank_mask:0xf
    v_max3_f32 v10, v10, v56, v57
    v_mfma_f32_16x16x32_bf16 v[24:27], v[44:47], v[16:19], v[24:27]
    s_waitcnt lgkmcnt(1)
    v_add_f32_dpp v20, v22, v20 quad_perm:[2,3,2,3] row_mask:0xf bank_mask:0xf
    v_add_f32_dpp v21, v23, v21 quad_perm:[2,3,2,3] row_mask:0xf bank_mask:0xf
    v_smfmac_f32_16x16x64_bf16 v[48:51], v[60:63], a[192:199], v2
    ds_read_b128 v[32:35], v1 offset:0
    v_max3_f32 v10, v10, v20, v21
    v_mov_b32 v17, 0
    s_nop 0
    v_add_f32_dpp v24, v26, v24 quad_perm:[2,3,2,3] row_mask:0xf bank_mask:0xf
    v_add_f32_dpp v25, v27, v25 quad_perm:[2,3,2,3] row_mask:0xf bank_mask:0xf
    v_max3_f32 v10, v10, v24, v25
    v_mov_b32 v11, v10
    v_smfmac_f32_16x16x64_bf16 v[52:55], v[60:63], a[200:207], v2
    s_waitcnt lgkmcnt(1)
    ds_read_b128 v[44:47], v1 offset:1024
    v_permlane32_swap_b32 v10, v11
    v_max_f32 v10, v10, v11
    v_mov_b32 v11, v10
    v_smfmac_f32_16x16x64_bf16 v[48:51], v[36:39], a[208:215], v2
    s_barrier
    v_permlane16_swap_b32 v10, v11
    v_max_f32 v10, v10, v11
    v_mul_f32 v10, s51, v10
    v_fma_f32 v8, v8, s51, -v10
    v_smfmac_f32_16x16x64_bf16 v[52:55], v[36:39], a[216:223], v2
    v_fma_f32 v9, v9, s51, -v10
    v_exp_f32 v8, v8
    v_fma_f32 v40, v40, s51, -v10
    v_exp_f32 v9, v9
    v_fma_f32 v41, v41, s51, -v10
    v_exp_f32 v40, v40
    v_cvt_pk_bf16_f32 v12, v8, v9
    v_fma_f32 v20, v20, s51, -v10
    v_exp_f32 v41, v41
    v_fma_f32 v21, v21, s51, -v10
    v_exp_f32 v20, v20
    v_cvt_pk_bf16_f32 v13, v40, v41
    v_fma_f32 v24, v24, s51, -v10
    v_exp_f32 v21, v21
    v_fma_f32 v25, v25, s51, -v10
    v_exp_f32 v24, v24
    v_cvt_pk_bf16_f32 v14, v20, v21
    v_fma_f32 v56, v56, s51, -v10
    v_exp_f32 v25, v25
    v_mov_b64 v[28:29], s[22:23]
    v_mov_b64 v[30:31], s[22:23]
    v_cvt_pk_bf16_f32 v15, v24, v25
    v_fma_f32 v57, v57, s51, -v10
    v_exp_f32 v56, v56
    v_mfma_f32_16x16x32_bf16 v[60:63], v[28:31], v[12:15], 0
    v_exp_f32 v57, v57
    s_waitcnt lgkmcnt(1)
    v_mfma_f32_16x16x32_bf16 v[32:35], v[32:35], v[12:15], 0
    v_cvt_pk_bf16_f32 v16, v56, v57
    v_add_f32 v48, v48, v50
    s_waitcnt lgkmcnt(0)
    v_mfma_f32_16x16x32_bf16 v[44:47], v[44:47], v[12:15], 0
    v_add_f32 v49, v49, v51
    v_add_f32 v52, v52, v54
    v_mfma_f32_16x16x16_bf16 v[60:63], v[28:29], v[16:17], v[60:63]
    v_add_f32 v53, v53, v55
    v_cvt_pk_bf16_f32 v22, v48, v49
    v_cvt_pk_bf16_f32 v23, v52, v53
    v_mov_b32 v18, 0
    v_mov_b32 v19, v16
    v_mfma_f32_16x16x16_bf16 v[32:35], v[22:23], v[16:17], v[32:35]
    ds_read_b128 v[48:51], v1 offset:20480
    ds_read_b128 v[52:55], v1 offset:21504
    v_mfma_f32_16x16x16_bf16 v[44:47], v[22:23], v[18:19], v[44:47]
    ds_read_b128 v[36:39], v1 offset:24576
    ds_read_b128 v[40:43], v1 offset:25600
    v_rcp_f32 v10, v60
    v_mov_b64 v[12:13], 0
    v_lshrrev_b32 v14, 1, v0
    v_permlane16_swap_b32 v22, v23
    v_pk_mul_f32 v[32:33], v[32:33], v[10:11] op_sel_hi:[1,0]
    v_pk_mul_f32 v[34:35], v[34:35], v[10:11] op_sel_hi:[1,0]
    v_cvt_pk_bf16_f32 v32, v32, v33
    v_cvt_pk_bf16_f32 v33, v34, v35
    v_pk_mul_f32 v[44:45], v[44:45], v[10:11] op_sel_hi:[1,0]
    v_pk_mul_f32 v[46:47], v[46:47], v[10:11] op_sel_hi:[1,0]
    v_cvt_pk_bf16_f32 v34, v44, v45
    v_cvt_pk_bf16_f32 v35, v46, v47
    v_mfma_f32_16x16x16_bf16 v[16:19], v[12:13], v[12:13], 0
    ds_write_b128 v5, v[32:35]
    buffer_store_dwordx2 v[22:23], v14, s[32:35], s97 offen sc1
    v_mfma_f32_16x16x16_bf16 v[20:23], v[12:13], v[12:13], 0
    ds_read_b128 v[56:59], v1 offset:22528
    ds_read_b128 v[60:63], v1 offset:23552
    v_mfma_f32_16x16x16_bf16 v[24:27], v[12:13], v[12:13], 0
    v_mfma_f32_16x16x16_bf16 v[28:31], v[12:13], v[12:13], 0
    v_mfma_f32_16x16x16_bf16 v[8:11], v[12:13], v[12:13], 0
    s_waitcnt lgkmcnt(2)
    s_barrier
    ds_read_b128 v[32:35], v0 offset:10240
    ds_read_b128 v[44:47], v0 offset:11264
    v_lshlrev_b32 v15, 3, v0
    v_bfe_u32 v14, v0, 2, 6
    v_and_or_b32 v14, v15, s94, v14
    s_waitcnt lgkmcnt(1)
    v_smfmac_f32_16x16x64_bf16 v[16:19], v[32:35], v[48:55], v2
    ds_read_b128 v[48:51], v1 offset:26624
    ds_read_b128 v[52:55], v1 offset:27648
    s_waitcnt lgkmcnt(2)
    v_smfmac_f32_16x16x64_bf16 v[16:19], v[44:47], v[56:63], v2
    ds_read_b128 v[56:59], v1 offset:28672
    ds_read_b128 v[60:63], v1 offset:29696
    v_smfmac_f32_16x16x64_bf16 v[20:23], v[32:35], v[36:43], v2
    ds_read_b128 v[36:39], v1 offset:30720
    ds_read_b128 v[40:43], v1 offset:31744
    v_smfmac_f32_16x16x64_bf16 v[20:23], v[44:47], a[224:231], v2
    v_add_f32 v16, v16, v18
    v_add_f32 v17, v17, v19
    v_smfmac_f32_16x16x64_bf16 v[24:27], v[32:35], a[232:239], v2
    v_smfmac_f32_16x16x64_bf16 v[24:27], v[44:47], a[240:247], v2
    s_waitcnt lgkmcnt(4)
    v_add_f32 v20, v20, v22
    v_add_f32 v21, v21, v23
    v_smfmac_f32_16x16x64_bf16 v[28:31], v[32:35], v[48:55], v2
    v_cvt_pk_bf16_f32 v16, v16, v20
    v_cvt_pk_bf16_f32 v17, v17, v21
    v_smfmac_f32_16x16x64_bf16 v[28:31], v[44:47], a[248:255], v2
    s_waitcnt lgkmcnt(2)
    v_and_or_b32 v16, v16, -2, 1
    v_smfmac_f32_16x16x64_bf16 v[8:11], v[32:35], v[56:63], v2
    s_waitcnt lgkmcnt(0)
    buffer_store_dwordx2 v[16:17], v7, s[28:31], 0 offen sc1
    v_add_f32 v24, v24, v26
    v_add_f32 v25, v25, v27
    v_smfmac_f32_16x16x64_bf16 v[8:11], v[44:47], v[36:43], v2
    v_add_f32 v28, v28, v30
    v_add_f32 v29, v29, v31
    s_cmp_eq_u32 s21, 3
    v_cvt_pk_bf16_f32 v24, v24, v28
    v_cvt_pk_bf16_f32 v25, v25, v29
    v_and_or_b32 v24, v24, -2, 1
    buffer_store_dwordx2 v[24:25], v7, s[28:31], s61 offen sc1
    s_nop 0
    v_add_f32 v8, v8, v10
    v_add_f32 v9, v9, v11
    v_cvt_pk_bf16_f32 v8, v8, v9
    v_and_or_b32 v8, v8, -2, 1
    buffer_store_dword v8, v14, s[28:31], s62 offen sc1
    s_cbranch_scc1 CH_h_82
    v_lshrrev_b32 v56, s91, v0
    v_and_b32 v56, 16, v56
    v_lshlrev_b32_e64 v56, v56, s65
    v_cndmask_b32 v40, 0, v56, s[52:53]
    v_cndmask_b32 v41, 0, v56, s[54:55]
    v_cndmask_b32 v42, 0, v56, s[56:57]
    v_cndmask_b32 v43, 0, v56, s[58:59]
    v_mov_b64 v[58:59], -1
    s_mov_b32 s44, s43
    s_add_u32 s43, s43, 0x2000
    s_and_b32 s43, s43, 0x7fff
    s_add_u32 s43, s43, 163840
    s_mov_b32 s49, 0
    s_add_u32 s40, s40, 1
    s_add_u32 s90, s90, 32768
    s_add_u32 s96, s96, 131072
    s_add_u32 s97, s97, 131072
    s_cmp_eq_u32 s40, 63
    s_cselect_b32 s42, 1073741824, s42
    s_cmp_lg_u32 s95, 0
    s_cbranch_scc1 CH_nt_86
    s_nop 5
    s_cmp_le_u32 s21, 0
    s_cbranch_scc1 CH_d_88
    s_nop 7
    s_cmp_le_u32 s21, 1
    s_cbranch_scc1 CH_d_88
    s_nop 7
CH_d_88:
    buffer_load_dwordx4 v[32:35], v0, s[28:31], s46 offen offset:0 sc1
    buffer_load_dwordx4 v[36:39], v0, s[28:31], s46 offen offset:1024 sc1
    v_add_u32 v61, s92, v0
    v_lshrrev_b32 v62, 2, v0
    v_add_u32 v62, s93, v62
    v_mov_b64 v[8:9], 0
    v_mov_b64 v[10:11], 0
    v_mov_b64 v[12:13], 0
    v_mov_b64 v[14:15], 0
    v_mov_b64 v[48:49], 0
    v_mov_b64 v[50:51], 0
    v_mov_b64 v[52:53], 0
    v_mov_b64 v[54:55], 0
    s_cmp_eq_u32 s21, 2
    s_cselect_b32 s47, 0, 1
    s_nop 15
    buffer_load_dwordx4 v[24:27], v0, s[28:31], s46 offen offset:0 sc1
    buffer_load_dwordx4 v[28:31], v0, s[28:31], s46 offen offset:1024 sc1
CH_h_85:
    s_waitcnt vmcnt(3)
    v_mfma_f32_16x16x32_bf16 v[44:47], v[40:43], v[32:35], 0
    s_waitcnt vmcnt(2)
    v_mfma_f32_16x16x32_bf16 v[44:47], v[40:43], v[36:39], v[44:47]
    v_bitop3_b32 v56, v33, v35, v37 bitop3:0x80
    v_bitop3_b32 v57, v32, v34, v36 bitop3:0x80
    v_bitop3_b32 v56, v56, v39, s47 bitop3:0xea
    v_bitop3_b32 v56, v56, v57, v38 bitop3:0x80
    v_and_b32 v56, 1, v56
    v_cmp_ne_u32 vcc, 1, v56
CH_ok_89:
    s_nop 1
    v_add_f32_dpp v44, v44, v44 row_ror:8 row_mask:0xf bank_mask:0xf
    v_add_f32_dpp v45, v45, v45 row_ror:8 row_mask:0xf bank_mask:0xf
    v_add_f32_dpp v46, v46, v46 row_ror:8 row_mask:0xf bank_mask:0xf
    v_add_f32_dpp v47, v47, v47 row_ror:8 row_mask:0xf bank_mask:0xf
    v_add_f32_dpp v44, v44, v44 row_ror:4 row_mask:0xf bank_mask:0xf
    v_add_f32_dpp v45, v45, v45 row_ror:4 row_mask:0xf bank_mask:0xf
    v_add_f32_dpp v46, v46, v46 row_ror:4 row_mask:0xf bank_mask:0xf
    v_add_f32_dpp v47, v47, v47 row_ror:4 row_mask:0xf bank_mask:0xf
    v_cvt_pk_bf16_f32 v56, v44, v45
    v_cvt_pk_bf16_f32 v57, v46, v47
    v_min_u32 v56, -2, v56
    v_min_u32 v57, -2, v57
    s_cbranch_vccnz CH_h_84
    buffer_store_dwordx2 v[56:57], v6, s[28:31], s43 offen sc1
CH_x0_87:
    s_barrier
    buffer_store_dwordx2 v[56:57], v6, s[36:39], s50 offen sc1
    buffer_store_dwordx2 v[58:59], v6, s[28:31], s44 offen sc1
    s_add_u32 s50, s50, 32768
    v_mov_b64 v[16:17], 0
    v_mov_b64 v[18:19], 0
    v_mov_b64 v[20:21], 0
    v_mov_b64 v[22:23], 0
    s_nop 15
    s_nop 15
    s_nop 15
    s_nop 15
    s_nop 3
    s_branch CH_h_83
CH_h_82:
    v_add_u32 v61, s92, v0
    v_lshrrev_b32 v62, 2, v0
    v_add_u32 v62, s93, v62
    v_mov_b64 v[48:49], 0
    v_mov_b64 v[50:51], 0
    v_mov_b64 v[52:53], 0
    v_mov_b64 v[54:55], 0
    s_mov_b32 s44, s43
    s_add_u32 s43, s43, 0x2000
    s_and_b32 s43, s43, 0x7fff
    s_add_u32 s43, s43, 163840
    s_mov_b32 s49, 0
    s_add_u32 s40, s40, 1
    s_add_u32 s90, s90, 32768
    s_add_u32 s96, s96, 131072
    s_add_u32 s97, s97, 131072
    s_cmp_eq_u32 s40, 63
    s_cselect_b32 s42, 1073741824, s42
    v_mfma_f32_32x32x2_f32 v[8:23], v48, v48, 0
    v_mfma_f32_32x32x2_f32 v[8:23], v48, v48, v[8:23]
    v_mfma_f32_32x32x2_f32 v[8:23], v48, v48, v[8:23]
    v_mfma_f32_32x32x2_f32 v[8:23], v48, v48, v[8:23]
    v_mfma_f32_32x32x2_f32 v[8:23], v48, v48, v[8:23]
    s_waitcnt vmcnt(0)
    v_and_b32 v40, 0x180, v0
    ds_read_b32 v41, v40 offset:15360
    s_add_u32 s47, s40, 2
    s_min_u32 s47, s47, 64
    s_add_u32 s47, s47, s99
CH_fb_91:
    s_waitcnt lgkmcnt(0)
    v_cmp_gt_u32 vcc, s47, v41
    s_cbranch_vccnz CH_fp_90
    v_mfma_f32_32x32x2_f32 v[8:23], v48, v48, v[8:23]
    s_barrier
    s_nop 15
    s_nop 15
    s_nop 15
    s_nop 15
    s_nop 15
CH_h_83:
    buffer_load_dwordx4 v[24:27], v61, s[28:31], s43 offen sc1
    buffer_load_dword v28, v62, s[28:31], s43 offen sc1
    s_waitcnt vmcnt(1)
    ds_write_b128 v61, v[24:27] offset:0
    s_waitcnt vmcnt(0)
    ds_write_b32 v62, v28 offset:0
    v_max3_u32 v63, v24, v26, v28
    v_cmp_eq_u32 vcc, -1, v63
    s_cbranch_vccnz CH_re_92
CH_bk_93:
    buffer_load_dwordx4 v[56:59], v61, s[36:39], s90 offen sc1
    buffer_load_dword v60, v62, s[36:39], s90 offen sc1
    s_waitcnt lgkmcnt(0)
    s_barrier
    ds_read_b128 v[24:27], v0 offset:0
    ds_read_b128 v[28:31], v0 offset:1024
    ds_read_b128 v[32:35], v1 offset:4096
    ds_read_b128 v[36:39], v1 offset:5120
    s_waitcnt lgkmcnt(3)
    v_smfmac_f32_16x16x64_bf16 v[8:11], v[24:27], v[64:71], v2
    ds_read_b128 v[40:43], v1 offset:6144
    ds_read_b128 v[44:47], v1 offset:7168
    v_smfmac_f32_16x16x64_bf16 v[12:15], v[24:27], v[72:79], v2
    v_smfmac_f32_16x16x64_bf16 v[16:19], v[24:27], v[80:87], v2
    v_smfmac_f32_16x16x64_bf16 v[20:23], v[24:27], v[88:95], v2
    s_waitcnt lgkmcnt(2)
    v_smfmac_f32_16x16x64_bf16 v[48:51], v[24:27], v[32:39], v2
    ds_read_b128 v[32:35], v1 offset:8192
    ds_read_b128 v[36:39], v1 offset:9216
    v_smfmac_f32_16x16x64_bf16 v[52:55], v[24:27], v[96:103], v2
    ds_read_b128 v[24:27], v0 offset:2048
    v_smfmac_f32_16x16x64_bf16 v[8:11], v[28:31], v[104:111], v2
    v_smfmac_f32_16x16x64_bf16 v[12:15], v[28:31], v[112:119], v2
    s_waitcnt lgkmcnt(3)
    v_smfmac_f32_16x16x64_bf16 v[16:19], v[28:31], v[40:47], v2
    ds_read_b128 v[40:43], v1 offset:10240
    ds_read_b128 v[44:47], v1 offset:11264
    v_smfmac_f32_16x16x64_bf16 v[20:23], v[28:31], v[120:127], v2
    v_smfmac_f32_16x16x64_bf16 v[48:51], v[28:31], v[128:135], v2
    v_smfmac_f32_16x16x64_bf16 v[52:55], v[28:31], v[136:143], v2
    ds_read_b128 v[28:31], v0 offset:3072
    s_waitcnt lgkmcnt(3)
    v_smfmac_f32_16x16x64_bf16 v[8:11], v[24:27], v[144:151], v2
    v_smfmac_f32_16x16x64_bf16 v[12:15], v[24:27], v[32:39], v2
    ds_read_b128 v[32:35], v1 offset:12288
    ds_read_b128 v[36:39], v1 offset:13312
    v_smfmac_f32_16x16x64_bf16 v[16:19], v[24:27], v[152:159], v2
    v_smfmac_f32_16x16x64_bf16 v[20:23], v[24:27], v[160:167], v2
    v_smfmac_f32_16x16x64_bf16 v[48:51], v[24:27], v[168:175], v2
    s_waitcnt vmcnt(1)
    ds_write_b128 v61, v[56:59] offset:5120
    v_smfmac_f32_16x16x64_bf16 v[52:55], v[24:27], v[176:183], v2
    ds_read_b128 v[24:27], v0 offset:4096
    s_waitcnt vmcnt(0)
    ds_write_b32 v62, v60 offset:5120
    v_max3_u32 v63, v56, v58, v60
    s_waitcnt lgkmcnt(5)
    v_smfmac_f32_16x16x64_bf16 v[8:11], v[28:31], v[40:47], v2
    ds_read_b128 v[40:43], v1 offset:14336
    v_cmp_eq_u32 vcc, -1, v63
    v_smfmac_f32_16x16x64_bf16 v[12:15], v[28:31], v[184:191], v2
    ds_read_b128 v[44:47], v1 offset:15360
    v_smfmac_f32_16x16x64_bf16 v[16:19], v[28:31], v[192:199], v2
    s_cbranch_vccnz CH_re_94
CH_bk_95:
    v_smfmac_f32_16x16x64_bf16 v[20:23], v[28:31], v[200:207], v2
    s_waitcnt lgkmcnt(2)
    s_barrier
    ds_read_b128 v[28:31], v0 offset:5120
    v_smfmac_f32_16x16x64_bf16 v[8:11], v[24:27], v[208:215], v2
    s_add_u32 s48, s40, s99
    v_mov_b32 v56, s48
    v_smfmac_f32_16x16x64_bf16 v[12:15], v[24:27], v[216:223], v2
    buffer_store_dword v56, off, s[32:35], s18 sc1
    v_smfmac_f32_16x16x64_bf16 v[16:19], v[24:27], v[224:231], v2
    s_add_u32 m0, s63, 0
    s_add_u32 s60, s42, 8192
    buffer_load_dwordx4 v0, s[32:35], s42 offen offset:0 sc1 lds
    v_smfmac_f32_16x16x64_bf16 v[20:23], v[24:27], v[32:39], v2
    ds_read_b128 v[24:27], v0 offset:6144
    ds_read_b128 v[32:35], v1 offset:16384
    s_waitcnt lgkmcnt(2)
    v_smfmac_f32_16x16x64_bf16 v[8:11], v[28:31], v[232:239], v2
    ds_read_b128 v[36:39], v1 offset:17408
    v_smfmac_f32_16x16x64_bf16 v[12:15], v[28:31], v[240:247], v2
    v_smfmac_f32_16x16x64_bf16 v[16:19], v[28:31], v[248:255], v2
    buffer_load_dwordx4 v0, s[32:35], s42 offen offset:1024 sc1 lds
    v_smfmac_f32_16x16x64_bf16 v[20:23], v[28:31], a[0:7], v2
    ds_read_b128 v[28:31], v0 offset:7168
    s_waitcnt lgkmcnt(3)
    v_smfmac_f32_16x16x64_bf16 v[8:11], v[24:27], v[40:47], v2
    ds_read_b128 v[40:43], v1 offset:18432
    ds_read_b128 v[44:47], v1 offset:19456
    v_smfmac_f32_16x16x64_bf16 v[12:15], v[24:27], a[8:15], v2
    v_smfmac_f32_16x16x64_bf16 v[16:19], v[24:27], a[16:23], v2
    s_add_u32 m0, s64, 0
    s_add_u32 s42, s42, 524288
    buffer_load_dwordx4 v0, s[32:35], s60 offen offset:0 sc1 lds
    v_smfmac_f32_16x16x64_bf16 v[20:23], v[24:27], a[24:31], v2
    ds_read_b128 v[24:27], v0 offset:8192
    s_waitcnt lgkmcnt(3)
    v_smfmac_f32_16x16x64_bf16 v[8:11], v[28:31], v[32:39], v2
    ds_read_b128 v[32:35], v0 offset:9216
    v_smfmac_f32_16x16x64_bf16 v[12:15], v[28:31], a[32:39], v2
    v_smfmac_f32_16x16x64_bf16 v[16:19], v[28:31], a[40:47], v2
    buffer_load_dwordx4 v0, s[32:35], s60 offen offset:1024 sc1 lds
    v_smfmac_f32_16x16x64_bf16 v[20:23], v[28:31], a[48:55], v2
    ds_read_b128 v[28:31], v0 offset:3072
    s_waitcnt lgkmcnt(2)
    v_smfmac_f32_16x16x64_bf16 v[8:11], v[24:27], a[56:63], v2
    ds_read_b128 v[56:59], v0 offset:26624
    ds_read_b128 v[60:63], v0 offset:27648
    v_smfmac_f32_16x16x64_bf16 v[12:15], v[24:27], v[40:47], v2
    s_waitcnt lgkmcnt(3)
    v_smfmac_f32_16x16x64_bf16 v[8:11], v[32:35], a[64:71], v2
    ds_read_b128 v[40:43], v0 offset:24576
    ds_read_b128 v[44:47], v0 offset:25600
    v_smfmac_f32_16x16x64_bf16 v[12:15], v[32:35], a[72:79], v2
    s_mov_b32 m0, 15360
    s_mov_b32 exec_hi, 0
    buffer_load_dwordx4 v0, s[32:35], s98 offen offset:0 sc1 lds
    s_mov_b32 exec_hi, -1
    v_smfmac_f32_16x16x64_bf16 v[16:19], v[24:27], a[80:87], v2
    v_add_f32 v8, v8, v10
    v_smfmac_f32_16x16x64_bf16 v[16:19], v[32:35], a[88:95], v2
    v_add_f32 v9, v9, v11
    v_add_f32 v12, v12, v14
    v_smfmac_f32_16x16x64_bf16 v[20:23], v[24:27], a[96:103], v2
    ds_read_b128 v[24:27], v0 offset:4096
    v_add_f32 v13, v13, v15
    v_cvt_pk_bf16_f32 v8, v8, v9
    v_smfmac_f32_16x16x64_bf16 v[20:23], v[32:35], a[104:111], v2
    s_waitcnt lgkmcnt(5)
    ds_read_b128 v[32:35], v0 offset:5120
    v_cvt_pk_bf16_f32 v9, v12, v13
    v_add_f32 v16, v16, v18
    v_add_f32 v17, v17, v19
    v_smfmac_f32_16x16x64_bf16 v[48:51], v[28:31], a[112:119], v2
    ds_write_b64 v3, v[8:9]
    v_cvt_pk_bf16_f32 v10, v16, v17
    v_add_f32 v20, v20, v22
    v_add_f32 v21, v21, v23
    v_cvt_pk_bf16_f32 v11, v20, v21
    v_smfmac_f32_16x16x64_bf16 v[52:55], v[28:31], a[120:127], v2
    s_waitcnt lgkmcnt(2)
    ds_write_b64 v3, v[10:11] offset:2176
    v_smfmac_f32_16x16x64_bf16 v[48:51], v[24:27], a[128:135], v2
    ds_read_b128 v[28:31], v0 offset:6144
    v_lshrrev_b32 v12, 1, v0
    v_smfmac_f32_16x16x64_bf16 v[52:55], v[24:27], a[136:143], v2
    s_waitcnt lgkmcnt(3)
    ds_read_b128 v[24:27], v0 offset:7168
    v_permlane16_swap_b32 v10, v11
    v_smfmac_f32_16x16x64_bf16 v[48:51], v[32:35], a[144:151], v2
    buffer_store_dwordx2 v[10:11], v12, s[32:35], s96 offen sc1
    s_waitcnt lgkmcnt(2)
    s_barrier
    ds_read_b64_tr_b16 v[12:13], v4 offset:0
    ds_read_b64_tr_b16 v[14:15], v4 offset:32
    v_smfmac_f32_16x16x64_bf16 v[52:55], v[32:35], a[152:159], v2
    s_waitcnt lgkmcnt(3)
    ds_read_b64_tr_b16 v[16:17], v4 offset:1088
    ds_read_b64_tr_b16 v[18:19], v4 offset:1120
    ds_read_b64_tr_b16 v[20:21], v4 offset:2176
    v_smfmac_f32_16x16x64_bf16 v[48:51], v[28:31], a[160:167], v2
    ds_read_b64_tr_b16 v[22:23], v4 offset:2208
    ds_read_b64_tr_b16 v[36:37], v4 offset:3264
    ds_read_b64_tr_b16 v[38:39], v4 offset:3296
    v_smfmac_f32_16x16x64_bf16 v[52:55], v[28:31], a[168:175], v2
    s_waitcnt lgkmcnt(8)
    ds_read_b128 v[32:35], v0 offset:30720
    ds_read_b128 v[28:31], v0 offset:29696
    v_smfmac_f32_16x16x64_bf16 v[48:51], v[24:27], a[176:183], v2
    v_smfmac_f32_16x16x64_bf16 v[52:55], v[24:27], a[184:191], v2
    ds_read_b128 v[24:27], v0 offset:28672
    s_waitcnt lgkmcnt(9)
    v_mfma_f32_16x16x32_bf16 v[8:11], v[40:43], v[12:15], 0
    s_waitcnt lgkmcnt(7)
    v_mfma_f32_16x16x32_bf16 v[8:11], v[44:47], v[16:19], v[8:11]
    ds_read_b128 v[44:47], v0 offset:31744
    v_mfma_f32_16x16x32_bf16 v[40:43], v[56:59], v[12:15], 0
    v_mfma_f32_16x16x32_bf16 v[40:43], v[60:63], v[16:19], v[40:43]
    s_waitcnt lgkmcnt(6)
    ds_read_b128 v[60:63], v0 offset:8192
    v_add_f32_dpp v8, v10, v8 quad_perm:[2,3,2,3] row_mask:0xf bank_mask:0xf
    v_mfma_f32_16x16x32_bf16 v[56:59], v[20:23], v[12:15], 0
    s_waitcnt lgkmcnt(5)
    v_add_f32_dpp v9, v11, v9 quad_perm:[2,3,2,3] row_mask:0xf bank_mask:0xf
    v_max_f32 v10, v8, v9
    v_mfma_f32_16x16x32_bf16 v[56:59], v[36:39], v[16:19], v[56:59]
    s_waitcnt lgkmcnt(2)
    ds_read_b128 v[36:39], v0 offset:9216
    v_add_f32_dpp v40, v42, v40 quad_perm:[2,3,2,3] row_mask:0xf bank_mask:0xf
    v_mfma_f32_16x16x32_bf16 v[20:23], v[24:27], v[12:15], 0
    v_add_f32_dpp v41, v43, v41 quad_perm:[2,3,2,3] row_mask:0xf bank_mask:0xf
    v_max3_f32 v10, v10, v40, v41
    v_mfma_f32_16x16x32_bf16 v[20:23], v[28:31], v[16:19], v[20:23]
    v_add_f32_dpp v56, v58, v56 quad_perm:[2,3,2,3] row_mask:0xf bank_mask:0xf
    v_mfma_f32_16x16x32_bf16 v[24:27], v[32:35], v[12:15], 0
    s_waitcnt lgkmcnt(2)
    v_add_f32_dpp v57, v59, v57 quad_perm:[2,3,2,3] row_mask:0xf bank_mask:0xf
    v_max3_f32 v10, v10, v56, v57
    v_mfma_f32_16x16x32_bf16 v[24:27], v[44:47], v[16:19], v[24:27]
    s_waitcnt lgkmcnt(1)
    v_add_f32_dpp v20, v22, v20 quad_perm:[2,3,2,3] row_mask:0xf bank_mask:0xf
    v_add_f32_dpp v21, v23, v21 quad_perm:[2,3,2,3] row_mask:0xf bank_mask:0xf
    v_smfmac_f32_16x16x64_bf16 v[48:51], v[60:63], a[192:199], v2
    ds_read_b128 v[32:35], v1 offset:2048
    v_max3_f32 v10, v10, v20, v21
    v_mov_b32 v17, 0
    s_nop 0
    v_add_f32_dpp v24, v26, v24 quad_perm:[2,3,2,3] row_mask:0xf bank_mask:0xf
    v_add_f32_dpp v25, v27, v25 quad_perm:[2,3,2,3] row_mask:0xf bank_mask:0xf
    v_max3_f32 v10, v10, v24, v25
    v_mov_b32 v11, v10
    v_smfmac_f32_16x16x64_bf16 v[52:55], v[60:63], a[200:207], v2
    s_waitcnt lgkmcnt(1)
    ds_read_b128 v[44:47], v1 offset:3072
    v_permlane32_swap_b32 v10, v11
    v_max_f32 v10, v10, v11
    v_mov_b32 v11, v10
    v_smfmac_f32_16x16x64_bf16 v[48:51], v[36:39], a[208:215], v2
    s_barrier
    v_permlane16_swap_b32 v10, v11
    v_max_f32 v10, v10, v11
    v_mul_f32 v10, s51, v10
    v_fma_f32 v8, v8, s51, -v10
    v_smfmac_f32_16x16x64_bf16 v[52:55], v[36:39], a[216:223], v2
    v_fma_f32 v9, v9, s51, -v10
    v_exp_f32 v8, v8
    v_fma_f32 v40, v40, s51, -v10
    v_exp_f32 v9, v9
    v_fma_f32 v41, v41, s51, -v10
    v_exp_f32 v40, v40
    v_cvt_pk_bf16_f32 v12, v8, v9
    v_fma_f32 v20, v20, s51, -v10
    v_exp_f32 v41, v41
    v_fma_f32 v21, v21, s51, -v10
    v_exp_f32 v20, v20
    v_cvt_pk_bf16_f32 v13, v40, v41
    v_fma_f32 v24, v24, s51, -v10
    v_exp_f32 v21, v21
    v_fma_f32 v25, v25, s51, -v10
    v_exp_f32 v24, v24
    v_cvt_pk_bf16_f32 v14, v20, v21
    v_fma_f32 v56, v56, s51, -v10
    v_exp_f32 v25, v25
    v_mov_b64 v[28:29], s[22:23]
    v_mov_b64 v[30:31], s[22:23]
    v_cvt_pk_bf16_f32 v15, v24, v25
    v_fma_f32 v57, v57, s51, -v10
    v_exp_f32 v56, v56
    v_mfma_f32_16x16x32_bf16 v[60:63], v[28:31], v[12:15], 0
    v_exp_f32 v57, v57
    s_waitcnt lgkmcnt(1)
    v_mfma_f32_16x16x32_bf16 v[32:35], v[32:35], v[12:15], 0
    v_cvt_pk_bf16_f32 v16, v56, v57
    v_add_f32 v48, v48, v50
    s_waitcnt lgkmcnt(0)
    v_mfma_f32_16x16x32_bf16 v[44:47], v[44:47], v[12:15], 0
    v_add_f32 v49, v49, v51
    v_add_f32 v52, v52, v54
    v_mfma_f32_16x16x16_bf16 v[60:63], v[28:29], v[16:17], v[60:63]
    v_add_f32 v53, v53, v55
    v_cvt_pk_bf16_f32 v22, v48, v49
    v_cvt_pk_bf16_f32 v23, v52, v53
    v_mov_b32 v18, 0
    v_mov_b32 v19, v16
    v_mfma_f32_16x16x16_bf16 v[32:35], v[22:23], v[16:17], v[32:35]
    ds_read_b128 v[48:51], v1 offset:20480
    ds_read_b128 v[52:55], v1 offset:21504
    v_mfma_f32_16x16x16_bf16 v[44:47], v[22:23], v[18:19], v[44:47]
    ds_read_b128 v[36:39], v1 offset:24576
    ds_read_b128 v[40:43], v1 offset:25600
    v_rcp_f32 v10, v60
    v_mov_b64 v[12:13], 0
    v_lshrrev_b32 v14, 1, v0
    v_permlane16_swap_b32 v22, v23
    v_pk_mul_f32 v[32:33], v[32:33], v[10:11] op_sel_hi:[1,0]
    v_pk_mul_f32 v[34:35], v[34:35], v[10:11] op_sel_hi:[1,0]
    v_cvt_pk_bf16_f32 v32, v32, v33
    v_cvt_pk_bf16_f32 v33, v34, v35
    v_pk_mul_f32 v[44:45], v[44:45], v[10:11] op_sel_hi:[1,0]
    v_pk_mul_f32 v[46:47], v[46:47], v[10:11] op_sel_hi:[1,0]
    v_cvt_pk_bf16_f32 v34, v44, v45
    v_cvt_pk_bf16_f32 v35, v46, v47
    v_mfma_f32_16x16x16_bf16 v[16:19], v[12:13], v[12:13], 0
    ds_write_b128 v5, v[32:35]
    buffer_store_dwordx2 v[22:23], v14, s[32:35], s97 offen sc1
    s_cmp_eq_u32 s40, 63
    s_cbranch_scc1 CH_exit_79
    v_mfma_f32_16x16x16_bf16 v[20:23], v[12:13], v[12:13], 0
    ds_read_b128 v[56:59], v1 offset:22528
    ds_read_b128 v[60:63], v1 offset:23552
    v_mfma_f32_16x16x16_bf16 v[24:27], v[12:13], v[12:13], 0
    v_mfma_f32_16x16x16_bf16 v[28:31], v[12:13], v[12:13], 0
    v_mfma_f32_16x16x16_bf16 v[8:11], v[12:13], v[12:13], 0
    s_waitcnt lgkmcnt(2)
    s_barrier
    ds_read_b128 v[32:35], v0 offset:10240
    ds_read_b128 v[44:47], v0 offset:11264
    v_lshlrev_b32 v15, 3, v0
    v_bfe_u32 v14, v0, 2, 6
    v_and_or_b32 v14, v15, s94, v14
    s_waitcnt lgkmcnt(1)
    v_smfmac_f32_16x16x64_bf16 v[16:19], v[32:35], v[48:55], v2
    ds_read_b128 v[48:51], v1 offset:26624
    ds_read_b128 v[52:55], v1 offset:27648
    s_waitcnt lgkmcnt(2)
    v_smfmac_f32_16x16x64_bf16 v[16:19], v[44:47], v[56:63], v2
    ds_read_b128 v[56:59], v1 offset:28672
    ds_read_b128 v[60:63], v1 offset:29696
    v_smfmac_f32_16x16x64_bf16 v[20:23], v[32:35], v[36:43], v2
    ds_read_b128 v[36:39], v1 offset:30720
    ds_read_b128 v[40:43], v1 offset:31744
    v_smfmac_f32_16x16x64_bf16 v[20:23], v[44:47], a[224:231], v2
    v_add_f32 v16, v16, v18
    v_add_f32 v17, v17, v19
    v_smfmac_f32_16x16x64_bf16 v[24:27], v[32:35], a[232:239], v2
    v_smfmac_f32_16x16x64_bf16 v[24:27], v[44:47], a[240:247], v2
    s_waitcnt lgkmcnt(4)
    v_add_f32 v20, v20, v22
    v_add_f32 v21, v21, v23
    v_smfmac_f32_16x16x64_bf16 v[28:31], v[32:35], v[48:55], v2
    v_cvt_pk_bf16_f32 v16, v16, v20
    v_cvt_pk_bf16_f32 v17, v17, v21
    v_smfmac_f32_16x16x64_bf16 v[28:31], v[44:47], a[248:255], v2
    s_waitcnt lgkmcnt(2)
    v_and_or_b32 v16, v16, -2, 0
    v_smfmac_f32_16x16x64_bf16 v[8:11], v[32:35], v[56:63], v2
    s_waitcnt lgkmcnt(0)
    buffer_store_dwordx2 v[16:17], v7, s[28:31], 0 offen sc1
    v_add_f32 v24, v24, v26
    v_add_f32 v25, v25, v27
    v_smfmac_f32_16x16x64_bf16 v[8:11], v[44:47], v[36:43], v2
    v_add_f32 v28, v28, v30
    v_add_f32 v29, v29, v31
    s_cmp_eq_u32 s21, 3
    v_cvt_pk_bf16_f32 v24, v24, v28
    v_cvt_pk_bf16_f32 v25, v25, v29
    v_and_or_b32 v24, v24, -2, 0
    buffer_store_dwordx2 v[24:25], v7, s[28:31], s61 offen sc1
    s_nop 0
    v_add_f32 v8, v8, v10
    v_add_f32 v9, v9, v11
    v_cvt_pk_bf16_f32 v8, v8, v9
    v_and_or_b32 v8, v8, -2, 0
    buffer_store_dword v8, v14, s[28:31], s62 offen sc1
    s_cbranch_scc1 CH_h_96
    v_lshrrev_b32 v56, s91, v0
    v_and_b32 v56, 16, v56
    v_lshlrev_b32_e64 v56, v56, s65
    v_cndmask_b32 v40, 0, v56, s[52:53]
    v_cndmask_b32 v41, 0, v56, s[54:55]
    v_cndmask_b32 v42, 0, v56, s[56:57]
    v_cndmask_b32 v43, 0, v56, s[58:59]
    v_mov_b64 v[58:59], -1
    s_mov_b32 s44, s43
    s_add_u32 s43, s43, 0x2000
    s_and_b32 s43, s43, 0x7fff
    s_add_u32 s43, s43, 163840
    s_mov_b32 s49, 0
    s_add_u32 s40, s40, 1
    s_add_u32 s90, s90, 32768
    s_add_u32 s96, s96, 131072
    s_add_u32 s97, s97, 131072
    s_cmp_lg_u32 s95, 0
    s_cbranch_scc1 CH_nt_100
    s_nop 5
    s_cmp_le_u32 s21, 0
    s_cbranch_scc1 CH_d_102
    s_nop 7
    s_cmp_le_u32 s21, 1
    s_cbranch_scc1 CH_d_102
    s_nop 7
CH_d_102:
    buffer_load_dwordx4 v[32:35], v0, s[28:31], s46 offen offset:0 sc1
    buffer_load_dwordx4 v[36:39], v0, s[28:31], s46 offen offset:1024 sc1
    v_add_u32 v61, s92, v0
    v_lshrrev_b32 v62, 2, v0
    v_add_u32 v62, s93, v62
    v_mov_b64 v[8:9], 0
    v_mov_b64 v[10:11], 0
    v_mov_b64 v[12:13], 0
    v_mov_b64 v[14:15], 0
    v_mov_b64 v[48:49], 0
    v_mov_b64 v[50:51], 0
    v_mov_b64 v[52:53], 0
    v_mov_b64 v[54:55], 0
    s_cmp_eq_u32 s21, 2
    s_cselect_b32 s47, 1, 0
    s_nop 15
    buffer_load_dwordx4 v[24:27], v0, s[28:31], s46 offen offset:0 sc1
    buffer_load_dwordx4 v[28:31], v0, s[28:31], s46 offen offset:1024 sc1
CH_h_99:
    s_waitcnt vmcnt(3)
    v_mfma_f32_16x16x32_bf16 v[44:47], v[40:43], v[32:35], 0
    s_waitcnt vmcnt(2)
    v_mfma_f32_16x16x32_bf16 v[44:47], v[40:43], v[36:39], v[44:47]
    v_bitop3_b32 v56, v33, v35, v37 bitop3:0xfe
    v_bitop3_b32 v57, v32, v34, v36 bitop3:0xfe
    v_bitop3_b32 v56, v56, v39, s47 bitop3:0xa8
    v_bitop3_b32 v56, v56, v57, v38 bitop3:0xfe
    v_and_b32 v56, 1, v56
    v_cmp_ne_u32 vcc, 0, v56
CH_ok_103:
    s_nop 1
    v_add_f32_dpp v44, v44, v44 row_ror:8 row_mask:0xf bank_mask:0xf
    v_add_f32_dpp v45, v45, v45 row_ror:8 row_mask:0xf bank_mask:0xf
    v_add_f32_dpp v46, v46, v46 row_ror:8 row_mask:0xf bank_mask:0xf
    v_add_f32_dpp v47, v47, v47 row_ror:8 row_mask:0xf bank_mask:0xf
    v_add_f32_dpp v44, v44, v44 row_ror:4 row_mask:0xf bank_mask:0xf
    v_add_f32_dpp v45, v45, v45 row_ror:4 row_mask:0xf bank_mask:0xf
    v_add_f32_dpp v46, v46, v46 row_ror:4 row_mask:0xf bank_mask:0xf
    v_add_f32_dpp v47, v47, v47 row_ror:4 row_mask:0xf bank_mask:0xf
    v_cvt_pk_bf16_f32 v56, v44, v45
    v_cvt_pk_bf16_f32 v57, v46, v47
    v_min_u32 v56, -2, v56
    v_min_u32 v57, -2, v57
    s_cbranch_vccnz CH_h_98
    buffer_store_dwordx2 v[56:57], v6, s[28:31], s43 offen sc1
CH_x0_101:
    s_barrier
    buffer_store_dwordx2 v[56:57], v6, s[36:39], s50 offen sc1
    buffer_store_dwordx2 v[58:59], v6, s[28:31], s44 offen sc1
    s_add_u32 s50, s50, 32768
    v_mov_b64 v[16:17], 0
    v_mov_b64 v[18:19], 0
    v_mov_b64 v[20:21], 0
    v_mov_b64 v[22:23], 0
    s_nop 15
    s_nop 15
    s_nop 15
    s_nop 15
    s_nop 3
    s_branch CH_h_97
CH_h_96:
    v_add_u32 v61, s92, v0
    v_lshrrev_b32 v62, 2, v0
    v_add_u32 v62, s93, v62
    v_mov_b64 v[48:49], 0
    v_mov_b64 v[50:51], 0
    v_mov_b64 v[52:53], 0
    v_mov_b64 v[54:55], 0
    s_mov_b32 s44, s43
    s_add_u32 s43, s43, 0x2000
    s_and_b32 s43, s43, 0x7fff
    s_add_u32 s43, s43, 163840
    s_mov_b32 s49, 0
    s_add_u32 s40, s40, 1
    s_add_u32 s90, s90, 32768
    s_add_u32 s96, s96, 131072
    s_add_u32 s97, s97, 131072
    v_mfma_f32_32x32x2_f32 v[8:23], v48, v48, 0
    v_mfma_f32_32x32x2_f32 v[8:23], v48, v48, v[8:23]
    v_mfma_f32_32x32x2_f32 v[8:23], v48, v48, v[8:23]
    v_mfma_f32_32x32x2_f32 v[8:23], v48, v48, v[8:23]
    v_mfma_f32_32x32x2_f32 v[8:23], v48, v48, v[8:23]
    s_waitcnt vmcnt(0)
    v_and_b32 v40, 0x180, v0
    ds_read_b32 v41, v40 offset:15360
    s_add_u32 s47, s40, 2
    s_min_u32 s47, s47, 64
    s_add_u32 s47, s47, s99
CH_fb_105:
    s_waitcnt lgkmcnt(0)
    v_cmp_gt_u32 vcc, s47, v41
    s_cbranch_vccnz CH_fp_104
    v_mfma_f32_32x32x2_f32 v[8:23], v48, v48, v[8:23]
    s_barrier
    s_nop 15
    s_nop 15
    s_nop 15
    s_nop 15
    s_nop 15
CH_h_97:
    buffer_load_dwordx4 v[24:27], v61, s[28:31], s43 offen sc1
    buffer_load_dword v28, v62, s[28:31], s43 offen sc1
    s_waitcnt vmcnt(1)
    ds_write_b128 v61, v[24:27] offset:0
    s_waitcnt vmcnt(0)
    ds_write_b32 v62, v28 offset:0
    v_max3_u32 v63, v24, v26, v28
    v_cmp_eq_u32 vcc, -1, v63
    s_cbranch_vccnz CH_re_106
CH_bk_107:
    buffer_load_dwordx4 v[56:59], v61, s[36:39], s90 offen sc1
    buffer_load_dword v60, v62, s[36:39], s90 offen sc1
    s_branch CH_top_78
CH_re_80:
    buffer_load_dwordx4 v[56:59], v61, s[36:39], s90 offen sc1
    buffer_load_dword v60, v62, s[36:39], s90 offen sc1
    s_add_u32 s49, s49, 1
    s_cmp_gt_u32 s49, 400000
    s_cbranch_scc1 L_end
    s_waitcnt vmcnt(0)
    v_max3_u32 v63, v56, v58, v60
    v_cmp_eq_u32 vcc, -1, v63
    s_cbranch_vccnz CH_re_80
    ds_write_b128 v61, v[56:59] offset:5120
    ds_write_b32 v62, v60 offset:5120
    s_waitcnt lgkmcnt(0)
    s_branch CH_bk_81
CH_nt_86:
    v_add_u32 v61, s92, v0
    v_lshrrev_b32 v62, 2, v0
    v_add_u32 v62, s93, v62
    v_mov_b64 v[8:9], 0
    v_mov_b64 v[10:11], 0
    v_mov_b64 v[12:13], 0
    v_mov_b64 v[14:15], 0
    v_mov_b64 v[16:17], 0
    v_mov_b64 v[18:19], 0
    v_mov_b64 v[20:21], 0
    v_mov_b64 v[22:23], 0
    v_mov_b64 v[48:49], 0
    v_mov_b64 v[50:51], 0
    v_mov_b64 v[52:53], 0
    v_mov_b64 v[54:55], 0
    s_waitcnt vmcnt(0)
    s_branch CH_x0_87
CH_h_84:
    buffer_load_dwordx4 v[32:35], v0, s[28:31], s46 offen offset:0 sc1
    buffer_load_dwordx4 v[36:39], v0, s[28:31], s46 offen offset:1024 sc1
    s_waitcnt vmcnt(3)
    v_mfma_f32_16x16x32_bf16 v[44:47], v[40:43], v[24:27], 0
    s_waitcnt vmcnt(2)
    v_mfma_f32_16x16x32_bf16 v[44:47], v[40:43], v[28:31], v[44:47]
    v_bitop3_b32 v56, v25, v27, v29 bitop3:0x80
    v_bitop3_b32 v57, v24, v26, v28 bitop3:0x80
    v_bitop3_b32 v56, v56, v31, s47 bitop3:0xea
    v_bitop3_b32 v56, v56, v57, v30 bitop3:0x80
    v_and_b32 v56, 1, v56
    v_cmp_ne_u32 vcc, 1, v56
    s_cbranch_vccz CH_ok_89
    buffer_load_dwordx4 v[24:27], v0, s[28:31], s46 offen offset:0 sc1
    buffer_load_dwordx4 v[28:31], v0, s[28:31], s46 offen offset:1024 sc1
    s_add_u32 s49, s49, 1
    s_cmp_gt_u32 s49, 400000
    s_cbranch_scc1 L_end
    s_branch CH_h_85
CH_fp_90:
    buffer_load_dword v41, v40, s[32:35], s98 offen sc1
    s_add_u32 s49, s49, 1
    s_cmp_gt_u32 s49, 400000
    s_cbranch_scc1 L_end
    s_waitcnt vmcnt(0)
    s_branch CH_fb_91
CH_re_92:
    buffer_load_dwordx4 v[24:27], v61, s[28:31], s43 offen sc1
    buffer_load_dword v28, v62, s[28:31], s43 offen sc1
    s_add_u32 s49, s49, 1
    s_cmp_gt_u32 s49, 400000
    s_cbranch_scc1 L_end
    s_waitcnt vmcnt(0)
    v_max3_u32 v63, v24, v26, v28
    v_cmp_eq_u32 vcc, -1, v63
    s_cbranch_vccnz CH_re_92
    ds_write_b128 v61, v[24:27] offset:0
    ds_write_b32 v62, v28 offset:0
    s_waitcnt lgkmcnt(0)
    s_branch CH_bk_93
CH_re_94:
    buffer_load_dwordx4 v[56:59], v61, s[36:39], s90 offen sc1
    buffer_load_dword v60, v62, s[36:39], s90 offen sc1
    s_add_u32 s49, s49, 1
    s_cmp_gt_u32 s49, 400000
    s_cbranch_scc1 L_end
    s_waitcnt vmcnt(0)
    v_max3_u32 v63, v56, v58, v60
    v_cmp_eq_u32 vcc, -1, v63
    s_cbranch_vccnz CH_re_94
    ds_write_b128 v61, v[56:59] offset:5120
    ds_write_b32 v62, v60 offset:5120
    s_waitcnt lgkmcnt(0)
    s_branch CH_bk_95
CH_nt_100:
    v_add_u32 v61, s92, v0
    v_lshrrev_b32 v62, 2, v0
    v_add_u32 v62, s93, v62
    v_mov_b64 v[8:9], 0
    v_mov_b64 v[10:11], 0
    v_mov_b64 v[12:13], 0
    v_mov_b64 v[14:15], 0
    v_mov_b64 v[16:17], 0
    v_mov_b64 v[18:19], 0
    v_mov_b64 v[20:21], 0
    v_mov_b64 v[22:23], 0
    v_mov_b64 v[48:49], 0
    v_mov_b64 v[50:51], 0
    v_mov_b64 v[52:53], 0
    v_mov_b64 v[54:55], 0
    s_waitcnt vmcnt(0)
    s_branch CH_x0_101
CH_h_98:
    buffer_load_dwordx4 v[32:35], v0, s[28:31], s46 offen offset:0 sc1
    buffer_load_dwordx4 v[36:39], v0, s[28:31], s46 offen offset:1024 sc1
    s_waitcnt vmcnt(3)
    v_mfma_f32_16x16x32_bf16 v[44:47], v[40:43], v[24:27], 0
    s_waitcnt vmcnt(2)
    v_mfma_f32_16x16x32_bf16 v[44:47], v[40:43], v[28:31], v[44:47]
    v_bitop3_b32 v56, v25, v27, v29 bitop3:0xfe
    v_bitop3_b32 v57, v24, v26, v28 bitop3:0xfe
    v_bitop3_b32 v56, v56, v31, s47 bitop3:0xa8
    v_bitop3_b32 v56, v56, v57, v30 bitop3:0xfe
    v_and_b32 v56, 1, v56
    v_cmp_ne_u32 vcc, 0, v56
    s_cbranch_vccz CH_ok_103
    buffer_load_dwordx4 v[24:27], v0, s[28:31], s46 offen offset:0 sc1
    buffer_load_dwordx4 v[28:31], v0, s[28:31], s46 offen offset:1024 sc1
    s_add_u32 s49, s49, 1
    s_cmp_gt_u32 s49, 400000
    s_cbranch_scc1 L_end
    s_branch CH_h_99
CH_fp_104:
    buffer_load_dword v41, v40, s[32:35], s98 offen sc1
    s_add_u32 s49, s49, 1
    s_cmp_gt_u32 s49, 400000
    s_cbranch_scc1 L_end
    s_waitcnt vmcnt(0)
    s_branch CH_fb_105
CH_re_106:
    buffer_load_dwordx4 v[24:27], v61, s[28:31], s43 offen sc1
    buffer_load_dword v28, v62, s[28:31], s43 offen sc1
    s_add_u32 s49, s49, 1
    s_cmp_gt_u32 s49, 400000
    s_cbranch_scc1 L_end
    s_waitcnt vmcnt(0)
    v_max3_u32 v63, v24, v26, v28
    v_cmp_eq_u32 vcc, -1, v63
    s_cbranch_vccnz CH_re_106
    ds_write_b128 v61, v[24:27] offset:0
    ds_write_b32 v62, v28 offset:0
    s_waitcnt lgkmcnt(0)
    s_branch CH_bk_107
CH_exit_79:
CH_fin_19:
    s_nop 15
    s_nop 3
    s_add_u32 s47, s99, 64
    v_mov_b32 v8, s47
    s_waitcnt vmcnt(0) lgkmcnt(0)
    s_barrier
    buffer_store_dword v8, off, s[32:35], s18 sc1
    s_add_u32 s100, s100, 1
    s_cmp_ge_u32 s100, 2
    s_cbranch_scc1 L_end
    s_add_u32 s28, s28, 393216
    s_addc_u32 s29, s29, 0
    s_waitcnt vmcnt(0)
    s_branch CH_layer_15
L_end:
    s_endpgm
L_worker:
    s_sub_u32 s3, s3, 2
    s_lshl_b32 s3, s3, 5
    s_add_u32 s28, s3, s2
    v_readfirstlane_b32 s29, v1
    v_and_b32 v1, 63, v0
    v_lshlrev_b32 v0, 4, v1
    s_load_dwordx2 s[4:5], s[0:1], 96
    s_mov_b32 s6, 268435456
    s_mov_b32 s7, 0x20000
    s_waitcnt lgkmcnt(0)
    s_load_dwordx2 s[8:9], s[0:1], 0
    s_mov_b32 s10, 2621440
    s_mov_b32 s11, 0x20000
    s_waitcnt lgkmcnt(0)
    s_load_dwordx2 s[12:13], s[0:1], 80
    s_mov_b32 s14, 2621440
    s_mov_b32 s15, 0x20000
    s_waitcnt lgkmcnt(0)
    s_load_dwordx2 s[24:25], s[0:1], 88
    s_mov_b32 s26, 256
    s_mov_b32 s27, 0x20000
    s_waitcnt lgkmcnt(0)
    s_mul_i32 s60, s29, 20480
    s_add_u32 s60, s60, 69632
    s_mov_b32 s30, 0
    s_mov_b32 s61, 0
    s_cmp_lt_u32 s28, 190
    s_cbranch_scc1 I_108
    v_mov_b64 v[4:5], 0
    v_mov_b64 v[6:7], 0
    v_bfe_u32 v9, v1, 2, 4
    v_mul_u32_u24 v9, 128, v9
    v_bfe_u32 v8, v1, 0, 2
    v_lshl_add_u32 v9, v8, 4, v9
    s_and_b32 s34, s28, 1
    s_lshl_b32 s34, s34, 2
    s_add_u32 s32, s34, s29
    s_mul_i32 s32, s32, 24576
    s_add_u32 s33, s32, 1048576
    buffer_store_dwordx4 v[4:7], v9, s[4:7], s33 offen sc1
    s_add_u32 s33, s32, 1050624
    buffer_store_dwordx4 v[4:7], v9, s[4:7], s33 offen sc1
    s_add_u32 s33, s32, 1052672
    buffer_store_dwordx4 v[4:7], v9, s[4:7], s33 offen sc1
    s_add_u32 s33, s32, 1054720
    buffer_store_dwordx4 v[4:7], v9, s[4:7], s33 offen sc1
    s_add_u32 s33, s32, 1056768
    buffer_store_dwordx4 v[4:7], v9, s[4:7], s33 offen sc1
    s_add_u32 s33, s32, 1058816
    buffer_store_dwordx4 v[4:7], v9, s[4:7], s33 offen sc1
    s_add_u32 s33, s32, 1060864
    buffer_store_dwordx4 v[4:7], v9, s[4:7], s33 offen sc1
    s_add_u32 s33, s32, 1062912
    buffer_store_dwordx4 v[4:7], v9, s[4:7], s33 offen sc1
    s_add_u32 s33, s32, 1064960
    buffer_store_dwordx4 v[4:7], v9, s[4:7], s33 offen sc1
    s_add_u32 s33, s32, 1067008
    buffer_store_dwordx4 v[4:7], v9, s[4:7], s33 offen sc1
    s_add_u32 s33, s32, 1069056
    buffer_store_dwordx4 v[4:7], v9, s[4:7], s33 offen sc1
    s_add_u32 s33, s32, 1071104
    buffer_store_dwordx4 v[4:7], v9, s[4:7], s33 offen sc1
    s_waitcnt vmcnt(0)
    s_barrier
    v_mov_b32 v8, 1
    buffer_store_dword v8, off, s[24:27], s34 offset:8 sc1
I_108:
    s_mul_i32 s66, s28, 6554
    s_lshr_b32 s66, s66, 16
    s_mul_i32 s67, s66, 10
    s_sub_u32 s67, s28, s67
    s_mul_i32 s63, s28, 10923
    s_lshr_b32 s63, s63, 16
    s_mul_i32 s65, s63, 6
    s_sub_u32 s65, s28, s65
    s_lshr_b32 s64, s65, 1
    s_and_b32 s65, s65, 1
    s_cmp_ge_u32 s28, 160
    s_cbranch_scc1 R_109
    s_load_dwordx2 s[16:17], s[0:1], 8
    s_mov_b32 s18, 1314816
    s_mov_b32 s19, 0x20000
    s_waitcnt lgkmcnt(0)
    s_load_dwordx2 s[20:21], s[0:1], 16
    s_mov_b32 s22, 1314816
    s_mov_b32 s23, 0x20000
    s_waitcnt lgkmcnt(0)
    s_lshl_b32 s34, s28, 2
    s_add_u32 s34, s34, s29
    s_mul_i32 s35, s34, 13108
    s_lshr_b32 s35, s35, 16
    s_mul_i32 s36, s35, 5
    s_sub_u32 s36, s34, s36
    s_lshr_b32 s37, s35, 1
    s_and_b32 s38, s35, 1
    s_lshl_b32 s38, s38, 8
    s_add_u32 s37, s37, s38
    s_mul_i32 s37, s37, 642
    s_lshl_b32 s38, s36, 7
    s_add_u32 s37, s37, s38
    v_lshlrev_b32 v248, 1, v1
    s_add_u32 s38, s37, 2
    buffer_load_ushort v216, v248, s[16:19], s38 offen
    buffer_load_ushort v232, v248, s[20:23], s38 offen
    s_add_u32 s38, s37, 41090
    buffer_load_ushort v217, v248, s[16:19], s38 offen
    buffer_load_ushort v233, v248, s[20:23], s38 offen
    s_add_u32 s38, s37, 82178
    buffer_load_ushort v218, v248, s[16:19], s38 offen
    buffer_load_ushort v234, v248, s[20:23], s38 offen
    s_add_u32 s38, s37, 123266
    buffer_load_ushort v219, v248, s[16:19], s38 offen
    buffer_load_ushort v235, v248, s[20:23], s38 offen
    s_add_u32 s38, s37, 328706
    buffer_load_ushort v220, v248, s[16:19], s38 offen
    buffer_load_ushort v236, v248, s[20:23], s38 offen
    s_add_u32 s38, s37, 369794
    buffer_load_ushort v221, v248, s[16:19], s38 offen
    buffer_load_ushort v237, v248, s[20:23], s38 offen
    s_add_u32 s38, s37, 410882
    buffer_load_ushort v222, v248, s[16:19], s38 offen
    buffer_load_ushort v238, v248, s[20:23], s38 offen
    s_add_u32 s38, s37, 451970
    buffer_load_ushort v223, v248, s[16:19], s38 offen
    buffer_load_ushort v239, v248, s[20:23], s38 offen
    s_add_u32 s38, s37, 657410
    buffer_load_ushort v224, v248, s[16:19], s38 offen
    buffer_load_ushort v240, v248, s[20:23], s38 offen
    s_add_u32 s38, s37, 698498
    buffer_load_ushort v225, v248, s[16:19], s38 offen
    buffer_load_ushort v241, v248, s[20:23], s38 offen
    s_add_u32 s38, s37, 739586
    buffer_load_ushort v226, v248, s[16:19], s38 offen
    buffer_load_ushort v242, v248, s[20:23], s38 offen
    s_add_u32 s38, s37, 780674
    buffer_load_ushort v227, v248, s[16:19], s38 offen
    buffer_load_ushort v243, v248, s[20:23], s38 offen
    s_add_u32 s38, s37, 986114
    buffer_load_ushort v228, v248, s[16:19], s38 offen
    buffer_load_ushort v244, v248, s[20:23], s38 offen
    s_add_u32 s38, s37, 1027202
    buffer_load_ushort v229, v248, s[16:19], s38 offen
    buffer_load_ushort v245, v248, s[20:23], s38 offen
    s_add_u32 s38, s37, 1068290
    buffer_load_ushort v230, v248, s[16:19], s38 offen
    buffer_load_ushort v246, v248, s[20:23], s38 offen
    s_add_u32 s38, s37, 1109378
    buffer_load_ushort v231, v248, s[16:19], s38 offen
    buffer_load_ushort v247, v248, s[20:23], s38 offen
    s_mul_i32 s62, s35, 20480
    s_lshl_b32 s38, s36, 10
    s_add_u32 s62, s62, s38
    s_add_u32 s62, s62, 8388608
R_109:
    s_mul_i32 s34, s29, 320
    v_bfe_u32 v2, v1, 0, 2
    v_mul_u32_u24 v2, 1280, v2
    v_bfe_u32 v172, v1, 2, 1
    v_mul_u32_u24 v172, 10240, v172
    v_add_u32 v2, v2, v172
    v_bfe_u32 v172, v1, 3, 1
    v_mul_u32_u24 v172, 5120, v172
    v_add_u32 v2, v2, v172
    v_bfe_u32 v172, v1, 4, 1
    v_mul_u32_u24 v172, 20480, v172
    v_add_u32 v2, v2, v172
    v_bfe_u32 v172, v1, 5, 1
    v_lshl_add_u32 v2, v172, 4, v2
    v_add_u32 v2, s34, v2
    s_lshl_b32 s34, s29, 13
    v_add_u32 v4, s34, v0
    s_lshl_b32 s34, s29, 3
    s_add_u32 s34, s34, 65536
    v_bfe_u32 v5, v1, 0, 5
    v_mul_u32_u24 v5, 32, v5
    v_add_u32 v5, s34, v5
    s_lshl_b32 s35, s29, 11
    s_lshl_b32 s36, s29, 8
    s_add_u32 s36, s36, 67584
    s_lshr_b32 s34, s29, 1
    s_lshl_b32 s34, s34, 12
    s_and_b32 s37, s29, 1
    s_lshl_b32 s37, s37, 8
    s_add_u32 s34, s34, s37
    v_bfe_u32 v3, v1, 1, 1
    v_mul_u32_u24 v3, 2048, v3
    v_bfe_u32 v172, v1, 0, 1
    v_lshl_add_u32 v3, v172, 9, v3
    v_bfe_u32 v172, v1, 2, 4
    v_lshl_add_u32 v3, v172, 4, v3
    v_add_u32 v3, s34, v3
    v_bfe_u32 v10, v1, 0, 2
    v_mul_u32_u24 v10, 32, v10
    v_add_u32 v10, s36, v10
    s_lshl_b32 s34, s29, 10
    v_add_u32 v7, s34, v0
    v_bfe_u32 v6, v1, 0, 5
    v_mul_u32_u24 v6, 32, v6
    v_add_u32 v6, 65536, v6
    v_bfe_u32 v9, v1, 0, 2
    v_mul_u32_u24 v9, 4, v9
    v_bfe_u32 v172, v1, 2, 1
    v_lshl_add_u32 v9, v172, 5, v9
    v_bfe_u32 v172, v1, 3, 1
    v_lshl_add_u32 v9, v172, 4, v9
    v_bfe_u32 v172, v1, 4, 1
    v_lshl_add_u32 v9, v172, 6, v9
    v_add_u32 v9, s36, v9
    s_mov_b32 s44, s66
    s_mov_b32 s47, 19
    s_mov_b32 s46, 64
    s_mov_b32 s50, 0
    s_mov_b32 s52, 0
    s_lshl_b32 s51, s67, 12
    s_add_u32 s51, s51, 20971520
    s_mov_b32 s58, 40960
    s_mul_i32 s54, s44, 40960
    s_add_u32 s56, s54, s52
    s_add_u32 s54, s54, s50
    buffer_load_dwordx4 v[16:19], v2, s[8:11], s54 offen offset:0
    buffer_load_dwordx4 v[20:23], v2, s[8:11], s54 offen offset:32
    buffer_load_dwordx4 v[24:27], v2, s[8:11], s54 offen offset:64
    buffer_load_dwordx4 v[28:31], v2, s[8:11], s54 offen offset:96
    buffer_load_dwordx4 v[32:35], v2, s[8:11], s54 offen offset:128
    buffer_load_dwordx4 v[36:39], v2, s[8:11], s54 offen offset:160
    buffer_load_dwordx4 v[40:43], v2, s[8:11], s54 offen offset:192
    buffer_load_dwordx4 v[44:47], v2, s[8:11], s54 offen offset:224
    buffer_load_dwordx4 v[48:51], v2, s[8:11], s54 offen offset:256
    buffer_load_dwordx4 v[52:55], v2, s[8:11], s54 offen offset:288
    s_lshl_b32 s34, s64, 3
    s_add_u32 s34, s34, 48
    s_cmp_eq_u32 s64, 2
    s_cselect_b32 s34, 40, s34
    s_load_dwordx2 s[20:21], s[0:1], s34
    s_mov_b32 s22, 5242880
    s_mov_b32 s23, 0x20000
    s_waitcnt lgkmcnt(0)
    v_bfe_u32 v14, v1, 2, 4
    v_mul_u32_u24 v14, 8192, v14
    v_bfe_u32 v15, v1, 0, 2
    v_lshl_add_u32 v14, v15, 4, v14
    s_lshl_b32 s38, s29, 6
    s_lshl_b32 s35, s63, 8
    s_add_u32 s38, s38, s35
    s_add_u32 m0, s60, 0
    s_add_u32 s39, s38, 0
    buffer_load_dwordx4 v14, s[20:23], s39 offen lds
    s_add_u32 m0, s60, 1024
    s_add_u32 s39, s38, 131072
    buffer_load_dwordx4 v14, s[20:23], s39 offen lds
    s_add_u32 m0, s60, 2048
    s_add_u32 s39, s38, 262144
    buffer_load_dwordx4 v14, s[20:23], s39 offen lds
    s_add_u32 m0, s60, 3072
    s_add_u32 s39, s38, 393216
    buffer_load_dwordx4 v14, s[20:23], s39 offen lds
    s_add_u32 m0, s60, 4096
    s_add_u32 s39, s38, 524288
    buffer_load_dwordx4 v14, s[20:23], s39 offen lds
    s_add_u32 m0, s60, 5120
    s_add_u32 s39, s38, 655360
    buffer_load_dwordx4 v14, s[20:23], s39 offen lds
    s_add_u32 m0, s60, 6144
    s_add_u32 s39, s38, 786432
    buffer_load_dwordx4 v14, s[20:23], s39 offen lds
    s_add_u32 m0, s60, 7168
    s_add_u32 s39, s38, 917504
    buffer_load_dwordx4 v14, s[20:23], s39 offen lds
    s_add_u32 m0, s60, 8192
    s_add_u32 s39, s38, 1048576
    buffer_load_dwordx4 v14, s[20:23], s39 offen lds
    s_add_u32 m0, s60, 9216
    s_add_u32 s39, s38, 1179648
    buffer_load_dwordx4 v14, s[20:23], s39 offen lds
    s_add_u32 m0, s60, 10240
    s_add_u32 s39, s38, 1310720
    buffer_load_dwordx4 v14, s[20:23], s39 offen lds
    s_add_u32 m0, s60, 11264
    s_add_u32 s39, s38, 1441792
    buffer_load_dwordx4 v14, s[20:23], s39 offen lds
    s_add_u32 m0, s60, 12288
    s_add_u32 s39, s38, 1572864
    buffer_load_dwordx4 v14, s[20:23], s39 offen lds
    s_add_u32 m0, s60, 13312
    s_add_u32 s39, s38, 1703936
    buffer_load_dwordx4 v14, s[20:23], s39 offen lds
    s_add_u32 m0, s60, 14336
    s_add_u32 s39, s38, 1835008
    buffer_load_dwordx4 v14, s[20:23], s39 offen lds
    s_add_u32 m0, s60, 15360
    s_add_u32 s39, s38, 1966080
    buffer_load_dwordx4 v14, s[20:23], s39 offen lds
    s_add_u32 m0, s60, 16384
    s_add_u32 s39, s38, 2097152
    buffer_load_dwordx4 v14, s[20:23], s39 offen lds
    s_add_u32 m0, s60, 17408
    s_add_u32 s39, s38, 2228224
    buffer_load_dwordx4 v14, s[20:23], s39 offen lds
    s_add_u32 m0, s60, 18432
    s_add_u32 s39, s38, 2359296
    buffer_load_dwordx4 v14, s[20:23], s39 offen lds
    s_add_u32 m0, s60, 19456
    s_add_u32 s39, s38, 2490368
    buffer_load_dwordx4 v14, s[20:23], s39 offen lds
    s_mov_b32 s35, 0x3acccccd
    s_lshl_b32 s34, s67, 6
    s_add_u32 s34, s34, 0
    s_lshr_b32 s34, s34, 1
    s_add_u32 s34, s34, 1
    v_bfe_u32 v173, v1, 1, 4
    v_add_u32 v173, s34, v173
    s_mul_i32 s36, s29, 160
    v_bfe_u32 v172, v1, 5, 1
    v_mul_u32_u24 v172, 8, v172
    v_add_u32 v172, s36, v172
    v_mul_u32_u24 v172, v172, v173
    v_and_b32 v174, 1, v1
    v_mul_u32_u24 v174, 160, v174
    v_add_u32 v172, v172, v174
    v_cvt_f32_u32 v172, v172
    v_cvt_f32_u32 v173, v173
    v_mul_f32 v172, s35, v172
    v_mul_f32 v173, s35, v173
    v_fract_f32 v172, v172
    v_fmamk_f32 v174, v173, 0x0, v172
    v_fmamk_f32 v175, v173, 0x3f800000, v172
    v_cos_f32 v175, v175
    v_cos_f32 v174, v174
    s_nop 0
    v_cvt_pk_bf16_f32 v178, v174, v175
    v_fmamk_f32 v176, v173, 0x40000000, v172
    v_fmamk_f32 v177, v173, 0x40400000, v172
    v_cos_f32 v177, v177
    v_cos_f32 v176, v176
    v_accvgpr_write_b32 a160, v178
    v_cvt_pk_bf16_f32 v178, v176, v177
    v_fmamk_f32 v174, v173, 0x40800000, v172
    v_fmamk_f32 v175, v173, 0x40a00000, v172
    v_cos_f32 v175, v175
    v_cos_f32 v174, v174
    v_accvgpr_write_b32 a161, v178
    v_cvt_pk_bf16_f32 v178, v174, v175
    v_fmamk_f32 v176, v173, 0x40c00000, v172
    v_fmamk_f32 v177, v173, 0x40e00000, v172
    v_cos_f32 v177, v177
    v_cos_f32 v176, v176
    v_accvgpr_write_b32 a162, v178
    v_cvt_pk_bf16_f32 v178, v176, v177
    v_fmamk_f32 v174, v173, 0x41800000, v172
    v_fmamk_f32 v175, v173, 0x41880000, v172
    v_cos_f32 v175, v175
    v_cos_f32 v174, v174
    v_accvgpr_write_b32 a163, v178
    v_cvt_pk_bf16_f32 v178, v174, v175
    v_fmamk_f32 v176, v173, 0x41900000, v172
    v_fmamk_f32 v177, v173, 0x41980000, v172
    v_cos_f32 v177, v177
    v_cos_f32 v176, v176
    v_accvgpr_write_b32 a164, v178
    v_cvt_pk_bf16_f32 v178, v176, v177
    v_fmamk_f32 v174, v173, 0x41a00000, v172
    v_fmamk_f32 v175, v173, 0x41a80000, v172
    v_cos_f32 v175, v175
    v_cos_f32 v174, v174
    v_accvgpr_write_b32 a165, v178
    v_cvt_pk_bf16_f32 v178, v174, v175
    v_fmamk_f32 v176, v173, 0x41b00000, v172
    v_fmamk_f32 v177, v173, 0x41b80000, v172
    v_cos_f32 v177, v177
    v_cos_f32 v176, v176
    v_accvgpr_write_b32 a166, v178
    v_cvt_pk_bf16_f32 v178, v176, v177
    v_fmamk_f32 v174, v173, 0x42000000, v172
    v_fmamk_f32 v175, v173, 0x42040000, v172
    v_cos_f32 v175, v175
    v_cos_f32 v174, v174
    v_accvgpr_write_b32 a167, v178
    v_cvt_pk_bf16_f32 v178, v174, v175
    v_fmamk_f32 v176, v173, 0x42080000, v172
    v_fmamk_f32 v177, v173, 0x420c0000, v172
    v_cos_f32 v177, v177
    v_cos_f32 v176, v176
    v_accvgpr_write_b32 a168, v178
    v_cvt_pk_bf16_f32 v178, v176, v177
    v_fmamk_f32 v174, v173, 0x42100000, v172
    v_fmamk_f32 v175, v173, 0x42140000, v172
    v_cos_f32 v175, v175
    v_cos_f32 v174, v174
    v_accvgpr_write_b32 a169, v178
    v_cvt_pk_bf16_f32 v178, v174, v175
    v_fmamk_f32 v176, v173, 0x42180000, v172
    v_fmamk_f32 v177, v173, 0x421c0000, v172
    v_cos_f32 v177, v177
    v_cos_f32 v176, v176
    v_accvgpr_write_b32 a170, v178
    v_cvt_pk_bf16_f32 v178, v176, v177
    v_fmamk_f32 v174, v173, 0x42400000, v172
    v_fmamk_f32 v175, v173, 0x42440000, v172
    v_cos_f32 v175, v175
    v_cos_f32 v174, v174
    v_accvgpr_write_b32 a171, v178
    v_cvt_pk_bf16_f32 v178, v174, v175
    v_fmamk_f32 v176, v173, 0x42480000, v172
    v_fmamk_f32 v177, v173, 0x424c0000, v172
    v_cos_f32 v177, v177
    v_cos_f32 v176, v176
    v_accvgpr_write_b32 a172, v178
    v_cvt_pk_bf16_f32 v178, v176, v177
    v_fmamk_f32 v174, v173, 0x42500000, v172
    v_fmamk_f32 v175, v173, 0x42540000, v172
    v_cos_f32 v175, v175
    v_cos_f32 v174, v174
    v_accvgpr_write_b32 a173, v178
    v_cvt_pk_bf16_f32 v178, v174, v175
    v_fmamk_f32 v176, v173, 0x42580000, v172
    v_fmamk_f32 v177, v173, 0x425c0000, v172
    v_cos_f32 v177, v177
    v_cos_f32 v176, v176
    v_accvgpr_write_b32 a174, v178
    v_cvt_pk_bf16_f32 v178, v176, v177
    v_fmamk_f32 v174, v173, 0x42800000, v172
    v_fmamk_f32 v175, v173, 0x42820000, v172
    v_cos_f32 v175, v175
    v_cos_f32 v174, v174
    v_accvgpr_write_b32 a175, v178
    v_cvt_pk_bf16_f32 v178, v174, v175
    v_fmamk_f32 v176, v173, 0x42840000, v172
    v_fmamk_f32 v177, v173, 0x42860000, v172
    v_cos_f32 v177, v177
    v_cos_f32 v176, v176
    v_accvgpr_write_b32 a176, v178
    v_cvt_pk_bf16_f32 v178, v176, v177
    v_fmamk_f32 v174, v173, 0x42880000, v172
    v_fmamk_f32 v175, v173, 0x428a0000, v172
    v_cos_f32 v175, v175
    v_cos_f32 v174, v174
    v_accvgpr_write_b32 a177, v178
    v_cvt_pk_bf16_f32 v178, v174, v175
    v_fmamk_f32 v176, v173, 0x428c0000, v172
    v_fmamk_f32 v177, v173, 0x428e0000, v172
    v_cos_f32 v177, v177
    v_cos_f32 v176, v176
    v_accvgpr_write_b32 a178, v178
    v_cvt_pk_bf16_f32 v178, v176, v177
    v_fmamk_f32 v174, v173, 0x42a00000, v172
    v_fmamk_f32 v175, v173, 0x42a20000, v172
    v_cos_f32 v175, v175
    v_cos_f32 v174, v174
    v_accvgpr_write_b32 a179, v178
    v_cvt_pk_bf16_f32 v178, v174, v175
    v_fmamk_f32 v176, v173, 0x42a40000, v172
    v_fmamk_f32 v177, v173, 0x42a60000, v172
    v_cos_f32 v177, v177
    v_cos_f32 v176, v176
    v_accvgpr_write_b32 a180, v178
    v_cvt_pk_bf16_f32 v178, v176, v177
    v_fmamk_f32 v174, v173, 0x42a80000, v172
    v_fmamk_f32 v175, v173, 0x42aa0000, v172
    v_cos_f32 v175, v175
    v_cos_f32 v174, v174
    v_accvgpr_write_b32 a181, v178
    v_cvt_pk_bf16_f32 v178, v174, v175
    v_fmamk_f32 v176, v173, 0x42ac0000, v172
    v_fmamk_f32 v177, v173, 0x42ae0000, v172
    v_cos_f32 v177, v177
    v_cos_f32 v176, v176
    v_accvgpr_write_b32 a182, v178
    v_cvt_pk_bf16_f32 v178, v176, v177
    v_fmamk_f32 v174, v173, 0x42c00000, v172
    v_fmamk_f32 v175, v173, 0x42c20000, v172
    v_cos_f32 v175, v175
    v_cos_f32 v174, v174
    v_accvgpr_write_b32 a183, v178
    v_cvt_pk_bf16_f32 v178, v174, v175
    v_fmamk_f32 v176, v173, 0x42c40000, v172
    v_fmamk_f32 v177, v173, 0x42c60000, v172
    v_cos_f32 v177, v177
    v_cos_f32 v176, v176
    v_accvgpr_write_b32 a184, v178
    v_cvt_pk_bf16_f32 v178, v176, v177
    v_fmamk_f32 v174, v173, 0x42c80000, v172
    v_fmamk_f32 v175, v173, 0x42ca0000, v172
    v_cos_f32 v175, v175
    v_cos_f32 v174, v174
    v_accvgpr_write_b32 a185, v178
    v_cvt_pk_bf16_f32 v178, v174, v175
    v_fmamk_f32 v176, v173, 0x42cc0000, v172
    v_fmamk_f32 v177, v173, 0x42ce0000, v172
    v_cos_f32 v177, v177
    v_cos_f32 v176, v176
    v_accvgpr_write_b32 a186, v178
    v_cvt_pk_bf16_f32 v178, v176, v177
    v_fmamk_f32 v174, v173, 0x42e00000, v172
    v_fmamk_f32 v175, v173, 0x42e20000, v172
    v_cos_f32 v175, v175
    v_cos_f32 v174, v174
    v_accvgpr_write_b32 a187, v178
    v_cvt_pk_bf16_f32 v178, v174, v175
    v_fmamk_f32 v176, v173, 0x42e40000, v172
    v_fmamk_f32 v177, v173, 0x42e60000, v172
    v_cos_f32 v177, v177
    v_cos_f32 v176, v176
    v_accvgpr_write_b32 a188, v178
    v_cvt_pk_bf16_f32 v178, v176, v177
    v_fmamk_f32 v174, v173, 0x42e80000, v172
    v_fmamk_f32 v175, v173, 0x42ea0000, v172
    v_cos_f32 v175, v175
    v_cos_f32 v174, v174
    v_accvgpr_write_b32 a189, v178
    v_cvt_pk_bf16_f32 v178, v174, v175
    v_fmamk_f32 v176, v173, 0x42ec0000, v172
    v_fmamk_f32 v177, v173, 0x42ee0000, v172
    v_cos_f32 v177, v177
    v_cos_f32 v176, v176
    v_accvgpr_write_b32 a190, v178
    v_cvt_pk_bf16_f32 v178, v176, v177
    v_fmamk_f32 v174, v173, 0x43000000, v172
    v_fmamk_f32 v175, v173, 0x43010000, v172
    v_cos_f32 v175, v175
    v_cos_f32 v174, v174
    v_accvgpr_write_b32 a191, v178
    v_cvt_pk_bf16_f32 v178, v174, v175
    v_fmamk_f32 v176, v173, 0x43020000, v172
    v_fmamk_f32 v177, v173, 0x43030000, v172
    v_cos_f32 v177, v177
    v_cos_f32 v176, v176
    v_accvgpr_write_b32 a192, v178
    v_cvt_pk_bf16_f32 v178, v176, v177
    v_fmamk_f32 v174, v173, 0x43040000, v172
    v_fmamk_f32 v175, v173, 0x43050000, v172
    v_cos_f32 v175, v175
    v_cos_f32 v174, v174
    v_accvgpr_write_b32 a193, v178
    v_cvt_pk_bf16_f32 v178, v174, v175
    v_fmamk_f32 v176, v173, 0x43060000, v172
    v_fmamk_f32 v177, v173, 0x43070000, v172
    v_cos_f32 v177, v177
    v_cos_f32 v176, v176
    v_accvgpr_write_b32 a194, v178
    v_cvt_pk_bf16_f32 v178, v176, v177
    v_fmamk_f32 v174, v173, 0x43100000, v172
    v_fmamk_f32 v175, v173, 0x43110000, v172
    v_cos_f32 v175, v175
    v_cos_f32 v174, v174
    v_accvgpr_write_b32 a195, v178
    v_cvt_pk_bf16_f32 v178, v174, v175
    v_fmamk_f32 v176, v173, 0x43120000, v172
    v_fmamk_f32 v177, v173, 0x43130000, v172
    v_cos_f32 v177, v177
    v_cos_f32 v176, v176
    v_accvgpr_write_b32 a196, v178
    v_cvt_pk_bf16_f32 v178, v176, v177
    v_fmamk_f32 v174, v173, 0x43140000, v172
    v_fmamk_f32 v175, v173, 0x43150000, v172
    v_cos_f32 v175, v175
    v_cos_f32 v174, v174
    v_accvgpr_write_b32 a197, v178
    v_cvt_pk_bf16_f32 v178, v174, v175
    v_fmamk_f32 v176, v173, 0x43160000, v172
    v_fmamk_f32 v177, v173, 0x43170000, v172
    v_cos_f32 v177, v177
    v_cos_f32 v176, v176
    v_accvgpr_write_b32 a198, v178
    v_cvt_pk_bf16_f32 v178, v176, v177
    v_accvgpr_write_b32 a199, v178
    s_lshl_b32 s34, s67, 6
    s_add_u32 s34, s34, 32
    s_lshr_b32 s34, s34, 1
    s_add_u32 s34, s34, 1
    v_bfe_u32 v173, v1, 1, 4
    v_add_u32 v173, s34, v173
    s_mul_i32 s36, s29, 160
    v_bfe_u32 v172, v1, 5, 1
    v_mul_u32_u24 v172, 8, v172
    v_add_u32 v172, s36, v172
    v_mul_u32_u24 v172, v172, v173
    v_and_b32 v174, 1, v1
    v_mul_u32_u24 v174, 160, v174
    v_add_u32 v172, v172, v174
    v_cvt_f32_u32 v172, v172
    v_cvt_f32_u32 v173, v173
    v_mul_f32 v172, s35, v172
    v_mul_f32 v173, s35, v173
    v_fract_f32 v172, v172
    v_fmamk_f32 v174, v173, 0x0, v172
    v_fmamk_f32 v175, v173, 0x3f800000, v172
    v_cos_f32 v175, v175
    v_cos_f32 v174, v174
    s_nop 0
    v_cvt_pk_bf16_f32 v178, v174, v175
    v_fmamk_f32 v176, v173, 0x40000000, v172
    v_fmamk_f32 v177, v173, 0x40400000, v172
    v_cos_f32 v177, v177
    v_cos_f32 v176, v176
    v_accvgpr_write_b32 a200, v178
    v_cvt_pk_bf16_f32 v178, v176, v177
    v_fmamk_f32 v174, v173, 0x40800000, v172
    v_fmamk_f32 v175, v173, 0x40a00000, v172
    v_cos_f32 v175, v175
    v_cos_f32 v174, v174
    v_accvgpr_write_b32 a201, v178
    v_cvt_pk_bf16_f32 v178, v174, v175
    v_fmamk_f32 v176, v173, 0x40c00000, v172
    v_fmamk_f32 v177, v173, 0x40e00000, v172
    v_cos_f32 v177, v177
    v_cos_f32 v176, v176
    v_accvgpr_write_b32 a202, v178
    v_cvt_pk_bf16_f32 v178, v176, v177
    v_fmamk_f32 v174, v173, 0x41800000, v172
    v_fmamk_f32 v175, v173, 0x41880000, v172
    v_cos_f32 v175, v175
    v_cos_f32 v174, v174
    v_accvgpr_write_b32 a203, v178
    v_cvt_pk_bf16_f32 v178, v174, v175
    v_fmamk_f32 v176, v173, 0x41900000, v172
    v_fmamk_f32 v177, v173, 0x41980000, v172
    v_cos_f32 v177, v177
    v_cos_f32 v176, v176
    v_accvgpr_write_b32 a204, v178
    v_cvt_pk_bf16_f32 v178, v176, v177
    v_fmamk_f32 v174, v173, 0x41a00000, v172
    v_fmamk_f32 v175, v173, 0x41a80000, v172
    v_cos_f32 v175, v175
    v_cos_f32 v174, v174
    v_accvgpr_write_b32 a205, v178
    v_cvt_pk_bf16_f32 v178, v174, v175
    v_fmamk_f32 v176, v173, 0x41b00000, v172
    v_fmamk_f32 v177, v173, 0x41b80000, v172
    v_cos_f32 v177, v177
    v_cos_f32 v176, v176
    v_accvgpr_write_b32 a206, v178
    v_cvt_pk_bf16_f32 v178, v176, v177
    v_fmamk_f32 v174, v173, 0x42000000, v172
    v_fmamk_f32 v175, v173, 0x42040000, v172
    v_cos_f32 v175, v175
    v_cos_f32 v174, v174
    v_accvgpr_write_b32 a207, v178
    v_cvt_pk_bf16_f32 v178, v174, v175
    v_fmamk_f32 v176, v173, 0x42080000, v172
    v_fmamk_f32 v177, v173, 0x420c0000, v172
    v_cos_f32 v177, v177
    v_cos_f32 v176, v176
    v_accvgpr_write_b32 a208, v178
    v_cvt_pk_bf16_f32 v178, v176, v177
    v_fmamk_f32 v174, v173, 0x42100000, v172
    v_fmamk_f32 v175, v173, 0x42140000, v172
    v_cos_f32 v175, v175
    v_cos_f32 v174, v174
    v_accvgpr_write_b32 a209, v178
    v_cvt_pk_bf16_f32 v178, v174, v175
    v_fmamk_f32 v176, v173, 0x42180000, v172
    v_fmamk_f32 v177, v173, 0x421c0000, v172
    v_cos_f32 v177, v177
    v_cos_f32 v176, v176
    v_accvgpr_write_b32 a210, v178
    v_cvt_pk_bf16_f32 v178, v176, v177
    v_fmamk_f32 v174, v173, 0x42400000, v172
    v_fmamk_f32 v175, v173, 0x42440000, v172
    v_cos_f32 v175, v175
    v_cos_f32 v174, v174
    v_accvgpr_write_b32 a211, v178
    v_cvt_pk_bf16_f32 v178, v174, v175
    v_fmamk_f32 v176, v173, 0x42480000, v172
    v_fmamk_f32 v177, v173, 0x424c0000, v172
    v_cos_f32 v177, v177
    v_cos_f32 v176, v176
    v_accvgpr_write_b32 a212, v178
    v_cvt_pk_bf16_f32 v178, v176, v177
    v_fmamk_f32 v174, v173, 0x42500000, v172
    v_fmamk_f32 v175, v173, 0x42540000, v172
    v_cos_f32 v175, v175
    v_cos_f32 v174, v174
    v_accvgpr_write_b32 a213, v178
    v_cvt_pk_bf16_f32 v178, v174, v175
    v_fmamk_f32 v176, v173, 0x42580000, v172
    v_fmamk_f32 v177, v173, 0x425c0000, v172
    v_cos_f32 v177, v177
    v_cos_f32 v176, v176
    v_accvgpr_write_b32 a214, v178
    v_cvt_pk_bf16_f32 v178, v176, v177
    v_fmamk_f32 v174, v173, 0x42800000, v172
    v_fmamk_f32 v175, v173, 0x42820000, v172
    v_cos_f32 v175, v175
    v_cos_f32 v174, v174
    v_accvgpr_write_b32 a215, v178
    v_cvt_pk_bf16_f32 v178, v174, v175
    v_fmamk_f32 v176, v173, 0x42840000, v172
    v_fmamk_f32 v177, v173, 0x42860000, v172
    v_cos_f32 v177, v177
    v_cos_f32 v176, v176
    v_accvgpr_write_b32 a216, v178
    v_cvt_pk_bf16_f32 v178, v176, v177
    v_fmamk_f32 v174, v173, 0x42880000, v172
    v_fmamk_f32 v175, v173, 0x428a0000, v172
    v_cos_f32 v175, v175
    v_cos_f32 v174, v174
    v_accvgpr_write_b32 a217, v178
    v_cvt_pk_bf16_f32 v178, v174, v175
    v_fmamk_f32 v176, v173, 0x428c0000, v172
    v_fmamk_f32 v177, v173, 0x428e0000, v172
    v_cos_f32 v177, v177
    v_cos_f32 v176, v176
    v_accvgpr_write_b32 a218, v178
    v_cvt_pk_bf16_f32 v178, v176, v177
    v_fmamk_f32 v174, v173, 0x42a00000, v172
    v_fmamk_f32 v175, v173, 0x42a20000, v172
    v_cos_f32 v175, v175
    v_cos_f32 v174, v174
    v_accvgpr_write_b32 a219, v178
    v_cvt_pk_bf16_f32 v178, v174, v175
    v_fmamk_f32 v176, v173, 0x42a40000, v172
    v_fmamk_f32 v177, v173, 0x42a60000, v172
    v_cos_f32 v177, v177
    v_cos_f32 v176, v176
    v_accvgpr_write_b32 a220, v178
    v_cvt_pk_bf16_f32 v178, v176, v177
    v_fmamk_f32 v174, v173, 0x42a80000, v172
    v_fmamk_f32 v175, v173, 0x42aa0000, v172
    v_cos_f32 v175, v175
    v_cos_f32 v174, v174
    v_accvgpr_write_b32 a221, v178
    v_cvt_pk_bf16_f32 v178, v174, v175
    v_fmamk_f32 v176, v173, 0x42ac0000, v172
    v_fmamk_f32 v177, v173, 0x42ae0000, v172
    v_cos_f32 v177, v177
    v_cos_f32 v176, v176
    v_accvgpr_write_b32 a222, v178
    v_cvt_pk_bf16_f32 v178, v176, v177
    v_fmamk_f32 v174, v173, 0x42c00000, v172
    v_fmamk_f32 v175, v173, 0x42c20000, v172
    v_cos_f32 v175, v175
    v_cos_f32 v174, v174
    v_accvgpr_write_b32 a223, v178
    v_cvt_pk_bf16_f32 v178, v174, v175
    v_fmamk_f32 v176, v173, 0x42c40000, v172
    v_fmamk_f32 v177, v173, 0x42c60000, v172
    v_cos_f32 v177, v177
    v_cos_f32 v176, v176
    v_accvgpr_write_b32 a224, v178
    v_cvt_pk_bf16_f32 v178, v176, v177
    v_fmamk_f32 v174, v173, 0x42c80000, v172
    v_fmamk_f32 v175, v173, 0x42ca0000, v172
    v_cos_f32 v175, v175
    v_cos_f32 v174, v174
    v_accvgpr_write_b32 a225, v178
    v_cvt_pk_bf16_f32 v178, v174, v175
    v_fmamk_f32 v176, v173, 0x42cc0000, v172
    v_fmamk_f32 v177, v173, 0x42ce0000, v172
    v_cos_f32 v177, v177
    v_cos_f32 v176, v176
    v_accvgpr_write_b32 a226, v178
    v_cvt_pk_bf16_f32 v178, v176, v177
    v_fmamk_f32 v174, v173, 0x42e00000, v172
    v_fmamk_f32 v175, v173, 0x42e20000, v172
    v_cos_f32 v175, v175
    v_cos_f32 v174, v174
    v_accvgpr_write_b32 a227, v178
    v_cvt_pk_bf16_f32 v178, v174, v175
    v_fmamk_f32 v176, v173, 0x42e40000, v172
    v_fmamk_f32 v177, v173, 0x42e60000, v172
    v_cos_f32 v177, v177
    v_cos_f32 v176, v176
    v_accvgpr_write_b32 a228, v178
    v_cvt_pk_bf16_f32 v178, v176, v177
    v_fmamk_f32 v174, v173, 0x42e80000, v172
    v_fmamk_f32 v175, v173, 0x42ea0000, v172
    v_cos_f32 v175, v175
    v_cos_f32 v174, v174
    v_accvgpr_write_b32 a229, v178
    v_cvt_pk_bf16_f32 v178, v174, v175
    v_fmamk_f32 v176, v173, 0x42ec0000, v172
    v_fmamk_f32 v177, v173, 0x42ee0000, v172
    v_cos_f32 v177, v177
    v_cos_f32 v176, v176
    v_accvgpr_write_b32 a230, v178
    v_cvt_pk_bf16_f32 v178, v176, v177
    v_fmamk_f32 v174, v173, 0x43000000, v172
    v_fmamk_f32 v175, v173, 0x43010000, v172
    v_cos_f32 v175, v175
    v_cos_f32 v174, v174
    v_accvgpr_write_b32 a231, v178
    v_cvt_pk_bf16_f32 v178, v174, v175
    v_fmamk_f32 v176, v173, 0x43020000, v172
    v_fmamk_f32 v177, v173, 0x43030000, v172
    v_cos_f32 v177, v177
    v_cos_f32 v176, v176
    v_accvgpr_write_b32 a232, v178
    v_cvt_pk_bf16_f32 v178, v176, v177
    v_fmamk_f32 v174, v173, 0x43040000, v172
    v_fmamk_f32 v175, v173, 0x43050000, v172
    v_cos_f32 v175, v175
    v_cos_f32 v174, v174
    v_accvgpr_write_b32 a233, v178
    v_cvt_pk_bf16_f32 v178, v174, v175
    v_fmamk_f32 v176, v173, 0x43060000, v172
    v_fmamk_f32 v177, v173, 0x43070000, v172
    v_cos_f32 v177, v177
    v_cos_f32 v176, v176
    v_accvgpr_write_b32 a234, v178
    v_cvt_pk_bf16_f32 v178, v176, v177
    v_fmamk_f32 v174, v173, 0x43100000, v172
    v_fmamk_f32 v175, v173, 0x43110000, v172
    v_cos_f32 v175, v175
    v_cos_f32 v174, v174
    v_accvgpr_write_b32 a235, v178
    v_cvt_pk_bf16_f32 v178, v174, v175
    v_fmamk_f32 v176, v173, 0x43120000, v172
    v_fmamk_f32 v177, v173, 0x43130000, v172
    v_cos_f32 v177, v177
    v_cos_f32 v176, v176
    v_accvgpr_write_b32 a236, v178
    v_cvt_pk_bf16_f32 v178, v176, v177
    v_fmamk_f32 v174, v173, 0x43140000, v172
    v_fmamk_f32 v175, v173, 0x43150000, v172
    v_cos_f32 v175, v175
    v_cos_f32 v174, v174
    v_accvgpr_write_b32 a237, v178
    v_cvt_pk_bf16_f32 v178, v174, v175
    v_fmamk_f32 v176, v173, 0x43160000, v172
    v_fmamk_f32 v177, v173, 0x43170000, v172
    v_cos_f32 v177, v177
    v_cos_f32 v176, v176
    v_accvgpr_write_b32 a238, v178
    v_cvt_pk_bf16_f32 v178, v176, v177
    v_accvgpr_write_b32 a239, v178
    s_cmp_ge_u32 s28, 160
    s_cbranch_scc1 R_110
    s_waitcnt vmcnt(60)
    v_lshl_or_b32 v216, v232, 16, v216
    s_waitcnt vmcnt(58)
    v_lshl_or_b32 v217, v233, 16, v217
    s_waitcnt vmcnt(56)
    v_lshl_or_b32 v218, v234, 16, v218
    s_waitcnt vmcnt(54)
    v_lshl_or_b32 v219, v235, 16, v219
    s_waitcnt vmcnt(52)
    v_lshl_or_b32 v220, v236, 16, v220
    s_waitcnt vmcnt(50)
    v_lshl_or_b32 v221, v237, 16, v221
    s_waitcnt vmcnt(48)
    v_lshl_or_b32 v222, v238, 16, v222
    s_waitcnt vmcnt(46)
    v_lshl_or_b32 v223, v239, 16, v223
    s_waitcnt vmcnt(44)
    v_lshl_or_b32 v224, v240, 16, v224
    s_waitcnt vmcnt(42)
    v_lshl_or_b32 v225, v241, 16, v225
    s_waitcnt vmcnt(40)
    v_lshl_or_b32 v226, v242, 16, v226
    s_waitcnt vmcnt(38)
    v_lshl_or_b32 v227, v243, 16, v227
    s_waitcnt vmcnt(36)
    v_lshl_or_b32 v228, v244, 16, v228
    s_waitcnt vmcnt(34)
    v_lshl_or_b32 v229, v245, 16, v229
    s_waitcnt vmcnt(32)
    v_lshl_or_b32 v230, v246, 16, v230
    s_waitcnt vmcnt(30)
    v_lshl_or_b32 v231, v247, 16, v231
    s_add_u32 s33, s62, 0
    buffer_store_dwordx4 v[216:219], v0, s[4:7], s33 offen sc1
    s_add_u32 s33, s62, 5120
    buffer_store_dwordx4 v[220:223], v0, s[4:7], s33 offen sc1
    s_add_u32 s33, s62, 10240
    buffer_store_dwordx4 v[224:227], v0, s[4:7], s33 offen sc1
    s_add_u32 s33, s62, 15360
    buffer_store_dwordx4 v[228:231], v0, s[4:7], s33 offen sc1
R_110:
    s_mov_b32 s34, 0x3f803f80
    v_mov_b32 v56, s34
    v_mov_b32 v57, s34
    v_mov_b32 v58, s34
    v_mov_b32 v59, s34
    s_nop 1
    v_mfma_f32_32x32x16_bf16 v[96:111], v[56:59], a[160:163], 0
    v_mfma_f32_32x32x16_bf16 v[112:127], v[56:59], a[200:203], 0
    v_mfma_f32_32x32x16_bf16 v[96:111], v[56:59], a[164:167], v[96:111]
    v_mfma_f32_32x32x16_bf16 v[112:127], v[56:59], a[204:207], v[112:127]
    v_mfma_f32_32x32x16_bf16 v[96:111], v[56:59], a[168:171], v[96:111]
    v_mfma_f32_32x32x16_bf16 v[112:127], v[56:59], a[208:211], v[112:127]
    v_mfma_f32_32x32x16_bf16 v[96:111], v[56:59], a[172:175], v[96:111]
    v_mfma_f32_32x32x16_bf16 v[112:127], v[56:59], a[212:215], v[112:127]
    v_mfma_f32_32x32x16_bf16 v[96:111], v[56:59], a[176:179], v[96:111]
    v_mfma_f32_32x32x16_bf16 v[112:127], v[56:59], a[216:219], v[112:127]
    v_mfma_f32_32x32x16_bf16 v[96:111], v[56:59], a[180:183], v[96:111]
    v_mfma_f32_32x32x16_bf16 v[112:127], v[56:59], a[220:223], v[112:127]
    v_mfma_f32_32x32x16_bf16 v[96:111], v[56:59], a[184:187], v[96:111]
    v_mfma_f32_32x32x16_bf16 v[112:127], v[56:59], a[224:227], v[112:127]
    v_mfma_f32_32x32x16_bf16 v[96:111], v[56:59], a[188:191], v[96:111]
    v_mfma_f32_32x32x16_bf16 v[112:127], v[56:59], a[228:231], v[112:127]
    v_mfma_f32_32x32x16_bf16 v[96:111], v[56:59], a[192:195], v[96:111]
    v_mfma_f32_32x32x16_bf16 v[112:127], v[56:59], a[232:235], v[112:127]
    v_mfma_f32_32x32x16_bf16 v[96:111], v[56:59], a[196:199], v[96:111]
    v_mfma_f32_32x32x16_bf16 v[112:127], v[56:59], a[236:239], v[112:127]
    s_nop 3
    ds_write_b128 v4, v[96:99] offset:32768
    ds_write_b128 v4, v[100:103] offset:33792
    ds_write_b128 v4, v[104:107] offset:34816
    ds_write_b128 v4, v[108:111] offset:35840
    s_nop 3
    ds_write_b128 v4, v[112:115] offset:36864
    ds_write_b128 v4, v[116:119] offset:37888
    ds_write_b128 v4, v[120:123] offset:38912
    ds_write_b128 v4, v[124:127] offset:39936
    s_waitcnt lgkmcnt(0)
    s_barrier
    ds_read_b128 v[96:99], v3 offset:32768
    ds_read_b128 v[100:103], v3 offset:33792
    ds_read_b128 v[104:107], v3 offset:40960
    ds_read_b128 v[108:111], v3 offset:41984
    ds_read_b128 v[112:115], v3 offset:49152
    ds_read_b128 v[116:119], v3 offset:50176
    ds_read_b128 v[120:123], v3 offset:57344
    ds_read_b128 v[124:127], v3 offset:58368
    s_waitcnt lgkmcnt(5)
    v_pk_add_f32 v[96:97], v[96:97], v[104:105]
    v_pk_add_f32 v[98:99], v[98:99], v[106:107]
    s_waitcnt lgkmcnt(4)
    v_pk_add_f32 v[100:101], v[100:101], v[108:109]
    v_pk_add_f32 v[102:103], v[102:103], v[110:111]
    s_waitcnt lgkmcnt(3)
    v_pk_add_f32 v[96:97], v[96:97], v[112:113]
    v_pk_add_f32 v[98:99], v[98:99], v[114:115]
    s_waitcnt lgkmcnt(2)
    v_pk_add_f32 v[100:101], v[100:101], v[116:117]
    v_pk_add_f32 v[102:103], v[102:103], v[118:119]
    s_waitcnt lgkmcnt(1)
    v_pk_add_f32 v[96:97], v[96:97], v[120:121]
    v_pk_add_f32 v[98:99], v[98:99], v[122:123]
    s_waitcnt lgkmcnt(0)
    v_pk_add_f32 v[100:101], v[100:101], v[124:125]
    v_pk_add_f32 v[102:103], v[102:103], v[126:127]
    v_mov_b64 v[154:155], v[96:97]
    v_mov_b64 v[156:157], v[98:99]
    v_mov_b64 v[158:159], v[100:101]
    v_mov_b64 v[160:161], v[102:103]
    s_barrier
    v_bfe_u32 v173, v1, 0, 1
    v_mul_u32_u24 v173, 4, v173
    v_add_u32 v173, 8, v173
    s_mov_b32 s48, 0
P_111:
    buffer_load_dword v172, v173, s[24:27], 0 offen sc1
    s_waitcnt vmcnt(0)
    v_cmp_gt_u32 vcc, 1, v172
    s_cbranch_vccz P_112
    s_add_u32 s48, s48, 1
    s_cmp_gt_u32 s48, 200000
    s_cbranch_scc1 L_end
    s_sleep 1
    s_branch P_111
P_112:
    s_cmp_ge_u32 s28, 160
    s_cbranch_scc1 R_113
    s_waitcnt vmcnt(0)
    s_barrier
    s_cmp_lg_u32 s29, 0
    s_cbranch_scc1 F_114
    s_lshl_b32 s32, s28, 5
    s_add_u32 s32, s32, s29
    s_lshl_b32 s32, s32, 2
    s_add_u32 s32, s32, 1048576
    v_mov_b32 v172, 1
    s_mov_b64 exec, 1
    buffer_store_dword v172, off, s[4:7], s32 sc1
    s_mov_b64 exec, -1
F_114:
R_113:
    s_cmp_eq_u32 s64, 1
    s_cbranch_scc1 Q_115
    v_bfe_u32 v14, v1, 5, 1
    v_mul_u32_u24 v14, 512, v14
    v_bfe_u32 v15, v1, 2, 2
    v_lshl_add_u32 v14, v15, 6, v14
    v_bfe_u32 v15, v1, 4, 1
    v_lshl_add_u32 v14, v15, 4, v14
    v_bfe_u32 v15, v1, 1, 1
    v_lshl_add_u32 v14, v15, 3, v14
    v_bfe_u32 v15, v1, 0, 1
    v_lshl_add_u32 v14, v15, 5, v14
    v_add_u32 v14, s60, v14
    s_branch Q_116
Q_115:
    v_bfe_u32 v14, v1, 5, 1
    v_mul_u32_u24 v14, 512, v14
    v_bfe_u32 v15, v1, 2, 2
    v_lshl_add_u32 v14, v15, 6, v14
    v_bfe_u32 v15, v1, 4, 1
    v_lshl_add_u32 v14, v15, 5, v14
    v_bfe_u32 v15, v1, 0, 2
    v_lshl_add_u32 v14, v15, 3, v14
    v_add_u32 v14, s60, v14
Q_116:
    s_waitcnt vmcnt(0)
    ds_read_b64_tr_b16 a[0:1], v14 offset:0
    ds_read_b64_tr_b16 a[2:3], v14 offset:256
    ds_read_b64_tr_b16 a[4:5], v14 offset:1024
    ds_read_b64_tr_b16 a[6:7], v14 offset:1280
    ds_read_b64_tr_b16 a[8:9], v14 offset:2048
    ds_read_b64_tr_b16 a[10:11], v14 offset:2304
    ds_read_b64_tr_b16 a[12:13], v14 offset:3072
    ds_read_b64_tr_b16 a[14:15], v14 offset:3328
    ds_read_b64_tr_b16 a[16:17], v14 offset:4096
    ds_read_b64_tr_b16 a[18:19], v14 offset:4352
    ds_read_b64_tr_b16 a[20:21], v14 offset:5120
    ds_read_b64_tr_b16 a[22:23], v14 offset:5376
    ds_read_b64_tr_b16 a[24:25], v14 offset:6144
    ds_read_b64_tr_b16 a[26:27], v14 offset:6400
    ds_read_b64_tr_b16 a[28:29], v14 offset:7168
    ds_read_b64_tr_b16 a[30:31], v14 offset:7424
    ds_read_b64_tr_b16 a[32:33], v14 offset:8192
    ds_read_b64_tr_b16 a[34:35], v14 offset:8448
    ds_read_b64_tr_b16 a[36:37], v14 offset:9216
    ds_read_b64_tr_b16 a[38:39], v14 offset:9472
    ds_read_b64_tr_b16 a[40:41], v14 offset:10240
    ds_read_b64_tr_b16 a[42:43], v14 offset:10496
    ds_read_b64_tr_b16 a[44:45], v14 offset:11264
    ds_read_b64_tr_b16 a[46:47], v14 offset:11520
    ds_read_b64_tr_b16 a[48:49], v14 offset:12288
    ds_read_b64_tr_b16 a[50:51], v14 offset:12544
    ds_read_b64_tr_b16 a[52:53], v14 offset:13312
    ds_read_b64_tr_b16 a[54:55], v14 offset:13568
    ds_read_b64_tr_b16 a[56:57], v14 offset:14336
    ds_read_b64_tr_b16 a[58:59], v14 offset:14592
    ds_read_b64_tr_b16 a[60:61], v14 offset:15360
    ds_read_b64_tr_b16 a[62:63], v14 offset:15616
    ds_read_b64_tr_b16 a[64:65], v14 offset:16384
    ds_read_b64_tr_b16 a[66:67], v14 offset:16640
    ds_read_b64_tr_b16 a[68:69], v14 offset:17408
    ds_read_b64_tr_b16 a[70:71], v14 offset:17664
    ds_read_b64_tr_b16 a[72:73], v14 offset:18432
    ds_read_b64_tr_b16 a[74:75], v14 offset:18688
    ds_read_b64_tr_b16 a[76:77], v14 offset:19456
    ds_read_b64_tr_b16 a[78:79], v14 offset:19712
    s_waitcnt lgkmcnt(0)
    s_cmp_ge_u32 s28, 190
    s_cbranch_scc1 R_117
    s_add_u32 s45, s44, s47
    s_mul_i32 s54, s45, 40960
    s_add_u32 s56, s54, s52
    s_add_u32 s54, s54, s50
    v_mfma_f32_32x32x16_bf16 v[96:111], v[16:19], a[160:163], 0
    v_mfma_f32_32x32x16_bf16 v[96:111], v[20:23], a[164:167], v[96:111]
    v_mfma_f32_32x32x16_bf16 v[96:111], v[24:27], a[168:171], v[96:111]
    v_mfma_f32_32x32x16_bf16 v[96:111], v[28:31], a[172:175], v[96:111]
    v_mfma_f32_32x32x16_bf16 v[96:111], v[32:35], a[176:179], v[96:111]
    v_mfma_f32_32x32x16_bf16 v[96:111], v[36:39], a[180:183], v[96:111]
    v_mfma_f32_32x32x16_bf16 v[96:111], v[40:43], a[184:187], v[96:111]
    v_mfma_f32_32x32x16_bf16 v[96:111], v[44:47], a[188:191], v[96:111]
    v_mfma_f32_32x32x16_bf16 v[96:111], v[48:51], a[192:195], v[96:111]
    buffer_load_dwordx4 v[56:59], v2, s[8:11], s54 offen offset:0
    v_mfma_f32_32x32x16_bf16 v[96:111], v[52:55], a[196:199], v[96:111]
    buffer_load_dwordx4 v[60:63], v2, s[8:11], s54 offen offset:32
    v_mfma_f32_32x32x16_bf16 v[112:127], v[16:19], a[200:203], 0
    buffer_load_dwordx4 v[64:67], v2, s[8:11], s54 offen offset:64
    v_mfma_f32_32x32x16_bf16 v[112:127], v[20:23], a[204:207], v[112:127]
    v_mfma_f32_32x32x16_bf16 v[112:127], v[24:27], a[208:211], v[112:127]
    buffer_load_dwordx4 v[68:71], v2, s[8:11], s54 offen offset:96
    v_mfma_f32_32x32x16_bf16 v[112:127], v[28:31], a[212:215], v[112:127]
    v_mfma_f32_32x32x16_bf16 v[112:127], v[32:35], a[216:219], v[112:127]
    buffer_load_dwordx4 v[72:75], v2, s[8:11], s54 offen offset:128
    v_mfma_f32_32x32x16_bf16 v[112:127], v[36:39], a[220:223], v[112:127]
    v_mfma_f32_32x32x16_bf16 v[112:127], v[40:43], a[224:227], v[112:127]
    buffer_load_dwordx4 v[76:79], v2, s[8:11], s54 offen offset:160
    ds_write_b128 v4, v[96:99] offset:0
    v_mfma_f32_32x32x16_bf16 v[112:127], v[44:47], a[228:231], v[112:127]
    ds_write_b128 v4, v[100:103] offset:1024
    v_mfma_f32_32x32x16_bf16 v[112:127], v[48:51], a[232:235], v[112:127]
    buffer_load_dwordx4 v[80:83], v2, s[8:11], s54 offen offset:192
    ds_write_b128 v4, v[104:107] offset:2048
    v_mfma_f32_32x32x16_bf16 v[112:127], v[52:55], a[236:239], v[112:127]
    ds_write_b128 v4, v[108:111] offset:3072
    s_mov_b32 s59, 1073741824
    s_mul_i32 s55, s44, s58
    s_add_u32 s55, s55, s51
    v_mov_b64 v[128:129], 0
    s_mov_b32 s34, 0x3f803f80
    v_dot2c_f32_bf16 v128, s34, v16
    v_dot2c_f32_bf16 v129, v16, v16
    buffer_load_dwordx4 v[84:87], v2, s[8:11], s54 offen offset:224
    v_dot2c_f32_bf16 v128, s34, v17
    v_dot2c_f32_bf16 v129, v17, v17
    v_dot2c_f32_bf16 v128, s34, v18
    v_dot2c_f32_bf16 v129, v18, v18
    v_dot2c_f32_bf16 v128, s34, v19
    v_dot2c_f32_bf16 v129, v19, v19
    v_dot2c_f32_bf16 v128, s34, v20
    v_dot2c_f32_bf16 v129, v20, v20
    v_dot2c_f32_bf16 v128, s34, v21
    v_dot2c_f32_bf16 v129, v21, v21
    v_dot2c_f32_bf16 v128, s34, v22
    v_dot2c_f32_bf16 v129, v22, v22
    v_dot2c_f32_bf16 v128, s34, v23
    v_dot2c_f32_bf16 v129, v23, v23
    v_dot2c_f32_bf16 v128, s34, v24
    v_dot2c_f32_bf16 v129, v24, v24
    buffer_load_dwordx4 v[88:91], v2, s[8:11], s54 offen offset:256
    v_dot2c_f32_bf16 v128, s34, v25
    v_dot2c_f32_bf16 v129, v25, v25
    v_dot2c_f32_bf16 v128, s34, v26
    v_dot2c_f32_bf16 v129, v26, v26
    v_dot2c_f32_bf16 v128, s34, v27
    v_dot2c_f32_bf16 v129, v27, v27
    v_dot2c_f32_bf16 v128, s34, v28
    v_dot2c_f32_bf16 v129, v28, v28
    v_dot2c_f32_bf16 v128, s34, v29
    v_dot2c_f32_bf16 v129, v29, v29
    v_dot2c_f32_bf16 v128, s34, v30
    v_dot2c_f32_bf16 v129, v30, v30
    v_dot2c_f32_bf16 v128, s34, v31
    v_dot2c_f32_bf16 v129, v31, v31
    v_dot2c_f32_bf16 v128, s34, v32
    v_dot2c_f32_bf16 v129, v32, v32
    buffer_load_dwordx4 v[92:95], v2, s[8:11], s54 offen offset:288
    v_dot2c_f32_bf16 v128, s34, v33
    v_dot2c_f32_bf16 v129, v33, v33
    v_dot2c_f32_bf16 v128, s34, v34
    v_dot2c_f32_bf16 v129, v34, v34
    v_dot2c_f32_bf16 v128, s34, v35
    v_dot2c_f32_bf16 v129, v35, v35
    v_dot2c_f32_bf16 v128, s34, v36
    v_dot2c_f32_bf16 v129, v36, v36
    v_dot2c_f32_bf16 v128, s34, v37
    v_dot2c_f32_bf16 v129, v37, v37
    v_dot2c_f32_bf16 v128, s34, v38
    v_dot2c_f32_bf16 v129, v38, v38
    v_dot2c_f32_bf16 v128, s34, v39
    v_dot2c_f32_bf16 v129, v39, v39
    v_dot2c_f32_bf16 v128, s34, v40
    v_dot2c_f32_bf16 v129, v40, v40
    v_dot2c_f32_bf16 v128, s34, v41
    v_dot2c_f32_bf16 v129, v41, v41
    v_dot2c_f32_bf16 v128, s34, v42
    v_dot2c_f32_bf16 v129, v42, v42
    v_dot2c_f32_bf16 v128, s34, v43
    v_dot2c_f32_bf16 v129, v43, v43
    v_dot2c_f32_bf16 v128, s34, v44
    v_dot2c_f32_bf16 v129, v44, v44
    v_dot2c_f32_bf16 v128, s34, v45
    v_dot2c_f32_bf16 v129, v45, v45
    v_dot2c_f32_bf16 v128, s34, v46
    v_dot2c_f32_bf16 v129, v46, v46
    v_dot2c_f32_bf16 v128, s34, v47
    v_dot2c_f32_bf16 v129, v47, v47
    v_dot2c_f32_bf16 v128, s34, v48
    v_dot2c_f32_bf16 v129, v48, v48
    v_dot2c_f32_bf16 v128, s34, v49
    v_dot2c_f32_bf16 v129, v49, v49
    v_dot2c_f32_bf16 v128, s34, v50
    v_dot2c_f32_bf16 v129, v50, v50
    v_dot2c_f32_bf16 v128, s34, v51
    v_dot2c_f32_bf16 v129, v51, v51
    v_dot2c_f32_bf16 v128, s34, v52
    v_dot2c_f32_bf16 v129, v52, v52
    v_dot2c_f32_bf16 v128, s34, v53
    v_dot2c_f32_bf16 v129, v53, v53
    v_dot2c_f32_bf16 v128, s34, v54
    v_dot2c_f32_bf16 v129, v54, v54
    v_dot2c_f32_bf16 v128, s34, v55
    v_dot2c_f32_bf16 v129, v55, v55
    s_nop 2
    v_mov_b64 v[176:177], v[128:129]
    s_nop 1
    v_permlane32_swap_b32 v128, v176
    v_permlane32_swap_b32 v129, v177
    v_pk_add_f32 v[128:129], v[128:129], v[176:177]
    ds_write_b64 v5, v[128:129] offset:0
G_118:
    s_mov_b32 s44, s45
    s_add_u32 s45, s44, s47
    s_cmp_lt_u32 s45, s46
    s_cbranch_scc0 G_121
    s_mul_i32 s54, s45, 40960
    s_add_u32 s56, s54, s52
    s_add_u32 s54, s54, s50
    s_waitcnt vmcnt(9)
    v_mfma_f32_32x32x16_bf16 v[96:111], v[56:59], a[160:163], 0
    ds_write_b128 v4, v[112:115] offset:4096
    s_waitcnt vmcnt(8)
    v_mfma_f32_32x32x16_bf16 v[96:111], v[60:63], a[164:167], v[96:111]
    ds_write_b128 v4, v[116:119] offset:5120
    s_waitcnt vmcnt(7)
    v_mfma_f32_32x32x16_bf16 v[96:111], v[64:67], a[168:171], v[96:111]
    ds_write_b128 v4, v[120:123] offset:6144
    s_waitcnt vmcnt(6)
    v_mfma_f32_32x32x16_bf16 v[96:111], v[68:71], a[172:175], v[96:111]
    ds_write_b128 v4, v[124:127] offset:7168
    s_waitcnt vmcnt(5)
    v_mfma_f32_32x32x16_bf16 v[96:111], v[72:75], a[176:179], v[96:111]
    s_waitcnt vmcnt(4)
    v_mfma_f32_32x32x16_bf16 v[96:111], v[76:79], a[180:183], v[96:111]
    s_waitcnt lgkmcnt(0)
    s_barrier
    buffer_store_dwordx4 v[172:175], v7, s[4:7], s59 offen sc1
    s_waitcnt vmcnt(4)
    v_mfma_f32_32x32x16_bf16 v[96:111], v[80:83], a[184:187], v[96:111]
    ds_read_b128 v[130:133], v6 offset:0
    ds_read_b128 v[134:137], v6 offset:16
    ds_read_b128 v[184:187], v3 offset:0
    ds_read_b128 v[188:191], v3 offset:1024
    ds_read_b128 v[192:195], v3 offset:8192
    ds_read_b128 v[196:199], v3 offset:9216
    s_waitcnt vmcnt(3)
    v_mfma_f32_32x32x16_bf16 v[96:111], v[84:87], a[188:191], v[96:111]
    ds_read_b128 v[200:203], v3 offset:16384
    ds_read_b128 v[204:207], v3 offset:17408
    ds_read_b128 v[208:211], v3 offset:24576
    ds_read_b128 v[212:215], v3 offset:25600
    s_waitcnt vmcnt(2)
    v_mfma_f32_32x32x16_bf16 v[96:111], v[88:91], a[192:195], v[96:111]
    buffer_load_dwordx4 v[16:19], v2, s[8:11], s54 offen offset:0
    s_waitcnt vmcnt(2)
    v_mfma_f32_32x32x16_bf16 v[96:111], v[92:95], a[196:199], v[96:111]
    buffer_load_dwordx4 v[20:23], v2, s[8:11], s54 offen offset:32
    v_mfma_f32_32x32x16_bf16 v[112:127], v[56:59], a[200:203], 0
    buffer_load_dwordx4 v[24:27], v2, s[8:11], s54 offen offset:64
    s_waitcnt lgkmcnt(9)
    v_add_f32 v130, v130, v132
    v_add_f32 v131, v131, v133
    s_waitcnt lgkmcnt(8)
    v_add_f32 v130, v130, v134
    v_add_f32 v131, v131, v135
    v_add_f32 v130, v130, v136
    v_add_f32 v131, v131, v137
    v_mul_f32 v130, 0x3acccccd, v130
    v_mfma_f32_32x32x16_bf16 v[112:127], v[60:63], a[204:207], v[112:127]
    v_mul_f32 v131, 0x3acccccd, v131
    v_fma_f32 v131, -v130, v130, v131
    v_max_f32 v131, 0, v131
    v_add_f32 v131, 0x3727c5ac, v131
    v_rsq_f32 v131, v131
    s_nop 0
    ds_write2_b32 v9, v130, v131 offset0:0 offset1:32
    ds_read_b128 v[138:141], v10 offset:0
    v_mfma_f32_32x32x16_bf16 v[112:127], v[64:67], a[208:211], v[112:127]
    buffer_load_dwordx4 v[28:31], v2, s[8:11], s54 offen offset:96
    ds_read_b128 v[142:145], v10 offset:16
    ds_read_b128 v[146:149], v10 offset:128
    ds_read_b128 v[150:153], v10 offset:144
    s_waitcnt lgkmcnt(10)
    v_add_f32 v184, v184, v192
    v_add_f32 v185, v185, v193
    v_add_f32 v186, v186, v194
    v_add_f32 v187, v187, v195
    v_mfma_f32_32x32x16_bf16 v[112:127], v[68:71], a[212:215], v[112:127]
    s_waitcnt lgkmcnt(9)
    v_add_f32 v188, v188, v196
    v_add_f32 v189, v189, v197
    v_add_f32 v190, v190, v198
    v_add_f32 v191, v191, v199
    s_waitcnt lgkmcnt(8)
    v_add_f32 v184, v184, v200
    v_add_f32 v185, v185, v201
    v_add_f32 v186, v186, v202
    v_mfma_f32_32x32x16_bf16 v[112:127], v[72:75], a[216:219], v[112:127]
    buffer_load_dwordx4 v[32:35], v2, s[8:11], s54 offen offset:128
    v_add_f32 v187, v187, v203
    s_waitcnt lgkmcnt(7)
    v_add_f32 v188, v188, v204
    v_add_f32 v189, v189, v205
    v_add_f32 v190, v190, v206
    v_add_f32 v191, v191, v207
    s_waitcnt lgkmcnt(6)
    v_add_f32 v184, v184, v208
    v_add_f32 v185, v185, v209
    v_mfma_f32_32x32x16_bf16 v[112:127], v[76:79], a[220:223], v[112:127]
    v_add_f32 v186, v186, v210
    v_add_f32 v187, v187, v211
    s_waitcnt lgkmcnt(5)
    v_add_f32 v188, v188, v212
    v_add_f32 v189, v189, v213
    v_add_f32 v190, v190, v214
    v_add_f32 v191, v191, v215
    s_waitcnt lgkmcnt(3)
    v_fma_f32 v184, -v138, v154, v184
    v_mfma_f32_32x32x16_bf16 v[112:127], v[80:83], a[224:227], v[112:127]
    buffer_load_dwordx4 v[36:39], v2, s[8:11], s54 offen offset:160
    ds_write_b128 v4, v[96:99] offset:32768
    s_waitcnt lgkmcnt(2)
    v_mul_f32 v184, v184, v146
    v_fma_f32 v185, -v139, v155, v185
    v_mul_f32 v185, v185, v147
    v_fma_f32 v186, -v140, v156, v186
    v_mul_f32 v186, v186, v148
    v_fma_f32 v187, -v141, v157, v187
    v_mul_f32 v187, v187, v149
    v_mfma_f32_32x32x16_bf16 v[112:127], v[84:87], a[228:231], v[112:127]
    ds_write_b128 v4, v[100:103] offset:33792
    v_fma_f32 v188, -v142, v158, v188
    s_waitcnt lgkmcnt(2)
    v_mul_f32 v188, v188, v150
    v_fma_f32 v189, -v143, v159, v189
    v_mul_f32 v189, v189, v151
    v_fma_f32 v190, -v144, v160, v190
    v_mul_f32 v190, v190, v152
    v_fma_f32 v191, -v145, v161, v191
    v_mfma_f32_32x32x16_bf16 v[112:127], v[88:91], a[232:235], v[112:127]
    buffer_load_dwordx4 v[40:43], v2, s[8:11], s54 offen offset:192
    ds_write_b128 v4, v[104:107] offset:34816
    v_mul_f32 v191, v191, v153
    v_cvt_pk_bf16_f32 v172, v184, v185
    v_cvt_pk_bf16_f32 v173, v186, v187
    v_cvt_pk_bf16_f32 v174, v188, v189
    v_cvt_pk_bf16_f32 v175, v190, v191
    v_mfma_f32_32x32x16_bf16 v[112:127], v[92:95], a[236:239], v[112:127]
    ds_write_b128 v4, v[108:111] offset:35840
    s_mov_b32 s59, s55
    s_mul_i32 s55, s44, s58
    s_add_u32 s55, s55, s51
    v_mov_b64 v[128:129], 0
    s_mov_b32 s34, 0x3f803f80
    v_dot2c_f32_bf16 v128, s34, v56
    v_dot2c_f32_bf16 v129, v56, v56
    buffer_load_dwordx4 v[44:47], v2, s[8:11], s54 offen offset:224
    v_dot2c_f32_bf16 v128, s34, v57
    v_dot2c_f32_bf16 v129, v57, v57
    v_dot2c_f32_bf16 v128, s34, v58
    v_dot2c_f32_bf16 v129, v58, v58
    v_dot2c_f32_bf16 v128, s34, v59
    v_dot2c_f32_bf16 v129, v59, v59
    v_dot2c_f32_bf16 v128, s34, v60
    v_dot2c_f32_bf16 v129, v60, v60
    v_dot2c_f32_bf16 v128, s34, v61
    v_dot2c_f32_bf16 v129, v61, v61
    v_dot2c_f32_bf16 v128, s34, v62
    v_dot2c_f32_bf16 v129, v62, v62
    v_dot2c_f32_bf16 v128, s34, v63
    v_dot2c_f32_bf16 v129, v63, v63
    v_dot2c_f32_bf16 v128, s34, v64
    v_dot2c_f32_bf16 v129, v64, v64
    buffer_load_dwordx4 v[48:51], v2, s[8:11], s54 offen offset:256
    v_dot2c_f32_bf16 v128, s34, v65
    v_dot2c_f32_bf16 v129, v65, v65
    v_dot2c_f32_bf16 v128, s34, v66
    v_dot2c_f32_bf16 v129, v66, v66
    v_dot2c_f32_bf16 v128, s34, v67
    v_dot2c_f32_bf16 v129, v67, v67
    v_dot2c_f32_bf16 v128, s34, v68
    v_dot2c_f32_bf16 v129, v68, v68
    v_dot2c_f32_bf16 v128, s34, v69
    v_dot2c_f32_bf16 v129, v69, v69
    v_dot2c_f32_bf16 v128, s34, v70
    v_dot2c_f32_bf16 v129, v70, v70
    v_dot2c_f32_bf16 v128, s34, v71
    v_dot2c_f32_bf16 v129, v71, v71
    v_dot2c_f32_bf16 v128, s34, v72
    v_dot2c_f32_bf16 v129, v72, v72
    buffer_load_dwordx4 v[52:55], v2, s[8:11], s54 offen offset:288
    v_dot2c_f32_bf16 v128, s34, v73
    v_dot2c_f32_bf16 v129, v73, v73
    v_dot2c_f32_bf16 v128, s34, v74
    v_dot2c_f32_bf16 v129, v74, v74
    v_dot2c_f32_bf16 v128, s34, v75
    v_dot2c_f32_bf16 v129, v75, v75
    v_dot2c_f32_bf16 v128, s34, v76
    v_dot2c_f32_bf16 v129, v76, v76
    v_dot2c_f32_bf16 v128, s34, v77
    v_dot2c_f32_bf16 v129, v77, v77
    v_dot2c_f32_bf16 v128, s34, v78
    v_dot2c_f32_bf16 v129, v78, v78
    v_dot2c_f32_bf16 v128, s34, v79
    v_dot2c_f32_bf16 v129, v79, v79
    v_dot2c_f32_bf16 v128, s34, v80
    v_dot2c_f32_bf16 v129, v80, v80
    v_dot2c_f32_bf16 v128, s34, v81
    v_dot2c_f32_bf16 v129, v81, v81
    v_dot2c_f32_bf16 v128, s34, v82
    v_dot2c_f32_bf16 v129, v82, v82
    v_dot2c_f32_bf16 v128, s34, v83
    v_dot2c_f32_bf16 v129, v83, v83
    v_dot2c_f32_bf16 v128, s34, v84
    v_dot2c_f32_bf16 v129, v84, v84
    v_dot2c_f32_bf16 v128, s34, v85
    v_dot2c_f32_bf16 v129, v85, v85
    v_dot2c_f32_bf16 v128, s34, v86
    v_dot2c_f32_bf16 v129, v86, v86
    v_dot2c_f32_bf16 v128, s34, v87
    v_dot2c_f32_bf16 v129, v87, v87
    v_dot2c_f32_bf16 v128, s34, v88
    v_dot2c_f32_bf16 v129, v88, v88
    v_dot2c_f32_bf16 v128, s34, v89
    v_dot2c_f32_bf16 v129, v89, v89
    v_dot2c_f32_bf16 v128, s34, v90
    v_dot2c_f32_bf16 v129, v90, v90
    v_dot2c_f32_bf16 v128, s34, v91
    v_dot2c_f32_bf16 v129, v91, v91
    v_dot2c_f32_bf16 v128, s34, v92
    v_dot2c_f32_bf16 v129, v92, v92
    v_dot2c_f32_bf16 v128, s34, v93
    v_dot2c_f32_bf16 v129, v93, v93
    v_dot2c_f32_bf16 v128, s34, v94
    v_dot2c_f32_bf16 v129, v94, v94
    v_dot2c_f32_bf16 v128, s34, v95
    v_dot2c_f32_bf16 v129, v95, v95
    s_nop 2
    v_mov_b64 v[176:177], v[128:129]
    s_nop 1
    v_permlane32_swap_b32 v128, v176
    v_permlane32_swap_b32 v129, v177
    v_pk_add_f32 v[128:129], v[128:129], v[176:177]
    ds_write_b64 v5, v[128:129] offset:1024
    s_mov_b32 s44, s45
    s_add_u32 s45, s44, s47
    s_cmp_lt_u32 s45, s46
    s_cbranch_scc0 G_120
    s_mul_i32 s54, s45, 40960
    s_add_u32 s56, s54, s52
    s_add_u32 s54, s54, s50
    s_waitcnt vmcnt(9)
    v_mfma_f32_32x32x16_bf16 v[96:111], v[16:19], a[160:163], 0
    ds_write_b128 v4, v[112:115] offset:36864
    s_waitcnt vmcnt(8)
    v_mfma_f32_32x32x16_bf16 v[96:111], v[20:23], a[164:167], v[96:111]
    ds_write_b128 v4, v[116:119] offset:37888
    s_waitcnt vmcnt(7)
    v_mfma_f32_32x32x16_bf16 v[96:111], v[24:27], a[168:171], v[96:111]
    ds_write_b128 v4, v[120:123] offset:38912
    s_waitcnt vmcnt(6)
    v_mfma_f32_32x32x16_bf16 v[96:111], v[28:31], a[172:175], v[96:111]
    ds_write_b128 v4, v[124:127] offset:39936
    s_waitcnt vmcnt(5)
    v_mfma_f32_32x32x16_bf16 v[96:111], v[32:35], a[176:179], v[96:111]
    s_waitcnt vmcnt(4)
    v_mfma_f32_32x32x16_bf16 v[96:111], v[36:39], a[180:183], v[96:111]
    s_waitcnt lgkmcnt(0)
    s_barrier
    buffer_store_dwordx4 v[172:175], v7, s[4:7], s59 offen sc1
    s_waitcnt vmcnt(4)
    v_mfma_f32_32x32x16_bf16 v[96:111], v[40:43], a[184:187], v[96:111]
    ds_read_b128 v[130:133], v6 offset:1024
    ds_read_b128 v[134:137], v6 offset:1040
    ds_read_b128 v[184:187], v3 offset:32768
    ds_read_b128 v[188:191], v3 offset:33792
    ds_read_b128 v[192:195], v3 offset:40960
    ds_read_b128 v[196:199], v3 offset:41984
    s_waitcnt vmcnt(3)
    v_mfma_f32_32x32x16_bf16 v[96:111], v[44:47], a[188:191], v[96:111]
    ds_read_b128 v[200:203], v3 offset:49152
    ds_read_b128 v[204:207], v3 offset:50176
    ds_read_b128 v[208:211], v3 offset:57344
    ds_read_b128 v[212:215], v3 offset:58368
    s_waitcnt vmcnt(2)
    v_mfma_f32_32x32x16_bf16 v[96:111], v[48:51], a[192:195], v[96:111]
    buffer_load_dwordx4 v[56:59], v2, s[8:11], s54 offen offset:0
    s_waitcnt vmcnt(2)
    v_mfma_f32_32x32x16_bf16 v[96:111], v[52:55], a[196:199], v[96:111]
    buffer_load_dwordx4 v[60:63], v2, s[8:11], s54 offen offset:32
    v_mfma_f32_32x32x16_bf16 v[112:127], v[16:19], a[200:203], 0
    buffer_load_dwordx4 v[64:67], v2, s[8:11], s54 offen offset:64
    s_waitcnt lgkmcnt(9)
    v_add_f32 v130, v130, v132
    v_add_f32 v131, v131, v133
    s_waitcnt lgkmcnt(8)
    v_add_f32 v130, v130, v134
    v_add_f32 v131, v131, v135
    v_add_f32 v130, v130, v136
    v_add_f32 v131, v131, v137
    v_mul_f32 v130, 0x3acccccd, v130
    v_mfma_f32_32x32x16_bf16 v[112:127], v[20:23], a[204:207], v[112:127]
    v_mul_f32 v131, 0x3acccccd, v131
    v_fma_f32 v131, -v130, v130, v131
    v_max_f32 v131, 0, v131
    v_add_f32 v131, 0x3727c5ac, v131
    v_rsq_f32 v131, v131
    s_nop 0
    ds_write2_b32 v9, v130, v131 offset0:0 offset1:32
    ds_read_b128 v[138:141], v10 offset:0
    v_mfma_f32_32x32x16_bf16 v[112:127], v[24:27], a[208:211], v[112:127]
    buffer_load_dwordx4 v[68:71], v2, s[8:11], s54 offen offset:96
    ds_read_b128 v[142:145], v10 offset:16
    ds_read_b128 v[146:149], v10 offset:128
    ds_read_b128 v[150:153], v10 offset:144
    s_waitcnt lgkmcnt(10)
    v_add_f32 v184, v184, v192
    v_add_f32 v185, v185, v193
    v_add_f32 v186, v186, v194
    v_add_f32 v187, v187, v195
    v_mfma_f32_32x32x16_bf16 v[112:127], v[28:31], a[212:215], v[112:127]
    s_waitcnt lgkmcnt(9)
    v_add_f32 v188, v188, v196
    v_add_f32 v189, v189, v197
    v_add_f32 v190, v190, v198
    v_add_f32 v191, v191, v199
    s_waitcnt lgkmcnt(8)
    v_add_f32 v184, v184, v200
    v_add_f32 v185, v185, v201
    v_add_f32 v186, v186, v202
    v_mfma_f32_32x32x16_bf16 v[112:127], v[32:35], a[216:219], v[112:127]
    buffer_load_dwordx4 v[72:75], v2, s[8:11], s54 offen offset:128
    v_add_f32 v187, v187, v203
    s_waitcnt lgkmcnt(7)
    v_add_f32 v188, v188, v204
    v_add_f32 v189, v189, v205
    v_add_f32 v190, v190, v206
    v_add_f32 v191, v191, v207
    s_waitcnt lgkmcnt(6)
    v_add_f32 v184, v184, v208
    v_add_f32 v185, v185, v209
    v_mfma_f32_32x32x16_bf16 v[112:127], v[36:39], a[220:223], v[112:127]
    v_add_f32 v186, v186, v210
    v_add_f32 v187, v187, v211
    s_waitcnt lgkmcnt(5)
    v_add_f32 v188, v188, v212
    v_add_f32 v189, v189, v213
    v_add_f32 v190, v190, v214
    v_add_f32 v191, v191, v215
    s_waitcnt lgkmcnt(3)
    v_fma_f32 v184, -v138, v154, v184
    v_mfma_f32_32x32x16_bf16 v[112:127], v[40:43], a[224:227], v[112:127]
    buffer_load_dwordx4 v[76:79], v2, s[8:11], s54 offen offset:160
    ds_write_b128 v4, v[96:99] offset:0
    s_waitcnt lgkmcnt(2)
    v_mul_f32 v184, v184, v146
    v_fma_f32 v185, -v139, v155, v185
    v_mul_f32 v185, v185, v147
    v_fma_f32 v186, -v140, v156, v186
    v_mul_f32 v186, v186, v148
    v_fma_f32 v187, -v141, v157, v187
    v_mul_f32 v187, v187, v149
    v_mfma_f32_32x32x16_bf16 v[112:127], v[44:47], a[228:231], v[112:127]
    ds_write_b128 v4, v[100:103] offset:1024
    v_fma_f32 v188, -v142, v158, v188
    s_waitcnt lgkmcnt(2)
    v_mul_f32 v188, v188, v150
    v_fma_f32 v189, -v143, v159, v189
    v_mul_f32 v189, v189, v151
    v_fma_f32 v190, -v144, v160, v190
    v_mul_f32 v190, v190, v152
    v_fma_f32 v191, -v145, v161, v191
    v_mfma_f32_32x32x16_bf16 v[112:127], v[48:51], a[232:235], v[112:127]
    buffer_load_dwordx4 v[80:83], v2, s[8:11], s54 offen offset:192
    ds_write_b128 v4, v[104:107] offset:2048
    v_mul_f32 v191, v191, v153
    v_cvt_pk_bf16_f32 v172, v184, v185
    v_cvt_pk_bf16_f32 v173, v186, v187
    v_cvt_pk_bf16_f32 v174, v188, v189
    v_cvt_pk_bf16_f32 v175, v190, v191
    v_mfma_f32_32x32x16_bf16 v[112:127], v[52:55], a[236:239], v[112:127]
    ds_write_b128 v4, v[108:111] offset:3072
    s_mov_b32 s59, s55
    s_mul_i32 s55, s44, s58
    s_add_u32 s55, s55, s51
    v_mov_b64 v[128:129], 0
    s_mov_b32 s34, 0x3f803f80
    v_dot2c_f32_bf16 v128, s34, v16
    v_dot2c_f32_bf16 v129, v16, v16
    buffer_load_dwordx4 v[84:87], v2, s[8:11], s54 offen offset:224
    v_dot2c_f32_bf16 v128, s34, v17
    v_dot2c_f32_bf16 v129, v17, v17
    v_dot2c_f32_bf16 v128, s34, v18
    v_dot2c_f32_bf16 v129, v18, v18
    v_dot2c_f32_bf16 v128, s34, v19
    v_dot2c_f32_bf16 v129, v19, v19
    v_dot2c_f32_bf16 v128, s34, v20
    v_dot2c_f32_bf16 v129, v20, v20
    v_dot2c_f32_bf16 v128, s34, v21
    v_dot2c_f32_bf16 v129, v21, v21
    v_dot2c_f32_bf16 v128, s34, v22
    v_dot2c_f32_bf16 v129, v22, v22
    v_dot2c_f32_bf16 v128, s34, v23
    v_dot2c_f32_bf16 v129, v23, v23
    v_dot2c_f32_bf16 v128, s34, v24
    v_dot2c_f32_bf16 v129, v24, v24
    buffer_load_dwordx4 v[88:91], v2, s[8:11], s54 offen offset:256
    v_dot2c_f32_bf16 v128, s34, v25
    v_dot2c_f32_bf16 v129, v25, v25
    v_dot2c_f32_bf16 v128, s34, v26
    v_dot2c_f32_bf16 v129, v26, v26
    v_dot2c_f32_bf16 v128, s34, v27
    v_dot2c_f32_bf16 v129, v27, v27
    v_dot2c_f32_bf16 v128, s34, v28
    v_dot2c_f32_bf16 v129, v28, v28
    v_dot2c_f32_bf16 v128, s34, v29
    v_dot2c_f32_bf16 v129, v29, v29
    v_dot2c_f32_bf16 v128, s34, v30
    v_dot2c_f32_bf16 v129, v30, v30
    v_dot2c_f32_bf16 v128, s34, v31
    v_dot2c_f32_bf16 v129, v31, v31
    v_dot2c_f32_bf16 v128, s34, v32
    v_dot2c_f32_bf16 v129, v32, v32
    buffer_load_dwordx4 v[92:95], v2, s[8:11], s54 offen offset:288
    v_dot2c_f32_bf16 v128, s34, v33
    v_dot2c_f32_bf16 v129, v33, v33
    v_dot2c_f32_bf16 v128, s34, v34
    v_dot2c_f32_bf16 v129, v34, v34
    v_dot2c_f32_bf16 v128, s34, v35
    v_dot2c_f32_bf16 v129, v35, v35
    v_dot2c_f32_bf16 v128, s34, v36
    v_dot2c_f32_bf16 v129, v36, v36
    v_dot2c_f32_bf16 v128, s34, v37
    v_dot2c_f32_bf16 v129, v37, v37
    v_dot2c_f32_bf16 v128, s34, v38
    v_dot2c_f32_bf16 v129, v38, v38
    v_dot2c_f32_bf16 v128, s34, v39
    v_dot2c_f32_bf16 v129, v39, v39
    v_dot2c_f32_bf16 v128, s34, v40
    v_dot2c_f32_bf16 v129, v40, v40
    v_dot2c_f32_bf16 v128, s34, v41
    v_dot2c_f32_bf16 v129, v41, v41
    v_dot2c_f32_bf16 v128, s34, v42
    v_dot2c_f32_bf16 v129, v42, v42
    v_dot2c_f32_bf16 v128, s34, v43
    v_dot2c_f32_bf16 v129, v43, v43
    v_dot2c_f32_bf16 v128, s34, v44
    v_dot2c_f32_bf16 v129, v44, v44
    v_dot2c_f32_bf16 v128, s34, v45
    v_dot2c_f32_bf16 v129, v45, v45
    v_dot2c_f32_bf16 v128, s34, v46
    v_dot2c_f32_bf16 v129, v46, v46
    v_dot2c_f32_bf16 v128, s34, v47
    v_dot2c_f32_bf16 v129, v47, v47
    v_dot2c_f32_bf16 v128, s34, v48
    v_dot2c_f32_bf16 v129, v48, v48
    v_dot2c_f32_bf16 v128, s34, v49
    v_dot2c_f32_bf16 v129, v49, v49
    v_dot2c_f32_bf16 v128, s34, v50
    v_dot2c_f32_bf16 v129, v50, v50
    v_dot2c_f32_bf16 v128, s34, v51
    v_dot2c_f32_bf16 v129, v51, v51
    v_dot2c_f32_bf16 v128, s34, v52
    v_dot2c_f32_bf16 v129, v52, v52
    v_dot2c_f32_bf16 v128, s34, v53
    v_dot2c_f32_bf16 v129, v53, v53
    v_dot2c_f32_bf16 v128, s34, v54
    v_dot2c_f32_bf16 v129, v54, v54
    v_dot2c_f32_bf16 v128, s34, v55
    v_dot2c_f32_bf16 v129, v55, v55
    s_nop 2
    v_mov_b64 v[176:177], v[128:129]
    s_nop 1
    v_permlane32_swap_b32 v128, v176
    v_permlane32_swap_b32 v129, v177
    v_pk_add_f32 v[128:129], v[128:129], v[176:177]
    ds_write_b64 v5, v[128:129] offset:0
    s_branch G_118
G_121:
    s_waitcnt vmcnt(9)
    v_mfma_f32_32x32x16_bf16 v[96:111], v[56:59], a[160:163], 0
    ds_write_b128 v4, v[112:115] offset:4096
    s_waitcnt vmcnt(8)
    v_mfma_f32_32x32x16_bf16 v[96:111], v[60:63], a[164:167], v[96:111]
    ds_write_b128 v4, v[116:119] offset:5120
    s_waitcnt vmcnt(7)
    v_mfma_f32_32x32x16_bf16 v[96:111], v[64:67], a[168:171], v[96:111]
    ds_write_b128 v4, v[120:123] offset:6144
    s_waitcnt vmcnt(6)
    v_mfma_f32_32x32x16_bf16 v[96:111], v[68:71], a[172:175], v[96:111]
    ds_write_b128 v4, v[124:127] offset:7168
    s_waitcnt vmcnt(5)
    v_mfma_f32_32x32x16_bf16 v[96:111], v[72:75], a[176:179], v[96:111]
    s_waitcnt vmcnt(4)
    v_mfma_f32_32x32x16_bf16 v[96:111], v[76:79], a[180:183], v[96:111]
    s_waitcnt lgkmcnt(0)
    s_barrier
    buffer_store_dwordx4 v[172:175], v7, s[4:7], s59 offen sc1
    s_waitcnt vmcnt(4)
    v_mfma_f32_32x32x16_bf16 v[96:111], v[80:83], a[184:187], v[96:111]
    ds_read_b128 v[130:133], v6 offset:0
    ds_read_b128 v[134:137], v6 offset:16
    ds_read_b128 v[184:187], v3 offset:0
    ds_read_b128 v[188:191], v3 offset:1024
    ds_read_b128 v[192:195], v3 offset:8192
    ds_read_b128 v[196:199], v3 offset:9216
    s_waitcnt vmcnt(3)
    v_mfma_f32_32x32x16_bf16 v[96:111], v[84:87], a[188:191], v[96:111]
    ds_read_b128 v[200:203], v3 offset:16384
    ds_read_b128 v[204:207], v3 offset:17408
    ds_read_b128 v[208:211], v3 offset:24576
    ds_read_b128 v[212:215], v3 offset:25600
    s_waitcnt vmcnt(2)
    v_mfma_f32_32x32x16_bf16 v[96:111], v[88:91], a[192:195], v[96:111]
    s_waitcnt vmcnt(1)
    v_mfma_f32_32x32x16_bf16 v[96:111], v[92:95], a[196:199], v[96:111]
    v_mfma_f32_32x32x16_bf16 v[112:127], v[56:59], a[200:203], 0
    s_waitcnt lgkmcnt(9)
    v_add_f32 v130, v130, v132
    v_add_f32 v131, v131, v133
    s_waitcnt lgkmcnt(8)
    v_add_f32 v130, v130, v134
    v_add_f32 v131, v131, v135
    v_add_f32 v130, v130, v136
    v_add_f32 v131, v131, v137
    v_mul_f32 v130, 0x3acccccd, v130
    v_mfma_f32_32x32x16_bf16 v[112:127], v[60:63], a[204:207], v[112:127]
    v_mul_f32 v131, 0x3acccccd, v131
    v_fma_f32 v131, -v130, v130, v131
    v_max_f32 v131, 0, v131
    v_add_f32 v131, 0x3727c5ac, v131
    v_rsq_f32 v131, v131
    s_nop 0
    ds_write2_b32 v9, v130, v131 offset0:0 offset1:32
    ds_read_b128 v[138:141], v10 offset:0
    v_mfma_f32_32x32x16_bf16 v[112:127], v[64:67], a[208:211], v[112:127]
    ds_read_b128 v[142:145], v10 offset:16
    ds_read_b128 v[146:149], v10 offset:128
    ds_read_b128 v[150:153], v10 offset:144
    s_waitcnt lgkmcnt(10)
    v_add_f32 v184, v184, v192
    v_add_f32 v185, v185, v193
    v_add_f32 v186, v186, v194
    v_add_f32 v187, v187, v195
    v_mfma_f32_32x32x16_bf16 v[112:127], v[68:71], a[212:215], v[112:127]
    s_waitcnt lgkmcnt(9)
    v_add_f32 v188, v188, v196
    v_add_f32 v189, v189, v197
    v_add_f32 v190, v190, v198
    v_add_f32 v191, v191, v199
    s_waitcnt lgkmcnt(8)
    v_add_f32 v184, v184, v200
    v_add_f32 v185, v185, v201
    v_add_f32 v186, v186, v202
    v_mfma_f32_32x32x16_bf16 v[112:127], v[72:75], a[216:219], v[112:127]
    v_add_f32 v187, v187, v203
    s_waitcnt lgkmcnt(7)
    v_add_f32 v188, v188, v204
    v_add_f32 v189, v189, v205
    v_add_f32 v190, v190, v206
    v_add_f32 v191, v191, v207
    s_waitcnt lgkmcnt(6)
    v_add_f32 v184, v184, v208
    v_add_f32 v185, v185, v209
    v_mfma_f32_32x32x16_bf16 v[112:127], v[76:79], a[220:223], v[112:127]
    v_add_f32 v186, v186, v210
    v_add_f32 v187, v187, v211
    s_waitcnt lgkmcnt(5)
    v_add_f32 v188, v188, v212
    v_add_f32 v189, v189, v213
    v_add_f32 v190, v190, v214
    v_add_f32 v191, v191, v215
    s_waitcnt lgkmcnt(3)
    v_fma_f32 v184, -v138, v154, v184
    v_mfma_f32_32x32x16_bf16 v[112:127], v[80:83], a[224:227], v[112:127]
    ds_write_b128 v4, v[96:99] offset:32768
    s_waitcnt lgkmcnt(2)
    v_mul_f32 v184, v184, v146
    v_fma_f32 v185, -v139, v155, v185
    v_mul_f32 v185, v185, v147
    v_fma_f32 v186, -v140, v156, v186
    v_mul_f32 v186, v186, v148
    v_fma_f32 v187, -v141, v157, v187
    v_mul_f32 v187, v187, v149
    v_mfma_f32_32x32x16_bf16 v[112:127], v[84:87], a[228:231], v[112:127]
    ds_write_b128 v4, v[100:103] offset:33792
    v_fma_f32 v188, -v142, v158, v188
    s_waitcnt lgkmcnt(2)
    v_mul_f32 v188, v188, v150
    v_fma_f32 v189, -v143, v159, v189
    v_mul_f32 v189, v189, v151
    v_fma_f32 v190, -v144, v160, v190
    v_mul_f32 v190, v190, v152
    v_fma_f32 v191, -v145, v161, v191
    v_mfma_f32_32x32x16_bf16 v[112:127], v[88:91], a[232:235], v[112:127]
    ds_write_b128 v4, v[104:107] offset:34816
    v_mul_f32 v191, v191, v153
    v_cvt_pk_bf16_f32 v172, v184, v185
    v_cvt_pk_bf16_f32 v173, v186, v187
    v_cvt_pk_bf16_f32 v174, v188, v189
    v_cvt_pk_bf16_f32 v175, v190, v191
    v_mfma_f32_32x32x16_bf16 v[112:127], v[92:95], a[236:239], v[112:127]
    ds_write_b128 v4, v[108:111] offset:35840
    s_mov_b32 s59, s55
    s_mul_i32 s55, s44, s58
    s_add_u32 s55, s55, s51
    v_mov_b64 v[128:129], 0
    s_mov_b32 s34, 0x3f803f80
    v_dot2c_f32_bf16 v128, s34, v56
    v_dot2c_f32_bf16 v129, v56, v56
    v_dot2c_f32_bf16 v128, s34, v57
    v_dot2c_f32_bf16 v129, v57, v57
    v_dot2c_f32_bf16 v128, s34, v58
    v_dot2c_f32_bf16 v129, v58, v58
    v_dot2c_f32_bf16 v128, s34, v59
    v_dot2c_f32_bf16 v129, v59, v59
    v_dot2c_f32_bf16 v128, s34, v60
    v_dot2c_f32_bf16 v129, v60, v60
    v_dot2c_f32_bf16 v128, s34, v61
    v_dot2c_f32_bf16 v129, v61, v61
    v_dot2c_f32_bf16 v128, s34, v62
    v_dot2c_f32_bf16 v129, v62, v62
    v_dot2c_f32_bf16 v128, s34, v63
    v_dot2c_f32_bf16 v129, v63, v63
    v_dot2c_f32_bf16 v128, s34, v64
    v_dot2c_f32_bf16 v129, v64, v64
    v_dot2c_f32_bf16 v128, s34, v65
    v_dot2c_f32_bf16 v129, v65, v65
    v_dot2c_f32_bf16 v128, s34, v66
    v_dot2c_f32_bf16 v129, v66, v66
    v_dot2c_f32_bf16 v128, s34, v67
    v_dot2c_f32_bf16 v129, v67, v67
    v_dot2c_f32_bf16 v128, s34, v68
    v_dot2c_f32_bf16 v129, v68, v68
    v_dot2c_f32_bf16 v128, s34, v69
    v_dot2c_f32_bf16 v129, v69, v69
    v_dot2c_f32_bf16 v128, s34, v70
    v_dot2c_f32_bf16 v129, v70, v70
    v_dot2c_f32_bf16 v128, s34, v71
    v_dot2c_f32_bf16 v129, v71, v71
    v_dot2c_f32_bf16 v128, s34, v72
    v_dot2c_f32_bf16 v129, v72, v72
    v_dot2c_f32_bf16 v128, s34, v73
    v_dot2c_f32_bf16 v129, v73, v73
    v_dot2c_f32_bf16 v128, s34, v74
    v_dot2c_f32_bf16 v129, v74, v74
    v_dot2c_f32_bf16 v128, s34, v75
    v_dot2c_f32_bf16 v129, v75, v75
    v_dot2c_f32_bf16 v128, s34, v76
    v_dot2c_f32_bf16 v129, v76, v76
    v_dot2c_f32_bf16 v128, s34, v77
    v_dot2c_f32_bf16 v129, v77, v77
    v_dot2c_f32_bf16 v128, s34, v78
    v_dot2c_f32_bf16 v129, v78, v78
    v_dot2c_f32_bf16 v128, s34, v79
    v_dot2c_f32_bf16 v129, v79, v79
    v_dot2c_f32_bf16 v128, s34, v80
    v_dot2c_f32_bf16 v129, v80, v80
    v_dot2c_f32_bf16 v128, s34, v81
    v_dot2c_f32_bf16 v129, v81, v81
    v_dot2c_f32_bf16 v128, s34, v82
    v_dot2c_f32_bf16 v129, v82, v82
    v_dot2c_f32_bf16 v128, s34, v83
    v_dot2c_f32_bf16 v129, v83, v83
    v_dot2c_f32_bf16 v128, s34, v84
    v_dot2c_f32_bf16 v129, v84, v84
    v_dot2c_f32_bf16 v128, s34, v85
    v_dot2c_f32_bf16 v129, v85, v85
    v_dot2c_f32_bf16 v128, s34, v86
    v_dot2c_f32_bf16 v129, v86, v86
    v_dot2c_f32_bf16 v128, s34, v87
    v_dot2c_f32_bf16 v129, v87, v87
    v_dot2c_f32_bf16 v128, s34, v88
    v_dot2c_f32_bf16 v129, v88, v88
    v_dot2c_f32_bf16 v128, s34, v89
    v_dot2c_f32_bf16 v129, v89, v89
    v_dot2c_f32_bf16 v128, s34, v90
    v_dot2c_f32_bf16 v129, v90, v90
    v_dot2c_f32_bf16 v128, s34, v91
    v_dot2c_f32_bf16 v129, v91, v91
    v_dot2c_f32_bf16 v128, s34, v92
    v_dot2c_f32_bf16 v129, v92, v92
    v_dot2c_f32_bf16 v128, s34, v93
    v_dot2c_f32_bf16 v129, v93, v93
    v_dot2c_f32_bf16 v128, s34, v94
    v_dot2c_f32_bf16 v129, v94, v94
    v_dot2c_f32_bf16 v128, s34, v95
    v_dot2c_f32_bf16 v129, v95, v95
    s_nop 2
    v_mov_b64 v[176:177], v[128:129]
    s_nop 1
    v_permlane32_swap_b32 v128, v176
    v_permlane32_swap_b32 v129, v177
    v_pk_add_f32 v[128:129], v[128:129], v[176:177]
    ds_write_b64 v5, v[128:129] offset:1024
    ds_write_b128 v4, v[112:115] offset:36864
    ds_write_b128 v4, v[116:119] offset:37888
    ds_write_b128 v4, v[120:123] offset:38912
    ds_write_b128 v4, v[124:127] offset:39936
    s_waitcnt vmcnt(0)
    s_waitcnt lgkmcnt(0)
    s_barrier
    buffer_store_dwordx4 v[172:175], v7, s[4:7], s59 offen sc1
    ds_read_b128 v[130:133], v6 offset:1024
    ds_read_b128 v[134:137], v6 offset:1040
    ds_read_b128 v[184:187], v3 offset:32768
    ds_read_b128 v[188:191], v3 offset:33792
    ds_read_b128 v[192:195], v3 offset:40960
    ds_read_b128 v[196:199], v3 offset:41984
    ds_read_b128 v[200:203], v3 offset:49152
    ds_read_b128 v[204:207], v3 offset:50176
    ds_read_b128 v[208:211], v3 offset:57344
    ds_read_b128 v[212:215], v3 offset:58368
    s_waitcnt lgkmcnt(9)
    v_add_f32 v130, v130, v132
    v_add_f32 v131, v131, v133
    s_waitcnt lgkmcnt(8)
    v_add_f32 v130, v130, v134
    v_add_f32 v131, v131, v135
    v_add_f32 v130, v130, v136
    v_add_f32 v131, v131, v137
    v_mul_f32 v130, 0x3acccccd, v130
    v_mul_f32 v131, 0x3acccccd, v131
    v_fma_f32 v131, -v130, v130, v131
    v_max_f32 v131, 0, v131
    v_add_f32 v131, 0x3727c5ac, v131
    v_rsq_f32 v131, v131
    s_nop 0
    ds_write2_b32 v9, v130, v131 offset0:0 offset1:32
    ds_read_b128 v[138:141], v10 offset:0
    ds_read_b128 v[142:145], v10 offset:16
    ds_read_b128 v[146:149], v10 offset:128
    ds_read_b128 v[150:153], v10 offset:144
    s_waitcnt lgkmcnt(10)
    v_add_f32 v184, v184, v192
    v_add_f32 v185, v185, v193
    v_add_f32 v186, v186, v194
    v_add_f32 v187, v187, v195
    s_waitcnt lgkmcnt(9)
    v_add_f32 v188, v188, v196
    v_add_f32 v189, v189, v197
    v_add_f32 v190, v190, v198
    v_add_f32 v191, v191, v199
    s_waitcnt lgkmcnt(8)
    v_add_f32 v184, v184, v200
    v_add_f32 v185, v185, v201
    v_add_f32 v186, v186, v202
    v_add_f32 v187, v187, v203
    s_waitcnt lgkmcnt(7)
    v_add_f32 v188, v188, v204
    v_add_f32 v189, v189, v205
    v_add_f32 v190, v190, v206
    v_add_f32 v191, v191, v207
    s_waitcnt lgkmcnt(6)
    v_add_f32 v184, v184, v208
    v_add_f32 v185, v185, v209
    v_add_f32 v186, v186, v210
    v_add_f32 v187, v187, v211
    s_waitcnt lgkmcnt(5)
    v_add_f32 v188, v188, v212
    v_add_f32 v189, v189, v213
    v_add_f32 v190, v190, v214
    v_add_f32 v191, v191, v215
    s_waitcnt lgkmcnt(3)
    v_fma_f32 v184, -v138, v154, v184
    s_waitcnt lgkmcnt(1)
    v_mul_f32 v184, v184, v146
    v_fma_f32 v185, -v139, v155, v185
    v_mul_f32 v185, v185, v147
    v_fma_f32 v186, -v140, v156, v186
    v_mul_f32 v186, v186, v148
    v_fma_f32 v187, -v141, v157, v187
    v_mul_f32 v187, v187, v149
    v_fma_f32 v188, -v142, v158, v188
    s_waitcnt lgkmcnt(0)
    v_mul_f32 v188, v188, v150
    v_fma_f32 v189, -v143, v159, v189
    v_mul_f32 v189, v189, v151
    v_fma_f32 v190, -v144, v160, v190
    v_mul_f32 v190, v190, v152
    v_fma_f32 v191, -v145, v161, v191
    v_mul_f32 v191, v191, v153
    v_cvt_pk_bf16_f32 v172, v184, v185
    v_cvt_pk_bf16_f32 v173, v186, v187
    v_cvt_pk_bf16_f32 v174, v188, v189
    v_cvt_pk_bf16_f32 v175, v190, v191
    s_mov_b32 s59, s55
    buffer_store_dwordx4 v[172:175], v7, s[4:7], s59 offen sc1
    s_branch G_119
G_120:
    s_waitcnt vmcnt(9)
    v_mfma_f32_32x32x16_bf16 v[96:111], v[16:19], a[160:163], 0
    ds_write_b128 v4, v[112:115] offset:36864
    s_waitcnt vmcnt(8)
    v_mfma_f32_32x32x16_bf16 v[96:111], v[20:23], a[164:167], v[96:111]
    ds_write_b128 v4, v[116:119] offset:37888
    s_waitcnt vmcnt(7)
    v_mfma_f32_32x32x16_bf16 v[96:111], v[24:27], a[168:171], v[96:111]
    ds_write_b128 v4, v[120:123] offset:38912
    s_waitcnt vmcnt(6)
    v_mfma_f32_32x32x16_bf16 v[96:111], v[28:31], a[172:175], v[96:111]
    ds_write_b128 v4, v[124:127] offset:39936
    s_waitcnt vmcnt(5)
    v_mfma_f32_32x32x16_bf16 v[96:111], v[32:35], a[176:179], v[96:111]
    s_waitcnt vmcnt(4)
    v_mfma_f32_32x32x16_bf16 v[96:111], v[36:39], a[180:183], v[96:111]
    s_waitcnt lgkmcnt(0)
    s_barrier
    buffer_store_dwordx4 v[172:175], v7, s[4:7], s59 offen sc1
    s_waitcnt vmcnt(4)
    v_mfma_f32_32x32x16_bf16 v[96:111], v[40:43], a[184:187], v[96:111]
    ds_read_b128 v[130:133], v6 offset:1024
    ds_read_b128 v[134:137], v6 offset:1040
    ds_read_b128 v[184:187], v3 offset:32768
    ds_read_b128 v[188:191], v3 offset:33792
    ds_read_b128 v[192:195], v3 offset:40960
    ds_read_b128 v[196:199], v3 offset:41984
    s_waitcnt vmcnt(3)
    v_mfma_f32_32x32x16_bf16 v[96:111], v[44:47], a[188:191], v[96:111]
    ds_read_b128 v[200:203], v3 offset:49152
    ds_read_b128 v[204:207], v3 offset:50176
    ds_read_b128 v[208:211], v3 offset:57344
    ds_read_b128 v[212:215], v3 offset:58368
    s_waitcnt vmcnt(2)
    v_mfma_f32_32x32x16_bf16 v[96:111], v[48:51], a[192:195], v[96:111]
    s_waitcnt vmcnt(1)
    v_mfma_f32_32x32x16_bf16 v[96:111], v[52:55], a[196:199], v[96:111]
    v_mfma_f32_32x32x16_bf16 v[112:127], v[16:19], a[200:203], 0
    s_waitcnt lgkmcnt(9)
    v_add_f32 v130, v130, v132
    v_add_f32 v131, v131, v133
    s_waitcnt lgkmcnt(8)
    v_add_f32 v130, v130, v134
    v_add_f32 v131, v131, v135
    v_add_f32 v130, v130, v136
    v_add_f32 v131, v131, v137
    v_mul_f32 v130, 0x3acccccd, v130
    v_mfma_f32_32x32x16_bf16 v[112:127], v[20:23], a[204:207], v[112:127]
    v_mul_f32 v131, 0x3acccccd, v131
    v_fma_f32 v131, -v130, v130, v131
    v_max_f32 v131, 0, v131
    v_add_f32 v131, 0x3727c5ac, v131
    v_rsq_f32 v131, v131
    s_nop 0
    ds_write2_b32 v9, v130, v131 offset0:0 offset1:32
    ds_read_b128 v[138:141], v10 offset:0
    v_mfma_f32_32x32x16_bf16 v[112:127], v[24:27], a[208:211], v[112:127]
    ds_read_b128 v[142:145], v10 offset:16
    ds_read_b128 v[146:149], v10 offset:128
    ds_read_b128 v[150:153], v10 offset:144
    s_waitcnt lgkmcnt(10)
    v_add_f32 v184, v184, v192
    v_add_f32 v185, v185, v193
    v_add_f32 v186, v186, v194
    v_add_f32 v187, v187, v195
    v_mfma_f32_32x32x16_bf16 v[112:127], v[28:31], a[212:215], v[112:127]
    s_waitcnt lgkmcnt(9)
    v_add_f32 v188, v188, v196
    v_add_f32 v189, v189, v197
    v_add_f32 v190, v190, v198
    v_add_f32 v191, v191, v199
    s_waitcnt lgkmcnt(8)
    v_add_f32 v184, v184, v200
    v_add_f32 v185, v185, v201
    v_add_f32 v186, v186, v202
    v_mfma_f32_32x32x16_bf16 v[112:127], v[32:35], a[216:219], v[112:127]
    v_add_f32 v187, v187, v203
    s_waitcnt lgkmcnt(7)
    v_add_f32 v188, v188, v204
    v_add_f32 v189, v189, v205
    v_add_f32 v190, v190, v206
    v_add_f32 v191, v191, v207
    s_waitcnt lgkmcnt(6)
    v_add_f32 v184, v184, v208
    v_add_f32 v185, v185, v209
    v_mfma_f32_32x32x16_bf16 v[112:127], v[36:39], a[220:223], v[112:127]
    v_add_f32 v186, v186, v210
    v_add_f32 v187, v187, v211
    s_waitcnt lgkmcnt(5)
    v_add_f32 v188, v188, v212
    v_add_f32 v189, v189, v213
    v_add_f32 v190, v190, v214
    v_add_f32 v191, v191, v215
    s_waitcnt lgkmcnt(3)
    v_fma_f32 v184, -v138, v154, v184
    v_mfma_f32_32x32x16_bf16 v[112:127], v[40:43], a[224:227], v[112:127]
    ds_write_b128 v4, v[96:99] offset:0
    s_waitcnt lgkmcnt(2)
    v_mul_f32 v184, v184, v146
    v_fma_f32 v185, -v139, v155, v185
    v_mul_f32 v185, v185, v147
    v_fma_f32 v186, -v140, v156, v186
    v_mul_f32 v186, v186, v148
    v_fma_f32 v187, -v141, v157, v187
    v_mul_f32 v187, v187, v149
    v_mfma_f32_32x32x16_bf16 v[112:127], v[44:47], a[228:231], v[112:127]
    ds_write_b128 v4, v[100:103] offset:1024
    v_fma_f32 v188, -v142, v158, v188
    s_waitcnt lgkmcnt(2)
    v_mul_f32 v188, v188, v150
    v_fma_f32 v189, -v143, v159, v189
    v_mul_f32 v189, v189, v151
    v_fma_f32 v190, -v144, v160, v190
    v_mul_f32 v190, v190, v152
    v_fma_f32 v191, -v145, v161, v191
    v_mfma_f32_32x32x16_bf16 v[112:127], v[48:51], a[232:235], v[112:127]
    ds_write_b128 v4, v[104:107] offset:2048
    v_mul_f32 v191, v191, v153
    v_cvt_pk_bf16_f32 v172, v184, v185
    v_cvt_pk_bf16_f32 v173, v186, v187
    v_cvt_pk_bf16_f32 v174, v188, v189
    v_cvt_pk_bf16_f32 v175, v190, v191
    v_mfma_f32_32x32x16_bf16 v[112:127], v[52:55], a[236:239], v[112:127]
    ds_write_b128 v4, v[108:111] offset:3072
    s_mov_b32 s59, s55
    s_mul_i32 s55, s44, s58
    s_add_u32 s55, s55, s51
    v_mov_b64 v[128:129], 0
    s_mov_b32 s34, 0x3f803f80
    v_dot2c_f32_bf16 v128, s34, v16
    v_dot2c_f32_bf16 v129, v16, v16
    v_dot2c_f32_bf16 v128, s34, v17
    v_dot2c_f32_bf16 v129, v17, v17
    v_dot2c_f32_bf16 v128, s34, v18
    v_dot2c_f32_bf16 v129, v18, v18
    v_dot2c_f32_bf16 v128, s34, v19
    v_dot2c_f32_bf16 v129, v19, v19
    v_dot2c_f32_bf16 v128, s34, v20
    v_dot2c_f32_bf16 v129, v20, v20
    v_dot2c_f32_bf16 v128, s34, v21
    v_dot2c_f32_bf16 v129, v21, v21
    v_dot2c_f32_bf16 v128, s34, v22
    v_dot2c_f32_bf16 v129, v22, v22
    v_dot2c_f32_bf16 v128, s34, v23
    v_dot2c_f32_bf16 v129, v23, v23
    v_dot2c_f32_bf16 v128, s34, v24
    v_dot2c_f32_bf16 v129, v24, v24
    v_dot2c_f32_bf16 v128, s34, v25
    v_dot2c_f32_bf16 v129, v25, v25
    v_dot2c_f32_bf16 v128, s34, v26
    v_dot2c_f32_bf16 v129, v26, v26
    v_dot2c_f32_bf16 v128, s34, v27
    v_dot2c_f32_bf16 v129, v27, v27
    v_dot2c_f32_bf16 v128, s34, v28
    v_dot2c_f32_bf16 v129, v28, v28
    v_dot2c_f32_bf16 v128, s34, v29
    v_dot2c_f32_bf16 v129, v29, v29
    v_dot2c_f32_bf16 v128, s34, v30
    v_dot2c_f32_bf16 v129, v30, v30
    v_dot2c_f32_bf16 v128, s34, v31
    v_dot2c_f32_bf16 v129, v31, v31
    v_dot2c_f32_bf16 v128, s34, v32
    v_dot2c_f32_bf16 v129, v32, v32
    v_dot2c_f32_bf16 v128, s34, v33
    v_dot2c_f32_bf16 v129, v33, v33
    v_dot2c_f32_bf16 v128, s34, v34
    v_dot2c_f32_bf16 v129, v34, v34
    v_dot2c_f32_bf16 v128, s34, v35
    v_dot2c_f32_bf16 v129, v35, v35
    v_dot2c_f32_bf16 v128, s34, v36
    v_dot2c_f32_bf16 v129, v36, v36
    v_dot2c_f32_bf16 v128, s34, v37
    v_dot2c_f32_bf16 v129, v37, v37
    v_dot2c_f32_bf16 v128, s34, v38
    v_dot2c_f32_bf16 v129, v38, v38
    v_dot2c_f32_bf16 v128, s34, v39
    v_dot2c_f32_bf16 v129, v39, v39
    v_dot2c_f32_bf16 v128, s34, v40
    v_dot2c_f32_bf16 v129, v40, v40
    v_dot2c_f32_bf16 v128, s34, v41
    v_dot2c_f32_bf16 v129, v41, v41
    v_dot2c_f32_bf16 v128, s34, v42
    v_dot2c_f32_bf16 v129, v42, v42
    v_dot2c_f32_bf16 v128, s34, v43
    v_dot2c_f32_bf16 v129, v43, v43
    v_dot2c_f32_bf16 v128, s34, v44
    v_dot2c_f32_bf16 v129, v44, v44
    v_dot2c_f32_bf16 v128, s34, v45
    v_dot2c_f32_bf16 v129, v45, v45
    v_dot2c_f32_bf16 v128, s34, v46
    v_dot2c_f32_bf16 v129, v46, v46
    v_dot2c_f32_bf16 v128, s34, v47
    v_dot2c_f32_bf16 v129, v47, v47
    v_dot2c_f32_bf16 v128, s34, v48
    v_dot2c_f32_bf16 v129, v48, v48
    v_dot2c_f32_bf16 v128, s34, v49
    v_dot2c_f32_bf16 v129, v49, v49
    v_dot2c_f32_bf16 v128, s34, v50
    v_dot2c_f32_bf16 v129, v50, v50
    v_dot2c_f32_bf16 v128, s34, v51
    v_dot2c_f32_bf16 v129, v51, v51
    v_dot2c_f32_bf16 v128, s34, v52
    v_dot2c_f32_bf16 v129, v52, v52
    v_dot2c_f32_bf16 v128, s34, v53
    v_dot2c_f32_bf16 v129, v53, v53
    v_dot2c_f32_bf16 v128, s34, v54
    v_dot2c_f32_bf16 v129, v54, v54
    v_dot2c_f32_bf16 v128, s34, v55
    v_dot2c_f32_bf16 v129, v55, v55
    s_nop 2
    v_mov_b64 v[176:177], v[128:129]
    s_nop 1
    v_permlane32_swap_b32 v128, v176
    v_permlane32_swap_b32 v129, v177
    v_pk_add_f32 v[128:129], v[128:129], v[176:177]
    ds_write_b64 v5, v[128:129] offset:0
    ds_write_b128 v4, v[112:115] offset:4096
    ds_write_b128 v4, v[116:119] offset:5120
    ds_write_b128 v4, v[120:123] offset:6144
    ds_write_b128 v4, v[124:127] offset:7168
    s_waitcnt vmcnt(0)
    s_waitcnt lgkmcnt(0)
    s_barrier
    buffer_store_dwordx4 v[172:175], v7, s[4:7], s59 offen sc1
    ds_read_b128 v[130:133], v6 offset:0
    ds_read_b128 v[134:137], v6 offset:16
    ds_read_b128 v[184:187], v3 offset:0
    ds_read_b128 v[188:191], v3 offset:1024
    ds_read_b128 v[192:195], v3 offset:8192
    ds_read_b128 v[196:199], v3 offset:9216
    ds_read_b128 v[200:203], v3 offset:16384
    ds_read_b128 v[204:207], v3 offset:17408
    ds_read_b128 v[208:211], v3 offset:24576
    ds_read_b128 v[212:215], v3 offset:25600
    s_waitcnt lgkmcnt(9)
    v_add_f32 v130, v130, v132
    v_add_f32 v131, v131, v133
    s_waitcnt lgkmcnt(8)
    v_add_f32 v130, v130, v134
    v_add_f32 v131, v131, v135
    v_add_f32 v130, v130, v136
    v_add_f32 v131, v131, v137
    v_mul_f32 v130, 0x3acccccd, v130
    v_mul_f32 v131, 0x3acccccd, v131
    v_fma_f32 v131, -v130, v130, v131
    v_max_f32 v131, 0, v131
    v_add_f32 v131, 0x3727c5ac, v131
    v_rsq_f32 v131, v131
    s_nop 0
    ds_write2_b32 v9, v130, v131 offset0:0 offset1:32
    ds_read_b128 v[138:141], v10 offset:0
    ds_read_b128 v[142:145], v10 offset:16
    ds_read_b128 v[146:149], v10 offset:128
    ds_read_b128 v[150:153], v10 offset:144
    s_waitcnt lgkmcnt(10)
    v_add_f32 v184, v184, v192
    v_add_f32 v185, v185, v193
    v_add_f32 v186, v186, v194
    v_add_f32 v187, v187, v195
    s_waitcnt lgkmcnt(9)
    v_add_f32 v188, v188, v196
    v_add_f32 v189, v189, v197
    v_add_f32 v190, v190, v198
    v_add_f32 v191, v191, v199
    s_waitcnt lgkmcnt(8)
    v_add_f32 v184, v184, v200
    v_add_f32 v185, v185, v201
    v_add_f32 v186, v186, v202
    v_add_f32 v187, v187, v203
    s_waitcnt lgkmcnt(7)
    v_add_f32 v188, v188, v204
    v_add_f32 v189, v189, v205
    v_add_f32 v190, v190, v206
    v_add_f32 v191, v191, v207
    s_waitcnt lgkmcnt(6)
    v_add_f32 v184, v184, v208
    v_add_f32 v185, v185, v209
    v_add_f32 v186, v186, v210
    v_add_f32 v187, v187, v211
    s_waitcnt lgkmcnt(5)
    v_add_f32 v188, v188, v212
    v_add_f32 v189, v189, v213
    v_add_f32 v190, v190, v214
    v_add_f32 v191, v191, v215
    s_waitcnt lgkmcnt(3)
    v_fma_f32 v184, -v138, v154, v184
    s_waitcnt lgkmcnt(1)
    v_mul_f32 v184, v184, v146
    v_fma_f32 v185, -v139, v155, v185
    v_mul_f32 v185, v185, v147
    v_fma_f32 v186, -v140, v156, v186
    v_mul_f32 v186, v186, v148
    v_fma_f32 v187, -v141, v157, v187
    v_mul_f32 v187, v187, v149
    v_fma_f32 v188, -v142, v158, v188
    s_waitcnt lgkmcnt(0)
    v_mul_f32 v188, v188, v150
    v_fma_f32 v189, -v143, v159, v189
    v_mul_f32 v189, v189, v151
    v_fma_f32 v190, -v144, v160, v190
    v_mul_f32 v190, v190, v152
    v_fma_f32 v191, -v145, v161, v191
    v_mul_f32 v191, v191, v153
    v_cvt_pk_bf16_f32 v172, v184, v185
    v_cvt_pk_bf16_f32 v173, v186, v187
    v_cvt_pk_bf16_f32 v174, v188, v189
    v_cvt_pk_bf16_f32 v175, v190, v191
    s_mov_b32 s59, s55
    buffer_store_dwordx4 v[172:175], v7, s[4:7], s59 offen sc1
G_119:
    s_waitcnt vmcnt(0)
    s_barrier
    s_cmp_lg_u32 s29, 0
    s_cbranch_scc1 F_122
    s_lshl_b32 s32, s28, 5
    s_add_u32 s32, s32, s29
    s_lshl_b32 s32, s32, 2
    s_add_u32 s32, s32, 1073152
    v_mov_b32 v172, 1
    s_mov_b64 exec, 1
    buffer_store_dword v172, off, s[4:7], s32 sc1
    s_mov_b64 exec, -1
F_122:
R_117:
    s_cmp_lt_u32 s28, 160
    s_cbranch_scc1 R_123
    v_mov_b64 v[4:5], -1
    v_mov_b64 v[6:7], -1
    s_sub_u32 s34, s28, 160
    s_lshl_b32 s34, s34, 2
    s_add_u32 s34, s34, s29
    s_lshl_b32 s34, s34, 14
    s_add_u32 s35, s34, 2097152
    buffer_store_dwordx4 v[4:7], v0, s[4:7], s35 offen sc1
    s_add_u32 s35, s34, 2098176
    buffer_store_dwordx4 v[4:7], v0, s[4:7], s35 offen sc1
    s_add_u32 s35, s34, 2099200
    buffer_store_dwordx4 v[4:7], v0, s[4:7], s35 offen sc1
    s_add_u32 s35, s34, 2100224
    buffer_store_dwordx4 v[4:7], v0, s[4:7], s35 offen sc1
    s_add_u32 s35, s34, 2101248
    buffer_store_dwordx4 v[4:7], v0, s[4:7], s35 offen sc1
    s_add_u32 s35, s34, 2105344
    buffer_store_dwordx4 v[4:7], v0, s[4:7], s35 offen sc1
    s_add_u32 s35, s34, 2106368
    buffer_store_dwordx4 v[4:7], v0, s[4:7], s35 offen sc1
    s_add_u32 s35, s34, 2107392
    buffer_store_dwordx4 v[4:7], v0, s[4:7], s35 offen sc1
    s_add_u32 s35, s34, 2108416
    buffer_store_dwordx4 v[4:7], v0, s[4:7], s35 offen sc1
    s_add_u32 s35, s34, 2109440
    buffer_store_dwordx4 v[4:7], v0, s[4:7], s35 offen sc1
    s_add_u32 s35, s34, 6291456
    buffer_store_dwordx4 v[4:7], v0, s[4:7], s35 offen sc1
    s_add_u32 s35, s34, 6292480
    buffer_store_dwordx4 v[4:7], v0, s[4:7], s35 offen sc1
    s_add_u32 s35, s34, 6293504
    buffer_store_dwordx4 v[4:7], v0, s[4:7], s35 offen sc1
    s_add_u32 s35, s34, 6294528
    buffer_store_dwordx4 v[4:7], v0, s[4:7], s35 offen sc1
    s_add_u32 s35, s34, 6295552
    buffer_store_dwordx4 v[4:7], v0, s[4:7], s35 offen sc1
    s_add_u32 s35, s34, 6299648
    buffer_store_dwordx4 v[4:7], v0, s[4:7], s35 offen sc1
    s_add_u32 s35, s34, 6300672
    buffer_store_dwordx4 v[4:7], v0, s[4:7], s35 offen sc1
    s_add_u32 s35, s34, 6301696
    buffer_store_dwordx4 v[4:7], v0, s[4:7], s35 offen sc1
    s_add_u32 s35, s34, 6302720
    buffer_store_dwordx4 v[4:7], v0, s[4:7], s35 offen sc1
    s_add_u32 s35, s34, 6303744
    buffer_store_dwordx4 v[4:7], v0, s[4:7], s35 offen sc1
    s_waitcnt vmcnt(0)
    s_barrier
    s_cmp_lg_u32 s29, 0
    s_cbranch_scc1 F_124
    s_lshl_b32 s32, s28, 5
    s_add_u32 s32, s32, s29
    s_lshl_b32 s32, s32, 2
    s_add_u32 s32, s32, 1220608
    v_mov_b32 v8, 1
    s_mov_b64 exec, 1
    buffer_store_dword v8, off, s[4:7], s32 sc1
    s_mov_b64 exec, -1
F_124:
    s_lshl_b32 s34, s64, 3
    s_add_u32 s34, s34, 48
    s_cmp_eq_u32 s64, 2
    s_cselect_b32 s34, 40, s34
    s_load_dwordx2 s[20:21], s[0:1], s34
    s_mov_b32 s22, 5242880
    s_mov_b32 s23, 0x20000
    s_waitcnt lgkmcnt(0)
    v_bfe_u32 v14, v1, 2, 4
    v_mul_u32_u24 v14, 8192, v14
    v_bfe_u32 v15, v1, 0, 2
    v_lshl_add_u32 v14, v15, 4, v14
    s_lshl_b32 s38, s29, 6
    s_lshl_b32 s35, s63, 8
    s_add_u32 s38, s38, s35
    s_add_u32 m0, s60, 0
    s_add_u32 s39, s38, 2621440
    buffer_load_dwordx4 v14, s[20:23], s39 offen lds
    s_add_u32 m0, s60, 1024
    s_add_u32 s39, s38, 2752512
    buffer_load_dwordx4 v14, s[20:23], s39 offen lds
    s_add_u32 m0, s60, 2048
    s_add_u32 s39, s38, 2883584
    buffer_load_dwordx4 v14, s[20:23], s39 offen lds
    s_add_u32 m0, s60, 3072
    s_add_u32 s39, s38, 3014656
    buffer_load_dwordx4 v14, s[20:23], s39 offen lds
    s_add_u32 m0, s60, 4096
    s_add_u32 s39, s38, 3145728
    buffer_load_dwordx4 v14, s[20:23], s39 offen lds
    s_add_u32 m0, s60, 5120
    s_add_u32 s39, s38, 3276800
    buffer_load_dwordx4 v14, s[20:23], s39 offen lds
    s_add_u32 m0, s60, 6144
    s_add_u32 s39, s38, 3407872
    buffer_load_dwordx4 v14, s[20:23], s39 offen lds
    s_add_u32 m0, s60, 7168
    s_add_u32 s39, s38, 3538944
    buffer_load_dwordx4 v14, s[20:23], s39 offen lds
    s_add_u32 m0, s60, 8192
    s_add_u32 s39, s38, 3670016
    buffer_load_dwordx4 v14, s[20:23], s39 offen lds
    s_add_u32 m0, s60, 9216
    s_add_u32 s39, s38, 3801088
    buffer_load_dwordx4 v14, s[20:23], s39 offen lds
    s_add_u32 m0, s60, 10240
    s_add_u32 s39, s38, 3932160
    buffer_load_dwordx4 v14, s[20:23], s39 offen lds
    s_add_u32 m0, s60, 11264
    s_add_u32 s39, s38, 4063232
    buffer_load_dwordx4 v14, s[20:23], s39 offen lds
    s_add_u32 m0, s60, 12288
    s_add_u32 s39, s38, 4194304
    buffer_load_dwordx4 v14, s[20:23], s39 offen lds
    s_add_u32 m0, s60, 13312
    s_add_u32 s39, s38, 4325376
    buffer_load_dwordx4 v14, s[20:23], s39 offen lds
    s_add_u32 m0, s60, 14336
    s_add_u32 s39, s38, 4456448
    buffer_load_dwordx4 v14, s[20:23], s39 offen lds
    s_add_u32 m0, s60, 15360
    s_add_u32 s39, s38, 4587520
    buffer_load_dwordx4 v14, s[20:23], s39 offen lds
    s_add_u32 m0, s60, 16384
    s_add_u32 s39, s38, 4718592
    buffer_load_dwordx4 v14, s[20:23], s39 offen lds
    s_add_u32 m0, s60, 17408
    s_add_u32 s39, s38, 4849664
    buffer_load_dwordx4 v14, s[20:23], s39 offen lds
    s_add_u32 m0, s60, 18432
    s_add_u32 s39, s38, 4980736
    buffer_load_dwordx4 v14, s[20:23], s39 offen lds
    s_add_u32 m0, s60, 19456
    s_add_u32 s39, s38, 5111808
    buffer_load_dwordx4 v14, s[20:23], s39 offen lds
R_123:
    s_waitcnt lgkmcnt(0)
LAYER_125:
    s_cmp_ge_u32 s28, 160
    s_cbranch_scc1 R_130
    s_and_b32 s40, s29, 1
    s_lshr_b32 s41, s29, 1
    s_mul_i32 s32, s29, 40
    v_min_u32 v6, 39, v1
    v_add_u32 v6, s32, v6
    v_min_u32 v6, 159, v6
    v_lshlrev_b32 v6, 7, v6
    s_mov_b32 s32, 1048576
    s_mov_b32 s48, 0
P_131:
    buffer_load_dword v2, v6, s[4:7], s32 offen sc1
    s_waitcnt vmcnt(0)
    v_cmp_gt_u32 vcc, 1, v2
    s_cbranch_vccz P_132
    s_add_u32 s48, s48, 1
    s_cmp_gt_u32 s48, 200000
    s_cbranch_scc1 L_end
    s_sleep 1
    s_branch P_131
P_132:
    s_barrier
    s_lshl_b32 s34, s28, 1
    s_add_u32 s42, s34, s41
    s_lshl_b32 s34, s42, 4
    s_mul_i32 s35, s40, 1310720
    s_add_u32 s34, s34, s35
    s_add_u32 s34, s34, 8388608
    v_bfe_u32 v2, v1, 0, 5
    v_mul_u32_u24 v2, 40960, v2
    v_bfe_u32 v3, v1, 5, 1
    v_mul_u32_u24 v3, 20480, v3
    v_add_u32 v2, v2, v3
    s_add_u32 s35, s34, 0
    buffer_load_dwordx4 v[216:219], v2, s[4:7], s35 offen sc1
    s_add_u32 s35, s34, 5120
    buffer_load_dwordx4 v[220:223], v2, s[4:7], s35 offen sc1
    s_add_u32 s35, s34, 10240
    buffer_load_dwordx4 v[224:227], v2, s[4:7], s35 offen sc1
    s_add_u32 s35, s34, 15360
    buffer_load_dwordx4 v[228:231], v2, s[4:7], s35 offen sc1
    s_lshl_b32 s34, s40, 5
    v_bfe_u32 v3, v1, 0, 5
    v_add_u32 v3, s34, v3
    v_bfe_u32 v4, v1, 5, 1
    v_mul_u32_u24 v4, 4, v4
    v_bfe_u32 v5, v1, 0, 5
    v_add_u32 v7, 0, v4
    v_mul_u32_u24 v7, v7, v3
    v_cvt_f32_u32 v7, v7
    v_cvt_f32_u32 v8, v3
    v_mul_f32 v7, 0x3c800000, v7
    v_mul_f32 v8, 0x3c800000, v8
    v_fmamk_f32 v10, v8, 0x0, v7
    v_sin_f32 v12, v10
    v_cos_f32 v10, v10
    v_fmamk_f32 v11, v8, 0x3f800000, v7
    v_sin_f32 v13, v11
    v_cos_f32 v11, v11
    v_cvt_pk_bf16_f32 v32, v12, v13
    v_cvt_pk_bf16_f32 v16, v10, v11
    v_xor_b32 v48, 0x80008000, v32
    v_fmamk_f32 v10, v8, 0x40000000, v7
    v_sin_f32 v12, v10
    v_cos_f32 v10, v10
    v_fmamk_f32 v11, v8, 0x40400000, v7
    v_sin_f32 v13, v11
    v_cos_f32 v11, v11
    v_cvt_pk_bf16_f32 v33, v12, v13
    v_cvt_pk_bf16_f32 v17, v10, v11
    v_xor_b32 v49, 0x80008000, v33
    v_fmamk_f32 v10, v8, 0x41000000, v7
    v_sin_f32 v12, v10
    v_cos_f32 v10, v10
    v_fmamk_f32 v11, v8, 0x41100000, v7
    v_sin_f32 v13, v11
    v_cos_f32 v11, v11
    v_cvt_pk_bf16_f32 v34, v12, v13
    v_cvt_pk_bf16_f32 v18, v10, v11
    v_xor_b32 v50, 0x80008000, v34
    v_fmamk_f32 v10, v8, 0x41200000, v7
    v_sin_f32 v12, v10
    v_cos_f32 v10, v10
    v_fmamk_f32 v11, v8, 0x41300000, v7
    v_sin_f32 v13, v11
    v_cos_f32 v11, v11
    v_cvt_pk_bf16_f32 v35, v12, v13
    v_cvt_pk_bf16_f32 v19, v10, v11
    v_xor_b32 v51, 0x80008000, v35
    v_fmamk_f32 v10, v8, 0x41800000, v7
    v_sin_f32 v12, v10
    v_cos_f32 v10, v10
    v_fmamk_f32 v11, v8, 0x41880000, v7
    v_sin_f32 v13, v11
    v_cos_f32 v11, v11
    v_cvt_pk_bf16_f32 v36, v12, v13
    v_cvt_pk_bf16_f32 v20, v10, v11
    v_xor_b32 v52, 0x80008000, v36
    v_fmamk_f32 v10, v8, 0x41900000, v7
    v_sin_f32 v12, v10
    v_cos_f32 v10, v10
    v_fmamk_f32 v11, v8, 0x41980000, v7
    v_sin_f32 v13, v11
    v_cos_f32 v11, v11
    v_cvt_pk_bf16_f32 v37, v12, v13
    v_cvt_pk_bf16_f32 v21, v10, v11
    v_xor_b32 v53, 0x80008000, v37
    v_fmamk_f32 v10, v8, 0x41c00000, v7
    v_sin_f32 v12, v10
    v_cos_f32 v10, v10
    v_fmamk_f32 v11, v8, 0x41c80000, v7
    v_sin_f32 v13, v11
    v_cos_f32 v11, v11
    v_cvt_pk_bf16_f32 v38, v12, v13
    v_cvt_pk_bf16_f32 v22, v10, v11
    v_xor_b32 v54, 0x80008000, v38
    v_fmamk_f32 v10, v8, 0x41d00000, v7
    v_sin_f32 v12, v10
    v_cos_f32 v10, v10
    v_fmamk_f32 v11, v8, 0x41d80000, v7
    v_sin_f32 v13, v11
    v_cos_f32 v11, v11
    v_cvt_pk_bf16_f32 v39, v12, v13
    v_cvt_pk_bf16_f32 v23, v10, v11
    v_xor_b32 v55, 0x80008000, v39
    v_fmamk_f32 v10, v8, 0x42000000, v7
    v_sin_f32 v12, v10
    v_cos_f32 v10, v10
    v_fmamk_f32 v11, v8, 0x42040000, v7
    v_sin_f32 v13, v11
    v_cos_f32 v11, v11
    v_cvt_pk_bf16_f32 v40, v12, v13
    v_cvt_pk_bf16_f32 v24, v10, v11
    v_xor_b32 v56, 0x80008000, v40
    v_fmamk_f32 v10, v8, 0x42080000, v7
    v_sin_f32 v12, v10
    v_cos_f32 v10, v10
    v_fmamk_f32 v11, v8, 0x420c0000, v7
    v_sin_f32 v13, v11
    v_cos_f32 v11, v11
    v_cvt_pk_bf16_f32 v41, v12, v13
    v_cvt_pk_bf16_f32 v25, v10, v11
    v_xor_b32 v57, 0x80008000, v41
    v_fmamk_f32 v10, v8, 0x42200000, v7
    v_sin_f32 v12, v10
    v_cos_f32 v10, v10
    v_fmamk_f32 v11, v8, 0x42240000, v7
    v_sin_f32 v13, v11
    v_cos_f32 v11, v11
    v_cvt_pk_bf16_f32 v42, v12, v13
    v_cvt_pk_bf16_f32 v26, v10, v11
    v_xor_b32 v58, 0x80008000, v42
    v_fmamk_f32 v10, v8, 0x42280000, v7
    v_sin_f32 v12, v10
    v_cos_f32 v10, v10
    v_fmamk_f32 v11, v8, 0x422c0000, v7
    v_sin_f32 v13, v11
    v_cos_f32 v11, v11
    v_cvt_pk_bf16_f32 v43, v12, v13
    v_cvt_pk_bf16_f32 v27, v10, v11
    v_xor_b32 v59, 0x80008000, v43
    v_fmamk_f32 v10, v8, 0x42400000, v7
    v_sin_f32 v12, v10
    v_cos_f32 v10, v10
    v_fmamk_f32 v11, v8, 0x42440000, v7
    v_sin_f32 v13, v11
    v_cos_f32 v11, v11
    v_cvt_pk_bf16_f32 v44, v12, v13
    v_cvt_pk_bf16_f32 v28, v10, v11
    v_xor_b32 v60, 0x80008000, v44
    v_fmamk_f32 v10, v8, 0x42480000, v7
    v_sin_f32 v12, v10
    v_cos_f32 v10, v10
    v_fmamk_f32 v11, v8, 0x424c0000, v7
    v_sin_f32 v13, v11
    v_cos_f32 v11, v11
    v_cvt_pk_bf16_f32 v45, v12, v13
    v_cvt_pk_bf16_f32 v29, v10, v11
    v_xor_b32 v61, 0x80008000, v45
    v_fmamk_f32 v10, v8, 0x42600000, v7
    v_sin_f32 v12, v10
    v_cos_f32 v10, v10
    v_fmamk_f32 v11, v8, 0x42640000, v7
    v_sin_f32 v13, v11
    v_cos_f32 v11, v11
    v_cvt_pk_bf16_f32 v46, v12, v13
    v_cvt_pk_bf16_f32 v30, v10, v11
    v_xor_b32 v62, 0x80008000, v46
    v_fmamk_f32 v10, v8, 0x42680000, v7
    v_sin_f32 v12, v10
    v_cos_f32 v10, v10
    v_fmamk_f32 v11, v8, 0x426c0000, v7
    v_sin_f32 v13, v11
    v_cos_f32 v11, v11
    v_cvt_pk_bf16_f32 v47, v12, v13
    v_cvt_pk_bf16_f32 v31, v10, v11
    v_xor_b32 v63, 0x80008000, v47
    v_add_u32 v7, 0, v4
    v_mul_u32_u24 v7, v7, v5
    v_cvt_f32_u32 v7, v7
    v_cvt_f32_u32 v8, v5
    v_mul_f32 v7, 0x3d000000, v7
    v_mul_f32 v8, 0x3d000000, v8
    v_fmamk_f32 v10, v8, 0x0, v7
    v_sin_f32 v12, v10
    v_cos_f32 v10, v10
    v_fmamk_f32 v11, v8, 0x3f800000, v7
    v_sin_f32 v13, v11
    v_cos_f32 v11, v11
    v_cvt_pk_bf16_f32 v72, v12, v13
    v_cvt_pk_bf16_f32 v64, v10, v11
    v_xor_b32 v80, 0x80008000, v72
    v_fmamk_f32 v10, v8, 0x40000000, v7
    v_sin_f32 v12, v10
    v_cos_f32 v10, v10
    v_fmamk_f32 v11, v8, 0x40400000, v7
    v_sin_f32 v13, v11
    v_cos_f32 v11, v11
    v_cvt_pk_bf16_f32 v73, v12, v13
    v_cvt_pk_bf16_f32 v65, v10, v11
    v_xor_b32 v81, 0x80008000, v73
    v_fmamk_f32 v10, v8, 0x41000000, v7
    v_sin_f32 v12, v10
    v_cos_f32 v10, v10
    v_fmamk_f32 v11, v8, 0x41100000, v7
    v_sin_f32 v13, v11
    v_cos_f32 v11, v11
    v_cvt_pk_bf16_f32 v74, v12, v13
    v_cvt_pk_bf16_f32 v66, v10, v11
    v_xor_b32 v82, 0x80008000, v74
    v_fmamk_f32 v10, v8, 0x41200000, v7
    v_sin_f32 v12, v10
    v_cos_f32 v10, v10
    v_fmamk_f32 v11, v8, 0x41300000, v7
    v_sin_f32 v13, v11
    v_cos_f32 v11, v11
    v_cvt_pk_bf16_f32 v75, v12, v13
    v_cvt_pk_bf16_f32 v67, v10, v11
    v_xor_b32 v83, 0x80008000, v75
    v_fmamk_f32 v10, v8, 0x41800000, v7
    v_sin_f32 v12, v10
    v_cos_f32 v10, v10
    v_fmamk_f32 v11, v8, 0x41880000, v7
    v_sin_f32 v13, v11
    v_cos_f32 v11, v11
    v_cvt_pk_bf16_f32 v76, v12, v13
    v_cvt_pk_bf16_f32 v68, v10, v11
    v_xor_b32 v84, 0x80008000, v76
    v_fmamk_f32 v10, v8, 0x41900000, v7
    v_sin_f32 v12, v10
    v_cos_f32 v10, v10
    v_fmamk_f32 v11, v8, 0x41980000, v7
    v_sin_f32 v13, v11
    v_cos_f32 v11, v11
    v_cvt_pk_bf16_f32 v77, v12, v13
    v_cvt_pk_bf16_f32 v69, v10, v11
    v_xor_b32 v85, 0x80008000, v77
    v_fmamk_f32 v10, v8, 0x41c00000, v7
    v_sin_f32 v12, v10
    v_cos_f32 v10, v10
    v_fmamk_f32 v11, v8, 0x41c80000, v7
    v_sin_f32 v13, v11
    v_cos_f32 v11, v11
    v_cvt_pk_bf16_f32 v78, v12, v13
    v_cvt_pk_bf16_f32 v70, v10, v11
    v_xor_b32 v86, 0x80008000, v78
    v_fmamk_f32 v10, v8, 0x41d00000, v7
    v_sin_f32 v12, v10
    v_cos_f32 v10, v10
    v_fmamk_f32 v11, v8, 0x41d80000, v7
    v_sin_f32 v13, v11
    v_cos_f32 v11, v11
    v_cvt_pk_bf16_f32 v79, v12, v13
    v_cvt_pk_bf16_f32 v71, v10, v11
    v_xor_b32 v87, 0x80008000, v79
    v_add_u32 v7, 0, v4
    v_mul_u32_u24 v7, v7, v3
    v_cvt_f32_u32 v7, v7
    v_cvt_f32_u32 v8, v3
    v_mul_f32 v7, 0x3a000000, v7
    v_mul_f32 v8, 0x3a000000, v8
    v_fmamk_f32 v88, v8, 0x0, v7
    v_sin_f32 v104, v88
    v_cos_f32 v88, v88
    v_fmamk_f32 v89, v8, 0x3f800000, v7
    v_sin_f32 v105, v89
    v_cos_f32 v89, v89
    v_fmamk_f32 v90, v8, 0x40000000, v7
    v_sin_f32 v106, v90
    v_cos_f32 v90, v90
    v_fmamk_f32 v91, v8, 0x40400000, v7
    v_sin_f32 v107, v91
    v_cos_f32 v91, v91
    v_fmamk_f32 v92, v8, 0x41000000, v7
    v_sin_f32 v108, v92
    v_cos_f32 v92, v92
    v_fmamk_f32 v93, v8, 0x41100000, v7
    v_sin_f32 v109, v93
    v_cos_f32 v93, v93
    v_fmamk_f32 v94, v8, 0x41200000, v7
    v_sin_f32 v110, v94
    v_cos_f32 v94, v94
    v_fmamk_f32 v95, v8, 0x41300000, v7
    v_sin_f32 v111, v95
    v_cos_f32 v95, v95
    v_fmamk_f32 v96, v8, 0x41800000, v7
    v_sin_f32 v112, v96
    v_cos_f32 v96, v96
    v_fmamk_f32 v97, v8, 0x41880000, v7
    v_sin_f32 v113, v97
    v_cos_f32 v97, v97
    v_fmamk_f32 v98, v8, 0x41900000, v7
    v_sin_f32 v114, v98
    v_cos_f32 v98, v98
    v_fmamk_f32 v99, v8, 0x41980000, v7
    v_sin_f32 v115, v99
    v_cos_f32 v99, v99
    v_fmamk_f32 v100, v8, 0x41c00000, v7
    v_sin_f32 v116, v100
    v_cos_f32 v100, v100
    v_fmamk_f32 v101, v8, 0x41c80000, v7
    v_sin_f32 v117, v101
    v_cos_f32 v101, v101
    v_fmamk_f32 v102, v8, 0x41d00000, v7
    v_sin_f32 v118, v102
    v_cos_f32 v102, v102
    v_fmamk_f32 v103, v8, 0x41d80000, v7
    v_sin_f32 v119, v103
    v_cos_f32 v103, v103
    v_add_u32 v7, s34, v4
    v_mul_u32_u24 v7, v7, v5
    v_cvt_f32_u32 v7, v7
    v_cvt_f32_u32 v8, v5
    v_mul_f32 v7, 0x3a000000, v7
    v_mul_f32 v8, 0x3a000000, v8
    v_fmamk_f32 v120, v8, 0x0, v7
    v_sin_f32 v136, v120
    v_cos_f32 v120, v120
    v_fmamk_f32 v121, v8, 0x3f800000, v7
    v_sin_f32 v137, v121
    v_cos_f32 v121, v121
    v_fmamk_f32 v122, v8, 0x40000000, v7
    v_sin_f32 v138, v122
    v_cos_f32 v122, v122
    v_fmamk_f32 v123, v8, 0x40400000, v7
    v_sin_f32 v139, v123
    v_cos_f32 v123, v123
    v_fmamk_f32 v124, v8, 0x41000000, v7
    v_sin_f32 v140, v124
    v_cos_f32 v124, v124
    v_fmamk_f32 v125, v8, 0x41100000, v7
    v_sin_f32 v141, v125
    v_cos_f32 v125, v125
    v_fmamk_f32 v126, v8, 0x41200000, v7
    v_sin_f32 v142, v126
    v_cos_f32 v126, v126
    v_fmamk_f32 v127, v8, 0x41300000, v7
    v_sin_f32 v143, v127
    v_cos_f32 v127, v127
    v_fmamk_f32 v128, v8, 0x41800000, v7
    v_sin_f32 v144, v128
    v_cos_f32 v128, v128
    v_fmamk_f32 v129, v8, 0x41880000, v7
    v_sin_f32 v145, v129
    v_cos_f32 v129, v129
    v_fmamk_f32 v130, v8, 0x41900000, v7
    v_sin_f32 v146, v130
    v_cos_f32 v130, v130
    v_fmamk_f32 v131, v8, 0x41980000, v7
    v_sin_f32 v147, v131
    v_cos_f32 v131, v131
    v_fmamk_f32 v132, v8, 0x41c00000, v7
    v_sin_f32 v148, v132
    v_cos_f32 v132, v132
    v_fmamk_f32 v133, v8, 0x41c80000, v7
    v_sin_f32 v149, v133
    v_cos_f32 v133, v133
    v_fmamk_f32 v134, v8, 0x41d00000, v7
    v_sin_f32 v150, v134
    v_cos_f32 v134, v134
    v_fmamk_f32 v135, v8, 0x41d80000, v7
    v_sin_f32 v151, v135
    v_cos_f32 v135, v135
    s_mov_b32 s36, 0x35cccccd
    s_cmp_eq_u32 s42, 319
    s_cselect_b32 s35, 0x354ccccd, s36
    s_waitcnt vmcnt(3)
    v_lshlrev_b32 v152, 16, v216
    v_and_b32 v168, 0xffff0000, v216
    v_mul_f32 v152, s35, v152
    v_mul_f32 v168, s35, v168
    v_lshlrev_b32 v153, 16, v217
    v_and_b32 v169, 0xffff0000, v217
    v_mul_f32 v153, s35, v153
    v_mul_f32 v169, s35, v169
    v_lshlrev_b32 v154, 16, v218
    v_and_b32 v170, 0xffff0000, v218
    v_mul_f32 v154, s35, v154
    v_mul_f32 v170, s35, v170
    v_lshlrev_b32 v155, 16, v219
    v_and_b32 v171, 0xffff0000, v219
    v_mul_f32 v155, s35, v155
    v_mul_f32 v171, s35, v171
    s_waitcnt vmcnt(2)
    v_lshlrev_b32 v156, 16, v220
    v_and_b32 v172, 0xffff0000, v220
    v_mul_f32 v156, s35, v156
    v_mul_f32 v172, s35, v172
    v_lshlrev_b32 v157, 16, v221
    v_and_b32 v173, 0xffff0000, v221
    v_mul_f32 v157, s35, v157
    v_mul_f32 v173, s35, v173
    v_lshlrev_b32 v158, 16, v222
    v_and_b32 v174, 0xffff0000, v222
    v_mul_f32 v158, s35, v158
    v_mul_f32 v174, s35, v174
    v_lshlrev_b32 v159, 16, v223
    v_and_b32 v175, 0xffff0000, v223
    v_mul_f32 v159, s35, v159
    v_mul_f32 v175, s35, v175
    s_waitcnt vmcnt(1)
    v_lshlrev_b32 v160, 16, v224
    v_and_b32 v176, 0xffff0000, v224
    v_mul_f32 v160, s35, v160
    v_mul_f32 v176, s35, v176
    v_lshlrev_b32 v161, 16, v225
    v_and_b32 v177, 0xffff0000, v225
    v_mul_f32 v161, s35, v161
    v_mul_f32 v177, s35, v177
    v_lshlrev_b32 v162, 16, v226
    v_and_b32 v178, 0xffff0000, v226
    v_mul_f32 v162, s35, v162
    v_mul_f32 v178, s35, v178
    v_lshlrev_b32 v163, 16, v227
    v_and_b32 v179, 0xffff0000, v227
    v_mul_f32 v163, s35, v163
    v_mul_f32 v179, s35, v179
    s_waitcnt vmcnt(0)
    v_lshlrev_b32 v164, 16, v228
    v_and_b32 v180, 0xffff0000, v228
    v_mul_f32 v164, s35, v164
    v_mul_f32 v180, s35, v180
    v_lshlrev_b32 v165, 16, v229
    v_and_b32 v181, 0xffff0000, v229
    v_mul_f32 v165, s35, v165
    v_mul_f32 v181, s35, v181
    v_lshlrev_b32 v166, 16, v230
    v_and_b32 v182, 0xffff0000, v230
    v_mul_f32 v166, s35, v166
    v_mul_f32 v182, s35, v182
    v_lshlrev_b32 v167, 16, v231
    v_and_b32 v183, 0xffff0000, v231
    v_mul_f32 v167, s35, v167
    v_mul_f32 v183, s35, v183
    v_bfe_u32 v2, v1, 4, 2
    v_mul_u32_u24 v2, 64, v2
    v_xor_b32 v2, v2, v0
    v_and_b32 v2, 255, v2
    v_bfe_u32 v8, v1, 4, 2
    v_mul_u32_u24 v8, 40960, v8
    v_add_u32 v2, v2, v8
    s_lshl_b32 s34, s41, 7
    v_bfe_u32 v3, v1, 4, 1
    v_mul_u32_u24 v3, 32, v3
    v_bfe_u32 v7, v1, 0, 2
    v_lshl_add_u32 v3, v7, 3, v3
    v_add_u32 v3, s34, v3
    v_bfe_u32 v8, v1, 2, 2
    v_mul_u32_u24 v8, 64, v8
    v_xor_b32 v3, v3, v8
    v_bfe_u32 v8, v1, 5, 1
    v_mul_u32_u24 v8, 1024, v8
    v_bfe_u32 v7, v1, 2, 2
    v_lshl_add_u32 v8, v7, 8, v8
    v_add_u32 v3, v3, v8
    v_xor_b32 v6, 64, v3
    s_lshl_b32 s34, s64, 3
    s_add_u32 s34, s34, 48
    s_cmp_eq_u32 s64, 2
    s_cselect_b32 s34, 40, s34
    s_load_dwordx2 s[20:21], s[0:1], s34
    s_mov_b32 s22, 5242880
    s_mov_b32 s23, 0x20000
    s_waitcnt lgkmcnt(0)
    v_bfe_u32 v250, v1, 2, 4
    v_mul_u32_u24 v250, 8192, v250
    v_bfe_u32 v251, v1, 0, 2
    v_lshl_add_u32 v250, v251, 4, v250
    s_lshl_b32 s38, s29, 6
    s_lshl_b32 s35, s63, 8
    s_add_u32 s38, s38, s35
    s_cmp_eq_u32 s30, 0
    s_cselect_b32 s38, s38, 0x40000000
    s_cmp_eq_u32 s30, 0
    s_cselect_b32 s34, 18, 2
    s_cselect_b32 s35, 0, 20480
    v_min_u32 v12, s34, v1
    v_mul_u32_u24 v12, 1280, v12
    s_lshr_b32 s34, s28, 4
    s_lshl_b32 s34, s34, 7
    s_add_u32 s35, s35, s34
    s_add_u32 s35, s35, 1073152
    s_add_u32 s57, s30, 1
    s_mov_b32 s48, 0
P_133:
    buffer_load_dword v8, v12, s[4:7], s35 offen sc1
    s_waitcnt vmcnt(0)
    v_cmp_gt_u32 vcc, s57, v8
    s_cbranch_vccz P_134
    s_add_u32 s48, s48, 1
    s_cmp_gt_u32 s48, 200000
    s_cbranch_scc1 L_end
    s_sleep 1
    s_branch P_133
P_134:
    s_mul_i32 s34, s30, 3145728
    s_add_u32 s34, s34, 20971520
    s_lshl_b32 s35, s28, 8
    s_mul_i32 s36, s29, 655360
    s_add_u32 s43, s35, s36
    s_add_u32 s34, s34, s43
    s_lshl_b32 s35, s29, 12
    s_add_u32 m0, s35, 0
    s_add_u32 s36, s34, 0
    buffer_load_dwordx4 v2, s[4:7], s36 offen sc1 lds
    s_add_u32 m0, s35, 1024
    s_add_u32 s36, s34, 163840
    buffer_load_dwordx4 v2, s[4:7], s36 offen sc1 lds
    s_add_u32 m0, s35, 2048
    s_add_u32 s36, s34, 327680
    buffer_load_dwordx4 v2, s[4:7], s36 offen sc1 lds
    s_add_u32 m0, s35, 3072
    s_add_u32 s36, s34, 491520
    buffer_load_dwordx4 v2, s[4:7], s36 offen sc1 lds
    s_lshl_b32 s34, s29, 12
    s_add_u32 s34, s34, 16384
    v_add_u32 v4, s34, v0
    s_lshl_b32 s34, s41, 13
    s_add_u32 s34, s34, 16384
    v_bfe_u32 v7, v1, 0, 2
    v_mul_u32_u24 v7, 16, v7
    v_bfe_u32 v8, v1, 2, 1
    v_lshl_add_u32 v7, v8, 7, v7
    v_bfe_u32 v8, v1, 3, 1
    v_lshl_add_u32 v7, v8, 6, v7
    v_bfe_u32 v8, v1, 4, 2
    v_lshl_add_u32 v7, v8, 8, v7
    v_add_u32 v7, s34, v7
    s_lshl_b32 s34, s41, 7
    v_bfe_u32 v5, v1, 5, 1
    v_mul_u32_u24 v5, 16, v5
    v_add_u32 v5, s34, v5
    v_bfe_u32 v9, v1, 0, 3
    v_mul_u32_u24 v9, 16, v9
    v_xor_b32 v5, v5, v9
    s_lshl_b32 s34, s40, 13
    s_add_u32 s34, s34, 32768
    v_bfe_u32 v9, v1, 0, 5
    v_mul_u32_u24 v9, 256, v9
    v_add_u32 v9, s34, v9
    v_add_u32 v5, v5, v9
    s_waitcnt vmcnt(0)
    s_barrier
    ds_read_b64_tr_b16 v[216:217], v3 offset:0
    ds_read_b64_tr_b16 v[232:233], v6 offset:0
    ds_read_b64_tr_b16 v[218:219], v3 offset:2048
    ds_read_b64_tr_b16 v[234:235], v6 offset:2048
    ds_read_b64_tr_b16 v[220:221], v3 offset:4096
    ds_read_b64_tr_b16 v[236:237], v6 offset:4096
    ds_read_b64_tr_b16 v[222:223], v3 offset:6144
    ds_read_b64_tr_b16 v[238:239], v6 offset:6144
    ds_read_b64_tr_b16 v[224:225], v3 offset:8192
    ds_read_b64_tr_b16 v[240:241], v6 offset:8192
    ds_read_b64_tr_b16 v[226:227], v3 offset:10240
    ds_read_b64_tr_b16 v[242:243], v6 offset:10240
    ds_read_b64_tr_b16 v[228:229], v3 offset:12288
    ds_read_b64_tr_b16 v[244:245], v6 offset:12288
    ds_read_b64_tr_b16 v[230:231], v3 offset:14336
    ds_read_b64_tr_b16 v[246:247], v6 offset:14336
    s_waitcnt lgkmcnt(13)
    v_mfma_f32_32x32x16_bf16 v[184:199], v[216:219], v[16:19], 0
    s_waitcnt lgkmcnt(12)
    v_mfma_f32_32x32x16_bf16 v[200:215], v[232:235], v[16:19], 0
    s_add_u32 m0, s60, 0
    s_add_u32 s39, s38, 2621440
    buffer_load_dwordx4 v250, s[20:23], s39 offen lds
    v_mfma_f32_32x32x16_bf16 v[184:199], v[232:235], v[32:35], v[184:199]
    v_mfma_f32_32x32x16_bf16 v[200:215], v[216:219], v[48:51], v[200:215]
    s_add_u32 m0, s60, 1024
    s_add_u32 s39, s38, 2752512
    buffer_load_dwordx4 v250, s[20:23], s39 offen lds
    s_waitcnt lgkmcnt(9)
    v_mfma_f32_32x32x16_bf16 v[184:199], v[220:223], v[20:23], v[184:199]
    s_waitcnt lgkmcnt(8)
    v_mfma_f32_32x32x16_bf16 v[200:215], v[236:239], v[20:23], v[200:215]
    s_add_u32 m0, s60, 2048
    s_add_u32 s39, s38, 2883584
    buffer_load_dwordx4 v250, s[20:23], s39 offen lds
    v_mfma_f32_32x32x16_bf16 v[184:199], v[236:239], v[36:39], v[184:199]
    v_mfma_f32_32x32x16_bf16 v[200:215], v[220:223], v[52:55], v[200:215]
    s_add_u32 m0, s60, 3072
    s_add_u32 s39, s38, 3014656
    buffer_load_dwordx4 v250, s[20:23], s39 offen lds
    s_waitcnt lgkmcnt(5)
    v_mfma_f32_32x32x16_bf16 v[184:199], v[224:227], v[24:27], v[184:199]
    s_waitcnt lgkmcnt(4)
    v_mfma_f32_32x32x16_bf16 v[200:215], v[240:243], v[24:27], v[200:215]
    s_add_u32 m0, s60, 4096
    s_add_u32 s39, s38, 3145728
    buffer_load_dwordx4 v250, s[20:23], s39 offen lds
    v_mfma_f32_32x32x16_bf16 v[184:199], v[240:243], v[40:43], v[184:199]
    v_mfma_f32_32x32x16_bf16 v[200:215], v[224:227], v[56:59], v[200:215]
    s_add_u32 m0, s60, 5120
    s_add_u32 s39, s38, 3276800
    buffer_load_dwordx4 v250, s[20:23], s39 offen lds
    s_waitcnt lgkmcnt(1)
    v_mfma_f32_32x32x16_bf16 v[184:199], v[228:231], v[28:31], v[184:199]
    s_waitcnt lgkmcnt(0)
    v_mfma_f32_32x32x16_bf16 v[200:215], v[244:247], v[28:31], v[200:215]
    s_add_u32 m0, s60, 6144
    s_add_u32 s39, s38, 3407872
    buffer_load_dwordx4 v250, s[20:23], s39 offen lds
    v_mfma_f32_32x32x16_bf16 v[184:199], v[244:247], v[44:47], v[184:199]
    v_mfma_f32_32x32x16_bf16 v[200:215], v[228:231], v[60:63], v[200:215]
    s_add_u32 m0, s60, 7168
    s_add_u32 s39, s38, 3538944
    buffer_load_dwordx4 v250, s[20:23], s39 offen lds
    s_nop 0
    v_pk_mul_f32 v[10:11], v[184:185], v[88:89]
    s_nop 6
    v_pk_mul_f32 v[12:13], v[200:201], v[88:89]
    v_pk_fma_f32 v[10:11], v[200:201], v[104:105], v[10:11]
    v_pk_fma_f32 v[12:13], v[184:185], v[104:105], v[12:13] neg_lo:[1,0,0] neg_hi:[1,0,0]
    v_cvt_pk_bf16_f32 v216, v10, v11
    v_cvt_pk_bf16_f32 v232, v12, v13
    v_pk_mul_f32 v[10:11], v[186:187], v[90:91]
    v_pk_mul_f32 v[12:13], v[202:203], v[90:91]
    v_pk_fma_f32 v[10:11], v[202:203], v[106:107], v[10:11]
    v_pk_fma_f32 v[12:13], v[186:187], v[106:107], v[12:13] neg_lo:[1,0,0] neg_hi:[1,0,0]
    v_cvt_pk_bf16_f32 v217, v10, v11
    v_cvt_pk_bf16_f32 v233, v12, v13
    v_pk_mul_f32 v[10:11], v[188:189], v[92:93]
    v_pk_mul_f32 v[12:13], v[204:205], v[92:93]
    v_pk_fma_f32 v[10:11], v[204:205], v[108:109], v[10:11]
    v_pk_fma_f32 v[12:13], v[188:189], v[108:109], v[12:13] neg_lo:[1,0,0] neg_hi:[1,0,0]
    v_cvt_pk_bf16_f32 v218, v10, v11
    v_cvt_pk_bf16_f32 v234, v12, v13
    v_pk_mul_f32 v[10:11], v[190:191], v[94:95]
    v_pk_mul_f32 v[12:13], v[206:207], v[94:95]
    v_pk_fma_f32 v[10:11], v[206:207], v[110:111], v[10:11]
    v_pk_fma_f32 v[12:13], v[190:191], v[110:111], v[12:13] neg_lo:[1,0,0] neg_hi:[1,0,0]
    v_cvt_pk_bf16_f32 v219, v10, v11
    v_cvt_pk_bf16_f32 v235, v12, v13
    v_pk_mul_f32 v[10:11], v[192:193], v[96:97]
    v_pk_mul_f32 v[12:13], v[208:209], v[96:97]
    v_pk_fma_f32 v[10:11], v[208:209], v[112:113], v[10:11]
    v_pk_fma_f32 v[12:13], v[192:193], v[112:113], v[12:13] neg_lo:[1,0,0] neg_hi:[1,0,0]
    v_cvt_pk_bf16_f32 v220, v10, v11
    v_cvt_pk_bf16_f32 v236, v12, v13
    v_pk_mul_f32 v[10:11], v[194:195], v[98:99]
    v_pk_mul_f32 v[12:13], v[210:211], v[98:99]
    v_pk_fma_f32 v[10:11], v[210:211], v[114:115], v[10:11]
    v_pk_fma_f32 v[12:13], v[194:195], v[114:115], v[12:13] neg_lo:[1,0,0] neg_hi:[1,0,0]
    v_cvt_pk_bf16_f32 v221, v10, v11
    v_cvt_pk_bf16_f32 v237, v12, v13
    v_pk_mul_f32 v[10:11], v[196:197], v[100:101]
    v_pk_mul_f32 v[12:13], v[212:213], v[100:101]
    v_pk_fma_f32 v[10:11], v[212:213], v[116:117], v[10:11]
    v_pk_fma_f32 v[12:13], v[196:197], v[116:117], v[12:13] neg_lo:[1,0,0] neg_hi:[1,0,0]
    v_cvt_pk_bf16_f32 v222, v10, v11
    v_cvt_pk_bf16_f32 v238, v12, v13
    v_pk_mul_f32 v[10:11], v[198:199], v[102:103]
    v_pk_mul_f32 v[12:13], v[214:215], v[102:103]
    v_pk_fma_f32 v[10:11], v[214:215], v[118:119], v[10:11]
    v_pk_fma_f32 v[12:13], v[198:199], v[118:119], v[12:13] neg_lo:[1,0,0] neg_hi:[1,0,0]
    v_cvt_pk_bf16_f32 v223, v10, v11
    v_cvt_pk_bf16_f32 v239, v12, v13
    v_mfma_f32_32x32x16_bf16 v[184:199], v[64:67], v[216:219], 0
    v_mfma_f32_32x32x16_bf16 v[200:215], v[64:67], v[232:235], 0
    s_add_u32 m0, s60, 8192
    s_add_u32 s39, s38, 3670016
    buffer_load_dwordx4 v250, s[20:23], s39 offen lds
    v_mfma_f32_32x32x16_bf16 v[184:199], v[72:75], v[232:235], v[184:199]
    v_mfma_f32_32x32x16_bf16 v[200:215], v[80:83], v[216:219], v[200:215]
    s_add_u32 m0, s60, 9216
    s_add_u32 s39, s38, 3801088
    buffer_load_dwordx4 v250, s[20:23], s39 offen lds
    v_mfma_f32_32x32x16_bf16 v[184:199], v[68:71], v[220:223], v[184:199]
    v_mfma_f32_32x32x16_bf16 v[200:215], v[68:71], v[236:239], v[200:215]
    s_add_u32 m0, s60, 10240
    s_add_u32 s39, s38, 3932160
    buffer_load_dwordx4 v250, s[20:23], s39 offen lds
    v_mfma_f32_32x32x16_bf16 v[184:199], v[76:79], v[236:239], v[184:199]
    v_mfma_f32_32x32x16_bf16 v[200:215], v[84:87], v[220:223], v[200:215]
    s_add_u32 m0, s60, 11264
    s_add_u32 s39, s38, 4063232
    buffer_load_dwordx4 v250, s[20:23], s39 offen lds
    s_nop 0
    v_pk_mul_f32 v[10:11], v[184:185], v[152:153]
    s_nop 6
    v_pk_mul_f32 v[12:13], v[200:201], v[152:153]
    v_pk_fma_f32 v[10:11], v[200:201], v[168:169], v[10:11] neg_lo:[1,0,0] neg_hi:[1,0,0]
    v_pk_fma_f32 v[12:13], v[184:185], v[168:169], v[12:13]
    v_cvt_pk_bf16_f32 v216, v10, v11
    v_cvt_pk_bf16_f32 v232, v12, v13
    v_pk_mul_f32 v[10:11], v[186:187], v[154:155]
    v_pk_mul_f32 v[12:13], v[202:203], v[154:155]
    v_pk_fma_f32 v[10:11], v[202:203], v[170:171], v[10:11] neg_lo:[1,0,0] neg_hi:[1,0,0]
    v_pk_fma_f32 v[12:13], v[186:187], v[170:171], v[12:13]
    v_cvt_pk_bf16_f32 v217, v10, v11
    v_cvt_pk_bf16_f32 v233, v12, v13
    v_pk_mul_f32 v[10:11], v[188:189], v[156:157]
    v_pk_mul_f32 v[12:13], v[204:205], v[156:157]
    v_pk_fma_f32 v[10:11], v[204:205], v[172:173], v[10:11] neg_lo:[1,0,0] neg_hi:[1,0,0]
    v_pk_fma_f32 v[12:13], v[188:189], v[172:173], v[12:13]
    v_cvt_pk_bf16_f32 v218, v10, v11
    v_cvt_pk_bf16_f32 v234, v12, v13
    v_pk_mul_f32 v[10:11], v[190:191], v[158:159]
    v_pk_mul_f32 v[12:13], v[206:207], v[158:159]
    v_pk_fma_f32 v[10:11], v[206:207], v[174:175], v[10:11] neg_lo:[1,0,0] neg_hi:[1,0,0]
    v_pk_fma_f32 v[12:13], v[190:191], v[174:175], v[12:13]
    v_cvt_pk_bf16_f32 v219, v10, v11
    v_cvt_pk_bf16_f32 v235, v12, v13
    v_pk_mul_f32 v[10:11], v[192:193], v[160:161]
    v_pk_mul_f32 v[12:13], v[208:209], v[160:161]
    v_pk_fma_f32 v[10:11], v[208:209], v[176:177], v[10:11] neg_lo:[1,0,0] neg_hi:[1,0,0]
    v_pk_fma_f32 v[12:13], v[192:193], v[176:177], v[12:13]
    v_cvt_pk_bf16_f32 v220, v10, v11
    v_cvt_pk_bf16_f32 v236, v12, v13
    v_pk_mul_f32 v[10:11], v[194:195], v[162:163]
    v_pk_mul_f32 v[12:13], v[210:211], v[162:163]
    v_pk_fma_f32 v[10:11], v[210:211], v[178:179], v[10:11] neg_lo:[1,0,0] neg_hi:[1,0,0]
    v_pk_fma_f32 v[12:13], v[194:195], v[178:179], v[12:13]
    v_cvt_pk_bf16_f32 v221, v10, v11
    v_cvt_pk_bf16_f32 v237, v12, v13
    v_pk_mul_f32 v[10:11], v[196:197], v[164:165]
    v_pk_mul_f32 v[12:13], v[212:213], v[164:165]
    v_pk_fma_f32 v[10:11], v[212:213], v[180:181], v[10:11] neg_lo:[1,0,0] neg_hi:[1,0,0]
    v_pk_fma_f32 v[12:13], v[196:197], v[180:181], v[12:13]
    v_cvt_pk_bf16_f32 v222, v10, v11
    v_cvt_pk_bf16_f32 v238, v12, v13
    v_pk_mul_f32 v[10:11], v[198:199], v[166:167]
    v_pk_mul_f32 v[12:13], v[214:215], v[166:167]
    v_pk_fma_f32 v[10:11], v[214:215], v[182:183], v[10:11] neg_lo:[1,0,0] neg_hi:[1,0,0]
    v_pk_fma_f32 v[12:13], v[198:199], v[182:183], v[12:13]
    v_cvt_pk_bf16_f32 v223, v10, v11
    v_cvt_pk_bf16_f32 v239, v12, v13
    v_mfma_f32_32x32x16_bf16 v[184:199], v[216:219], v[64:67], 0
    s_add_u32 m0, s60, 12288
    s_add_u32 s39, s38, 4194304
    buffer_load_dwordx4 v250, s[20:23], s39 offen lds
    v_mfma_f32_32x32x16_bf16 v[200:215], v[232:235], v[64:67], 0
    s_add_u32 m0, s60, 13312
    s_add_u32 s39, s38, 4325376
    buffer_load_dwordx4 v250, s[20:23], s39 offen lds
    v_mfma_f32_32x32x16_bf16 v[184:199], v[232:235], v[80:83], v[184:199]
    s_add_u32 m0, s60, 14336
    s_add_u32 s39, s38, 4456448
    buffer_load_dwordx4 v250, s[20:23], s39 offen lds
    v_mfma_f32_32x32x16_bf16 v[200:215], v[216:219], v[72:75], v[200:215]
    s_add_u32 m0, s60, 15360
    s_add_u32 s39, s38, 4587520
    buffer_load_dwordx4 v250, s[20:23], s39 offen lds
    v_mfma_f32_32x32x16_bf16 v[184:199], v[220:223], v[68:71], v[184:199]
    s_add_u32 m0, s60, 16384
    s_add_u32 s39, s38, 4718592
    buffer_load_dwordx4 v250, s[20:23], s39 offen lds
    v_mfma_f32_32x32x16_bf16 v[200:215], v[236:239], v[68:71], v[200:215]
    s_add_u32 m0, s60, 17408
    s_add_u32 s39, s38, 4849664
    buffer_load_dwordx4 v250, s[20:23], s39 offen lds
    v_mfma_f32_32x32x16_bf16 v[184:199], v[236:239], v[84:87], v[184:199]
    s_add_u32 m0, s60, 18432
    s_add_u32 s39, s38, 4980736
    buffer_load_dwordx4 v250, s[20:23], s39 offen lds
    v_mfma_f32_32x32x16_bf16 v[200:215], v[220:223], v[76:79], v[200:215]
    s_add_u32 m0, s60, 19456
    s_add_u32 s39, s38, 5111808
    buffer_load_dwordx4 v250, s[20:23], s39 offen lds
    s_nop 0
    v_pk_mul_f32 v[10:11], v[184:185], v[120:121]
    s_nop 6
    v_pk_mul_f32 v[12:13], v[200:201], v[120:121]
    v_pk_fma_f32 v[10:11], v[200:201], v[136:137], v[10:11] neg_lo:[1,0,0] neg_hi:[1,0,0]
    v_pk_fma_f32 v[12:13], v[184:185], v[136:137], v[12:13]
    v_cvt_pk_bf16_f32 v216, v10, v11
    v_cvt_pk_bf16_f32 v232, v12, v13
    v_pk_mul_f32 v[10:11], v[186:187], v[122:123]
    v_pk_mul_f32 v[12:13], v[202:203], v[122:123]
    v_pk_fma_f32 v[10:11], v[202:203], v[138:139], v[10:11] neg_lo:[1,0,0] neg_hi:[1,0,0]
    v_pk_fma_f32 v[12:13], v[186:187], v[138:139], v[12:13]
    v_cvt_pk_bf16_f32 v217, v10, v11
    v_cvt_pk_bf16_f32 v233, v12, v13
    v_pk_mul_f32 v[10:11], v[188:189], v[124:125]
    v_pk_mul_f32 v[12:13], v[204:205], v[124:125]
    v_pk_fma_f32 v[10:11], v[204:205], v[140:141], v[10:11] neg_lo:[1,0,0] neg_hi:[1,0,0]
    v_pk_fma_f32 v[12:13], v[188:189], v[140:141], v[12:13]
    v_cvt_pk_bf16_f32 v218, v10, v11
    v_cvt_pk_bf16_f32 v234, v12, v13
    v_pk_mul_f32 v[10:11], v[190:191], v[126:127]
    v_pk_mul_f32 v[12:13], v[206:207], v[126:127]
    v_pk_fma_f32 v[10:11], v[206:207], v[142:143], v[10:11] neg_lo:[1,0,0] neg_hi:[1,0,0]
    v_pk_fma_f32 v[12:13], v[190:191], v[142:143], v[12:13]
    v_cvt_pk_bf16_f32 v219, v10, v11
    v_cvt_pk_bf16_f32 v235, v12, v13
    v_pk_mul_f32 v[10:11], v[192:193], v[128:129]
    v_pk_mul_f32 v[12:13], v[208:209], v[128:129]
    v_pk_fma_f32 v[10:11], v[208:209], v[144:145], v[10:11] neg_lo:[1,0,0] neg_hi:[1,0,0]
    v_pk_fma_f32 v[12:13], v[192:193], v[144:145], v[12:13]
    v_cvt_pk_bf16_f32 v220, v10, v11
    v_cvt_pk_bf16_f32 v236, v12, v13
    v_pk_mul_f32 v[10:11], v[194:195], v[130:131]
    v_pk_mul_f32 v[12:13], v[210:211], v[130:131]
    v_pk_fma_f32 v[10:11], v[210:211], v[146:147], v[10:11] neg_lo:[1,0,0] neg_hi:[1,0,0]
    v_pk_fma_f32 v[12:13], v[194:195], v[146:147], v[12:13]
    v_cvt_pk_bf16_f32 v221, v10, v11
    v_cvt_pk_bf16_f32 v237, v12, v13
    v_pk_mul_f32 v[10:11], v[196:197], v[132:133]
    v_pk_mul_f32 v[12:13], v[212:213], v[132:133]
    v_pk_fma_f32 v[10:11], v[212:213], v[148:149], v[10:11] neg_lo:[1,0,0] neg_hi:[1,0,0]
    v_pk_fma_f32 v[12:13], v[196:197], v[148:149], v[12:13]
    v_cvt_pk_bf16_f32 v222, v10, v11
    v_cvt_pk_bf16_f32 v238, v12, v13
    v_pk_mul_f32 v[10:11], v[198:199], v[134:135]
    v_pk_mul_f32 v[12:13], v[214:215], v[134:135]
    v_pk_fma_f32 v[10:11], v[214:215], v[150:151], v[10:11] neg_lo:[1,0,0] neg_hi:[1,0,0]
    v_pk_fma_f32 v[12:13], v[198:199], v[150:151], v[12:13]
    v_cvt_pk_bf16_f32 v223, v10, v11
    v_cvt_pk_bf16_f32 v239, v12, v13
    ds_write_b128 v4, v[216:219] offset:0
    ds_write_b128 v4, v[220:223] offset:1024
    ds_write_b128 v4, v[232:235] offset:2048
    ds_write_b128 v4, v[236:239] offset:3072
    s_waitcnt lgkmcnt(0)
    s_barrier
    ds_read_b128 v[216:219], v7 offset:0
    ds_read_b128 v[232:235], v7 offset:2048
    ds_read_b128 v[220:223], v7 offset:1024
    ds_read_b128 v[236:239], v7 offset:3072
    ds_read_b128 v[224:227], v7 offset:4096
    ds_read_b128 v[240:243], v7 offset:6144
    ds_read_b128 v[228:231], v7 offset:5120
    ds_read_b128 v[244:247], v7 offset:7168
    s_waitcnt lgkmcnt(7)
    v_mfma_f32_32x32x16_bf16 v[184:199], v[216:219], v[16:19], 0
    s_waitcnt lgkmcnt(6)
    v_mfma_f32_32x32x16_bf16 v[200:215], v[232:235], v[16:19], 0
    v_mfma_f32_32x32x16_bf16 v[184:199], v[232:235], v[48:51], v[184:199]
    v_mfma_f32_32x32x16_bf16 v[200:215], v[216:219], v[32:35], v[200:215]
    s_waitcnt lgkmcnt(5)
    v_mfma_f32_32x32x16_bf16 v[184:199], v[220:223], v[20:23], v[184:199]
    s_waitcnt lgkmcnt(4)
    v_mfma_f32_32x32x16_bf16 v[200:215], v[236:239], v[20:23], v[200:215]
    v_mfma_f32_32x32x16_bf16 v[184:199], v[236:239], v[52:55], v[184:199]
    v_mfma_f32_32x32x16_bf16 v[200:215], v[220:223], v[36:39], v[200:215]
    s_waitcnt lgkmcnt(3)
    v_mfma_f32_32x32x16_bf16 v[184:199], v[224:227], v[24:27], v[184:199]
    s_waitcnt lgkmcnt(2)
    v_mfma_f32_32x32x16_bf16 v[200:215], v[240:243], v[24:27], v[200:215]
    v_mfma_f32_32x32x16_bf16 v[184:199], v[240:243], v[56:59], v[184:199]
    v_mfma_f32_32x32x16_bf16 v[200:215], v[224:227], v[40:43], v[200:215]
    s_waitcnt lgkmcnt(1)
    v_mfma_f32_32x32x16_bf16 v[184:199], v[228:231], v[28:31], v[184:199]
    s_waitcnt lgkmcnt(0)
    v_mfma_f32_32x32x16_bf16 v[200:215], v[244:247], v[28:31], v[200:215]
    v_mfma_f32_32x32x16_bf16 v[184:199], v[244:247], v[60:63], v[184:199]
    v_mfma_f32_32x32x16_bf16 v[200:215], v[228:231], v[44:47], v[200:215]
    v_bfe_u32 v2, v1, 4, 2
    v_mul_u32_u24 v2, 16, v2
    v_xor_b32 v2, v2, v0
    s_lshl_b32 s34, s29, 12
    s_add_u32 s34, s34, 32768
    v_add_u32 v2, s34, v2
    v_xor_b32 v6, 64, v2
    v_bfe_u32 v3, v1, 4, 2
    v_mul_u32_u24 v3, 40960, v3
    v_bfe_u32 v8, v1, 0, 4
    v_lshl_add_u32 v3, v8, 4, v3
    v_cvt_pk_bf16_f32 v216, v184, v185
    v_cvt_pk_bf16_f32 v217, v186, v187
    v_cvt_pk_bf16_f32 v218, v188, v189
    v_cvt_pk_bf16_f32 v219, v190, v191
    v_xor_b32 v10, 0, v5
    ds_write_b128 v10, v[216:219]
    v_cvt_pk_bf16_f32 v220, v192, v193
    v_cvt_pk_bf16_f32 v221, v194, v195
    v_cvt_pk_bf16_f32 v222, v196, v197
    v_cvt_pk_bf16_f32 v223, v198, v199
    v_xor_b32 v11, 32, v5
    ds_write_b128 v11, v[220:223]
    v_cvt_pk_bf16_f32 v224, v200, v201
    v_cvt_pk_bf16_f32 v225, v202, v203
    v_cvt_pk_bf16_f32 v226, v204, v205
    v_cvt_pk_bf16_f32 v227, v206, v207
    v_xor_b32 v12, 64, v5
    ds_write_b128 v12, v[224:227]
    v_cvt_pk_bf16_f32 v228, v208, v209
    v_cvt_pk_bf16_f32 v229, v210, v211
    v_cvt_pk_bf16_f32 v230, v212, v213
    v_cvt_pk_bf16_f32 v231, v214, v215
    v_xor_b32 v13, 96, v5
    ds_write_b128 v13, v[228:231]
    s_mul_i32 s34, s30, 3145728
    s_add_u32 s34, s34, 27262976
    s_add_u32 s34, s34, s43
    s_waitcnt lgkmcnt(0)
    s_barrier
    ds_read_b128 v[232:235], v2 offset:0
    ds_read_b128 v[236:239], v6 offset:1024
    ds_read_b128 v[240:243], v2 offset:2048
    ds_read_b128 v[244:247], v6 offset:3072
    s_add_u32 s36, s34, 0
    s_waitcnt lgkmcnt(3)
    buffer_store_dwordx4 v[232:235], v3, s[4:7], s36 offen sc1
    s_add_u32 s36, s34, 163840
    s_waitcnt lgkmcnt(2)
    buffer_store_dwordx4 v[236:239], v3, s[4:7], s36 offen sc1
    s_add_u32 s36, s34, 327680
    s_waitcnt lgkmcnt(1)
    buffer_store_dwordx4 v[240:243], v3, s[4:7], s36 offen sc1
    s_add_u32 s36, s34, 491520
    s_waitcnt lgkmcnt(0)
    buffer_store_dwordx4 v[244:247], v3, s[4:7], s36 offen sc1
    s_add_u32 s57, s30, 1
    s_waitcnt vmcnt(0)
    s_barrier
    s_cmp_lg_u32 s29, 0
    s_cbranch_scc1 F_135
    s_lshl_b32 s32, s28, 5
    s_add_u32 s32, s32, s29
    s_lshl_b32 s32, s32, 2
    s_add_u32 s32, s32, 1097728
    v_mov_b32 v8, s57
    s_mov_b64 exec, 1
    buffer_store_dword v8, off, s[4:7], s32 sc1
    s_mov_b64 exec, -1
F_135:
R_130:
    s_cmp_lg_u32 s30, 0
    s_cbranch_scc1 LAYER_129
    s_cmp_eq_u32 s64, 1
    s_cbranch_scc1 Q_136
    v_bfe_u32 v2, v1, 5, 1
    v_mul_u32_u24 v2, 512, v2
    v_bfe_u32 v3, v1, 2, 2
    v_lshl_add_u32 v2, v3, 6, v2
    v_bfe_u32 v3, v1, 4, 1
    v_lshl_add_u32 v2, v3, 4, v2
    v_bfe_u32 v3, v1, 1, 1
    v_lshl_add_u32 v2, v3, 3, v2
    v_bfe_u32 v3, v1, 0, 1
    v_lshl_add_u32 v2, v3, 5, v2
    v_add_u32 v2, s60, v2
    s_branch Q_137
Q_136:
    v_bfe_u32 v2, v1, 5, 1
    v_mul_u32_u24 v2, 512, v2
    v_bfe_u32 v3, v1, 2, 2
    v_lshl_add_u32 v2, v3, 6, v2
    v_bfe_u32 v3, v1, 4, 1
    v_lshl_add_u32 v2, v3, 5, v2
    v_bfe_u32 v3, v1, 0, 2
    v_lshl_add_u32 v2, v3, 3, v2
    v_add_u32 v2, s60, v2
Q_137:
    s_waitcnt vmcnt(0)
    ds_read_b64_tr_b16 a[80:81], v2 offset:0
    ds_read_b64_tr_b16 a[82:83], v2 offset:256
    ds_read_b64_tr_b16 a[84:85], v2 offset:1024
    ds_read_b64_tr_b16 a[86:87], v2 offset:1280
    ds_read_b64_tr_b16 a[88:89], v2 offset:2048
    ds_read_b64_tr_b16 a[90:91], v2 offset:2304
    ds_read_b64_tr_b16 a[92:93], v2 offset:3072
    ds_read_b64_tr_b16 a[94:95], v2 offset:3328
    ds_read_b64_tr_b16 a[96:97], v2 offset:4096
    ds_read_b64_tr_b16 a[98:99], v2 offset:4352
    ds_read_b64_tr_b16 a[100:101], v2 offset:5120
    ds_read_b64_tr_b16 a[102:103], v2 offset:5376
    ds_read_b64_tr_b16 a[104:105], v2 offset:6144
    ds_read_b64_tr_b16 a[106:107], v2 offset:6400
    ds_read_b64_tr_b16 a[108:109], v2 offset:7168
    ds_read_b64_tr_b16 a[110:111], v2 offset:7424
    ds_read_b64_tr_b16 a[112:113], v2 offset:8192
    ds_read_b64_tr_b16 a[114:115], v2 offset:8448
    ds_read_b64_tr_b16 a[116:117], v2 offset:9216
    ds_read_b64_tr_b16 a[118:119], v2 offset:9472
    ds_read_b64_tr_b16 a[120:121], v2 offset:10240
    ds_read_b64_tr_b16 a[122:123], v2 offset:10496
    ds_read_b64_tr_b16 a[124:125], v2 offset:11264
    ds_read_b64_tr_b16 a[126:127], v2 offset:11520
    ds_read_b64_tr_b16 a[128:129], v2 offset:12288
    ds_read_b64_tr_b16 a[130:131], v2 offset:12544
    ds_read_b64_tr_b16 a[132:133], v2 offset:13312
    ds_read_b64_tr_b16 a[134:135], v2 offset:13568
    ds_read_b64_tr_b16 a[136:137], v2 offset:14336
    ds_read_b64_tr_b16 a[138:139], v2 offset:14592
    ds_read_b64_tr_b16 a[140:141], v2 offset:15360
    ds_read_b64_tr_b16 a[142:143], v2 offset:15616
    ds_read_b64_tr_b16 a[144:145], v2 offset:16384
    ds_read_b64_tr_b16 a[146:147], v2 offset:16640
    ds_read_b64_tr_b16 a[148:149], v2 offset:17408
    ds_read_b64_tr_b16 a[150:151], v2 offset:17664
    ds_read_b64_tr_b16 a[152:153], v2 offset:18432
    ds_read_b64_tr_b16 a[154:155], v2 offset:18688
    ds_read_b64_tr_b16 a[156:157], v2 offset:19456
    ds_read_b64_tr_b16 a[158:159], v2 offset:19712
    s_waitcnt lgkmcnt(0)
    s_mov_b32 s35, 0x3acccccd
    s_lshl_b32 s34, s67, 6
    s_add_u32 s34, s34, 0
    v_bfe_u32 v5, v1, 0, 2
    v_bfe_u32 v6, v1, 2, 1
    v_lshl_add_u32 v5, v6, 3, v5
    v_bfe_u32 v6, v1, 3, 1
    v_lshl_add_u32 v5, v6, 2, v5
    v_bfe_u32 v6, v1, 4, 1
    v_lshl_add_u32 v5, v6, 4, v5
    v_add_u32 v5, s34, v5
    s_mul_i32 s36, s29, 80
    s_add_u32 s36, s36, 1
    v_bfe_u32 v4, v1, 5, 1
    v_mul_u32_u24 v4, 4, v4
    v_add_u32 v4, s36, v4
    v_mul_u32_u24 v4, v4, v5
    v_cvt_f32_u32 v4, v4
    v_cvt_f32_u32 v5, v5
    v_mul_f32 v4, s35, v4
    v_mul_f32 v5, s35, v5
    v_fract_f32 v4, v4
    v_fmamk_f32 v6, v5, 0x0, v4
    v_sin_f32 v7, -v6
    v_cos_f32 v6, v6
    s_nop 0
    v_cvt_pk_bf16_f32 v10, v6, v7
    v_fmamk_f32 v8, v5, 0x3f800000, v4
    v_sin_f32 v9, -v8
    v_cos_f32 v8, v8
    v_accvgpr_write_b32 a160, v10
    v_cvt_pk_bf16_f32 v10, v8, v9
    v_fmamk_f32 v6, v5, 0x40000000, v4
    v_sin_f32 v7, -v6
    v_cos_f32 v6, v6
    v_accvgpr_write_b32 a161, v10
    v_cvt_pk_bf16_f32 v10, v6, v7
    v_fmamk_f32 v8, v5, 0x40400000, v4
    v_sin_f32 v9, -v8
    v_cos_f32 v8, v8
    v_accvgpr_write_b32 a162, v10
    v_cvt_pk_bf16_f32 v10, v8, v9
    v_fmamk_f32 v6, v5, 0x41000000, v4
    v_sin_f32 v7, -v6
    v_cos_f32 v6, v6
    v_accvgpr_write_b32 a163, v10
    v_cvt_pk_bf16_f32 v10, v6, v7
    v_fmamk_f32 v8, v5, 0x41100000, v4
    v_sin_f32 v9, -v8
    v_cos_f32 v8, v8
    v_accvgpr_write_b32 a164, v10
    v_cvt_pk_bf16_f32 v10, v8, v9
    v_fmamk_f32 v6, v5, 0x41200000, v4
    v_sin_f32 v7, -v6
    v_cos_f32 v6, v6
    v_accvgpr_write_b32 a165, v10
    v_cvt_pk_bf16_f32 v10, v6, v7
    v_fmamk_f32 v8, v5, 0x41300000, v4
    v_sin_f32 v9, -v8
    v_cos_f32 v8, v8
    v_accvgpr_write_b32 a166, v10
    v_cvt_pk_bf16_f32 v10, v8, v9
    v_fmamk_f32 v6, v5, 0x41800000, v4
    v_sin_f32 v7, -v6
    v_cos_f32 v6, v6
    v_accvgpr_write_b32 a167, v10
    v_cvt_pk_bf16_f32 v10, v6, v7
    v_fmamk_f32 v8, v5, 0x41880000, v4
    v_sin_f32 v9, -v8
    v_cos_f32 v8, v8
    v_accvgpr_write_b32 a168, v10
    v_cvt_pk_bf16_f32 v10, v8, v9
    v_fmamk_f32 v6, v5, 0x41900000, v4
    v_sin_f32 v7, -v6
    v_cos_f32 v6, v6
    v_accvgpr_write_b32 a169, v10
    v_cvt_pk_bf16_f32 v10, v6, v7
    v_fmamk_f32 v8, v5, 0x41980000, v4
    v_sin_f32 v9, -v8
    v_cos_f32 v8, v8
    v_accvgpr_write_b32 a170, v10
    v_cvt_pk_bf16_f32 v10, v8, v9
    v_fmamk_f32 v6, v5, 0x41c00000, v4
    v_sin_f32 v7, -v6
    v_cos_f32 v6, v6
    v_accvgpr_write_b32 a171, v10
    v_cvt_pk_bf16_f32 v10, v6, v7
    v_fmamk_f32 v8, v5, 0x41c80000, v4
    v_sin_f32 v9, -v8
    v_cos_f32 v8, v8
    v_accvgpr_write_b32 a172, v10
    v_cvt_pk_bf16_f32 v10, v8, v9
    v_fmamk_f32 v6, v5, 0x41d00000, v4
    v_sin_f32 v7, -v6
    v_cos_f32 v6, v6
    v_accvgpr_write_b32 a173, v10
    v_cvt_pk_bf16_f32 v10, v6, v7
    v_fmamk_f32 v8, v5, 0x41d80000, v4
    v_sin_f32 v9, -v8
    v_cos_f32 v8, v8
    v_accvgpr_write_b32 a174, v10
    v_cvt_pk_bf16_f32 v10, v8, v9
    v_fmamk_f32 v6, v5, 0x42000000, v4
    v_sin_f32 v7, -v6
    v_cos_f32 v6, v6
    v_accvgpr_write_b32 a175, v10
    v_cvt_pk_bf16_f32 v10, v6, v7
    v_fmamk_f32 v8, v5, 0x42040000, v4
    v_sin_f32 v9, -v8
    v_cos_f32 v8, v8
    v_accvgpr_write_b32 a176, v10
    v_cvt_pk_bf16_f32 v10, v8, v9
    v_fmamk_f32 v6, v5, 0x42080000, v4
    v_sin_f32 v7, -v6
    v_cos_f32 v6, v6
    v_accvgpr_write_b32 a177, v10
    v_cvt_pk_bf16_f32 v10, v6, v7
    v_fmamk_f32 v8, v5, 0x420c0000, v4
    v_sin_f32 v9, -v8
    v_cos_f32 v8, v8
    v_accvgpr_write_b32 a178, v10
    v_cvt_pk_bf16_f32 v10, v8, v9
    v_fmamk_f32 v6, v5, 0x42200000, v4
    v_sin_f32 v7, -v6
    v_cos_f32 v6, v6
    v_accvgpr_write_b32 a179, v10
    v_cvt_pk_bf16_f32 v10, v6, v7
    v_fmamk_f32 v8, v5, 0x42240000, v4
    v_sin_f32 v9, -v8
    v_cos_f32 v8, v8
    v_accvgpr_write_b32 a180, v10
    v_cvt_pk_bf16_f32 v10, v8, v9
    v_fmamk_f32 v6, v5, 0x42280000, v4
    v_sin_f32 v7, -v6
    v_cos_f32 v6, v6
    v_accvgpr_write_b32 a181, v10
    v_cvt_pk_bf16_f32 v10, v6, v7
    v_fmamk_f32 v8, v5, 0x422c0000, v4
    v_sin_f32 v9, -v8
    v_cos_f32 v8, v8
    v_accvgpr_write_b32 a182, v10
    v_cvt_pk_bf16_f32 v10, v8, v9
    v_fmamk_f32 v6, v5, 0x42400000, v4
    v_sin_f32 v7, -v6
    v_cos_f32 v6, v6
    v_accvgpr_write_b32 a183, v10
    v_cvt_pk_bf16_f32 v10, v6, v7
    v_fmamk_f32 v8, v5, 0x42440000, v4
    v_sin_f32 v9, -v8
    v_cos_f32 v8, v8
    v_accvgpr_write_b32 a184, v10
    v_cvt_pk_bf16_f32 v10, v8, v9
    v_fmamk_f32 v6, v5, 0x42480000, v4
    v_sin_f32 v7, -v6
    v_cos_f32 v6, v6
    v_accvgpr_write_b32 a185, v10
    v_cvt_pk_bf16_f32 v10, v6, v7
    v_fmamk_f32 v8, v5, 0x424c0000, v4
    v_sin_f32 v9, -v8
    v_cos_f32 v8, v8
    v_accvgpr_write_b32 a186, v10
    v_cvt_pk_bf16_f32 v10, v8, v9
    v_fmamk_f32 v6, v5, 0x42600000, v4
    v_sin_f32 v7, -v6
    v_cos_f32 v6, v6
    v_accvgpr_write_b32 a187, v10
    v_cvt_pk_bf16_f32 v10, v6, v7
    v_fmamk_f32 v8, v5, 0x42640000, v4
    v_sin_f32 v9, -v8
    v_cos_f32 v8, v8
    v_accvgpr_write_b32 a188, v10
    v_cvt_pk_bf16_f32 v10, v8, v9
    v_fmamk_f32 v6, v5, 0x42680000, v4
    v_sin_f32 v7, -v6
    v_cos_f32 v6, v6
    v_accvgpr_write_b32 a189, v10
    v_cvt_pk_bf16_f32 v10, v6, v7
    v_fmamk_f32 v8, v5, 0x426c0000, v4
    v_sin_f32 v9, -v8
    v_cos_f32 v8, v8
    v_accvgpr_write_b32 a190, v10
    v_cvt_pk_bf16_f32 v10, v8, v9
    v_fmamk_f32 v6, v5, 0x42800000, v4
    v_sin_f32 v7, -v6
    v_cos_f32 v6, v6
    v_accvgpr_write_b32 a191, v10
    v_cvt_pk_bf16_f32 v10, v6, v7
    v_fmamk_f32 v8, v5, 0x42820000, v4
    v_sin_f32 v9, -v8
    v_cos_f32 v8, v8
    v_accvgpr_write_b32 a192, v10
    v_cvt_pk_bf16_f32 v10, v8, v9
    v_fmamk_f32 v6, v5, 0x42840000, v4
    v_sin_f32 v7, -v6
    v_cos_f32 v6, v6
    v_accvgpr_write_b32 a193, v10
    v_cvt_pk_bf16_f32 v10, v6, v7
    v_fmamk_f32 v8, v5, 0x42860000, v4
    v_sin_f32 v9, -v8
    v_cos_f32 v8, v8
    v_accvgpr_write_b32 a194, v10
    v_cvt_pk_bf16_f32 v10, v8, v9
    v_fmamk_f32 v6, v5, 0x42900000, v4
    v_sin_f32 v7, -v6
    v_cos_f32 v6, v6
    v_accvgpr_write_b32 a195, v10
    v_cvt_pk_bf16_f32 v10, v6, v7
    v_fmamk_f32 v8, v5, 0x42920000, v4
    v_sin_f32 v9, -v8
    v_cos_f32 v8, v8
    v_accvgpr_write_b32 a196, v10
    v_cvt_pk_bf16_f32 v10, v8, v9
    v_fmamk_f32 v6, v5, 0x42940000, v4
    v_sin_f32 v7, -v6
    v_cos_f32 v6, v6
    v_accvgpr_write_b32 a197, v10
    v_cvt_pk_bf16_f32 v10, v6, v7
    v_fmamk_f32 v8, v5, 0x42960000, v4
    v_sin_f32 v9, -v8
    v_cos_f32 v8, v8
    v_accvgpr_write_b32 a198, v10
    v_cvt_pk_bf16_f32 v10, v8, v9
    v_accvgpr_write_b32 a199, v10
    s_lshl_b32 s34, s67, 6
    s_add_u32 s34, s34, 32
    v_bfe_u32 v5, v1, 0, 2
    v_bfe_u32 v6, v1, 2, 1
    v_lshl_add_u32 v5, v6, 3, v5
    v_bfe_u32 v6, v1, 3, 1
    v_lshl_add_u32 v5, v6, 2, v5
    v_bfe_u32 v6, v1, 4, 1
    v_lshl_add_u32 v5, v6, 4, v5
    v_add_u32 v5, s34, v5
    s_mul_i32 s36, s29, 80
    s_add_u32 s36, s36, 1
    v_bfe_u32 v4, v1, 5, 1
    v_mul_u32_u24 v4, 4, v4
    v_add_u32 v4, s36, v4
    v_mul_u32_u24 v4, v4, v5
    v_cvt_f32_u32 v4, v4
    v_cvt_f32_u32 v5, v5
    v_mul_f32 v4, s35, v4
    v_mul_f32 v5, s35, v5
    v_fract_f32 v4, v4
    v_fmamk_f32 v6, v5, 0x0, v4
    v_sin_f32 v7, -v6
    v_cos_f32 v6, v6
    s_nop 0
    v_cvt_pk_bf16_f32 v10, v6, v7
    v_fmamk_f32 v8, v5, 0x3f800000, v4
    v_sin_f32 v9, -v8
    v_cos_f32 v8, v8
    v_accvgpr_write_b32 a200, v10
    v_cvt_pk_bf16_f32 v10, v8, v9
    v_fmamk_f32 v6, v5, 0x40000000, v4
    v_sin_f32 v7, -v6
    v_cos_f32 v6, v6
    v_accvgpr_write_b32 a201, v10
    v_cvt_pk_bf16_f32 v10, v6, v7
    v_fmamk_f32 v8, v5, 0x40400000, v4
    v_sin_f32 v9, -v8
    v_cos_f32 v8, v8
    v_accvgpr_write_b32 a202, v10
    v_cvt_pk_bf16_f32 v10, v8, v9
    v_fmamk_f32 v6, v5, 0x41000000, v4
    v_sin_f32 v7, -v6
    v_cos_f32 v6, v6
    v_accvgpr_write_b32 a203, v10
    v_cvt_pk_bf16_f32 v10, v6, v7
    v_fmamk_f32 v8, v5, 0x41100000, v4
    v_sin_f32 v9, -v8
    v_cos_f32 v8, v8
    v_accvgpr_write_b32 a204, v10
    v_cvt_pk_bf16_f32 v10, v8, v9
    v_fmamk_f32 v6, v5, 0x41200000, v4
    v_sin_f32 v7, -v6
    v_cos_f32 v6, v6
    v_accvgpr_write_b32 a205, v10
    v_cvt_pk_bf16_f32 v10, v6, v7
    v_fmamk_f32 v8, v5, 0x41300000, v4
    v_sin_f32 v9, -v8
    v_cos_f32 v8, v8
    v_accvgpr_write_b32 a206, v10
    v_cvt_pk_bf16_f32 v10, v8, v9
    v_fmamk_f32 v6, v5, 0x41800000, v4
    v_sin_f32 v7, -v6
    v_cos_f32 v6, v6
    v_accvgpr_write_b32 a207, v10
    v_cvt_pk_bf16_f32 v10, v6, v7
    v_fmamk_f32 v8, v5, 0x41880000, v4
    v_sin_f32 v9, -v8
    v_cos_f32 v8, v8
    v_accvgpr_write_b32 a208, v10
    v_cvt_pk_bf16_f32 v10, v8, v9
    v_fmamk_f32 v6, v5, 0x41900000, v4
    v_sin_f32 v7, -v6
    v_cos_f32 v6, v6
    v_accvgpr_write_b32 a209, v10
    v_cvt_pk_bf16_f32 v10, v6, v7
    v_fmamk_f32 v8, v5, 0x41980000, v4
    v_sin_f32 v9, -v8
    v_cos_f32 v8, v8
    v_accvgpr_write_b32 a210, v10
    v_cvt_pk_bf16_f32 v10, v8, v9
    v_fmamk_f32 v6, v5, 0x41c00000, v4
    v_sin_f32 v7, -v6
    v_cos_f32 v6, v6
    v_accvgpr_write_b32 a211, v10
    v_cvt_pk_bf16_f32 v10, v6, v7
    v_fmamk_f32 v8, v5, 0x41c80000, v4
    v_sin_f32 v9, -v8
    v_cos_f32 v8, v8
    v_accvgpr_write_b32 a212, v10
    v_cvt_pk_bf16_f32 v10, v8, v9
    v_fmamk_f32 v6, v5, 0x41d00000, v4
    v_sin_f32 v7, -v6
    v_cos_f32 v6, v6
    v_accvgpr_write_b32 a213, v10
    v_cvt_pk_bf16_f32 v10, v6, v7
    v_fmamk_f32 v8, v5, 0x41d80000, v4
    v_sin_f32 v9, -v8
    v_cos_f32 v8, v8
    v_accvgpr_write_b32 a214, v10
    v_cvt_pk_bf16_f32 v10, v8, v9
    v_fmamk_f32 v6, v5, 0x42000000, v4
    v_sin_f32 v7, -v6
    v_cos_f32 v6, v6
    v_accvgpr_write_b32 a215, v10
    v_cvt_pk_bf16_f32 v10, v6, v7
    v_fmamk_f32 v8, v5, 0x42040000, v4
    v_sin_f32 v9, -v8
    v_cos_f32 v8, v8
    v_accvgpr_write_b32 a216, v10
    v_cvt_pk_bf16_f32 v10, v8, v9
    v_fmamk_f32 v6, v5, 0x42080000, v4
    v_sin_f32 v7, -v6
    v_cos_f32 v6, v6
    v_accvgpr_write_b32 a217, v10
    v_cvt_pk_bf16_f32 v10, v6, v7
    v_fmamk_f32 v8, v5, 0x420c0000, v4
    v_sin_f32 v9, -v8
    v_cos_f32 v8, v8
    v_accvgpr_write_b32 a218, v10
    v_cvt_pk_bf16_f32 v10, v8, v9
    v_fmamk_f32 v6, v5, 0x42200000, v4
    v_sin_f32 v7, -v6
    v_cos_f32 v6, v6
    v_accvgpr_write_b32 a219, v10
    v_cvt_pk_bf16_f32 v10, v6, v7
    v_fmamk_f32 v8, v5, 0x42240000, v4
    v_sin_f32 v9, -v8
    v_cos_f32 v8, v8
    v_accvgpr_write_b32 a220, v10
    v_cvt_pk_bf16_f32 v10, v8, v9
    v_fmamk_f32 v6, v5, 0x42280000, v4
    v_sin_f32 v7, -v6
    v_cos_f32 v6, v6
    v_accvgpr_write_b32 a221, v10
    v_cvt_pk_bf16_f32 v10, v6, v7
    v_fmamk_f32 v8, v5, 0x422c0000, v4
    v_sin_f32 v9, -v8
    v_cos_f32 v8, v8
    v_accvgpr_write_b32 a222, v10
    v_cvt_pk_bf16_f32 v10, v8, v9
    v_fmamk_f32 v6, v5, 0x42400000, v4
    v_sin_f32 v7, -v6
    v_cos_f32 v6, v6
    v_accvgpr_write_b32 a223, v10
    v_cvt_pk_bf16_f32 v10, v6, v7
    v_fmamk_f32 v8, v5, 0x42440000, v4
    v_sin_f32 v9, -v8
    v_cos_f32 v8, v8
    v_accvgpr_write_b32 a224, v10
    v_cvt_pk_bf16_f32 v10, v8, v9
    v_fmamk_f32 v6, v5, 0x42480000, v4
    v_sin_f32 v7, -v6
    v_cos_f32 v6, v6
    v_accvgpr_write_b32 a225, v10
    v_cvt_pk_bf16_f32 v10, v6, v7
    v_fmamk_f32 v8, v5, 0x424c0000, v4
    v_sin_f32 v9, -v8
    v_cos_f32 v8, v8
    v_accvgpr_write_b32 a226, v10
    v_cvt_pk_bf16_f32 v10, v8, v9
    v_fmamk_f32 v6, v5, 0x42600000, v4
    v_sin_f32 v7, -v6
    v_cos_f32 v6, v6
    v_accvgpr_write_b32 a227, v10
    v_cvt_pk_bf16_f32 v10, v6, v7
    v_fmamk_f32 v8, v5, 0x42640000, v4
    v_sin_f32 v9, -v8
    v_cos_f32 v8, v8
    v_accvgpr_write_b32 a228, v10
    v_cvt_pk_bf16_f32 v10, v8, v9
    v_fmamk_f32 v6, v5, 0x42680000, v4
    v_sin_f32 v7, -v6
    v_cos_f32 v6, v6
    v_accvgpr_write_b32 a229, v10
    v_cvt_pk_bf16_f32 v10, v6, v7
    v_fmamk_f32 v8, v5, 0x426c0000, v4
    v_sin_f32 v9, -v8
    v_cos_f32 v8, v8
    v_accvgpr_write_b32 a230, v10
    v_cvt_pk_bf16_f32 v10, v8, v9
    v_fmamk_f32 v6, v5, 0x42800000, v4
    v_sin_f32 v7, -v6
    v_cos_f32 v6, v6
    v_accvgpr_write_b32 a231, v10
    v_cvt_pk_bf16_f32 v10, v6, v7
    v_fmamk_f32 v8, v5, 0x42820000, v4
    v_sin_f32 v9, -v8
    v_cos_f32 v8, v8
    v_accvgpr_write_b32 a232, v10
    v_cvt_pk_bf16_f32 v10, v8, v9
    v_fmamk_f32 v6, v5, 0x42840000, v4
    v_sin_f32 v7, -v6
    v_cos_f32 v6, v6
    v_accvgpr_write_b32 a233, v10
    v_cvt_pk_bf16_f32 v10, v6, v7
    v_fmamk_f32 v8, v5, 0x42860000, v4
    v_sin_f32 v9, -v8
    v_cos_f32 v8, v8
    v_accvgpr_write_b32 a234, v10
    v_cvt_pk_bf16_f32 v10, v8, v9
    v_fmamk_f32 v6, v5, 0x42900000, v4
    v_sin_f32 v7, -v6
    v_cos_f32 v6, v6
    v_accvgpr_write_b32 a235, v10
    v_cvt_pk_bf16_f32 v10, v6, v7
    v_fmamk_f32 v8, v5, 0x42920000, v4
    v_sin_f32 v9, -v8
    v_cos_f32 v8, v8
    v_accvgpr_write_b32 a236, v10
    v_cvt_pk_bf16_f32 v10, v8, v9
    v_fmamk_f32 v6, v5, 0x42940000, v4
    v_sin_f32 v7, -v6
    v_cos_f32 v6, v6
    v_accvgpr_write_b32 a237, v10
    v_cvt_pk_bf16_f32 v10, v6, v7
    v_fmamk_f32 v8, v5, 0x42960000, v4
    v_sin_f32 v9, -v8
    v_cos_f32 v8, v8
    v_accvgpr_write_b32 a238, v10
    v_cvt_pk_bf16_f32 v10, v8, v9
    v_accvgpr_write_b32 a239, v10
LAYER_129:
    s_cmp_ge_u32 s28, 190
    s_cbranch_scc1 R_138
    s_add_u32 s44, s66, 0
    s_mov_b32 s47, 19
    s_mov_b32 s46, 64
    s_mul_i32 s50, s30, 3145728
    s_add_u32 s50, s50, 27262976
    s_mul_i32 s34, s29, 10240
    s_add_u32 s50, s50, s34
    s_mul_i32 s51, s30, 6291456
    s_add_u32 s51, s51, 11534336
    s_lshl_b32 s34, s67, 12
    s_add_u32 s51, s51, s34
    s_add_u32 s52, s34, 14680064
    s_mov_b32 s58, 40960
    v_bfe_u32 v2, v1, 5, 1
    v_mul_u32_u24 v2, 512, v2
    v_bfe_u32 v172, v1, 2, 2
    v_lshl_add_u32 v2, v172, 6, v2
    v_bfe_u32 v172, v1, 4, 1
    v_lshl_add_u32 v2, v172, 5, v2
    v_bfe_u32 v172, v1, 0, 1
    v_lshl_add_u32 v2, v172, 4, v2
    v_bfe_u32 v172, v1, 1, 1
    v_lshl_add_u32 v2, v172, 3, v2
    v_add_u32 v2, s60, v2
    s_lshl_b32 s34, s29, 13
    v_add_u32 v4, s34, v0
    s_lshl_b32 s34, s29, 3
    s_add_u32 s34, s34, 65536
    v_bfe_u32 v5, v1, 0, 5
    v_mul_u32_u24 v5, 32, v5
    v_add_u32 v5, s34, v5
    s_lshl_b32 s35, s29, 11
    s_lshl_b32 s36, s29, 8
    s_add_u32 s36, s36, 67584
    v_add_u32 v3, s35, v0
    s_lshl_b32 s34, s29, 10
    v_add_u32 v7, s34, v0
    v_bfe_u32 v6, v1, 0, 5
    v_mul_u32_u24 v6, 32, v6
    v_add_u32 v6, 65536, v6
    s_lshl_b32 s34, s29, 5
    v_bfe_u32 v8, v1, 0, 2
    v_mul_u32_u24 v8, 1280, v8
    v_bfe_u32 v172, v1, 2, 1
    v_mul_u32_u24 v172, 10240, v172
    v_add_u32 v8, v8, v172
    v_bfe_u32 v172, v1, 3, 1
    v_mul_u32_u24 v172, 5120, v172
    v_add_u32 v8, v8, v172
    v_bfe_u32 v172, v1, 4, 1
    v_mul_u32_u24 v172, 20480, v172
    v_add_u32 v8, v8, v172
    v_bfe_u32 v172, v1, 5, 1
    v_lshl_add_u32 v8, v172, 4, v8
    v_add_u32 v8, s34, v8
    s_cmp_lg_u32 s30, 0
    s_cbranch_scc1 F3_139
    s_lshl_b32 s52, s67, 7
    s_load_dwordx2 s[16:17], s[0:1], 0
    s_mov_b32 s18, 2621440
    s_mov_b32 s19, 0x20000
    s_waitcnt lgkmcnt(0)
    s_branch F3_140
F3_139:
    v_mov_b32 v8, v7
    s_load_dwordx2 s[16:17], s[0:1], 96
    s_mov_b32 s18, 268435456
    s_mov_b32 s19, 0x20000
    s_waitcnt lgkmcnt(0)
F3_140:
    s_add_u32 s57, s30, 1
    s_mul_i32 s37, s29, 40
    v_min_u32 v176, 39, v1
    v_lshlrev_b32 v176, 7, v176
    s_lshl_b32 s32, s37, 7
    s_add_u32 s32, s32, 1097728
    s_mov_b32 s48, 0
P_141:
    buffer_load_dword v172, v176, s[4:7], s32 offen sc1
    s_waitcnt vmcnt(0)
    v_cmp_gt_u32 vcc, s57, v172
    s_cbranch_vccz P_142
    s_add_u32 s48, s48, 1
    s_cmp_gt_u32 s48, 200000
    s_cbranch_scc1 L_end
    s_sleep 1
    s_branch P_141
P_142:
    s_mul_i32 s54, s44, 40960
    s_add_u32 s56, s54, s52
    s_add_u32 s54, s54, s50
    s_add_u32 m0, s60, 0
    s_nop 0
    buffer_load_dwordx4 v0, s[4:7], s54 offen offset:0 sc1 lds
    buffer_load_dwordx4 v0, s[4:7], s54 offen offset:1024 sc1 lds
    buffer_load_dwordx4 v0, s[4:7], s54 offen offset:2048 sc1 lds
    buffer_load_dwordx4 v0, s[4:7], s54 offen offset:3072 sc1 lds
    s_add_u32 s54, s54, 4096
    s_add_u32 m0, s60, 4096
    s_nop 0
    buffer_load_dwordx4 v0, s[4:7], s54 offen offset:0 sc1 lds
    buffer_load_dwordx4 v0, s[4:7], s54 offen offset:1024 sc1 lds
    buffer_load_dwordx4 v0, s[4:7], s54 offen offset:2048 sc1 lds
    buffer_load_dwordx4 v0, s[4:7], s54 offen offset:3072 sc1 lds
    s_add_u32 s54, s54, 4096
    s_add_u32 m0, s60, 8192
    s_nop 0
    buffer_load_dwordx4 v0, s[4:7], s54 offen offset:0 sc1 lds
    buffer_load_dwordx4 v0, s[4:7], s54 offen offset:1024 sc1 lds
    buffer_load_dwordx4 v[164:167], v8, s[16:19], s56 offen sc1
    s_waitcnt vmcnt(0)
    ds_read_b64_tr_b16 v[16:17], v2 offset:0
    ds_read_b64_tr_b16 v[18:19], v2 offset:256
    ds_read_b64_tr_b16 v[20:21], v2 offset:1024
    ds_read_b64_tr_b16 v[22:23], v2 offset:1280
    ds_read_b64_tr_b16 v[24:25], v2 offset:2048
    ds_read_b64_tr_b16 v[26:27], v2 offset:2304
    ds_read_b64_tr_b16 v[28:29], v2 offset:3072
    ds_read_b64_tr_b16 v[30:31], v2 offset:3328
    ds_read_b64_tr_b16 v[32:33], v2 offset:4096
    ds_read_b64_tr_b16 v[34:35], v2 offset:4352
    ds_read_b64_tr_b16 v[36:37], v2 offset:5120
    ds_read_b64_tr_b16 v[38:39], v2 offset:5376
    ds_read_b64_tr_b16 v[40:41], v2 offset:6144
    ds_read_b64_tr_b16 v[42:43], v2 offset:6400
    ds_read_b64_tr_b16 v[44:45], v2 offset:7168
    ds_read_b64_tr_b16 v[46:47], v2 offset:7424
    ds_read_b64_tr_b16 v[48:49], v2 offset:8192
    ds_read_b64_tr_b16 v[50:51], v2 offset:8448
    ds_read_b64_tr_b16 v[52:53], v2 offset:9216
    ds_read_b64_tr_b16 v[54:55], v2 offset:9472
    s_waitcnt lgkmcnt(15)
    v_mfma_f32_32x32x16_bf16 v[96:111], a[160:163], v[16:19], 0
    v_mfma_f32_32x32x16_bf16 v[112:127], a[200:203], v[16:19], 0
    v_mfma_f32_32x32x16_bf16 v[96:111], a[164:167], v[20:23], v[96:111]
    v_mfma_f32_32x32x16_bf16 v[112:127], a[204:207], v[20:23], v[112:127]
    s_waitcnt lgkmcnt(14)
    v_mfma_f32_32x32x16_bf16 v[96:111], a[168:171], v[24:27], v[96:111]
    v_mfma_f32_32x32x16_bf16 v[112:127], a[208:211], v[24:27], v[112:127]
    s_waitcnt lgkmcnt(12)
    v_mfma_f32_32x32x16_bf16 v[96:111], a[172:175], v[28:31], v[96:111]
    v_mfma_f32_32x32x16_bf16 v[112:127], a[212:215], v[28:31], v[112:127]
    s_waitcnt lgkmcnt(10)
    v_mfma_f32_32x32x16_bf16 v[96:111], a[176:179], v[32:35], v[96:111]
    v_mfma_f32_32x32x16_bf16 v[112:127], a[216:219], v[32:35], v[112:127]
    s_waitcnt lgkmcnt(8)
    v_mfma_f32_32x32x16_bf16 v[96:111], a[180:183], v[36:39], v[96:111]
    v_mfma_f32_32x32x16_bf16 v[112:127], a[220:223], v[36:39], v[112:127]
    s_waitcnt lgkmcnt(6)
    v_mfma_f32_32x32x16_bf16 v[96:111], a[184:187], v[40:43], v[96:111]
    v_mfma_f32_32x32x16_bf16 v[112:127], a[224:227], v[40:43], v[112:127]
    s_waitcnt lgkmcnt(4)
    v_mfma_f32_32x32x16_bf16 v[96:111], a[188:191], v[44:47], v[96:111]
    v_mfma_f32_32x32x16_bf16 v[112:127], a[228:231], v[44:47], v[112:127]
    s_waitcnt lgkmcnt(2)
    v_mfma_f32_32x32x16_bf16 v[96:111], a[192:195], v[48:51], v[96:111]
    v_mfma_f32_32x32x16_bf16 v[112:127], a[232:235], v[48:51], v[112:127]
    s_waitcnt lgkmcnt(0)
    v_mfma_f32_32x32x16_bf16 v[96:111], a[196:199], v[52:55], v[96:111]
    v_mfma_f32_32x32x16_bf16 v[112:127], a[236:239], v[52:55], v[112:127]
    s_mul_i32 s55, s44, s58
    s_add_u32 s55, s55, s51
    s_nop 1
    ds_write_b128 v4, v[96:99] offset:0
    ds_write_b128 v4, v[100:103] offset:1024
    ds_write_b128 v4, v[104:107] offset:2048
    ds_write_b128 v4, v[108:111] offset:3072
    s_nop 3
    ds_write_b128 v4, v[112:115] offset:4096
    ds_write_b128 v4, v[116:119] offset:5120
    ds_write_b128 v4, v[120:123] offset:6144
    ds_write_b128 v4, v[124:127] offset:7168
    s_waitcnt lgkmcnt(0)
    s_barrier
    ds_read_b128 v[96:99], v3 offset:0
    ds_read_b128 v[100:103], v3 offset:1024
    ds_read_b128 v[104:107], v3 offset:8192
    ds_read_b128 v[108:111], v3 offset:9216
    ds_read_b128 v[112:115], v3 offset:16384
    ds_read_b128 v[116:119], v3 offset:17408
    ds_read_b128 v[120:123], v3 offset:24576
    ds_read_b128 v[124:127], v3 offset:25600
    s_waitcnt lgkmcnt(5)
    v_pk_add_f32 v[96:97], v[96:97], v[104:105]
    v_pk_add_f32 v[98:99], v[98:99], v[106:107]
    s_waitcnt lgkmcnt(4)
    v_pk_add_f32 v[100:101], v[100:101], v[108:109]
    v_pk_add_f32 v[102:103], v[102:103], v[110:111]
    s_waitcnt lgkmcnt(3)
    v_pk_add_f32 v[96:97], v[96:97], v[112:113]
    v_pk_add_f32 v[98:99], v[98:99], v[114:115]
    s_waitcnt lgkmcnt(2)
    v_pk_add_f32 v[100:101], v[100:101], v[116:117]
    v_pk_add_f32 v[102:103], v[102:103], v[118:119]
    s_waitcnt lgkmcnt(1)
    v_pk_add_f32 v[96:97], v[96:97], v[120:121]
    v_pk_add_f32 v[98:99], v[98:99], v[122:123]
    s_waitcnt lgkmcnt(0)
    v_pk_add_f32 v[100:101], v[100:101], v[124:125]
    v_pk_add_f32 v[102:103], v[102:103], v[126:127]
    v_cvt_pk_bf16_f32 v172, v96, v97
    v_cvt_pk_bf16_f32 v173, v98, v99
    v_cvt_pk_bf16_f32 v174, v100, v101
    v_cvt_pk_bf16_f32 v175, v102, v103
    v_lshlrev_b32 v96, 16, v172
    v_lshlrev_b32 v97, 16, v164
    v_and_b32 v98, 0xffff0000, v172
    v_and_b32 v99, 0xffff0000, v164
    v_add_f32 v96, v96, v97
    v_add_f32 v98, v98, v99
    v_cvt_pk_bf16_f32 v172, v96, v98
    v_lshlrev_b32 v96, 16, v173
    v_lshlrev_b32 v97, 16, v165
    v_and_b32 v98, 0xffff0000, v173
    v_and_b32 v99, 0xffff0000, v165
    v_add_f32 v96, v96, v97
    v_add_f32 v98, v98, v99
    v_cvt_pk_bf16_f32 v173, v96, v98
    v_lshlrev_b32 v96, 16, v174
    v_lshlrev_b32 v97, 16, v166
    v_and_b32 v98, 0xffff0000, v174
    v_and_b32 v99, 0xffff0000, v166
    v_add_f32 v96, v96, v97
    v_add_f32 v98, v98, v99
    v_cvt_pk_bf16_f32 v174, v96, v98
    v_lshlrev_b32 v96, 16, v175
    v_lshlrev_b32 v97, 16, v167
    v_and_b32 v98, 0xffff0000, v175
    v_and_b32 v99, 0xffff0000, v167
    v_add_f32 v96, v96, v97
    v_add_f32 v98, v98, v99
    v_cvt_pk_bf16_f32 v175, v96, v98
    buffer_store_dwordx4 v[172:175], v7, s[4:7], s55 offen sc1
    s_lshl_b32 s57, s30, 1
    s_add_u32 s57, s57, 1
    s_waitcnt vmcnt(0)
    s_barrier
    s_cmp_lg_u32 s29, 0
    s_cbranch_scc1 F_143
    s_lshl_b32 s32, s28, 5
    s_add_u32 s32, s32, s29
    s_lshl_b32 s32, s32, 2
    s_add_u32 s32, s32, 1122304
    v_mov_b32 v172, s57
    s_mov_b64 exec, 1
    buffer_store_dword v172, off, s[4:7], s32 sc1
    s_mov_b64 exec, -1
F_143:
R_138:
    s_mov_b32 s68, 0
    s_mov_b32 s46, 10
    s_lshl_b32 s57, s30, 1
    s_add_u32 s57, s57, 1
    s_branch LAYER_128
LAYER_126:
    s_cmp_ge_u32 s28, 190
    s_cbranch_scc1 R_144
    s_add_u32 s44, s66, 19
    s_mov_b32 s47, 19
    s_mov_b32 s46, 64
    s_mul_i32 s50, s30, 3145728
    s_add_u32 s50, s50, 27262976
    s_mul_i32 s34, s29, 10240
    s_add_u32 s50, s50, s34
    s_mul_i32 s51, s30, 6291456
    s_add_u32 s51, s51, 11534336
    s_lshl_b32 s34, s67, 12
    s_add_u32 s51, s51, s34
    s_add_u32 s52, s34, 14680064
    s_mov_b32 s58, 40960
    v_bfe_u32 v2, v1, 5, 1
    v_mul_u32_u24 v2, 512, v2
    v_bfe_u32 v172, v1, 2, 2
    v_lshl_add_u32 v2, v172, 6, v2
    v_bfe_u32 v172, v1, 4, 1
    v_lshl_add_u32 v2, v172, 5, v2
    v_bfe_u32 v172, v1, 0, 1
    v_lshl_add_u32 v2, v172, 4, v2
    v_bfe_u32 v172, v1, 1, 1
    v_lshl_add_u32 v2, v172, 3, v2
    v_add_u32 v2, s60, v2
    s_lshl_b32 s34, s29, 13
    v_add_u32 v4, s34, v0
    s_lshl_b32 s34, s29, 3
    s_add_u32 s34, s34, 65536
    v_bfe_u32 v5, v1, 0, 5
    v_mul_u32_u24 v5, 32, v5
    v_add_u32 v5, s34, v5
    s_lshl_b32 s35, s29, 11
    s_lshl_b32 s36, s29, 8
    s_add_u32 s36, s36, 67584
    v_add_u32 v3, s35, v0
    s_lshl_b32 s34, s29, 10
    v_add_u32 v7, s34, v0
    v_bfe_u32 v6, v1, 0, 5
    v_mul_u32_u24 v6, 32, v6
    v_add_u32 v6, 65536, v6
    s_lshl_b32 s34, s29, 5
    v_bfe_u32 v8, v1, 0, 2
    v_mul_u32_u24 v8, 1280, v8
    v_bfe_u32 v172, v1, 2, 1
    v_mul_u32_u24 v172, 10240, v172
    v_add_u32 v8, v8, v172
    v_bfe_u32 v172, v1, 3, 1
    v_mul_u32_u24 v172, 5120, v172
    v_add_u32 v8, v8, v172
    v_bfe_u32 v172, v1, 4, 1
    v_mul_u32_u24 v172, 20480, v172
    v_add_u32 v8, v8, v172
    v_bfe_u32 v172, v1, 5, 1
    v_lshl_add_u32 v8, v172, 4, v8
    v_add_u32 v8, s34, v8
    s_cmp_lg_u32 s30, 0
    s_cbranch_scc1 F3_145
    s_lshl_b32 s52, s67, 7
    s_load_dwordx2 s[16:17], s[0:1], 0
    s_mov_b32 s18, 2621440
    s_mov_b32 s19, 0x20000
    s_waitcnt lgkmcnt(0)
    s_branch F3_146
F3_145:
    v_mov_b32 v8, v7
    s_load_dwordx2 s[16:17], s[0:1], 96
    s_mov_b32 s18, 268435456
    s_mov_b32 s19, 0x20000
    s_waitcnt lgkmcnt(0)
F3_146:
    s_mul_i32 s54, s44, 40960
    s_add_u32 s56, s54, s52
    s_add_u32 s54, s54, s50
    s_waitcnt vmcnt(0) lgkmcnt(0)
    s_add_u32 m0, s60, 0
    s_nop 0
    buffer_load_dwordx4 v0, s[4:7], s54 offen offset:0 sc1 lds
    buffer_load_dwordx4 v0, s[4:7], s54 offen offset:1024 sc1 lds
    buffer_load_dwordx4 v0, s[4:7], s54 offen offset:2048 sc1 lds
    buffer_load_dwordx4 v0, s[4:7], s54 offen offset:3072 sc1 lds
    s_add_u32 s54, s54, 4096
    s_add_u32 m0, s60, 4096
    s_nop 0
    buffer_load_dwordx4 v0, s[4:7], s54 offen offset:0 sc1 lds
    buffer_load_dwordx4 v0, s[4:7], s54 offen offset:1024 sc1 lds
    buffer_load_dwordx4 v0, s[4:7], s54 offen offset:2048 sc1 lds
    buffer_load_dwordx4 v0, s[4:7], s54 offen offset:3072 sc1 lds
    s_add_u32 s54, s54, 4096
    s_add_u32 m0, s60, 8192
    s_nop 0
    buffer_load_dwordx4 v0, s[4:7], s54 offen offset:0 sc1 lds
    buffer_load_dwordx4 v0, s[4:7], s54 offen offset:1024 sc1 lds
    buffer_load_dwordx4 v[164:167], v8, s[16:19], s56 offen sc1
    s_add_u32 s45, s44, s47
    s_mul_i32 s54, s45, 40960
    s_add_u32 s56, s54, s52
    s_add_u32 s54, s54, s50
    s_waitcnt vmcnt(0)
    ds_read_b64_tr_b16 v[16:17], v2 offset:0
    ds_read_b64_tr_b16 v[18:19], v2 offset:256
    ds_read_b64_tr_b16 v[20:21], v2 offset:1024
    ds_read_b64_tr_b16 v[22:23], v2 offset:1280
    ds_read_b64_tr_b16 v[24:25], v2 offset:2048
    ds_read_b64_tr_b16 v[26:27], v2 offset:2304
    ds_read_b64_tr_b16 v[28:29], v2 offset:3072
    ds_read_b64_tr_b16 v[30:31], v2 offset:3328
    ds_read_b64_tr_b16 v[32:33], v2 offset:4096
    ds_read_b64_tr_b16 v[34:35], v2 offset:4352
    ds_read_b64_tr_b16 v[36:37], v2 offset:5120
    ds_read_b64_tr_b16 v[38:39], v2 offset:5376
    ds_read_b64_tr_b16 v[40:41], v2 offset:6144
    ds_read_b64_tr_b16 v[42:43], v2 offset:6400
    ds_read_b64_tr_b16 v[44:45], v2 offset:7168
    ds_read_b64_tr_b16 v[46:47], v2 offset:7424
    ds_read_b64_tr_b16 v[48:49], v2 offset:8192
    ds_read_b64_tr_b16 v[50:51], v2 offset:8448
    ds_read_b64_tr_b16 v[52:53], v2 offset:9216
    ds_read_b64_tr_b16 v[54:55], v2 offset:9472
    s_waitcnt lgkmcnt(15)
    v_mfma_f32_32x32x16_bf16 v[96:111], a[160:163], v[16:19], 0
    v_mfma_f32_32x32x16_bf16 v[96:111], a[164:167], v[20:23], v[96:111]
    s_waitcnt lgkmcnt(14)
    v_mfma_f32_32x32x16_bf16 v[96:111], a[168:171], v[24:27], v[96:111]
    s_waitcnt lgkmcnt(12)
    v_mfma_f32_32x32x16_bf16 v[96:111], a[172:175], v[28:31], v[96:111]
    s_waitcnt lgkmcnt(10)
    v_mfma_f32_32x32x16_bf16 v[96:111], a[176:179], v[32:35], v[96:111]
    s_waitcnt lgkmcnt(8)
    v_mfma_f32_32x32x16_bf16 v[96:111], a[180:183], v[36:39], v[96:111]
    s_waitcnt lgkmcnt(6)
    v_mfma_f32_32x32x16_bf16 v[96:111], a[184:187], v[40:43], v[96:111]
    s_waitcnt lgkmcnt(4)
    v_mfma_f32_32x32x16_bf16 v[96:111], a[188:191], v[44:47], v[96:111]
    s_waitcnt lgkmcnt(2)
    v_mfma_f32_32x32x16_bf16 v[96:111], a[192:195], v[48:51], v[96:111]
    s_add_u32 m0, s60, 10240
    s_nop 0
    buffer_load_dwordx4 v0, s[4:7], s54 offen offset:0 sc1 lds
    s_waitcnt lgkmcnt(0)
    v_mfma_f32_32x32x16_bf16 v[96:111], a[196:199], v[52:55], v[96:111]
    buffer_load_dwordx4 v0, s[4:7], s54 offen offset:1024 sc1 lds
    v_mfma_f32_32x32x16_bf16 v[112:127], a[200:203], v[16:19], 0
    buffer_load_dwordx4 v0, s[4:7], s54 offen offset:2048 sc1 lds
    v_mfma_f32_32x32x16_bf16 v[112:127], a[204:207], v[20:23], v[112:127]
    buffer_load_dwordx4 v0, s[4:7], s54 offen offset:3072 sc1 lds
    v_mfma_f32_32x32x16_bf16 v[112:127], a[208:211], v[24:27], v[112:127]
    s_add_u32 s54, s54, 4096
    s_add_u32 m0, s60, 14336
    s_nop 0
    buffer_load_dwordx4 v0, s[4:7], s54 offen offset:0 sc1 lds
    v_mfma_f32_32x32x16_bf16 v[112:127], a[212:215], v[28:31], v[112:127]
    buffer_load_dwordx4 v0, s[4:7], s54 offen offset:1024 sc1 lds
    v_mfma_f32_32x32x16_bf16 v[112:127], a[216:219], v[32:35], v[112:127]
    buffer_load_dwordx4 v0, s[4:7], s54 offen offset:2048 sc1 lds
    v_mfma_f32_32x32x16_bf16 v[112:127], a[220:223], v[36:39], v[112:127]
    buffer_load_dwordx4 v0, s[4:7], s54 offen offset:3072 sc1 lds
    v_mfma_f32_32x32x16_bf16 v[112:127], a[224:227], v[40:43], v[112:127]
    s_add_u32 s54, s54, 4096
    s_add_u32 m0, s60, 18432
    s_nop 0
    buffer_load_dwordx4 v0, s[4:7], s54 offen offset:0 sc1 lds
    ds_write_b128 v4, v[96:99] offset:0
    v_mfma_f32_32x32x16_bf16 v[112:127], a[228:231], v[44:47], v[112:127]
    buffer_load_dwordx4 v0, s[4:7], s54 offen offset:1024 sc1 lds
    ds_write_b128 v4, v[100:103] offset:1024
    v_mfma_f32_32x32x16_bf16 v[112:127], a[232:235], v[48:51], v[112:127]
    ds_write_b128 v4, v[104:107] offset:2048
    v_mfma_f32_32x32x16_bf16 v[112:127], a[236:239], v[52:55], v[112:127]
    ds_write_b128 v4, v[108:111] offset:3072
    s_mov_b32 s59, 1073741824
    s_mul_i32 s55, s44, s58
    s_add_u32 s55, s55, s51
    buffer_load_dwordx4 v[168:171], v8, s[16:19], s56 offen sc1
G_147:
    s_mov_b32 s44, s45
    s_add_u32 s45, s44, s47
    s_cmp_lt_u32 s45, s46
    s_cbranch_scc0 G_150
    s_mul_i32 s54, s45, 40960
    s_add_u32 s56, s54, s52
    s_add_u32 s54, s54, s50
    s_waitcnt vmcnt(0)
    ds_read_b64_tr_b16 v[56:57], v2 offset:10240
    ds_read_b64_tr_b16 v[58:59], v2 offset:10496
    ds_read_b64_tr_b16 v[60:61], v2 offset:11264
    ds_read_b64_tr_b16 v[62:63], v2 offset:11520
    ds_read_b64_tr_b16 v[64:65], v2 offset:12288
    ds_read_b64_tr_b16 v[66:67], v2 offset:12544
    ds_read_b64_tr_b16 v[68:69], v2 offset:13312
    ds_read_b64_tr_b16 v[70:71], v2 offset:13568
    ds_read_b64_tr_b16 v[72:73], v2 offset:14336
    ds_read_b64_tr_b16 v[74:75], v2 offset:14592
    ds_read_b64_tr_b16 v[76:77], v2 offset:15360
    ds_read_b64_tr_b16 v[78:79], v2 offset:15616
    ds_read_b64_tr_b16 v[80:81], v2 offset:16384
    ds_read_b64_tr_b16 v[82:83], v2 offset:16640
    ds_read_b64_tr_b16 v[84:85], v2 offset:17408
    ds_read_b64_tr_b16 v[86:87], v2 offset:17664
    ds_read_b64_tr_b16 v[88:89], v2 offset:18432
    ds_read_b64_tr_b16 v[90:91], v2 offset:18688
    ds_read_b64_tr_b16 v[92:93], v2 offset:19456
    ds_read_b64_tr_b16 v[94:95], v2 offset:19712
    s_waitcnt lgkmcnt(15)
    v_mfma_f32_32x32x16_bf16 v[96:111], a[160:163], v[56:59], 0
    ds_write_b128 v4, v[112:115] offset:4096
    v_mfma_f32_32x32x16_bf16 v[96:111], a[164:167], v[60:63], v[96:111]
    ds_write_b128 v4, v[116:119] offset:5120
    s_waitcnt lgkmcnt(15)
    v_mfma_f32_32x32x16_bf16 v[96:111], a[168:171], v[64:67], v[96:111]
    ds_write_b128 v4, v[120:123] offset:6144
    s_waitcnt lgkmcnt(15)
    v_mfma_f32_32x32x16_bf16 v[96:111], a[172:175], v[68:71], v[96:111]
    ds_write_b128 v4, v[124:127] offset:7168
    s_waitcnt lgkmcnt(14)
    v_mfma_f32_32x32x16_bf16 v[96:111], a[176:179], v[72:75], v[96:111]
    s_waitcnt lgkmcnt(12)
    v_mfma_f32_32x32x16_bf16 v[96:111], a[180:183], v[76:79], v[96:111]
    s_waitcnt lgkmcnt(0)
    s_barrier
    buffer_store_dwordx4 v[172:175], v7, s[4:7], s59 offen sc1
    v_mfma_f32_32x32x16_bf16 v[96:111], a[184:187], v[80:83], v[96:111]
    ds_read_b128 v[184:187], v3 offset:0
    ds_read_b128 v[188:191], v3 offset:1024
    ds_read_b128 v[192:195], v3 offset:8192
    ds_read_b128 v[196:199], v3 offset:9216
    v_mfma_f32_32x32x16_bf16 v[96:111], a[188:191], v[84:87], v[96:111]
    ds_read_b128 v[200:203], v3 offset:16384
    ds_read_b128 v[204:207], v3 offset:17408
    ds_read_b128 v[208:211], v3 offset:24576
    ds_read_b128 v[212:215], v3 offset:25600
    v_mfma_f32_32x32x16_bf16 v[96:111], a[192:195], v[88:91], v[96:111]
    s_add_u32 m0, s60, 0
    s_nop 0
    buffer_load_dwordx4 v0, s[4:7], s54 offen offset:0 sc1 lds
    v_mfma_f32_32x32x16_bf16 v[96:111], a[196:199], v[92:95], v[96:111]
    buffer_load_dwordx4 v0, s[4:7], s54 offen offset:1024 sc1 lds
    v_mfma_f32_32x32x16_bf16 v[112:127], a[200:203], v[56:59], 0
    buffer_load_dwordx4 v0, s[4:7], s54 offen offset:2048 sc1 lds
    s_waitcnt lgkmcnt(5)
    v_add_f32 v184, v184, v192
    v_add_f32 v185, v185, v193
    v_add_f32 v186, v186, v194
    v_add_f32 v187, v187, v195
    s_waitcnt lgkmcnt(4)
    v_add_f32 v188, v188, v196
    v_add_f32 v189, v189, v197
    v_mfma_f32_32x32x16_bf16 v[112:127], a[204:207], v[60:63], v[112:127]
    buffer_load_dwordx4 v0, s[4:7], s54 offen offset:3072 sc1 lds
    v_add_f32 v190, v190, v198
    v_add_f32 v191, v191, v199
    s_waitcnt lgkmcnt(3)
    v_add_f32 v184, v184, v200
    v_add_f32 v185, v185, v201
    v_add_f32 v186, v186, v202
    v_add_f32 v187, v187, v203
    v_mfma_f32_32x32x16_bf16 v[112:127], a[208:211], v[64:67], v[112:127]
    s_add_u32 s54, s54, 4096
    s_add_u32 m0, s60, 4096
    s_nop 0
    buffer_load_dwordx4 v0, s[4:7], s54 offen offset:0 sc1 lds
    s_waitcnt lgkmcnt(2)
    v_add_f32 v188, v188, v204
    v_add_f32 v189, v189, v205
    v_add_f32 v190, v190, v206
    v_add_f32 v191, v191, v207
    s_waitcnt lgkmcnt(1)
    v_add_f32 v184, v184, v208
    v_add_f32 v185, v185, v209
    v_mfma_f32_32x32x16_bf16 v[112:127], a[212:215], v[68:71], v[112:127]
    buffer_load_dwordx4 v0, s[4:7], s54 offen offset:1024 sc1 lds
    v_add_f32 v186, v186, v210
    v_add_f32 v187, v187, v211
    s_waitcnt lgkmcnt(0)
    v_add_f32 v188, v188, v212
    v_add_f32 v189, v189, v213
    v_add_f32 v190, v190, v214
    v_add_f32 v191, v191, v215
    v_mfma_f32_32x32x16_bf16 v[112:127], a[216:219], v[72:75], v[112:127]
    buffer_load_dwordx4 v0, s[4:7], s54 offen offset:2048 sc1 lds
    v_cvt_pk_bf16_f32 v172, v184, v185
    v_cvt_pk_bf16_f32 v173, v186, v187
    v_cvt_pk_bf16_f32 v174, v188, v189
    v_cvt_pk_bf16_f32 v175, v190, v191
    v_lshlrev_b32 v184, 16, v172
    v_lshlrev_b32 v185, 16, v164
    v_mfma_f32_32x32x16_bf16 v[112:127], a[220:223], v[76:79], v[112:127]
    buffer_load_dwordx4 v0, s[4:7], s54 offen offset:3072 sc1 lds
    v_and_b32 v186, 0xffff0000, v172
    v_and_b32 v187, 0xffff0000, v164
    v_add_f32 v184, v184, v185
    v_add_f32 v186, v186, v187
    v_cvt_pk_bf16_f32 v172, v184, v186
    v_lshlrev_b32 v184, 16, v173
    v_mfma_f32_32x32x16_bf16 v[112:127], a[224:227], v[80:83], v[112:127]
    s_add_u32 s54, s54, 4096
    s_add_u32 m0, s60, 8192
    s_nop 0
    buffer_load_dwordx4 v0, s[4:7], s54 offen offset:0 sc1 lds
    ds_write_b128 v4, v[96:99] offset:32768
    v_lshlrev_b32 v185, 16, v165
    v_and_b32 v186, 0xffff0000, v173
    v_and_b32 v187, 0xffff0000, v165
    v_add_f32 v184, v184, v185
    v_add_f32 v186, v186, v187
    v_cvt_pk_bf16_f32 v173, v184, v186
    v_mfma_f32_32x32x16_bf16 v[112:127], a[228:231], v[84:87], v[112:127]
    buffer_load_dwordx4 v0, s[4:7], s54 offen offset:1024 sc1 lds
    ds_write_b128 v4, v[100:103] offset:33792
    v_lshlrev_b32 v184, 16, v174
    v_lshlrev_b32 v185, 16, v166
    v_and_b32 v186, 0xffff0000, v174
    v_and_b32 v187, 0xffff0000, v166
    v_add_f32 v184, v184, v185
    v_add_f32 v186, v186, v187
    v_mfma_f32_32x32x16_bf16 v[112:127], a[232:235], v[88:91], v[112:127]
    ds_write_b128 v4, v[104:107] offset:34816
    v_cvt_pk_bf16_f32 v174, v184, v186
    v_lshlrev_b32 v184, 16, v175
    v_lshlrev_b32 v185, 16, v167
    v_and_b32 v186, 0xffff0000, v175
    v_and_b32 v187, 0xffff0000, v167
    v_add_f32 v184, v184, v185
    v_mfma_f32_32x32x16_bf16 v[112:127], a[236:239], v[92:95], v[112:127]
    ds_write_b128 v4, v[108:111] offset:35840
    v_add_f32 v186, v186, v187
    v_cvt_pk_bf16_f32 v175, v184, v186
    s_mov_b32 s59, s55
    s_mul_i32 s55, s44, s58
    s_add_u32 s55, s55, s51
    buffer_load_dwordx4 v[164:167], v8, s[16:19], s56 offen sc1
    s_mov_b32 s44, s45
    s_add_u32 s45, s44, s47
    s_cmp_lt_u32 s45, s46
    s_cbranch_scc0 G_149
    s_mul_i32 s54, s45, 40960
    s_add_u32 s56, s54, s52
    s_add_u32 s54, s54, s50
    s_waitcnt vmcnt(0)
    ds_read_b64_tr_b16 v[16:17], v2 offset:0
    ds_read_b64_tr_b16 v[18:19], v2 offset:256
    ds_read_b64_tr_b16 v[20:21], v2 offset:1024
    ds_read_b64_tr_b16 v[22:23], v2 offset:1280
    ds_read_b64_tr_b16 v[24:25], v2 offset:2048
    ds_read_b64_tr_b16 v[26:27], v2 offset:2304
    ds_read_b64_tr_b16 v[28:29], v2 offset:3072
    ds_read_b64_tr_b16 v[30:31], v2 offset:3328
    ds_read_b64_tr_b16 v[32:33], v2 offset:4096
    ds_read_b64_tr_b16 v[34:35], v2 offset:4352
    ds_read_b64_tr_b16 v[36:37], v2 offset:5120
    ds_read_b64_tr_b16 v[38:39], v2 offset:5376
    ds_read_b64_tr_b16 v[40:41], v2 offset:6144
    ds_read_b64_tr_b16 v[42:43], v2 offset:6400
    ds_read_b64_tr_b16 v[44:45], v2 offset:7168
    ds_read_b64_tr_b16 v[46:47], v2 offset:7424
    ds_read_b64_tr_b16 v[48:49], v2 offset:8192
    ds_read_b64_tr_b16 v[50:51], v2 offset:8448
    ds_read_b64_tr_b16 v[52:53], v2 offset:9216
    ds_read_b64_tr_b16 v[54:55], v2 offset:9472
    s_waitcnt lgkmcnt(15)
    v_mfma_f32_32x32x16_bf16 v[96:111], a[160:163], v[16:19], 0
    ds_write_b128 v4, v[112:115] offset:36864
    v_mfma_f32_32x32x16_bf16 v[96:111], a[164:167], v[20:23], v[96:111]
    ds_write_b128 v4, v[116:119] offset:37888
    s_waitcnt lgkmcnt(15)
    v_mfma_f32_32x32x16_bf16 v[96:111], a[168:171], v[24:27], v[96:111]
    ds_write_b128 v4, v[120:123] offset:38912
    s_waitcnt lgkmcnt(15)
    v_mfma_f32_32x32x16_bf16 v[96:111], a[172:175], v[28:31], v[96:111]
    ds_write_b128 v4, v[124:127] offset:39936
    s_waitcnt lgkmcnt(14)
    v_mfma_f32_32x32x16_bf16 v[96:111], a[176:179], v[32:35], v[96:111]
    s_waitcnt lgkmcnt(12)
    v_mfma_f32_32x32x16_bf16 v[96:111], a[180:183], v[36:39], v[96:111]
    s_waitcnt lgkmcnt(0)
    s_barrier
    buffer_store_dwordx4 v[172:175], v7, s[4:7], s59 offen sc1
    v_mfma_f32_32x32x16_bf16 v[96:111], a[184:187], v[40:43], v[96:111]
    ds_read_b128 v[184:187], v3 offset:32768
    ds_read_b128 v[188:191], v3 offset:33792
    ds_read_b128 v[192:195], v3 offset:40960
    ds_read_b128 v[196:199], v3 offset:41984
    v_mfma_f32_32x32x16_bf16 v[96:111], a[188:191], v[44:47], v[96:111]
    ds_read_b128 v[200:203], v3 offset:49152
    ds_read_b128 v[204:207], v3 offset:50176
    ds_read_b128 v[208:211], v3 offset:57344
    ds_read_b128 v[212:215], v3 offset:58368
    v_mfma_f32_32x32x16_bf16 v[96:111], a[192:195], v[48:51], v[96:111]
    s_add_u32 m0, s60, 10240
    s_nop 0
    buffer_load_dwordx4 v0, s[4:7], s54 offen offset:0 sc1 lds
    v_mfma_f32_32x32x16_bf16 v[96:111], a[196:199], v[52:55], v[96:111]
    buffer_load_dwordx4 v0, s[4:7], s54 offen offset:1024 sc1 lds
    v_mfma_f32_32x32x16_bf16 v[112:127], a[200:203], v[16:19], 0
    buffer_load_dwordx4 v0, s[4:7], s54 offen offset:2048 sc1 lds
    s_waitcnt lgkmcnt(5)
    v_add_f32 v184, v184, v192
    v_add_f32 v185, v185, v193
    v_add_f32 v186, v186, v194
    v_add_f32 v187, v187, v195
    s_waitcnt lgkmcnt(4)
    v_add_f32 v188, v188, v196
    v_add_f32 v189, v189, v197
    v_mfma_f32_32x32x16_bf16 v[112:127], a[204:207], v[20:23], v[112:127]
    buffer_load_dwordx4 v0, s[4:7], s54 offen offset:3072 sc1 lds
    v_add_f32 v190, v190, v198
    v_add_f32 v191, v191, v199
    s_waitcnt lgkmcnt(3)
    v_add_f32 v184, v184, v200
    v_add_f32 v185, v185, v201
    v_add_f32 v186, v186, v202
    v_add_f32 v187, v187, v203
    v_mfma_f32_32x32x16_bf16 v[112:127], a[208:211], v[24:27], v[112:127]
    s_add_u32 s54, s54, 4096
    s_add_u32 m0, s60, 14336
    s_nop 0
    buffer_load_dwordx4 v0, s[4:7], s54 offen offset:0 sc1 lds
    s_waitcnt lgkmcnt(2)
    v_add_f32 v188, v188, v204
    v_add_f32 v189, v189, v205
    v_add_f32 v190, v190, v206
    v_add_f32 v191, v191, v207
    s_waitcnt lgkmcnt(1)
    v_add_f32 v184, v184, v208
    v_add_f32 v185, v185, v209
    v_mfma_f32_32x32x16_bf16 v[112:127], a[212:215], v[28:31], v[112:127]
    buffer_load_dwordx4 v0, s[4:7], s54 offen offset:1024 sc1 lds
    v_add_f32 v186, v186, v210
    v_add_f32 v187, v187, v211
    s_waitcnt lgkmcnt(0)
    v_add_f32 v188, v188, v212
    v_add_f32 v189, v189, v213
    v_add_f32 v190, v190, v214
    v_add_f32 v191, v191, v215
    v_mfma_f32_32x32x16_bf16 v[112:127], a[216:219], v[32:35], v[112:127]
    buffer_load_dwordx4 v0, s[4:7], s54 offen offset:2048 sc1 lds
    v_cvt_pk_bf16_f32 v172, v184, v185
    v_cvt_pk_bf16_f32 v173, v186, v187
    v_cvt_pk_bf16_f32 v174, v188, v189
    v_cvt_pk_bf16_f32 v175, v190, v191
    v_lshlrev_b32 v184, 16, v172
    v_lshlrev_b32 v185, 16, v168
    v_mfma_f32_32x32x16_bf16 v[112:127], a[220:223], v[36:39], v[112:127]
    buffer_load_dwordx4 v0, s[4:7], s54 offen offset:3072 sc1 lds
    v_and_b32 v186, 0xffff0000, v172
    v_and_b32 v187, 0xffff0000, v168
    v_add_f32 v184, v184, v185
    v_add_f32 v186, v186, v187
    v_cvt_pk_bf16_f32 v172, v184, v186
    v_lshlrev_b32 v184, 16, v173
    v_mfma_f32_32x32x16_bf16 v[112:127], a[224:227], v[40:43], v[112:127]
    s_add_u32 s54, s54, 4096
    s_add_u32 m0, s60, 18432
    s_nop 0
    buffer_load_dwordx4 v0, s[4:7], s54 offen offset:0 sc1 lds
    ds_write_b128 v4, v[96:99] offset:0
    v_lshlrev_b32 v185, 16, v169
    v_and_b32 v186, 0xffff0000, v173
    v_and_b32 v187, 0xffff0000, v169
    v_add_f32 v184, v184, v185
    v_add_f32 v186, v186, v187
    v_cvt_pk_bf16_f32 v173, v184, v186
    v_mfma_f32_32x32x16_bf16 v[112:127], a[228:231], v[44:47], v[112:127]
    buffer_load_dwordx4 v0, s[4:7], s54 offen offset:1024 sc1 lds
    ds_write_b128 v4, v[100:103] offset:1024
    v_lshlrev_b32 v184, 16, v174
    v_lshlrev_b32 v185, 16, v170
    v_and_b32 v186, 0xffff0000, v174
    v_and_b32 v187, 0xffff0000, v170
    v_add_f32 v184, v184, v185
    v_add_f32 v186, v186, v187
    v_mfma_f32_32x32x16_bf16 v[112:127], a[232:235], v[48:51], v[112:127]
    ds_write_b128 v4, v[104:107] offset:2048
    v_cvt_pk_bf16_f32 v174, v184, v186
    v_lshlrev_b32 v184, 16, v175
    v_lshlrev_b32 v185, 16, v171
    v_and_b32 v186, 0xffff0000, v175
    v_and_b32 v187, 0xffff0000, v171
    v_add_f32 v184, v184, v185
    v_mfma_f32_32x32x16_bf16 v[112:127], a[236:239], v[52:55], v[112:127]
    ds_write_b128 v4, v[108:111] offset:3072
    v_add_f32 v186, v186, v187
    v_cvt_pk_bf16_f32 v175, v184, v186
    s_mov_b32 s59, s55
    s_mul_i32 s55, s44, s58
    s_add_u32 s55, s55, s51
    buffer_load_dwordx4 v[168:171], v8, s[16:19], s56 offen sc1
    s_branch G_147
G_150:
    s_waitcnt vmcnt(0)
    ds_read_b64_tr_b16 v[56:57], v2 offset:10240
    ds_read_b64_tr_b16 v[58:59], v2 offset:10496
    ds_read_b64_tr_b16 v[60:61], v2 offset:11264
    ds_read_b64_tr_b16 v[62:63], v2 offset:11520
    ds_read_b64_tr_b16 v[64:65], v2 offset:12288
    ds_read_b64_tr_b16 v[66:67], v2 offset:12544
    ds_read_b64_tr_b16 v[68:69], v2 offset:13312
    ds_read_b64_tr_b16 v[70:71], v2 offset:13568
    ds_read_b64_tr_b16 v[72:73], v2 offset:14336
    ds_read_b64_tr_b16 v[74:75], v2 offset:14592
    ds_read_b64_tr_b16 v[76:77], v2 offset:15360
    ds_read_b64_tr_b16 v[78:79], v2 offset:15616
    ds_read_b64_tr_b16 v[80:81], v2 offset:16384
    ds_read_b64_tr_b16 v[82:83], v2 offset:16640
    ds_read_b64_tr_b16 v[84:85], v2 offset:17408
    ds_read_b64_tr_b16 v[86:87], v2 offset:17664
    ds_read_b64_tr_b16 v[88:89], v2 offset:18432
    ds_read_b64_tr_b16 v[90:91], v2 offset:18688
    ds_read_b64_tr_b16 v[92:93], v2 offset:19456
    ds_read_b64_tr_b16 v[94:95], v2 offset:19712
    s_waitcnt lgkmcnt(15)
    v_mfma_f32_32x32x16_bf16 v[96:111], a[160:163], v[56:59], 0
    ds_write_b128 v4, v[112:115] offset:4096
    v_mfma_f32_32x32x16_bf16 v[96:111], a[164:167], v[60:63], v[96:111]
    ds_write_b128 v4, v[116:119] offset:5120
    s_waitcnt lgkmcnt(15)
    v_mfma_f32_32x32x16_bf16 v[96:111], a[168:171], v[64:67], v[96:111]
    ds_write_b128 v4, v[120:123] offset:6144
    s_waitcnt lgkmcnt(15)
    v_mfma_f32_32x32x16_bf16 v[96:111], a[172:175], v[68:71], v[96:111]
    ds_write_b128 v4, v[124:127] offset:7168
    s_waitcnt lgkmcnt(14)
    v_mfma_f32_32x32x16_bf16 v[96:111], a[176:179], v[72:75], v[96:111]
    s_waitcnt lgkmcnt(12)
    v_mfma_f32_32x32x16_bf16 v[96:111], a[180:183], v[76:79], v[96:111]
    s_waitcnt lgkmcnt(0)
    s_barrier
    buffer_store_dwordx4 v[172:175], v7, s[4:7], s59 offen sc1
    v_mfma_f32_32x32x16_bf16 v[96:111], a[184:187], v[80:83], v[96:111]
    ds_read_b128 v[184:187], v3 offset:0
    ds_read_b128 v[188:191], v3 offset:1024
    ds_read_b128 v[192:195], v3 offset:8192
    ds_read_b128 v[196:199], v3 offset:9216
    v_mfma_f32_32x32x16_bf16 v[96:111], a[188:191], v[84:87], v[96:111]
    ds_read_b128 v[200:203], v3 offset:16384
    ds_read_b128 v[204:207], v3 offset:17408
    ds_read_b128 v[208:211], v3 offset:24576
    ds_read_b128 v[212:215], v3 offset:25600
    v_mfma_f32_32x32x16_bf16 v[96:111], a[192:195], v[88:91], v[96:111]
    v_mfma_f32_32x32x16_bf16 v[96:111], a[196:199], v[92:95], v[96:111]
    v_mfma_f32_32x32x16_bf16 v[112:127], a[200:203], v[56:59], 0
    s_waitcnt lgkmcnt(5)
    v_add_f32 v184, v184, v192
    v_add_f32 v185, v185, v193
    v_add_f32 v186, v186, v194
    v_add_f32 v187, v187, v195
    s_waitcnt lgkmcnt(4)
    v_add_f32 v188, v188, v196
    v_add_f32 v189, v189, v197
    v_mfma_f32_32x32x16_bf16 v[112:127], a[204:207], v[60:63], v[112:127]
    v_add_f32 v190, v190, v198
    v_add_f32 v191, v191, v199
    s_waitcnt lgkmcnt(3)
    v_add_f32 v184, v184, v200
    v_add_f32 v185, v185, v201
    v_add_f32 v186, v186, v202
    v_add_f32 v187, v187, v203
    v_mfma_f32_32x32x16_bf16 v[112:127], a[208:211], v[64:67], v[112:127]
    s_waitcnt lgkmcnt(2)
    v_add_f32 v188, v188, v204
    v_add_f32 v189, v189, v205
    v_add_f32 v190, v190, v206
    v_add_f32 v191, v191, v207
    s_waitcnt lgkmcnt(1)
    v_add_f32 v184, v184, v208
    v_add_f32 v185, v185, v209
    v_mfma_f32_32x32x16_bf16 v[112:127], a[212:215], v[68:71], v[112:127]
    v_add_f32 v186, v186, v210
    v_add_f32 v187, v187, v211
    s_waitcnt lgkmcnt(0)
    v_add_f32 v188, v188, v212
    v_add_f32 v189, v189, v213
    v_add_f32 v190, v190, v214
    v_add_f32 v191, v191, v215
    v_mfma_f32_32x32x16_bf16 v[112:127], a[216:219], v[72:75], v[112:127]
    v_cvt_pk_bf16_f32 v172, v184, v185
    v_cvt_pk_bf16_f32 v173, v186, v187
    v_cvt_pk_bf16_f32 v174, v188, v189
    v_cvt_pk_bf16_f32 v175, v190, v191
    v_lshlrev_b32 v184, 16, v172
    v_lshlrev_b32 v185, 16, v164
    v_mfma_f32_32x32x16_bf16 v[112:127], a[220:223], v[76:79], v[112:127]
    v_and_b32 v186, 0xffff0000, v172
    v_and_b32 v187, 0xffff0000, v164
    v_add_f32 v184, v184, v185
    v_add_f32 v186, v186, v187
    v_cvt_pk_bf16_f32 v172, v184, v186
    v_lshlrev_b32 v184, 16, v173
    v_mfma_f32_32x32x16_bf16 v[112:127], a[224:227], v[80:83], v[112:127]
    ds_write_b128 v4, v[96:99] offset:32768
    v_lshlrev_b32 v185, 16, v165
    v_and_b32 v186, 0xffff0000, v173
    v_and_b32 v187, 0xffff0000, v165
    v_add_f32 v184, v184, v185
    v_add_f32 v186, v186, v187
    v_cvt_pk_bf16_f32 v173, v184, v186
    v_mfma_f32_32x32x16_bf16 v[112:127], a[228:231], v[84:87], v[112:127]
    ds_write_b128 v4, v[100:103] offset:33792
    v_lshlrev_b32 v184, 16, v174
    v_lshlrev_b32 v185, 16, v166
    v_and_b32 v186, 0xffff0000, v174
    v_and_b32 v187, 0xffff0000, v166
    v_add_f32 v184, v184, v185
    v_add_f32 v186, v186, v187
    v_mfma_f32_32x32x16_bf16 v[112:127], a[232:235], v[88:91], v[112:127]
    ds_write_b128 v4, v[104:107] offset:34816
    v_cvt_pk_bf16_f32 v174, v184, v186
    v_lshlrev_b32 v184, 16, v175
    v_lshlrev_b32 v185, 16, v167
    v_and_b32 v186, 0xffff0000, v175
    v_and_b32 v187, 0xffff0000, v167
    v_add_f32 v184, v184, v185
    v_mfma_f32_32x32x16_bf16 v[112:127], a[236:239], v[92:95], v[112:127]
    ds_write_b128 v4, v[108:111] offset:35840
    v_add_f32 v186, v186, v187
    v_cvt_pk_bf16_f32 v175, v184, v186
    s_mov_b32 s59, s55
    s_mul_i32 s55, s44, s58
    s_add_u32 s55, s55, s51
    s_nop 5
    ds_write_b128 v4, v[112:115] offset:36864
    ds_write_b128 v4, v[116:119] offset:37888
    ds_write_b128 v4, v[120:123] offset:38912
    ds_write_b128 v4, v[124:127] offset:39936
    s_waitcnt vmcnt(0)
    s_waitcnt lgkmcnt(0)
    s_barrier
    buffer_store_dwordx4 v[172:175], v7, s[4:7], s59 offen sc1
    ds_read_b128 v[184:187], v3 offset:32768
    ds_read_b128 v[188:191], v3 offset:33792
    ds_read_b128 v[192:195], v3 offset:40960
    ds_read_b128 v[196:199], v3 offset:41984
    ds_read_b128 v[200:203], v3 offset:49152
    ds_read_b128 v[204:207], v3 offset:50176
    ds_read_b128 v[208:211], v3 offset:57344
    ds_read_b128 v[212:215], v3 offset:58368
    s_waitcnt lgkmcnt(5)
    v_add_f32 v184, v184, v192
    v_add_f32 v185, v185, v193
    v_add_f32 v186, v186, v194
    v_add_f32 v187, v187, v195
    s_waitcnt lgkmcnt(4)
    v_add_f32 v188, v188, v196
    v_add_f32 v189, v189, v197
    v_add_f32 v190, v190, v198
    v_add_f32 v191, v191, v199
    s_waitcnt lgkmcnt(3)
    v_add_f32 v184, v184, v200
    v_add_f32 v185, v185, v201
    v_add_f32 v186, v186, v202
    v_add_f32 v187, v187, v203
    s_waitcnt lgkmcnt(2)
    v_add_f32 v188, v188, v204
    v_add_f32 v189, v189, v205
    v_add_f32 v190, v190, v206
    v_add_f32 v191, v191, v207
    s_waitcnt lgkmcnt(1)
    v_add_f32 v184, v184, v208
    v_add_f32 v185, v185, v209
    v_add_f32 v186, v186, v210
    v_add_f32 v187, v187, v211
    s_waitcnt lgkmcnt(0)
    v_add_f32 v188, v188, v212
    v_add_f32 v189, v189, v213
    v_add_f32 v190, v190, v214
    v_add_f32 v191, v191, v215
    v_cvt_pk_bf16_f32 v172, v184, v185
    v_cvt_pk_bf16_f32 v173, v186, v187
    v_cvt_pk_bf16_f32 v174, v188, v189
    v_cvt_pk_bf16_f32 v175, v190, v191
    v_lshlrev_b32 v184, 16, v172
    v_lshlrev_b32 v185, 16, v168
    v_and_b32 v186, 0xffff0000, v172
    v_and_b32 v187, 0xffff0000, v168
    v_add_f32 v184, v184, v185
    v_add_f32 v186, v186, v187
    v_cvt_pk_bf16_f32 v172, v184, v186
    v_lshlrev_b32 v184, 16, v173
    v_lshlrev_b32 v185, 16, v169
    v_and_b32 v186, 0xffff0000, v173
    v_and_b32 v187, 0xffff0000, v169
    v_add_f32 v184, v184, v185
    v_add_f32 v186, v186, v187
    v_cvt_pk_bf16_f32 v173, v184, v186
    v_lshlrev_b32 v184, 16, v174
    v_lshlrev_b32 v185, 16, v170
    v_and_b32 v186, 0xffff0000, v174
    v_and_b32 v187, 0xffff0000, v170
    v_add_f32 v184, v184, v185
    v_add_f32 v186, v186, v187
    v_cvt_pk_bf16_f32 v174, v184, v186
    v_lshlrev_b32 v184, 16, v175
    v_lshlrev_b32 v185, 16, v171
    v_and_b32 v186, 0xffff0000, v175
    v_and_b32 v187, 0xffff0000, v171
    v_add_f32 v184, v184, v185
    v_add_f32 v186, v186, v187
    v_cvt_pk_bf16_f32 v175, v184, v186
    s_mov_b32 s59, s55
    buffer_store_dwordx4 v[172:175], v7, s[4:7], s59 offen sc1
    s_branch G_148
G_149:
    s_waitcnt vmcnt(0)
    ds_read_b64_tr_b16 v[16:17], v2 offset:0
    ds_read_b64_tr_b16 v[18:19], v2 offset:256
    ds_read_b64_tr_b16 v[20:21], v2 offset:1024
    ds_read_b64_tr_b16 v[22:23], v2 offset:1280
    ds_read_b64_tr_b16 v[24:25], v2 offset:2048
    ds_read_b64_tr_b16 v[26:27], v2 offset:2304
    ds_read_b64_tr_b16 v[28:29], v2 offset:3072
    ds_read_b64_tr_b16 v[30:31], v2 offset:3328
    ds_read_b64_tr_b16 v[32:33], v2 offset:4096
    ds_read_b64_tr_b16 v[34:35], v2 offset:4352
    ds_read_b64_tr_b16 v[36:37], v2 offset:5120
    ds_read_b64_tr_b16 v[38:39], v2 offset:5376
    ds_read_b64_tr_b16 v[40:41], v2 offset:6144
    ds_read_b64_tr_b16 v[42:43], v2 offset:6400
    ds_read_b64_tr_b16 v[44:45], v2 offset:7168
    ds_read_b64_tr_b16 v[46:47], v2 offset:7424
    ds_read_b64_tr_b16 v[48:49], v2 offset:8192
    ds_read_b64_tr_b16 v[50:51], v2 offset:8448
    ds_read_b64_tr_b16 v[52:53], v2 offset:9216
    ds_read_b64_tr_b16 v[54:55], v2 offset:9472
    s_waitcnt lgkmcnt(15)
    v_mfma_f32_32x32x16_bf16 v[96:111], a[160:163], v[16:19], 0
    ds_write_b128 v4, v[112:115] offset:36864
    v_mfma_f32_32x32x16_bf16 v[96:111], a[164:167], v[20:23], v[96:111]
    ds_write_b128 v4, v[116:119] offset:37888
    s_waitcnt lgkmcnt(15)
    v_mfma_f32_32x32x16_bf16 v[96:111], a[168:171], v[24:27], v[96:111]
    ds_write_b128 v4, v[120:123] offset:38912
    s_waitcnt lgkmcnt(15)
    v_mfma_f32_32x32x16_bf16 v[96:111], a[172:175], v[28:31], v[96:111]
    ds_write_b128 v4, v[124:127] offset:39936
    s_waitcnt lgkmcnt(14)
    v_mfma_f32_32x32x16_bf16 v[96:111], a[176:179], v[32:35], v[96:111]
    s_waitcnt lgkmcnt(12)
    v_mfma_f32_32x32x16_bf16 v[96:111], a[180:183], v[36:39], v[96:111]
    s_waitcnt lgkmcnt(0)
    s_barrier
    buffer_store_dwordx4 v[172:175], v7, s[4:7], s59 offen sc1
    v_mfma_f32_32x32x16_bf16 v[96:111], a[184:187], v[40:43], v[96:111]
    ds_read_b128 v[184:187], v3 offset:32768
    ds_read_b128 v[188:191], v3 offset:33792
    ds_read_b128 v[192:195], v3 offset:40960
    ds_read_b128 v[196:199], v3 offset:41984
    v_mfma_f32_32x32x16_bf16 v[96:111], a[188:191], v[44:47], v[96:111]
    ds_read_b128 v[200:203], v3 offset:49152
    ds_read_b128 v[204:207], v3 offset:50176
    ds_read_b128 v[208:211], v3 offset:57344
    ds_read_b128 v[212:215], v3 offset:58368
    v_mfma_f32_32x32x16_bf16 v[96:111], a[192:195], v[48:51], v[96:111]
    v_mfma_f32_32x32x16_bf16 v[96:111], a[196:199], v[52:55], v[96:111]
    v_mfma_f32_32x32x16_bf16 v[112:127], a[200:203], v[16:19], 0
    s_waitcnt lgkmcnt(5)
    v_add_f32 v184, v184, v192
    v_add_f32 v185, v185, v193
    v_add_f32 v186, v186, v194
    v_add_f32 v187, v187, v195
    s_waitcnt lgkmcnt(4)
    v_add_f32 v188, v188, v196
    v_add_f32 v189, v189, v197
    v_mfma_f32_32x32x16_bf16 v[112:127], a[204:207], v[20:23], v[112:127]
    v_add_f32 v190, v190, v198
    v_add_f32 v191, v191, v199
    s_waitcnt lgkmcnt(3)
    v_add_f32 v184, v184, v200
    v_add_f32 v185, v185, v201
    v_add_f32 v186, v186, v202
    v_add_f32 v187, v187, v203
    v_mfma_f32_32x32x16_bf16 v[112:127], a[208:211], v[24:27], v[112:127]
    s_waitcnt lgkmcnt(2)
    v_add_f32 v188, v188, v204
    v_add_f32 v189, v189, v205
    v_add_f32 v190, v190, v206
    v_add_f32 v191, v191, v207
    s_waitcnt lgkmcnt(1)
    v_add_f32 v184, v184, v208
    v_add_f32 v185, v185, v209
    v_mfma_f32_32x32x16_bf16 v[112:127], a[212:215], v[28:31], v[112:127]
    v_add_f32 v186, v186, v210
    v_add_f32 v187, v187, v211
    s_waitcnt lgkmcnt(0)
    v_add_f32 v188, v188, v212
    v_add_f32 v189, v189, v213
    v_add_f32 v190, v190, v214
    v_add_f32 v191, v191, v215
    v_mfma_f32_32x32x16_bf16 v[112:127], a[216:219], v[32:35], v[112:127]
    v_cvt_pk_bf16_f32 v172, v184, v185
    v_cvt_pk_bf16_f32 v173, v186, v187
    v_cvt_pk_bf16_f32 v174, v188, v189
    v_cvt_pk_bf16_f32 v175, v190, v191
    v_lshlrev_b32 v184, 16, v172
    v_lshlrev_b32 v185, 16, v168
    v_mfma_f32_32x32x16_bf16 v[112:127], a[220:223], v[36:39], v[112:127]
    v_and_b32 v186, 0xffff0000, v172
    v_and_b32 v187, 0xffff0000, v168
    v_add_f32 v184, v184, v185
    v_add_f32 v186, v186, v187
    v_cvt_pk_bf16_f32 v172, v184, v186
    v_lshlrev_b32 v184, 16, v173
    v_mfma_f32_32x32x16_bf16 v[112:127], a[224:227], v[40:43], v[112:127]
    ds_write_b128 v4, v[96:99] offset:0
    v_lshlrev_b32 v185, 16, v169
    v_and_b32 v186, 0xffff0000, v173
    v_and_b32 v187, 0xffff0000, v169
    v_add_f32 v184, v184, v185
    v_add_f32 v186, v186, v187
    v_cvt_pk_bf16_f32 v173, v184, v186
    v_mfma_f32_32x32x16_bf16 v[112:127], a[228:231], v[44:47], v[112:127]
    ds_write_b128 v4, v[100:103] offset:1024
    v_lshlrev_b32 v184, 16, v174
    v_lshlrev_b32 v185, 16, v170
    v_and_b32 v186, 0xffff0000, v174
    v_and_b32 v187, 0xffff0000, v170
    v_add_f32 v184, v184, v185
    v_add_f32 v186, v186, v187
    v_mfma_f32_32x32x16_bf16 v[112:127], a[232:235], v[48:51], v[112:127]
    ds_write_b128 v4, v[104:107] offset:2048
    v_cvt_pk_bf16_f32 v174, v184, v186
    v_lshlrev_b32 v184, 16, v175
    v_lshlrev_b32 v185, 16, v171
    v_and_b32 v186, 0xffff0000, v175
    v_and_b32 v187, 0xffff0000, v171
    v_add_f32 v184, v184, v185
    v_mfma_f32_32x32x16_bf16 v[112:127], a[236:239], v[52:55], v[112:127]
    ds_write_b128 v4, v[108:111] offset:3072
    v_add_f32 v186, v186, v187
    v_cvt_pk_bf16_f32 v175, v184, v186
    s_mov_b32 s59, s55
    s_mul_i32 s55, s44, s58
    s_add_u32 s55, s55, s51
    s_nop 5
    ds_write_b128 v4, v[112:115] offset:4096
    ds_write_b128 v4, v[116:119] offset:5120
    ds_write_b128 v4, v[120:123] offset:6144
    ds_write_b128 v4, v[124:127] offset:7168
    s_waitcnt vmcnt(0)
    s_waitcnt lgkmcnt(0)
    s_barrier
    buffer_store_dwordx4 v[172:175], v7, s[4:7], s59 offen sc1
    ds_read_b128 v[184:187], v3 offset:0
    ds_read_b128 v[188:191], v3 offset:1024
    ds_read_b128 v[192:195], v3 offset:8192
    ds_read_b128 v[196:199], v3 offset:9216
    ds_read_b128 v[200:203], v3 offset:16384
    ds_read_b128 v[204:207], v3 offset:17408
    ds_read_b128 v[208:211], v3 offset:24576
    ds_read_b128 v[212:215], v3 offset:25600
    s_waitcnt lgkmcnt(5)
    v_add_f32 v184, v184, v192
    v_add_f32 v185, v185, v193
    v_add_f32 v186, v186, v194
    v_add_f32 v187, v187, v195
    s_waitcnt lgkmcnt(4)
    v_add_f32 v188, v188, v196
    v_add_f32 v189, v189, v197
    v_add_f32 v190, v190, v198
    v_add_f32 v191, v191, v199
    s_waitcnt lgkmcnt(3)
    v_add_f32 v184, v184, v200
    v_add_f32 v185, v185, v201
    v_add_f32 v186, v186, v202
    v_add_f32 v187, v187, v203
    s_waitcnt lgkmcnt(2)
    v_add_f32 v188, v188, v204
    v_add_f32 v189, v189, v205
    v_add_f32 v190, v190, v206
    v_add_f32 v191, v191, v207
    s_waitcnt lgkmcnt(1)
    v_add_f32 v184, v184, v208
    v_add_f32 v185, v185, v209
    v_add_f32 v186, v186, v210
    v_add_f32 v187, v187, v211
    s_waitcnt lgkmcnt(0)
    v_add_f32 v188, v188, v212
    v_add_f32 v189, v189, v213
    v_add_f32 v190, v190, v214
    v_add_f32 v191, v191, v215
    v_cvt_pk_bf16_f32 v172, v184, v185
    v_cvt_pk_bf16_f32 v173, v186, v187
    v_cvt_pk_bf16_f32 v174, v188, v189
    v_cvt_pk_bf16_f32 v175, v190, v191
    v_lshlrev_b32 v184, 16, v172
    v_lshlrev_b32 v185, 16, v164
    v_and_b32 v186, 0xffff0000, v172
    v_and_b32 v187, 0xffff0000, v164
    v_add_f32 v184, v184, v185
    v_add_f32 v186, v186, v187
    v_cvt_pk_bf16_f32 v172, v184, v186
    v_lshlrev_b32 v184, 16, v173
    v_lshlrev_b32 v185, 16, v165
    v_and_b32 v186, 0xffff0000, v173
    v_and_b32 v187, 0xffff0000, v165
    v_add_f32 v184, v184, v185
    v_add_f32 v186, v186, v187
    v_cvt_pk_bf16_f32 v173, v184, v186
    v_lshlrev_b32 v184, 16, v174
    v_lshlrev_b32 v185, 16, v166
    v_and_b32 v186, 0xffff0000, v174
    v_and_b32 v187, 0xffff0000, v166
    v_add_f32 v184, v184, v185
    v_add_f32 v186, v186, v187
    v_cvt_pk_bf16_f32 v174, v184, v186
    v_lshlrev_b32 v184, 16, v175
    v_lshlrev_b32 v185, 16, v167
    v_and_b32 v186, 0xffff0000, v175
    v_and_b32 v187, 0xffff0000, v167
    v_add_f32 v184, v184, v185
    v_add_f32 v186, v186, v187
    v_cvt_pk_bf16_f32 v175, v184, v186
    s_mov_b32 s59, s55
    buffer_store_dwordx4 v[172:175], v7, s[4:7], s59 offen sc1
G_148:
    s_lshl_b32 s57, s30, 1
    s_add_u32 s57, s57, 2
    s_waitcnt vmcnt(0)
    s_barrier
    s_cmp_lg_u32 s29, 0
    s_cbranch_scc1 F_151
    s_lshl_b32 s32, s28, 5
    s_add_u32 s32, s32, s29
    s_lshl_b32 s32, s32, 2
    s_add_u32 s32, s32, 1122304
    v_mov_b32 v172, s57
    s_mov_b64 exec, 1
    buffer_store_dword v172, off, s[4:7], s32 sc1
    s_mov_b64 exec, -1
F_151:
R_144:
    s_mov_b32 s68, 10
    s_mov_b32 s46, 64
    s_lshl_b32 s57, s30, 1
    s_add_u32 s57, s57, 2
LAYER_128:
    s_waitcnt vmcnt(0) lgkmcnt(0)
    s_add_u32 s44, s68, s65
    s_mul_i32 s52, s29, 10240
    s_mul_i32 s50, s30, 6291456
    s_add_u32 s50, s50, 11534336
    s_add_u32 s50, s50, s52
    s_add_u32 s49, s61, s44
    s_lshl_b32 s53, s28, 7
    s_add_u32 s53, s53, 1146880
    s_cmp_eq_u32 s29, 0
    s_cselect_b32 s53, s53, 0x40000000
    v_add_u32 v2, s52, v0
    v_add_u32 v8, 0x10000, v0
    s_lshl_b32 s34, s29, 3
    s_add_u32 s34, s34, 81920
    v_bfe_u32 v3, v1, 0, 5
    v_mul_u32_u24 v3, 32, v3
    v_add_u32 v3, s34, v3
    v_bfe_u32 v4, v1, 0, 5
    v_mul_u32_u24 v4, 32, v4
    v_add_u32 v4, 81920, v4
    s_lshl_b32 s36, s29, 8
    s_add_u32 s37, s36, 151552
    s_cmp_eq_u32 s64, 1
    s_cbranch_scc1 G1_152
    s_cmp_eq_u32 s64, 2
    s_cbranch_scc1 G1_153
    s_mul_i32 s51, s30, 34603008
    s_add_u32 s51, s51, 117440512
    s_lshl_b32 s34, s63, 14
    s_lshl_b32 s35, s29, 9
    s_add_u32 s51, s51, s34
    s_add_u32 s51, s51, s35
    s_mov_b32 s58, 524288
    s_mov_b32 s59, 256
    v_bfe_u32 v5, v1, 1, 1
    v_mul_u32_u24 v5, 2048, v5
    v_bfe_u32 v176, v1, 3, 1
    v_lshl_add_u32 v5, v176, 12, v5
    v_bfe_u32 v176, v1, 2, 1
    v_lshl_add_u32 v5, v176, 6, v5
    v_bfe_u32 v176, v1, 4, 1
    v_lshl_add_u32 v5, v176, 7, v5
    v_bfe_u32 v176, v1, 5, 1
    v_lshl_add_u32 v5, v176, 5, v5
    v_bfe_u32 v176, v1, 0, 1
    v_lshl_add_u32 v5, v176, 4, v5
    s_branch G1_154
G1_152:
    s_mul_i32 s51, s30, 34603008
    s_add_u32 s51, s51, 117448704
    s_lshl_b32 s34, s63, 14
    s_lshl_b32 s35, s29, 11
    s_add_u32 s51, s51, s34
    s_add_u32 s51, s51, s35
    s_mov_b32 s58, 524288
    s_mov_b32 s59, 512
    v_bfe_u32 v5, v1, 4, 1
    v_mul_u32_u24 v5, 1024, v5
    v_bfe_u32 v176, v1, 5, 1
    v_lshl_add_u32 v5, v176, 8, v5
    v_bfe_u32 v176, v1, 0, 4
    v_lshl_add_u32 v5, v176, 4, v5
    s_add_u32 s36, s36, 83968
    v_bfe_u32 v6, v1, 0, 2
    v_mul_u32_u24 v6, 4, v6
    v_bfe_u32 v176, v1, 2, 1
    v_lshl_add_u32 v6, v176, 5, v6
    v_bfe_u32 v176, v1, 3, 1
    v_lshl_add_u32 v6, v176, 4, v6
    v_bfe_u32 v176, v1, 4, 1
    v_lshl_add_u32 v6, v176, 6, v6
    v_add_u32 v6, s36, v6
    v_bfe_u32 v7, v1, 5, 1
    v_mul_u32_u24 v7, 32, v7
    v_add_u32 v7, s36, v7
    v_bfe_u32 v184, v1, 0, 6
    v_mul_u32_u24 v184, 4, v184
    v_add_u32 v184, s37, v184
    s_cmp_gt_u32 s49, 1
    s_cbranch_scc1 G1_156
    s_mov_b32 s34, 0x3f803f80
    v_mov_b32 v16, s34
    v_mov_b32 v17, s34
    v_mov_b32 v18, s34
    v_mov_b32 v19, s34
    s_nop 1
    v_mfma_f32_32x32x16_bf16 v[88:103], v[16:19], a[0:3], 0
    v_mfma_f32_32x32x16_bf16 v[88:103], v[16:19], a[4:7], v[88:103]
    v_mfma_f32_32x32x16_bf16 v[88:103], v[16:19], a[8:11], v[88:103]
    v_mfma_f32_32x32x16_bf16 v[88:103], v[16:19], a[12:15], v[88:103]
    v_mfma_f32_32x32x16_bf16 v[88:103], v[16:19], a[16:19], v[88:103]
    v_mfma_f32_32x32x16_bf16 v[88:103], v[16:19], a[20:23], v[88:103]
    v_mfma_f32_32x32x16_bf16 v[88:103], v[16:19], a[24:27], v[88:103]
    v_mfma_f32_32x32x16_bf16 v[88:103], v[16:19], a[28:31], v[88:103]
    v_mfma_f32_32x32x16_bf16 v[88:103], v[16:19], a[32:35], v[88:103]
    v_mfma_f32_32x32x16_bf16 v[88:103], v[16:19], a[36:39], v[88:103]
    v_mfma_f32_32x32x16_bf16 v[88:103], v[16:19], a[40:43], v[88:103]
    v_mfma_f32_32x32x16_bf16 v[88:103], v[16:19], a[44:47], v[88:103]
    v_mfma_f32_32x32x16_bf16 v[88:103], v[16:19], a[48:51], v[88:103]
    v_mfma_f32_32x32x16_bf16 v[88:103], v[16:19], a[52:55], v[88:103]
    v_mfma_f32_32x32x16_bf16 v[88:103], v[16:19], a[56:59], v[88:103]
    v_mfma_f32_32x32x16_bf16 v[88:103], v[16:19], a[60:63], v[88:103]
    v_mfma_f32_32x32x16_bf16 v[88:103], v[16:19], a[64:67], v[88:103]
    v_mfma_f32_32x32x16_bf16 v[88:103], v[16:19], a[68:71], v[88:103]
    v_mfma_f32_32x32x16_bf16 v[88:103], v[16:19], a[72:75], v[88:103]
    v_mfma_f32_32x32x16_bf16 v[88:103], v[16:19], a[76:79], v[88:103]
    v_mfma_f32_32x32x16_bf16 v[88:103], v[16:19], a[80:83], v[88:103]
    v_mfma_f32_32x32x16_bf16 v[88:103], v[16:19], a[84:87], v[88:103]
    v_mfma_f32_32x32x16_bf16 v[88:103], v[16:19], a[88:91], v[88:103]
    v_mfma_f32_32x32x16_bf16 v[88:103], v[16:19], a[92:95], v[88:103]
    v_mfma_f32_32x32x16_bf16 v[88:103], v[16:19], a[96:99], v[88:103]
    v_mfma_f32_32x32x16_bf16 v[88:103], v[16:19], a[100:103], v[88:103]
    v_mfma_f32_32x32x16_bf16 v[88:103], v[16:19], a[104:107], v[88:103]
    v_mfma_f32_32x32x16_bf16 v[88:103], v[16:19], a[108:111], v[88:103]
    v_mfma_f32_32x32x16_bf16 v[88:103], v[16:19], a[112:115], v[88:103]
    v_mfma_f32_32x32x16_bf16 v[88:103], v[16:19], a[116:119], v[88:103]
    v_mfma_f32_32x32x16_bf16 v[88:103], v[16:19], a[120:123], v[88:103]
    v_mfma_f32_32x32x16_bf16 v[88:103], v[16:19], a[124:127], v[88:103]
    v_mfma_f32_32x32x16_bf16 v[88:103], v[16:19], a[128:131], v[88:103]
    v_mfma_f32_32x32x16_bf16 v[88:103], v[16:19], a[132:135], v[88:103]
    v_mfma_f32_32x32x16_bf16 v[88:103], v[16:19], a[136:139], v[88:103]
    v_mfma_f32_32x32x16_bf16 v[88:103], v[16:19], a[140:143], v[88:103]
    v_mfma_f32_32x32x16_bf16 v[88:103], v[16:19], a[144:147], v[88:103]
    v_mfma_f32_32x32x16_bf16 v[88:103], v[16:19], a[148:151], v[88:103]
    v_mfma_f32_32x32x16_bf16 v[88:103], v[16:19], a[152:155], v[88:103]
    v_mfma_f32_32x32x16_bf16 v[88:103], v[16:19], a[156:159], v[88:103]
    s_nop 11
    ds_write_b32 v184, v88
G1_156:
    ds_read_b32 v116, v184
    s_mul_i32 s32, s29, 48
    v_min_u32 v180, 47, v1
    v_add_u32 v180, s32, v180
    v_min_u32 v180, 189, v180
    v_lshlrev_b32 v180, 7, v180
    s_mov_b32 s32, 1122304
    s_mov_b32 s48, 0
P_157:
    buffer_load_dword v176, v180, s[4:7], s32 offen sc1
    s_waitcnt vmcnt(0)
    v_cmp_gt_u32 vcc, s57, v176
    s_cbranch_vccz P_158
    s_add_u32 s48, s48, 1
    s_cmp_gt_u32 s48, 200000
    s_cbranch_scc1 L_end
    s_sleep 1
    s_branch P_157
P_158:
    s_barrier
    s_mul_i32 s54, s44, 40960
    s_add_u32 s56, s54, s52
    s_add_u32 s54, s54, s50
    s_waitcnt vmcnt(0) lgkmcnt(0)
    s_add_u32 m0, s52, 0
    s_add_u32 s35, s54, 0
    buffer_load_dwordx4 v0, s[4:7], s35 offen offset:0 sc1 lds
    buffer_load_dwordx4 v0, s[4:7], s35 offen offset:1024 sc1 lds
    buffer_load_dwordx4 v0, s[4:7], s35 offen offset:2048 sc1 lds
    buffer_load_dwordx4 v0, s[4:7], s35 offen offset:3072 sc1 lds
    s_add_u32 m0, s52, 4096
    s_add_u32 s35, s54, 4096
    buffer_load_dwordx4 v0, s[4:7], s35 offen offset:0 sc1 lds
    buffer_load_dwordx4 v0, s[4:7], s35 offen offset:1024 sc1 lds
    buffer_load_dwordx4 v0, s[4:7], s35 offen offset:2048 sc1 lds
    buffer_load_dwordx4 v0, s[4:7], s35 offen offset:3072 sc1 lds
    s_add_u32 m0, s52, 8192
    s_add_u32 s35, s54, 8192
    buffer_load_dwordx4 v0, s[4:7], s35 offen offset:0 sc1 lds
    buffer_load_dwordx4 v0, s[4:7], s35 offen offset:1024 sc1 lds
    buffer_load_dword v185, off, s[8:11], 0
    buffer_load_dword v185, off, s[8:11], 0
G1_159:
    v_mov_b64 v[104:105], 0
    s_mov_b32 s34, 0x3f803f80
    s_waitcnt vmcnt(10)
    ds_read_b128 v[16:19], v2 offset:0
    ds_read_b128 v[20:23], v2 offset:1024
    s_waitcnt vmcnt(8)
    ds_read_b128 v[24:27], v2 offset:2048
    ds_read_b128 v[28:31], v2 offset:3072
    s_waitcnt vmcnt(6)
    ds_read_b128 v[32:35], v2 offset:4096
    ds_read_b128 v[36:39], v2 offset:5120
    s_waitcnt lgkmcnt(5)
    v_dot2c_f32_bf16 v104, s34, v16
    v_dot2c_f32_bf16 v105, v16, v16
    v_dot2c_f32_bf16 v104, s34, v17
    v_dot2c_f32_bf16 v105, v17, v17
    v_dot2c_f32_bf16 v104, s34, v18
    v_dot2c_f32_bf16 v105, v18, v18
    v_dot2c_f32_bf16 v104, s34, v19
    v_dot2c_f32_bf16 v105, v19, v19
    s_waitcnt lgkmcnt(4)
    v_dot2c_f32_bf16 v104, s34, v20
    v_dot2c_f32_bf16 v105, v20, v20
    v_dot2c_f32_bf16 v104, s34, v21
    v_dot2c_f32_bf16 v105, v21, v21
    v_dot2c_f32_bf16 v104, s34, v22
    v_dot2c_f32_bf16 v105, v22, v22
    v_dot2c_f32_bf16 v104, s34, v23
    v_dot2c_f32_bf16 v105, v23, v23
    s_waitcnt vmcnt(4)
    ds_read_b128 v[40:43], v2 offset:6144
    ds_read_b128 v[44:47], v2 offset:7168
    s_waitcnt lgkmcnt(5)
    v_dot2c_f32_bf16 v104, s34, v24
    v_dot2c_f32_bf16 v105, v24, v24
    v_dot2c_f32_bf16 v104, s34, v25
    v_dot2c_f32_bf16 v105, v25, v25
    v_dot2c_f32_bf16 v104, s34, v26
    v_dot2c_f32_bf16 v105, v26, v26
    v_dot2c_f32_bf16 v104, s34, v27
    v_dot2c_f32_bf16 v105, v27, v27
    s_waitcnt lgkmcnt(4)
    v_dot2c_f32_bf16 v104, s34, v28
    v_dot2c_f32_bf16 v105, v28, v28
    v_dot2c_f32_bf16 v104, s34, v29
    v_dot2c_f32_bf16 v105, v29, v29
    v_dot2c_f32_bf16 v104, s34, v30
    v_dot2c_f32_bf16 v105, v30, v30
    v_dot2c_f32_bf16 v104, s34, v31
    v_dot2c_f32_bf16 v105, v31, v31
    s_waitcnt vmcnt(2)
    ds_read_b128 v[48:51], v2 offset:8192
    ds_read_b128 v[52:55], v2 offset:9216
    s_waitcnt lgkmcnt(5)
    v_dot2c_f32_bf16 v104, s34, v32
    v_dot2c_f32_bf16 v105, v32, v32
    v_dot2c_f32_bf16 v104, s34, v33
    v_dot2c_f32_bf16 v105, v33, v33
    v_dot2c_f32_bf16 v104, s34, v34
    v_dot2c_f32_bf16 v105, v34, v34
    v_dot2c_f32_bf16 v104, s34, v35
    v_dot2c_f32_bf16 v105, v35, v35
    s_waitcnt lgkmcnt(4)
    v_dot2c_f32_bf16 v104, s34, v36
    v_dot2c_f32_bf16 v105, v36, v36
    v_dot2c_f32_bf16 v104, s34, v37
    v_dot2c_f32_bf16 v105, v37, v37
    v_dot2c_f32_bf16 v104, s34, v38
    v_dot2c_f32_bf16 v105, v38, v38
    v_dot2c_f32_bf16 v104, s34, v39
    v_dot2c_f32_bf16 v105, v39, v39
    s_waitcnt lgkmcnt(3)
    v_dot2c_f32_bf16 v104, s34, v40
    v_dot2c_f32_bf16 v105, v40, v40
    v_dot2c_f32_bf16 v104, s34, v41
    v_dot2c_f32_bf16 v105, v41, v41
    v_dot2c_f32_bf16 v104, s34, v42
    v_dot2c_f32_bf16 v105, v42, v42
    v_dot2c_f32_bf16 v104, s34, v43
    v_dot2c_f32_bf16 v105, v43, v43
    s_waitcnt lgkmcnt(2)
    v_dot2c_f32_bf16 v104, s34, v44
    v_dot2c_f32_bf16 v105, v44, v44
    v_dot2c_f32_bf16 v104, s34, v45
    v_dot2c_f32_bf16 v105, v45, v45
    v_dot2c_f32_bf16 v104, s34, v46
    v_dot2c_f32_bf16 v105, v46, v46
    v_dot2c_f32_bf16 v104, s34, v47
    v_dot2c_f32_bf16 v105, v47, v47
    s_waitcnt lgkmcnt(1)
    v_dot2c_f32_bf16 v104, s34, v48
    v_dot2c_f32_bf16 v105, v48, v48
    v_dot2c_f32_bf16 v104, s34, v49
    v_dot2c_f32_bf16 v105, v49, v49
    v_dot2c_f32_bf16 v104, s34, v50
    v_dot2c_f32_bf16 v105, v50, v50
    v_dot2c_f32_bf16 v104, s34, v51
    v_dot2c_f32_bf16 v105, v51, v51
    s_waitcnt lgkmcnt(0)
    v_dot2c_f32_bf16 v104, s34, v52
    v_dot2c_f32_bf16 v105, v52, v52
    v_dot2c_f32_bf16 v104, s34, v53
    v_dot2c_f32_bf16 v105, v53, v53
    v_dot2c_f32_bf16 v104, s34, v54
    v_dot2c_f32_bf16 v105, v54, v54
    v_dot2c_f32_bf16 v104, s34, v55
    v_dot2c_f32_bf16 v105, v55, v55
    s_nop 2
    v_mov_b64 v[106:107], v[104:105]
    s_nop 1
    v_permlane32_swap_b32 v104, v106
    v_permlane32_swap_b32 v105, v107
    v_pk_add_f32 v[104:105], v[104:105], v[106:107]
    ds_write_b64 v3, v[104:105] offset:0
    v_mov_b32 v172, s49
    s_add_u32 s45, s44, 2
    s_mul_i32 s54, s45, 40960
    s_add_u32 s56, s54, s52
    s_add_u32 s54, s54, s50
    s_cmp_lt_u32 s45, s46
    s_cselect_b32 s54, s54, 0x40000000
    s_waitcnt vmcnt(0) lgkmcnt(0)
    s_barrier
    s_mov_b64 exec, 1
    buffer_store_dword v172, off, s[4:7], s53 sc1
    s_mov_b64 exec, -1
    ds_read_b128 v[56:59], v0 offset:0
    ds_read_b128 v[60:63], v0 offset:1024
    ds_read_b128 v[64:67], v0 offset:2048
    ds_read_b128 v[68:71], v0 offset:3072
    ds_read_b128 v[106:109], v4 offset:0
    ds_read_b128 v[110:113], v4 offset:16
    s_waitcnt lgkmcnt(5)
    v_mfma_f32_32x32x16_bf16 v[88:103], v[56:59], a[0:3], 0
    ds_read_b128 v[72:75], v0 offset:4096
    s_waitcnt lgkmcnt(5)
    v_mfma_f32_32x32x16_bf16 v[88:103], v[60:63], a[4:7], v[88:103]
    ds_read_b128 v[76:79], v0 offset:5120
    s_add_u32 m0, s52, 40960
    s_add_u32 s35, s54, 0
    buffer_load_dwordx4 v0, s[4:7], s35 offen offset:0 sc1 lds
    s_waitcnt lgkmcnt(5)
    v_mfma_f32_32x32x16_bf16 v[88:103], v[64:67], a[8:11], v[88:103]
    ds_read_b128 v[80:83], v0 offset:6144
    s_waitcnt lgkmcnt(5)
    v_mfma_f32_32x32x16_bf16 v[88:103], v[68:71], a[12:15], v[88:103]
    ds_read_b128 v[84:87], v0 offset:7168
    buffer_load_dwordx4 v0, s[4:7], s35 offen offset:1024 sc1 lds
    s_waitcnt lgkmcnt(3)
    v_mfma_f32_32x32x16_bf16 v[88:103], v[72:75], a[16:19], v[88:103]
    ds_read_b128 v[56:59], v0 offset:8192
    s_waitcnt lgkmcnt(3)
    v_mfma_f32_32x32x16_bf16 v[88:103], v[76:79], a[20:23], v[88:103]
    ds_read_b128 v[60:63], v0 offset:9216
    buffer_load_dwordx4 v0, s[4:7], s35 offen offset:2048 sc1 lds
    s_waitcnt lgkmcnt(3)
    v_mfma_f32_32x32x16_bf16 v[88:103], v[80:83], a[24:27], v[88:103]
    ds_read_b128 v[64:67], v0 offset:10240
    s_waitcnt lgkmcnt(3)
    v_mfma_f32_32x32x16_bf16 v[88:103], v[84:87], a[28:31], v[88:103]
    ds_read_b128 v[68:71], v0 offset:11264
    buffer_load_dwordx4 v0, s[4:7], s35 offen offset:3072 sc1 lds
    s_waitcnt lgkmcnt(3)
    v_mfma_f32_32x32x16_bf16 v[88:103], v[56:59], a[32:35], v[88:103]
    ds_read_b128 v[72:75], v0 offset:12288
    s_waitcnt lgkmcnt(3)
    v_mfma_f32_32x32x16_bf16 v[88:103], v[60:63], a[36:39], v[88:103]
    ds_read_b128 v[76:79], v0 offset:13312
    s_add_u32 m0, s52, 45056
    s_add_u32 s35, s54, 4096
    buffer_load_dwordx4 v0, s[4:7], s35 offen offset:0 sc1 lds
    s_waitcnt lgkmcnt(3)
    v_mfma_f32_32x32x16_bf16 v[88:103], v[64:67], a[40:43], v[88:103]
    ds_read_b128 v[80:83], v0 offset:14336
    s_waitcnt lgkmcnt(3)
    v_mfma_f32_32x32x16_bf16 v[88:103], v[68:71], a[44:47], v[88:103]
    ds_read_b128 v[84:87], v0 offset:15360
    buffer_load_dwordx4 v0, s[4:7], s35 offen offset:1024 sc1 lds
    s_waitcnt lgkmcnt(3)
    v_mfma_f32_32x32x16_bf16 v[88:103], v[72:75], a[48:51], v[88:103]
    ds_read_b128 v[56:59], v0 offset:16384
    s_waitcnt lgkmcnt(3)
    v_mfma_f32_32x32x16_bf16 v[88:103], v[76:79], a[52:55], v[88:103]
    ds_read_b128 v[60:63], v0 offset:17408
    buffer_load_dwordx4 v0, s[4:7], s35 offen offset:2048 sc1 lds
    s_waitcnt lgkmcnt(3)
    v_mfma_f32_32x32x16_bf16 v[88:103], v[80:83], a[56:59], v[88:103]
    ds_read_b128 v[64:67], v0 offset:18432
    s_waitcnt lgkmcnt(3)
    v_mfma_f32_32x32x16_bf16 v[88:103], v[84:87], a[60:63], v[88:103]
    ds_read_b128 v[68:71], v0 offset:19456
    buffer_load_dwordx4 v0, s[4:7], s35 offen offset:3072 sc1 lds
    s_waitcnt lgkmcnt(3)
    v_mfma_f32_32x32x16_bf16 v[88:103], v[56:59], a[64:67], v[88:103]
    ds_read_b128 v[72:75], v0 offset:20480
    s_waitcnt lgkmcnt(3)
    v_mfma_f32_32x32x16_bf16 v[88:103], v[60:63], a[68:71], v[88:103]
    ds_read_b128 v[76:79], v0 offset:21504
    s_add_u32 m0, s52, 49152
    s_add_u32 s35, s54, 8192
    buffer_load_dwordx4 v0, s[4:7], s35 offen offset:0 sc1 lds
    s_waitcnt lgkmcnt(3)
    v_mfma_f32_32x32x16_bf16 v[88:103], v[64:67], a[72:75], v[88:103]
    ds_read_b128 v[80:83], v0 offset:22528
    s_waitcnt lgkmcnt(3)
    v_mfma_f32_32x32x16_bf16 v[88:103], v[68:71], a[76:79], v[88:103]
    ds_read_b128 v[84:87], v0 offset:23552
    buffer_load_dwordx4 v0, s[4:7], s35 offen offset:1024 sc1 lds
    s_waitcnt lgkmcnt(3)
    v_mfma_f32_32x32x16_bf16 v[88:103], v[72:75], a[80:83], v[88:103]
    ds_read_b128 v[56:59], v0 offset:24576
    v_add_f32 v106, v106, v108
    v_add_f32 v107, v107, v109
    s_waitcnt lgkmcnt(3)
    v_mfma_f32_32x32x16_bf16 v[88:103], v[76:79], a[84:87], v[88:103]
    ds_read_b128 v[60:63], v0 offset:25600
    v_add_f32 v106, v106, v110
    v_add_f32 v107, v107, v111
    s_waitcnt lgkmcnt(3)
    v_mfma_f32_32x32x16_bf16 v[88:103], v[80:83], a[88:91], v[88:103]
    ds_read_b128 v[64:67], v0 offset:26624
    v_add_f32 v106, v106, v112
    v_add_f32 v107, v107, v113
    s_waitcnt lgkmcnt(3)
    v_mfma_f32_32x32x16_bf16 v[88:103], v[84:87], a[92:95], v[88:103]
    ds_read_b128 v[68:71], v0 offset:27648
    v_mul_f32 v106, 0x3acccccd, v106
    v_mul_f32 v107, 0x3acccccd, v107
    s_waitcnt lgkmcnt(3)
    v_mfma_f32_32x32x16_bf16 v[88:103], v[56:59], a[96:99], v[88:103]
    ds_read_b128 v[72:75], v0 offset:28672
    v_fma_f32 v107, -v106, v106, v107
    v_max_f32 v107, 0, v107
    s_waitcnt lgkmcnt(3)
    v_mfma_f32_32x32x16_bf16 v[88:103], v[60:63], a[100:103], v[88:103]
    ds_read_b128 v[76:79], v0 offset:29696
    v_add_f32 v107, 0x3727c5ac, v107
    v_rsq_f32 v107, v107
    s_waitcnt lgkmcnt(3)
    v_mfma_f32_32x32x16_bf16 v[88:103], v[64:67], a[104:107], v[88:103]
    ds_read_b128 v[80:83], v0 offset:30720
    ds_write2_b32 v6, v106, v107 offset0:0 offset1:32
    ds_read_b128 v[132:135], v7 offset:0
    s_waitcnt lgkmcnt(5)
    v_mfma_f32_32x32x16_bf16 v[88:103], v[68:71], a[108:111], v[88:103]
    ds_read_b128 v[84:87], v0 offset:31744
    ds_read_b128 v[136:139], v7 offset:16
    ds_read_b128 v[140:143], v7 offset:64
    s_waitcnt lgkmcnt(7)
    v_mfma_f32_32x32x16_bf16 v[88:103], v[72:75], a[112:115], v[88:103]
    ds_read_b128 v[56:59], v0 offset:32768
    ds_read_b128 v[144:147], v7 offset:80
    ds_read_b128 v[148:151], v7 offset:128
    s_waitcnt lgkmcnt(9)
    v_mfma_f32_32x32x16_bf16 v[88:103], v[76:79], a[116:119], v[88:103]
    ds_read_b128 v[60:63], v0 offset:33792
    ds_read_b128 v[152:155], v7 offset:144
    ds_read_b128 v[156:159], v7 offset:192
    s_waitcnt lgkmcnt(11)
    v_mfma_f32_32x32x16_bf16 v[88:103], v[80:83], a[120:123], v[88:103]
    ds_read_b128 v[64:67], v0 offset:34816
    ds_read_b128 v[160:163], v7 offset:208
    s_waitcnt lgkmcnt(10)
    v_mfma_f32_32x32x16_bf16 v[88:103], v[84:87], a[124:127], v[88:103]
    ds_read_b128 v[68:71], v0 offset:35840
    s_waitcnt lgkmcnt(8)
    v_mfma_f32_32x32x16_bf16 v[88:103], v[56:59], a[128:131], v[88:103]
    ds_read_b128 v[72:75], v0 offset:36864
    s_waitcnt lgkmcnt(6)
    v_mfma_f32_32x32x16_bf16 v[88:103], v[60:63], a[132:135], v[88:103]
    ds_read_b128 v[76:79], v0 offset:37888
    s_waitcnt lgkmcnt(4)
    v_mfma_f32_32x32x16_bf16 v[88:103], v[64:67], a[136:139], v[88:103]
    ds_read_b128 v[80:83], v0 offset:38912
    s_waitcnt lgkmcnt(3)
    v_mfma_f32_32x32x16_bf16 v[88:103], v[68:71], a[140:143], v[88:103]
    ds_read_b128 v[84:87], v0 offset:39936
    s_waitcnt lgkmcnt(3)
    v_mfma_f32_32x32x16_bf16 v[88:103], v[72:75], a[144:147], v[88:103]
    s_waitcnt lgkmcnt(2)
    v_mfma_f32_32x32x16_bf16 v[88:103], v[76:79], a[148:151], v[88:103]
    s_waitcnt lgkmcnt(1)
    v_mfma_f32_32x32x16_bf16 v[88:103], v[80:83], a[152:155], v[88:103]
    s_waitcnt lgkmcnt(0)
    v_mfma_f32_32x32x16_bf16 v[88:103], v[84:87], a[156:159], v[88:103]
    s_mul_i32 s55, s44, s58
    s_add_u32 s55, s55, s51
    s_add_u32 s35, s55, s59
    s_add_u32 s49, s45, s61
    s_mov_b32 s44, s45
    s_nop 6
    v_pk_fma_f32 v[88:89], v[132:133], v[116:117], v[88:89] op_sel_hi:[1,0,1] neg_lo:[1,0,0] neg_hi:[1,0,0]
    s_nop 0
    v_pk_mul_f32 v[88:89], v[88:89], v[148:149]
    v_pk_fma_f32 v[90:91], v[134:135], v[116:117], v[90:91] op_sel_hi:[1,0,1] neg_lo:[1,0,0] neg_hi:[1,0,0]
    s_nop 0
    v_pk_mul_f32 v[90:91], v[90:91], v[150:151]
    v_pk_fma_f32 v[92:93], v[136:137], v[116:117], v[92:93] op_sel_hi:[1,0,1] neg_lo:[1,0,0] neg_hi:[1,0,0]
    s_nop 0
    v_pk_mul_f32 v[92:93], v[92:93], v[152:153]
    v_pk_fma_f32 v[94:95], v[138:139], v[116:117], v[94:95] op_sel_hi:[1,0,1] neg_lo:[1,0,0] neg_hi:[1,0,0]
    s_nop 0
    v_pk_mul_f32 v[94:95], v[94:95], v[154:155]
    v_pk_fma_f32 v[96:97], v[140:141], v[116:117], v[96:97] op_sel_hi:[1,0,1] neg_lo:[1,0,0] neg_hi:[1,0,0]
    s_nop 0
    v_pk_mul_f32 v[96:97], v[96:97], v[156:157]
    v_pk_fma_f32 v[98:99], v[142:143], v[116:117], v[98:99] op_sel_hi:[1,0,1] neg_lo:[1,0,0] neg_hi:[1,0,0]
    s_nop 0
    v_pk_mul_f32 v[98:99], v[98:99], v[158:159]
    v_pk_fma_f32 v[100:101], v[144:145], v[116:117], v[100:101] op_sel_hi:[1,0,1] neg_lo:[1,0,0] neg_hi:[1,0,0]
    s_nop 0
    v_pk_mul_f32 v[100:101], v[100:101], v[160:161]
    v_pk_fma_f32 v[102:103], v[146:147], v[116:117], v[102:103] op_sel_hi:[1,0,1] neg_lo:[1,0,0] neg_hi:[1,0,0]
    s_nop 0
    v_pk_mul_f32 v[102:103], v[102:103], v[162:163]
    v_cvt_pk_bf16_f32 v164, v88, v89
    v_cvt_pk_bf16_f32 v165, v90, v91
    v_cvt_pk_bf16_f32 v166, v92, v93
    v_cvt_pk_bf16_f32 v167, v94, v95
    v_cvt_pk_bf16_f32 v168, v96, v97
    v_cvt_pk_bf16_f32 v169, v98, v99
    v_cvt_pk_bf16_f32 v170, v100, v101
    v_cvt_pk_bf16_f32 v171, v102, v103
    buffer_store_dwordx4 v[164:167], v5, s[4:7], s55 offen sc1
    buffer_store_dwordx4 v[168:171], v5, s[4:7], s35 offen sc1
    s_cmp_lt_u32 s44, s46
    s_cbranch_scc0 G1_155
    v_mov_b64 v[104:105], 0
    s_mov_b32 s34, 0x3f803f80
    s_waitcnt vmcnt(10)
    ds_read_b128 v[16:19], v2 offset:40960
    ds_read_b128 v[20:23], v2 offset:41984
    s_waitcnt vmcnt(8)
    ds_read_b128 v[24:27], v2 offset:43008
    ds_read_b128 v[28:31], v2 offset:44032
    s_waitcnt vmcnt(6)
    ds_read_b128 v[32:35], v2 offset:45056
    ds_read_b128 v[36:39], v2 offset:46080
    s_waitcnt lgkmcnt(5)
    v_dot2c_f32_bf16 v104, s34, v16
    v_dot2c_f32_bf16 v105, v16, v16
    v_dot2c_f32_bf16 v104, s34, v17
    v_dot2c_f32_bf16 v105, v17, v17
    v_dot2c_f32_bf16 v104, s34, v18
    v_dot2c_f32_bf16 v105, v18, v18
    v_dot2c_f32_bf16 v104, s34, v19
    v_dot2c_f32_bf16 v105, v19, v19
    s_waitcnt lgkmcnt(4)
    v_dot2c_f32_bf16 v104, s34, v20
    v_dot2c_f32_bf16 v105, v20, v20
    v_dot2c_f32_bf16 v104, s34, v21
    v_dot2c_f32_bf16 v105, v21, v21
    v_dot2c_f32_bf16 v104, s34, v22
    v_dot2c_f32_bf16 v105, v22, v22
    v_dot2c_f32_bf16 v104, s34, v23
    v_dot2c_f32_bf16 v105, v23, v23
    s_waitcnt vmcnt(4)
    ds_read_b128 v[40:43], v2 offset:47104
    ds_read_b128 v[44:47], v2 offset:48128
    s_waitcnt lgkmcnt(5)
    v_dot2c_f32_bf16 v104, s34, v24
    v_dot2c_f32_bf16 v105, v24, v24
    v_dot2c_f32_bf16 v104, s34, v25
    v_dot2c_f32_bf16 v105, v25, v25
    v_dot2c_f32_bf16 v104, s34, v26
    v_dot2c_f32_bf16 v105, v26, v26
    v_dot2c_f32_bf16 v104, s34, v27
    v_dot2c_f32_bf16 v105, v27, v27
    s_waitcnt lgkmcnt(4)
    v_dot2c_f32_bf16 v104, s34, v28
    v_dot2c_f32_bf16 v105, v28, v28
    v_dot2c_f32_bf16 v104, s34, v29
    v_dot2c_f32_bf16 v105, v29, v29
    v_dot2c_f32_bf16 v104, s34, v30
    v_dot2c_f32_bf16 v105, v30, v30
    v_dot2c_f32_bf16 v104, s34, v31
    v_dot2c_f32_bf16 v105, v31, v31
    s_waitcnt vmcnt(2)
    ds_read_b128 v[48:51], v2 offset:49152
    ds_read_b128 v[52:55], v2 offset:50176
    s_waitcnt lgkmcnt(5)
    v_dot2c_f32_bf16 v104, s34, v32
    v_dot2c_f32_bf16 v105, v32, v32
    v_dot2c_f32_bf16 v104, s34, v33
    v_dot2c_f32_bf16 v105, v33, v33
    v_dot2c_f32_bf16 v104, s34, v34
    v_dot2c_f32_bf16 v105, v34, v34
    v_dot2c_f32_bf16 v104, s34, v35
    v_dot2c_f32_bf16 v105, v35, v35
    s_waitcnt lgkmcnt(4)
    v_dot2c_f32_bf16 v104, s34, v36
    v_dot2c_f32_bf16 v105, v36, v36
    v_dot2c_f32_bf16 v104, s34, v37
    v_dot2c_f32_bf16 v105, v37, v37
    v_dot2c_f32_bf16 v104, s34, v38
    v_dot2c_f32_bf16 v105, v38, v38
    v_dot2c_f32_bf16 v104, s34, v39
    v_dot2c_f32_bf16 v105, v39, v39
    s_waitcnt lgkmcnt(3)
    v_dot2c_f32_bf16 v104, s34, v40
    v_dot2c_f32_bf16 v105, v40, v40
    v_dot2c_f32_bf16 v104, s34, v41
    v_dot2c_f32_bf16 v105, v41, v41
    v_dot2c_f32_bf16 v104, s34, v42
    v_dot2c_f32_bf16 v105, v42, v42
    v_dot2c_f32_bf16 v104, s34, v43
    v_dot2c_f32_bf16 v105, v43, v43
    s_waitcnt lgkmcnt(2)
    v_dot2c_f32_bf16 v104, s34, v44
    v_dot2c_f32_bf16 v105, v44, v44
    v_dot2c_f32_bf16 v104, s34, v45
    v_dot2c_f32_bf16 v105, v45, v45
    v_dot2c_f32_bf16 v104, s34, v46
    v_dot2c_f32_bf16 v105, v46, v46
    v_dot2c_f32_bf16 v104, s34, v47
    v_dot2c_f32_bf16 v105, v47, v47
    s_waitcnt lgkmcnt(1)
    v_dot2c_f32_bf16 v104, s34, v48
    v_dot2c_f32_bf16 v105, v48, v48
    v_dot2c_f32_bf16 v104, s34, v49
    v_dot2c_f32_bf16 v105, v49, v49
    v_dot2c_f32_bf16 v104, s34, v50
    v_dot2c_f32_bf16 v105, v50, v50
    v_dot2c_f32_bf16 v104, s34, v51
    v_dot2c_f32_bf16 v105, v51, v51
    s_waitcnt lgkmcnt(0)
    v_dot2c_f32_bf16 v104, s34, v52
    v_dot2c_f32_bf16 v105, v52, v52
    v_dot2c_f32_bf16 v104, s34, v53
    v_dot2c_f32_bf16 v105, v53, v53
    v_dot2c_f32_bf16 v104, s34, v54
    v_dot2c_f32_bf16 v105, v54, v54
    v_dot2c_f32_bf16 v104, s34, v55
    v_dot2c_f32_bf16 v105, v55, v55
    s_nop 2
    v_mov_b64 v[106:107], v[104:105]
    s_nop 1
    v_permlane32_swap_b32 v104, v106
    v_permlane32_swap_b32 v105, v107
    v_pk_add_f32 v[104:105], v[104:105], v[106:107]
    ds_write_b64 v3, v[104:105] offset:1024
    v_mov_b32 v172, s49
    s_add_u32 s45, s44, 2
    s_mul_i32 s54, s45, 40960
    s_add_u32 s56, s54, s52
    s_add_u32 s54, s54, s50
    s_cmp_lt_u32 s45, s46
    s_cselect_b32 s54, s54, 0x40000000
    s_waitcnt vmcnt(0) lgkmcnt(0)
    s_barrier
    s_mov_b64 exec, 1
    buffer_store_dword v172, off, s[4:7], s53 sc1
    s_mov_b64 exec, -1
    ds_read_b128 v[56:59], v0 offset:40960
    ds_read_b128 v[60:63], v0 offset:41984
    ds_read_b128 v[64:67], v0 offset:43008
    ds_read_b128 v[68:71], v0 offset:44032
    ds_read_b128 v[106:109], v4 offset:1024
    ds_read_b128 v[110:113], v4 offset:1040
    s_waitcnt lgkmcnt(5)
    v_mfma_f32_32x32x16_bf16 v[88:103], v[56:59], a[0:3], 0
    ds_read_b128 v[72:75], v0 offset:45056
    s_waitcnt lgkmcnt(5)
    v_mfma_f32_32x32x16_bf16 v[88:103], v[60:63], a[4:7], v[88:103]
    ds_read_b128 v[76:79], v0 offset:46080
    s_add_u32 m0, s52, 0
    s_add_u32 s35, s54, 0
    buffer_load_dwordx4 v0, s[4:7], s35 offen offset:0 sc1 lds
    s_waitcnt lgkmcnt(5)
    v_mfma_f32_32x32x16_bf16 v[88:103], v[64:67], a[8:11], v[88:103]
    ds_read_b128 v[80:83], v0 offset:47104
    s_waitcnt lgkmcnt(5)
    v_mfma_f32_32x32x16_bf16 v[88:103], v[68:71], a[12:15], v[88:103]
    ds_read_b128 v[84:87], v0 offset:48128
    buffer_load_dwordx4 v0, s[4:7], s35 offen offset:1024 sc1 lds
    s_waitcnt lgkmcnt(3)
    v_mfma_f32_32x32x16_bf16 v[88:103], v[72:75], a[16:19], v[88:103]
    ds_read_b128 v[56:59], v0 offset:49152
    s_waitcnt lgkmcnt(3)
    v_mfma_f32_32x32x16_bf16 v[88:103], v[76:79], a[20:23], v[88:103]
    ds_read_b128 v[60:63], v0 offset:50176
    buffer_load_dwordx4 v0, s[4:7], s35 offen offset:2048 sc1 lds
    s_waitcnt lgkmcnt(3)
    v_mfma_f32_32x32x16_bf16 v[88:103], v[80:83], a[24:27], v[88:103]
    ds_read_b128 v[64:67], v0 offset:51200
    s_waitcnt lgkmcnt(3)
    v_mfma_f32_32x32x16_bf16 v[88:103], v[84:87], a[28:31], v[88:103]
    ds_read_b128 v[68:71], v0 offset:52224
    buffer_load_dwordx4 v0, s[4:7], s35 offen offset:3072 sc1 lds
    s_waitcnt lgkmcnt(3)
    v_mfma_f32_32x32x16_bf16 v[88:103], v[56:59], a[32:35], v[88:103]
    ds_read_b128 v[72:75], v0 offset:53248
    s_waitcnt lgkmcnt(3)
    v_mfma_f32_32x32x16_bf16 v[88:103], v[60:63], a[36:39], v[88:103]
    ds_read_b128 v[76:79], v0 offset:54272
    s_add_u32 m0, s52, 4096
    s_add_u32 s35, s54, 4096
    buffer_load_dwordx4 v0, s[4:7], s35 offen offset:0 sc1 lds
    s_waitcnt lgkmcnt(3)
    v_mfma_f32_32x32x16_bf16 v[88:103], v[64:67], a[40:43], v[88:103]
    ds_read_b128 v[80:83], v0 offset:55296
    s_waitcnt lgkmcnt(3)
    v_mfma_f32_32x32x16_bf16 v[88:103], v[68:71], a[44:47], v[88:103]
    ds_read_b128 v[84:87], v0 offset:56320
    buffer_load_dwordx4 v0, s[4:7], s35 offen offset:1024 sc1 lds
    s_waitcnt lgkmcnt(3)
    v_mfma_f32_32x32x16_bf16 v[88:103], v[72:75], a[48:51], v[88:103]
    ds_read_b128 v[56:59], v0 offset:57344
    s_waitcnt lgkmcnt(3)
    v_mfma_f32_32x32x16_bf16 v[88:103], v[76:79], a[52:55], v[88:103]
    ds_read_b128 v[60:63], v0 offset:58368
    buffer_load_dwordx4 v0, s[4:7], s35 offen offset:2048 sc1 lds
    s_waitcnt lgkmcnt(3)
    v_mfma_f32_32x32x16_bf16 v[88:103], v[80:83], a[56:59], v[88:103]
    ds_read_b128 v[64:67], v0 offset:59392
    s_waitcnt lgkmcnt(3)
    v_mfma_f32_32x32x16_bf16 v[88:103], v[84:87], a[60:63], v[88:103]
    ds_read_b128 v[68:71], v0 offset:60416
    buffer_load_dwordx4 v0, s[4:7], s35 offen offset:3072 sc1 lds
    s_waitcnt lgkmcnt(3)
    v_mfma_f32_32x32x16_bf16 v[88:103], v[56:59], a[64:67], v[88:103]
    ds_read_b128 v[72:75], v0 offset:61440
    s_waitcnt lgkmcnt(3)
    v_mfma_f32_32x32x16_bf16 v[88:103], v[60:63], a[68:71], v[88:103]
    ds_read_b128 v[76:79], v0 offset:62464
    s_add_u32 m0, s52, 8192
    s_add_u32 s35, s54, 8192
    buffer_load_dwordx4 v0, s[4:7], s35 offen offset:0 sc1 lds
    s_waitcnt lgkmcnt(3)
    v_mfma_f32_32x32x16_bf16 v[88:103], v[64:67], a[72:75], v[88:103]
    ds_read_b128 v[80:83], v0 offset:63488
    s_waitcnt lgkmcnt(3)
    v_mfma_f32_32x32x16_bf16 v[88:103], v[68:71], a[76:79], v[88:103]
    ds_read_b128 v[84:87], v0 offset:64512
    buffer_load_dwordx4 v0, s[4:7], s35 offen offset:1024 sc1 lds
    s_waitcnt lgkmcnt(3)
    v_mfma_f32_32x32x16_bf16 v[88:103], v[72:75], a[80:83], v[88:103]
    ds_read_b128 v[56:59], v8 offset:0
    v_add_f32 v106, v106, v108
    v_add_f32 v107, v107, v109
    s_waitcnt lgkmcnt(3)
    v_mfma_f32_32x32x16_bf16 v[88:103], v[76:79], a[84:87], v[88:103]
    ds_read_b128 v[60:63], v8 offset:1024
    v_add_f32 v106, v106, v110
    v_add_f32 v107, v107, v111
    s_waitcnt lgkmcnt(3)
    v_mfma_f32_32x32x16_bf16 v[88:103], v[80:83], a[88:91], v[88:103]
    ds_read_b128 v[64:67], v8 offset:2048
    v_add_f32 v106, v106, v112
    v_add_f32 v107, v107, v113
    s_waitcnt lgkmcnt(3)
    v_mfma_f32_32x32x16_bf16 v[88:103], v[84:87], a[92:95], v[88:103]
    ds_read_b128 v[68:71], v8 offset:3072
    v_mul_f32 v106, 0x3acccccd, v106
    v_mul_f32 v107, 0x3acccccd, v107
    s_waitcnt lgkmcnt(3)
    v_mfma_f32_32x32x16_bf16 v[88:103], v[56:59], a[96:99], v[88:103]
    ds_read_b128 v[72:75], v8 offset:4096
    v_fma_f32 v107, -v106, v106, v107
    v_max_f32 v107, 0, v107
    s_waitcnt lgkmcnt(3)
    v_mfma_f32_32x32x16_bf16 v[88:103], v[60:63], a[100:103], v[88:103]
    ds_read_b128 v[76:79], v8 offset:5120
    v_add_f32 v107, 0x3727c5ac, v107
    v_rsq_f32 v107, v107
    s_waitcnt lgkmcnt(3)
    v_mfma_f32_32x32x16_bf16 v[88:103], v[64:67], a[104:107], v[88:103]
    ds_read_b128 v[80:83], v8 offset:6144
    ds_write2_b32 v6, v106, v107 offset0:0 offset1:32
    ds_read_b128 v[132:135], v7 offset:0
    s_waitcnt lgkmcnt(5)
    v_mfma_f32_32x32x16_bf16 v[88:103], v[68:71], a[108:111], v[88:103]
    ds_read_b128 v[84:87], v8 offset:7168
    ds_read_b128 v[136:139], v7 offset:16
    ds_read_b128 v[140:143], v7 offset:64
    s_waitcnt lgkmcnt(7)
    v_mfma_f32_32x32x16_bf16 v[88:103], v[72:75], a[112:115], v[88:103]
    ds_read_b128 v[56:59], v8 offset:8192
    ds_read_b128 v[144:147], v7 offset:80
    ds_read_b128 v[148:151], v7 offset:128
    s_waitcnt lgkmcnt(9)
    v_mfma_f32_32x32x16_bf16 v[88:103], v[76:79], a[116:119], v[88:103]
    ds_read_b128 v[60:63], v8 offset:9216
    ds_read_b128 v[152:155], v7 offset:144
    ds_read_b128 v[156:159], v7 offset:192
    s_waitcnt lgkmcnt(11)
    v_mfma_f32_32x32x16_bf16 v[88:103], v[80:83], a[120:123], v[88:103]
    ds_read_b128 v[64:67], v8 offset:10240
    ds_read_b128 v[160:163], v7 offset:208
    s_waitcnt lgkmcnt(10)
    v_mfma_f32_32x32x16_bf16 v[88:103], v[84:87], a[124:127], v[88:103]
    ds_read_b128 v[68:71], v8 offset:11264
    s_waitcnt lgkmcnt(8)
    v_mfma_f32_32x32x16_bf16 v[88:103], v[56:59], a[128:131], v[88:103]
    ds_read_b128 v[72:75], v8 offset:12288
    s_waitcnt lgkmcnt(6)
    v_mfma_f32_32x32x16_bf16 v[88:103], v[60:63], a[132:135], v[88:103]
    ds_read_b128 v[76:79], v8 offset:13312
    s_waitcnt lgkmcnt(4)
    v_mfma_f32_32x32x16_bf16 v[88:103], v[64:67], a[136:139], v[88:103]
    ds_read_b128 v[80:83], v8 offset:14336
    s_waitcnt lgkmcnt(3)
    v_mfma_f32_32x32x16_bf16 v[88:103], v[68:71], a[140:143], v[88:103]
    ds_read_b128 v[84:87], v8 offset:15360
    s_waitcnt lgkmcnt(3)
    v_mfma_f32_32x32x16_bf16 v[88:103], v[72:75], a[144:147], v[88:103]
    s_waitcnt lgkmcnt(2)
    v_mfma_f32_32x32x16_bf16 v[88:103], v[76:79], a[148:151], v[88:103]
    s_waitcnt lgkmcnt(1)
    v_mfma_f32_32x32x16_bf16 v[88:103], v[80:83], a[152:155], v[88:103]
    s_waitcnt lgkmcnt(0)
    v_mfma_f32_32x32x16_bf16 v[88:103], v[84:87], a[156:159], v[88:103]
    s_mul_i32 s55, s44, s58
    s_add_u32 s55, s55, s51
    s_add_u32 s35, s55, s59
    s_add_u32 s49, s45, s61
    s_mov_b32 s44, s45
    s_nop 6
    v_pk_fma_f32 v[88:89], v[132:133], v[116:117], v[88:89] op_sel_hi:[1,0,1] neg_lo:[1,0,0] neg_hi:[1,0,0]
    s_nop 0
    v_pk_mul_f32 v[88:89], v[88:89], v[148:149]
    v_pk_fma_f32 v[90:91], v[134:135], v[116:117], v[90:91] op_sel_hi:[1,0,1] neg_lo:[1,0,0] neg_hi:[1,0,0]
    s_nop 0
    v_pk_mul_f32 v[90:91], v[90:91], v[150:151]
    v_pk_fma_f32 v[92:93], v[136:137], v[116:117], v[92:93] op_sel_hi:[1,0,1] neg_lo:[1,0,0] neg_hi:[1,0,0]
    s_nop 0
    v_pk_mul_f32 v[92:93], v[92:93], v[152:153]
    v_pk_fma_f32 v[94:95], v[138:139], v[116:117], v[94:95] op_sel_hi:[1,0,1] neg_lo:[1,0,0] neg_hi:[1,0,0]
    s_nop 0
    v_pk_mul_f32 v[94:95], v[94:95], v[154:155]
    v_pk_fma_f32 v[96:97], v[140:141], v[116:117], v[96:97] op_sel_hi:[1,0,1] neg_lo:[1,0,0] neg_hi:[1,0,0]
    s_nop 0
    v_pk_mul_f32 v[96:97], v[96:97], v[156:157]
    v_pk_fma_f32 v[98:99], v[142:143], v[116:117], v[98:99] op_sel_hi:[1,0,1] neg_lo:[1,0,0] neg_hi:[1,0,0]
    s_nop 0
    v_pk_mul_f32 v[98:99], v[98:99], v[158:159]
    v_pk_fma_f32 v[100:101], v[144:145], v[116:117], v[100:101] op_sel_hi:[1,0,1] neg_lo:[1,0,0] neg_hi:[1,0,0]
    s_nop 0
    v_pk_mul_f32 v[100:101], v[100:101], v[160:161]
    v_pk_fma_f32 v[102:103], v[146:147], v[116:117], v[102:103] op_sel_hi:[1,0,1] neg_lo:[1,0,0] neg_hi:[1,0,0]
    s_nop 0
    v_pk_mul_f32 v[102:103], v[102:103], v[162:163]
    v_cvt_pk_bf16_f32 v164, v88, v89
    v_cvt_pk_bf16_f32 v165, v90, v91
    v_cvt_pk_bf16_f32 v166, v92, v93
    v_cvt_pk_bf16_f32 v167, v94, v95
    v_cvt_pk_bf16_f32 v168, v96, v97
    v_cvt_pk_bf16_f32 v169, v98, v99
    v_cvt_pk_bf16_f32 v170, v100, v101
    v_cvt_pk_bf16_f32 v171, v102, v103
    buffer_store_dwordx4 v[164:167], v5, s[4:7], s55 offen sc1
    buffer_store_dwordx4 v[168:171], v5, s[4:7], s35 offen sc1
    s_cmp_lt_u32 s44, s46
    s_cbranch_scc1 G1_159
    s_branch G1_155
G1_153:
    s_mul_i32 s51, s30, 16777216
    s_add_u32 s51, s51, 33554432
    s_lshl_b32 s34, s63, 13
    s_lshl_b32 s35, s29, 11
    s_add_u32 s51, s51, s34
    s_add_u32 s51, s51, s35
    s_mov_b32 s58, 262144
    s_mov_b32 s59, 1024
    v_mov_b32 v5, v0
G1_154:
    v_bfe_u32 v184, v1, 5, 1
    v_mul_u32_u24 v184, 64, v184
    v_add_u32 v184, s37, v184
    s_cmp_gt_u32 s49, 1
    s_cbranch_scc1 G1_160
    s_mov_b32 s34, 0x3f803f80
    v_mov_b32 v16, s34
    v_mov_b32 v17, s34
    v_mov_b32 v18, s34
    v_mov_b32 v19, s34
    s_nop 1
    v_mfma_f32_32x32x16_bf16 v[88:103], a[0:3], v[16:19], 0
    v_mfma_f32_32x32x16_bf16 v[88:103], a[4:7], v[16:19], v[88:103]
    v_mfma_f32_32x32x16_bf16 v[88:103], a[8:11], v[16:19], v[88:103]
    v_mfma_f32_32x32x16_bf16 v[88:103], a[12:15], v[16:19], v[88:103]
    v_mfma_f32_32x32x16_bf16 v[88:103], a[16:19], v[16:19], v[88:103]
    v_mfma_f32_32x32x16_bf16 v[88:103], a[20:23], v[16:19], v[88:103]
    v_mfma_f32_32x32x16_bf16 v[88:103], a[24:27], v[16:19], v[88:103]
    v_mfma_f32_32x32x16_bf16 v[88:103], a[28:31], v[16:19], v[88:103]
    v_mfma_f32_32x32x16_bf16 v[88:103], a[32:35], v[16:19], v[88:103]
    v_mfma_f32_32x32x16_bf16 v[88:103], a[36:39], v[16:19], v[88:103]
    v_mfma_f32_32x32x16_bf16 v[88:103], a[40:43], v[16:19], v[88:103]
    v_mfma_f32_32x32x16_bf16 v[88:103], a[44:47], v[16:19], v[88:103]
    v_mfma_f32_32x32x16_bf16 v[88:103], a[48:51], v[16:19], v[88:103]
    v_mfma_f32_32x32x16_bf16 v[88:103], a[52:55], v[16:19], v[88:103]
    v_mfma_f32_32x32x16_bf16 v[88:103], a[56:59], v[16:19], v[88:103]
    v_mfma_f32_32x32x16_bf16 v[88:103], a[60:63], v[16:19], v[88:103]
    v_mfma_f32_32x32x16_bf16 v[88:103], a[64:67], v[16:19], v[88:103]
    v_mfma_f32_32x32x16_bf16 v[88:103], a[68:71], v[16:19], v[88:103]
    v_mfma_f32_32x32x16_bf16 v[88:103], a[72:75], v[16:19], v[88:103]
    v_mfma_f32_32x32x16_bf16 v[88:103], a[76:79], v[16:19], v[88:103]
    v_mfma_f32_32x32x16_bf16 v[88:103], a[80:83], v[16:19], v[88:103]
    v_mfma_f32_32x32x16_bf16 v[88:103], a[84:87], v[16:19], v[88:103]
    v_mfma_f32_32x32x16_bf16 v[88:103], a[88:91], v[16:19], v[88:103]
    v_mfma_f32_32x32x16_bf16 v[88:103], a[92:95], v[16:19], v[88:103]
    v_mfma_f32_32x32x16_bf16 v[88:103], a[96:99], v[16:19], v[88:103]
    v_mfma_f32_32x32x16_bf16 v[88:103], a[100:103], v[16:19], v[88:103]
    v_mfma_f32_32x32x16_bf16 v[88:103], a[104:107], v[16:19], v[88:103]
    v_mfma_f32_32x32x16_bf16 v[88:103], a[108:111], v[16:19], v[88:103]
    v_mfma_f32_32x32x16_bf16 v[88:103], a[112:115], v[16:19], v[88:103]
    v_mfma_f32_32x32x16_bf16 v[88:103], a[116:119], v[16:19], v[88:103]
    v_mfma_f32_32x32x16_bf16 v[88:103], a[120:123], v[16:19], v[88:103]
    v_mfma_f32_32x32x16_bf16 v[88:103], a[124:127], v[16:19], v[88:103]
    v_mfma_f32_32x32x16_bf16 v[88:103], a[128:131], v[16:19], v[88:103]
    v_mfma_f32_32x32x16_bf16 v[88:103], a[132:135], v[16:19], v[88:103]
    v_mfma_f32_32x32x16_bf16 v[88:103], a[136:139], v[16:19], v[88:103]
    v_mfma_f32_32x32x16_bf16 v[88:103], a[140:143], v[16:19], v[88:103]
    v_mfma_f32_32x32x16_bf16 v[88:103], a[144:147], v[16:19], v[88:103]
    v_mfma_f32_32x32x16_bf16 v[88:103], a[148:151], v[16:19], v[88:103]
    v_mfma_f32_32x32x16_bf16 v[88:103], a[152:155], v[16:19], v[88:103]
    v_mfma_f32_32x32x16_bf16 v[88:103], a[156:159], v[16:19], v[88:103]
    s_nop 11
    ds_write_b128 v184, v[88:91] offset:0
    ds_write_b128 v184, v[92:95] offset:16
    ds_write_b128 v184, v[96:99] offset:32
    ds_write_b128 v184, v[100:103] offset:48
G1_160:
    ds_read_b128 v[116:119], v184 offset:0
    ds_read_b128 v[120:123], v184 offset:16
    ds_read_b128 v[124:127], v184 offset:32
    ds_read_b128 v[128:131], v184 offset:48
    s_mul_i32 s32, s29, 48
    v_min_u32 v180, 47, v1
    v_add_u32 v180, s32, v180
    v_min_u32 v180, 189, v180
    v_lshlrev_b32 v180, 7, v180
    s_mov_b32 s32, 1122304
    s_mov_b32 s48, 0
P_161:
    buffer_load_dword v176, v180, s[4:7], s32 offen sc1
    s_waitcnt vmcnt(0)
    v_cmp_gt_u32 vcc, s57, v176
    s_cbranch_vccz P_162
    s_add_u32 s48, s48, 1
    s_cmp_gt_u32 s48, 200000
    s_cbranch_scc1 L_end
    s_sleep 1
    s_branch P_161
P_162:
    s_barrier
    s_mul_i32 s54, s44, 40960
    s_add_u32 s56, s54, s52
    s_add_u32 s54, s54, s50
    s_waitcnt vmcnt(0) lgkmcnt(0)
    s_add_u32 m0, s52, 0
    s_add_u32 s35, s54, 0
    buffer_load_dwordx4 v0, s[4:7], s35 offen offset:0 sc1 lds
    buffer_load_dwordx4 v0, s[4:7], s35 offen offset:1024 sc1 lds
    buffer_load_dwordx4 v0, s[4:7], s35 offen offset:2048 sc1 lds
    buffer_load_dwordx4 v0, s[4:7], s35 offen offset:3072 sc1 lds
    s_add_u32 m0, s52, 4096
    s_add_u32 s35, s54, 4096
    buffer_load_dwordx4 v0, s[4:7], s35 offen offset:0 sc1 lds
    buffer_load_dwordx4 v0, s[4:7], s35 offen offset:1024 sc1 lds
    buffer_load_dwordx4 v0, s[4:7], s35 offen offset:2048 sc1 lds
    buffer_load_dwordx4 v0, s[4:7], s35 offen offset:3072 sc1 lds
    s_add_u32 m0, s52, 8192
    s_add_u32 s35, s54, 8192
    buffer_load_dwordx4 v0, s[4:7], s35 offen offset:0 sc1 lds
    buffer_load_dwordx4 v0, s[4:7], s35 offen offset:1024 sc1 lds
    buffer_load_dword v185, off, s[8:11], 0
    buffer_load_dword v185, off, s[8:11], 0
G1_163:
    v_mov_b64 v[104:105], 0
    s_mov_b32 s34, 0x3f803f80
    s_waitcnt vmcnt(10)
    ds_read_b128 v[16:19], v2 offset:0
    ds_read_b128 v[20:23], v2 offset:1024
    s_waitcnt vmcnt(8)
    ds_read_b128 v[24:27], v2 offset:2048
    ds_read_b128 v[28:31], v2 offset:3072
    s_waitcnt vmcnt(6)
    ds_read_b128 v[32:35], v2 offset:4096
    ds_read_b128 v[36:39], v2 offset:5120
    s_waitcnt lgkmcnt(5)
    v_dot2c_f32_bf16 v104, s34, v16
    v_dot2c_f32_bf16 v105, v16, v16
    v_dot2c_f32_bf16 v104, s34, v17
    v_dot2c_f32_bf16 v105, v17, v17
    v_dot2c_f32_bf16 v104, s34, v18
    v_dot2c_f32_bf16 v105, v18, v18
    v_dot2c_f32_bf16 v104, s34, v19
    v_dot2c_f32_bf16 v105, v19, v19
    s_waitcnt lgkmcnt(4)
    v_dot2c_f32_bf16 v104, s34, v20
    v_dot2c_f32_bf16 v105, v20, v20
    v_dot2c_f32_bf16 v104, s34, v21
    v_dot2c_f32_bf16 v105, v21, v21
    v_dot2c_f32_bf16 v104, s34, v22
    v_dot2c_f32_bf16 v105, v22, v22
    v_dot2c_f32_bf16 v104, s34, v23
    v_dot2c_f32_bf16 v105, v23, v23
    s_waitcnt vmcnt(4)
    ds_read_b128 v[40:43], v2 offset:6144
    ds_read_b128 v[44:47], v2 offset:7168
    s_waitcnt lgkmcnt(5)
    v_dot2c_f32_bf16 v104, s34, v24
    v_dot2c_f32_bf16 v105, v24, v24
    v_dot2c_f32_bf16 v104, s34, v25
    v_dot2c_f32_bf16 v105, v25, v25
    v_dot2c_f32_bf16 v104, s34, v26
    v_dot2c_f32_bf16 v105, v26, v26
    v_dot2c_f32_bf16 v104, s34, v27
    v_dot2c_f32_bf16 v105, v27, v27
    s_waitcnt lgkmcnt(4)
    v_dot2c_f32_bf16 v104, s34, v28
    v_dot2c_f32_bf16 v105, v28, v28
    v_dot2c_f32_bf16 v104, s34, v29
    v_dot2c_f32_bf16 v105, v29, v29
    v_dot2c_f32_bf16 v104, s34, v30
    v_dot2c_f32_bf16 v105, v30, v30
    v_dot2c_f32_bf16 v104, s34, v31
    v_dot2c_f32_bf16 v105, v31, v31
    s_waitcnt vmcnt(2)
    ds_read_b128 v[48:51], v2 offset:8192
    ds_read_b128 v[52:55], v2 offset:9216
    s_waitcnt lgkmcnt(5)
    v_dot2c_f32_bf16 v104, s34, v32
    v_dot2c_f32_bf16 v105, v32, v32
    v_dot2c_f32_bf16 v104, s34, v33
    v_dot2c_f32_bf16 v105, v33, v33
    v_dot2c_f32_bf16 v104, s34, v34
    v_dot2c_f32_bf16 v105, v34, v34
    v_dot2c_f32_bf16 v104, s34, v35
    v_dot2c_f32_bf16 v105, v35, v35
    s_waitcnt lgkmcnt(4)
    v_dot2c_f32_bf16 v104, s34, v36
    v_dot2c_f32_bf16 v105, v36, v36
    v_dot2c_f32_bf16 v104, s34, v37
    v_dot2c_f32_bf16 v105, v37, v37
    v_dot2c_f32_bf16 v104, s34, v38
    v_dot2c_f32_bf16 v105, v38, v38
    v_dot2c_f32_bf16 v104, s34, v39
    v_dot2c_f32_bf16 v105, v39, v39
    s_waitcnt lgkmcnt(3)
    v_dot2c_f32_bf16 v104, s34, v40
    v_dot2c_f32_bf16 v105, v40, v40
    v_dot2c_f32_bf16 v104, s34, v41
    v_dot2c_f32_bf16 v105, v41, v41
    v_dot2c_f32_bf16 v104, s34, v42
    v_dot2c_f32_bf16 v105, v42, v42
    v_dot2c_f32_bf16 v104, s34, v43
    v_dot2c_f32_bf16 v105, v43, v43
    s_waitcnt lgkmcnt(2)
    v_dot2c_f32_bf16 v104, s34, v44
    v_dot2c_f32_bf16 v105, v44, v44
    v_dot2c_f32_bf16 v104, s34, v45
    v_dot2c_f32_bf16 v105, v45, v45
    v_dot2c_f32_bf16 v104, s34, v46
    v_dot2c_f32_bf16 v105, v46, v46
    v_dot2c_f32_bf16 v104, s34, v47
    v_dot2c_f32_bf16 v105, v47, v47
    s_waitcnt lgkmcnt(1)
    v_dot2c_f32_bf16 v104, s34, v48
    v_dot2c_f32_bf16 v105, v48, v48
    v_dot2c_f32_bf16 v104, s34, v49
    v_dot2c_f32_bf16 v105, v49, v49
    v_dot2c_f32_bf16 v104, s34, v50
    v_dot2c_f32_bf16 v105, v50, v50
    v_dot2c_f32_bf16 v104, s34, v51
    v_dot2c_f32_bf16 v105, v51, v51
    s_waitcnt lgkmcnt(0)
    v_dot2c_f32_bf16 v104, s34, v52
    v_dot2c_f32_bf16 v105, v52, v52
    v_dot2c_f32_bf16 v104, s34, v53
    v_dot2c_f32_bf16 v105, v53, v53
    v_dot2c_f32_bf16 v104, s34, v54
    v_dot2c_f32_bf16 v105, v54, v54
    v_dot2c_f32_bf16 v104, s34, v55
    v_dot2c_f32_bf16 v105, v55, v55
    s_nop 2
    v_mov_b64 v[106:107], v[104:105]
    s_nop 1
    v_permlane32_swap_b32 v104, v106
    v_permlane32_swap_b32 v105, v107
    v_pk_add_f32 v[104:105], v[104:105], v[106:107]
    ds_write_b64 v3, v[104:105] offset:0
    v_mov_b32 v172, s49
    s_add_u32 s45, s44, 2
    s_mul_i32 s54, s45, 40960
    s_add_u32 s56, s54, s52
    s_add_u32 s54, s54, s50
    s_cmp_lt_u32 s45, s46
    s_cselect_b32 s54, s54, 0x40000000
    s_waitcnt vmcnt(0) lgkmcnt(0)
    s_barrier
    s_mov_b64 exec, 1
    buffer_store_dword v172, off, s[4:7], s53 sc1
    s_mov_b64 exec, -1
    ds_read_b128 v[56:59], v0 offset:0
    ds_read_b128 v[60:63], v0 offset:1024
    ds_read_b128 v[64:67], v0 offset:2048
    ds_read_b128 v[68:71], v0 offset:3072
    ds_read_b128 v[106:109], v4 offset:0
    ds_read_b128 v[110:113], v4 offset:16
    s_waitcnt lgkmcnt(5)
    v_mfma_f32_32x32x16_bf16 v[88:103], a[0:3], v[56:59], 0
    ds_read_b128 v[72:75], v0 offset:4096
    s_waitcnt lgkmcnt(5)
    v_mfma_f32_32x32x16_bf16 v[88:103], a[4:7], v[60:63], v[88:103]
    ds_read_b128 v[76:79], v0 offset:5120
    s_add_u32 m0, s52, 40960
    s_add_u32 s35, s54, 0
    buffer_load_dwordx4 v0, s[4:7], s35 offen offset:0 sc1 lds
    s_waitcnt lgkmcnt(5)
    v_mfma_f32_32x32x16_bf16 v[88:103], a[8:11], v[64:67], v[88:103]
    ds_read_b128 v[80:83], v0 offset:6144
    s_waitcnt lgkmcnt(5)
    v_mfma_f32_32x32x16_bf16 v[88:103], a[12:15], v[68:71], v[88:103]
    ds_read_b128 v[84:87], v0 offset:7168
    buffer_load_dwordx4 v0, s[4:7], s35 offen offset:1024 sc1 lds
    s_waitcnt lgkmcnt(3)
    v_mfma_f32_32x32x16_bf16 v[88:103], a[16:19], v[72:75], v[88:103]
    ds_read_b128 v[56:59], v0 offset:8192
    s_waitcnt lgkmcnt(3)
    v_mfma_f32_32x32x16_bf16 v[88:103], a[20:23], v[76:79], v[88:103]
    ds_read_b128 v[60:63], v0 offset:9216
    buffer_load_dwordx4 v0, s[4:7], s35 offen offset:2048 sc1 lds
    s_waitcnt lgkmcnt(3)
    v_mfma_f32_32x32x16_bf16 v[88:103], a[24:27], v[80:83], v[88:103]
    ds_read_b128 v[64:67], v0 offset:10240
    s_waitcnt lgkmcnt(3)
    v_mfma_f32_32x32x16_bf16 v[88:103], a[28:31], v[84:87], v[88:103]
    ds_read_b128 v[68:71], v0 offset:11264
    buffer_load_dwordx4 v0, s[4:7], s35 offen offset:3072 sc1 lds
    s_waitcnt lgkmcnt(3)
    v_mfma_f32_32x32x16_bf16 v[88:103], a[32:35], v[56:59], v[88:103]
    ds_read_b128 v[72:75], v0 offset:12288
    s_waitcnt lgkmcnt(3)
    v_mfma_f32_32x32x16_bf16 v[88:103], a[36:39], v[60:63], v[88:103]
    ds_read_b128 v[76:79], v0 offset:13312
    s_add_u32 m0, s52, 45056
    s_add_u32 s35, s54, 4096
    buffer_load_dwordx4 v0, s[4:7], s35 offen offset:0 sc1 lds
    s_waitcnt lgkmcnt(3)
    v_mfma_f32_32x32x16_bf16 v[88:103], a[40:43], v[64:67], v[88:103]
    ds_read_b128 v[80:83], v0 offset:14336
    s_waitcnt lgkmcnt(3)
    v_mfma_f32_32x32x16_bf16 v[88:103], a[44:47], v[68:71], v[88:103]
    ds_read_b128 v[84:87], v0 offset:15360
    buffer_load_dwordx4 v0, s[4:7], s35 offen offset:1024 sc1 lds
    s_waitcnt lgkmcnt(3)
    v_mfma_f32_32x32x16_bf16 v[88:103], a[48:51], v[72:75], v[88:103]
    ds_read_b128 v[56:59], v0 offset:16384
    s_waitcnt lgkmcnt(3)
    v_mfma_f32_32x32x16_bf16 v[88:103], a[52:55], v[76:79], v[88:103]
    ds_read_b128 v[60:63], v0 offset:17408
    buffer_load_dwordx4 v0, s[4:7], s35 offen offset:2048 sc1 lds
    s_waitcnt lgkmcnt(3)
    v_mfma_f32_32x32x16_bf16 v[88:103], a[56:59], v[80:83], v[88:103]
    ds_read_b128 v[64:67], v0 offset:18432
    s_waitcnt lgkmcnt(3)
    v_mfma_f32_32x32x16_bf16 v[88:103], a[60:63], v[84:87], v[88:103]
    ds_read_b128 v[68:71], v0 offset:19456
    buffer_load_dwordx4 v0, s[4:7], s35 offen offset:3072 sc1 lds
    s_waitcnt lgkmcnt(3)
    v_mfma_f32_32x32x16_bf16 v[88:103], a[64:67], v[56:59], v[88:103]
    ds_read_b128 v[72:75], v0 offset:20480
    s_waitcnt lgkmcnt(3)
    v_mfma_f32_32x32x16_bf16 v[88:103], a[68:71], v[60:63], v[88:103]
    ds_read_b128 v[76:79], v0 offset:21504
    s_add_u32 m0, s52, 49152
    s_add_u32 s35, s54, 8192
    buffer_load_dwordx4 v0, s[4:7], s35 offen offset:0 sc1 lds
    s_waitcnt lgkmcnt(3)
    v_mfma_f32_32x32x16_bf16 v[88:103], a[72:75], v[64:67], v[88:103]
    ds_read_b128 v[80:83], v0 offset:22528
    s_waitcnt lgkmcnt(3)
    v_mfma_f32_32x32x16_bf16 v[88:103], a[76:79], v[68:71], v[88:103]
    ds_read_b128 v[84:87], v0 offset:23552
    buffer_load_dwordx4 v0, s[4:7], s35 offen offset:1024 sc1 lds
    s_waitcnt lgkmcnt(3)
    v_mfma_f32_32x32x16_bf16 v[88:103], a[80:83], v[72:75], v[88:103]
    ds_read_b128 v[56:59], v0 offset:24576
    v_add_f32 v106, v106, v108
    v_add_f32 v107, v107, v109
    s_waitcnt lgkmcnt(3)
    v_mfma_f32_32x32x16_bf16 v[88:103], a[84:87], v[76:79], v[88:103]
    ds_read_b128 v[60:63], v0 offset:25600
    v_add_f32 v106, v106, v110
    v_add_f32 v107, v107, v111
    s_waitcnt lgkmcnt(3)
    v_mfma_f32_32x32x16_bf16 v[88:103], a[88:91], v[80:83], v[88:103]
    ds_read_b128 v[64:67], v0 offset:26624
    v_add_f32 v106, v106, v112
    v_add_f32 v107, v107, v113
    s_waitcnt lgkmcnt(3)
    v_mfma_f32_32x32x16_bf16 v[88:103], a[92:95], v[84:87], v[88:103]
    ds_read_b128 v[68:71], v0 offset:27648
    v_mul_f32 v106, 0x3acccccd, v106
    v_mul_f32 v107, 0x3acccccd, v107
    s_waitcnt lgkmcnt(3)
    v_mfma_f32_32x32x16_bf16 v[88:103], a[96:99], v[56:59], v[88:103]
    ds_read_b128 v[72:75], v0 offset:28672
    v_fma_f32 v107, -v106, v106, v107
    v_max_f32 v107, 0, v107
    s_waitcnt lgkmcnt(3)
    v_mfma_f32_32x32x16_bf16 v[88:103], a[100:103], v[60:63], v[88:103]
    ds_read_b128 v[76:79], v0 offset:29696
    v_add_f32 v107, 0x3727c5ac, v107
    v_rsq_f32 v107, v107
    s_waitcnt lgkmcnt(3)
    v_mfma_f32_32x32x16_bf16 v[88:103], a[104:107], v[64:67], v[88:103]
    ds_read_b128 v[80:83], v0 offset:30720
    s_waitcnt lgkmcnt(3)
    v_mfma_f32_32x32x16_bf16 v[88:103], a[108:111], v[68:71], v[88:103]
    ds_read_b128 v[84:87], v0 offset:31744
    s_waitcnt lgkmcnt(3)
    v_mfma_f32_32x32x16_bf16 v[88:103], a[112:115], v[72:75], v[88:103]
    ds_read_b128 v[56:59], v0 offset:32768
    s_waitcnt lgkmcnt(3)
    v_mfma_f32_32x32x16_bf16 v[88:103], a[116:119], v[76:79], v[88:103]
    ds_read_b128 v[60:63], v0 offset:33792
    s_waitcnt lgkmcnt(3)
    v_mfma_f32_32x32x16_bf16 v[88:103], a[120:123], v[80:83], v[88:103]
    ds_read_b128 v[64:67], v0 offset:34816
    s_waitcnt lgkmcnt(3)
    v_mfma_f32_32x32x16_bf16 v[88:103], a[124:127], v[84:87], v[88:103]
    ds_read_b128 v[68:71], v0 offset:35840
    s_waitcnt lgkmcnt(3)
    v_mfma_f32_32x32x16_bf16 v[88:103], a[128:131], v[56:59], v[88:103]
    ds_read_b128 v[72:75], v0 offset:36864
    s_waitcnt lgkmcnt(3)
    v_mfma_f32_32x32x16_bf16 v[88:103], a[132:135], v[60:63], v[88:103]
    ds_read_b128 v[76:79], v0 offset:37888
    s_waitcnt lgkmcnt(3)
    v_mfma_f32_32x32x16_bf16 v[88:103], a[136:139], v[64:67], v[88:103]
    ds_read_b128 v[80:83], v0 offset:38912
    s_waitcnt lgkmcnt(3)
    v_mfma_f32_32x32x16_bf16 v[88:103], a[140:143], v[68:71], v[88:103]
    ds_read_b128 v[84:87], v0 offset:39936
    s_waitcnt lgkmcnt(3)
    v_mfma_f32_32x32x16_bf16 v[88:103], a[144:147], v[72:75], v[88:103]
    s_waitcnt lgkmcnt(2)
    v_mfma_f32_32x32x16_bf16 v[88:103], a[148:151], v[76:79], v[88:103]
    s_waitcnt lgkmcnt(1)
    v_mfma_f32_32x32x16_bf16 v[88:103], a[152:155], v[80:83], v[88:103]
    s_waitcnt lgkmcnt(0)
    v_mfma_f32_32x32x16_bf16 v[88:103], a[156:159], v[84:87], v[88:103]
    s_mul_i32 s55, s44, s58
    s_add_u32 s55, s55, s51
    s_add_u32 s35, s55, s59
    s_add_u32 s49, s45, s61
    s_mov_b32 s44, s45
    s_nop 6
    v_pk_fma_f32 v[88:89], v[106:107], v[116:117], v[88:89] op_sel_hi:[0,1,1] neg_lo:[1,0,0] neg_hi:[1,0,0]
    s_nop 0
    v_pk_mul_f32 v[88:89], v[88:89], v[106:107] op_sel:[0,1]
    v_pk_fma_f32 v[90:91], v[106:107], v[118:119], v[90:91] op_sel_hi:[0,1,1] neg_lo:[1,0,0] neg_hi:[1,0,0]
    s_nop 0
    v_pk_mul_f32 v[90:91], v[90:91], v[106:107] op_sel:[0,1]
    v_pk_fma_f32 v[92:93], v[106:107], v[120:121], v[92:93] op_sel_hi:[0,1,1] neg_lo:[1,0,0] neg_hi:[1,0,0]
    s_nop 0
    v_pk_mul_f32 v[92:93], v[92:93], v[106:107] op_sel:[0,1]
    v_pk_fma_f32 v[94:95], v[106:107], v[122:123], v[94:95] op_sel_hi:[0,1,1] neg_lo:[1,0,0] neg_hi:[1,0,0]
    s_nop 0
    v_pk_mul_f32 v[94:95], v[94:95], v[106:107] op_sel:[0,1]
    v_pk_fma_f32 v[96:97], v[106:107], v[124:125], v[96:97] op_sel_hi:[0,1,1] neg_lo:[1,0,0] neg_hi:[1,0,0]
    s_nop 0
    v_pk_mul_f32 v[96:97], v[96:97], v[106:107] op_sel:[0,1]
    v_pk_fma_f32 v[98:99], v[106:107], v[126:127], v[98:99] op_sel_hi:[0,1,1] neg_lo:[1,0,0] neg_hi:[1,0,0]
    s_nop 0
    v_pk_mul_f32 v[98:99], v[98:99], v[106:107] op_sel:[0,1]
    v_pk_fma_f32 v[100:101], v[106:107], v[128:129], v[100:101] op_sel_hi:[0,1,1] neg_lo:[1,0,0] neg_hi:[1,0,0]
    s_nop 0
    v_pk_mul_f32 v[100:101], v[100:101], v[106:107] op_sel:[0,1]
    v_pk_fma_f32 v[102:103], v[106:107], v[130:131], v[102:103] op_sel_hi:[0,1,1] neg_lo:[1,0,0] neg_hi:[1,0,0]
    s_nop 0
    v_pk_mul_f32 v[102:103], v[102:103], v[106:107] op_sel:[0,1]
    v_cvt_pk_bf16_f32 v164, v88, v89
    v_cvt_pk_bf16_f32 v165, v90, v91
    v_cvt_pk_bf16_f32 v166, v92, v93
    v_cvt_pk_bf16_f32 v167, v94, v95
    v_cvt_pk_bf16_f32 v168, v96, v97
    v_cvt_pk_bf16_f32 v169, v98, v99
    v_cvt_pk_bf16_f32 v170, v100, v101
    v_cvt_pk_bf16_f32 v171, v102, v103
    buffer_store_dwordx4 v[164:167], v5, s[4:7], s55 offen sc1
    buffer_store_dwordx4 v[168:171], v5, s[4:7], s35 offen sc1
    s_cmp_lt_u32 s44, s46
    s_cbranch_scc0 G1_155
    v_mov_b64 v[104:105], 0
    s_mov_b32 s34, 0x3f803f80
    s_waitcnt vmcnt(10)
    ds_read_b128 v[16:19], v2 offset:40960
    ds_read_b128 v[20:23], v2 offset:41984
    s_waitcnt vmcnt(8)
    ds_read_b128 v[24:27], v2 offset:43008
    ds_read_b128 v[28:31], v2 offset:44032
    s_waitcnt vmcnt(6)
    ds_read_b128 v[32:35], v2 offset:45056
    ds_read_b128 v[36:39], v2 offset:46080
    s_waitcnt lgkmcnt(5)
    v_dot2c_f32_bf16 v104, s34, v16
    v_dot2c_f32_bf16 v105, v16, v16
    v_dot2c_f32_bf16 v104, s34, v17
    v_dot2c_f32_bf16 v105, v17, v17
    v_dot2c_f32_bf16 v104, s34, v18
    v_dot2c_f32_bf16 v105, v18, v18
    v_dot2c_f32_bf16 v104, s34, v19
    v_dot2c_f32_bf16 v105, v19, v19
    s_waitcnt lgkmcnt(4)
    v_dot2c_f32_bf16 v104, s34, v20
    v_dot2c_f32_bf16 v105, v20, v20
    v_dot2c_f32_bf16 v104, s34, v21
    v_dot2c_f32_bf16 v105, v21, v21
    v_dot2c_f32_bf16 v104, s34, v22
    v_dot2c_f32_bf16 v105, v22, v22
    v_dot2c_f32_bf16 v104, s34, v23
    v_dot2c_f32_bf16 v105, v23, v23
    s_waitcnt vmcnt(4)
    ds_read_b128 v[40:43], v2 offset:47104
    ds_read_b128 v[44:47], v2 offset:48128
    s_waitcnt lgkmcnt(5)
    v_dot2c_f32_bf16 v104, s34, v24
    v_dot2c_f32_bf16 v105, v24, v24
    v_dot2c_f32_bf16 v104, s34, v25
    v_dot2c_f32_bf16 v105, v25, v25
    v_dot2c_f32_bf16 v104, s34, v26
    v_dot2c_f32_bf16 v105, v26, v26
    v_dot2c_f32_bf16 v104, s34, v27
    v_dot2c_f32_bf16 v105, v27, v27
    s_waitcnt lgkmcnt(4)
    v_dot2c_f32_bf16 v104, s34, v28
    v_dot2c_f32_bf16 v105, v28, v28
    v_dot2c_f32_bf16 v104, s34, v29
    v_dot2c_f32_bf16 v105, v29, v29
    v_dot2c_f32_bf16 v104, s34, v30
    v_dot2c_f32_bf16 v105, v30, v30
    v_dot2c_f32_bf16 v104, s34, v31
    v_dot2c_f32_bf16 v105, v31, v31
    s_waitcnt vmcnt(2)
    ds_read_b128 v[48:51], v2 offset:49152
    ds_read_b128 v[52:55], v2 offset:50176
    s_waitcnt lgkmcnt(5)
    v_dot2c_f32_bf16 v104, s34, v32
    v_dot2c_f32_bf16 v105, v32, v32
    v_dot2c_f32_bf16 v104, s34, v33
    v_dot2c_f32_bf16 v105, v33, v33
    v_dot2c_f32_bf16 v104, s34, v34
    v_dot2c_f32_bf16 v105, v34, v34
    v_dot2c_f32_bf16 v104, s34, v35
    v_dot2c_f32_bf16 v105, v35, v35
    s_waitcnt lgkmcnt(4)
    v_dot2c_f32_bf16 v104, s34, v36
    v_dot2c_f32_bf16 v105, v36, v36
    v_dot2c_f32_bf16 v104, s34, v37
    v_dot2c_f32_bf16 v105, v37, v37
    v_dot2c_f32_bf16 v104, s34, v38
    v_dot2c_f32_bf16 v105, v38, v38
    v_dot2c_f32_bf16 v104, s34, v39
    v_dot2c_f32_bf16 v105, v39, v39
    s_waitcnt lgkmcnt(3)
    v_dot2c_f32_bf16 v104, s34, v40
    v_dot2c_f32_bf16 v105, v40, v40
    v_dot2c_f32_bf16 v104, s34, v41
    v_dot2c_f32_bf16 v105, v41, v41
    v_dot2c_f32_bf16 v104, s34, v42
    v_dot2c_f32_bf16 v105, v42, v42
    v_dot2c_f32_bf16 v104, s34, v43
    v_dot2c_f32_bf16 v105, v43, v43
    s_waitcnt lgkmcnt(2)
    v_dot2c_f32_bf16 v104, s34, v44
    v_dot2c_f32_bf16 v105, v44, v44
    v_dot2c_f32_bf16 v104, s34, v45
    v_dot2c_f32_bf16 v105, v45, v45
    v_dot2c_f32_bf16 v104, s34, v46
    v_dot2c_f32_bf16 v105, v46, v46
    v_dot2c_f32_bf16 v104, s34, v47
    v_dot2c_f32_bf16 v105, v47, v47
    s_waitcnt lgkmcnt(1)
    v_dot2c_f32_bf16 v104, s34, v48
    v_dot2c_f32_bf16 v105, v48, v48
    v_dot2c_f32_bf16 v104, s34, v49
    v_dot2c_f32_bf16 v105, v49, v49
    v_dot2c_f32_bf16 v104, s34, v50
    v_dot2c_f32_bf16 v105, v50, v50
    v_dot2c_f32_bf16 v104, s34, v51
    v_dot2c_f32_bf16 v105, v51, v51
    s_waitcnt lgkmcnt(0)
    v_dot2c_f32_bf16 v104, s34, v52
    v_dot2c_f32_bf16 v105, v52, v52
    v_dot2c_f32_bf16 v104, s34, v53
    v_dot2c_f32_bf16 v105, v53, v53
    v_dot2c_f32_bf16 v104, s34, v54
    v_dot2c_f32_bf16 v105, v54, v54
    v_dot2c_f32_bf16 v104, s34, v55
    v_dot2c_f32_bf16 v105, v55, v55
    s_nop 2
    v_mov_b64 v[106:107], v[104:105]
    s_nop 1
    v_permlane32_swap_b32 v104, v106
    v_permlane32_swap_b32 v105, v107
    v_pk_add_f32 v[104:105], v[104:105], v[106:107]
    ds_write_b64 v3, v[104:105] offset:1024
    v_mov_b32 v172, s49
    s_add_u32 s45, s44, 2
    s_mul_i32 s54, s45, 40960
    s_add_u32 s56, s54, s52
    s_add_u32 s54, s54, s50
    s_cmp_lt_u32 s45, s46
    s_cselect_b32 s54, s54, 0x40000000
    s_waitcnt vmcnt(0) lgkmcnt(0)
    s_barrier
    s_mov_b64 exec, 1
    buffer_store_dword v172, off, s[4:7], s53 sc1
    s_mov_b64 exec, -1
    ds_read_b128 v[56:59], v0 offset:40960
    ds_read_b128 v[60:63], v0 offset:41984
    ds_read_b128 v[64:67], v0 offset:43008
    ds_read_b128 v[68:71], v0 offset:44032
    ds_read_b128 v[106:109], v4 offset:1024
    ds_read_b128 v[110:113], v4 offset:1040
    s_waitcnt lgkmcnt(5)
    v_mfma_f32_32x32x16_bf16 v[88:103], a[0:3], v[56:59], 0
    ds_read_b128 v[72:75], v0 offset:45056
    s_waitcnt lgkmcnt(5)
    v_mfma_f32_32x32x16_bf16 v[88:103], a[4:7], v[60:63], v[88:103]
    ds_read_b128 v[76:79], v0 offset:46080
    s_add_u32 m0, s52, 0
    s_add_u32 s35, s54, 0
    buffer_load_dwordx4 v0, s[4:7], s35 offen offset:0 sc1 lds
    s_waitcnt lgkmcnt(5)
    v_mfma_f32_32x32x16_bf16 v[88:103], a[8:11], v[64:67], v[88:103]
    ds_read_b128 v[80:83], v0 offset:47104
    s_waitcnt lgkmcnt(5)
    v_mfma_f32_32x32x16_bf16 v[88:103], a[12:15], v[68:71], v[88:103]
    ds_read_b128 v[84:87], v0 offset:48128
    buffer_load_dwordx4 v0, s[4:7], s35 offen offset:1024 sc1 lds
    s_waitcnt lgkmcnt(3)
    v_mfma_f32_32x32x16_bf16 v[88:103], a[16:19], v[72:75], v[88:103]
    ds_read_b128 v[56:59], v0 offset:49152
    s_waitcnt lgkmcnt(3)
    v_mfma_f32_32x32x16_bf16 v[88:103], a[20:23], v[76:79], v[88:103]
    ds_read_b128 v[60:63], v0 offset:50176
    buffer_load_dwordx4 v0, s[4:7], s35 offen offset:2048 sc1 lds
    s_waitcnt lgkmcnt(3)
    v_mfma_f32_32x32x16_bf16 v[88:103], a[24:27], v[80:83], v[88:103]
    ds_read_b128 v[64:67], v0 offset:51200
    s_waitcnt lgkmcnt(3)
    v_mfma_f32_32x32x16_bf16 v[88:103], a[28:31], v[84:87], v[88:103]
    ds_read_b128 v[68:71], v0 offset:52224
    buffer_load_dwordx4 v0, s[4:7], s35 offen offset:3072 sc1 lds
    s_waitcnt lgkmcnt(3)
    v_mfma_f32_32x32x16_bf16 v[88:103], a[32:35], v[56:59], v[88:103]
    ds_read_b128 v[72:75], v0 offset:53248
    s_waitcnt lgkmcnt(3)
    v_mfma_f32_32x32x16_bf16 v[88:103], a[36:39], v[60:63], v[88:103]
    ds_read_b128 v[76:79], v0 offset:54272
    s_add_u32 m0, s52, 4096
    s_add_u32 s35, s54, 4096
    buffer_load_dwordx4 v0, s[4:7], s35 offen offset:0 sc1 lds
    s_waitcnt lgkmcnt(3)
    v_mfma_f32_32x32x16_bf16 v[88:103], a[40:43], v[64:67], v[88:103]
    ds_read_b128 v[80:83], v0 offset:55296
    s_waitcnt lgkmcnt(3)
    v_mfma_f32_32x32x16_bf16 v[88:103], a[44:47], v[68:71], v[88:103]
    ds_read_b128 v[84:87], v0 offset:56320
    buffer_load_dwordx4 v0, s[4:7], s35 offen offset:1024 sc1 lds
    s_waitcnt lgkmcnt(3)
    v_mfma_f32_32x32x16_bf16 v[88:103], a[48:51], v[72:75], v[88:103]
    ds_read_b128 v[56:59], v0 offset:57344
    s_waitcnt lgkmcnt(3)
    v_mfma_f32_32x32x16_bf16 v[88:103], a[52:55], v[76:79], v[88:103]
    ds_read_b128 v[60:63], v0 offset:58368
    buffer_load_dwordx4 v0, s[4:7], s35 offen offset:2048 sc1 lds
    s_waitcnt lgkmcnt(3)
    v_mfma_f32_32x32x16_bf16 v[88:103], a[56:59], v[80:83], v[88:103]
    ds_read_b128 v[64:67], v0 offset:59392
    s_waitcnt lgkmcnt(3)
    v_mfma_f32_32x32x16_bf16 v[88:103], a[60:63], v[84:87], v[88:103]
    ds_read_b128 v[68:71], v0 offset:60416
    buffer_load_dwordx4 v0, s[4:7], s35 offen offset:3072 sc1 lds
    s_waitcnt lgkmcnt(3)
    v_mfma_f32_32x32x16_bf16 v[88:103], a[64:67], v[56:59], v[88:103]
    ds_read_b128 v[72:75], v0 offset:61440
    s_waitcnt lgkmcnt(3)
    v_mfma_f32_32x32x16_bf16 v[88:103], a[68:71], v[60:63], v[88:103]
    ds_read_b128 v[76:79], v0 offset:62464
    s_add_u32 m0, s52, 8192
    s_add_u32 s35, s54, 8192
    buffer_load_dwordx4 v0, s[4:7], s35 offen offset:0 sc1 lds
    s_waitcnt lgkmcnt(3)
    v_mfma_f32_32x32x16_bf16 v[88:103], a[72:75], v[64:67], v[88:103]
    ds_read_b128 v[80:83], v0 offset:63488
    s_waitcnt lgkmcnt(3)
    v_mfma_f32_32x32x16_bf16 v[88:103], a[76:79], v[68:71], v[88:103]
    ds_read_b128 v[84:87], v0 offset:64512
    buffer_load_dwordx4 v0, s[4:7], s35 offen offset:1024 sc1 lds
    s_waitcnt lgkmcnt(3)
    v_mfma_f32_32x32x16_bf16 v[88:103], a[80:83], v[72:75], v[88:103]
    ds_read_b128 v[56:59], v8 offset:0
    v_add_f32 v106, v106, v108
    v_add_f32 v107, v107, v109
    s_waitcnt lgkmcnt(3)
    v_mfma_f32_32x32x16_bf16 v[88:103], a[84:87], v[76:79], v[88:103]
    ds_read_b128 v[60:63], v8 offset:1024
    v_add_f32 v106, v106, v110
    v_add_f32 v107, v107, v111
    s_waitcnt lgkmcnt(3)
    v_mfma_f32_32x32x16_bf16 v[88:103], a[88:91], v[80:83], v[88:103]
    ds_read_b128 v[64:67], v8 offset:2048
    v_add_f32 v106, v106, v112
    v_add_f32 v107, v107, v113
    s_waitcnt lgkmcnt(3)
    v_mfma_f32_32x32x16_bf16 v[88:103], a[92:95], v[84:87], v[88:103]
    ds_read_b128 v[68:71], v8 offset:3072
    v_mul_f32 v106, 0x3acccccd, v106
    v_mul_f32 v107, 0x3acccccd, v107
    s_waitcnt lgkmcnt(3)
    v_mfma_f32_32x32x16_bf16 v[88:103], a[96:99], v[56:59], v[88:103]
    ds_read_b128 v[72:75], v8 offset:4096
    v_fma_f32 v107, -v106, v106, v107
    v_max_f32 v107, 0, v107
    s_waitcnt lgkmcnt(3)
    v_mfma_f32_32x32x16_bf16 v[88:103], a[100:103], v[60:63], v[88:103]
    ds_read_b128 v[76:79], v8 offset:5120
    v_add_f32 v107, 0x3727c5ac, v107
    v_rsq_f32 v107, v107
    s_waitcnt lgkmcnt(3)
    v_mfma_f32_32x32x16_bf16 v[88:103], a[104:107], v[64:67], v[88:103]
    ds_read_b128 v[80:83], v8 offset:6144
    s_waitcnt lgkmcnt(3)
    v_mfma_f32_32x32x16_bf16 v[88:103], a[108:111], v[68:71], v[88:103]
    ds_read_b128 v[84:87], v8 offset:7168
    s_waitcnt lgkmcnt(3)
    v_mfma_f32_32x32x16_bf16 v[88:103], a[112:115], v[72:75], v[88:103]
    ds_read_b128 v[56:59], v8 offset:8192
    s_waitcnt lgkmcnt(3)
    v_mfma_f32_32x32x16_bf16 v[88:103], a[116:119], v[76:79], v[88:103]
    ds_read_b128 v[60:63], v8 offset:9216
    s_waitcnt lgkmcnt(3)
    v_mfma_f32_32x32x16_bf16 v[88:103], a[120:123], v[80:83], v[88:103]
    ds_read_b128 v[64:67], v8 offset:10240
    s_waitcnt lgkmcnt(3)
    v_mfma_f32_32x32x16_bf16 v[88:103], a[124:127], v[84:87], v[88:103]
    ds_read_b128 v[68:71], v8 offset:11264
    s_waitcnt lgkmcnt(3)
    v_mfma_f32_32x32x16_bf16 v[88:103], a[128:131], v[56:59], v[88:103]
    ds_read_b128 v[72:75], v8 offset:12288
    s_waitcnt lgkmcnt(3)
    v_mfma_f32_32x32x16_bf16 v[88:103], a[132:135], v[60:63], v[88:103]
    ds_read_b128 v[76:79], v8 offset:13312
    s_waitcnt lgkmcnt(3)
    v_mfma_f32_32x32x16_bf16 v[88:103], a[136:139], v[64:67], v[88:103]
    ds_read_b128 v[80:83], v8 offset:14336
    s_waitcnt lgkmcnt(3)
    v_mfma_f32_32x32x16_bf16 v[88:103], a[140:143], v[68:71], v[88:103]
    ds_read_b128 v[84:87], v8 offset:15360
    s_waitcnt lgkmcnt(3)
    v_mfma_f32_32x32x16_bf16 v[88:103], a[144:147], v[72:75], v[88:103]
    s_waitcnt lgkmcnt(2)
    v_mfma_f32_32x32x16_bf16 v[88:103], a[148:151], v[76:79], v[88:103]
    s_waitcnt lgkmcnt(1)
    v_mfma_f32_32x32x16_bf16 v[88:103], a[152:155], v[80:83], v[88:103]
    s_waitcnt lgkmcnt(0)
    v_mfma_f32_32x32x16_bf16 v[88:103], a[156:159], v[84:87], v[88:103]
    s_mul_i32 s55, s44, s58
    s_add_u32 s55, s55, s51
    s_add_u32 s35, s55, s59
    s_add_u32 s49, s45, s61
    s_mov_b32 s44, s45
    s_nop 6
    v_pk_fma_f32 v[88:89], v[106:107], v[116:117], v[88:89] op_sel_hi:[0,1,1] neg_lo:[1,0,0] neg_hi:[1,0,0]
    s_nop 0
    v_pk_mul_f32 v[88:89], v[88:89], v[106:107] op_sel:[0,1]
    v_pk_fma_f32 v[90:91], v[106:107], v[118:119], v[90:91] op_sel_hi:[0,1,1] neg_lo:[1,0,0] neg_hi:[1,0,0]
    s_nop 0
    v_pk_mul_f32 v[90:91], v[90:91], v[106:107] op_sel:[0,1]
    v_pk_fma_f32 v[92:93], v[106:107], v[120:121], v[92:93] op_sel_hi:[0,1,1] neg_lo:[1,0,0] neg_hi:[1,0,0]
    s_nop 0
    v_pk_mul_f32 v[92:93], v[92:93], v[106:107] op_sel:[0,1]
    v_pk_fma_f32 v[94:95], v[106:107], v[122:123], v[94:95] op_sel_hi:[0,1,1] neg_lo:[1,0,0] neg_hi:[1,0,0]
    s_nop 0
    v_pk_mul_f32 v[94:95], v[94:95], v[106:107] op_sel:[0,1]
    v_pk_fma_f32 v[96:97], v[106:107], v[124:125], v[96:97] op_sel_hi:[0,1,1] neg_lo:[1,0,0] neg_hi:[1,0,0]
    s_nop 0
    v_pk_mul_f32 v[96:97], v[96:97], v[106:107] op_sel:[0,1]
    v_pk_fma_f32 v[98:99], v[106:107], v[126:127], v[98:99] op_sel_hi:[0,1,1] neg_lo:[1,0,0] neg_hi:[1,0,0]
    s_nop 0
    v_pk_mul_f32 v[98:99], v[98:99], v[106:107] op_sel:[0,1]
    v_pk_fma_f32 v[100:101], v[106:107], v[128:129], v[100:101] op_sel_hi:[0,1,1] neg_lo:[1,0,0] neg_hi:[1,0,0]
    s_nop 0
    v_pk_mul_f32 v[100:101], v[100:101], v[106:107] op_sel:[0,1]
    v_pk_fma_f32 v[102:103], v[106:107], v[130:131], v[102:103] op_sel_hi:[0,1,1] neg_lo:[1,0,0] neg_hi:[1,0,0]
    s_nop 0
    v_pk_mul_f32 v[102:103], v[102:103], v[106:107] op_sel:[0,1]
    v_cvt_pk_bf16_f32 v164, v88, v89
    v_cvt_pk_bf16_f32 v165, v90, v91
    v_cvt_pk_bf16_f32 v166, v92, v93
    v_cvt_pk_bf16_f32 v167, v94, v95
    v_cvt_pk_bf16_f32 v168, v96, v97
    v_cvt_pk_bf16_f32 v169, v98, v99
    v_cvt_pk_bf16_f32 v170, v100, v101
    v_cvt_pk_bf16_f32 v171, v102, v103
    buffer_store_dwordx4 v[164:167], v5, s[4:7], s55 offen sc1
    buffer_store_dwordx4 v[168:171], v5, s[4:7], s35 offen sc1
    s_cmp_lt_u32 s44, s46
    s_cbranch_scc1 G1_163
G1_155:
    s_waitcnt vmcnt(0)
    s_barrier
    s_cmp_lg_u32 s29, 0
    s_cbranch_scc1 F_164
    s_lshl_b32 s32, s28, 5
    s_add_u32 s32, s32, s29
    s_lshl_b32 s32, s32, 2
    s_add_u32 s32, s32, 1146880
    v_mov_b32 v176, s49
    s_mov_b64 exec, 1
    buffer_store_dword v176, off, s[4:7], s32 sc1
    s_mov_b64 exec, -1
F_164:
    s_waitcnt vmcnt(0) lgkmcnt(0)
    s_cmp_eq_u32 s68, 0
    s_cbranch_scc1 LAYER_126
    s_sub_u32 s32, s28, 120
    s_cmp_lt_u32 s32, 32
    s_cbranch_scc1 R_165
    v_add_u32 v2, s60, v0
    ds_write_b128 v2, a[160:163] offset:0
    ds_write_b128 v2, a[164:167] offset:1024
    ds_write_b128 v2, a[168:171] offset:2048
    ds_write_b128 v2, a[172:175] offset:3072
    ds_write_b128 v2, a[176:179] offset:4096
    ds_write_b128 v2, a[180:183] offset:5120
    ds_write_b128 v2, a[184:187] offset:6144
    ds_write_b128 v2, a[188:191] offset:7168
    ds_write_b128 v2, a[192:195] offset:8192
    ds_write_b128 v2, a[196:199] offset:9216
    ds_write_b128 v2, a[200:203] offset:10240
    ds_write_b128 v2, a[204:207] offset:11264
    ds_write_b128 v2, a[208:211] offset:12288
    ds_write_b128 v2, a[212:215] offset:13312
    ds_write_b128 v2, a[216:219] offset:14336
    ds_write_b128 v2, a[220:223] offset:15360
    ds_write_b128 v2, a[224:227] offset:16384
    ds_write_b128 v2, a[228:231] offset:17408
    ds_write_b128 v2, a[232:235] offset:18432
    ds_write_b128 v2, a[236:239] offset:19456
    s_waitcnt lgkmcnt(0)
R_165:
    s_cmp_lt_u32 s28, 120
    s_cbranch_scc1 R_166
    s_cmp_ge_u32 s28, 152
    s_cbranch_scc1 R_166
    s_sub_u32 s40, s28, 120
    v_bfe_u32 v2, v1, 1, 1
    v_mul_u32_u24 v2, 2048, v2
    v_bfe_u32 v8, v1, 3, 1
    v_lshl_add_u32 v2, v8, 12, v2
    v_bfe_u32 v8, v1, 2, 1
    v_lshl_add_u32 v2, v8, 6, v2
    v_bfe_u32 v8, v1, 4, 1
    v_lshl_add_u32 v2, v8, 7, v2
    v_bfe_u32 v8, v1, 5, 1
    v_lshl_add_u32 v2, v8, 5, v2
    v_bfe_u32 v8, v1, 0, 1
    v_lshl_add_u32 v2, v8, 4, v2
    v_bfe_u32 v3, v1, 4, 1
    v_mul_u32_u24 v3, 1024, v3
    v_bfe_u32 v8, v1, 5, 1
    v_lshl_add_u32 v3, v8, 8, v3
    v_bfe_u32 v8, v1, 0, 2
    v_lshl_add_u32 v3, v8, 4, v3
    v_bfe_u32 v8, v1, 2, 1
    v_lshl_add_u32 v3, v8, 7, v3
    v_bfe_u32 v8, v1, 3, 1
    v_lshl_add_u32 v3, v8, 6, v3
    v_bfe_u32 v4, v1, 0, 1
    v_mul_u32_u24 v4, 256, v4
    v_bfe_u32 v8, v1, 5, 1
    v_lshl_add_u32 v4, v8, 7, v4
    v_bfe_u32 v8, v1, 2, 2
    v_lshl_add_u32 v4, v8, 3, v4
    v_add_u32 v4, s60, v4
    s_mov_b32 m0, s60
    v_bfe_u32 v5, v1, 0, 2
    v_mul_u32_u24 v5, 8, v5
    v_bfe_u32 v8, v1, 2, 1
    v_lshl_add_u32 v5, v8, 6, v5
    v_bfe_u32 v8, v1, 3, 1
    v_lshl_add_u32 v5, v8, 5, v5
    v_bfe_u32 v8, v1, 4, 2
    v_lshl_add_u32 v5, v8, 7, v5
    v_add_u32 v5, 2048, v5
    v_bfe_u32 v6, v1, 4, 1
    v_mul_u32_u24 v6, 131072, v6
    v_bfe_u32 v8, v1, 5, 1
    v_lshl_add_u32 v6, v8, 8, v6
    v_bfe_u32 v8, v1, 0, 4
    v_lshl_add_u32 v6, v8, 4, v6
    v_bfe_u32 v9, v1, 0, 2
    v_bfe_u32 v8, v1, 2, 1
    v_lshl_add_u32 v9, v8, 3, v9
    v_bfe_u32 v8, v1, 3, 1
    v_lshl_add_u32 v9, v8, 2, v9
    v_bfe_u32 v8, v1, 4, 1
    v_lshl_add_u32 v9, v8, 4, v9
    v_bfe_u32 v10, v1, 5, 1
    v_mul_u32_u24 v10, 8, v10
    v_sub_u32 v9, v9, v10
    v_mov_b32 v10, 0xf149f2ca
    v_cmp_gt_i32 vcc, 0, v9
    s_nop 1
    v_cndmask_b32 v152, 0, v10, vcc
    v_cmp_gt_i32 vcc, 1, v9
    s_nop 1
    v_cndmask_b32 v153, 0, v10, vcc
    v_cmp_gt_i32 vcc, 2, v9
    s_nop 1
    v_cndmask_b32 v154, 0, v10, vcc
    v_cmp_gt_i32 vcc, 3, v9
    s_nop 1
    v_cndmask_b32 v155, 0, v10, vcc
    v_cmp_gt_i32 vcc, 4, v9
    s_nop 1
    v_cndmask_b32 v156, 0, v10, vcc
    v_cmp_gt_i32 vcc, 5, v9
    s_nop 1
    v_cndmask_b32 v157, 0, v10, vcc
    v_cmp_gt_i32 vcc, 6, v9
    s_nop 1
    v_cndmask_b32 v158, 0, v10, vcc
    v_cmp_gt_i32 vcc, 7, v9
    s_nop 1
    v_cndmask_b32 v159, 0, v10, vcc
    v_cmp_gt_i32 vcc, 16, v9
    s_nop 1
    v_cndmask_b32 v160, 0, v10, vcc
    v_cmp_gt_i32 vcc, 17, v9
    s_nop 1
    v_cndmask_b32 v161, 0, v10, vcc
    v_cmp_gt_i32 vcc, 18, v9
    s_nop 1
    v_cndmask_b32 v162, 0, v10, vcc
    v_cmp_gt_i32 vcc, 19, v9
    s_nop 1
    v_cndmask_b32 v163, 0, v10, vcc
    v_cmp_gt_i32 vcc, 20, v9
    s_nop 1
    v_cndmask_b32 v164, 0, v10, vcc
    v_cmp_gt_i32 vcc, 21, v9
    s_nop 1
    v_cndmask_b32 v165, 0, v10, vcc
    v_cmp_gt_i32 vcc, 22, v9
    s_nop 1
    v_cndmask_b32 v166, 0, v10, vcc
    v_cmp_gt_i32 vcc, 23, v9
    s_nop 1
    v_cndmask_b32 v167, 0, v10, vcc
    s_lshl_b32 s34, s40, 8
    s_add_u32 s34, s34, 1220608
    v_bfe_u32 v7, v1, 0, 1
    v_mul_u32_u24 v7, 128, v7
    v_add_u32 v7, s34, v7
    s_add_u32 s57, s61, 64
    s_mul_i32 s37, s40, 6
    v_min_u32 v12, 5, v1
    v_lshlrev_b32 v12, 7, v12
    s_lshl_b32 s32, s37, 7
    s_add_u32 s32, s32, 1146880
    s_mov_b32 s48, 0
P_167:
    buffer_load_dword v8, v12, s[4:7], s32 offen sc1
    s_waitcnt vmcnt(0)
    v_cmp_gt_u32 vcc, s57, v8
    s_cbranch_vccz P_168
    s_add_u32 s48, s48, 1
    s_cmp_gt_u32 s48, 200000
    s_cbranch_scc1 L_end
    s_sleep 1
    s_branch P_167
P_168:
    s_mov_b32 s44, s29
    s_add_u32 s49, s61, 1
    s_mov_b32 s68, 0x3e0293ee
    s_waitcnt vmcnt(0) lgkmcnt(0)
AT_169:
    s_lshl_b32 s34, s44, 5
    s_add_u32 s34, s34, s40
    s_mul_i32 s35, s30, 16777216
    s_add_u32 s35, s35, 33554432
    s_lshl_b32 s36, s34, 13
    s_add_u32 s35, s35, s36
    s_mul_i32 s37, s30, 34603008
    s_add_u32 s37, s37, 117440512
    s_lshl_b32 s36, s34, 14
    s_add_u32 s37, s37, s36
    buffer_load_dwordx4 v[16:19], v0, s[4:7], s35 offen offset:0 sc1
    buffer_load_dwordx4 v[48:51], v2, s[4:7], s37 offen offset:0 sc1
    buffer_load_dwordx4 v[20:23], v0, s[4:7], s35 offen offset:1024 sc1
    buffer_load_dwordx4 v[52:55], v2, s[4:7], s37 offen offset:256 sc1
    buffer_load_dwordx4 v[24:27], v0, s[4:7], s35 offen offset:2048 sc1
    buffer_load_dwordx4 v[56:59], v2, s[4:7], s37 offen offset:512 sc1
    buffer_load_dwordx4 v[28:31], v0, s[4:7], s35 offen offset:3072 sc1
    buffer_load_dwordx4 v[60:63], v2, s[4:7], s37 offen offset:768 sc1
    s_add_u32 s35, s35, 4096
    buffer_load_dwordx4 v[32:35], v0, s[4:7], s35 offen offset:0 sc1
    buffer_load_dwordx4 v[64:67], v2, s[4:7], s37 offen offset:1024 sc1
    buffer_load_dwordx4 v[36:39], v0, s[4:7], s35 offen offset:1024 sc1
    buffer_load_dwordx4 v[68:71], v2, s[4:7], s37 offen offset:1280 sc1
    buffer_load_dwordx4 v[40:43], v0, s[4:7], s35 offen offset:2048 sc1
    buffer_load_dwordx4 v[72:75], v2, s[4:7], s37 offen offset:1536 sc1
    buffer_load_dwordx4 v[44:47], v0, s[4:7], s35 offen offset:3072 sc1
    buffer_load_dwordx4 v[76:79], v2, s[4:7], s37 offen offset:1792 sc1
    s_add_u32 s37, s37, 8192
    buffer_load_dwordx4 v[80:83], v3, s[4:7], s37 offen offset:0 sc1
    buffer_load_dwordx4 v[84:87], v3, s[4:7], s37 offen offset:512 sc1
    buffer_load_dwordx4 v[88:91], v3, s[4:7], s37 offen offset:2048 sc1
    buffer_load_dwordx4 v[92:95], v3, s[4:7], s37 offen offset:2560 sc1
    s_add_u32 s37, s37, 4096
    buffer_load_dwordx4 v[96:99], v3, s[4:7], s37 offen offset:0 sc1
    buffer_load_dwordx4 v[100:103], v3, s[4:7], s37 offen offset:512 sc1
    buffer_load_dwordx4 v[104:107], v3, s[4:7], s37 offen offset:2048 sc1
    buffer_load_dwordx4 v[108:111], v3, s[4:7], s37 offen offset:2560 sc1
    s_waitcnt vmcnt(22)
    v_mfma_f32_32x32x16_bf16 v[168:183], v[48:51], v[16:19], v[152:167]
    s_waitcnt vmcnt(20)
    v_mfma_f32_32x32x16_bf16 v[168:183], v[52:55], v[20:23], v[168:183]
    s_waitcnt vmcnt(18)
    v_mfma_f32_32x32x16_bf16 v[168:183], v[56:59], v[24:27], v[168:183]
    s_waitcnt vmcnt(16)
    v_mfma_f32_32x32x16_bf16 v[168:183], v[60:63], v[28:31], v[168:183]
    s_waitcnt vmcnt(14)
    v_mfma_f32_32x32x16_bf16 v[168:183], v[64:67], v[32:35], v[168:183]
    s_waitcnt vmcnt(12)
    v_mfma_f32_32x32x16_bf16 v[168:183], v[68:71], v[36:39], v[168:183]
    s_waitcnt vmcnt(10)
    v_mfma_f32_32x32x16_bf16 v[168:183], v[72:75], v[40:43], v[168:183]
    s_waitcnt vmcnt(8)
    v_mfma_f32_32x32x16_bf16 v[168:183], v[76:79], v[44:47], v[168:183]
    s_add_u32 s57, s44, s61
    s_add_u32 s57, s57, 1
    s_mov_b32 s48, 0
P_170:
    buffer_load_dword v8, v7, s[4:7], 0 offen sc1
    s_waitcnt vmcnt(0)
    v_cmp_gt_u32 vcc, s57, v8
    s_cbranch_vccz P_171
    s_add_u32 s48, s48, 1
    s_cmp_gt_u32 s48, 200000
    s_cbranch_scc1 L_end
    s_sleep 2
    s_branch P_170
P_171:
    s_mul_i32 s35, s30, 8388608
    s_add_u32 s35, s35, 100663296
    s_lshl_b32 s36, s34, 12
    s_add_u32 s35, s35, s36
    buffer_load_dwordx4 v0, s[4:7], s35 offen offset:0 sc1 lds
    buffer_load_dwordx4 v0, s[4:7], s35 offen offset:1024 sc1 lds
    buffer_load_dwordx2 v[144:145], v5, s[4:7], s35 offen offset:0 sc1
    buffer_load_dwordx2 v[146:147], v5, s[4:7], s35 offen offset:512 sc1
    buffer_load_dwordx2 v[148:149], v5, s[4:7], s35 offen offset:1024 sc1
    buffer_load_dwordx2 v[150:151], v5, s[4:7], s35 offen offset:1536 sc1
    v_max3_f32 v8, v168, v169, v170
    v_max3_f32 v8, v8, v171, v172
    v_max3_f32 v8, v8, v173, v174
    v_max3_f32 v8, v8, v175, v176
    v_max3_f32 v8, v8, v177, v178
    v_max3_f32 v8, v8, v179, v180
    v_max3_f32 v8, v8, v181, v182
    v_max_f32 v8, v8, v183
    s_waitcnt vmcnt(4)
    ds_read_b64_tr_b16 v[112:113], v4 offset:0
    ds_read_b64_tr_b16 v[114:115], v4 offset:32
    ds_read_b64_tr_b16 v[116:117], v4 offset:64
    ds_read_b64_tr_b16 v[118:119], v4 offset:96
    ds_read_b64_tr_b16 v[120:121], v4 offset:512
    ds_read_b64_tr_b16 v[122:123], v4 offset:544
    ds_read_b64_tr_b16 v[124:125], v4 offset:576
    ds_read_b64_tr_b16 v[126:127], v4 offset:608
    ds_read_b64_tr_b16 v[128:129], v4 offset:1024
    ds_read_b64_tr_b16 v[130:131], v4 offset:1056
    ds_read_b64_tr_b16 v[132:133], v4 offset:1088
    ds_read_b64_tr_b16 v[134:135], v4 offset:1120
    ds_read_b64_tr_b16 v[136:137], v4 offset:1536
    ds_read_b64_tr_b16 v[138:139], v4 offset:1568
    ds_read_b64_tr_b16 v[140:141], v4 offset:1600
    ds_read_b64_tr_b16 v[142:143], v4 offset:1632
    s_waitcnt lgkmcnt(14)
    v_mfma_f32_32x32x16_bf16 v[184:199], v[112:115], v[16:19], 0
    s_waitcnt lgkmcnt(12)
    v_mfma_f32_32x32x16_bf16 v[184:199], v[116:119], v[20:23], v[184:199]
    s_waitcnt lgkmcnt(10)
    v_mfma_f32_32x32x16_bf16 v[184:199], v[120:123], v[24:27], v[184:199]
    s_waitcnt lgkmcnt(8)
    v_mfma_f32_32x32x16_bf16 v[184:199], v[124:127], v[28:31], v[184:199]
    s_waitcnt lgkmcnt(6)
    v_mfma_f32_32x32x16_bf16 v[184:199], v[128:131], v[32:35], v[184:199]
    s_waitcnt lgkmcnt(4)
    v_mfma_f32_32x32x16_bf16 v[184:199], v[132:135], v[36:39], v[184:199]
    s_waitcnt lgkmcnt(2)
    v_mfma_f32_32x32x16_bf16 v[184:199], v[136:139], v[40:43], v[184:199]
    s_waitcnt lgkmcnt(0)
    v_mfma_f32_32x32x16_bf16 v[184:199], v[140:143], v[44:47], v[184:199]
    s_nop 11
    v_max3_f32 v8, v8, v184, v185
    v_max3_f32 v8, v8, v186, v187
    v_mov_b32 v9, v8
    s_nop 1
    v_permlane32_swap_b32 v8, v9
    v_max_f32 v8, v8, v9
    v_mul_f32 v8, s68, v8
    v_fma_f32 v168, v168, s68, -v8
    v_fma_f32 v169, v169, s68, -v8
    v_fma_f32 v170, v170, s68, -v8
    v_fma_f32 v171, v171, s68, -v8
    v_fma_f32 v172, v172, s68, -v8
    v_fma_f32 v173, v173, s68, -v8
    v_fma_f32 v174, v174, s68, -v8
    v_fma_f32 v175, v175, s68, -v8
    v_fma_f32 v176, v176, s68, -v8
    v_fma_f32 v177, v177, s68, -v8
    v_fma_f32 v178, v178, s68, -v8
    v_fma_f32 v179, v179, s68, -v8
    v_fma_f32 v180, v180, s68, -v8
    v_fma_f32 v181, v181, s68, -v8
    v_fma_f32 v182, v182, s68, -v8
    v_fma_f32 v183, v183, s68, -v8
    v_fma_f32 v184, v184, s68, -v8
    v_fma_f32 v185, v185, s68, -v8
    v_fma_f32 v186, v186, s68, -v8
    v_fma_f32 v187, v187, s68, -v8
    v_exp_f32 v168, v168
    v_exp_f32 v169, v169
    v_exp_f32 v170, v170
    v_exp_f32 v171, v171
    v_exp_f32 v172, v172
    v_exp_f32 v173, v173
    v_exp_f32 v174, v174
    v_exp_f32 v175, v175
    v_exp_f32 v176, v176
    v_exp_f32 v177, v177
    v_exp_f32 v178, v178
    v_exp_f32 v179, v179
    v_exp_f32 v180, v180
    v_exp_f32 v181, v181
    v_exp_f32 v182, v182
    v_exp_f32 v183, v183
    v_exp_f32 v184, v184
    v_exp_f32 v185, v185
    v_exp_f32 v186, v186
    v_exp_f32 v187, v187
    v_pk_add_f32 v[8:9], v[168:169], v[170:171]
    v_pk_add_f32 v[8:9], v[8:9], v[172:173]
    v_pk_add_f32 v[8:9], v[8:9], v[174:175]
    v_pk_add_f32 v[8:9], v[8:9], v[176:177]
    v_pk_add_f32 v[8:9], v[8:9], v[178:179]
    v_pk_add_f32 v[8:9], v[8:9], v[180:181]
    v_pk_add_f32 v[8:9], v[8:9], v[182:183]
    v_pk_add_f32 v[8:9], v[8:9], v[184:185]
    v_pk_add_f32 v[8:9], v[8:9], v[186:187]
    v_add_f32 v8, v8, v9
    v_mov_b32 v9, v8
    s_nop 1
    v_permlane32_swap_b32 v8, v9
    v_add_f32 v8, v8, v9
    v_rcp_f32 v8, v8
    s_nop 0
    v_pk_mul_f32 v[168:169], v[168:169], v[8:9] op_sel_hi:[1,0]
    s_nop 0
    v_cvt_pk_bf16_f32 v188, v168, v169
    v_pk_mul_f32 v[170:171], v[170:171], v[8:9] op_sel_hi:[1,0]
    s_nop 0
    v_cvt_pk_bf16_f32 v189, v170, v171
    v_pk_mul_f32 v[172:173], v[172:173], v[8:9] op_sel_hi:[1,0]
    s_nop 0
    v_cvt_pk_bf16_f32 v190, v172, v173
    v_pk_mul_f32 v[174:175], v[174:175], v[8:9] op_sel_hi:[1,0]
    s_nop 0
    v_cvt_pk_bf16_f32 v191, v174, v175
    v_pk_mul_f32 v[176:177], v[176:177], v[8:9] op_sel_hi:[1,0]
    s_nop 0
    v_cvt_pk_bf16_f32 v192, v176, v177
    v_pk_mul_f32 v[178:179], v[178:179], v[8:9] op_sel_hi:[1,0]
    s_nop 0
    v_cvt_pk_bf16_f32 v193, v178, v179
    v_pk_mul_f32 v[180:181], v[180:181], v[8:9] op_sel_hi:[1,0]
    s_nop 0
    v_cvt_pk_bf16_f32 v194, v180, v181
    v_pk_mul_f32 v[182:183], v[182:183], v[8:9] op_sel_hi:[1,0]
    s_nop 0
    v_cvt_pk_bf16_f32 v195, v182, v183
    v_pk_mul_f32 v[184:185], v[184:185], v[8:9] op_sel_hi:[1,0]
    s_nop 0
    v_cvt_pk_bf16_f32 v196, v184, v185
    v_pk_mul_f32 v[186:187], v[186:187], v[8:9] op_sel_hi:[1,0]
    s_nop 0
    v_cvt_pk_bf16_f32 v197, v186, v187
    s_waitcnt vmcnt(3)
    s_nop 0
    v_mfma_f32_32x32x8_bf16 v[16:31], v[144:145], v[196:197], 0
    s_waitcnt vmcnt(2)
    v_mfma_f32_32x32x8_bf16 v[32:47], v[146:147], v[196:197], 0
    s_waitcnt vmcnt(1)
    v_mfma_f32_32x32x8_bf16 v[48:63], v[148:149], v[196:197], 0
    s_waitcnt vmcnt(0)
    v_mfma_f32_32x32x8_bf16 v[64:79], v[150:151], v[196:197], 0
    v_mfma_f32_32x32x16_bf16 v[16:31], v[80:83], v[188:191], v[16:31]
    v_mfma_f32_32x32x16_bf16 v[16:31], v[84:87], v[192:195], v[16:31]
    v_mfma_f32_32x32x16_bf16 v[32:47], v[88:91], v[188:191], v[32:47]
    v_mfma_f32_32x32x16_bf16 v[32:47], v[92:95], v[192:195], v[32:47]
    v_mfma_f32_32x32x16_bf16 v[48:63], v[96:99], v[188:191], v[48:63]
    v_mfma_f32_32x32x16_bf16 v[48:63], v[100:103], v[192:195], v[48:63]
    v_mfma_f32_32x32x16_bf16 v[64:79], v[104:107], v[188:191], v[64:79]
    v_mfma_f32_32x32x16_bf16 v[64:79], v[108:111], v[192:195], v[64:79]
    s_mul_i32 s35, s30, 16777216
    s_add_u32 s35, s35, 67108864
    s_lshl_b32 s36, s44, 18
    s_add_u32 s35, s35, s36
    s_lshl_b32 s36, s40, 12
    s_add_u32 s35, s35, s36
    v_cvt_pk_bf16_f32 v112, v16, v17
    v_cvt_pk_bf16_f32 v113, v18, v19
    v_cvt_pk_bf16_f32 v114, v20, v21
    v_cvt_pk_bf16_f32 v115, v22, v23
    v_cvt_pk_bf16_f32 v116, v24, v25
    v_cvt_pk_bf16_f32 v117, v26, v27
    v_cvt_pk_bf16_f32 v118, v28, v29
    v_cvt_pk_bf16_f32 v119, v30, v31
    v_cvt_pk_bf16_f32 v120, v32, v33
    v_cvt_pk_bf16_f32 v121, v34, v35
    v_cvt_pk_bf16_f32 v122, v36, v37
    v_cvt_pk_bf16_f32 v123, v38, v39
    v_cvt_pk_bf16_f32 v124, v40, v41
    v_cvt_pk_bf16_f32 v125, v42, v43
    v_cvt_pk_bf16_f32 v126, v44, v45
    v_cvt_pk_bf16_f32 v127, v46, v47
    v_cvt_pk_bf16_f32 v128, v48, v49
    v_cvt_pk_bf16_f32 v129, v50, v51
    v_cvt_pk_bf16_f32 v130, v52, v53
    v_cvt_pk_bf16_f32 v131, v54, v55
    v_cvt_pk_bf16_f32 v132, v56, v57
    v_cvt_pk_bf16_f32 v133, v58, v59
    v_cvt_pk_bf16_f32 v134, v60, v61
    v_cvt_pk_bf16_f32 v135, v62, v63
    v_cvt_pk_bf16_f32 v136, v64, v65
    v_cvt_pk_bf16_f32 v137, v66, v67
    v_cvt_pk_bf16_f32 v138, v68, v69
    v_cvt_pk_bf16_f32 v139, v70, v71
    v_cvt_pk_bf16_f32 v140, v72, v73
    v_cvt_pk_bf16_f32 v141, v74, v75
    v_cvt_pk_bf16_f32 v142, v76, v77
    v_cvt_pk_bf16_f32 v143, v78, v79
    buffer_store_dwordx4 v[112:115], v6, s[4:7], s35 offen offset:0 sc1
    buffer_store_dwordx4 v[116:119], v6, s[4:7], s35 offen offset:512 sc1
    buffer_store_dwordx4 v[120:123], v6, s[4:7], s35 offen offset:1024 sc1
    buffer_store_dwordx4 v[124:127], v6, s[4:7], s35 offen offset:1536 sc1
    buffer_store_dwordx4 v[128:131], v6, s[4:7], s35 offen offset:2048 sc1
    buffer_store_dwordx4 v[132:135], v6, s[4:7], s35 offen offset:2560 sc1
    buffer_store_dwordx4 v[136:139], v6, s[4:7], s35 offen offset:3072 sc1
    buffer_store_dwordx4 v[140:143], v6, s[4:7], s35 offen offset:3584 sc1
    s_waitcnt vmcnt(0)
    s_lshl_b32 s32, s28, 5
    s_add_u32 s32, s32, s29
    s_lshl_b32 s32, s32, 2
    s_add_u32 s32, s32, 1171456
    v_mov_b32 v8, s49
    s_mov_b64 exec, 1
    buffer_store_dword v8, off, s[4:7], s32 sc1
    s_mov_b64 exec, -1
F_172:
    s_add_u32 s49, s49, 1
    s_add_u32 s44, s44, 4
    s_cmp_lt_u32 s44, 64
    s_cbranch_scc1 AT_169
R_166:
    s_cmp_ge_u32 s28, 120
    s_cbranch_scc1 R_173
    s_mul_i32 s68, s28, 3277
    s_lshr_b32 s68, s68, 16
    s_mul_i32 s69, s68, 20
    s_sub_u32 s69, s28, s69
    s_load_dwordx2 s[16:17], s[0:1], 64
    s_mov_b32 s18, 5242880
    s_mov_b32 s19, 0x20000
    s_waitcnt lgkmcnt(0)
    v_bfe_u32 v2, v1, 2, 4
    v_mul_u32_u24 v2, 1280, v2
    v_bfe_u32 v8, v1, 0, 2
    v_lshl_add_u32 v2, v8, 4, v2
    s_lshl_b32 s36, s29, 14
    v_bfe_u32 v3, v1, 4, 2
    v_mul_u32_u24 v3, 512, v3
    v_bfe_u32 v8, v1, 2, 2
    v_lshl_add_u32 v3, v8, 6, v3
    v_bfe_u32 v8, v1, 0, 2
    v_lshl_add_u32 v3, v8, 4, v3
    v_add_u32 v3, s36, v3
    s_mul_i32 s34, s29, 1310720
    s_lshl_b32 s35, s69, 6
    s_add_u32 s34, s34, s35
    s_add_u32 m0, s36, 0
    s_add_u32 s35, s34, 0
    buffer_load_dwordx4 v2, s[16:19], s35 offen lds
    s_add_u32 m0, s36, 1024
    s_add_u32 s35, s34, 20480
    buffer_load_dwordx4 v2, s[16:19], s35 offen lds
    s_add_u32 m0, s36, 2048
    s_add_u32 s35, s34, 40960
    buffer_load_dwordx4 v2, s[16:19], s35 offen lds
    s_add_u32 m0, s36, 3072
    s_add_u32 s35, s34, 61440
    buffer_load_dwordx4 v2, s[16:19], s35 offen lds
    s_add_u32 m0, s36, 4096
    s_add_u32 s35, s34, 81920
    buffer_load_dwordx4 v2, s[16:19], s35 offen lds
    s_add_u32 m0, s36, 5120
    s_add_u32 s35, s34, 102400
    buffer_load_dwordx4 v2, s[16:19], s35 offen lds
    s_add_u32 m0, s36, 6144
    s_add_u32 s35, s34, 122880
    buffer_load_dwordx4 v2, s[16:19], s35 offen lds
    s_add_u32 m0, s36, 7168
    s_add_u32 s35, s34, 143360
    buffer_load_dwordx4 v2, s[16:19], s35 offen lds
    s_add_u32 m0, s36, 8192
    s_add_u32 s35, s34, 163840
    buffer_load_dwordx4 v2, s[16:19], s35 offen lds
    s_add_u32 m0, s36, 9216
    s_add_u32 s35, s34, 184320
    buffer_load_dwordx4 v2, s[16:19], s35 offen lds
    s_add_u32 m0, s36, 10240
    s_add_u32 s35, s34, 204800
    buffer_load_dwordx4 v2, s[16:19], s35 offen lds
    s_add_u32 m0, s36, 11264
    s_add_u32 s35, s34, 225280
    buffer_load_dwordx4 v2, s[16:19], s35 offen lds
    s_add_u32 m0, s36, 12288
    s_add_u32 s35, s34, 245760
    buffer_load_dwordx4 v2, s[16:19], s35 offen lds
    s_add_u32 m0, s36, 13312
    s_add_u32 s35, s34, 266240
    buffer_load_dwordx4 v2, s[16:19], s35 offen lds
    s_add_u32 m0, s36, 14336
    s_add_u32 s35, s34, 286720
    buffer_load_dwordx4 v2, s[16:19], s35 offen lds
    s_add_u32 m0, s36, 15360
    s_add_u32 s35, s34, 307200
    buffer_load_dwordx4 v2, s[16:19], s35 offen lds
    s_waitcnt vmcnt(0)
    ds_read_b64_tr_b16 v[96:97], v3 offset:0
    ds_read_b64_tr_b16 v[98:99], v3 offset:256
    ds_read_b64_tr_b16 v[100:101], v3 offset:8
    ds_read_b64_tr_b16 v[102:103], v3 offset:264
    ds_read_b64_tr_b16 v[104:105], v3 offset:2048
    ds_read_b64_tr_b16 v[106:107], v3 offset:2304
    ds_read_b64_tr_b16 v[108:109], v3 offset:2056
    ds_read_b64_tr_b16 v[110:111], v3 offset:2312
    ds_read_b64_tr_b16 v[112:113], v3 offset:4096
    ds_read_b64_tr_b16 v[114:115], v3 offset:4352
    ds_read_b64_tr_b16 v[116:117], v3 offset:4104
    ds_read_b64_tr_b16 v[118:119], v3 offset:4360
    ds_read_b64_tr_b16 v[120:121], v3 offset:6144
    ds_read_b64_tr_b16 v[122:123], v3 offset:6400
    ds_read_b64_tr_b16 v[124:125], v3 offset:6152
    ds_read_b64_tr_b16 v[126:127], v3 offset:6408
    ds_read_b64_tr_b16 v[128:129], v3 offset:8192
    ds_read_b64_tr_b16 v[130:131], v3 offset:8448
    ds_read_b64_tr_b16 v[132:133], v3 offset:8200
    ds_read_b64_tr_b16 v[134:135], v3 offset:8456
    ds_read_b64_tr_b16 v[136:137], v3 offset:10240
    ds_read_b64_tr_b16 v[138:139], v3 offset:10496
    ds_read_b64_tr_b16 v[140:141], v3 offset:10248
    ds_read_b64_tr_b16 v[142:143], v3 offset:10504
    ds_read_b64_tr_b16 v[144:145], v3 offset:12288
    ds_read_b64_tr_b16 v[146:147], v3 offset:12544
    ds_read_b64_tr_b16 v[148:149], v3 offset:12296
    ds_read_b64_tr_b16 v[150:151], v3 offset:12552
    ds_read_b64_tr_b16 v[152:153], v3 offset:14336
    ds_read_b64_tr_b16 v[154:155], v3 offset:14592
    ds_read_b64_tr_b16 v[156:157], v3 offset:14344
    ds_read_b64_tr_b16 v[158:159], v3 offset:14600
    s_waitcnt lgkmcnt(0)
    s_add_u32 m0, s36, 0
    s_add_u32 s35, s34, 327680
    buffer_load_dwordx4 v2, s[16:19], s35 offen lds
    s_add_u32 m0, s36, 1024
    s_add_u32 s35, s34, 348160
    buffer_load_dwordx4 v2, s[16:19], s35 offen lds
    s_add_u32 m0, s36, 2048
    s_add_u32 s35, s34, 368640
    buffer_load_dwordx4 v2, s[16:19], s35 offen lds
    s_add_u32 m0, s36, 3072
    s_add_u32 s35, s34, 389120
    buffer_load_dwordx4 v2, s[16:19], s35 offen lds
    s_add_u32 m0, s36, 4096
    s_add_u32 s35, s34, 409600
    buffer_load_dwordx4 v2, s[16:19], s35 offen lds
    s_add_u32 m0, s36, 5120
    s_add_u32 s35, s34, 430080
    buffer_load_dwordx4 v2, s[16:19], s35 offen lds
    s_add_u32 m0, s36, 6144
    s_add_u32 s35, s34, 450560
    buffer_load_dwordx4 v2, s[16:19], s35 offen lds
    s_add_u32 m0, s36, 7168
    s_add_u32 s35, s34, 471040
    buffer_load_dwordx4 v2, s[16:19], s35 offen lds
    s_add_u32 m0, s36, 8192
    s_add_u32 s35, s34, 491520
    buffer_load_dwordx4 v2, s[16:19], s35 offen lds
    s_add_u32 m0, s36, 9216
    s_add_u32 s35, s34, 512000
    buffer_load_dwordx4 v2, s[16:19], s35 offen lds
    s_add_u32 m0, s36, 10240
    s_add_u32 s35, s34, 532480
    buffer_load_dwordx4 v2, s[16:19], s35 offen lds
    s_add_u32 m0, s36, 11264
    s_add_u32 s35, s34, 552960
    buffer_load_dwordx4 v2, s[16:19], s35 offen lds
    s_add_u32 m0, s36, 12288
    s_add_u32 s35, s34, 573440
    buffer_load_dwordx4 v2, s[16:19], s35 offen lds
    s_add_u32 m0, s36, 13312
    s_add_u32 s35, s34, 593920
    buffer_load_dwordx4 v2, s[16:19], s35 offen lds
    s_add_u32 m0, s36, 14336
    s_add_u32 s35, s34, 614400
    buffer_load_dwordx4 v2, s[16:19], s35 offen lds
    s_add_u32 m0, s36, 15360
    s_add_u32 s35, s34, 634880
    buffer_load_dwordx4 v2, s[16:19], s35 offen lds
    s_waitcnt vmcnt(0)
    ds_read_b64_tr_b16 v[160:161], v3 offset:0
    ds_read_b64_tr_b16 v[162:163], v3 offset:256
    ds_read_b64_tr_b16 v[164:165], v3 offset:8
    ds_read_b64_tr_b16 v[166:167], v3 offset:264
    ds_read_b64_tr_b16 v[168:169], v3 offset:2048
    ds_read_b64_tr_b16 v[170:171], v3 offset:2304
    ds_read_b64_tr_b16 v[172:173], v3 offset:2056
    ds_read_b64_tr_b16 v[174:175], v3 offset:2312
    ds_read_b64_tr_b16 v[176:177], v3 offset:4096
    ds_read_b64_tr_b16 v[178:179], v3 offset:4352
    ds_read_b64_tr_b16 v[180:181], v3 offset:4104
    ds_read_b64_tr_b16 v[182:183], v3 offset:4360
    ds_read_b64_tr_b16 v[184:185], v3 offset:6144
    ds_read_b64_tr_b16 v[186:187], v3 offset:6400
    ds_read_b64_tr_b16 v[188:189], v3 offset:6152
    ds_read_b64_tr_b16 v[190:191], v3 offset:6408
    ds_read_b64_tr_b16 v[192:193], v3 offset:8192
    ds_read_b64_tr_b16 v[194:195], v3 offset:8448
    ds_read_b64_tr_b16 v[196:197], v3 offset:8200
    ds_read_b64_tr_b16 v[198:199], v3 offset:8456
    ds_read_b64_tr_b16 v[200:201], v3 offset:10240
    ds_read_b64_tr_b16 v[202:203], v3 offset:10496
    ds_read_b64_tr_b16 v[204:205], v3 offset:10248
    ds_read_b64_tr_b16 v[206:207], v3 offset:10504
    ds_read_b64_tr_b16 v[208:209], v3 offset:12288
    ds_read_b64_tr_b16 v[210:211], v3 offset:12544
    ds_read_b64_tr_b16 v[212:213], v3 offset:12296
    ds_read_b64_tr_b16 v[214:215], v3 offset:12552
    ds_read_b64_tr_b16 v[216:217], v3 offset:14336
    ds_read_b64_tr_b16 v[218:219], v3 offset:14592
    ds_read_b64_tr_b16 v[220:221], v3 offset:14344
    ds_read_b64_tr_b16 v[222:223], v3 offset:14600
    s_waitcnt lgkmcnt(0)
    s_add_u32 m0, s36, 0
    s_add_u32 s35, s34, 655360
    buffer_load_dwordx4 v2, s[16:19], s35 offen lds
    s_add_u32 m0, s36, 1024
    s_add_u32 s35, s34, 675840
    buffer_load_dwordx4 v2, s[16:19], s35 offen lds
    s_add_u32 m0, s36, 2048
    s_add_u32 s35, s34, 696320
    buffer_load_dwordx4 v2, s[16:19], s35 offen lds
    s_add_u32 m0, s36, 3072
    s_add_u32 s35, s34, 716800
    buffer_load_dwordx4 v2, s[16:19], s35 offen lds
    s_add_u32 m0, s36, 4096
    s_add_u32 s35, s34, 737280
    buffer_load_dwordx4 v2, s[16:19], s35 offen lds
    s_add_u32 m0, s36, 5120
    s_add_u32 s35, s34, 757760
    buffer_load_dwordx4 v2, s[16:19], s35 offen lds
    s_add_u32 m0, s36, 6144
    s_add_u32 s35, s34, 778240
    buffer_load_dwordx4 v2, s[16:19], s35 offen lds
    s_add_u32 m0, s36, 7168
    s_add_u32 s35, s34, 798720
    buffer_load_dwordx4 v2, s[16:19], s35 offen lds
    s_add_u32 m0, s36, 8192
    s_add_u32 s35, s34, 819200
    buffer_load_dwordx4 v2, s[16:19], s35 offen lds
    s_add_u32 m0, s36, 9216
    s_add_u32 s35, s34, 839680
    buffer_load_dwordx4 v2, s[16:19], s35 offen lds
    s_add_u32 m0, s36, 10240
    s_add_u32 s35, s34, 860160
    buffer_load_dwordx4 v2, s[16:19], s35 offen lds
    s_add_u32 m0, s36, 11264
    s_add_u32 s35, s34, 880640
    buffer_load_dwordx4 v2, s[16:19], s35 offen lds
    s_add_u32 m0, s36, 12288
    s_add_u32 s35, s34, 901120
    buffer_load_dwordx4 v2, s[16:19], s35 offen lds
    s_add_u32 m0, s36, 13312
    s_add_u32 s35, s34, 921600
    buffer_load_dwordx4 v2, s[16:19], s35 offen lds
    s_add_u32 m0, s36, 14336
    s_add_u32 s35, s34, 942080
    buffer_load_dwordx4 v2, s[16:19], s35 offen lds
    s_add_u32 m0, s36, 15360
    s_add_u32 s35, s34, 962560
    buffer_load_dwordx4 v2, s[16:19], s35 offen lds
    s_waitcnt vmcnt(0)
    ds_read_b64_tr_b16 v[224:225], v3 offset:0
    ds_read_b64_tr_b16 v[226:227], v3 offset:256
    ds_read_b64_tr_b16 v[228:229], v3 offset:8
    ds_read_b64_tr_b16 v[230:231], v3 offset:264
    ds_read_b64_tr_b16 v[232:233], v3 offset:2048
    ds_read_b64_tr_b16 v[234:235], v3 offset:2304
    ds_read_b64_tr_b16 v[236:237], v3 offset:2056
    ds_read_b64_tr_b16 v[238:239], v3 offset:2312
    ds_read_b64_tr_b16 v[240:241], v3 offset:4096
    ds_read_b64_tr_b16 v[242:243], v3 offset:4352
    ds_read_b64_tr_b16 v[244:245], v3 offset:4104
    ds_read_b64_tr_b16 v[246:247], v3 offset:4360
    ds_read_b64_tr_b16 v[248:249], v3 offset:6144
    ds_read_b64_tr_b16 v[250:251], v3 offset:6400
    ds_read_b64_tr_b16 v[252:253], v3 offset:6152
    ds_read_b64_tr_b16 v[254:255], v3 offset:6408
    ds_read_b64_tr_b16 a[160:161], v3 offset:8192
    ds_read_b64_tr_b16 a[162:163], v3 offset:8448
    ds_read_b64_tr_b16 a[164:165], v3 offset:8200
    ds_read_b64_tr_b16 a[166:167], v3 offset:8456
    ds_read_b64_tr_b16 a[168:169], v3 offset:10240
    ds_read_b64_tr_b16 a[170:171], v3 offset:10496
    ds_read_b64_tr_b16 a[172:173], v3 offset:10248
    ds_read_b64_tr_b16 a[174:175], v3 offset:10504
    ds_read_b64_tr_b16 a[176:177], v3 offset:12288
    ds_read_b64_tr_b16 a[178:179], v3 offset:12544
    ds_read_b64_tr_b16 a[180:181], v3 offset:12296
    ds_read_b64_tr_b16 a[182:183], v3 offset:12552
    ds_read_b64_tr_b16 a[184:185], v3 offset:14336
    ds_read_b64_tr_b16 a[186:187], v3 offset:14592
    ds_read_b64_tr_b16 a[188:189], v3 offset:14344
    ds_read_b64_tr_b16 a[190:191], v3 offset:14600
    s_waitcnt lgkmcnt(0)
    s_add_u32 m0, s36, 0
    s_add_u32 s35, s34, 983040
    buffer_load_dwordx4 v2, s[16:19], s35 offen lds
    s_add_u32 m0, s36, 1024
    s_add_u32 s35, s34, 1003520
    buffer_load_dwordx4 v2, s[16:19], s35 offen lds
    s_add_u32 m0, s36, 2048
    s_add_u32 s35, s34, 1024000
    buffer_load_dwordx4 v2, s[16:19], s35 offen lds
    s_add_u32 m0, s36, 3072
    s_add_u32 s35, s34, 1044480
    buffer_load_dwordx4 v2, s[16:19], s35 offen lds
    s_add_u32 m0, s36, 4096
    s_add_u32 s35, s34, 1064960
    buffer_load_dwordx4 v2, s[16:19], s35 offen lds
    s_add_u32 m0, s36, 5120
    s_add_u32 s35, s34, 1085440
    buffer_load_dwordx4 v2, s[16:19], s35 offen lds
    s_add_u32 m0, s36, 6144
    s_add_u32 s35, s34, 1105920
    buffer_load_dwordx4 v2, s[16:19], s35 offen lds
    s_add_u32 m0, s36, 7168
    s_add_u32 s35, s34, 1126400
    buffer_load_dwordx4 v2, s[16:19], s35 offen lds
    s_add_u32 m0, s36, 8192
    s_add_u32 s35, s34, 1146880
    buffer_load_dwordx4 v2, s[16:19], s35 offen lds
    s_add_u32 m0, s36, 9216
    s_add_u32 s35, s34, 1167360
    buffer_load_dwordx4 v2, s[16:19], s35 offen lds
    s_add_u32 m0, s36, 10240
    s_add_u32 s35, s34, 1187840
    buffer_load_dwordx4 v2, s[16:19], s35 offen lds
    s_add_u32 m0, s36, 11264
    s_add_u32 s35, s34, 1208320
    buffer_load_dwordx4 v2, s[16:19], s35 offen lds
    s_add_u32 m0, s36, 12288
    s_add_u32 s35, s34, 1228800
    buffer_load_dwordx4 v2, s[16:19], s35 offen lds
    s_add_u32 m0, s36, 13312
    s_add_u32 s35, s34, 1249280
    buffer_load_dwordx4 v2, s[16:19], s35 offen lds
    s_add_u32 m0, s36, 14336
    s_add_u32 s35, s34, 1269760
    buffer_load_dwordx4 v2, s[16:19], s35 offen lds
    s_add_u32 m0, s36, 15360
    s_add_u32 s35, s34, 1290240
    buffer_load_dwordx4 v2, s[16:19], s35 offen lds
    s_waitcnt vmcnt(0)
    ds_read_b64_tr_b16 a[192:193], v3 offset:0
    ds_read_b64_tr_b16 a[194:195], v3 offset:256
    ds_read_b64_tr_b16 a[196:197], v3 offset:8
    ds_read_b64_tr_b16 a[198:199], v3 offset:264
    ds_read_b64_tr_b16 a[200:201], v3 offset:2048
    ds_read_b64_tr_b16 a[202:203], v3 offset:2304
    ds_read_b64_tr_b16 a[204:205], v3 offset:2056
    ds_read_b64_tr_b16 a[206:207], v3 offset:2312
    ds_read_b64_tr_b16 a[208:209], v3 offset:4096
    ds_read_b64_tr_b16 a[210:211], v3 offset:4352
    ds_read_b64_tr_b16 a[212:213], v3 offset:4104
    ds_read_b64_tr_b16 a[214:215], v3 offset:4360
    ds_read_b64_tr_b16 a[216:217], v3 offset:6144
    ds_read_b64_tr_b16 a[218:219], v3 offset:6400
    ds_read_b64_tr_b16 a[220:221], v3 offset:6152
    ds_read_b64_tr_b16 a[222:223], v3 offset:6408
    ds_read_b64_tr_b16 a[224:225], v3 offset:8192
    ds_read_b64_tr_b16 a[226:227], v3 offset:8448
    ds_read_b64_tr_b16 a[228:229], v3 offset:8200
    ds_read_b64_tr_b16 a[230:231], v3 offset:8456
    ds_read_b64_tr_b16 a[232:233], v3 offset:10240
    ds_read_b64_tr_b16 a[234:235], v3 offset:10496
    ds_read_b64_tr_b16 a[236:237], v3 offset:10248
    ds_read_b64_tr_b16 a[238:239], v3 offset:10504
    ds_read_b64_tr_b16 a[240:241], v3 offset:12288
    ds_read_b64_tr_b16 a[242:243], v3 offset:12544
    ds_read_b64_tr_b16 a[244:245], v3 offset:12296
    ds_read_b64_tr_b16 a[246:247], v3 offset:12552
    ds_read_b64_tr_b16 a[248:249], v3 offset:14336
    ds_read_b64_tr_b16 a[250:251], v3 offset:14592
    ds_read_b64_tr_b16 a[252:253], v3 offset:14344
    ds_read_b64_tr_b16 a[254:255], v3 offset:14600
    s_waitcnt lgkmcnt(0)
    v_bfe_u32 v4, v1, 4, 2
    v_mul_u32_u24 v4, 512, v4
    v_bfe_u32 v8, v1, 0, 4
    v_lshl_add_u32 v4, v8, 4, v4
    v_bfe_u32 v5, v1, 0, 2
    v_mul_u32_u24 v5, 1280, v5
    v_bfe_u32 v8, v1, 2, 1
    v_mul_u32_u24 v8, 10240, v8
    v_add_u32 v5, v5, v8
    v_bfe_u32 v8, v1, 3, 1
    v_mul_u32_u24 v8, 5120, v8
    v_add_u32 v5, v5, v8
    v_bfe_u32 v8, v1, 4, 2
    v_lshl_add_u32 v5, v8, 4, v5
    s_lshl_b32 s34, s29, 10
    s_add_u32 s34, s34, 1186816
    v_bfe_u32 v6, v1, 0, 3
    v_mul_u32_u24 v6, 128, v6
    v_add_u32 v6, s34, v6
    s_lshl_b32 s34, s29, 11
    v_add_u32 v7, s34, v0
    s_mov_b32 s44, s68
    s_mov_b32 s49, 1
    s_mov_b32 s56, 0
    s_waitcnt vmcnt(0) lgkmcnt(0)
    s_barrier
G4_174:
    s_lshr_b32 s40, s44, 1
    s_and_b32 s41, s44, 1
    s_mul_i32 s42, s40, 40960
    s_lshl_b32 s34, s69, 11
    s_add_u32 s43, s42, s34
    s_lshl_b32 s34, s41, 8
    s_add_u32 s43, s43, s34
    s_mul_i32 s34, s30, 6291456
    s_add_u32 s34, s34, 11534336
    s_add_u32 s34, s34, s43
    buffer_load_dwordx4 v[24:27], v4, s[4:7], s34 offen sc1
    s_lshr_b32 s57, s40, 2
    s_add_u32 s57, s57, s61
    s_add_u32 s57, s57, 1
    s_and_b32 s34, s40, 3
    s_lshl_b32 s34, s34, 2
    s_mov_b32 s48, 0
P_178:
    buffer_load_dword v8, v6, s[4:7], s34 offen sc1
    s_waitcnt vmcnt(0)
    v_cmp_gt_u32 vcc, s57, v8
    s_cbranch_vccz P_179
    s_add_u32 s48, s48, 1
    s_cmp_gt_u32 s48, 200000
    s_cbranch_scc1 L_end
    s_sleep 1
    s_branch P_178
P_179:
    s_mul_i32 s54, s30, 16777216
    s_add_u32 s54, s54, 67108864
    s_lshl_b32 s34, s44, 17
    s_add_u32 s54, s54, s34
    s_lshl_b32 s34, s29, 15
    s_add_u32 s54, s54, s34
    buffer_load_dwordx4 v[32:35], v0, s[4:7], s54 offen offset:0 sc1
    buffer_load_dwordx4 v[36:39], v0, s[4:7], s54 offen offset:1024 sc1
    buffer_load_dwordx4 v[40:43], v0, s[4:7], s54 offen offset:2048 sc1
    buffer_load_dwordx4 v[44:47], v0, s[4:7], s54 offen offset:3072 sc1
    s_add_u32 s54, s54, 4096
    buffer_load_dwordx4 v[48:51], v0, s[4:7], s54 offen offset:0 sc1
    buffer_load_dwordx4 v[52:55], v0, s[4:7], s54 offen offset:1024 sc1
    buffer_load_dwordx4 v[56:59], v0, s[4:7], s54 offen offset:2048 sc1
    buffer_load_dwordx4 v[60:63], v0, s[4:7], s54 offen offset:3072 sc1
    s_add_u32 s54, s54, 4096
    buffer_load_dwordx4 v[64:67], v0, s[4:7], s54 offen offset:0 sc1
    buffer_load_dwordx4 v[68:71], v0, s[4:7], s54 offen offset:1024 sc1
    buffer_load_dwordx4 v[72:75], v0, s[4:7], s54 offen offset:2048 sc1
    buffer_load_dwordx4 v[76:79], v0, s[4:7], s54 offen offset:3072 sc1
    s_add_u32 s54, s54, 4096
    buffer_load_dwordx4 v[80:83], v0, s[4:7], s54 offen offset:0 sc1
    buffer_load_dwordx4 v[84:87], v0, s[4:7], s54 offen offset:1024 sc1
    buffer_load_dwordx4 v[88:91], v0, s[4:7], s54 offen offset:2048 sc1
    buffer_load_dwordx4 v[92:95], v0, s[4:7], s54 offen offset:3072 sc1
    s_waitcnt vmcnt(15)
    v_mfma_f32_16x16x32_bf16 v[16:19], v[96:99], v[32:35], 0
    v_mfma_f32_16x16x32_bf16 v[20:23], v[100:103], v[32:35], 0
    s_add_u32 s54, s54, 4096
    buffer_load_dwordx4 v[32:35], v0, s[4:7], s54 offen offset:0 sc1
    s_waitcnt vmcnt(15)
    v_mfma_f32_16x16x32_bf16 v[16:19], v[104:107], v[36:39], v[16:19]
    v_mfma_f32_16x16x32_bf16 v[20:23], v[108:111], v[36:39], v[20:23]
    buffer_load_dwordx4 v[36:39], v0, s[4:7], s54 offen offset:1024 sc1
    s_waitcnt vmcnt(15)
    v_mfma_f32_16x16x32_bf16 v[16:19], v[112:115], v[40:43], v[16:19]
    v_mfma_f32_16x16x32_bf16 v[20:23], v[116:119], v[40:43], v[20:23]
    buffer_load_dwordx4 v[40:43], v0, s[4:7], s54 offen offset:2048 sc1
    s_waitcnt vmcnt(15)
    v_mfma_f32_16x16x32_bf16 v[16:19], v[120:123], v[44:47], v[16:19]
    v_mfma_f32_16x16x32_bf16 v[20:23], v[124:127], v[44:47], v[20:23]
    buffer_load_dwordx4 v[44:47], v0, s[4:7], s54 offen offset:3072 sc1
    s_waitcnt vmcnt(15)
    v_mfma_f32_16x16x32_bf16 v[16:19], v[128:131], v[48:51], v[16:19]
    v_mfma_f32_16x16x32_bf16 v[20:23], v[132:135], v[48:51], v[20:23]
    s_add_u32 s54, s54, 4096
    buffer_load_dwordx4 v[48:51], v0, s[4:7], s54 offen offset:0 sc1
    s_waitcnt vmcnt(15)
    v_mfma_f32_16x16x32_bf16 v[16:19], v[136:139], v[52:55], v[16:19]
    v_mfma_f32_16x16x32_bf16 v[20:23], v[140:143], v[52:55], v[20:23]
    buffer_load_dwordx4 v[52:55], v0, s[4:7], s54 offen offset:1024 sc1
    s_waitcnt vmcnt(15)
    v_mfma_f32_16x16x32_bf16 v[16:19], v[144:147], v[56:59], v[16:19]
    v_mfma_f32_16x16x32_bf16 v[20:23], v[148:151], v[56:59], v[20:23]
    buffer_load_dwordx4 v[56:59], v0, s[4:7], s54 offen offset:2048 sc1
    s_waitcnt vmcnt(15)
    v_mfma_f32_16x16x32_bf16 v[16:19], v[152:155], v[60:63], v[16:19]
    v_mfma_f32_16x16x32_bf16 v[20:23], v[156:159], v[60:63], v[20:23]
    buffer_load_dwordx4 v[60:63], v0, s[4:7], s54 offen offset:3072 sc1
    s_waitcnt vmcnt(15)
    v_mfma_f32_16x16x32_bf16 v[16:19], v[160:163], v[64:67], v[16:19]
    v_mfma_f32_16x16x32_bf16 v[20:23], v[164:167], v[64:67], v[20:23]
    s_add_u32 s54, s54, 4096
    buffer_load_dwordx4 v[64:67], v0, s[4:7], s54 offen offset:0 sc1
    s_waitcnt vmcnt(15)
    v_mfma_f32_16x16x32_bf16 v[16:19], v[168:171], v[68:71], v[16:19]
    v_mfma_f32_16x16x32_bf16 v[20:23], v[172:175], v[68:71], v[20:23]
    buffer_load_dwordx4 v[68:71], v0, s[4:7], s54 offen offset:1024 sc1
    s_waitcnt vmcnt(15)
    v_mfma_f32_16x16x32_bf16 v[16:19], v[176:179], v[72:75], v[16:19]
    v_mfma_f32_16x16x32_bf16 v[20:23], v[180:183], v[72:75], v[20:23]
    buffer_load_dwordx4 v[72:75], v0, s[4:7], s54 offen offset:2048 sc1
    s_waitcnt vmcnt(15)
    v_mfma_f32_16x16x32_bf16 v[16:19], v[184:187], v[76:79], v[16:19]
    v_mfma_f32_16x16x32_bf16 v[20:23], v[188:191], v[76:79], v[20:23]
    buffer_load_dwordx4 v[76:79], v0, s[4:7], s54 offen offset:3072 sc1
    s_waitcnt vmcnt(15)
    v_mfma_f32_16x16x32_bf16 v[16:19], v[192:195], v[80:83], v[16:19]
    v_mfma_f32_16x16x32_bf16 v[20:23], v[196:199], v[80:83], v[20:23]
    s_add_u32 s54, s54, 4096
    buffer_load_dwordx4 v[80:83], v0, s[4:7], s54 offen offset:0 sc1
    s_waitcnt vmcnt(15)
    v_mfma_f32_16x16x32_bf16 v[16:19], v[200:203], v[84:87], v[16:19]
    v_mfma_f32_16x16x32_bf16 v[20:23], v[204:207], v[84:87], v[20:23]
    buffer_load_dwordx4 v[84:87], v0, s[4:7], s54 offen offset:1024 sc1
    s_waitcnt vmcnt(15)
    v_mfma_f32_16x16x32_bf16 v[16:19], v[208:211], v[88:91], v[16:19]
    v_mfma_f32_16x16x32_bf16 v[20:23], v[212:215], v[88:91], v[20:23]
    buffer_load_dwordx4 v[88:91], v0, s[4:7], s54 offen offset:2048 sc1
    s_waitcnt vmcnt(15)
    v_mfma_f32_16x16x32_bf16 v[16:19], v[216:219], v[92:95], v[16:19]
    v_mfma_f32_16x16x32_bf16 v[20:23], v[220:223], v[92:95], v[20:23]
    buffer_load_dwordx4 v[92:95], v0, s[4:7], s54 offen offset:3072 sc1
    s_waitcnt vmcnt(15)
    v_mfma_f32_16x16x32_bf16 v[16:19], v[224:227], v[32:35], v[16:19]
    v_mfma_f32_16x16x32_bf16 v[20:23], v[228:231], v[32:35], v[20:23]
    s_waitcnt vmcnt(14)
    v_mfma_f32_16x16x32_bf16 v[16:19], v[232:235], v[36:39], v[16:19]
    v_mfma_f32_16x16x32_bf16 v[20:23], v[236:239], v[36:39], v[20:23]
    s_waitcnt vmcnt(13)
    v_mfma_f32_16x16x32_bf16 v[16:19], v[240:243], v[40:43], v[16:19]
    v_mfma_f32_16x16x32_bf16 v[20:23], v[244:247], v[40:43], v[20:23]
    s_waitcnt vmcnt(12)
    v_mfma_f32_16x16x32_bf16 v[16:19], v[248:251], v[44:47], v[16:19]
    v_mfma_f32_16x16x32_bf16 v[20:23], v[252:255], v[44:47], v[20:23]
    s_waitcnt vmcnt(11)
    v_mfma_f32_16x16x32_bf16 v[16:19], a[160:163], v[48:51], v[16:19]
    v_mfma_f32_16x16x32_bf16 v[20:23], a[164:167], v[48:51], v[20:23]
    s_waitcnt vmcnt(10)
    v_mfma_f32_16x16x32_bf16 v[16:19], a[168:171], v[52:55], v[16:19]
    v_mfma_f32_16x16x32_bf16 v[20:23], a[172:175], v[52:55], v[20:23]
    s_waitcnt vmcnt(9)
    v_mfma_f32_16x16x32_bf16 v[16:19], a[176:179], v[56:59], v[16:19]
    v_mfma_f32_16x16x32_bf16 v[20:23], a[180:183], v[56:59], v[20:23]
    s_waitcnt vmcnt(8)
    v_mfma_f32_16x16x32_bf16 v[16:19], a[184:187], v[60:63], v[16:19]
    v_mfma_f32_16x16x32_bf16 v[20:23], a[188:191], v[60:63], v[20:23]
    s_waitcnt vmcnt(7)
    v_mfma_f32_16x16x32_bf16 v[16:19], a[192:195], v[64:67], v[16:19]
    v_mfma_f32_16x16x32_bf16 v[20:23], a[196:199], v[64:67], v[20:23]
    s_waitcnt vmcnt(6)
    v_mfma_f32_16x16x32_bf16 v[16:19], a[200:203], v[68:71], v[16:19]
    v_mfma_f32_16x16x32_bf16 v[20:23], a[204:207], v[68:71], v[20:23]
    s_waitcnt vmcnt(5)
    v_mfma_f32_16x16x32_bf16 v[16:19], a[208:211], v[72:75], v[16:19]
    v_mfma_f32_16x16x32_bf16 v[20:23], a[212:215], v[72:75], v[20:23]
    s_waitcnt vmcnt(4)
    v_mfma_f32_16x16x32_bf16 v[16:19], a[216:219], v[76:79], v[16:19]
    v_mfma_f32_16x16x32_bf16 v[20:23], a[220:223], v[76:79], v[20:23]
    s_waitcnt vmcnt(3)
    v_mfma_f32_16x16x32_bf16 v[16:19], a[224:227], v[80:83], v[16:19]
    v_mfma_f32_16x16x32_bf16 v[20:23], a[228:231], v[80:83], v[20:23]
    s_waitcnt vmcnt(2)
    v_mfma_f32_16x16x32_bf16 v[16:19], a[232:235], v[84:87], v[16:19]
    v_mfma_f32_16x16x32_bf16 v[20:23], a[236:239], v[84:87], v[20:23]
    s_waitcnt vmcnt(1)
    v_mfma_f32_16x16x32_bf16 v[16:19], a[240:243], v[88:91], v[16:19]
    v_mfma_f32_16x16x32_bf16 v[20:23], a[244:247], v[88:91], v[20:23]
    s_waitcnt vmcnt(0)
    v_mfma_f32_16x16x32_bf16 v[16:19], a[248:251], v[92:95], v[16:19]
    v_mfma_f32_16x16x32_bf16 v[20:23], a[252:255], v[92:95], v[20:23]
    v_add_u32 v8, s56, v7
    s_nop 2
    ds_write_b128 v8, v[16:19]
    s_nop 2
    ds_write_b128 v8, v[20:23] offset:1024
    s_waitcnt lgkmcnt(0)
    s_barrier
    s_cmp_lg_u32 s29, 0
    s_cbranch_scc1 G4_175
    ds_read_b128 v[32:35], v8 offset:2048
    ds_read_b128 v[36:39], v8 offset:3072
    ds_read_b128 v[40:43], v8 offset:4096
    ds_read_b128 v[44:47], v8 offset:5120
    ds_read_b128 v[48:51], v8 offset:6144
    ds_read_b128 v[52:55], v8 offset:7168
    s_waitcnt lgkmcnt(5)
    v_pk_add_f32 v[16:17], v[16:17], v[32:33]
    v_pk_add_f32 v[18:19], v[18:19], v[34:35]
    s_waitcnt lgkmcnt(4)
    v_pk_add_f32 v[20:21], v[20:21], v[36:37]
    v_pk_add_f32 v[22:23], v[22:23], v[38:39]
    s_waitcnt lgkmcnt(3)
    v_pk_add_f32 v[16:17], v[16:17], v[40:41]
    v_pk_add_f32 v[18:19], v[18:19], v[42:43]
    s_waitcnt lgkmcnt(2)
    v_pk_add_f32 v[20:21], v[20:21], v[44:45]
    v_pk_add_f32 v[22:23], v[22:23], v[46:47]
    s_waitcnt lgkmcnt(1)
    v_pk_add_f32 v[16:17], v[16:17], v[48:49]
    v_pk_add_f32 v[18:19], v[18:19], v[50:51]
    s_waitcnt lgkmcnt(0)
    v_pk_add_f32 v[20:21], v[20:21], v[52:53]
    v_pk_add_f32 v[22:23], v[22:23], v[54:55]
    v_cvt_pk_bf16_f32 v56, v16, v17
    v_cvt_pk_bf16_f32 v57, v18, v19
    v_cvt_pk_bf16_f32 v58, v20, v21
    v_cvt_pk_bf16_f32 v59, v22, v23
    v_lshlrev_b32 v32, 16, v56
    v_lshlrev_b32 v33, 16, v24
    v_and_b32 v34, 0xffff0000, v56
    v_and_b32 v35, 0xffff0000, v24
    v_add_f32 v32, v32, v33
    v_add_f32 v34, v34, v35
    v_cvt_pk_bf16_f32 v56, v32, v34
    v_lshlrev_b32 v32, 16, v57
    v_lshlrev_b32 v33, 16, v25
    v_and_b32 v34, 0xffff0000, v57
    v_and_b32 v35, 0xffff0000, v25
    v_add_f32 v32, v32, v33
    v_add_f32 v34, v34, v35
    v_cvt_pk_bf16_f32 v57, v32, v34
    v_lshlrev_b32 v32, 16, v58
    v_lshlrev_b32 v33, 16, v26
    v_and_b32 v34, 0xffff0000, v58
    v_and_b32 v35, 0xffff0000, v26
    v_add_f32 v32, v32, v33
    v_add_f32 v34, v34, v35
    v_cvt_pk_bf16_f32 v58, v32, v34
    v_lshlrev_b32 v32, 16, v59
    v_lshlrev_b32 v33, 16, v27
    v_and_b32 v34, 0xffff0000, v59
    v_and_b32 v35, 0xffff0000, v27
    v_add_f32 v32, v32, v33
    v_add_f32 v34, v34, v35
    v_cvt_pk_bf16_f32 v59, v32, v34
    s_cmp_lg_u32 s30, 0
    s_cbranch_scc1 G4_176
    s_add_u32 s34, s43, 14680064
    buffer_store_dwordx4 v[56:59], v4, s[4:7], s34 offen sc1
    s_waitcnt vmcnt(0)
    s_cmp_lg_u32 s29, 0
    s_cbranch_scc1 F_180
    s_lshl_b32 s32, s28, 5
    s_add_u32 s32, s32, s29
    s_lshl_b32 s32, s32, 2
    s_add_u32 s32, s32, 1196032
    v_mov_b32 v8, s49
    s_mov_b64 exec, 1
    buffer_store_dword v8, off, s[4:7], s32 sc1
    s_mov_b64 exec, -1
F_180:
    s_branch G4_175
G4_176:
    s_mul_i32 s34, s41, 20480
    s_add_u32 s34, s34, s42
    s_lshl_b32 s35, s69, 6
    s_add_u32 s34, s34, s35
    buffer_store_dwordx4 v[56:59], v5, s[12:15], s34 offen
G4_175:
    s_xor_b32 s56, s56, 8192
    s_add_u32 s49, s49, 1
    s_add_u32 s44, s44, 6
    s_cmp_lt_u32 s44, 128
    s_cbranch_scc1 G4_174
    s_waitcnt vmcnt(0)
    s_barrier
R_173:
    s_cmp_lg_u32 s30, 0
    s_cbranch_scc1 L_end
    s_cmp_lt_u32 s28, 160
    s_cbranch_scc1 R_181
    s_cmp_ge_u32 s28, 190
    s_cbranch_scc1 R_181
    s_mov_b32 s35, 0x3acccccd
    s_lshl_b32 s34, s67, 6
    s_add_u32 s34, s34, 0
    s_lshr_b32 s34, s34, 1
    s_add_u32 s34, s34, 1
    v_bfe_u32 v173, v1, 1, 4
    v_add_u32 v173, s34, v173
    s_mul_i32 s36, s29, 160
    v_bfe_u32 v172, v1, 5, 1
    v_mul_u32_u24 v172, 8, v172
    v_add_u32 v172, s36, v172
    v_mul_u32_u24 v172, v172, v173
    v_and_b32 v174, 1, v1
    v_mul_u32_u24 v174, 160, v174
    v_add_u32 v172, v172, v174
    v_cvt_f32_u32 v172, v172
    v_cvt_f32_u32 v173, v173
    v_mul_f32 v172, s35, v172
    v_mul_f32 v173, s35, v173
    v_fract_f32 v172, v172
    v_fmamk_f32 v174, v173, 0x0, v172
    v_fmamk_f32 v175, v173, 0x3f800000, v172
    v_cos_f32 v175, v175
    v_cos_f32 v174, v174
    s_nop 0
    v_cvt_pk_bf16_f32 v178, v174, v175
    v_fmamk_f32 v176, v173, 0x40000000, v172
    v_fmamk_f32 v177, v173, 0x40400000, v172
    v_cos_f32 v177, v177
    v_cos_f32 v176, v176
    v_accvgpr_write_b32 a160, v178
    v_cvt_pk_bf16_f32 v178, v176, v177
    v_fmamk_f32 v174, v173, 0x40800000, v172
    v_fmamk_f32 v175, v173, 0x40a00000, v172
    v_cos_f32 v175, v175
    v_cos_f32 v174, v174
    v_accvgpr_write_b32 a161, v178
    v_cvt_pk_bf16_f32 v178, v174, v175
    v_fmamk_f32 v176, v173, 0x40c00000, v172
    v_fmamk_f32 v177, v173, 0x40e00000, v172
    v_cos_f32 v177, v177
    v_cos_f32 v176, v176
    v_accvgpr_write_b32 a162, v178
    v_cvt_pk_bf16_f32 v178, v176, v177
    v_fmamk_f32 v174, v173, 0x41800000, v172
    v_fmamk_f32 v175, v173, 0x41880000, v172
    v_cos_f32 v175, v175
    v_cos_f32 v174, v174
    v_accvgpr_write_b32 a163, v178
    v_cvt_pk_bf16_f32 v178, v174, v175
    v_fmamk_f32 v176, v173, 0x41900000, v172
    v_fmamk_f32 v177, v173, 0x41980000, v172
    v_cos_f32 v177, v177
    v_cos_f32 v176, v176
    v_accvgpr_write_b32 a164, v178
    v_cvt_pk_bf16_f32 v178, v176, v177
    v_fmamk_f32 v174, v173, 0x41a00000, v172
    v_fmamk_f32 v175, v173, 0x41a80000, v172
    v_cos_f32 v175, v175
    v_cos_f32 v174, v174
    v_accvgpr_write_b32 a165, v178
    v_cvt_pk_bf16_f32 v178, v174, v175
    v_fmamk_f32 v176, v173, 0x41b00000, v172
    v_fmamk_f32 v177, v173, 0x41b80000, v172
    v_cos_f32 v177, v177
    v_cos_f32 v176, v176
    v_accvgpr_write_b32 a166, v178
    v_cvt_pk_bf16_f32 v178, v176, v177
    v_fmamk_f32 v174, v173, 0x42000000, v172
    v_fmamk_f32 v175, v173, 0x42040000, v172
    v_cos_f32 v175, v175
    v_cos_f32 v174, v174
    v_accvgpr_write_b32 a167, v178
    v_cvt_pk_bf16_f32 v178, v174, v175
    v_fmamk_f32 v176, v173, 0x42080000, v172
    v_fmamk_f32 v177, v173, 0x420c0000, v172
    v_cos_f32 v177, v177
    v_cos_f32 v176, v176
    v_accvgpr_write_b32 a168, v178
    v_cvt_pk_bf16_f32 v178, v176, v177
    v_fmamk_f32 v174, v173, 0x42100000, v172
    v_fmamk_f32 v175, v173, 0x42140000, v172
    v_cos_f32 v175, v175
    v_cos_f32 v174, v174
    v_accvgpr_write_b32 a169, v178
    v_cvt_pk_bf16_f32 v178, v174, v175
    v_fmamk_f32 v176, v173, 0x42180000, v172
    v_fmamk_f32 v177, v173, 0x421c0000, v172
    v_cos_f32 v177, v177
    v_cos_f32 v176, v176
    v_accvgpr_write_b32 a170, v178
    v_cvt_pk_bf16_f32 v178, v176, v177
    v_fmamk_f32 v174, v173, 0x42400000, v172
    v_fmamk_f32 v175, v173, 0x42440000, v172
    v_cos_f32 v175, v175
    v_cos_f32 v174, v174
    v_accvgpr_write_b32 a171, v178
    v_cvt_pk_bf16_f32 v178, v174, v175
    v_fmamk_f32 v176, v173, 0x42480000, v172
    v_fmamk_f32 v177, v173, 0x424c0000, v172
    v_cos_f32 v177, v177
    v_cos_f32 v176, v176
    v_accvgpr_write_b32 a172, v178
    v_cvt_pk_bf16_f32 v178, v176, v177
    v_fmamk_f32 v174, v173, 0x42500000, v172
    v_fmamk_f32 v175, v173, 0x42540000, v172
    v_cos_f32 v175, v175
    v_cos_f32 v174, v174
    v_accvgpr_write_b32 a173, v178
    v_cvt_pk_bf16_f32 v178, v174, v175
    v_fmamk_f32 v176, v173, 0x42580000, v172
    v_fmamk_f32 v177, v173, 0x425c0000, v172
    v_cos_f32 v177, v177
    v_cos_f32 v176, v176
    v_accvgpr_write_b32 a174, v178
    v_cvt_pk_bf16_f32 v178, v176, v177
    v_fmamk_f32 v174, v173, 0x42800000, v172
    v_fmamk_f32 v175, v173, 0x42820000, v172
    v_cos_f32 v175, v175
    v_cos_f32 v174, v174
    v_accvgpr_write_b32 a175, v178
    v_cvt_pk_bf16_f32 v178, v174, v175
    v_fmamk_f32 v176, v173, 0x42840000, v172
    v_fmamk_f32 v177, v173, 0x42860000, v172
    v_cos_f32 v177, v177
    v_cos_f32 v176, v176
    v_accvgpr_write_b32 a176, v178
    v_cvt_pk_bf16_f32 v178, v176, v177
    v_fmamk_f32 v174, v173, 0x42880000, v172
    v_fmamk_f32 v175, v173, 0x428a0000, v172
    v_cos_f32 v175, v175
    v_cos_f32 v174, v174
    v_accvgpr_write_b32 a177, v178
    v_cvt_pk_bf16_f32 v178, v174, v175
    v_fmamk_f32 v176, v173, 0x428c0000, v172
    v_fmamk_f32 v177, v173, 0x428e0000, v172
    v_cos_f32 v177, v177
    v_cos_f32 v176, v176
    v_accvgpr_write_b32 a178, v178
    v_cvt_pk_bf16_f32 v178, v176, v177
    v_fmamk_f32 v174, v173, 0x42a00000, v172
    v_fmamk_f32 v175, v173, 0x42a20000, v172
    v_cos_f32 v175, v175
    v_cos_f32 v174, v174
    v_accvgpr_write_b32 a179, v178
    v_cvt_pk_bf16_f32 v178, v174, v175
    v_fmamk_f32 v176, v173, 0x42a40000, v172
    v_fmamk_f32 v177, v173, 0x42a60000, v172
    v_cos_f32 v177, v177
    v_cos_f32 v176, v176
    v_accvgpr_write_b32 a180, v178
    v_cvt_pk_bf16_f32 v178, v176, v177
    v_fmamk_f32 v174, v173, 0x42a80000, v172
    v_fmamk_f32 v175, v173, 0x42aa0000, v172
    v_cos_f32 v175, v175
    v_cos_f32 v174, v174
    v_accvgpr_write_b32 a181, v178
    v_cvt_pk_bf16_f32 v178, v174, v175
    v_fmamk_f32 v176, v173, 0x42ac0000, v172
    v_fmamk_f32 v177, v173, 0x42ae0000, v172
    v_cos_f32 v177, v177
    v_cos_f32 v176, v176
    v_accvgpr_write_b32 a182, v178
    v_cvt_pk_bf16_f32 v178, v176, v177
    v_fmamk_f32 v174, v173, 0x42c00000, v172
    v_fmamk_f32 v175, v173, 0x42c20000, v172
    v_cos_f32 v175, v175
    v_cos_f32 v174, v174
    v_accvgpr_write_b32 a183, v178
    v_cvt_pk_bf16_f32 v178, v174, v175
    v_fmamk_f32 v176, v173, 0x42c40000, v172
    v_fmamk_f32 v177, v173, 0x42c60000, v172
    v_cos_f32 v177, v177
    v_cos_f32 v176, v176
    v_accvgpr_write_b32 a184, v178
    v_cvt_pk_bf16_f32 v178, v176, v177
    v_fmamk_f32 v174, v173, 0x42c80000, v172
    v_fmamk_f32 v175, v173, 0x42ca0000, v172
    v_cos_f32 v175, v175
    v_cos_f32 v174, v174
    v_accvgpr_write_b32 a185, v178
    v_cvt_pk_bf16_f32 v178, v174, v175
    v_fmamk_f32 v176, v173, 0x42cc0000, v172
    v_fmamk_f32 v177, v173, 0x42ce0000, v172
    v_cos_f32 v177, v177
    v_cos_f32 v176, v176
    v_accvgpr_write_b32 a186, v178
    v_cvt_pk_bf16_f32 v178, v176, v177
    v_fmamk_f32 v174, v173, 0x42e00000, v172
    v_fmamk_f32 v175, v173, 0x42e20000, v172
    v_cos_f32 v175, v175
    v_cos_f32 v174, v174
    v_accvgpr_write_b32 a187, v178
    v_cvt_pk_bf16_f32 v178, v174, v175
    v_fmamk_f32 v176, v173, 0x42e40000, v172
    v_fmamk_f32 v177, v173, 0x42e60000, v172
    v_cos_f32 v177, v177
    v_cos_f32 v176, v176
    v_accvgpr_write_b32 a188, v178
    v_cvt_pk_bf16_f32 v178, v176, v177
    v_fmamk_f32 v174, v173, 0x42e80000, v172
    v_fmamk_f32 v175, v173, 0x42ea0000, v172
    v_cos_f32 v175, v175
    v_cos_f32 v174, v174
    v_accvgpr_write_b32 a189, v178
    v_cvt_pk_bf16_f32 v178, v174, v175
    v_fmamk_f32 v176, v173, 0x42ec0000, v172
    v_fmamk_f32 v177, v173, 0x42ee0000, v172
    v_cos_f32 v177, v177
    v_cos_f32 v176, v176
    v_accvgpr_write_b32 a190, v178
    v_cvt_pk_bf16_f32 v178, v176, v177
    v_fmamk_f32 v174, v173, 0x43000000, v172
    v_fmamk_f32 v175, v173, 0x43010000, v172
    v_cos_f32 v175, v175
    v_cos_f32 v174, v174
    v_accvgpr_write_b32 a191, v178
    v_cvt_pk_bf16_f32 v178, v174, v175
    v_fmamk_f32 v176, v173, 0x43020000, v172
    v_fmamk_f32 v177, v173, 0x43030000, v172
    v_cos_f32 v177, v177
    v_cos_f32 v176, v176
    v_accvgpr_write_b32 a192, v178
    v_cvt_pk_bf16_f32 v178, v176, v177
    v_fmamk_f32 v174, v173, 0x43040000, v172
    v_fmamk_f32 v175, v173, 0x43050000, v172
    v_cos_f32 v175, v175
    v_cos_f32 v174, v174
    v_accvgpr_write_b32 a193, v178
    v_cvt_pk_bf16_f32 v178, v174, v175
    v_fmamk_f32 v176, v173, 0x43060000, v172
    v_fmamk_f32 v177, v173, 0x43070000, v172
    v_cos_f32 v177, v177
    v_cos_f32 v176, v176
    v_accvgpr_write_b32 a194, v178
    v_cvt_pk_bf16_f32 v178, v176, v177
    v_fmamk_f32 v174, v173, 0x43100000, v172
    v_fmamk_f32 v175, v173, 0x43110000, v172
    v_cos_f32 v175, v175
    v_cos_f32 v174, v174
    v_accvgpr_write_b32 a195, v178
    v_cvt_pk_bf16_f32 v178, v174, v175
    v_fmamk_f32 v176, v173, 0x43120000, v172
    v_fmamk_f32 v177, v173, 0x43130000, v172
    v_cos_f32 v177, v177
    v_cos_f32 v176, v176
    v_accvgpr_write_b32 a196, v178
    v_cvt_pk_bf16_f32 v178, v176, v177
    v_fmamk_f32 v174, v173, 0x43140000, v172
    v_fmamk_f32 v175, v173, 0x43150000, v172
    v_cos_f32 v175, v175
    v_cos_f32 v174, v174
    v_accvgpr_write_b32 a197, v178
    v_cvt_pk_bf16_f32 v178, v174, v175
    v_fmamk_f32 v176, v173, 0x43160000, v172
    v_fmamk_f32 v177, v173, 0x43170000, v172
    v_cos_f32 v177, v177
    v_cos_f32 v176, v176
    v_accvgpr_write_b32 a198, v178
    v_cvt_pk_bf16_f32 v178, v176, v177
    v_accvgpr_write_b32 a199, v178
    s_lshl_b32 s34, s67, 6
    s_add_u32 s34, s34, 32
    s_lshr_b32 s34, s34, 1
    s_add_u32 s34, s34, 1
    v_bfe_u32 v173, v1, 1, 4
    v_add_u32 v173, s34, v173
    s_mul_i32 s36, s29, 160
    v_bfe_u32 v172, v1, 5, 1
    v_mul_u32_u24 v172, 8, v172
    v_add_u32 v172, s36, v172
    v_mul_u32_u24 v172, v172, v173
    v_and_b32 v174, 1, v1
    v_mul_u32_u24 v174, 160, v174
    v_add_u32 v172, v172, v174
    v_cvt_f32_u32 v172, v172
    v_cvt_f32_u32 v173, v173
    v_mul_f32 v172, s35, v172
    v_mul_f32 v173, s35, v173
    v_fract_f32 v172, v172
    v_fmamk_f32 v174, v173, 0x0, v172
    v_fmamk_f32 v175, v173, 0x3f800000, v172
    v_cos_f32 v175, v175
    v_cos_f32 v174, v174
    s_nop 0
    v_cvt_pk_bf16_f32 v178, v174, v175
    v_fmamk_f32 v176, v173, 0x40000000, v172
    v_fmamk_f32 v177, v173, 0x40400000, v172
    v_cos_f32 v177, v177
    v_cos_f32 v176, v176
    v_accvgpr_write_b32 a200, v178
    v_cvt_pk_bf16_f32 v178, v176, v177
    v_fmamk_f32 v174, v173, 0x40800000, v172
    v_fmamk_f32 v175, v173, 0x40a00000, v172
    v_cos_f32 v175, v175
    v_cos_f32 v174, v174
    v_accvgpr_write_b32 a201, v178
    v_cvt_pk_bf16_f32 v178, v174, v175
    v_fmamk_f32 v176, v173, 0x40c00000, v172
    v_fmamk_f32 v177, v173, 0x40e00000, v172
    v_cos_f32 v177, v177
    v_cos_f32 v176, v176
    v_accvgpr_write_b32 a202, v178
    v_cvt_pk_bf16_f32 v178, v176, v177
    v_fmamk_f32 v174, v173, 0x41800000, v172
    v_fmamk_f32 v175, v173, 0x41880000, v172
    v_cos_f32 v175, v175
    v_cos_f32 v174, v174
    v_accvgpr_write_b32 a203, v178
    v_cvt_pk_bf16_f32 v178, v174, v175
    v_fmamk_f32 v176, v173, 0x41900000, v172
    v_fmamk_f32 v177, v173, 0x41980000, v172
    v_cos_f32 v177, v177
    v_cos_f32 v176, v176
    v_accvgpr_write_b32 a204, v178
    v_cvt_pk_bf16_f32 v178, v176, v177
    v_fmamk_f32 v174, v173, 0x41a00000, v172
    v_fmamk_f32 v175, v173, 0x41a80000, v172
    v_cos_f32 v175, v175
    v_cos_f32 v174, v174
    v_accvgpr_write_b32 a205, v178
    v_cvt_pk_bf16_f32 v178, v174, v175
    v_fmamk_f32 v176, v173, 0x41b00000, v172
    v_fmamk_f32 v177, v173, 0x41b80000, v172
    v_cos_f32 v177, v177
    v_cos_f32 v176, v176
    v_accvgpr_write_b32 a206, v178
    v_cvt_pk_bf16_f32 v178, v176, v177
    v_fmamk_f32 v174, v173, 0x42000000, v172
    v_fmamk_f32 v175, v173, 0x42040000, v172
    v_cos_f32 v175, v175
    v_cos_f32 v174, v174
    v_accvgpr_write_b32 a207, v178
    v_cvt_pk_bf16_f32 v178, v174, v175
    v_fmamk_f32 v176, v173, 0x42080000, v172
    v_fmamk_f32 v177, v173, 0x420c0000, v172
    v_cos_f32 v177, v177
    v_cos_f32 v176, v176
    v_accvgpr_write_b32 a208, v178
    v_cvt_pk_bf16_f32 v178, v176, v177
    v_fmamk_f32 v174, v173, 0x42100000, v172
    v_fmamk_f32 v175, v173, 0x42140000, v172
    v_cos_f32 v175, v175
    v_cos_f32 v174, v174
    v_accvgpr_write_b32 a209, v178
    v_cvt_pk_bf16_f32 v178, v174, v175
    v_fmamk_f32 v176, v173, 0x42180000, v172
    v_fmamk_f32 v177, v173, 0x421c0000, v172
    v_cos_f32 v177, v177
    v_cos_f32 v176, v176
    v_accvgpr_write_b32 a210, v178
    v_cvt_pk_bf16_f32 v178, v176, v177
    v_fmamk_f32 v174, v173, 0x42400000, v172
    v_fmamk_f32 v175, v173, 0x42440000, v172
    v_cos_f32 v175, v175
    v_cos_f32 v174, v174
    v_accvgpr_write_b32 a211, v178
    v_cvt_pk_bf16_f32 v178, v174, v175
    v_fmamk_f32 v176, v173, 0x42480000, v172
    v_fmamk_f32 v177, v173, 0x424c0000, v172
    v_cos_f32 v177, v177
    v_cos_f32 v176, v176
    v_accvgpr_write_b32 a212, v178
    v_cvt_pk_bf16_f32 v178, v176, v177
    v_fmamk_f32 v174, v173, 0x42500000, v172
    v_fmamk_f32 v175, v173, 0x42540000, v172
    v_cos_f32 v175, v175
    v_cos_f32 v174, v174
    v_accvgpr_write_b32 a213, v178
    v_cvt_pk_bf16_f32 v178, v174, v175
    v_fmamk_f32 v176, v173, 0x42580000, v172
    v_fmamk_f32 v177, v173, 0x425c0000, v172
    v_cos_f32 v177, v177
    v_cos_f32 v176, v176
    v_accvgpr_write_b32 a214, v178
    v_cvt_pk_bf16_f32 v178, v176, v177
    v_fmamk_f32 v174, v173, 0x42800000, v172
    v_fmamk_f32 v175, v173, 0x42820000, v172
    v_cos_f32 v175, v175
    v_cos_f32 v174, v174
    v_accvgpr_write_b32 a215, v178
    v_cvt_pk_bf16_f32 v178, v174, v175
    v_fmamk_f32 v176, v173, 0x42840000, v172
    v_fmamk_f32 v177, v173, 0x42860000, v172
    v_cos_f32 v177, v177
    v_cos_f32 v176, v176
    v_accvgpr_write_b32 a216, v178
    v_cvt_pk_bf16_f32 v178, v176, v177
    v_fmamk_f32 v174, v173, 0x42880000, v172
    v_fmamk_f32 v175, v173, 0x428a0000, v172
    v_cos_f32 v175, v175
    v_cos_f32 v174, v174
    v_accvgpr_write_b32 a217, v178
    v_cvt_pk_bf16_f32 v178, v174, v175
    v_fmamk_f32 v176, v173, 0x428c0000, v172
    v_fmamk_f32 v177, v173, 0x428e0000, v172
    v_cos_f32 v177, v177
    v_cos_f32 v176, v176
    v_accvgpr_write_b32 a218, v178
    v_cvt_pk_bf16_f32 v178, v176, v177
    v_fmamk_f32 v174, v173, 0x42a00000, v172
    v_fmamk_f32 v175, v173, 0x42a20000, v172
    v_cos_f32 v175, v175
    v_cos_f32 v174, v174
    v_accvgpr_write_b32 a219, v178
    v_cvt_pk_bf16_f32 v178, v174, v175
    v_fmamk_f32 v176, v173, 0x42a40000, v172
    v_fmamk_f32 v177, v173, 0x42a60000, v172
    v_cos_f32 v177, v177
    v_cos_f32 v176, v176
    v_accvgpr_write_b32 a220, v178
    v_cvt_pk_bf16_f32 v178, v176, v177
    v_fmamk_f32 v174, v173, 0x42a80000, v172
    v_fmamk_f32 v175, v173, 0x42aa0000, v172
    v_cos_f32 v175, v175
    v_cos_f32 v174, v174
    v_accvgpr_write_b32 a221, v178
    v_cvt_pk_bf16_f32 v178, v174, v175
    v_fmamk_f32 v176, v173, 0x42ac0000, v172
    v_fmamk_f32 v177, v173, 0x42ae0000, v172
    v_cos_f32 v177, v177
    v_cos_f32 v176, v176
    v_accvgpr_write_b32 a222, v178
    v_cvt_pk_bf16_f32 v178, v176, v177
    v_fmamk_f32 v174, v173, 0x42c00000, v172
    v_fmamk_f32 v175, v173, 0x42c20000, v172
    v_cos_f32 v175, v175
    v_cos_f32 v174, v174
    v_accvgpr_write_b32 a223, v178
    v_cvt_pk_bf16_f32 v178, v174, v175
    v_fmamk_f32 v176, v173, 0x42c40000, v172
    v_fmamk_f32 v177, v173, 0x42c60000, v172
    v_cos_f32 v177, v177
    v_cos_f32 v176, v176
    v_accvgpr_write_b32 a224, v178
    v_cvt_pk_bf16_f32 v178, v176, v177
    v_fmamk_f32 v174, v173, 0x42c80000, v172
    v_fmamk_f32 v175, v173, 0x42ca0000, v172
    v_cos_f32 v175, v175
    v_cos_f32 v174, v174
    v_accvgpr_write_b32 a225, v178
    v_cvt_pk_bf16_f32 v178, v174, v175
    v_fmamk_f32 v176, v173, 0x42cc0000, v172
    v_fmamk_f32 v177, v173, 0x42ce0000, v172
    v_cos_f32 v177, v177
    v_cos_f32 v176, v176
    v_accvgpr_write_b32 a226, v178
    v_cvt_pk_bf16_f32 v178, v176, v177
    v_fmamk_f32 v174, v173, 0x42e00000, v172
    v_fmamk_f32 v175, v173, 0x42e20000, v172
    v_cos_f32 v175, v175
    v_cos_f32 v174, v174
    v_accvgpr_write_b32 a227, v178
    v_cvt_pk_bf16_f32 v178, v174, v175
    v_fmamk_f32 v176, v173, 0x42e40000, v172
    v_fmamk_f32 v177, v173, 0x42e60000, v172
    v_cos_f32 v177, v177
    v_cos_f32 v176, v176
    v_accvgpr_write_b32 a228, v178
    v_cvt_pk_bf16_f32 v178, v176, v177
    v_fmamk_f32 v174, v173, 0x42e80000, v172
    v_fmamk_f32 v175, v173, 0x42ea0000, v172
    v_cos_f32 v175, v175
    v_cos_f32 v174, v174
    v_accvgpr_write_b32 a229, v178
    v_cvt_pk_bf16_f32 v178, v174, v175
    v_fmamk_f32 v176, v173, 0x42ec0000, v172
    v_fmamk_f32 v177, v173, 0x42ee0000, v172
    v_cos_f32 v177, v177
    v_cos_f32 v176, v176
    v_accvgpr_write_b32 a230, v178
    v_cvt_pk_bf16_f32 v178, v176, v177
    v_fmamk_f32 v174, v173, 0x43000000, v172
    v_fmamk_f32 v175, v173, 0x43010000, v172
    v_cos_f32 v175, v175
    v_cos_f32 v174, v174
    v_accvgpr_write_b32 a231, v178
    v_cvt_pk_bf16_f32 v178, v174, v175
    v_fmamk_f32 v176, v173, 0x43020000, v172
    v_fmamk_f32 v177, v173, 0x43030000, v172
    v_cos_f32 v177, v177
    v_cos_f32 v176, v176
    v_accvgpr_write_b32 a232, v178
    v_cvt_pk_bf16_f32 v178, v176, v177
    v_fmamk_f32 v174, v173, 0x43040000, v172
    v_fmamk_f32 v175, v173, 0x43050000, v172
    v_cos_f32 v175, v175
    v_cos_f32 v174, v174
    v_accvgpr_write_b32 a233, v178
    v_cvt_pk_bf16_f32 v178, v174, v175
    v_fmamk_f32 v176, v173, 0x43060000, v172
    v_fmamk_f32 v177, v173, 0x43070000, v172
    v_cos_f32 v177, v177
    v_cos_f32 v176, v176
    v_accvgpr_write_b32 a234, v178
    v_cvt_pk_bf16_f32 v178, v176, v177
    v_fmamk_f32 v174, v173, 0x43100000, v172
    v_fmamk_f32 v175, v173, 0x43110000, v172
    v_cos_f32 v175, v175
    v_cos_f32 v174, v174
    v_accvgpr_write_b32 a235, v178
    v_cvt_pk_bf16_f32 v178, v174, v175
    v_fmamk_f32 v176, v173, 0x43120000, v172
    v_fmamk_f32 v177, v173, 0x43130000, v172
    v_cos_f32 v177, v177
    v_cos_f32 v176, v176
    v_accvgpr_write_b32 a236, v178
    v_cvt_pk_bf16_f32 v178, v176, v177
    v_fmamk_f32 v174, v173, 0x43140000, v172
    v_fmamk_f32 v175, v173, 0x43150000, v172
    v_cos_f32 v175, v175
    v_cos_f32 v174, v174
    v_accvgpr_write_b32 a237, v178
    v_cvt_pk_bf16_f32 v178, v174, v175
    v_fmamk_f32 v176, v173, 0x43160000, v172
    v_fmamk_f32 v177, v173, 0x43170000, v172
    v_cos_f32 v177, v177
    v_cos_f32 v176, v176
    v_accvgpr_write_b32 a238, v178
    v_cvt_pk_bf16_f32 v178, v176, v177
    v_accvgpr_write_b32 a239, v178
    s_lshl_b32 s34, s29, 13
    v_add_u32 v4, s34, v0
    s_lshl_b32 s34, s29, 3
    s_add_u32 s34, s34, 65536
    v_bfe_u32 v5, v1, 0, 5
    v_mul_u32_u24 v5, 32, v5
    v_add_u32 v5, s34, v5
    s_lshl_b32 s35, s29, 11
    s_lshl_b32 s36, s29, 8
    s_add_u32 s36, s36, 67584
    s_lshr_b32 s34, s29, 1
    s_lshl_b32 s34, s34, 12
    s_and_b32 s37, s29, 1
    s_lshl_b32 s37, s37, 8
    s_add_u32 s34, s34, s37
    v_bfe_u32 v3, v1, 1, 1
    v_mul_u32_u24 v3, 2048, v3
    v_bfe_u32 v172, v1, 0, 1
    v_lshl_add_u32 v3, v172, 9, v3
    v_bfe_u32 v172, v1, 2, 4
    v_lshl_add_u32 v3, v172, 4, v3
    v_add_u32 v3, s34, v3
    v_bfe_u32 v10, v1, 0, 2
    v_mul_u32_u24 v10, 32, v10
    v_add_u32 v10, s36, v10
    s_lshl_b32 s34, s29, 10
    v_add_u32 v7, s34, v0
    v_bfe_u32 v6, v1, 0, 5
    v_mul_u32_u24 v6, 32, v6
    v_add_u32 v6, 65536, v6
    v_bfe_u32 v9, v1, 0, 2
    v_mul_u32_u24 v9, 4, v9
    v_bfe_u32 v172, v1, 2, 1
    v_lshl_add_u32 v9, v172, 5, v9
    v_bfe_u32 v172, v1, 3, 1
    v_lshl_add_u32 v9, v172, 4, v9
    v_bfe_u32 v172, v1, 4, 1
    v_lshl_add_u32 v9, v172, 6, v9
    v_add_u32 v9, s36, v9
    s_mov_b32 s34, 0x3f803f80
    v_mov_b32 v56, s34
    v_mov_b32 v57, s34
    v_mov_b32 v58, s34
    v_mov_b32 v59, s34
    s_nop 1
    v_mfma_f32_32x32x16_bf16 v[96:111], v[56:59], a[160:163], 0
    v_mfma_f32_32x32x16_bf16 v[112:127], v[56:59], a[200:203], 0
    v_mfma_f32_32x32x16_bf16 v[96:111], v[56:59], a[164:167], v[96:111]
    v_mfma_f32_32x32x16_bf16 v[112:127], v[56:59], a[204:207], v[112:127]
    v_mfma_f32_32x32x16_bf16 v[96:111], v[56:59], a[168:171], v[96:111]
    v_mfma_f32_32x32x16_bf16 v[112:127], v[56:59], a[208:211], v[112:127]
    v_mfma_f32_32x32x16_bf16 v[96:111], v[56:59], a[172:175], v[96:111]
    v_mfma_f32_32x32x16_bf16 v[112:127], v[56:59], a[212:215], v[112:127]
    v_mfma_f32_32x32x16_bf16 v[96:111], v[56:59], a[176:179], v[96:111]
    v_mfma_f32_32x32x16_bf16 v[112:127], v[56:59], a[216:219], v[112:127]
    v_mfma_f32_32x32x16_bf16 v[96:111], v[56:59], a[180:183], v[96:111]
    v_mfma_f32_32x32x16_bf16 v[112:127], v[56:59], a[220:223], v[112:127]
    v_mfma_f32_32x32x16_bf16 v[96:111], v[56:59], a[184:187], v[96:111]
    v_mfma_f32_32x32x16_bf16 v[112:127], v[56:59], a[224:227], v[112:127]
    v_mfma_f32_32x32x16_bf16 v[96:111], v[56:59], a[188:191], v[96:111]
    v_mfma_f32_32x32x16_bf16 v[112:127], v[56:59], a[228:231], v[112:127]
    v_mfma_f32_32x32x16_bf16 v[96:111], v[56:59], a[192:195], v[96:111]
    v_mfma_f32_32x32x16_bf16 v[112:127], v[56:59], a[232:235], v[112:127]
    v_mfma_f32_32x32x16_bf16 v[96:111], v[56:59], a[196:199], v[96:111]
    v_mfma_f32_32x32x16_bf16 v[112:127], v[56:59], a[236:239], v[112:127]
    s_nop 3
    ds_write_b128 v4, v[96:99] offset:32768
    ds_write_b128 v4, v[100:103] offset:33792
    ds_write_b128 v4, v[104:107] offset:34816
    ds_write_b128 v4, v[108:111] offset:35840
    s_nop 3
    ds_write_b128 v4, v[112:115] offset:36864
    ds_write_b128 v4, v[116:119] offset:37888
    ds_write_b128 v4, v[120:123] offset:38912
    ds_write_b128 v4, v[124:127] offset:39936
    s_waitcnt lgkmcnt(0)
    s_barrier
    ds_read_b128 v[96:99], v3 offset:32768
    ds_read_b128 v[100:103], v3 offset:33792
    ds_read_b128 v[104:107], v3 offset:40960
    ds_read_b128 v[108:111], v3 offset:41984
    ds_read_b128 v[112:115], v3 offset:49152
    ds_read_b128 v[116:119], v3 offset:50176
    ds_read_b128 v[120:123], v3 offset:57344
    ds_read_b128 v[124:127], v3 offset:58368
    s_waitcnt lgkmcnt(5)
    v_pk_add_f32 v[96:97], v[96:97], v[104:105]
    v_pk_add_f32 v[98:99], v[98:99], v[106:107]
    s_waitcnt lgkmcnt(4)
    v_pk_add_f32 v[100:101], v[100:101], v[108:109]
    v_pk_add_f32 v[102:103], v[102:103], v[110:111]
    s_waitcnt lgkmcnt(3)
    v_pk_add_f32 v[96:97], v[96:97], v[112:113]
    v_pk_add_f32 v[98:99], v[98:99], v[114:115]
    s_waitcnt lgkmcnt(2)
    v_pk_add_f32 v[100:101], v[100:101], v[116:117]
    v_pk_add_f32 v[102:103], v[102:103], v[118:119]
    s_waitcnt lgkmcnt(1)
    v_pk_add_f32 v[96:97], v[96:97], v[120:121]
    v_pk_add_f32 v[98:99], v[98:99], v[122:123]
    s_waitcnt lgkmcnt(0)
    v_pk_add_f32 v[100:101], v[100:101], v[124:125]
    v_pk_add_f32 v[102:103], v[102:103], v[126:127]
    v_mov_b64 v[154:155], v[96:97]
    v_mov_b64 v[156:157], v[98:99]
    v_mov_b64 v[158:159], v[100:101]
    v_mov_b64 v[160:161], v[102:103]
    s_barrier
    s_sub_u32 s44, s66, 16
    s_mov_b32 s47, 3
    s_mul_i32 s50, s29, 10240
    s_add_u32 s50, s50, 14680064
    s_mov_b32 s52, 0
    s_lshl_b32 s51, s67, 12
    s_add_u32 s51, s51, 24117248
    s_mov_b32 s58, 40960
    s_mul_i32 s34, s29, 640
    s_add_u32 s34, s34, 1196032
    v_lshrrev_b32 v181, 1, v1
    v_min_u32 v181, 4, v181
    v_lshlrev_b32 v181, 7, v181
    v_bfe_u32 v182, v1, 0, 1
    v_mul_u32_u24 v182, 2560, v182
    v_add_u32 v182, s34, v182
    v_add_u32 v181, v181, v182
    s_waitcnt vmcnt(0) lgkmcnt(0)
G_182:
    s_mul_i32 s38, s44, 21846
    s_lshr_b32 s38, s38, 16
    s_mul_i32 s39, s38, 3
    s_sub_u32 s39, s44, s39
    s_add_u32 s57, s38, 1
    s_mul_i32 s39, s39, 5120
    s_mov_b32 s48, 0
P_184:
    buffer_load_dword v172, v181, s[4:7], s39 offen sc1
    s_waitcnt vmcnt(0)
    v_cmp_gt_u32 vcc, s57, v172
    s_cbranch_vccz P_185
    s_add_u32 s48, s48, 1
    s_cmp_gt_u32 s48, 200000
    s_cbranch_scc1 L_end
    s_sleep 1
    s_branch P_184
P_185:
    s_mul_i32 s54, s44, 40960
    s_add_u32 s56, s54, s52
    s_add_u32 s54, s54, s50
    buffer_load_dwordx4 v[16:19], v0, s[4:7], s54 offen offset:0 sc1
    buffer_load_dwordx4 v[20:23], v0, s[4:7], s54 offen offset:1024 sc1
    buffer_load_dwordx4 v[24:27], v0, s[4:7], s54 offen offset:2048 sc1
    buffer_load_dwordx4 v[28:31], v0, s[4:7], s54 offen offset:3072 sc1
    s_add_u32 s54, s54, 4096
    buffer_load_dwordx4 v[32:35], v0, s[4:7], s54 offen offset:0 sc1
    buffer_load_dwordx4 v[36:39], v0, s[4:7], s54 offen offset:1024 sc1
    buffer_load_dwordx4 v[40:43], v0, s[4:7], s54 offen offset:2048 sc1
    buffer_load_dwordx4 v[44:47], v0, s[4:7], s54 offen offset:3072 sc1
    s_add_u32 s54, s54, 4096
    buffer_load_dwordx4 v[48:51], v0, s[4:7], s54 offen offset:0 sc1
    buffer_load_dwordx4 v[52:55], v0, s[4:7], s54 offen offset:1024 sc1
    s_waitcnt vmcnt(9)
    v_mfma_f32_32x32x16_bf16 v[96:111], v[16:19], a[160:163], 0
    v_mfma_f32_32x32x16_bf16 v[112:127], v[16:19], a[200:203], 0
    s_waitcnt vmcnt(8)
    v_mfma_f32_32x32x16_bf16 v[96:111], v[20:23], a[164:167], v[96:111]
    v_mfma_f32_32x32x16_bf16 v[112:127], v[20:23], a[204:207], v[112:127]
    s_waitcnt vmcnt(7)
    v_mfma_f32_32x32x16_bf16 v[96:111], v[24:27], a[168:171], v[96:111]
    v_mfma_f32_32x32x16_bf16 v[112:127], v[24:27], a[208:211], v[112:127]
    s_waitcnt vmcnt(6)
    v_mfma_f32_32x32x16_bf16 v[96:111], v[28:31], a[172:175], v[96:111]
    v_mfma_f32_32x32x16_bf16 v[112:127], v[28:31], a[212:215], v[112:127]
    s_waitcnt vmcnt(5)
    v_mfma_f32_32x32x16_bf16 v[96:111], v[32:35], a[176:179], v[96:111]
    v_mfma_f32_32x32x16_bf16 v[112:127], v[32:35], a[216:219], v[112:127]
    s_waitcnt vmcnt(4)
    v_mfma_f32_32x32x16_bf16 v[96:111], v[36:39], a[180:183], v[96:111]
    v_mfma_f32_32x32x16_bf16 v[112:127], v[36:39], a[220:223], v[112:127]
    s_waitcnt vmcnt(3)
    v_mfma_f32_32x32x16_bf16 v[96:111], v[40:43], a[184:187], v[96:111]
    v_mfma_f32_32x32x16_bf16 v[112:127], v[40:43], a[224:227], v[112:127]
    s_waitcnt vmcnt(2)
    v_mfma_f32_32x32x16_bf16 v[96:111], v[44:47], a[188:191], v[96:111]
    v_mfma_f32_32x32x16_bf16 v[112:127], v[44:47], a[228:231], v[112:127]
    s_waitcnt vmcnt(1)
    v_mfma_f32_32x32x16_bf16 v[96:111], v[48:51], a[192:195], v[96:111]
    v_mfma_f32_32x32x16_bf16 v[112:127], v[48:51], a[232:235], v[112:127]
    s_waitcnt vmcnt(0)
    v_mfma_f32_32x32x16_bf16 v[96:111], v[52:55], a[196:199], v[96:111]
    v_mfma_f32_32x32x16_bf16 v[112:127], v[52:55], a[236:239], v[112:127]
    s_mul_i32 s55, s44, s58
    s_add_u32 s55, s55, s51
    s_nop 1
    ds_write_b128 v4, v[96:99] offset:0
    v_mov_b64 v[128:129], 0
    s_mov_b32 s34, 0x3f803f80
    v_dot2c_f32_bf16 v128, s34, v16
    v_dot2c_f32_bf16 v129, v16, v16
    v_dot2c_f32_bf16 v128, s34, v17
    v_dot2c_f32_bf16 v129, v17, v17
    v_dot2c_f32_bf16 v128, s34, v18
    v_dot2c_f32_bf16 v129, v18, v18
    v_dot2c_f32_bf16 v128, s34, v19
    v_dot2c_f32_bf16 v129, v19, v19
    v_dot2c_f32_bf16 v128, s34, v20
    v_dot2c_f32_bf16 v129, v20, v20
    ds_write_b128 v4, v[100:103] offset:1024
    v_dot2c_f32_bf16 v128, s34, v21
    v_dot2c_f32_bf16 v129, v21, v21
    v_dot2c_f32_bf16 v128, s34, v22
    v_dot2c_f32_bf16 v129, v22, v22
    v_dot2c_f32_bf16 v128, s34, v23
    v_dot2c_f32_bf16 v129, v23, v23
    v_dot2c_f32_bf16 v128, s34, v24
    v_dot2c_f32_bf16 v129, v24, v24
    v_dot2c_f32_bf16 v128, s34, v25
    v_dot2c_f32_bf16 v129, v25, v25
    ds_write_b128 v4, v[104:107] offset:2048
    v_dot2c_f32_bf16 v128, s34, v26
    v_dot2c_f32_bf16 v129, v26, v26
    v_dot2c_f32_bf16 v128, s34, v27
    v_dot2c_f32_bf16 v129, v27, v27
    v_dot2c_f32_bf16 v128, s34, v28
    v_dot2c_f32_bf16 v129, v28, v28
    v_dot2c_f32_bf16 v128, s34, v29
    v_dot2c_f32_bf16 v129, v29, v29
    v_dot2c_f32_bf16 v128, s34, v30
    v_dot2c_f32_bf16 v129, v30, v30
    ds_write_b128 v4, v[108:111] offset:3072
    v_dot2c_f32_bf16 v128, s34, v31
    v_dot2c_f32_bf16 v129, v31, v31
    v_dot2c_f32_bf16 v128, s34, v32
    v_dot2c_f32_bf16 v129, v32, v32
    v_dot2c_f32_bf16 v128, s34, v33
    v_dot2c_f32_bf16 v129, v33, v33
    v_dot2c_f32_bf16 v128, s34, v34
    v_dot2c_f32_bf16 v129, v34, v34
    v_dot2c_f32_bf16 v128, s34, v35
    v_dot2c_f32_bf16 v129, v35, v35
    ds_write_b128 v4, v[112:115] offset:4096
    v_dot2c_f32_bf16 v128, s34, v36
    v_dot2c_f32_bf16 v129, v36, v36
    v_dot2c_f32_bf16 v128, s34, v37
    v_dot2c_f32_bf16 v129, v37, v37
    v_dot2c_f32_bf16 v128, s34, v38
    v_dot2c_f32_bf16 v129, v38, v38
    v_dot2c_f32_bf16 v128, s34, v39
    v_dot2c_f32_bf16 v129, v39, v39
    v_dot2c_f32_bf16 v128, s34, v40
    v_dot2c_f32_bf16 v129, v40, v40
    ds_write_b128 v4, v[116:119] offset:5120
    v_dot2c_f32_bf16 v128, s34, v41
    v_dot2c_f32_bf16 v129, v41, v41
    v_dot2c_f32_bf16 v128, s34, v42
    v_dot2c_f32_bf16 v129, v42, v42
    v_dot2c_f32_bf16 v128, s34, v43
    v_dot2c_f32_bf16 v129, v43, v43
    v_dot2c_f32_bf16 v128, s34, v44
    v_dot2c_f32_bf16 v129, v44, v44
    v_dot2c_f32_bf16 v128, s34, v45
    v_dot2c_f32_bf16 v129, v45, v45
    ds_write_b128 v4, v[120:123] offset:6144
    v_dot2c_f32_bf16 v128, s34, v46
    v_dot2c_f32_bf16 v129, v46, v46
    v_dot2c_f32_bf16 v128, s34, v47
    v_dot2c_f32_bf16 v129, v47, v47
    v_dot2c_f32_bf16 v128, s34, v48
    v_dot2c_f32_bf16 v129, v48, v48
    v_dot2c_f32_bf16 v128, s34, v49
    v_dot2c_f32_bf16 v129, v49, v49
    v_dot2c_f32_bf16 v128, s34, v50
    v_dot2c_f32_bf16 v129, v50, v50
    ds_write_b128 v4, v[124:127] offset:7168
    v_dot2c_f32_bf16 v128, s34, v51
    v_dot2c_f32_bf16 v129, v51, v51
    v_dot2c_f32_bf16 v128, s34, v52
    v_dot2c_f32_bf16 v129, v52, v52
    v_dot2c_f32_bf16 v128, s34, v53
    v_dot2c_f32_bf16 v129, v53, v53
    v_dot2c_f32_bf16 v128, s34, v54
    v_dot2c_f32_bf16 v129, v54, v54
    v_dot2c_f32_bf16 v128, s34, v55
    v_dot2c_f32_bf16 v129, v55, v55
    s_nop 2
    v_mov_b64 v[172:173], v[128:129]
    s_nop 1
    v_permlane32_swap_b32 v128, v172
    v_permlane32_swap_b32 v129, v173
    v_pk_add_f32 v[128:129], v[128:129], v[172:173]
    ds_write_b64 v5, v[128:129] offset:0
    s_waitcnt lgkmcnt(0)
    s_barrier
    ds_read_b128 v[130:133], v6 offset:0
    ds_read_b128 v[134:137], v6 offset:16
    ds_read_b128 v[96:99], v3 offset:0
    ds_read_b128 v[100:103], v3 offset:1024
    ds_read_b128 v[104:107], v3 offset:8192
    ds_read_b128 v[108:111], v3 offset:9216
    ds_read_b128 v[112:115], v3 offset:16384
    ds_read_b128 v[116:119], v3 offset:17408
    ds_read_b128 v[120:123], v3 offset:24576
    ds_read_b128 v[124:127], v3 offset:25600
    s_waitcnt lgkmcnt(9)
    v_pk_add_f32 v[130:131], v[130:131], v[132:133]
    s_waitcnt lgkmcnt(8)
    v_pk_add_f32 v[134:135], v[134:135], v[136:137]
    v_pk_add_f32 v[130:131], v[130:131], v[134:135]
    v_mul_f32 v130, 0x3acccccd, v130
    v_mul_f32 v131, 0x3acccccd, v131
    v_fma_f32 v131, -v130, v130, v131
    v_max_f32 v131, 0, v131
    v_add_f32 v131, 0x3727c5ac, v131
    v_rsq_f32 v131, v131
    s_nop 0
    ds_write2_b32 v9, v130, v131 offset0:0 offset1:32
    ds_read_b128 v[138:141], v10 offset:0
    ds_read_b128 v[142:145], v10 offset:16
    ds_read_b128 v[146:149], v10 offset:128
    ds_read_b128 v[150:153], v10 offset:144
    s_waitcnt lgkmcnt(10)
    v_pk_add_f32 v[96:97], v[96:97], v[104:105]
    v_pk_add_f32 v[98:99], v[98:99], v[106:107]
    s_waitcnt lgkmcnt(9)
    v_pk_add_f32 v[100:101], v[100:101], v[108:109]
    v_pk_add_f32 v[102:103], v[102:103], v[110:111]
    s_waitcnt lgkmcnt(8)
    v_pk_add_f32 v[96:97], v[96:97], v[112:113]
    v_pk_add_f32 v[98:99], v[98:99], v[114:115]
    s_waitcnt lgkmcnt(7)
    v_pk_add_f32 v[100:101], v[100:101], v[116:117]
    v_pk_add_f32 v[102:103], v[102:103], v[118:119]
    s_waitcnt lgkmcnt(6)
    v_pk_add_f32 v[96:97], v[96:97], v[120:121]
    v_pk_add_f32 v[98:99], v[98:99], v[122:123]
    s_waitcnt lgkmcnt(5)
    v_pk_add_f32 v[100:101], v[100:101], v[124:125]
    v_pk_add_f32 v[102:103], v[102:103], v[126:127]
    s_waitcnt lgkmcnt(3)
    v_fma_f32 v96, -v138, v154, v96
    s_waitcnt lgkmcnt(1)
    v_mul_f32 v96, v96, v146
    v_fma_f32 v97, -v139, v155, v97
    v_mul_f32 v97, v97, v147
    v_fma_f32 v98, -v140, v156, v98
    v_mul_f32 v98, v98, v148
    v_fma_f32 v99, -v141, v157, v99
    v_mul_f32 v99, v99, v149
    v_fma_f32 v100, -v142, v158, v100
    s_waitcnt lgkmcnt(0)
    v_mul_f32 v100, v100, v150
    v_fma_f32 v101, -v143, v159, v101
    v_mul_f32 v101, v101, v151
    v_fma_f32 v102, -v144, v160, v102
    v_mul_f32 v102, v102, v152
    v_fma_f32 v103, -v145, v161, v103
    v_mul_f32 v103, v103, v153
    v_cvt_pk_bf16_f32 v172, v96, v97
    v_cvt_pk_bf16_f32 v173, v98, v99
    v_cvt_pk_bf16_f32 v174, v100, v101
    v_cvt_pk_bf16_f32 v175, v102, v103
    buffer_store_dwordx4 v[172:175], v7, s[4:7], s55 offen sc1
    s_add_u32 s44, s44, s47
    s_cmp_lt_u32 s44, 64
    s_cbranch_scc0 G_183
    s_mul_i32 s38, s44, 21846
    s_lshr_b32 s38, s38, 16
    s_mul_i32 s39, s38, 3
    s_sub_u32 s39, s44, s39
    s_add_u32 s57, s38, 1
    s_mul_i32 s39, s39, 5120
    s_mov_b32 s48, 0
P_186:
    buffer_load_dword v172, v181, s[4:7], s39 offen sc1
    s_waitcnt vmcnt(0)
    v_cmp_gt_u32 vcc, s57, v172
    s_cbranch_vccz P_187
    s_add_u32 s48, s48, 1
    s_cmp_gt_u32 s48, 200000
    s_cbranch_scc1 L_end
    s_sleep 1
    s_branch P_186
P_187:
    s_mul_i32 s54, s44, 40960
    s_add_u32 s56, s54, s52
    s_add_u32 s54, s54, s50
    buffer_load_dwordx4 v[56:59], v0, s[4:7], s54 offen offset:0 sc1
    buffer_load_dwordx4 v[60:63], v0, s[4:7], s54 offen offset:1024 sc1
    buffer_load_dwordx4 v[64:67], v0, s[4:7], s54 offen offset:2048 sc1
    buffer_load_dwordx4 v[68:71], v0, s[4:7], s54 offen offset:3072 sc1
    s_add_u32 s54, s54, 4096
    buffer_load_dwordx4 v[72:75], v0, s[4:7], s54 offen offset:0 sc1
    buffer_load_dwordx4 v[76:79], v0, s[4:7], s54 offen offset:1024 sc1
    buffer_load_dwordx4 v[80:83], v0, s[4:7], s54 offen offset:2048 sc1
    buffer_load_dwordx4 v[84:87], v0, s[4:7], s54 offen offset:3072 sc1
    s_add_u32 s54, s54, 4096
    buffer_load_dwordx4 v[88:91], v0, s[4:7], s54 offen offset:0 sc1
    buffer_load_dwordx4 v[92:95], v0, s[4:7], s54 offen offset:1024 sc1
    s_waitcnt vmcnt(9)
    v_mfma_f32_32x32x16_bf16 v[96:111], v[56:59], a[160:163], 0
    v_mfma_f32_32x32x16_bf16 v[112:127], v[56:59], a[200:203], 0
    s_waitcnt vmcnt(8)
    v_mfma_f32_32x32x16_bf16 v[96:111], v[60:63], a[164:167], v[96:111]
    v_mfma_f32_32x32x16_bf16 v[112:127], v[60:63], a[204:207], v[112:127]
    s_waitcnt vmcnt(7)
    v_mfma_f32_32x32x16_bf16 v[96:111], v[64:67], a[168:171], v[96:111]
    v_mfma_f32_32x32x16_bf16 v[112:127], v[64:67], a[208:211], v[112:127]
    s_waitcnt vmcnt(6)
    v_mfma_f32_32x32x16_bf16 v[96:111], v[68:71], a[172:175], v[96:111]
    v_mfma_f32_32x32x16_bf16 v[112:127], v[68:71], a[212:215], v[112:127]
    s_waitcnt vmcnt(5)
    v_mfma_f32_32x32x16_bf16 v[96:111], v[72:75], a[176:179], v[96:111]
    v_mfma_f32_32x32x16_bf16 v[112:127], v[72:75], a[216:219], v[112:127]
    s_waitcnt vmcnt(4)
    v_mfma_f32_32x32x16_bf16 v[96:111], v[76:79], a[180:183], v[96:111]
    v_mfma_f32_32x32x16_bf16 v[112:127], v[76:79], a[220:223], v[112:127]
    s_waitcnt vmcnt(3)
    v_mfma_f32_32x32x16_bf16 v[96:111], v[80:83], a[184:187], v[96:111]
    v_mfma_f32_32x32x16_bf16 v[112:127], v[80:83], a[224:227], v[112:127]
    s_waitcnt vmcnt(2)
    v_mfma_f32_32x32x16_bf16 v[96:111], v[84:87], a[188:191], v[96:111]
    v_mfma_f32_32x32x16_bf16 v[112:127], v[84:87], a[228:231], v[112:127]
    s_waitcnt vmcnt(1)
    v_mfma_f32_32x32x16_bf16 v[96:111], v[88:91], a[192:195], v[96:111]
    v_mfma_f32_32x32x16_bf16 v[112:127], v[88:91], a[232:235], v[112:127]
    s_waitcnt vmcnt(0)
    v_mfma_f32_32x32x16_bf16 v[96:111], v[92:95], a[196:199], v[96:111]
    v_mfma_f32_32x32x16_bf16 v[112:127], v[92:95], a[236:239], v[112:127]
    s_mul_i32 s55, s44, s58
    s_add_u32 s55, s55, s51
    s_nop 1
    ds_write_b128 v4, v[96:99] offset:32768
    v_mov_b64 v[128:129], 0
    s_mov_b32 s34, 0x3f803f80
    v_dot2c_f32_bf16 v128, s34, v56
    v_dot2c_f32_bf16 v129, v56, v56
    v_dot2c_f32_bf16 v128, s34, v57
    v_dot2c_f32_bf16 v129, v57, v57
    v_dot2c_f32_bf16 v128, s34, v58
    v_dot2c_f32_bf16 v129, v58, v58
    v_dot2c_f32_bf16 v128, s34, v59
    v_dot2c_f32_bf16 v129, v59, v59
    v_dot2c_f32_bf16 v128, s34, v60
    v_dot2c_f32_bf16 v129, v60, v60
    ds_write_b128 v4, v[100:103] offset:33792
    v_dot2c_f32_bf16 v128, s34, v61
    v_dot2c_f32_bf16 v129, v61, v61
    v_dot2c_f32_bf16 v128, s34, v62
    v_dot2c_f32_bf16 v129, v62, v62
    v_dot2c_f32_bf16 v128, s34, v63
    v_dot2c_f32_bf16 v129, v63, v63
    v_dot2c_f32_bf16 v128, s34, v64
    v_dot2c_f32_bf16 v129, v64, v64
    v_dot2c_f32_bf16 v128, s34, v65
    v_dot2c_f32_bf16 v129, v65, v65
    ds_write_b128 v4, v[104:107] offset:34816
    v_dot2c_f32_bf16 v128, s34, v66
    v_dot2c_f32_bf16 v129, v66, v66
    v_dot2c_f32_bf16 v128, s34, v67
    v_dot2c_f32_bf16 v129, v67, v67
    v_dot2c_f32_bf16 v128, s34, v68
    v_dot2c_f32_bf16 v129, v68, v68
    v_dot2c_f32_bf16 v128, s34, v69
    v_dot2c_f32_bf16 v129, v69, v69
    v_dot2c_f32_bf16 v128, s34, v70
    v_dot2c_f32_bf16 v129, v70, v70
    ds_write_b128 v4, v[108:111] offset:35840
    v_dot2c_f32_bf16 v128, s34, v71
    v_dot2c_f32_bf16 v129, v71, v71
    v_dot2c_f32_bf16 v128, s34, v72
    v_dot2c_f32_bf16 v129, v72, v72
    v_dot2c_f32_bf16 v128, s34, v73
    v_dot2c_f32_bf16 v129, v73, v73
    v_dot2c_f32_bf16 v128, s34, v74
    v_dot2c_f32_bf16 v129, v74, v74
    v_dot2c_f32_bf16 v128, s34, v75
    v_dot2c_f32_bf16 v129, v75, v75
    ds_write_b128 v4, v[112:115] offset:36864
    v_dot2c_f32_bf16 v128, s34, v76
    v_dot2c_f32_bf16 v129, v76, v76
    v_dot2c_f32_bf16 v128, s34, v77
    v_dot2c_f32_bf16 v129, v77, v77
    v_dot2c_f32_bf16 v128, s34, v78
    v_dot2c_f32_bf16 v129, v78, v78
    v_dot2c_f32_bf16 v128, s34, v79
    v_dot2c_f32_bf16 v129, v79, v79
    v_dot2c_f32_bf16 v128, s34, v80
    v_dot2c_f32_bf16 v129, v80, v80
    ds_write_b128 v4, v[116:119] offset:37888
    v_dot2c_f32_bf16 v128, s34, v81
    v_dot2c_f32_bf16 v129, v81, v81
    v_dot2c_f32_bf16 v128, s34, v82
    v_dot2c_f32_bf16 v129, v82, v82
    v_dot2c_f32_bf16 v128, s34, v83
    v_dot2c_f32_bf16 v129, v83, v83
    v_dot2c_f32_bf16 v128, s34, v84
    v_dot2c_f32_bf16 v129, v84, v84
    v_dot2c_f32_bf16 v128, s34, v85
    v_dot2c_f32_bf16 v129, v85, v85
    ds_write_b128 v4, v[120:123] offset:38912
    v_dot2c_f32_bf16 v128, s34, v86
    v_dot2c_f32_bf16 v129, v86, v86
    v_dot2c_f32_bf16 v128, s34, v87
    v_dot2c_f32_bf16 v129, v87, v87
    v_dot2c_f32_bf16 v128, s34, v88
    v_dot2c_f32_bf16 v129, v88, v88
    v_dot2c_f32_bf16 v128, s34, v89
    v_dot2c_f32_bf16 v129, v89, v89
    v_dot2c_f32_bf16 v128, s34, v90
    v_dot2c_f32_bf16 v129, v90, v90
    ds_write_b128 v4, v[124:127] offset:39936
    v_dot2c_f32_bf16 v128, s34, v91
    v_dot2c_f32_bf16 v129, v91, v91
    v_dot2c_f32_bf16 v128, s34, v92
    v_dot2c_f32_bf16 v129, v92, v92
    v_dot2c_f32_bf16 v128, s34, v93
    v_dot2c_f32_bf16 v129, v93, v93
    v_dot2c_f32_bf16 v128, s34, v94
    v_dot2c_f32_bf16 v129, v94, v94
    v_dot2c_f32_bf16 v128, s34, v95
    v_dot2c_f32_bf16 v129, v95, v95
    s_nop 2
    v_mov_b64 v[172:173], v[128:129]
    s_nop 1
    v_permlane32_swap_b32 v128, v172
    v_permlane32_swap_b32 v129, v173
    v_pk_add_f32 v[128:129], v[128:129], v[172:173]
    ds_write_b64 v5, v[128:129] offset:1024
    s_waitcnt lgkmcnt(0)
    s_barrier
    ds_read_b128 v[130:133], v6 offset:1024
    ds_read_b128 v[134:137], v6 offset:1040
    ds_read_b128 v[96:99], v3 offset:32768
    ds_read_b128 v[100:103], v3 offset:33792
    ds_read_b128 v[104:107], v3 offset:40960
    ds_read_b128 v[108:111], v3 offset:41984
    ds_read_b128 v[112:115], v3 offset:49152
    ds_read_b128 v[116:119], v3 offset:50176
    ds_read_b128 v[120:123], v3 offset:57344
    ds_read_b128 v[124:127], v3 offset:58368
    s_waitcnt lgkmcnt(9)
    v_pk_add_f32 v[130:131], v[130:131], v[132:133]
    s_waitcnt lgkmcnt(8)
    v_pk_add_f32 v[134:135], v[134:135], v[136:137]
    v_pk_add_f32 v[130:131], v[130:131], v[134:135]
    v_mul_f32 v130, 0x3acccccd, v130
    v_mul_f32 v131, 0x3acccccd, v131
    v_fma_f32 v131, -v130, v130, v131
    v_max_f32 v131, 0, v131
    v_add_f32 v131, 0x3727c5ac, v131
    v_rsq_f32 v131, v131
    s_nop 0
    ds_write2_b32 v9, v130, v131 offset0:0 offset1:32
    ds_read_b128 v[138:141], v10 offset:0
    ds_read_b128 v[142:145], v10 offset:16
    ds_read_b128 v[146:149], v10 offset:128
    ds_read_b128 v[150:153], v10 offset:144
    s_waitcnt lgkmcnt(10)
    v_pk_add_f32 v[96:97], v[96:97], v[104:105]
    v_pk_add_f32 v[98:99], v[98:99], v[106:107]
    s_waitcnt lgkmcnt(9)
    v_pk_add_f32 v[100:101], v[100:101], v[108:109]
    v_pk_add_f32 v[102:103], v[102:103], v[110:111]
    s_waitcnt lgkmcnt(8)
    v_pk_add_f32 v[96:97], v[96:97], v[112:113]
    v_pk_add_f32 v[98:99], v[98:99], v[114:115]
    s_waitcnt lgkmcnt(7)
    v_pk_add_f32 v[100:101], v[100:101], v[116:117]
    v_pk_add_f32 v[102:103], v[102:103], v[118:119]
    s_waitcnt lgkmcnt(6)
    v_pk_add_f32 v[96:97], v[96:97], v[120:121]
    v_pk_add_f32 v[98:99], v[98:99], v[122:123]
    s_waitcnt lgkmcnt(5)
    v_pk_add_f32 v[100:101], v[100:101], v[124:125]
    v_pk_add_f32 v[102:103], v[102:103], v[126:127]
    s_waitcnt lgkmcnt(3)
    v_fma_f32 v96, -v138, v154, v96
    s_waitcnt lgkmcnt(1)
    v_mul_f32 v96, v96, v146
    v_fma_f32 v97, -v139, v155, v97
    v_mul_f32 v97, v97, v147
    v_fma_f32 v98, -v140, v156, v98
    v_mul_f32 v98, v98, v148
    v_fma_f32 v99, -v141, v157, v99
    v_mul_f32 v99, v99, v149
    v_fma_f32 v100, -v142, v158, v100
    s_waitcnt lgkmcnt(0)
    v_mul_f32 v100, v100, v150
    v_fma_f32 v101, -v143, v159, v101
    v_mul_f32 v101, v101, v151
    v_fma_f32 v102, -v144, v160, v102
    v_mul_f32 v102, v102, v152
    v_fma_f32 v103, -v145, v161, v103
    v_mul_f32 v103, v103, v153
    v_cvt_pk_bf16_f32 v172, v96, v97
    v_cvt_pk_bf16_f32 v173, v98, v99
    v_cvt_pk_bf16_f32 v174, v100, v101
    v_cvt_pk_bf16_f32 v175, v102, v103
    buffer_store_dwordx4 v[172:175], v7, s[4:7], s55 offen sc1
    s_add_u32 s44, s44, s47
    s_cmp_lt_u32 s44, 64
    s_cbranch_scc1 G_182
G_183:
    s_waitcnt vmcnt(0)
    s_barrier
    s_cmp_lg_u32 s29, 0
    s_cbranch_scc1 F_188
    s_lshl_b32 s32, s28, 5
    s_add_u32 s32, s32, s29
    s_lshl_b32 s32, s32, 2
    s_add_u32 s32, s32, 1073152
    v_mov_b32 v172, 2
    s_mov_b64 exec, 1
    buffer_store_dword v172, off, s[4:7], s32 sc1
    s_mov_b64 exec, -1
F_188:
R_181:
    s_sub_u32 s32, s28, 120
    s_cmp_lt_u32 s32, 32
    s_cbranch_scc1 R_189
    v_add_u32 v2, s60, v0
    ds_read_b128 a[160:163], v2 offset:0
    ds_read_b128 a[164:167], v2 offset:1024
    ds_read_b128 a[168:171], v2 offset:2048
    ds_read_b128 a[172:175], v2 offset:3072
    ds_read_b128 a[176:179], v2 offset:4096
    ds_read_b128 a[180:183], v2 offset:5120
    ds_read_b128 a[184:187], v2 offset:6144
    ds_read_b128 a[188:191], v2 offset:7168
    ds_read_b128 a[192:195], v2 offset:8192
    ds_read_b128 a[196:199], v2 offset:9216
    ds_read_b128 a[200:203], v2 offset:10240
    ds_read_b128 a[204:207], v2 offset:11264
    ds_read_b128 a[208:211], v2 offset:12288
    ds_read_b128 a[212:215], v2 offset:13312
    ds_read_b128 a[216:219], v2 offset:14336
    ds_read_b128 a[220:223], v2 offset:15360
    ds_read_b128 a[224:227], v2 offset:16384
    ds_read_b128 a[228:231], v2 offset:17408
    ds_read_b128 a[232:235], v2 offset:18432
    ds_read_b128 a[236:239], v2 offset:19456
    s_waitcnt lgkmcnt(0)
R_189:
    s_mov_b32 s30, 1
    s_mov_b32 s61, 64
    s_waitcnt vmcnt(0) lgkmcnt(0)
    s_branch LAYER_125

s_endpgm
.section .rodata,"a"
.p2align 6
.amdhsa_kernel interleave_layers__spectral_gfnet__memory_aug_recurrent_mem_tr__prompt_kernel
  .amdhsa_next_free_vgpr 512
  .amdhsa_next_free_sgpr 102
  .amdhsa_accum_offset 256
  .amdhsa_group_segment_fixed_size 0
  .amdhsa_kernarg_size 104
  .amdhsa_user_sgpr_count 2
  .amdhsa_user_sgpr_kernarg_segment_ptr 1
  .amdhsa_system_sgpr_workgroup_id_x 1
  .amdhsa_float_denorm_mode_32 3
.end_amdhsa_kernel
```

```asm
; @launch grid=(256,1,1) block=(256,1,1) lds=163840
.amdgcn_target "amdgcn-amd-amdhsa--gfx950"
.text
.globl interleave_layers__spectral_gfnet__memory_aug_recurrent_mem_tr__prompt_kernel
.p2align 8
.type interleave_layers__spectral_gfnet__memory_aug_recurrent_mem_tr__prompt_kernel,@function
interleave_layers__spectral_gfnet__memory_aug_recurrent_mem_tr__prompt_kernel:
    s_cmp_ge_u32 s2, 256
    s_cbranch_scc1 L_end0
    v_lshrrev_b32 v1, 6, v0
    s_and_b32 s3, s2, 7
    s_lshr_b32 s2, s2, 3
    s_lshl_b32 s3, s3, 2
    s_lshr_b32 s3, 0x54321706, s3
    s_and_b32 s3, s3, 15
    s_cmp_ge_u32 s3, 2
    s_cbranch_scc1 L_worker0
    s_mov_b32 s19, s3
    s_mov_b32 s20, s2
    v_readfirstlane_b32 s21, v1
    s_branch L_chain
L_worker0:
    s_branch L_worker
L_end0:
    s_endpgm
L_chain:
    s_load_dwordx2 s[32:33], s[0:1], 96
    s_mov_b32 s34, 268435456
    s_mov_b32 s35, 0x20000
    s_load_dwordx2 s[36:37], s[0:1], 96
    s_mov_b32 s38, 268435456
    s_mov_b32 s39, 0x20000
    s_load_dwordx2 s[28:29], s[0:1], 96
    s_mov_b32 s30, 196608
    s_mov_b32 s31, 0x20000
    s_load_dwordx2 s[4:5], s[0:1], 88
    s_mov_b32 s6, 256
    s_mov_b32 s7, 0x20000
    v_and_b32 v12, 63, v0
    v_lshrrev_b32 v13, 4, v12
    v_and_b32 v14, 15, v12
    v_lshlrev_b32 v0, 4, v12
    s_lshl_b32 s64, s21, 15
    s_add_u32 s64, s64, 32768
    v_add_u32 v1, s64, v0
    v_bfe_u32 v8, v14, 1, 1
    v_mul_u32_u24 v8, 0xAAAA, v8
    v_add_u32 v2, 0x4444, v8
    s_mul_i32 s47, s21, 544
    s_add_u32 s47, s47, 10240
    v_lshrrev_b32 v8, 1, v13
    v_and_b32 v9, 1, v13
    v_lshlrev_b32 v10, 3, v12
    v_lshl_add_u32 v10, v8, 5, v10
    v_add_u32 v3, s47, v10
    v_mul_u32_u24 v10, 544, v8
    v_and_b32 v11, 3, v14
    v_lshl_add_u32 v10, v11, 7, v10
    v_bfe_u32 v11, v14, 1, 1
    v_lshl_add_u32 v10, v11, 5, v10
    v_lshl_add_u32 v10, v9, 6, v10
    v_lshrrev_b32 v4, 2, v14
    v_lshl_add_u32 v10, v4, 3, v10
    v_add_u32 v4, 10240, v10
    s_lshl_b32 s47, s21, 9
    s_add_u32 s47, s47, 8192
    v_mul_u32_u24 v10, 8, v11
    v_and_b32 v11, 13, v14
    v_lshl_add_u32 v11, v9, 1, v11
    v_lshl_add_u32 v11, v8, 4, v11
    v_lshl_add_u32 v11, v11, 4, v10
    v_add_u32 v5, s47, v11
    s_lshl_b32 s47, s21, 14
    s_lshl_b32 s48, s20, 6
    s_add_u32 s47, s47, s48
    v_lshrrev_b32 v8, 3, v12
    v_and_b32 v9, 7, v12
    v_lshlrev_b32 v9, 3, v9
    v_lshl_add_u32 v8, v8, 11, v9
    v_add_u32 v7, s47, v8
    v_and_b32 v8, 1, v14
    v_lshlrev_b32 v8, 3, v8
    v_lshl_add_u32 v9, v13, 4, v8
    v_and_b32 v8, 2, v14
    v_lshl_add_u32 v9, v8, 4, v9
    v_lshrrev_b32 v11, 3, v14
    s_cmp_ge_u32 s21, 2
    s_cbranch_scc1 CH_s_1
    s_lshl_b32 s46, s21, 16
    s_lshl_b32 s47, s20, 11
    s_add_u32 s46, s46, s47
    s_lshl_b32 s47, s21, 11
    s_lshr_b32 s48, s20, 3
    s_lshl_b32 s48, s48, 9
    s_add_u32 s47, s47, s48
    s_and_b32 s48, s20, 1
    s_lshl_b32 s48, s48, 8
    s_add_u32 s47, s47, s48
    s_bfe_u32 s48, s20, 0x20001
    s_lshl_b32 s48, s48, 6
    s_add_u32 s47, s47, s48
    v_bfe_u32 v10, v14, 2, 1
    v_or_b32 v10, v10, v8
    s_mov_b32 s91, 0
    s_mov_b32 s95, 0
    s_branch CH_s_2
CH_s_1:
    s_and_b32 s48, s20, 15
    s_lshl_b32 s46, s48, 11
    s_add_u32 s46, s46, 131072
    s_lshl_b32 s47, s48, 6
    s_add_u32 s47, s47, 4096
    v_and_b32 v10, 3, v14
    s_mov_b32 s91, 2
    s_and_b32 s95, s20, 16
CH_s_2:
    v_add_u32 v9, s47, v9
    v_lshl_add_u32 v10, v11, 2, v10
    v_and_b32 v8, 0x2c, v12
    v_or_b32 v8, s95, v8
    v_cmp_eq_u32 vcc, 0, v8
    v_mov_b32 v11, 1073741824
    s_nop 0
    v_cndmask_b32 v6, v11, v9, vcc
    v_cmp_eq_u32 s[52:53], 0, v10
    v_cmp_eq_u32 s[54:55], 1, v10
    v_cmp_eq_u32 s[56:57], 2, v10
    v_cmp_eq_u32 s[58:59], 3, v10
    s_lshl_b32 s47, s19, 5
    s_add_u32 s47, s47, s20
    s_lshl_b32 s47, s47, 2
    s_add_u32 s47, s47, s21
    s_mul_i32 s45, s47, 143360
    s_lshl_b32 s63, s21, 11
    s_add_u32 s63, s63, 16384
    s_mov_b32 s51, 0x3e0293ee
    s_mov_b32 s61, 65536
    s_lshl_b32 s47, s21, 13
    s_lshl_b32 s48, s20, 6
    s_add_u32 s47, s47, s48
    s_add_u32 s62, s47, 131072
    s_mov_b32 s94, 0x7ffff800
    s_mov_b32 s65, 0x3f80
    s_mov_b32 s22, 0x3f803f80
    s_mov_b32 s23, 0x3f803f80
    s_lshl_b32 s92, s21, 10
    s_mov_b32 s86, 0xcccccccc
    s_mov_b32 s87, 0xcccccccc
    s_mov_b32 s16, s51
    s_mov_b32 s17, s51
    s_waitcnt lgkmcnt(0)
    v_mov_b64 v[8:9], 0
    v_mov_b64 v[10:11], 0
    v_mov_b64 v[12:13], -1
    v_mov_b64 v[14:15], -1
    s_lshr_b32 s47, s21, 1
    s_lshl_b32 s47, s47, 1
    s_add_u32 s47, s47, s19
    s_mul_i32 s47, s47, 196608
    s_lshl_b32 s48, s20, 10
    s_add_u32 s47, s47, s48
    s_add_u32 s47, s47, 65536
    s_bitcmp1_b32 s21, 0
    s_cbranch_scc1 CH_i_3
    s_add_u32 s48, s47, 0
    buffer_store_dwordx4 v[8:11], v0, s[32:35], s48 offen sc1
    s_add_u32 s48, s47, 32768
    buffer_store_dwordx4 v[8:11], v0, s[32:35], s48 offen sc1
    s_add_u32 s48, s47, 65536
    buffer_store_dwordx4 v[8:11], v0, s[32:35], s48 offen sc1
    s_branch CH_i_4
CH_i_3:
    s_add_u32 s48, s47, 98304
    buffer_store_dwordx4 v[8:11], v0, s[32:35], s48 offen sc1
    s_add_u32 s48, s47, 131072
    buffer_store_dwordx4 v[8:11], v0, s[32:35], s48 offen sc1
    s_add_u32 s48, s47, 163840
    buffer_store_dwordx4 v[12:15], v0, s[32:35], s48 offen sc1
CH_i_4:
    s_waitcnt vmcnt(0)
    s_barrier
    s_getreg_b32 s101, hwreg(HW_REG_XCC_ID, 0, 3)
    s_mul_i32 s101, s101, 6
    s_cmp_lg_u32 s21, 0
    s_cbranch_scc1 CH_i_5
    s_lshl_b64 s[66:67], 1, s101
    s_or_b32 s67, s67, 0x10000
    v_mov_b64 v[8:9], s[66:67]
    s_lshl_b32 s47, s19, 3
    s_mov_b64 exec, 1
    buffer_atomic_add_x2 v[8:9], off, s[4:7], s47 offset:128
    s_mov_b64 exec, -1
CH_i_5:
    s_waitcnt vmcnt(0)
    s_load_dwordx2 s[4:5], s[0:1], 40
    s_mov_b32 s6, 5242880
    s_mov_b32 s7, 0x20000
    s_load_dwordx2 s[8:9], s[0:1], 48
    s_mov_b32 s10, 5242880
    s_mov_b32 s11, 0x20000
    s_load_dwordx2 s[12:13], s[0:1], 56
    s_mov_b32 s14, 5242880
    s_mov_b32 s15, 0x20000
    s_load_dwordx2 s[24:25], s[0:1], 64
    s_mov_b32 s26, 5242880
    s_mov_b32 s27, 0x20000
    v_lshrrev_b32 v8, 4, v0
    v_bfe_u32 v9, v8, 4, 2
    v_mul_u32_u24 v9, 8192, v9
    v_bfe_u32 v10, v8, 4, 2
    v_mul_u32_u24 v10, 1280, v10
    v_xor_b32 v20, 0, v0
    v_and_b32 v20, 255, v20
    v_add_u32 v40, v9, v20
    v_add_u32 v44, v10, v20
    v_xor_b32 v20, 64, v0
    v_and_b32 v20, 255, v20
    v_add_u32 v41, v9, v20
    v_add_u32 v45, v10, v20
    v_xor_b32 v20, 128, v0
    v_and_b32 v20, 255, v20
    v_add_u32 v42, v9, v20
    v_add_u32 v46, v10, v20
    v_xor_b32 v20, 192, v0
    v_and_b32 v20, 255, v20
    v_add_u32 v43, v9, v20
    v_add_u32 v47, v10, v20
    v_bfe_u32 v11, v8, 3, 3
    v_mul_u32_u24 v11, 1280, v11
    v_bfe_u32 v20, v8, 0, 3
    v_lshl_add_u32 v11, v20, 4, v11
    s_lshl_b32 s47, s21, 6
    v_bfe_u32 v18, v8, 3, 1
    v_mul_u32_u24 v18, 128, v18
    v_bfe_u32 v20, v8, 2, 1
    v_lshl_add_u32 v18, v20, 6, v18
    v_xor_b32 v18, s47, v18
    v_bfe_u32 v12, v8, 3, 1
    v_mul_u32_u24 v12, 2048, v12
    v_bfe_u32 v20, v8, 2, 1
    v_lshl_add_u32 v12, v20, 10, v12
    v_bfe_u32 v20, v8, 4, 1
    v_lshl_add_u32 v12, v20, 9, v12
    v_bfe_u32 v20, v8, 0, 2
    v_lshl_add_u32 v12, v20, 3, v12
    v_add_u32 v12, v12, v18
    v_bfe_u32 v18, v8, 3, 1
    v_mul_u32_u24 v18, 128, v18
    v_bfe_u32 v20, v8, 4, 1
    v_lshl_add_u32 v18, v20, 6, v18
    v_xor_b32 v18, s47, v18
    v_bfe_u32 v13, v8, 3, 1
    v_mul_u32_u24 v13, 2048, v13
    v_bfe_u32 v20, v8, 4, 1
    v_lshl_add_u32 v13, v20, 10, v13
    v_bfe_u32 v20, v8, 2, 1
    v_lshl_add_u32 v13, v20, 8, v13
    v_bfe_u32 v20, v8, 0, 2
    v_lshl_add_u32 v13, v20, 3, v13
    v_add_u32 v13, v13, v18
    v_bfe_u32 v18, v8, 5, 1
    v_mul_u32_u24 v18, 128, v18
    v_bfe_u32 v20, v8, 3, 1
    v_lshl_add_u32 v18, v20, 6, v18
    v_xor_b32 v18, s47, v18
    v_bfe_u32 v14, v8, 5, 1
    v_mul_u32_u24 v14, 2048, v14
    v_bfe_u32 v20, v8, 3, 1
    v_lshl_add_u32 v14, v20, 10, v14
    v_bfe_u32 v20, v8, 2, 1
    v_lshl_add_u32 v14, v20, 8, v14
    v_bfe_u32 v20, v8, 0, 2
    v_lshl_add_u32 v14, v20, 4, v14
    v_add_u32 v14, v14, v18
    s_lshl_b32 s47, s21, 5
    v_bfe_u32 v15, v8, 4, 1
    v_mul_u32_u24 v15, 2048, v15
    v_bfe_u32 v20, v8, 5, 1
    v_lshl_add_u32 v15, v20, 10, v15
    v_bfe_u32 v20, v8, 3, 1
    v_lshl_add_u32 v15, v20, 9, v15
    v_bfe_u32 v20, v8, 2, 1
    v_lshl_add_u32 v15, v20, 7, v15
    v_bfe_u32 v20, v8, 0, 2
    v_lshl_add_u32 v15, v20, 3, v15
    v_add_u32 v15, s47, v15
    v_bfe_u32 v16, v8, 4, 1
    v_bfe_u32 v17, v8, 5, 1
    s_lshl_b32 s47, s20, 8
    s_lshl_b32 s48, s21, 17
    s_add_u32 s47, s47, s48
    s_mul_i32 s48, s19, 2621440
    s_add_u32 s66, s47, s48
    s_sub_u32 s67, s47, s48
    s_add_u32 s67, s67, 2621440
    s_mul_i32 s47, s20, 163840
    s_mul_i32 s48, s19, 640
    s_add_u32 s47, s47, s48
    s_mul_i32 s48, s21, 20480
    s_add_u32 s68, s47, s48
    s_add_u32 s69, s68, s48
    s_add_u32 s69, s69, 512
    s_lshl_b32 s70, s21, 13
    s_waitcnt lgkmcnt(0)
    s_add_u32 m0, s64, 4096
    s_add_u32 s47, s66, 2097152
    buffer_load_dwordx4 v40, s[4:7], s47 offen  lds
    s_add_u32 m0, s64, 5120
    s_add_u32 s47, s66, 2129920
    buffer_load_dwordx4 v41, s[4:7], s47 offen  lds
    s_add_u32 m0, s64, 6144
    s_add_u32 s47, s66, 2162688
    buffer_load_dwordx4 v42, s[4:7], s47 offen  lds
    s_add_u32 m0, s64, 7168
    s_add_u32 s47, s66, 2195456
    buffer_load_dwordx4 v43, s[4:7], s47 offen  lds
    s_add_u32 m0, s64, 8192
    s_add_u32 s47, s66, 2097152
    buffer_load_dwordx4 v40, s[8:11], s47 offen  lds
    s_add_u32 m0, s64, 9216
    s_add_u32 s47, s66, 2129920
    buffer_load_dwordx4 v41, s[8:11], s47 offen  lds
    s_add_u32 m0, s64, 10240
    s_add_u32 s47, s66, 2162688
    buffer_load_dwordx4 v42, s[8:11], s47 offen  lds
    s_add_u32 m0, s64, 11264
    s_add_u32 s47, s66, 2195456
    buffer_load_dwordx4 v43, s[8:11], s47 offen  lds
    s_add_u32 m0, s64, 12288
    s_add_u32 s47, s67, 2097152
    buffer_load_dwordx4 v40, s[8:11], s47 offen  lds
    s_add_u32 m0, s64, 13312
    s_add_u32 s47, s67, 2129920
    buffer_load_dwordx4 v41, s[8:11], s47 offen  lds
    s_add_u32 m0, s64, 14336
    s_add_u32 s47, s67, 2162688
    buffer_load_dwordx4 v42, s[8:11], s47 offen  lds
    s_add_u32 m0, s64, 15360
    s_add_u32 s47, s67, 2195456
    buffer_load_dwordx4 v43, s[8:11], s47 offen  lds
    s_add_u32 m0, s64, 16384
    s_add_u32 s47, s66, 0
    buffer_load_dwordx4 v40, s[12:15], s47 offen  lds
    s_add_u32 m0, s64, 17408
    s_add_u32 s47, s66, 32768
    buffer_load_dwordx4 v41, s[12:15], s47 offen  lds
    s_add_u32 m0, s64, 18432
    s_add_u32 s47, s66, 65536
    buffer_load_dwordx4 v42, s[12:15], s47 offen  lds
    s_add_u32 m0, s64, 19456
    s_add_u32 s47, s66, 98304
    buffer_load_dwordx4 v43, s[12:15], s47 offen  lds
    s_add_u32 m0, s64, 20480
    s_add_u32 s47, s66, 524288
    buffer_load_dwordx4 v40, s[12:15], s47 offen  lds
    s_add_u32 m0, s64, 21504
    s_add_u32 s47, s66, 557056
    buffer_load_dwordx4 v41, s[12:15], s47 offen  lds
    s_add_u32 m0, s64, 22528
    s_add_u32 s47, s66, 589824
    buffer_load_dwordx4 v42, s[12:15], s47 offen  lds
    s_add_u32 m0, s64, 23552
    s_add_u32 s47, s66, 622592
    buffer_load_dwordx4 v43, s[12:15], s47 offen  lds
    v_lshl_add_u32 v18, v17, 15, v13
    v_add_u32 v18, 32768, v18
    v_add_u32 v19, 65536, v18
    s_waitcnt vmcnt(16)
    s_barrier
    s_add_u32 m0, s64, 24576
    s_add_u32 s47, s66, 1048576
    buffer_load_dwordx4 v40, s[12:15], s47 offen  lds
    s_add_u32 m0, s64, 25600
    s_add_u32 s47, s66, 1081344
    buffer_load_dwordx4 v41, s[12:15], s47 offen  lds
    s_add_u32 m0, s64, 26624
    s_add_u32 s47, s66, 1114112
    buffer_load_dwordx4 v42, s[12:15], s47 offen  lds
    s_add_u32 m0, s64, 27648
    s_add_u32 s47, s66, 1146880
    buffer_load_dwordx4 v43, s[12:15], s47 offen  lds
    ds_read_b64_tr_b16 v[104:105], v18 offset:4096
    ds_read_b64_tr_b16 v[106:107], v18 offset:4608
    ds_read_b64_tr_b16 v[108:109], v19 offset:4096
    ds_read_b64_tr_b16 v[110:111], v19 offset:4608
    ds_read_b64_tr_b16 v[112:113], v18 offset:4128
    ds_read_b64_tr_b16 v[114:115], v18 offset:4640
    ds_read_b64_tr_b16 v[116:117], v19 offset:4128
    ds_read_b64_tr_b16 v[118:119], v19 offset:4640
    s_waitcnt lgkmcnt(0)
CH_u_6:
    v_lshl_add_u32 v18, v17, 15, v13
    v_add_u32 v18, 32768, v18
    v_add_u32 v19, 65536, v18
    s_waitcnt vmcnt(16)
    s_barrier
    s_add_u32 m0, s64, 4096
    s_add_u32 s47, s66, 1572864
    buffer_load_dwordx4 v40, s[12:15], s47 offen  lds
    s_add_u32 m0, s64, 5120
    s_add_u32 s47, s66, 1605632
    buffer_load_dwordx4 v41, s[12:15], s47 offen  lds
    s_add_u32 m0, s64, 6144
    s_add_u32 s47, s66, 1638400
    buffer_load_dwordx4 v42, s[12:15], s47 offen  lds
    s_add_u32 m0, s64, 7168
    s_add_u32 s47, s66, 1671168
    buffer_load_dwordx4 v43, s[12:15], s47 offen  lds
    ds_read_b64_tr_b16 v[120:121], v18 offset:8192
    ds_read_b64_tr_b16 v[122:123], v18 offset:8704
    ds_read_b64_tr_b16 v[124:125], v19 offset:8192
    ds_read_b64_tr_b16 v[126:127], v19 offset:8704
    ds_read_b64_tr_b16 v[128:129], v18 offset:8224
    ds_read_b64_tr_b16 v[130:131], v18 offset:8736
    ds_read_b64_tr_b16 v[132:133], v19 offset:8224
    ds_read_b64_tr_b16 v[134:135], v19 offset:8736
    s_waitcnt lgkmcnt(0)
CH_u_8:
    v_lshl_add_u32 v18, v17, 15, v13
    v_add_u32 v18, 32768, v18
    v_add_u32 v19, 65536, v18
    s_waitcnt vmcnt(16)
    s_barrier
    s_add_u32 m0, s64, 8192
    s_add_u32 s47, s67, 0
    buffer_load_dwordx4 v40, s[12:15], s47 offen  lds
    s_add_u32 m0, s64, 9216
    s_add_u32 s47, s67, 32768
    buffer_load_dwordx4 v41, s[12:15], s47 offen  lds
    s_add_u32 m0, s64, 10240
    s_add_u32 s47, s67, 65536
    buffer_load_dwordx4 v42, s[12:15], s47 offen  lds
    s_add_u32 m0, s64, 11264
    s_add_u32 s47, s67, 98304
    buffer_load_dwordx4 v43, s[12:15], s47 offen  lds
    ds_read_b64_tr_b16 a[48:49], v18 offset:12288
    ds_read_b64_tr_b16 a[50:51], v18 offset:12800
    ds_read_b64_tr_b16 a[52:53], v19 offset:12288
    ds_read_b64_tr_b16 a[54:55], v19 offset:12800
    ds_read_b64_tr_b16 a[56:57], v18 offset:12320
    ds_read_b64_tr_b16 a[58:59], v18 offset:12832
    ds_read_b64_tr_b16 a[60:61], v19 offset:12320
    ds_read_b64_tr_b16 a[62:63], v19 offset:12832
    s_waitcnt lgkmcnt(0)
CH_u_10:
    v_lshl_add_u32 v18, v17, 15, v12
    v_add_u32 v18, 32768, v18
    v_add_u32 v19, 65536, v18
    s_waitcnt vmcnt(16)
    s_barrier
    s_add_u32 m0, s64, 12288
    s_add_u32 s47, s67, 524288
    buffer_load_dwordx4 v40, s[12:15], s47 offen  lds
    s_add_u32 m0, s64, 13312
    s_add_u32 s47, s67, 557056
    buffer_load_dwordx4 v41, s[12:15], s47 offen  lds
    s_add_u32 m0, s64, 14336
    s_add_u32 s47, s67, 589824
    buffer_load_dwordx4 v42, s[12:15], s47 offen  lds
    s_add_u32 m0, s64, 15360
    s_add_u32 s47, s67, 622592
    buffer_load_dwordx4 v43, s[12:15], s47 offen  lds
    s_cmp_lg_u32 s21, 0
    s_cbranch_scc1 CH_u_13
    ds_read_b64_tr_b16 v[88:89], v18 offset:16384
    ds_read_b64_tr_b16 v[90:91], v18 offset:16640
    ds_read_b64_tr_b16 v[92:93], v19 offset:16384
    ds_read_b64_tr_b16 v[94:95], v19 offset:16640
    ds_read_b64_tr_b16 v[96:97], v18 offset:16416
    ds_read_b64_tr_b16 v[98:99], v18 offset:16672
    ds_read_b64_tr_b16 v[100:101], v19 offset:16416
    ds_read_b64_tr_b16 v[102:103], v19 offset:16672
    s_waitcnt lgkmcnt(0)
    s_branch CH_u_12
CH_u_13:
    s_cmp_lg_u32 s21, 1
    s_cbranch_scc1 CH_u_14
    ds_read_b64_tr_b16 v[168:169], v18 offset:16384
    ds_read_b64_tr_b16 v[170:171], v18 offset:16640
    ds_read_b64_tr_b16 v[172:173], v19 offset:16384
    ds_read_b64_tr_b16 v[174:175], v19 offset:16640
    ds_read_b64_tr_b16 v[176:177], v18 offset:16416
    ds_read_b64_tr_b16 v[178:179], v18 offset:16672
    ds_read_b64_tr_b16 v[180:181], v19 offset:16416
    ds_read_b64_tr_b16 v[182:183], v19 offset:16672
    s_waitcnt lgkmcnt(0)
    s_branch CH_u_12
CH_u_14:
    s_cmp_lg_u32 s21, 2
    s_cbranch_scc1 CH_u_15
    ds_read_b64_tr_b16 v[200:201], v18 offset:16384
    ds_read_b64_tr_b16 v[202:203], v18 offset:16640
    ds_read_b64_tr_b16 v[204:205], v19 offset:16384
    ds_read_b64_tr_b16 v[206:207], v19 offset:16640
    ds_read_b64_tr_b16 v[208:209], v18 offset:16416
    ds_read_b64_tr_b16 v[210:211], v18 offset:16672
    ds_read_b64_tr_b16 v[212:213], v19 offset:16416
    ds_read_b64_tr_b16 v[214:215], v19 offset:16672
    s_waitcnt lgkmcnt(0)
    s_branch CH_u_12
CH_u_15:
    ds_read_b64_tr_b16 v[248:249], v18 offset:16384
    ds_read_b64_tr_b16 v[250:251], v18 offset:16640
    ds_read_b64_tr_b16 v[252:253], v19 offset:16384
    ds_read_b64_tr_b16 v[254:255], v19 offset:16640
    ds_read_b64_tr_b16 a[0:1], v18 offset:16416
    ds_read_b64_tr_b16 a[2:3], v18 offset:16672
    ds_read_b64_tr_b16 a[4:5], v19 offset:16416
    ds_read_b64_tr_b16 a[6:7], v19 offset:16672
    s_waitcnt lgkmcnt(0)
CH_u_12:
    v_lshl_add_u32 v18, v17, 15, v12
    v_add_u32 v18, 32768, v18
    v_add_u32 v19, 65536, v18
    s_waitcnt vmcnt(16)
    s_barrier
    s_add_u32 m0, s64, 16384
    s_add_u32 s47, s67, 1048576
    buffer_load_dwordx4 v40, s[12:15], s47 offen  lds
    s_add_u32 m0, s64, 17408
    s_add_u32 s47, s67, 1081344
    buffer_load_dwordx4 v41, s[12:15], s47 offen  lds
    s_add_u32 m0, s64, 18432
    s_add_u32 s47, s67, 1114112
    buffer_load_dwordx4 v42, s[12:15], s47 offen  lds
    s_add_u32 m0, s64, 19456
    s_add_u32 s47, s67, 1146880
    buffer_load_dwordx4 v43, s[12:15], s47 offen  lds
    s_cmp_lg_u32 s21, 0
    s_cbranch_scc1 CH_u_18
    ds_read_b64_tr_b16 v[168:169], v18 offset:20480
    ds_read_b64_tr_b16 v[170:171], v18 offset:20736
    ds_read_b64_tr_b16 v[172:173], v19 offset:20480
    ds_read_b64_tr_b16 v[174:175], v19 offset:20736
    ds_read_b64_tr_b16 v[176:177], v18 offset:20512
    ds_read_b64_tr_b16 v[178:179], v18 offset:20768
    ds_read_b64_tr_b16 v[180:181], v19 offset:20512
    ds_read_b64_tr_b16 v[182:183], v19 offset:20768
    s_waitcnt lgkmcnt(0)
    s_branch CH_u_17
CH_u_18:
    s_cmp_lg_u32 s21, 1
    s_cbranch_scc1 CH_u_19
    ds_read_b64_tr_b16 v[88:89], v18 offset:20480
    ds_read_b64_tr_b16 v[90:91], v18 offset:20736
    ds_read_b64_tr_b16 v[92:93], v19 offset:20480
    ds_read_b64_tr_b16 v[94:95], v19 offset:20736
    ds_read_b64_tr_b16 v[96:97], v18 offset:20512
    ds_read_b64_tr_b16 v[98:99], v18 offset:20768
    ds_read_b64_tr_b16 v[100:101], v19 offset:20512
    ds_read_b64_tr_b16 v[102:103], v19 offset:20768
    s_waitcnt lgkmcnt(0)
    s_branch CH_u_17
CH_u_19:
    s_cmp_lg_u32 s21, 2
    s_cbranch_scc1 CH_u_20
    ds_read_b64_tr_b16 v[248:249], v18 offset:20480
    ds_read_b64_tr_b16 v[250:251], v18 offset:20736
    ds_read_b64_tr_b16 v[252:253], v19 offset:20480
    ds_read_b64_tr_b16 v[254:255], v19 offset:20736
    ds_read_b64_tr_b16 a[0:1], v18 offset:20512
    ds_read_b64_tr_b16 a[2:3], v18 offset:20768
    ds_read_b64_tr_b16 a[4:5], v19 offset:20512
    ds_read_b64_tr_b16 a[6:7], v19 offset:20768
    s_waitcnt lgkmcnt(0)
    s_branch CH_u_17
CH_u_20:
    ds_read_b64_tr_b16 v[200:201], v18 offset:20480
    ds_read_b64_tr_b16 v[202:203], v18 offset:20736
    ds_read_b64_tr_b16 v[204:205], v19 offset:20480
    ds_read_b64_tr_b16 v[206:207], v19 offset:20736
    ds_read_b64_tr_b16 v[208:209], v18 offset:20512
    ds_read_b64_tr_b16 v[210:211], v18 offset:20768
    ds_read_b64_tr_b16 v[212:213], v19 offset:20512
    ds_read_b64_tr_b16 v[214:215], v19 offset:20768
    s_waitcnt lgkmcnt(0)
CH_u_17:
    v_lshl_add_u32 v18, v17, 15, v12
    v_add_u32 v18, 32768, v18
    v_add_u32 v19, 65536, v18
    s_waitcnt vmcnt(16)
    s_barrier
    s_add_u32 m0, s64, 20480
    s_add_u32 s47, s67, 1572864
    buffer_load_dwordx4 v40, s[12:15], s47 offen  lds
    s_add_u32 m0, s64, 21504
    s_add_u32 s47, s67, 1605632
    buffer_load_dwordx4 v41, s[12:15], s47 offen  lds
    s_add_u32 m0, s64, 22528
    s_add_u32 s47, s67, 1638400
    buffer_load_dwordx4 v42, s[12:15], s47 offen  lds
    s_add_u32 m0, s64, 23552
    s_add_u32 s47, s67, 1671168
    buffer_load_dwordx4 v43, s[12:15], s47 offen  lds
    s_cmp_lg_u32 s21, 0
    s_cbranch_scc1 CH_u_23
    ds_read_b64_tr_b16 v[200:201], v18 offset:24576
    ds_read_b64_tr_b16 v[202:203], v18 offset:24832
    ds_read_b64_tr_b16 v[204:205], v19 offset:24576
    ds_read_b64_tr_b16 v[206:207], v19 offset:24832
    ds_read_b64_tr_b16 v[208:209], v18 offset:24608
    ds_read_b64_tr_b16 v[210:211], v18 offset:24864
    ds_read_b64_tr_b16 v[212:213], v19 offset:24608
    ds_read_b64_tr_b16 v[214:215], v19 offset:24864
    s_waitcnt lgkmcnt(0)
    s_branch CH_u_22
CH_u_23:
    s_cmp_lg_u32 s21, 1
    s_cbranch_scc1 CH_u_24
    ds_read_b64_tr_b16 v[248:249], v18 offset:24576
    ds_read_b64_tr_b16 v[250:251], v18 offset:24832
    ds_read_b64_tr_b16 v[252:253], v19 offset:24576
    ds_read_b64_tr_b16 v[254:255], v19 offset:24832
    ds_read_b64_tr_b16 a[0:1], v18 offset:24608
    ds_read_b64_tr_b16 a[2:3], v18 offset:24864
    ds_read_b64_tr_b16 a[4:5], v19 offset:24608
    ds_read_b64_tr_b16 a[6:7], v19 offset:24864
    s_waitcnt lgkmcnt(0)
    s_branch CH_u_22
CH_u_24:
    s_cmp_lg_u32 s21, 2
    s_cbranch_scc1 CH_u_25
    ds_read_b64_tr_b16 v[88:89], v18 offset:24576
    ds_read_b64_tr_b16 v[90:91], v18 offset:24832
    ds_read_b64_tr_b16 v[92:93], v19 offset:24576
    ds_read_b64_tr_b16 v[94:95], v19 offset:24832
    ds_read_b64_tr_b16 v[96:97], v18 offset:24608
    ds_read_b64_tr_b16 v[98:99], v18 offset:24864
    ds_read_b64_tr_b16 v[100:101], v19 offset:24608
    ds_read_b64_tr_b16 v[102:103], v19 offset:24864
    s_waitcnt lgkmcnt(0)
    s_branch CH_u_22
CH_u_25:
    ds_read_b64_tr_b16 v[168:169], v18 offset:24576
    ds_read_b64_tr_b16 v[170:171], v18 offset:24832
    ds_read_b64_tr_b16 v[172:173], v19 offset:24576
    ds_read_b64_tr_b16 v[174:175], v19 offset:24832
    ds_read_b64_tr_b16 v[176:177], v18 offset:24608
    ds_read_b64_tr_b16 v[178:179], v18 offset:24864
    ds_read_b64_tr_b16 v[180:181], v19 offset:24608
    ds_read_b64_tr_b16 v[182:183], v19 offset:24864
    s_waitcnt lgkmcnt(0)
CH_u_22:
    v_lshl_add_u32 v18, v17, 15, v12
    v_add_u32 v18, 32768, v18
    v_add_u32 v19, 65536, v18
    s_waitcnt vmcnt(16)
    s_barrier
    s_add_u32 m0, s64, 24576
    s_add_u32 s47, s67, 2097152
    buffer_load_dwordx4 v40, s[12:15], s47 offen  lds
    s_add_u32 m0, s64, 25600
    s_add_u32 s47, s67, 2129920
    buffer_load_dwordx4 v41, s[12:15], s47 offen  lds
    s_add_u32 m0, s64, 26624
    s_add_u32 s47, s67, 2162688
    buffer_load_dwordx4 v42, s[12:15], s47 offen  lds
    s_add_u32 m0, s64, 27648
    s_add_u32 s47, s67, 2195456
    buffer_load_dwordx4 v43, s[12:15], s47 offen  lds
    s_cmp_lg_u32 s21, 0
    s_cbranch_scc1 CH_u_28
    ds_read_b64_tr_b16 v[248:249], v18 offset:4096
    ds_read_b64_tr_b16 v[250:251], v18 offset:4352
    ds_read_b64_tr_b16 v[252:253], v19 offset:4096
    ds_read_b64_tr_b16 v[254:255], v19 offset:4352
    ds_read_b64_tr_b16 a[0:1], v18 offset:4128
    ds_read_b64_tr_b16 a[2:3], v18 offset:4384
    ds_read_b64_tr_b16 a[4:5], v19 offset:4128
    ds_read_b64_tr_b16 a[6:7], v19 offset:4384
    s_waitcnt lgkmcnt(0)
    s_branch CH_u_27
CH_u_28:
    s_cmp_lg_u32 s21, 1
    s_cbranch_scc1 CH_u_29
    ds_read_b64_tr_b16 v[200:201], v18 offset:4096
    ds_read_b64_tr_b16 v[202:203], v18 offset:4352
    ds_read_b64_tr_b16 v[204:205], v19 offset:4096
    ds_read_b64_tr_b16 v[206:207], v19 offset:4352
    ds_read_b64_tr_b16 v[208:209], v18 offset:4128
    ds_read_b64_tr_b16 v[210:211], v18 offset:4384
    ds_read_b64_tr_b16 v[212:213], v19 offset:4128
    ds_read_b64_tr_b16 v[214:215], v19 offset:4384
    s_waitcnt lgkmcnt(0)
    s_branch CH_u_27
CH_u_29:
    s_cmp_lg_u32 s21, 2
    s_cbranch_scc1 CH_u_30
    ds_read_b64_tr_b16 v[168:169], v18 offset:4096
    ds_read_b64_tr_b16 v[170:171], v18 offset:4352
    ds_read_b64_tr_b16 v[172:173], v19 offset:4096
    ds_read_b64_tr_b16 v[174:175], v19 offset:4352
    ds_read_b64_tr_b16 v[176:177], v18 offset:4128
    ds_read_b64_tr_b16 v[178:179], v18 offset:4384
    ds_read_b64_tr_b16 v[180:181], v19 offset:4128
    ds_read_b64_tr_b16 v[182:183], v19 offset:4384
    s_waitcnt lgkmcnt(0)
    s_branch CH_u_27
CH_u_30:
    ds_read_b64_tr_b16 v[88:89], v18 offset:4096
    ds_read_b64_tr_b16 v[90:91], v18 offset:4352
    ds_read_b64_tr_b16 v[92:93], v19 offset:4096
    ds_read_b64_tr_b16 v[94:95], v19 offset:4352
    ds_read_b64_tr_b16 v[96:97], v18 offset:4128
    ds_read_b64_tr_b16 v[98:99], v18 offset:4384
    ds_read_b64_tr_b16 v[100:101], v19 offset:4128
    ds_read_b64_tr_b16 v[102:103], v19 offset:4384
    s_waitcnt lgkmcnt(0)
CH_u_27:
    v_lshl_add_u32 v18, v17, 15, v12
    v_add_u32 v18, 32768, v18
    v_add_u32 v19, 65536, v18
    s_waitcnt vmcnt(16)
    s_barrier
    s_add_u32 m0, s64, 4096
    s_add_u32 s47, s68, 256
    buffer_load_dwordx4 v44, s[24:27], s47 offen  lds
    s_add_u32 m0, s64, 5120
    s_add_u32 s47, s68, 5376
    buffer_load_dwordx4 v45, s[24:27], s47 offen  lds
    s_add_u32 m0, s64, 6144
    s_add_u32 s47, s68, 10496
    buffer_load_dwordx4 v46, s[24:27], s47 offen  lds
    s_add_u32 m0, s64, 7168
    s_add_u32 s47, s68, 15616
    buffer_load_dwordx4 v47, s[24:27], s47 offen  lds
    s_cmp_lg_u32 s21, 0
    s_cbranch_scc1 CH_u_33
    ds_read_b64_tr_b16 a[144:145], v18 offset:8192
    ds_read_b64_tr_b16 a[146:147], v18 offset:8448
    ds_read_b64_tr_b16 a[148:149], v19 offset:8192
    ds_read_b64_tr_b16 a[150:151], v19 offset:8448
    ds_read_b64_tr_b16 a[152:153], v18 offset:8224
    ds_read_b64_tr_b16 a[154:155], v18 offset:8480
    ds_read_b64_tr_b16 a[156:157], v19 offset:8224
    ds_read_b64_tr_b16 a[158:159], v19 offset:8480
    s_waitcnt lgkmcnt(0)
    s_branch CH_u_32
CH_u_33:
    s_cmp_lg_u32 s21, 1
    s_cbranch_scc1 CH_u_34
    ds_read_b64_tr_b16 a[176:177], v18 offset:8192
    ds_read_b64_tr_b16 a[178:179], v18 offset:8448
    ds_read_b64_tr_b16 a[180:181], v19 offset:8192
    ds_read_b64_tr_b16 a[182:183], v19 offset:8448
    ds_read_b64_tr_b16 a[184:185], v18 offset:8224
    ds_read_b64_tr_b16 a[186:187], v18 offset:8480
    ds_read_b64_tr_b16 a[188:189], v19 offset:8224
    ds_read_b64_tr_b16 a[190:191], v19 offset:8480
    s_waitcnt lgkmcnt(0)
    s_branch CH_u_32
CH_u_34:
    s_cmp_lg_u32 s21, 2
    s_cbranch_scc1 CH_u_35
    ds_read_b64_tr_b16 a[192:193], v18 offset:8192
    ds_read_b64_tr_b16 a[194:195], v18 offset:8448
    ds_read_b64_tr_b16 a[196:197], v19 offset:8192
    ds_read_b64_tr_b16 a[198:199], v19 offset:8448
    ds_read_b64_tr_b16 a[200:201], v18 offset:8224
    ds_read_b64_tr_b16 a[202:203], v18 offset:8480
    ds_read_b64_tr_b16 a[204:205], v19 offset:8224
    ds_read_b64_tr_b16 a[206:207], v19 offset:8480
    s_waitcnt lgkmcnt(0)
    s_branch CH_u_32
CH_u_35:
    ds_read_b64_tr_b16 a[208:209], v18 offset:8192
    ds_read_b64_tr_b16 a[210:211], v18 offset:8448
    ds_read_b64_tr_b16 a[212:213], v19 offset:8192
    ds_read_b64_tr_b16 a[214:215], v19 offset:8448
    ds_read_b64_tr_b16 a[216:217], v18 offset:8224
    ds_read_b64_tr_b16 a[218:219], v18 offset:8480
    ds_read_b64_tr_b16 a[220:221], v19 offset:8224
    ds_read_b64_tr_b16 a[222:223], v19 offset:8480
    s_waitcnt lgkmcnt(0)
CH_u_32:
    v_lshl_add_u32 v18, v17, 15, v12
    v_add_u32 v18, 32768, v18
    v_add_u32 v19, 65536, v18
    s_waitcnt vmcnt(16)
    s_barrier
    s_add_u32 m0, s64, 8192
    s_add_u32 s47, s66, 2097152
    buffer_load_dwordx4 v40, s[12:15], s47 offen  lds
    s_add_u32 m0, s64, 9216
    s_add_u32 s47, s66, 2129920
    buffer_load_dwordx4 v41, s[12:15], s47 offen  lds
    s_add_u32 m0, s64, 10240
    s_add_u32 s47, s66, 2162688
    buffer_load_dwordx4 v42, s[12:15], s47 offen  lds
    s_add_u32 m0, s64, 11264
    s_add_u32 s47, s66, 2195456
    buffer_load_dwordx4 v43, s[12:15], s47 offen  lds
    s_cmp_lg_u32 s21, 0
    s_cbranch_scc1 CH_u_38
    ds_read_b64_tr_b16 a[176:177], v18 offset:12288
    ds_read_b64_tr_b16 a[178:179], v18 offset:12544
    ds_read_b64_tr_b16 a[180:181], v19 offset:12288
    ds_read_b64_tr_b16 a[182:183], v19 offset:12544
    ds_read_b64_tr_b16 a[184:185], v18 offset:12320
    ds_read_b64_tr_b16 a[186:187], v18 offset:12576
    ds_read_b64_tr_b16 a[188:189], v19 offset:12320
    ds_read_b64_tr_b16 a[190:191], v19 offset:12576
    s_waitcnt lgkmcnt(0)
    s_branch CH_u_37
CH_u_38:
    s_cmp_lg_u32 s21, 1
    s_cbranch_scc1 CH_u_39
    ds_read_b64_tr_b16 a[144:145], v18 offset:12288
    ds_read_b64_tr_b16 a[146:147], v18 offset:12544
    ds_read_b64_tr_b16 a[148:149], v19 offset:12288
    ds_read_b64_tr_b16 a[150:151], v19 offset:12544
    ds_read_b64_tr_b16 a[152:153], v18 offset:12320
    ds_read_b64_tr_b16 a[154:155], v18 offset:12576
    ds_read_b64_tr_b16 a[156:157], v19 offset:12320
    ds_read_b64_tr_b16 a[158:159], v19 offset:12576
    s_waitcnt lgkmcnt(0)
    s_branch CH_u_37
CH_u_39:
    s_cmp_lg_u32 s21, 2
    s_cbranch_scc1 CH_u_40
    ds_read_b64_tr_b16 a[208:209], v18 offset:12288
    ds_read_b64_tr_b16 a[210:211], v18 offset:12544
    ds_read_b64_tr_b16 a[212:213], v19 offset:12288
    ds_read_b64_tr_b16 a[214:215], v19 offset:12544
    ds_read_b64_tr_b16 a[216:217], v18 offset:12320
    ds_read_b64_tr_b16 a[218:219], v18 offset:12576
    ds_read_b64_tr_b16 a[220:221], v19 offset:12320
    ds_read_b64_tr_b16 a[222:223], v19 offset:12576
    s_waitcnt lgkmcnt(0)
    s_branch CH_u_37
CH_u_40:
    ds_read_b64_tr_b16 a[192:193], v18 offset:12288
    ds_read_b64_tr_b16 a[194:195], v18 offset:12544
    ds_read_b64_tr_b16 a[196:197], v19 offset:12288
    ds_read_b64_tr_b16 a[198:199], v19 offset:12544
    ds_read_b64_tr_b16 a[200:201], v18 offset:12320
    ds_read_b64_tr_b16 a[202:203], v18 offset:12576
    ds_read_b64_tr_b16 a[204:205], v19 offset:12320
    ds_read_b64_tr_b16 a[206:207], v19 offset:12576
    s_waitcnt lgkmcnt(0)
CH_u_37:
    v_lshl_add_u32 v18, v17, 15, v12
    v_add_u32 v18, 32768, v18
    v_add_u32 v19, 65536, v18
    s_waitcnt vmcnt(16)
    s_barrier
    s_add_u32 m0, s64, 12288
    s_add_u32 s47, s66, 0
    buffer_load_dwordx4 v40, s[4:7], s47 offen  lds
    s_add_u32 m0, s64, 13312
    s_add_u32 s47, s66, 32768
    buffer_load_dwordx4 v41, s[4:7], s47 offen  lds
    s_add_u32 m0, s64, 14336
    s_add_u32 s47, s66, 65536
    buffer_load_dwordx4 v42, s[4:7], s47 offen  lds
    s_add_u32 m0, s64, 15360
    s_add_u32 s47, s66, 98304
    buffer_load_dwordx4 v43, s[4:7], s47 offen  lds
    s_cmp_lg_u32 s21, 0
    s_cbranch_scc1 CH_u_43
    ds_read_b64_tr_b16 a[192:193], v18 offset:16384
    ds_read_b64_tr_b16 a[194:195], v18 offset:16640
    ds_read_b64_tr_b16 a[196:197], v19 offset:16384
    ds_read_b64_tr_b16 a[198:199], v19 offset:16640
    ds_read_b64_tr_b16 a[200:201], v18 offset:16416
    ds_read_b64_tr_b16 a[202:203], v18 offset:16672
    ds_read_b64_tr_b16 a[204:205], v19 offset:16416
    ds_read_b64_tr_b16 a[206:207], v19 offset:16672
    s_waitcnt lgkmcnt(0)
    s_branch CH_u_42
CH_u_43:
    s_cmp_lg_u32 s21, 1
    s_cbranch_scc1 CH_u_44
    ds_read_b64_tr_b16 a[208:209], v18 offset:16384
    ds_read_b64_tr_b16 a[210:211], v18 offset:16640
    ds_read_b64_tr_b16 a[212:213], v19 offset:16384
    ds_read_b64_tr_b16 a[214:215], v19 offset:16640
    ds_read_b64_tr_b16 a[216:217], v18 offset:16416
    ds_read_b64_tr_b16 a[218:219], v18 offset:16672
    ds_read_b64_tr_b16 a[220:221], v19 offset:16416
    ds_read_b64_tr_b16 a[222:223], v19 offset:16672
    s_waitcnt lgkmcnt(0)
    s_branch CH_u_42
CH_u_44:
    s_cmp_lg_u32 s21, 2
    s_cbranch_scc1 CH_u_45
    ds_read_b64_tr_b16 a[144:145], v18 offset:16384
    ds_read_b64_tr_b16 a[146:147], v18 offset:16640
    ds_read_b64_tr_b16 a[148:149], v19 offset:16384
    ds_read_b64_tr_b16 a[150:151], v19 offset:16640
    ds_read_b64_tr_b16 a[152:153], v18 offset:16416
    ds_read_b64_tr_b16 a[154:155], v18 offset:16672
    ds_read_b64_tr_b16 a[156:157], v19 offset:16416
    ds_read_b64_tr_b16 a[158:159], v19 offset:16672
    s_waitcnt lgkmcnt(0)
    s_branch CH_u_42
CH_u_45:
    ds_read_b64_tr_b16 a[176:177], v18 offset:16384
    ds_read_b64_tr_b16 a[178:179], v18 offset:16640
    ds_read_b64_tr_b16 a[180:181], v19 offset:16384
    ds_read_b64_tr_b16 a[182:183], v19 offset:16640
    ds_read_b64_tr_b16 a[184:185], v18 offset:16416
    ds_read_b64_tr_b16 a[186:187], v18 offset:16672
    ds_read_b64_tr_b16 a[188:189], v19 offset:16416
    ds_read_b64_tr_b16 a[190:191], v19 offset:16672
    s_waitcnt lgkmcnt(0)
CH_u_42:
    v_lshl_add_u32 v18, v17, 15, v12
    v_add_u32 v18, 32768, v18
    v_add_u32 v19, 65536, v18
    s_waitcnt vmcnt(16)
    s_barrier
    s_add_u32 m0, s64, 16384
    s_add_u32 s47, s66, 524288
    buffer_load_dwordx4 v40, s[4:7], s47 offen  lds
    s_add_u32 m0, s64, 17408
    s_add_u32 s47, s66, 557056
    buffer_load_dwordx4 v41, s[4:7], s47 offen  lds
    s_add_u32 m0, s64, 18432
    s_add_u32 s47, s66, 589824
    buffer_load_dwordx4 v42, s[4:7], s47 offen  lds
    s_add_u32 m0, s64, 19456
    s_add_u32 s47, s66, 622592
    buffer_load_dwordx4 v43, s[4:7], s47 offen  lds
    s_cmp_lg_u32 s21, 0
    s_cbranch_scc1 CH_u_48
    ds_read_b64_tr_b16 a[208:209], v18 offset:20480
    ds_read_b64_tr_b16 a[210:211], v18 offset:20736
    ds_read_b64_tr_b16 a[212:213], v19 offset:20480
    ds_read_b64_tr_b16 a[214:215], v19 offset:20736
    ds_read_b64_tr_b16 a[216:217], v18 offset:20512
    ds_read_b64_tr_b16 a[218:219], v18 offset:20768
    ds_read_b64_tr_b16 a[220:221], v19 offset:20512
    ds_read_b64_tr_b16 a[222:223], v19 offset:20768
    s_waitcnt lgkmcnt(0)
    s_branch CH_u_47
CH_u_48:
    s_cmp_lg_u32 s21, 1
    s_cbranch_scc1 CH_u_49
    ds_read_b64_tr_b16 a[192:193], v18 offset:20480
    ds_read_b64_tr_b16 a[194:195], v18 offset:20736
    ds_read_b64_tr_b16 a[196:197], v19 offset:20480
    ds_read_b64_tr_b16 a[198:199], v19 offset:20736
    ds_read_b64_tr_b16 a[200:201], v18 offset:20512
    ds_read_b64_tr_b16 a[202:203], v18 offset:20768
    ds_read_b64_tr_b16 a[204:205], v19 offset:20512
    ds_read_b64_tr_b16 a[206:207], v19 offset:20768
    s_waitcnt lgkmcnt(0)
    s_branch CH_u_47
CH_u_49:
    s_cmp_lg_u32 s21, 2
    s_cbranch_scc1 CH_u_50
    ds_read_b64_tr_b16 a[176:177], v18 offset:20480
    ds_read_b64_tr_b16 a[178:179], v18 offset:20736
    ds_read_b64_tr_b16 a[180:181], v19 offset:20480
    ds_read_b64_tr_b16 a[182:183], v19 offset:20736
    ds_read_b64_tr_b16 a[184:185], v18 offset:20512
    ds_read_b64_tr_b16 a[186:187], v18 offset:20768
    ds_read_b64_tr_b16 a[188:189], v19 offset:20512
    ds_read_b64_tr_b16 a[190:191], v19 offset:20768
    s_waitcnt lgkmcnt(0)
    s_branch CH_u_47
CH_u_50:
    ds_read_b64_tr_b16 a[144:145], v18 offset:20480
    ds_read_b64_tr_b16 a[146:147], v18 offset:20736
    ds_read_b64_tr_b16 a[148:149], v19 offset:20480
    ds_read_b64_tr_b16 a[150:151], v19 offset:20736
    ds_read_b64_tr_b16 a[152:153], v18 offset:20512
    ds_read_b64_tr_b16 a[154:155], v18 offset:20768
    ds_read_b64_tr_b16 a[156:157], v19 offset:20512
    ds_read_b64_tr_b16 a[158:159], v19 offset:20768
    s_waitcnt lgkmcnt(0)
CH_u_47:
    v_lshl_add_u32 v18, v17, 15, v13
    v_add_u32 v18, 32768, v18
    v_add_u32 v19, 65536, v18
    s_waitcnt vmcnt(16)
    s_barrier
    s_add_u32 m0, s64, 20480
    s_add_u32 s47, s66, 1048576
    buffer_load_dwordx4 v40, s[4:7], s47 offen  lds
    s_add_u32 m0, s64, 21504
    s_add_u32 s47, s66, 1081344
    buffer_load_dwordx4 v41, s[4:7], s47 offen  lds
    s_add_u32 m0, s64, 22528
    s_add_u32 s47, s66, 1114112
    buffer_load_dwordx4 v42, s[4:7], s47 offen  lds
    s_add_u32 m0, s64, 23552
    s_add_u32 s47, s66, 1146880
    buffer_load_dwordx4 v43, s[4:7], s47 offen  lds
    ds_read_b64_tr_b16 a[160:161], v18 offset:24576
    ds_read_b64_tr_b16 a[162:163], v18 offset:25088
    ds_read_b64_tr_b16 a[164:165], v19 offset:24576
    ds_read_b64_tr_b16 a[166:167], v19 offset:25088
    ds_read_b64_tr_b16 a[168:169], v18 offset:24608
    ds_read_b64_tr_b16 a[170:171], v18 offset:25120
    ds_read_b64_tr_b16 a[172:173], v19 offset:24608
    ds_read_b64_tr_b16 a[174:175], v19 offset:25120
    s_waitcnt lgkmcnt(0)
CH_u_52:
    v_lshl_add_u32 v18, v16, 15, v14
    v_add_u32 v18, 32768, v18
    v_add_u32 v19, 65536, v18
    s_waitcnt vmcnt(16)
    s_barrier
    s_add_u32 m0, s64, 24576
    s_add_u32 s47, s66, 1572864
    buffer_load_dwordx4 v40, s[4:7], s47 offen  lds
    s_add_u32 m0, s64, 25600
    s_add_u32 s47, s66, 1605632
    buffer_load_dwordx4 v41, s[4:7], s47 offen  lds
    s_add_u32 m0, s64, 26624
    s_add_u32 s47, s66, 1638400
    buffer_load_dwordx4 v42, s[4:7], s47 offen  lds
    s_add_u32 m0, s64, 27648
    s_add_u32 s47, s66, 1671168
    buffer_load_dwordx4 v43, s[4:7], s47 offen  lds
    ds_read_b64_tr_b16 a[232:233], v18 offset:4096
    ds_read_b64_tr_b16 a[234:235], v18 offset:4608
    ds_read_b64_tr_b16 a[236:237], v19 offset:4096
    ds_read_b64_tr_b16 a[238:239], v19 offset:4608
    ds_read_b64_tr_b16 a[248:249], v18 offset:4104
    ds_read_b64_tr_b16 a[250:251], v18 offset:4616
    ds_read_b64_tr_b16 a[252:253], v19 offset:4104
    ds_read_b64_tr_b16 a[254:255], v19 offset:4616
    s_waitcnt lgkmcnt(0)
CH_u_54:
    v_lshl_add_u32 v18, v17, 15, v13
    v_add_u32 v18, 32768, v18
    v_add_u32 v19, 65536, v18
    s_waitcnt vmcnt(16)
    s_barrier
    s_add_u32 m0, s64, 28672
    s_add_u32 s47, s66, 0
    buffer_load_dwordx4 v40, s[8:11], s47 offen  lds
    s_add_u32 m0, s64, 29696
    s_add_u32 s47, s66, 32768
    buffer_load_dwordx4 v41, s[8:11], s47 offen  lds
    s_add_u32 m0, s64, 30720
    s_add_u32 s47, s66, 65536
    buffer_load_dwordx4 v42, s[8:11], s47 offen  lds
    s_add_u32 m0, s64, 31744
    s_add_u32 s47, s66, 98304
    buffer_load_dwordx4 v43, s[8:11], s47 offen  lds
    ds_read_b64_tr_b16 v[24:25], v18 offset:8192
    ds_read_b64_tr_b16 v[26:27], v18 offset:8704
    ds_read_b64_tr_b16 v[28:29], v19 offset:8192
    ds_read_b64_tr_b16 v[30:31], v19 offset:8704
    ds_read_b64_tr_b16 v[136:137], v18 offset:8224
    ds_read_b64_tr_b16 v[138:139], v18 offset:8736
    ds_read_b64_tr_b16 v[140:141], v19 offset:8224
    ds_read_b64_tr_b16 v[142:143], v19 offset:8736
    s_waitcnt lgkmcnt(6)
    ds_write_b128 v1, v[24:27] offset:6144
    s_waitcnt lgkmcnt(5)
    ds_write_b128 v1, v[28:31] offset:7168
    s_waitcnt lgkmcnt(0)
CH_u_56:
    v_lshl_add_u32 v18, v17, 15, v12
    v_add_u32 v18, 32768, v18
    v_add_u32 v19, 65536, v18
    s_waitcnt vmcnt(16)
    s_barrier
    s_add_u32 m0, s70, 0
    s_add_u32 s47, s66, 524288
    buffer_load_dwordx4 v40, s[8:11], s47 offen  lds
    s_add_u32 m0, s70, 1024
    s_add_u32 s47, s66, 557056
    buffer_load_dwordx4 v41, s[8:11], s47 offen  lds
    s_add_u32 m0, s70, 2048
    s_add_u32 s47, s66, 589824
    buffer_load_dwordx4 v42, s[8:11], s47 offen  lds
    s_add_u32 m0, s70, 3072
    s_add_u32 s47, s66, 622592
    buffer_load_dwordx4 v43, s[8:11], s47 offen  lds
    s_cmp_lg_u32 s21, 0
    s_cbranch_scc1 CH_u_59
    ds_read_b64_tr_b16 v[64:65], v18 offset:12288
    ds_read_b64_tr_b16 v[66:67], v18 offset:12544
    ds_read_b64_tr_b16 v[68:69], v19 offset:12288
    ds_read_b64_tr_b16 v[70:71], v19 offset:12544
    ds_read_b64_tr_b16 v[72:73], v18 offset:12320
    ds_read_b64_tr_b16 v[74:75], v18 offset:12576
    ds_read_b64_tr_b16 v[76:77], v19 offset:12320
    ds_read_b64_tr_b16 v[78:79], v19 offset:12576
    s_waitcnt lgkmcnt(0)
    s_branch CH_u_58
CH_u_59:
    s_cmp_lg_u32 s21, 1
    s_cbranch_scc1 CH_u_60
    ds_read_b64_tr_b16 v[144:145], v18 offset:12288
    ds_read_b64_tr_b16 v[146:147], v18 offset:12544
    ds_read_b64_tr_b16 v[148:149], v19 offset:12288
    ds_read_b64_tr_b16 v[150:151], v19 offset:12544
    ds_read_b64_tr_b16 v[152:153], v18 offset:12320
    ds_read_b64_tr_b16 v[154:155], v18 offset:12576
    ds_read_b64_tr_b16 v[156:157], v19 offset:12320
    ds_read_b64_tr_b16 v[158:159], v19 offset:12576
    s_waitcnt lgkmcnt(0)
    s_branch CH_u_58
CH_u_60:
    s_cmp_lg_u32 s21, 2
    s_cbranch_scc1 CH_u_61
    ds_read_b64_tr_b16 v[184:185], v18 offset:12288
    ds_read_b64_tr_b16 v[186:187], v18 offset:12544
    ds_read_b64_tr_b16 v[188:189], v19 offset:12288
    ds_read_b64_tr_b16 v[190:191], v19 offset:12544
    ds_read_b64_tr_b16 v[32:33], v18 offset:12320
    ds_read_b64_tr_b16 v[34:35], v18 offset:12576
    ds_read_b64_tr_b16 v[36:37], v19 offset:12320
    ds_read_b64_tr_b16 v[38:39], v19 offset:12576
    s_waitcnt lgkmcnt(2)
    ds_write_b128 v1, v[32:35] offset:10240
    s_waitcnt lgkmcnt(1)
    ds_write_b128 v1, v[36:39] offset:11264
    s_waitcnt lgkmcnt(0)
    s_branch CH_u_58
CH_u_61:
    ds_read_b64_tr_b16 v[216:217], v18 offset:12288
    ds_read_b64_tr_b16 v[218:219], v18 offset:12544
    ds_read_b64_tr_b16 v[220:221], v19 offset:12288
    ds_read_b64_tr_b16 v[222:223], v19 offset:12544
    ds_read_b64_tr_b16 v[224:225], v18 offset:12320
    ds_read_b64_tr_b16 v[226:227], v18 offset:12576
    ds_read_b64_tr_b16 v[228:229], v19 offset:12320
    ds_read_b64_tr_b16 v[230:231], v19 offset:12576
    s_waitcnt lgkmcnt(0)
CH_u_58:
    v_lshl_add_u32 v18, v17, 15, v12
    v_add_u32 v18, 32768, v18
    v_add_u32 v19, 65536, v18
    s_waitcnt vmcnt(16)
    s_barrier
    s_add_u32 m0, s70, 4096
    s_add_u32 s47, s66, 1048576
    buffer_load_dwordx4 v40, s[8:11], s47 offen  lds
    s_add_u32 m0, s70, 5120
    s_add_u32 s47, s66, 1081344
    buffer_load_dwordx4 v41, s[8:11], s47 offen  lds
    s_add_u32 m0, s70, 6144
    s_add_u32 s47, s66, 1114112
    buffer_load_dwordx4 v42, s[8:11], s47 offen  lds
    s_add_u32 m0, s70, 7168
    s_add_u32 s47, s66, 1146880
    buffer_load_dwordx4 v43, s[8:11], s47 offen  lds
    s_cmp_lg_u32 s21, 0
    s_cbranch_scc1 CH_u_64
    ds_read_b64_tr_b16 v[144:145], v18 offset:16384
    ds_read_b64_tr_b16 v[146:147], v18 offset:16640
    ds_read_b64_tr_b16 v[148:149], v19 offset:16384
    ds_read_b64_tr_b16 v[150:151], v19 offset:16640
    ds_read_b64_tr_b16 v[152:153], v18 offset:16416
    ds_read_b64_tr_b16 v[154:155], v18 offset:16672
    ds_read_b64_tr_b16 v[156:157], v19 offset:16416
    ds_read_b64_tr_b16 v[158:159], v19 offset:16672
    s_waitcnt lgkmcnt(0)
    s_branch CH_u_63
CH_u_64:
    s_cmp_lg_u32 s21, 1
    s_cbranch_scc1 CH_u_65
    ds_read_b64_tr_b16 v[64:65], v18 offset:16384
    ds_read_b64_tr_b16 v[66:67], v18 offset:16640
    ds_read_b64_tr_b16 v[68:69], v19 offset:16384
    ds_read_b64_tr_b16 v[70:71], v19 offset:16640
    ds_read_b64_tr_b16 v[72:73], v18 offset:16416
    ds_read_b64_tr_b16 v[74:75], v18 offset:16672
    ds_read_b64_tr_b16 v[76:77], v19 offset:16416
    ds_read_b64_tr_b16 v[78:79], v19 offset:16672
    s_waitcnt lgkmcnt(0)
    s_branch CH_u_63
CH_u_65:
    s_cmp_lg_u32 s21, 2
    s_cbranch_scc1 CH_u_66
    ds_read_b64_tr_b16 v[216:217], v18 offset:16384
    ds_read_b64_tr_b16 v[218:219], v18 offset:16640
    ds_read_b64_tr_b16 v[220:221], v19 offset:16384
    ds_read_b64_tr_b16 v[222:223], v19 offset:16640
    ds_read_b64_tr_b16 v[224:225], v18 offset:16416
    ds_read_b64_tr_b16 v[226:227], v18 offset:16672
    ds_read_b64_tr_b16 v[228:229], v19 offset:16416
    ds_read_b64_tr_b16 v[230:231], v19 offset:16672
    s_waitcnt lgkmcnt(0)
    s_branch CH_u_63
CH_u_66:
    ds_read_b64_tr_b16 v[184:185], v18 offset:16384
    ds_read_b64_tr_b16 v[186:187], v18 offset:16640
    ds_read_b64_tr_b16 v[188:189], v19 offset:16384
    ds_read_b64_tr_b16 v[190:191], v19 offset:16640
    ds_read_b64_tr_b16 v[32:33], v18 offset:16416
    ds_read_b64_tr_b16 v[34:35], v18 offset:16672
    ds_read_b64_tr_b16 v[36:37], v19 offset:16416
    ds_read_b64_tr_b16 v[38:39], v19 offset:16672
    s_waitcnt lgkmcnt(2)
    ds_write_b128 v1, v[32:35] offset:10240
    s_waitcnt lgkmcnt(1)
    ds_write_b128 v1, v[36:39] offset:11264
    s_waitcnt lgkmcnt(0)
CH_u_63:
    v_lshl_add_u32 v18, v17, 15, v12
    v_add_u32 v18, 32768, v18
    v_add_u32 v19, 65536, v18
    s_waitcnt vmcnt(16)
    s_barrier
    s_add_u32 m0, s64, 16384
    s_add_u32 s47, s66, 1572864
    buffer_load_dwordx4 v40, s[8:11], s47 offen  lds
    s_add_u32 m0, s64, 17408
    s_add_u32 s47, s66, 1605632
    buffer_load_dwordx4 v41, s[8:11], s47 offen  lds
    s_add_u32 m0, s64, 18432
    s_add_u32 s47, s66, 1638400
    buffer_load_dwordx4 v42, s[8:11], s47 offen  lds
    s_add_u32 m0, s64, 19456
    s_add_u32 s47, s66, 1671168
    buffer_load_dwordx4 v43, s[8:11], s47 offen  lds
    s_cmp_lg_u32 s21, 0
    s_cbranch_scc1 CH_u_69
    ds_read_b64_tr_b16 v[184:185], v18 offset:20480
    ds_read_b64_tr_b16 v[186:187], v18 offset:20736
    ds_read_b64_tr_b16 v[188:189], v19 offset:20480
    ds_read_b64_tr_b16 v[190:191], v19 offset:20736
    ds_read_b64_tr_b16 v[32:33], v18 offset:20512
    ds_read_b64_tr_b16 v[34:35], v18 offset:20768
    ds_read_b64_tr_b16 v[36:37], v19 offset:20512
    ds_read_b64_tr_b16 v[38:39], v19 offset:20768
    s_waitcnt lgkmcnt(2)
    ds_write_b128 v1, v[32:35] offset:10240
    s_waitcnt lgkmcnt(1)
    ds_write_b128 v1, v[36:39] offset:11264
    s_waitcnt lgkmcnt(0)
    s_branch CH_u_68
CH_u_69:
    s_cmp_lg_u32 s21, 1
    s_cbranch_scc1 CH_u_70
    ds_read_b64_tr_b16 v[216:217], v18 offset:20480
    ds_read_b64_tr_b16 v[218:219], v18 offset:20736
    ds_read_b64_tr_b16 v[220:221], v19 offset:20480
    ds_read_b64_tr_b16 v[222:223], v19 offset:20736
    ds_read_b64_tr_b16 v[224:225], v18 offset:20512
    ds_read_b64_tr_b16 v[226:227], v18 offset:20768
    ds_read_b64_tr_b16 v[228:229], v19 offset:20512
    ds_read_b64_tr_b16 v[230:231], v19 offset:20768
    s_waitcnt lgkmcnt(0)
    s_branch CH_u_68
CH_u_70:
    s_cmp_lg_u32 s21, 2
    s_cbranch_scc1 CH_u_71
    ds_read_b64_tr_b16 v[64:65], v18 offset:20480
    ds_read_b64_tr_b16 v[66:67], v18 offset:20736
    ds_read_b64_tr_b16 v[68:69], v19 offset:20480
    ds_read_b64_tr_b16 v[70:71], v19 offset:20736
    ds_read_b64_tr_b16 v[72:73], v18 offset:20512
    ds_read_b64_tr_b16 v[74:75], v18 offset:20768
    ds_read_b64_tr_b16 v[76:77], v19 offset:20512
    ds_read_b64_tr_b16 v[78:79], v19 offset:20768
    s_waitcnt lgkmcnt(0)
    s_branch CH_u_68
CH_u_71:
    ds_read_b64_tr_b16 v[144:145], v18 offset:20480
    ds_read_b64_tr_b16 v[146:147], v18 offset:20736
    ds_read_b64_tr_b16 v[148:149], v19 offset:20480
    ds_read_b64_tr_b16 v[150:151], v19 offset:20736
    ds_read_b64_tr_b16 v[152:153], v18 offset:20512
    ds_read_b64_tr_b16 v[154:155], v18 offset:20768
    ds_read_b64_tr_b16 v[156:157], v19 offset:20512
    ds_read_b64_tr_b16 v[158:159], v19 offset:20768
    s_waitcnt lgkmcnt(0)
CH_u_68:
    v_lshl_add_u32 v18, v17, 15, v12
    v_add_u32 v18, 32768, v18
    v_add_u32 v19, 65536, v18
    s_waitcnt vmcnt(16)
    s_barrier
    s_add_u32 m0, s64, 20480
    s_add_u32 s47, s67, 2097152
    buffer_load_dwordx4 v40, s[4:7], s47 offen  lds
    s_add_u32 m0, s64, 21504
    s_add_u32 s47, s67, 2129920
    buffer_load_dwordx4 v41, s[4:7], s47 offen  lds
    s_add_u32 m0, s64, 22528
    s_add_u32 s47, s67, 2162688
    buffer_load_dwordx4 v42, s[4:7], s47 offen  lds
    s_add_u32 m0, s64, 23552
    s_add_u32 s47, s67, 2195456
    buffer_load_dwordx4 v43, s[4:7], s47 offen  lds
    s_cmp_lg_u32 s21, 0
    s_cbranch_scc1 CH_u_74
    ds_read_b64_tr_b16 v[216:217], v18 offset:24576
    ds_read_b64_tr_b16 v[218:219], v18 offset:24832
    ds_read_b64_tr_b16 v[220:221], v19 offset:24576
    ds_read_b64_tr_b16 v[222:223], v19 offset:24832
    ds_read_b64_tr_b16 v[224:225], v18 offset:24608
    ds_read_b64_tr_b16 v[226:227], v18 offset:24864
    ds_read_b64_tr_b16 v[228:229], v19 offset:24608
    ds_read_b64_tr_b16 v[230:231], v19 offset:24864
    s_waitcnt lgkmcnt(0)
    s_branch CH_u_73
CH_u_74:
    s_cmp_lg_u32 s21, 1
    s_cbranch_scc1 CH_u_75
    ds_read_b64_tr_b16 v[184:185], v18 offset:24576
    ds_read_b64_tr_b16 v[186:187], v18 offset:24832
    ds_read_b64_tr_b16 v[188:189], v19 offset:24576
    ds_read_b64_tr_b16 v[190:191], v19 offset:24832
    ds_read_b64_tr_b16 v[32:33], v18 offset:24608
    ds_read_b64_tr_b16 v[34:35], v18 offset:24864
    ds_read_b64_tr_b16 v[36:37], v19 offset:24608
    ds_read_b64_tr_b16 v[38:39], v19 offset:24864
    s_waitcnt lgkmcnt(2)
    ds_write_b128 v1, v[32:35] offset:10240
    s_waitcnt lgkmcnt(1)
    ds_write_b128 v1, v[36:39] offset:11264
    s_waitcnt lgkmcnt(0)
    s_branch CH_u_73
CH_u_75:
    s_cmp_lg_u32 s21, 2
    s_cbranch_scc1 CH_u_76
    ds_read_b64_tr_b16 v[144:145], v18 offset:24576
    ds_read_b64_tr_b16 v[146:147], v18 offset:24832
    ds_read_b64_tr_b16 v[148:149], v19 offset:24576
    ds_read_b64_tr_b16 v[150:151], v19 offset:24832
    ds_read_b64_tr_b16 v[152:153], v18 offset:24608
    ds_read_b64_tr_b16 v[154:155], v18 offset:24864
    ds_read_b64_tr_b16 v[156:157], v19 offset:24608
    ds_read_b64_tr_b16 v[158:159], v19 offset:24864
    s_waitcnt lgkmcnt(0)
    s_branch CH_u_73
CH_u_76:
    ds_read_b64_tr_b16 v[64:65], v18 offset:24576
    ds_read_b64_tr_b16 v[66:67], v18 offset:24832
    ds_read_b64_tr_b16 v[68:69], v19 offset:24576
    ds_read_b64_tr_b16 v[70:71], v19 offset:24832
    ds_read_b64_tr_b16 v[72:73], v18 offset:24608
    ds_read_b64_tr_b16 v[74:75], v18 offset:24864
    ds_read_b64_tr_b16 v[76:77], v19 offset:24608
    ds_read_b64_tr_b16 v[78:79], v19 offset:24864
    s_waitcnt lgkmcnt(0)
CH_u_73:
    v_lshl_add_u32 v18, v17, 15, v12
    v_add_u32 v18, 32768, v18
    v_add_u32 v19, 65536, v18
    s_waitcnt vmcnt(16)
    s_barrier
    s_add_u32 m0, s64, 24576
    s_add_u32 s47, s67, 0
    buffer_load_dwordx4 v40, s[4:7], s47 offen  lds
    s_add_u32 m0, s64, 25600
    s_add_u32 s47, s67, 32768
    buffer_load_dwordx4 v41, s[4:7], s47 offen  lds
    s_add_u32 m0, s64, 26624
    s_add_u32 s47, s67, 65536
    buffer_load_dwordx4 v42, s[4:7], s47 offen  lds
    s_add_u32 m0, s64, 27648
    s_add_u32 s47, s67, 98304
    buffer_load_dwordx4 v43, s[4:7], s47 offen  lds
    s_cmp_lg_u32 s21, 0
    s_cbranch_scc1 CH_u_79
    ds_read_b64_tr_b16 v[24:25], v18 offset:28672
    ds_read_b64_tr_b16 v[26:27], v18 offset:28928
    ds_read_b64_tr_b16 v[28:29], v19 offset:28672
    ds_read_b64_tr_b16 v[30:31], v19 offset:28928
    ds_read_b64_tr_b16 v[80:81], v18 offset:28704
    ds_read_b64_tr_b16 v[82:83], v18 offset:28960
    ds_read_b64_tr_b16 v[84:85], v19 offset:28704
    ds_read_b64_tr_b16 v[86:87], v19 offset:28960
    s_waitcnt lgkmcnt(6)
    ds_write_b128 v1, v[24:27] offset:4096
    s_waitcnt lgkmcnt(5)
    ds_write_b128 v1, v[28:31] offset:5120
    s_waitcnt lgkmcnt(0)
    s_branch CH_u_78
CH_u_79:
    s_cmp_lg_u32 s21, 1
    s_cbranch_scc1 CH_u_80
    ds_read_b64_tr_b16 v[160:161], v18 offset:28672
    ds_read_b64_tr_b16 v[162:163], v18 offset:28928
    ds_read_b64_tr_b16 v[164:165], v19 offset:28672
    ds_read_b64_tr_b16 v[166:167], v19 offset:28928
    ds_read_b64_tr_b16 v[32:33], v18 offset:28704
    ds_read_b64_tr_b16 v[34:35], v18 offset:28960
    ds_read_b64_tr_b16 v[36:37], v19 offset:28704
    ds_read_b64_tr_b16 v[38:39], v19 offset:28960
    s_waitcnt lgkmcnt(2)
    ds_write_b128 v1, v[32:35] offset:8192
    s_waitcnt lgkmcnt(1)
    ds_write_b128 v1, v[36:39] offset:9216
    s_waitcnt lgkmcnt(0)
    s_branch CH_u_78
CH_u_80:
    s_cmp_lg_u32 s21, 2
    s_cbranch_scc1 CH_u_81
    ds_read_b64_tr_b16 v[192:193], v18 offset:28672
    ds_read_b64_tr_b16 v[194:195], v18 offset:28928
    ds_read_b64_tr_b16 v[196:197], v19 offset:28672
    ds_read_b64_tr_b16 v[198:199], v19 offset:28928
    ds_read_b64_tr_b16 v[32:33], v18 offset:28704
    ds_read_b64_tr_b16 v[34:35], v18 offset:28960
    ds_read_b64_tr_b16 v[36:37], v19 offset:28704
    ds_read_b64_tr_b16 v[38:39], v19 offset:28960
    s_waitcnt lgkmcnt(2)
    ds_write_b128 v1, v[32:35] offset:12288
    s_waitcnt lgkmcnt(1)
    ds_write_b128 v1, v[36:39] offset:13312
    s_waitcnt lgkmcnt(0)
    s_branch CH_u_78
CH_u_81:
    ds_read_b64_tr_b16 v[232:233], v18 offset:28672
    ds_read_b64_tr_b16 v[234:235], v18 offset:28928
    ds_read_b64_tr_b16 v[236:237], v19 offset:28672
    ds_read_b64_tr_b16 v[238:239], v19 offset:28928
    ds_read_b64_tr_b16 v[240:241], v18 offset:28704
    ds_read_b64_tr_b16 v[242:243], v18 offset:28960
    ds_read_b64_tr_b16 v[244:245], v19 offset:28704
    ds_read_b64_tr_b16 v[246:247], v19 offset:28960
    s_waitcnt lgkmcnt(0)
CH_u_78:
    v_lshl_add_u32 v18, v17, 13, v12
    v_add_u32 v18, 0, v18
    v_add_u32 v19, 16384, v18
    s_waitcnt vmcnt(16)
    s_barrier
    s_add_u32 m0, s64, 28672
    s_add_u32 s47, s67, 524288
    buffer_load_dwordx4 v40, s[4:7], s47 offen  lds
    s_add_u32 m0, s64, 29696
    s_add_u32 s47, s67, 557056
    buffer_load_dwordx4 v41, s[4:7], s47 offen  lds
    s_add_u32 m0, s64, 30720
    s_add_u32 s47, s67, 589824
    buffer_load_dwordx4 v42, s[4:7], s47 offen  lds
    s_add_u32 m0, s64, 31744
    s_add_u32 s47, s67, 622592
    buffer_load_dwordx4 v43, s[4:7], s47 offen  lds
    s_cmp_lg_u32 s21, 0
    s_cbranch_scc1 CH_u_84
    ds_read_b64_tr_b16 v[160:161], v18 offset:0
    ds_read_b64_tr_b16 v[162:163], v18 offset:256
    ds_read_b64_tr_b16 v[164:165], v19 offset:0
    ds_read_b64_tr_b16 v[166:167], v19 offset:256
    ds_read_b64_tr_b16 v[32:33], v18 offset:32
    ds_read_b64_tr_b16 v[34:35], v18 offset:288
    ds_read_b64_tr_b16 v[36:37], v19 offset:32
    ds_read_b64_tr_b16 v[38:39], v19 offset:288
    s_waitcnt lgkmcnt(2)
    ds_write_b128 v1, v[32:35] offset:8192
    s_waitcnt lgkmcnt(1)
    ds_write_b128 v1, v[36:39] offset:9216
    s_waitcnt lgkmcnt(0)
    s_branch CH_u_83
CH_u_84:
    s_cmp_lg_u32 s21, 1
    s_cbranch_scc1 CH_u_85
    ds_read_b64_tr_b16 v[24:25], v18 offset:0
    ds_read_b64_tr_b16 v[26:27], v18 offset:256
    ds_read_b64_tr_b16 v[28:29], v19 offset:0
    ds_read_b64_tr_b16 v[30:31], v19 offset:256
    ds_read_b64_tr_b16 v[80:81], v18 offset:32
    ds_read_b64_tr_b16 v[82:83], v18 offset:288
    ds_read_b64_tr_b16 v[84:85], v19 offset:32
    ds_read_b64_tr_b16 v[86:87], v19 offset:288
    s_waitcnt lgkmcnt(6)
    ds_write_b128 v1, v[24:27] offset:4096
    s_waitcnt lgkmcnt(5)
    ds_write_b128 v1, v[28:31] offset:5120
    s_waitcnt lgkmcnt(0)
    s_branch CH_u_83
CH_u_85:
    s_cmp_lg_u32 s21, 2
    s_cbranch_scc1 CH_u_86
    ds_read_b64_tr_b16 v[232:233], v18 offset:0
    ds_read_b64_tr_b16 v[234:235], v18 offset:256
    ds_read_b64_tr_b16 v[236:237], v19 offset:0
    ds_read_b64_tr_b16 v[238:239], v19 offset:256
    ds_read_b64_tr_b16 v[240:241], v18 offset:32
    ds_read_b64_tr_b16 v[242:243], v18 offset:288
    ds_read_b64_tr_b16 v[244:245], v19 offset:32
    ds_read_b64_tr_b16 v[246:247], v19 offset:288
    s_waitcnt lgkmcnt(0)
    s_branch CH_u_83
CH_u_86:
    ds_read_b64_tr_b16 v[192:193], v18 offset:0
    ds_read_b64_tr_b16 v[194:195], v18 offset:256
    ds_read_b64_tr_b16 v[196:197], v19 offset:0
    ds_read_b64_tr_b16 v[198:199], v19 offset:256
    ds_read_b64_tr_b16 v[32:33], v18 offset:32
    ds_read_b64_tr_b16 v[34:35], v18 offset:288
    ds_read_b64_tr_b16 v[36:37], v19 offset:32
    ds_read_b64_tr_b16 v[38:39], v19 offset:288
    s_waitcnt lgkmcnt(2)
    ds_write_b128 v1, v[32:35] offset:12288
    s_waitcnt lgkmcnt(1)
    ds_write_b128 v1, v[36:39] offset:13312
    s_waitcnt lgkmcnt(0)
CH_u_83:
    v_lshl_add_u32 v18, v17, 13, v12
    v_add_u32 v18, 0, v18
    v_add_u32 v19, 16384, v18
    s_waitcnt vmcnt(16)
    s_barrier
    s_add_u32 m0, s64, 0
    s_add_u32 s47, s67, 1048576
    buffer_load_dwordx4 v40, s[4:7], s47 offen  lds
    s_add_u32 m0, s64, 1024
    s_add_u32 s47, s67, 1081344
    buffer_load_dwordx4 v41, s[4:7], s47 offen  lds
    s_add_u32 m0, s64, 2048
    s_add_u32 s47, s67, 1114112
    buffer_load_dwordx4 v42, s[4:7], s47 offen  lds
    s_add_u32 m0, s64, 3072
    s_add_u32 s47, s67, 1146880
    buffer_load_dwordx4 v43, s[4:7], s47 offen  lds
    s_cmp_lg_u32 s21, 0
    s_cbranch_scc1 CH_u_89
    ds_read_b64_tr_b16 v[192:193], v18 offset:4096
    ds_read_b64_tr_b16 v[194:195], v18 offset:4352
    ds_read_b64_tr_b16 v[196:197], v19 offset:4096
    ds_read_b64_tr_b16 v[198:199], v19 offset:4352
    ds_read_b64_tr_b16 v[32:33], v18 offset:4128
    ds_read_b64_tr_b16 v[34:35], v18 offset:4384
    ds_read_b64_tr_b16 v[36:37], v19 offset:4128
    ds_read_b64_tr_b16 v[38:39], v19 offset:4384
    s_waitcnt lgkmcnt(2)
    ds_write_b128 v1, v[32:35] offset:12288
    s_waitcnt lgkmcnt(1)
    ds_write_b128 v1, v[36:39] offset:13312
    s_waitcnt lgkmcnt(0)
    s_branch CH_u_88
CH_u_89:
    s_cmp_lg_u32 s21, 1
    s_cbranch_scc1 CH_u_90
    ds_read_b64_tr_b16 v[232:233], v18 offset:4096
    ds_read_b64_tr_b16 v[234:235], v18 offset:4352
    ds_read_b64_tr_b16 v[236:237], v19 offset:4096
    ds_read_b64_tr_b16 v[238:239], v19 offset:4352
    ds_read_b64_tr_b16 v[240:241], v18 offset:4128
    ds_read_b64_tr_b16 v[242:243], v18 offset:4384
    ds_read_b64_tr_b16 v[244:245], v19 offset:4128
    ds_read_b64_tr_b16 v[246:247], v19 offset:4384
    s_waitcnt lgkmcnt(0)
    s_branch CH_u_88
CH_u_90:
    s_cmp_lg_u32 s21, 2
    s_cbranch_scc1 CH_u_91
    ds_read_b64_tr_b16 v[24:25], v18 offset:4096
    ds_read_b64_tr_b16 v[26:27], v18 offset:4352
    ds_read_b64_tr_b16 v[28:29], v19 offset:4096
    ds_read_b64_tr_b16 v[30:31], v19 offset:4352
    ds_read_b64_tr_b16 v[80:81], v18 offset:4128
    ds_read_b64_tr_b16 v[82:83], v18 offset:4384
    ds_read_b64_tr_b16 v[84:85], v19 offset:4128
    ds_read_b64_tr_b16 v[86:87], v19 offset:4384
    s_waitcnt lgkmcnt(6)
    ds_write_b128 v1, v[24:27] offset:4096
    s_waitcnt lgkmcnt(5)
    ds_write_b128 v1, v[28:31] offset:5120
    s_waitcnt lgkmcnt(0)
    s_branch CH_u_88
CH_u_91:
    ds_read_b64_tr_b16 v[160:161], v18 offset:4096
    ds_read_b64_tr_b16 v[162:163], v18 offset:4352
    ds_read_b64_tr_b16 v[164:165], v19 offset:4096
    ds_read_b64_tr_b16 v[166:167], v19 offset:4352
    ds_read_b64_tr_b16 v[32:33], v18 offset:4128
    ds_read_b64_tr_b16 v[34:35], v18 offset:4384
    ds_read_b64_tr_b16 v[36:37], v19 offset:4128
    ds_read_b64_tr_b16 v[38:39], v19 offset:4384
    s_waitcnt lgkmcnt(2)
    ds_write_b128 v1, v[32:35] offset:8192
    s_waitcnt lgkmcnt(1)
    ds_write_b128 v1, v[36:39] offset:9216
    s_waitcnt lgkmcnt(0)
CH_u_88:
    v_lshl_add_u32 v18, v17, 15, v12
    v_add_u32 v18, 32768, v18
    v_add_u32 v19, 65536, v18
    s_waitcnt vmcnt(16)
    s_barrier
    s_add_u32 m0, s70, 0
    s_add_u32 s47, s67, 1572864
    buffer_load_dwordx4 v40, s[4:7], s47 offen  lds
    s_add_u32 m0, s70, 1024
    s_add_u32 s47, s67, 1605632
    buffer_load_dwordx4 v41, s[4:7], s47 offen  lds
    s_add_u32 m0, s70, 2048
    s_add_u32 s47, s67, 1638400
    buffer_load_dwordx4 v42, s[4:7], s47 offen  lds
    s_add_u32 m0, s70, 3072
    s_add_u32 s47, s67, 1671168
    buffer_load_dwordx4 v43, s[4:7], s47 offen  lds
    s_cmp_lg_u32 s21, 0
    s_cbranch_scc1 CH_u_94
    ds_read_b64_tr_b16 v[232:233], v18 offset:16384
    ds_read_b64_tr_b16 v[234:235], v18 offset:16640
    ds_read_b64_tr_b16 v[236:237], v19 offset:16384
    ds_read_b64_tr_b16 v[238:239], v19 offset:16640
    ds_read_b64_tr_b16 v[240:241], v18 offset:16416
    ds_read_b64_tr_b16 v[242:243], v18 offset:16672
    ds_read_b64_tr_b16 v[244:245], v19 offset:16416
    ds_read_b64_tr_b16 v[246:247], v19 offset:16672
    s_waitcnt lgkmcnt(0)
    s_branch CH_u_93
CH_u_94:
    s_cmp_lg_u32 s21, 1
    s_cbranch_scc1 CH_u_95
    ds_read_b64_tr_b16 v[192:193], v18 offset:16384
    ds_read_b64_tr_b16 v[194:195], v18 offset:16640
    ds_read_b64_tr_b16 v[196:197], v19 offset:16384
    ds_read_b64_tr_b16 v[198:199], v19 offset:16640
    ds_read_b64_tr_b16 v[32:33], v18 offset:16416
    ds_read_b64_tr_b16 v[34:35], v18 offset:16672
    ds_read_b64_tr_b16 v[36:37], v19 offset:16416
    ds_read_b64_tr_b16 v[38:39], v19 offset:16672
    s_waitcnt lgkmcnt(2)
    ds_write_b128 v1, v[32:35] offset:12288
    s_waitcnt lgkmcnt(1)
    ds_write_b128 v1, v[36:39] offset:13312
    s_waitcnt lgkmcnt(0)
    s_branch CH_u_93
CH_u_95:
    s_cmp_lg_u32 s21, 2
    s_cbranch_scc1 CH_u_96
    ds_read_b64_tr_b16 v[160:161], v18 offset:16384
    ds_read_b64_tr_b16 v[162:163], v18 offset:16640
    ds_read_b64_tr_b16 v[164:165], v19 offset:16384
    ds_read_b64_tr_b16 v[166:167], v19 offset:16640
    ds_read_b64_tr_b16 v[32:33], v18 offset:16416
    ds_read_b64_tr_b16 v[34:35], v18 offset:16672
    ds_read_b64_tr_b16 v[36:37], v19 offset:16416
    ds_read_b64_tr_b16 v[38:39], v19 offset:16672
    s_waitcnt lgkmcnt(2)
    ds_write_b128 v1, v[32:35] offset:8192
    s_waitcnt lgkmcnt(1)
    ds_write_b128 v1, v[36:39] offset:9216
    s_waitcnt lgkmcnt(0)
    s_branch CH_u_93
CH_u_96:
    ds_read_b64_tr_b16 v[24:25], v18 offset:16384
    ds_read_b64_tr_b16 v[26:27], v18 offset:16640
    ds_read_b64_tr_b16 v[28:29], v19 offset:16384
    ds_read_b64_tr_b16 v[30:31], v19 offset:16640
    ds_read_b64_tr_b16 v[80:81], v18 offset:16416
    ds_read_b64_tr_b16 v[82:83], v18 offset:16672
    ds_read_b64_tr_b16 v[84:85], v19 offset:16416
    ds_read_b64_tr_b16 v[86:87], v19 offset:16672
    s_waitcnt lgkmcnt(6)
    ds_write_b128 v1, v[24:27] offset:4096
    s_waitcnt lgkmcnt(5)
    ds_write_b128 v1, v[28:31] offset:5120
    s_waitcnt lgkmcnt(0)
CH_u_93:
    v_lshl_add_u32 v18, v17, 15, v13
    v_add_u32 v18, 32768, v18
    v_add_u32 v19, 65536, v18
    s_waitcnt vmcnt(16)
    s_barrier
    s_add_u32 m0, s70, 4096
    s_add_u32 s47, s67, 0
    buffer_load_dwordx4 v40, s[8:11], s47 offen  lds
    s_add_u32 m0, s70, 5120
    s_add_u32 s47, s67, 32768
    buffer_load_dwordx4 v41, s[8:11], s47 offen  lds
    s_add_u32 m0, s70, 6144
    s_add_u32 s47, s67, 65536
    buffer_load_dwordx4 v42, s[8:11], s47 offen  lds
    s_add_u32 m0, s70, 7168
    s_add_u32 s47, s67, 98304
    buffer_load_dwordx4 v43, s[8:11], s47 offen  lds
    ds_read_b64_tr_b16 a[40:41], v18 offset:20480
    ds_read_b64_tr_b16 a[42:43], v18 offset:20992
    ds_read_b64_tr_b16 a[44:45], v19 offset:20480
    ds_read_b64_tr_b16 a[46:47], v19 offset:20992
    ds_read_b64_tr_b16 v[32:33], v18 offset:20512
    ds_read_b64_tr_b16 v[34:35], v18 offset:21024
    ds_read_b64_tr_b16 v[36:37], v19 offset:20512
    ds_read_b64_tr_b16 v[38:39], v19 offset:21024
    s_waitcnt lgkmcnt(2)
    ds_write_b128 v1, v[32:35] offset:14336
    s_waitcnt lgkmcnt(1)
    ds_write_b128 v1, v[36:39] offset:15360
    s_waitcnt lgkmcnt(0)
CH_u_98:
    v_lshl_add_u32 v18, v17, 15, v12
    v_add_u32 v18, 32768, v18
    v_add_u32 v19, 65536, v18
    s_waitcnt vmcnt(16)
    s_barrier
    s_add_u32 m0, s64, 20480
    s_add_u32 s47, s67, 524288
    buffer_load_dwordx4 v40, s[8:11], s47 offen  lds
    s_add_u32 m0, s64, 21504
    s_add_u32 s47, s67, 557056
    buffer_load_dwordx4 v41, s[8:11], s47 offen  lds
    s_add_u32 m0, s64, 22528
    s_add_u32 s47, s67, 589824
    buffer_load_dwordx4 v42, s[8:11], s47 offen  lds
    s_add_u32 m0, s64, 23552
    s_add_u32 s47, s67, 622592
    buffer_load_dwordx4 v43, s[8:11], s47 offen  lds
    s_cmp_lg_u32 s21, 0
    s_cbranch_scc1 CH_u_101
    ds_read_b64_tr_b16 a[8:9], v18 offset:24576
    ds_read_b64_tr_b16 a[10:11], v18 offset:24832
    ds_read_b64_tr_b16 a[12:13], v19 offset:24576
    ds_read_b64_tr_b16 a[14:15], v19 offset:24832
    ds_read_b64_tr_b16 a[16:17], v18 offset:24608
    ds_read_b64_tr_b16 a[18:19], v18 offset:24864
    ds_read_b64_tr_b16 a[20:21], v19 offset:24608
    ds_read_b64_tr_b16 a[22:23], v19 offset:24864
    s_waitcnt lgkmcnt(0)
    s_branch CH_u_100
CH_u_101:
    s_cmp_lg_u32 s21, 1
    s_cbranch_scc1 CH_u_102
    ds_read_b64_tr_b16 v[24:25], v18 offset:24576
    ds_read_b64_tr_b16 v[26:27], v18 offset:24832
    ds_read_b64_tr_b16 v[28:29], v19 offset:24576
    ds_read_b64_tr_b16 v[30:31], v19 offset:24832
    ds_read_b64_tr_b16 a[64:65], v18 offset:24608
    ds_read_b64_tr_b16 a[66:67], v18 offset:24864
    ds_read_b64_tr_b16 a[68:69], v19 offset:24608
    ds_read_b64_tr_b16 a[70:71], v19 offset:24864
    s_waitcnt lgkmcnt(6)
    ds_write_b128 v1, v[24:27] offset:16384
    s_waitcnt lgkmcnt(5)
    ds_write_b128 v1, v[28:31] offset:17408
    s_waitcnt lgkmcnt(0)
    s_branch CH_u_100
CH_u_102:
    s_cmp_lg_u32 s21, 2
    s_cbranch_scc1 CH_u_103
    ds_read_b64_tr_b16 a[72:73], v18 offset:24576
    ds_read_b64_tr_b16 a[74:75], v18 offset:24832
    ds_read_b64_tr_b16 a[76:77], v19 offset:24576
    ds_read_b64_tr_b16 a[78:79], v19 offset:24832
    ds_read_b64_tr_b16 a[80:81], v18 offset:24608
    ds_read_b64_tr_b16 a[82:83], v18 offset:24864
    ds_read_b64_tr_b16 a[84:85], v19 offset:24608
    ds_read_b64_tr_b16 a[86:87], v19 offset:24864
    s_waitcnt lgkmcnt(0)
    s_branch CH_u_100
CH_u_103:
    ds_read_b64_tr_b16 a[88:89], v18 offset:24576
    ds_read_b64_tr_b16 a[90:91], v18 offset:24832
    ds_read_b64_tr_b16 a[92:93], v19 offset:24576
    ds_read_b64_tr_b16 a[94:95], v19 offset:24832
    ds_read_b64_tr_b16 a[96:97], v18 offset:24608
    ds_read_b64_tr_b16 a[98:99], v18 offset:24864
    ds_read_b64_tr_b16 a[100:101], v19 offset:24608
    ds_read_b64_tr_b16 a[102:103], v19 offset:24864
    s_waitcnt lgkmcnt(0)
CH_u_100:
    v_lshl_add_u32 v18, v17, 15, v12
    v_add_u32 v18, 32768, v18
    v_add_u32 v19, 65536, v18
    s_waitcnt vmcnt(16)
    s_barrier
    s_add_u32 m0, s64, 24576
    s_add_u32 s47, s67, 1048576
    buffer_load_dwordx4 v40, s[8:11], s47 offen  lds
    s_add_u32 m0, s64, 25600
    s_add_u32 s47, s67, 1081344
    buffer_load_dwordx4 v41, s[8:11], s47 offen  lds
    s_add_u32 m0, s64, 26624
    s_add_u32 s47, s67, 1114112
    buffer_load_dwordx4 v42, s[8:11], s47 offen  lds
    s_add_u32 m0, s64, 27648
    s_add_u32 s47, s67, 1146880
    buffer_load_dwordx4 v43, s[8:11], s47 offen  lds
    s_cmp_lg_u32 s21, 0
    s_cbranch_scc1 CH_u_106
    ds_read_b64_tr_b16 v[24:25], v18 offset:28672
    ds_read_b64_tr_b16 v[26:27], v18 offset:28928
    ds_read_b64_tr_b16 v[28:29], v19 offset:28672
    ds_read_b64_tr_b16 v[30:31], v19 offset:28928
    ds_read_b64_tr_b16 a[64:65], v18 offset:28704
    ds_read_b64_tr_b16 a[66:67], v18 offset:28960
    ds_read_b64_tr_b16 a[68:69], v19 offset:28704
    ds_read_b64_tr_b16 a[70:71], v19 offset:28960
    s_waitcnt lgkmcnt(6)
    ds_write_b128 v1, v[24:27] offset:16384
    s_waitcnt lgkmcnt(5)
    ds_write_b128 v1, v[28:31] offset:17408
    s_waitcnt lgkmcnt(0)
    s_branch CH_u_105
CH_u_106:
    s_cmp_lg_u32 s21, 1
    s_cbranch_scc1 CH_u_107
    ds_read_b64_tr_b16 a[8:9], v18 offset:28672
    ds_read_b64_tr_b16 a[10:11], v18 offset:28928
    ds_read_b64_tr_b16 a[12:13], v19 offset:28672
    ds_read_b64_tr_b16 a[14:15], v19 offset:28928
    ds_read_b64_tr_b16 a[16:17], v18 offset:28704
    ds_read_b64_tr_b16 a[18:19], v18 offset:28960
    ds_read_b64_tr_b16 a[20:21], v19 offset:28704
    ds_read_b64_tr_b16 a[22:23], v19 offset:28960
    s_waitcnt lgkmcnt(0)
    s_branch CH_u_105
CH_u_107:
    s_cmp_lg_u32 s21, 2
    s_cbranch_scc1 CH_u_108
    ds_read_b64_tr_b16 a[88:89], v18 offset:28672
    ds_read_b64_tr_b16 a[90:91], v18 offset:28928
    ds_read_b64_tr_b16 a[92:93], v19 offset:28672
    ds_read_b64_tr_b16 a[94:95], v19 offset:28928
    ds_read_b64_tr_b16 a[96:97], v18 offset:28704
    ds_read_b64_tr_b16 a[98:99], v18 offset:28960
    ds_read_b64_tr_b16 a[100:101], v19 offset:28704
    ds_read_b64_tr_b16 a[102:103], v19 offset:28960
    s_waitcnt lgkmcnt(0)
    s_branch CH_u_105
CH_u_108:
    ds_read_b64_tr_b16 a[72:73], v18 offset:28672
    ds_read_b64_tr_b16 a[74:75], v18 offset:28928
    ds_read_b64_tr_b16 a[76:77], v19 offset:28672
    ds_read_b64_tr_b16 a[78:79], v19 offset:28928
    ds_read_b64_tr_b16 a[80:81], v18 offset:28704
    ds_read_b64_tr_b16 a[82:83], v18 offset:28960
    ds_read_b64_tr_b16 a[84:85], v19 offset:28704
    ds_read_b64_tr_b16 a[86:87], v19 offset:28960
    s_waitcnt lgkmcnt(0)
CH_u_105:
    v_lshl_add_u32 v18, v17, 15, v12
    v_add_u32 v18, 32768, v18
    v_add_u32 v19, 65536, v18
    s_waitcnt vmcnt(16)
    s_barrier
    s_add_u32 m0, s64, 28672
    s_add_u32 s47, s67, 1572864
    buffer_load_dwordx4 v40, s[8:11], s47 offen  lds
    s_add_u32 m0, s64, 29696
    s_add_u32 s47, s67, 1605632
    buffer_load_dwordx4 v41, s[8:11], s47 offen  lds
    s_add_u32 m0, s64, 30720
    s_add_u32 s47, s67, 1638400
    buffer_load_dwordx4 v42, s[8:11], s47 offen  lds
    s_add_u32 m0, s64, 31744
    s_add_u32 s47, s67, 1671168
    buffer_load_dwordx4 v43, s[8:11], s47 offen  lds
    s_cmp_lg_u32 s21, 0
    s_cbranch_scc1 CH_u_111
    ds_read_b64_tr_b16 a[72:73], v18 offset:0
    ds_read_b64_tr_b16 a[74:75], v18 offset:256
    ds_read_b64_tr_b16 a[76:77], v19 offset:0
    ds_read_b64_tr_b16 a[78:79], v19 offset:256
    ds_read_b64_tr_b16 a[80:81], v18 offset:32
    ds_read_b64_tr_b16 a[82:83], v18 offset:288
    ds_read_b64_tr_b16 a[84:85], v19 offset:32
    ds_read_b64_tr_b16 a[86:87], v19 offset:288
    s_waitcnt lgkmcnt(0)
    s_branch CH_u_110
CH_u_111:
    s_cmp_lg_u32 s21, 1
    s_cbranch_scc1 CH_u_112
    ds_read_b64_tr_b16 a[88:89], v18 offset:0
    ds_read_b64_tr_b16 a[90:91], v18 offset:256
    ds_read_b64_tr_b16 a[92:93], v19 offset:0
    ds_read_b64_tr_b16 a[94:95], v19 offset:256
    ds_read_b64_tr_b16 a[96:97], v18 offset:32
    ds_read_b64_tr_b16 a[98:99], v18 offset:288
    ds_read_b64_tr_b16 a[100:101], v19 offset:32
    ds_read_b64_tr_b16 a[102:103], v19 offset:288
    s_waitcnt lgkmcnt(0)
    s_branch CH_u_110
CH_u_112:
    s_cmp_lg_u32 s21, 2
    s_cbranch_scc1 CH_u_113
    ds_read_b64_tr_b16 a[8:9], v18 offset:0
    ds_read_b64_tr_b16 a[10:11], v18 offset:256
    ds_read_b64_tr_b16 a[12:13], v19 offset:0
    ds_read_b64_tr_b16 a[14:15], v19 offset:256
    ds_read_b64_tr_b16 a[16:17], v18 offset:32
    ds_read_b64_tr_b16 a[18:19], v18 offset:288
    ds_read_b64_tr_b16 a[20:21], v19 offset:32
    ds_read_b64_tr_b16 a[22:23], v19 offset:288
    s_waitcnt lgkmcnt(0)
    s_branch CH_u_110
CH_u_113:
    ds_read_b64_tr_b16 v[24:25], v18 offset:0
    ds_read_b64_tr_b16 v[26:27], v18 offset:256
    ds_read_b64_tr_b16 v[28:29], v19 offset:0
    ds_read_b64_tr_b16 v[30:31], v19 offset:256
    ds_read_b64_tr_b16 a[64:65], v18 offset:32
    ds_read_b64_tr_b16 a[66:67], v18 offset:288
    ds_read_b64_tr_b16 a[68:69], v19 offset:32
    ds_read_b64_tr_b16 a[70:71], v19 offset:288
    s_waitcnt lgkmcnt(6)
    ds_write_b128 v1, v[24:27] offset:16384
    s_waitcnt lgkmcnt(5)
    ds_write_b128 v1, v[28:31] offset:17408
    s_waitcnt lgkmcnt(0)
CH_u_110:
    v_lshl_add_u32 v18, v17, 13, v12
    v_add_u32 v18, 0, v18
    v_add_u32 v19, 16384, v18
    s_waitcnt vmcnt(16)
    s_barrier
    s_add_u32 m0, s64, 0
    s_add_u32 s47, s68, 81920
    buffer_load_dwordx4 v44, s[24:27], s47 offen  lds
    s_add_u32 m0, s64, 1024
    s_add_u32 s47, s68, 87040
    buffer_load_dwordx4 v45, s[24:27], s47 offen  lds
    s_add_u32 m0, s64, 2048
    s_add_u32 s47, s68, 92160
    buffer_load_dwordx4 v46, s[24:27], s47 offen  lds
    s_add_u32 m0, s64, 3072
    s_add_u32 s47, s68, 97280
    buffer_load_dwordx4 v47, s[24:27], s47 offen  lds
    s_cmp_lg_u32 s21, 0
    s_cbranch_scc1 CH_u_116
    ds_read_b64_tr_b16 a[88:89], v18 offset:0
    ds_read_b64_tr_b16 a[90:91], v18 offset:256
    ds_read_b64_tr_b16 a[92:93], v19 offset:0
    ds_read_b64_tr_b16 a[94:95], v19 offset:256
    ds_read_b64_tr_b16 a[96:97], v18 offset:32
    ds_read_b64_tr_b16 a[98:99], v18 offset:288
    ds_read_b64_tr_b16 a[100:101], v19 offset:32
    ds_read_b64_tr_b16 a[102:103], v19 offset:288
    s_waitcnt lgkmcnt(0)
    s_branch CH_u_115
CH_u_116:
    s_cmp_lg_u32 s21, 1
    s_cbranch_scc1 CH_u_117
    ds_read_b64_tr_b16 a[72:73], v18 offset:0
    ds_read_b64_tr_b16 a[74:75], v18 offset:256
    ds_read_b64_tr_b16 a[76:77], v19 offset:0
    ds_read_b64_tr_b16 a[78:79], v19 offset:256
    ds_read_b64_tr_b16 a[80:81], v18 offset:32
    ds_read_b64_tr_b16 a[82:83], v18 offset:288
    ds_read_b64_tr_b16 a[84:85], v19 offset:32
    ds_read_b64_tr_b16 a[86:87], v19 offset:288
    s_waitcnt lgkmcnt(0)
    s_branch CH_u_115
CH_u_117:
    s_cmp_lg_u32 s21, 2
    s_cbranch_scc1 CH_u_118
    ds_read_b64_tr_b16 v[24:25], v18 offset:0
    ds_read_b64_tr_b16 v[26:27], v18 offset:256
    ds_read_b64_tr_b16 v[28:29], v19 offset:0
    ds_read_b64_tr_b16 v[30:31], v19 offset:256
    ds_read_b64_tr_b16 a[64:65], v18 offset:32
    ds_read_b64_tr_b16 a[66:67], v18 offset:288
    ds_read_b64_tr_b16 a[68:69], v19 offset:32
    ds_read_b64_tr_b16 a[70:71], v19 offset:288
    s_waitcnt lgkmcnt(6)
    ds_write_b128 v1, v[24:27] offset:16384
    s_waitcnt lgkmcnt(5)
    ds_write_b128 v1, v[28:31] offset:17408
    s_waitcnt lgkmcnt(0)
    s_branch CH_u_115
CH_u_118:
    ds_read_b64_tr_b16 a[8:9], v18 offset:0
    ds_read_b64_tr_b16 a[10:11], v18 offset:256
    ds_read_b64_tr_b16 a[12:13], v19 offset:0
    ds_read_b64_tr_b16 a[14:15], v19 offset:256
    ds_read_b64_tr_b16 a[16:17], v18 offset:32
    ds_read_b64_tr_b16 a[18:19], v18 offset:288
    ds_read_b64_tr_b16 a[20:21], v19 offset:32
    ds_read_b64_tr_b16 a[22:23], v19 offset:288
    s_waitcnt lgkmcnt(0)
CH_u_115:
    v_lshl_add_u32 v18, v17, 13, v12
    v_add_u32 v18, 0, v18
    v_add_u32 v19, 16384, v18
    s_waitcnt vmcnt(16)
    s_barrier
    s_add_u32 m0, s70, 0
    s_add_u32 s47, s68, 0
    buffer_load_dwordx4 v44, s[24:27], s47 offen  lds
    s_add_u32 m0, s70, 1024
    s_add_u32 s47, s68, 5120
    buffer_load_dwordx4 v45, s[24:27], s47 offen  lds
    s_add_u32 m0, s70, 2048
    s_add_u32 s47, s68, 10240
    buffer_load_dwordx4 v46, s[24:27], s47 offen  lds
    s_add_u32 m0, s70, 3072
    s_add_u32 s47, s68, 15360
    buffer_load_dwordx4 v47, s[24:27], s47 offen  lds
    s_cmp_lg_u32 s21, 0
    s_cbranch_scc1 CH_u_121
    ds_read_b64_tr_b16 a[24:25], v18 offset:4096
    ds_read_b64_tr_b16 a[26:27], v18 offset:4352
    ds_read_b64_tr_b16 a[28:29], v19 offset:4096
    ds_read_b64_tr_b16 a[30:31], v19 offset:4352
    ds_read_b64_tr_b16 a[32:33], v18 offset:4128
    ds_read_b64_tr_b16 a[34:35], v18 offset:4384
    ds_read_b64_tr_b16 a[36:37], v19 offset:4128
    ds_read_b64_tr_b16 a[38:39], v19 offset:4384
    s_waitcnt lgkmcnt(0)
    s_branch CH_u_120
CH_u_121:
    s_cmp_lg_u32 s21, 1
    s_cbranch_scc1 CH_u_122
    ds_read_b64_tr_b16 a[104:105], v18 offset:4096
    ds_read_b64_tr_b16 a[106:107], v18 offset:4352
    ds_read_b64_tr_b16 a[108:109], v19 offset:4096
    ds_read_b64_tr_b16 a[110:111], v19 offset:4352
    ds_read_b64_tr_b16 a[120:121], v18 offset:4128
    ds_read_b64_tr_b16 a[122:123], v18 offset:4384
    ds_read_b64_tr_b16 a[124:125], v19 offset:4128
    ds_read_b64_tr_b16 a[126:127], v19 offset:4384
    s_waitcnt lgkmcnt(0)
    s_branch CH_u_120
CH_u_122:
    s_cmp_lg_u32 s21, 2
    s_cbranch_scc1 CH_u_123
    ds_read_b64_tr_b16 v[24:25], v18 offset:4096
    ds_read_b64_tr_b16 v[26:27], v18 offset:4352
    ds_read_b64_tr_b16 v[28:29], v19 offset:4096
    ds_read_b64_tr_b16 v[30:31], v19 offset:4352
    ds_read_b64_tr_b16 a[128:129], v18 offset:4128
    ds_read_b64_tr_b16 a[130:131], v18 offset:4384
    ds_read_b64_tr_b16 a[132:133], v19 offset:4128
    ds_read_b64_tr_b16 a[134:135], v19 offset:4384
    s_waitcnt lgkmcnt(6)
    ds_write_b128 v1, v[24:27] offset:18432
    s_waitcnt lgkmcnt(5)
    ds_write_b128 v1, v[28:31] offset:19456
    s_waitcnt lgkmcnt(0)
    s_branch CH_u_120
CH_u_123:
    ds_read_b64_tr_b16 a[112:113], v18 offset:4096
    ds_read_b64_tr_b16 a[114:115], v18 offset:4352
    ds_read_b64_tr_b16 a[116:117], v19 offset:4096
    ds_read_b64_tr_b16 a[118:119], v19 offset:4352
    ds_read_b64_tr_b16 a[136:137], v18 offset:4128
    ds_read_b64_tr_b16 a[138:139], v18 offset:4384
    ds_read_b64_tr_b16 a[140:141], v19 offset:4128
    ds_read_b64_tr_b16 a[142:143], v19 offset:4384
    s_waitcnt lgkmcnt(0)
CH_u_120:
    v_lshl_add_u32 v18, v17, 15, v12
    v_add_u32 v18, 32768, v18
    v_add_u32 v19, 65536, v18
    s_waitcnt vmcnt(16)
    s_barrier
    s_add_u32 m0, s70, 4096
    s_add_u32 s47, s68, 82176
    buffer_load_dwordx4 v44, s[24:27], s47 offen  lds
    s_add_u32 m0, s70, 5120
    s_add_u32 s47, s68, 87296
    buffer_load_dwordx4 v45, s[24:27], s47 offen  lds
    s_add_u32 m0, s70, 6144
    s_add_u32 s47, s68, 92416
    buffer_load_dwordx4 v46, s[24:27], s47 offen  lds
    s_add_u32 m0, s70, 7168
    s_add_u32 s47, s68, 97536
    buffer_load_dwordx4 v47, s[24:27], s47 offen  lds
    s_cmp_lg_u32 s21, 0
    s_cbranch_scc1 CH_u_126
    ds_read_b64_tr_b16 a[104:105], v18 offset:20480
    ds_read_b64_tr_b16 a[106:107], v18 offset:20736
    ds_read_b64_tr_b16 a[108:109], v19 offset:20480
    ds_read_b64_tr_b16 a[110:111], v19 offset:20736
    ds_read_b64_tr_b16 a[120:121], v18 offset:20512
    ds_read_b64_tr_b16 a[122:123], v18 offset:20768
    ds_read_b64_tr_b16 a[124:125], v19 offset:20512
    ds_read_b64_tr_b16 a[126:127], v19 offset:20768
    s_waitcnt lgkmcnt(0)
    s_branch CH_u_125
CH_u_126:
    s_cmp_lg_u32 s21, 1
    s_cbranch_scc1 CH_u_127
    ds_read_b64_tr_b16 a[24:25], v18 offset:20480
    ds_read_b64_tr_b16 a[26:27], v18 offset:20736
    ds_read_b64_tr_b16 a[28:29], v19 offset:20480
    ds_read_b64_tr_b16 a[30:31], v19 offset:20736
    ds_read_b64_tr_b16 a[32:33], v18 offset:20512
    ds_read_b64_tr_b16 a[34:35], v18 offset:20768
    ds_read_b64_tr_b16 a[36:37], v19 offset:20512
    ds_read_b64_tr_b16 a[38:39], v19 offset:20768
    s_waitcnt lgkmcnt(0)
    s_branch CH_u_125
CH_u_127:
    s_cmp_lg_u32 s21, 2
    s_cbranch_scc1 CH_u_128
    ds_read_b64_tr_b16 a[112:113], v18 offset:20480
    ds_read_b64_tr_b16 a[114:115], v18 offset:20736
    ds_read_b64_tr_b16 a[116:117], v19 offset:20480
    ds_read_b64_tr_b16 a[118:119], v19 offset:20736
    ds_read_b64_tr_b16 a[136:137], v18 offset:20512
    ds_read_b64_tr_b16 a[138:139], v18 offset:20768
    ds_read_b64_tr_b16 a[140:141], v19 offset:20512
    ds_read_b64_tr_b16 a[142:143], v19 offset:20768
    s_waitcnt lgkmcnt(0)
    s_branch CH_u_125
CH_u_128:
    ds_read_b64_tr_b16 v[24:25], v18 offset:20480
    ds_read_b64_tr_b16 v[26:27], v18 offset:20736
    ds_read_b64_tr_b16 v[28:29], v19 offset:20480
    ds_read_b64_tr_b16 v[30:31], v19 offset:20736
    ds_read_b64_tr_b16 a[128:129], v18 offset:20512
    ds_read_b64_tr_b16 a[130:131], v18 offset:20768
    ds_read_b64_tr_b16 a[132:133], v19 offset:20512
    ds_read_b64_tr_b16 a[134:135], v19 offset:20768
    s_waitcnt lgkmcnt(6)
    ds_write_b128 v1, v[24:27] offset:18432
    s_waitcnt lgkmcnt(5)
    ds_write_b128 v1, v[28:31] offset:19456
    s_waitcnt lgkmcnt(0)
CH_u_125:
    v_lshl_add_u32 v18, v17, 15, v12
    v_add_u32 v18, 32768, v18
    v_add_u32 v19, 65536, v18
    s_waitcnt vmcnt(16)
    s_barrier
    s_cmp_lg_u32 s21, 0
    s_cbranch_scc1 CH_u_131
    ds_read_b64_tr_b16 v[24:25], v18 offset:24576
    ds_read_b64_tr_b16 v[26:27], v18 offset:24832
    ds_read_b64_tr_b16 v[28:29], v19 offset:24576
    ds_read_b64_tr_b16 v[30:31], v19 offset:24832
    ds_read_b64_tr_b16 a[128:129], v18 offset:24608
    ds_read_b64_tr_b16 a[130:131], v18 offset:24864
    ds_read_b64_tr_b16 a[132:133], v19 offset:24608
    ds_read_b64_tr_b16 a[134:135], v19 offset:24864
    s_waitcnt lgkmcnt(6)
    ds_write_b128 v1, v[24:27] offset:18432
    s_waitcnt lgkmcnt(5)
    ds_write_b128 v1, v[28:31] offset:19456
    s_waitcnt lgkmcnt(0)
    s_branch CH_u_130
CH_u_131:
    s_cmp_lg_u32 s21, 1
    s_cbranch_scc1 CH_u_132
    ds_read_b64_tr_b16 a[112:113], v18 offset:24576
    ds_read_b64_tr_b16 a[114:115], v18 offset:24832
    ds_read_b64_tr_b16 a[116:117], v19 offset:24576
    ds_read_b64_tr_b16 a[118:119], v19 offset:24832
    ds_read_b64_tr_b16 a[136:137], v18 offset:24608
    ds_read_b64_tr_b16 a[138:139], v18 offset:24864
    ds_read_b64_tr_b16 a[140:141], v19 offset:24608
    ds_read_b64_tr_b16 a[142:143], v19 offset:24864
    s_waitcnt lgkmcnt(0)
    s_branch CH_u_130
CH_u_132:
    s_cmp_lg_u32 s21, 2
    s_cbranch_scc1 CH_u_133
    ds_read_b64_tr_b16 a[24:25], v18 offset:24576
    ds_read_b64_tr_b16 a[26:27], v18 offset:24832
    ds_read_b64_tr_b16 a[28:29], v19 offset:24576
    ds_read_b64_tr_b16 a[30:31], v19 offset:24832
    ds_read_b64_tr_b16 a[32:33], v18 offset:24608
    ds_read_b64_tr_b16 a[34:35], v18 offset:24864
    ds_read_b64_tr_b16 a[36:37], v19 offset:24608
    ds_read_b64_tr_b16 a[38:39], v19 offset:24864
    s_waitcnt lgkmcnt(0)
    s_branch CH_u_130
CH_u_133:
    ds_read_b64_tr_b16 a[104:105], v18 offset:24576
    ds_read_b64_tr_b16 a[106:107], v18 offset:24832
    ds_read_b64_tr_b16 a[108:109], v19 offset:24576
    ds_read_b64_tr_b16 a[110:111], v19 offset:24832
    ds_read_b64_tr_b16 a[120:121], v18 offset:24608
    ds_read_b64_tr_b16 a[122:123], v18 offset:24864
    ds_read_b64_tr_b16 a[124:125], v19 offset:24608
    ds_read_b64_tr_b16 a[126:127], v19 offset:24864
    s_waitcnt lgkmcnt(0)
CH_u_130:
    v_lshl_add_u32 v18, v17, 15, v12
    v_add_u32 v18, 32768, v18
    v_add_u32 v19, 65536, v18
    s_waitcnt vmcnt(12)
    s_barrier
    s_cmp_lg_u32 s21, 0
    s_cbranch_scc1 CH_u_136
    ds_read_b64_tr_b16 a[112:113], v18 offset:28672
    ds_read_b64_tr_b16 a[114:115], v18 offset:28928
    ds_read_b64_tr_b16 a[116:117], v19 offset:28672
    ds_read_b64_tr_b16 a[118:119], v19 offset:28928
    ds_read_b64_tr_b16 a[136:137], v18 offset:28704
    ds_read_b64_tr_b16 a[138:139], v18 offset:28960
    ds_read_b64_tr_b16 a[140:141], v19 offset:28704
    ds_read_b64_tr_b16 a[142:143], v19 offset:28960
    s_waitcnt lgkmcnt(0)
    s_branch CH_u_135
CH_u_136:
    s_cmp_lg_u32 s21, 1
    s_cbranch_scc1 CH_u_137
    ds_read_b64_tr_b16 v[24:25], v18 offset:28672
    ds_read_b64_tr_b16 v[26:27], v18 offset:28928
    ds_read_b64_tr_b16 v[28:29], v19 offset:28672
    ds_read_b64_tr_b16 v[30:31], v19 offset:28928
    ds_read_b64_tr_b16 a[128:129], v18 offset:28704
    ds_read_b64_tr_b16 a[130:131], v18 offset:28960
    ds_read_b64_tr_b16 a[132:133], v19 offset:28704
    ds_read_b64_tr_b16 a[134:135], v19 offset:28960
    s_waitcnt lgkmcnt(6)
    ds_write_b128 v1, v[24:27] offset:18432
    s_waitcnt lgkmcnt(5)
    ds_write_b128 v1, v[28:31] offset:19456
    s_waitcnt lgkmcnt(0)
    s_branch CH_u_135
CH_u_137:
    s_cmp_lg_u32 s21, 2
    s_cbranch_scc1 CH_u_138
    ds_read_b64_tr_b16 a[104:105], v18 offset:28672
    ds_read_b64_tr_b16 a[106:107], v18 offset:28928
    ds_read_b64_tr_b16 a[108:109], v19 offset:28672
    ds_read_b64_tr_b16 a[110:111], v19 offset:28928
    ds_read_b64_tr_b16 a[120:121], v18 offset:28704
    ds_read_b64_tr_b16 a[122:123], v18 offset:28960
    ds_read_b64_tr_b16 a[124:125], v19 offset:28704
    ds_read_b64_tr_b16 a[126:127], v19 offset:28960
    s_waitcnt lgkmcnt(0)
    s_branch CH_u_135
CH_u_138:
    ds_read_b64_tr_b16 a[24:25], v18 offset:28672
    ds_read_b64_tr_b16 a[26:27], v18 offset:28928
    ds_read_b64_tr_b16 a[28:29], v19 offset:28672
    ds_read_b64_tr_b16 a[30:31], v19 offset:28928
    ds_read_b64_tr_b16 a[32:33], v18 offset:28704
    ds_read_b64_tr_b16 a[34:35], v18 offset:28960
    ds_read_b64_tr_b16 a[36:37], v19 offset:28704
    ds_read_b64_tr_b16 a[38:39], v19 offset:28960
    s_waitcnt lgkmcnt(0)
CH_u_135:
    v_lshl_add_u32 v18, v16, 15, v14
    v_add_u32 v18, 32768, v18
    v_add_u32 v19, 65536, v18
    s_waitcnt vmcnt(8)
    s_barrier
    ds_read_b64_tr_b16 v[24:25], v18 offset:0
    ds_read_b64_tr_b16 v[26:27], v18 offset:512
    ds_read_b64_tr_b16 v[28:29], v19 offset:0
    ds_read_b64_tr_b16 v[30:31], v19 offset:512
    ds_read_b64_tr_b16 a[224:225], v18 offset:8
    ds_read_b64_tr_b16 a[226:227], v18 offset:520
    ds_read_b64_tr_b16 a[228:229], v19 offset:8
    ds_read_b64_tr_b16 a[230:231], v19 offset:520
    s_waitcnt lgkmcnt(6)
    ds_write_b128 v1, v[24:27] offset:22528
    s_waitcnt lgkmcnt(5)
    ds_write_b128 v1, v[28:31] offset:23552
    s_waitcnt lgkmcnt(0)
CH_u_140:
    v_lshl_add_u32 v18, v16, 13, v14
    v_add_u32 v18, 0, v18
    v_add_u32 v19, 16384, v18
    s_waitcnt vmcnt(4)
    s_barrier
    s_add_u32 m0, s64, 0
    s_add_u32 s47, s69, 0
    buffer_load_dwordx4 v11, s[24:27], s47 offen  lds
    s_add_u32 m0, s64, 1024
    s_add_u32 s47, s69, 10240
    buffer_load_dwordx4 v11, s[24:27], s47 offen  lds
    s_add_u32 m0, s64, 2048
    s_add_u32 s47, s69, 20480
    buffer_load_dwordx4 v11, s[24:27], s47 offen  lds
    s_add_u32 m0, s64, 3072
    s_add_u32 s47, s69, 30720
    buffer_load_dwordx4 v11, s[24:27], s47 offen  lds
    ds_read_b64_tr_b16 v[24:25], v18 offset:0
    ds_read_b64_tr_b16 v[26:27], v18 offset:512
    ds_read_b64_tr_b16 v[28:29], v19 offset:0
    ds_read_b64_tr_b16 v[30:31], v19 offset:512
    ds_read_b64_tr_b16 v[32:33], v18 offset:8
    ds_read_b64_tr_b16 v[34:35], v18 offset:520
    ds_read_b64_tr_b16 v[36:37], v19 offset:8
    ds_read_b64_tr_b16 v[38:39], v19 offset:520
    s_waitcnt lgkmcnt(6)
    ds_write_b128 v1, v[24:27] offset:20480
    s_waitcnt lgkmcnt(5)
    ds_write_b128 v1, v[28:31] offset:21504
    s_waitcnt lgkmcnt(4)
    ds_write_b128 v1, v[32:35] offset:24576
    s_waitcnt lgkmcnt(3)
    ds_write_b128 v1, v[36:39] offset:25600
    s_waitcnt lgkmcnt(0)
CH_u_142:
    v_lshl_add_u32 v18, v16, 13, v14
    v_add_u32 v18, 0, v18
    v_add_u32 v19, 16384, v18
    s_waitcnt vmcnt(4)
    s_barrier
    ds_read_b64_tr_b16 a[240:241], v18 offset:4096
    ds_read_b64_tr_b16 a[242:243], v18 offset:4608
    ds_read_b64_tr_b16 a[244:245], v19 offset:4096
    ds_read_b64_tr_b16 a[246:247], v19 offset:4608
    ds_read_b64_tr_b16 v[32:33], v18 offset:4104
    ds_read_b64_tr_b16 v[34:35], v18 offset:4616
    ds_read_b64_tr_b16 v[36:37], v19 offset:4104
    ds_read_b64_tr_b16 v[38:39], v19 offset:4616
    s_waitcnt lgkmcnt(2)
    ds_write_b128 v1, v[32:35] offset:26624
    s_waitcnt lgkmcnt(1)
    ds_write_b128 v1, v[36:39] offset:27648
    s_waitcnt lgkmcnt(0)
CH_u_144:
    v_add_u32 v18, 32768, v15
    v_add_u32 v19, 65536, v18
    s_waitcnt vmcnt(0)
    s_barrier
    ds_read_b64_tr_b16 v[24:25], v18 offset:0
    ds_read_b64_tr_b16 v[26:27], v18 offset:256
    ds_read_b64_tr_b16 v[28:29], v18 offset:32768
    ds_read_b64_tr_b16 v[30:31], v18 offset:33024
    ds_read_b64_tr_b16 v[32:33], v19 offset:0
    ds_read_b64_tr_b16 v[34:35], v19 offset:256
    ds_read_b64_tr_b16 v[36:37], v19 offset:32768
    ds_read_b64_tr_b16 v[38:39], v19 offset:33024
    s_waitcnt lgkmcnt(6)
    ds_write_b128 v1, v[24:27] offset:28672
    s_waitcnt lgkmcnt(5)
    ds_write_b128 v1, v[28:31] offset:29696
    s_waitcnt lgkmcnt(4)
    ds_write_b128 v1, v[32:35] offset:30720
    s_waitcnt lgkmcnt(3)
    ds_write_b128 v1, v[36:39] offset:31744
    s_waitcnt lgkmcnt(0)
CH_u_146:
    s_xor_b32 s13, s92, 1024
    s_xor_b32 s14, s92, 2048
    s_xor_b32 s15, s92, 3072
    s_load_dwordx2 s[4:5], s[0:1], 88
    s_mov_b32 s6, 256
    s_mov_b32 s7, 0x20000
    s_load_dwordx2 s[8:9], s[0:1], 32
    s_mov_b32 s10, 10240
    s_mov_b32 s11, 0x20000
    s_waitcnt lgkmcnt(0)
    s_lshl_b32 s47, s19, 3
    v_mov_b32 v8, 132
    s_mov_b32 s49, 0
CP_148:
    buffer_load_dword v9, v8, s[4:7], s47 offen sc1
    s_waitcnt vmcnt(0)
    v_cmp_gt_u32 vcc, 2097152, v9
    s_cbranch_vccz CP_149
    s_add_u32 s49, s49, 1
    s_cmp_gt_u32 s49, 400000
    s_cbranch_scc1 L_end
    s_sleep 1
    s_branch CP_148
CP_149:
    buffer_load_dwordx2 v[8:9], off, s[4:7], s47 offset:128 sc1
    s_waitcnt vmcnt(0)
    v_readfirstlane_b32 s66, v8
    v_readfirstlane_b32 s67, v9
    s_nop 0
    s_lshr_b64 s[66:67], s[66:67], s101
    s_and_b32 s101, s66, 63
    v_mov_b32 v8, 4
    s_mov_b32 s49, 0
CP_150:
    buffer_load_dword v9, v8, s[4:7], 0 offen sc1
    s_waitcnt vmcnt(0)
    v_cmp_gt_u32 vcc, 1, v9
    s_cbranch_vccz CP_151
    s_add_u32 s49, s49, 1
    s_cmp_gt_u32 s49, 400000
    s_cbranch_scc1 L_end
    s_sleep 1
    s_branch CP_150
CP_151:
    v_readfirstlane_b32 s41, v9
    s_nop 0
    s_and_b32 s41, s41, 2
    s_lshl_b32 s41, s41, 12
    v_bfe_u32 v8, v0, 2, 3
    v_add_u32 v8, 8, v8
    s_mov_b32 s49, 0
CP_152:
    buffer_load_dword v9, v8, s[4:7], 0 offen sc1
    s_waitcnt vmcnt(0)
    v_cmp_gt_u32 vcc, 1, v9
    s_cbranch_vccz CP_153
    s_add_u32 s49, s49, 1
    s_cmp_gt_u32 s49, 400000
    s_cbranch_scc1 L_end
    s_sleep 1
    s_branch CP_152
CP_153:
    v_and_b32 v8, 511, v0
    v_lshlrev_b32 v8, 3, v8
    s_mov_b32 s47, 1241088
    s_mov_b32 s49, 0
CP_154:
    buffer_load_dword v9, v8, s[32:35], s47 offen sc1
    s_waitcnt vmcnt(0)
    v_cmp_gt_u32 vcc, 1, v9
    s_cbranch_vccz CP_155
    s_add_u32 s49, s49, 1
    s_cmp_gt_u32 s49, 400000
    s_cbranch_scc1 L_end
    s_sleep 1
    s_branch CP_154
CP_155:
    s_mul_i32 s47, s19, 196608
    s_add_u32 s47, s47, 65536
    s_add_u32 s28, s28, s47
    s_addc_u32 s29, s29, 0
    s_mul_i32 s98, s20, 768
    s_add_u32 s98, s98, 1146880
    s_lshl_b32 s47, s20, 1
    s_add_u32 s47, s47, s19
    s_lshl_b32 s47, s47, 7
    s_add_u32 s47, s47, 1220608
    s_cmp_eq_u32 s21, 0
    s_cselect_b32 s18, s47, 1073741824
    s_mov_b32 s100, 0
    s_barrier
CH_layer_156:
    s_mul_i32 s42, s100, 67108864
    s_add_u32 s42, s42, 119537664
    s_mul_i32 s50, s100, 4194304
    s_add_u32 s50, s50, 2097152
    s_mul_i32 s97, s100, 8388608
    s_add_u32 s97, s97, 100663296
    s_lshl_b32 s47, s20, 14
    s_lshl_b32 s48, s21, 11
    s_add_u32 s47, s47, s48
    s_add_u32 s42, s42, s47
    s_lshl_b32 s48, s20, 14
    s_add_u32 s42, s42, s48
    s_add_u32 s42, s42, s41
    s_lshr_b32 s47, s47, 2
    s_add_u32 s97, s97, s47
    s_lshl_b32 s47, s19, 11
    s_add_u32 s97, s97, s47
    s_mov_b32 s96, 1073741824
    s_lshl_b32 s84, s100, 6
    s_cmp_eq_u32 s19, 0
    s_cselect_b64 s[82:83], 0, -1
    s_lshl_b32 s47, s19, 14
    s_add_u32 s47, s47, s41
    s_add_u32 s50, s50, s47
    s_xor_b32 s90, s50, 0x4000
    s_sub_u32 s90, s90, 32768
    s_mov_b32 s40, 0
    s_mov_b32 s43, 163840
    s_lshl_b32 s99, s100, 6
    v_lshrrev_b32 v8, 4, v0
    v_bfe_u32 v9, v8, 2, 2
    v_mul_u32_u24 v9, 2560, v9
    v_bfe_u32 v11, v8, 0, 1
    v_mul_u32_u24 v11, 1280, v11
    v_add_u32 v9, v9, v11
    v_bfe_u32 v11, v8, 4, 2
    v_lshl_add_u32 v9, v11, 5, v9
    v_bfe_u32 v11, v8, 1, 1
    v_lshl_add_u32 v9, v11, 4, v9
    s_mov_b32 s66, 0x05040100
    s_mov_b32 s67, 0x07060302
    s_xor_b32 s47, s19, 0
    s_mul_i32 s47, s47, 640
    s_lshl_b32 s48, s21, 7
    s_add_u32 s48, s48, s47
    buffer_load_dwordx4 v[12:15], v9, s[8:11], s48 offen
    buffer_load_dwordx4 v[28:31], v9, s[8:11], s47 offen offset:512
    s_waitcnt vmcnt(1)
    v_perm_b32 v24, v14, v12, s66
    v_perm_b32 v25, v14, v12, s67
    v_perm_b32 v26, v15, v13, s66
    v_perm_b32 v27, v15, v13, s67
    v_min_u32 v24, -2, v24
    v_min_u32 v26, -2, v26
    s_waitcnt vmcnt(0)
    v_min_u32 v28, -2, v28
    v_min_u32 v30, -2, v30
    s_xor_b32 s47, s19, 1
    s_mul_i32 s47, s47, 640
    s_lshl_b32 s48, s21, 7
    s_add_u32 s48, s48, s47
    buffer_load_dwordx4 v[12:15], v9, s[8:11], s48 offen
    buffer_load_dwordx4 v[60:63], v9, s[8:11], s47 offen offset:512
    s_waitcnt vmcnt(1)
    v_perm_b32 v56, v14, v12, s66
    v_perm_b32 v57, v14, v12, s67
    v_perm_b32 v58, v15, v13, s66
    v_perm_b32 v59, v15, v13, s67
    v_min_u32 v56, -2, v56
    v_min_u32 v58, -2, v58
    s_waitcnt vmcnt(0)
    v_min_u32 v60, -2, v60
    v_min_u32 v62, -2, v62
    v_add_u32 v40, s92, v0
    v_xor_b32 v42, 1024, v40
    v_and_b32 v8, 0x180, v0
    s_add_u32 s47, s99, 2
    s_mov_b32 s49, 0
CP_157:
    buffer_load_dword v9, v8, s[32:35], s98 offen sc1
    s_waitcnt vmcnt(0)
    v_cmp_gt_u32 vcc, s47, v9
    s_cbranch_vccz CP_158
    s_add_u32 s49, s49, 1
    s_cmp_gt_u32 s49, 400000
    s_cbranch_scc1 L_end
    s_sleep 1
    s_branch CP_157
CP_158:
    s_add_u32 m0, s63, 0
    s_add_u32 s60, s42, 16384
    buffer_load_dwordx4 v0, s[32:35], s42 offen offset:0 sc1 lds
    buffer_load_dwordx4 v0, s[32:35], s42 offen offset:1024 sc1 lds
    s_add_u32 m0, s64, 0
    s_add_u32 s42, s42, 1048576
    buffer_load_dwordx4 v0, s[32:35], s60 offen offset:0 sc1 lds
    buffer_load_dwordx4 v0, s[32:35], s60 offen offset:1024 sc1 lds
    ds_read_b128 v[32:35], v1 offset:4096
    ds_read_b128 v[36:39], v1 offset:5120
    v_mov_b64 v[8:9], 0
    v_mov_b64 v[10:11], 0
    v_mov_b64 v[12:13], 0
    v_mov_b64 v[14:15], 0
    v_mov_b64 v[16:17], 0
    v_mov_b64 v[18:19], 0
    v_mov_b64 v[20:21], 0
    v_mov_b64 v[22:23], 0
    v_mov_b64 v[48:49], 0
    v_mov_b64 v[50:51], 0
    v_mov_b64 v[52:53], 0
    v_mov_b64 v[54:55], 0
    s_mov_b32 s49, 0
    s_waitcnt vmcnt(0) lgkmcnt(0)
    s_cmp_lg_u32 s101, 32
    s_cbranch_scc1 CH_slow_159
.p2align 6
CH_top_175:
CH_st_177:
    s_waitcnt vmcnt(3)
    v_smfmac_f32_16x16x64_bf16 v[8:11], v[24:27], v[64:71], v2
    ds_write_b128 v40, v[24:27] offset:0
    v_smfmac_f32_16x16x64_bf16 v[12:15], v[24:27], v[72:79], v2
    s_waitcnt lgkmcnt(1)
    v_max_u32_e64 v41, v24, v26
    v_smfmac_f32_16x16x64_bf16 v[16:19], v[24:27], v[32:39], v2
    v_smfmac_f32_16x16x64_bf16 v[20:23], v[24:27], v[80:87], v2
    ds_read_b128 v[32:35], v1 offset:6144
    v_smfmac_f32_16x16x64_bf16 v[48:51], v[24:27], v[88:95], v2
    ds_read_b128 v[36:39], v1 offset:7168
    s_waitcnt vmcnt(2)
    v_max3_u32 v41, v41, v28, v30
    v_smfmac_f32_16x16x64_bf16 v[52:55], v[24:27], v[96:103], v2
    v_cmp_eq_u32_e64 vcc, -1, v41
    v_smfmac_f32_16x16x64_bf16 v[8:11], v[28:31], v[104:111], v2
    v_smfmac_f32_16x16x64_bf16 v[12:15], v[28:31], v[112:119], v2
    s_cbranch_vccnz CH_re_178
    v_smfmac_f32_16x16x64_bf16 v[16:19], v[28:31], v[120:127], v2
    s_waitcnt lgkmcnt(2)
    s_barrier
    v_smfmac_f32_16x16x64_bf16 v[20:23], v[28:31], v[128:135], v2
    s_waitcnt lgkmcnt(0)
    ds_read_b128 v[24:27], v42 offset:0
    v_smfmac_f32_16x16x64_bf16 v[48:51], v[28:31], v[32:39], v2
    ds_read_b128 v[40:43], v1 offset:8192
    v_smfmac_f32_16x16x64_bf16 v[52:55], v[28:31], v[136:143], v2
    ds_read_b128 v[44:47], v1 offset:9216
    v_add_u32_e64 v28, s14, v0
    s_waitcnt lgkmcnt(2)
    v_smfmac_f32_16x16x64_bf16 v[8:11], v[24:27], v[144:151], v2
    ds_read_b128 v[28:31], v28 offset:0
    v_smfmac_f32_16x16x64_bf16 v[12:15], v[24:27], v[152:159], v2
    ds_read_b128 v[32:35], v1 offset:10240
    v_smfmac_f32_16x16x64_bf16 v[16:19], v[24:27], v[160:167], v2
    s_waitcnt lgkmcnt(2)
    ds_read_b128 v[36:39], v1 offset:11264
    v_smfmac_f32_16x16x64_bf16 v[20:23], v[24:27], v[40:47], v2
    ds_read_b128 v[40:43], v1 offset:12288
    v_smfmac_f32_16x16x64_bf16 v[48:51], v[24:27], v[168:175], v2
    ds_read_b128 v[44:47], v1 offset:13312
    v_smfmac_f32_16x16x64_bf16 v[52:55], v[24:27], v[176:183], v2
    s_waitcnt lgkmcnt(4)
    v_add_u32 v24, s15, v0
    v_smfmac_f32_16x16x64_bf16 v[8:11], v[28:31], v[184:191], v2
    s_waitcnt lgkmcnt(2)
    ds_read_b128 v[24:27], v24 offset:0
    v_smfmac_f32_16x16x64_bf16 v[12:15], v[28:31], v[32:39], v2
    ds_read_b128 v[32:35], v1 offset:14336
    v_smfmac_f32_16x16x64_bf16 v[16:19], v[28:31], v[192:199], v2
    s_waitcnt lgkmcnt(2)
    ds_read_b128 v[36:39], v1 offset:15360
    v_smfmac_f32_16x16x64_bf16 v[20:23], v[28:31], v[40:47], v2
    ds_read_b128 v[40:43], v1 offset:16384
    v_smfmac_f32_16x16x64_bf16 v[48:51], v[28:31], v[200:207], v2
    ds_read_b128 v[44:47], v1 offset:17408
    v_smfmac_f32_16x16x64_bf16 v[52:55], v[28:31], v[208:215], v2
    s_waitcnt lgkmcnt(4)
    v_cndmask_b32 v30, v3, v1, s[82:83]
    v_smfmac_f32_16x16x64_bf16 v[8:11], v[24:27], v[216:223], v2
    ds_read_b64 v[30:31], v30 offset:2176
    v_add_u32 v28, s92, v0
    v_smfmac_f32_16x16x64_bf16 v[12:15], v[24:27], v[224:231], v2
    s_waitcnt vmcnt(1)
    ds_write_b128 v28, v[56:59] offset:4096
    v_max_u32 v29, v56, v58
    v_smfmac_f32_16x16x64_bf16 v[16:19], v[24:27], v[232:239], v2
    s_waitcnt vmcnt(0)
    v_max3_u32 v29, v29, v60, v62
    v_smfmac_f32_16x16x64_bf16 v[20:23], v[24:27], v[240:247], v2
    s_add_u32 m0, s63, 8192
    s_add_u32 s60, s42, 16384
    v_cmp_eq_u32_e64 vcc, -1, v29
    v_smfmac_f32_16x16x64_bf16 v[48:51], v[24:27], v[248:255], v2
    s_waitcnt lgkmcnt(1)
    v_permlane16_swap_b32 v30, v31
    v_smfmac_f32_16x16x64_bf16 v[52:55], v[24:27], a[0:7], v2
    s_cbranch_vccnz CH_re_179
CH_re_180:
    v_lshrrev_b32 v29, 1, v0
    v_smfmac_f32_16x16x64_bf16 v[8:11], v[56:59], a[8:15], v2
    s_waitcnt lgkmcnt(0)
    s_barrier
    v_smfmac_f32_16x16x64_bf16 v[12:15], v[56:59], a[16:23], v2
    buffer_store_dwordx2 v[30:31], v29, s[32:35], s96 offen sc1
    v_mov_b32 v24, s84
    v_smfmac_f32_16x16x64_bf16 v[16:19], v[56:59], a[24:31], v2
    buffer_store_dword v24, off, s[32:35], s18 sc1
    v_add_u32 v28, s13, v0
    v_smfmac_f32_16x16x64_bf16 v[20:23], v[56:59], a[32:39], v2
    ds_read_b128 v[28:31], v28 offset:4096
    v_add_u32_e64 v24, s14, v0
    v_smfmac_f32_16x16x64_bf16 v[8:11], v[60:63], a[40:47], v2
    ds_read_b128 v[24:27], v24 offset:4096
    v_smfmac_f32_16x16x64_bf16 v[12:15], v[60:63], v[32:39], v2
    buffer_load_dwordx4 v0, s[32:35], s42 offen offset:0 sc1 lds
    v_smfmac_f32_16x16x64_bf16 v[16:19], v[60:63], a[48:55], v2
    v_add_u32_e64 v32, s15, v0
    v_smfmac_f32_16x16x64_bf16 v[20:23], v[60:63], a[56:63], v2
    s_waitcnt lgkmcnt(1)
    ds_read_b128 v[32:35], v32 offset:4096
    v_smfmac_f32_16x16x64_bf16 v[8:11], v[28:31], v[40:47], v2
    ds_read_b128 v[40:43], v1 offset:18432
    v_smfmac_f32_16x16x64_bf16 v[12:15], v[28:31], a[64:71], v2
    s_waitcnt lgkmcnt(2)
    ds_read_b128 v[44:47], v1 offset:19456
    v_smfmac_f32_16x16x64_bf16 v[8:11], v[24:27], a[72:79], v2
    buffer_load_dwordx4 v0, s[32:35], s42 offen offset:1024 sc1 lds
    v_smfmac_f32_16x16x64_bf16 v[12:15], v[24:27], a[80:87], v2
    s_waitcnt lgkmcnt(2)
    v_smfmac_f32_16x16x64_bf16 v[8:11], v[32:35], a[88:95], v2
    s_add_u32 m0, s64, 2048
    s_add_u32 s42, s42, 1048576
    s_xor_b32 s42, s42, 8192
    v_smfmac_f32_16x16x64_bf16 v[12:15], v[32:35], a[96:103], v2
    buffer_load_dwordx4 v0, s[32:35], s60 offen offset:0 sc1 lds
    v_smfmac_f32_16x16x64_bf16 v[16:19], v[28:31], a[104:111], v2
    s_waitcnt lgkmcnt(0)
    v_add_f32_e64 v8, v8, v10
    v_smfmac_f32_16x16x64_bf16 v[16:19], v[24:27], v[40:47], v2
    ds_read_b128 v[40:43], v0 offset:16384
    v_add_f32 v9, v9, v11
    v_smfmac_f32_16x16x64_bf16 v[16:19], v[32:35], a[112:119], v2
    ds_read_b128 v[44:47], v0 offset:17408
    v_add_f32 v12, v12, v14
    v_smfmac_f32_16x16x64_bf16 v[20:23], v[28:31], a[120:127], v2
    buffer_load_dwordx4 v0, s[32:35], s60 offen offset:1024 sc1 lds
    v_add_f32_e64 v13, v13, v15
    v_smfmac_f32_16x16x64_bf16 v[20:23], v[24:27], a[128:135], v2
    v_cvt_pk_bf16_f32 v8, v8, v9
    v_cvt_pk_bf16_f32 v9, v12, v13
    v_smfmac_f32_16x16x64_bf16 v[20:23], v[32:35], a[136:143], v2
    ds_write_b64 v3, v[8:9] offset:2176
    v_add_f32 v16, v16, v18
    v_add_f32 v17, v17, v19
    v_smfmac_f32_16x16x64_bf16 v[48:51], v[56:59], a[144:151], v2
    v_cvt_pk_bf16_f32 v10, v16, v17
    v_add_f32 v20, v20, v22
    v_add_f32 v21, v21, v23
    v_cvt_pk_bf16_f32 v11, v20, v21
    v_smfmac_f32_16x16x64_bf16 v[52:55], v[56:59], a[152:159], v2
    ds_write_b64 v3, v[10:11] offset:0
    v_smfmac_f32_16x16x64_bf16 v[48:51], v[60:63], a[160:167], v2
    ds_read_b128 v[56:59], v0 offset:18432
    v_smfmac_f32_16x16x64_bf16 v[52:55], v[60:63], a[168:175], v2
    ds_read_b128 v[60:63], v0 offset:19456
    v_smfmac_f32_16x16x64_bf16 v[48:51], v[28:31], a[176:183], v2
    s_waitcnt lgkmcnt(2)
    s_barrier
    v_smfmac_f32_16x16x64_bf16 v[52:55], v[28:31], a[184:191], v2
    ds_read_b64_tr_b16 v[12:13], v4 offset:2176
    ds_read_b64_tr_b16 v[14:15], v4 offset:2208
    v_smfmac_f32_16x16x64_bf16 v[48:51], v[24:27], a[192:199], v2
    ds_read_b64_tr_b16 v[16:17], v4 offset:3264
    ds_read_b64_tr_b16 v[18:19], v4 offset:3296
    v_smfmac_f32_16x16x64_bf16 v[52:55], v[24:27], a[200:207], v2
    ds_read_b64_tr_b16 v[20:21], v4 offset:0
    ds_read_b64_tr_b16 v[22:23], v4 offset:32
    v_smfmac_f32_16x16x64_bf16 v[48:51], v[32:35], a[208:215], v2
    ds_read_b64_tr_b16 v[36:37], v4 offset:1088
    ds_read_b64_tr_b16 v[38:39], v4 offset:1120
    v_smfmac_f32_16x16x64_bf16 v[52:55], v[32:35], a[216:223], v2
    ds_read_b128 v[28:31], v0 offset:21504
    ds_read_b128 v[24:27], v0 offset:20480
    s_waitcnt lgkmcnt(8)
    v_mfma_f32_16x16x32_bf16 v[8:11], v[40:43], v[12:15], 0
    ds_read_b128 v[32:35], v0 offset:22528
    s_waitcnt lgkmcnt(7)
    v_mfma_f32_16x16x32_bf16 v[8:11], v[44:47], v[16:19], v[8:11]
    ds_read_b128 v[44:47], v0 offset:23552
    v_add_f32 v48, v48, v50
    v_mfma_f32_16x16x32_bf16 v[40:43], v[56:59], v[12:15], 0
    v_add_f32 v49, v49, v51
    v_mfma_f32_16x16x32_bf16 v[40:43], v[60:63], v[16:19], v[40:43]
    s_waitcnt lgkmcnt(6)
    v_add_f32_e64 v52, v52, v54
    v_add_f32_dpp v8, v10, v8 quad_perm:[2,3,2,3] row_mask:0xf bank_mask:0xf
    v_mfma_f32_16x16x32_bf16 v[56:59], v[20:23], v[12:15], 0
    s_waitcnt lgkmcnt(4)
    v_add_f32_dpp v9, v11, v9 quad_perm:[2,3,2,3] row_mask:0xf bank_mask:0xf
    v_max_f32 v10, v8, v9
    v_mfma_f32_16x16x32_bf16 v[56:59], v[36:39], v[16:19], v[56:59]
    s_waitcnt lgkmcnt(2)
    v_add_f32_e64 v53, v53, v55
    v_add_f32_dpp v40, v42, v40 quad_perm:[2,3,2,3] row_mask:0xf bank_mask:0xf
    v_mfma_f32_16x16x32_bf16 v[20:23], v[24:27], v[12:15], 0
    v_add_f32_dpp v41, v43, v41 quad_perm:[2,3,2,3] row_mask:0xf bank_mask:0xf
    v_max3_f32 v10, v10, v40, v41
    v_mfma_f32_16x16x32_bf16 v[20:23], v[28:31], v[16:19], v[20:23]
    s_waitcnt lgkmcnt(1)
    v_cvt_pk_bf16_f32 v50, v48, v49
    v_add_f32_dpp v56, v58, v56 quad_perm:[2,3,2,3] row_mask:0xf bank_mask:0xf
    v_mfma_f32_16x16x32_bf16 v[24:27], v[32:35], v[12:15], 0
    s_waitcnt lgkmcnt(0)
    v_add_f32_dpp v57, v59, v57 quad_perm:[2,3,2,3] row_mask:0xf bank_mask:0xf
    v_max3_f32 v10, v10, v56, v57
    v_mfma_f32_16x16x32_bf16 v[24:27], v[44:47], v[16:19], v[24:27]
    ds_read_b128 v[32:35], v1 offset:0
    v_add_f32_dpp v20, v22, v20 quad_perm:[2,3,2,3] row_mask:0xf bank_mask:0xf
    v_add_f32_dpp v21, v23, v21 quad_perm:[2,3,2,3] row_mask:0xf bank_mask:0xf
    v_max3_f32 v10, v10, v20, v21
    v_cvt_pk_bf16_f32 v51, v52, v53
    v_mov_b64 v[60:61], s[22:23]
    v_mov_b64_e64 v[62:63], s[22:23]
    s_nop 0
    v_add_f32_dpp v24, v26, v24 quad_perm:[2,3,2,3] row_mask:0xf bank_mask:0xf
    v_add_f32_dpp v25, v27, v25 quad_perm:[2,3,2,3] row_mask:0xf bank_mask:0xf
    v_max3_f32 v10, v10, v24, v25
    v_mov_b32 v11, v10
    v_mov_b32 v29, 0
    v_mov_b32 v30, 0
    v_permlane32_swap_b32 v10, v11
    v_max_f32 v10, v10, v11
    v_mov_b32 v11, v10
    s_nop 1
    v_permlane16_swap_b32 v10, v11
    v_max_f32 v10, v10, v11
    v_mul_f32 v10, s51, v10
    v_pk_fma_f32 v[56:57], v[56:57], s[16:17], v[10:11] op_sel_hi:[1,1,0] neg_lo:[0,0,1] neg_hi:[0,0,1]
    v_pk_fma_f32 v[8:9], v[8:9], s[16:17], v[10:11] op_sel_hi:[1,1,0] neg_lo:[0,0,1] neg_hi:[0,0,1]
    v_pk_fma_f32 v[40:41], v[40:41], s[16:17], v[10:11] op_sel_hi:[1,1,0] neg_lo:[0,0,1] neg_hi:[0,0,1]
    v_pk_fma_f32 v[20:21], v[20:21], s[16:17], v[10:11] op_sel_hi:[1,1,0] neg_lo:[0,0,1] neg_hi:[0,0,1]
    v_pk_fma_f32 v[24:25], v[24:25], s[16:17], v[10:11] op_sel_hi:[1,1,0] neg_lo:[0,0,1] neg_hi:[0,0,1]
    v_exp_f32_dpp v56, v56 quad_perm:[0,1,0,1] row_mask:0xf bank_mask:0xf
    v_exp_f32_dpp v57, v57 quad_perm:[0,1,0,1] row_mask:0xf bank_mask:0xf
    v_exp_f32_dpp v8, v8 quad_perm:[0,1,0,1] row_mask:0xf bank_mask:0xf
    v_cvt_pk_bf16_f32 v28, v56, v57
    v_cvt_pk_bf16_f32 v31, v56, v57
    v_exp_f32_dpp v9, v9 quad_perm:[0,1,0,1] row_mask:0xf bank_mask:0xf
    v_mfma_f32_16x16x16_bf16 v[36:39], v[60:61], v[28:29], 0
    ds_read_b128 v[44:47], v1 offset:1024
    v_exp_f32_dpp v40, v40 quad_perm:[0,1,0,1] row_mask:0xf bank_mask:0xf
    v_mfma_f32_16x16x16_bf16 v[16:19], v[50:51], v[28:29], 0
    v_exp_f32_dpp v41, v41 quad_perm:[0,1,0,1] row_mask:0xf bank_mask:0xf
    v_mfma_f32_16x16x16_bf16 v[52:55], v[50:51], v[30:31], 0
    v_exp_f32_dpp v20, v20 quad_perm:[0,1,0,1] row_mask:0xf bank_mask:0xf
    v_cvt_pk_bf16_f32 v12, v8, v9
    v_exp_f32_dpp v21, v21 quad_perm:[0,1,0,1] row_mask:0xf bank_mask:0xf
    v_cvt_pk_bf16_f32 v13, v40, v41
    v_exp_f32_dpp v24, v24 quad_perm:[0,1,0,1] row_mask:0xf bank_mask:0xf
    v_exp_f32_dpp v25, v25 quad_perm:[0,1,0,1] row_mask:0xf bank_mask:0xf
    v_cvt_pk_bf16_f32 v14, v20, v21
    v_cvt_pk_bf16_f32 v15, v24, v25
    s_waitcnt lgkmcnt(0)
    s_nop 0
    v_mfma_f32_16x16x32_bf16 v[36:39], v[60:63], v[12:15], v[36:39]
    ds_write_b64 v1, v[50:51] offset:0
    v_mfma_f32_16x16x32_bf16 v[16:19], v[32:35], v[12:15], v[16:19]
    ds_read_b128 v[56:59], v1 offset:20480
    v_mfma_f32_16x16x32_bf16 v[52:55], v[44:47], v[12:15], v[52:55]
    ds_read_b128 v[60:63], v1 offset:21504
    v_rcp_f32 v10, v36
    v_mov_b64 v[12:13], 0
    s_nop 0
    v_pk_mul_f32 v[16:17], v[16:17], v[10:11] op_sel_hi:[1,0]
    v_pk_mul_f32 v[18:19], v[18:19], v[10:11] op_sel_hi:[1,0]
    s_mov_b64 exec, s[86:87]
    s_nop 0
    v_pk_mul_f32 v[16:17], v[52:53], v[10:11] op_sel_hi:[1,0]
    v_pk_mul_f32 v[18:19], v[54:55], v[10:11] op_sel_hi:[1,0]
    s_mov_b64 exec, -1
    v_cvt_pk_bf16_f32 v16, v16, v17
    v_cvt_pk_bf16_f32 v17, v18, v19
    v_mfma_f32_16x16x16_bf16 v[20:23], v[12:13], v[12:13], 0
    ds_write_b64 v5, v[16:17]
    v_mfma_f32_16x16x16_bf16 v[24:27], v[12:13], v[12:13], 0
    ds_read_b128 v[40:43], v1 offset:22528
    v_mfma_f32_16x16x16_bf16 v[28:31], v[12:13], v[12:13], 0
    ds_read_b128 v[44:47], v1 offset:23552
    v_mfma_f32_16x16x16_bf16 v[48:51], v[12:13], v[12:13], 0
    ds_read_b128 v[32:35], v1 offset:24576
    s_waitcnt lgkmcnt(3)
    s_barrier
    v_mfma_f32_16x16x16_bf16 v[8:11], v[12:13], v[12:13], 0
    ds_read_b128 v[16:19], v0 offset:8192
    ds_read_b128 v[52:55], v0 offset:9216
    ds_read_b128 v[36:39], v1 offset:25600
    v_mfma_f32_16x16x16_bf16 v[28:31], v[12:13], v[12:13], 0
    v_lshlrev_b32_e64 v15, 3, v0
    v_mfma_f32_16x16x16_bf16 v[48:51], v[12:13], v[12:13], 0
    v_bfe_u32 v14, v0, 2, 6
    v_and_or_b32 v14, v15, s94, v14
    s_waitcnt lgkmcnt(2)
    v_smfmac_f32_16x16x64_bf16 v[20:23], v[16:19], v[56:63], v2
    ds_read_b128 v[56:59], v1 offset:26624
    s_waitcnt lgkmcnt(2)
    v_smfmac_f32_16x16x64_bf16 v[20:23], v[52:55], v[40:47], v2
    s_waitcnt lgkmcnt(1)
    ds_read_b128 v[60:63], v1 offset:27648
    v_smfmac_f32_16x16x64_bf16 v[24:27], v[16:19], v[32:39], v2
    ds_read_b128 v[40:43], v1 offset:28672
    v_smfmac_f32_16x16x64_bf16 v[24:27], v[52:55], a[224:231], v2
    ds_read_b128 v[44:47], v1 offset:29696
    v_add_f32 v20, v20, v22
    v_smfmac_f32_16x16x64_bf16 v[28:31], v[16:19], a[232:239], v2
    ds_read_b128 v[32:35], v1 offset:30720
    v_add_f32_e64 v21, v21, v23
    v_smfmac_f32_16x16x64_bf16 v[28:31], v[52:55], a[240:247], v2
    ds_read_b128 v[36:39], v1 offset:31744
    v_add_f32 v24, v24, v26
    v_smfmac_f32_16x16x64_bf16 v[48:51], v[16:19], a[248:255], v2
    s_waitcnt lgkmcnt(4)
    v_add_f32_e64 v25, v25, v27
    v_smfmac_f32_16x16x64_bf16 v[48:51], v[52:55], v[56:63], v2
    s_waitcnt lgkmcnt(2)
    v_cvt_pk_bf16_f32 v20, v20, v24
    v_smfmac_f32_16x16x64_bf16 v[8:11], v[16:19], v[40:47], v2
    s_waitcnt lgkmcnt(0)
    v_cvt_pk_bf16_f32 v21, v21, v25
    v_and_or_b32 v20, v20, -2, 1
    v_smfmac_f32_16x16x64_bf16 v[8:11], v[52:55], v[32:39], v2
    s_cmp_eq_u32 s21, 3
    buffer_store_dwordx2 v[20:21], v7, s[28:31], 0 offen
    v_pk_add_f32 v[28:29], v[28:29], v[30:31]
    v_pk_add_f32 v[48:49], v[48:49], v[50:51]
    v_cvt_pk_bf16_f32 v28, v28, v48
    v_cvt_pk_bf16_f32 v29, v29, v49
    v_and_or_b32 v28, v28, -2, 1
    s_nop 0
    v_pk_add_f32 v[8:9], v[8:9], v[10:11]
    v_cvt_pk_bf16_f32 v8, v8, v9
    v_and_or_b32 v8, v8, -2, 1
    buffer_store_dword v8, v14, s[28:31], s62 offen
    buffer_store_dwordx2 v[28:29], v7, s[28:31], s61 offen
    s_cbranch_scc1 CH_h_181
    v_lshrrev_b32 v56, s91, v0
    v_and_b32_e64 v56, 16, v56
    v_lshlrev_b32_e64 v56, v56, s65
    v_cndmask_b32 v40, 0, v56, s[52:53]
    v_cndmask_b32 v41, 0, v56, s[54:55]
    v_cndmask_b32 v42, 0, v56, s[56:57]
    v_cndmask_b32 v43, 0, v56, s[58:59]
    v_mov_b64 v[58:59], -1
    s_mov_b32 s44, s43
    s_add_u32 s43, s43, 0x2000
    s_and_b32 s43, s43, 0x7fff
    s_add_u32 s43, s43, 163840
    s_mov_b32 s49, 0
    s_add_u32 s40, s40, 1
    s_add_u32 s90, s90, 32768
    s_mov_b32 s96, s97
    s_add_u32 s97, s97, 131072
    s_add_u32 s84, s40, s99
    s_sub_u32 s84, s84, 1
    s_cmp_eq_u32 s40, 63
    s_cselect_b32 s42, 1073741824, s42
    s_cmp_lg_u32 s95, 0
    s_cbranch_scc1 CH_nt_185
    s_nop 9
    s_cmp_le_u32 s21, 0
    s_cbranch_scc1 CH_d_187
    s_nop 7
CH_d_187:
    buffer_load_dwordx4 v[32:35], v0, s[28:31], s46 offen offset:0 sc1
    buffer_load_dwordx4 v[36:39], v0, s[28:31], s46 offen offset:1024 sc1
    v_mov_b64 v[8:9], 0
    v_mov_b64 v[10:11], 0
    v_mov_b64 v[12:13], 0
    v_mov_b64 v[14:15], 0
    v_mov_b64 v[48:49], 0
    v_mov_b64 v[50:51], 0
    v_mov_b64 v[52:53], 0
    v_mov_b64_e64 v[54:55], 0
    s_cmp_eq_u32 s21, 2
    s_cselect_b32 s47, 0, 1
    s_nop 15
    s_nop 2
    buffer_load_dwordx4 v[24:27], v0, s[28:31], s46 offen offset:0 sc1
    buffer_load_dwordx4 v[28:31], v0, s[28:31], s46 offen offset:1024 sc1
CH_h_184:
    s_waitcnt vmcnt(3)
    v_mfma_f32_16x16x32_bf16 v[44:47], v[40:43], v[32:35], 0
    s_waitcnt vmcnt(2)
    v_mfma_f32_16x16x32_bf16 v[44:47], v[40:43], v[36:39], v[44:47]
    v_bitop3_b32 v56, v33, v35, v37 bitop3:0x80
    v_bitop3_b32 v57, v32, v34, v36 bitop3:0x80
    v_bitop3_b32 v56, v56, v39, s47 bitop3:0xea
    v_bitop3_b32 v56, v56, v57, v38 bitop3:0x80
    v_and_b32 v56, 1, v56
    v_cmp_ne_u32_e64 vcc, 1, v56
CH_ok_188:
    s_nop 0
    v_add_f32_dpp v44, v44, v44 row_ror:8 row_mask:0xf bank_mask:0xf
    v_add_f32_dpp v45, v45, v45 row_ror:8 row_mask:0xf bank_mask:0xf
    v_add_f32_dpp v46, v46, v46 row_ror:8 row_mask:0xf bank_mask:0xf
    v_add_f32_dpp v47, v47, v47 row_ror:8 row_mask:0xf bank_mask:0xf
    v_add_f32_dpp v44, v44, v44 row_ror:4 row_mask:0xf bank_mask:0xf
    v_add_f32_dpp v45, v45, v45 row_ror:4 row_mask:0xf bank_mask:0xf
    v_add_f32_dpp v46, v46, v46 row_ror:4 row_mask:0xf bank_mask:0xf
    v_add_f32_dpp v47, v47, v47 row_ror:4 row_mask:0xf bank_mask:0xf
    v_cvt_pk_bf16_f32 v56, v44, v45
    v_cvt_pk_bf16_f32 v57, v46, v47
    v_min_u32_e64 v56, -2, v56
    s_cbranch_vccnz CH_h_183
    buffer_store_dwordx2 v[56:57], v6, s[28:31], s43 offen
CH_x0_186:
    s_barrier
    buffer_store_dwordx2 v[56:57], v6, s[36:39], s50 offen sc1
    buffer_store_dwordx2 v[58:59], v6, s[28:31], s44 offen
    s_add_u32 s50, s50, 32768
    s_waitcnt vmcnt(3)
    v_mov_b64 v[16:17], 0
    v_mov_b64 v[18:19], 0
    v_mov_b64 v[20:21], 0
    v_mov_b64 v[22:23], 0
    s_nop 15
    s_nop 15
    s_nop 15
    s_nop 15
    s_nop 2
    s_branch CH_h_182
CH_h_181:
    v_mov_b64 v[48:49], 0
    v_mov_b64 v[50:51], 0
    v_mov_b64 v[52:53], 0
    v_mov_b64 v[54:55], 0
    s_mov_b32 s44, s43
    s_add_u32 s43, s43, 0x2000
    s_and_b32 s43, s43, 0x7fff
    s_add_u32 s43, s43, 163840
    s_mov_b32 s49, 0
    s_add_u32 s40, s40, 1
    s_add_u32 s90, s90, 32768
    s_mov_b32 s96, s97
    s_add_u32 s97, s97, 131072
    s_add_u32 s84, s40, s99
    s_sub_u32 s84, s84, 1
    s_cmp_eq_u32 s40, 63
    s_cselect_b32 s42, 1073741824, s42
    s_add_u32 s47, s98, 0
    s_load_dword s72, s[32:33], s47 glc
    s_add_u32 s47, s98, 128
    s_load_dword s73, s[32:33], s47 glc
    s_add_u32 s47, s98, 256
    s_load_dword s74, s[32:33], s47 glc
    s_add_u32 s47, s98, 384
    s_load_dword s75, s[32:33], s47 glc
    v_mfma_f32_32x32x2_f32 v[8:23], v48, v48, 0
    v_mfma_f32_32x32x2_f32 v[8:23], v48, v48, v[8:23]
    v_mfma_f32_32x32x2_f32 v[8:23], v48, v48, v[8:23]
    v_mfma_f32_32x32x2_f32 v[8:23], v48, v48, v[8:23]
    v_mfma_f32_32x32x2_f32 v[8:23], v48, v48, v[8:23]
    v_mfma_f32_32x32x2_f32 v[8:23], v48, v48, v[8:23]
    s_waitcnt vmcnt(0)
    s_barrier
    s_nop 15
    s_nop 15
    s_nop 15
    s_nop 15
    s_nop 3
    s_add_u32 s47, s40, 2
    s_min_u32 s47, s47, 64
    s_add_u32 s47, s47, s99
    s_waitcnt lgkmcnt(0)
    s_min_u32 s72, s72, s73
    s_min_u32 s72, s72, s74
    s_min_u32 s72, s72, s75
    s_cmp_lt_u32 s72, s47
    s_cbranch_scc1 CH_fp_189
CH_fb_190:
CH_h_182:
    s_add_u32 s93, s43, s92
    buffer_load_dwordx4 v[24:27], v0, s[28:31], s93 offen sc1
    ds_read_b128 v[32:35], v1 offset:4096
    ds_read_b128 v[36:39], v1 offset:5120
    v_add_u32 v40, s92, v0
    v_xor_b32 v42, 1024, v40
    s_add_u32 s93, s43, 4096
    buffer_load_dwordx4 v[28:31], v0, s[28:31], s93 offen sc1
    s_nop 15
    s_nop 15
    s_nop 11
    s_add_u32 s93, s90, s92
    buffer_load_dwordx4 v[56:59], v0, s[36:39], s93 offen sc1
    s_nop 5
    s_add_u32 s93, s90, 4096
    buffer_load_dwordx4 v[60:63], v0, s[36:39], s93 offen sc1
CH_st_191:
    s_waitcnt vmcnt(3)
    v_smfmac_f32_16x16x64_bf16 v[8:11], v[24:27], v[64:71], v2
    ds_write_b128 v40, v[24:27] offset:0
    v_smfmac_f32_16x16x64_bf16 v[12:15], v[24:27], v[72:79], v2
    s_waitcnt lgkmcnt(1)
    v_max_u32 v41, v24, v26
    v_smfmac_f32_16x16x64_bf16 v[16:19], v[24:27], v[32:39], v2
    v_smfmac_f32_16x16x64_bf16 v[20:23], v[24:27], v[80:87], v2
    ds_read_b128 v[32:35], v1 offset:6144
    v_smfmac_f32_16x16x64_bf16 v[48:51], v[24:27], v[88:95], v2
    ds_read_b128 v[36:39], v1 offset:7168
    s_waitcnt vmcnt(2)
    v_max3_u32 v41, v41, v28, v30
    v_smfmac_f32_16x16x64_bf16 v[52:55], v[24:27], v[96:103], v2
    v_cmp_eq_u32_e64 vcc, -1, v41
    v_smfmac_f32_16x16x64_bf16 v[8:11], v[28:31], v[104:111], v2
    v_smfmac_f32_16x16x64_bf16 v[12:15], v[28:31], v[112:119], v2
    s_cbranch_vccnz CH_re_192
    v_smfmac_f32_16x16x64_bf16 v[16:19], v[28:31], v[120:127], v2
    s_waitcnt lgkmcnt(2)
    s_barrier
    v_smfmac_f32_16x16x64_bf16 v[20:23], v[28:31], v[128:135], v2
    s_waitcnt lgkmcnt(0)
    ds_read_b128 v[24:27], v42 offset:0
    v_smfmac_f32_16x16x64_bf16 v[48:51], v[28:31], v[32:39], v2
    ds_read_b128 v[40:43], v1 offset:8192
    v_smfmac_f32_16x16x64_bf16 v[52:55], v[28:31], v[136:143], v2
    ds_read_b128 v[44:47], v1 offset:9216
    v_add_u32_e64 v28, s14, v0
    s_waitcnt lgkmcnt(2)
    v_smfmac_f32_16x16x64_bf16 v[8:11], v[24:27], v[144:151], v2
    ds_read_b128 v[28:31], v28 offset:0
    v_smfmac_f32_16x16x64_bf16 v[12:15], v[24:27], v[152:159], v2
    ds_read_b128 v[32:35], v1 offset:10240
    v_smfmac_f32_16x16x64_bf16 v[16:19], v[24:27], v[160:167], v2
    s_waitcnt lgkmcnt(2)
    ds_read_b128 v[36:39], v1 offset:11264
    v_smfmac_f32_16x16x64_bf16 v[20:23], v[24:27], v[40:47], v2
    ds_read_b128 v[40:43], v1 offset:12288
    v_smfmac_f32_16x16x64_bf16 v[48:51], v[24:27], v[168:175], v2
    ds_read_b128 v[44:47], v1 offset:13312
    v_smfmac_f32_16x16x64_bf16 v[52:55], v[24:27], v[176:183], v2
    s_waitcnt lgkmcnt(4)
    v_add_u32 v24, s15, v0
    v_smfmac_f32_16x16x64_bf16 v[8:11], v[28:31], v[184:191], v2
    s_waitcnt lgkmcnt(2)
    ds_read_b128 v[24:27], v24 offset:0
    v_smfmac_f32_16x16x64_bf16 v[12:15], v[28:31], v[32:39], v2
    ds_read_b128 v[32:35], v1 offset:14336
    v_smfmac_f32_16x16x64_bf16 v[16:19], v[28:31], v[192:199], v2
    s_waitcnt lgkmcnt(2)
    ds_read_b128 v[36:39], v1 offset:15360
    v_smfmac_f32_16x16x64_bf16 v[20:23], v[28:31], v[40:47], v2
    ds_read_b128 v[40:43], v1 offset:16384
    v_smfmac_f32_16x16x64_bf16 v[48:51], v[28:31], v[200:207], v2
    ds_read_b128 v[44:47], v1 offset:17408
    v_smfmac_f32_16x16x64_bf16 v[52:55], v[28:31], v[208:215], v2
    s_waitcnt lgkmcnt(4)
    v_cndmask_b32 v30, v3, v1, s[82:83]
    v_smfmac_f32_16x16x64_bf16 v[8:11], v[24:27], v[216:223], v2
    ds_read_b64 v[30:31], v30 offset:0
    v_add_u32 v28, s92, v0
    v_smfmac_f32_16x16x64_bf16 v[12:15], v[24:27], v[224:231], v2
    s_waitcnt vmcnt(1)
    ds_write_b128 v28, v[56:59] offset:4096
    v_max_u32 v29, v56, v58
    v_smfmac_f32_16x16x64_bf16 v[16:19], v[24:27], v[232:239], v2
    s_waitcnt vmcnt(0)
    v_max3_u32 v29, v29, v60, v62
    v_smfmac_f32_16x16x64_bf16 v[20:23], v[24:27], v[240:247], v2
    s_add_u32 m0, s63, 0
    s_add_u32 s60, s42, 16384
    v_cmp_eq_u32 vcc, -1, v29
    v_smfmac_f32_16x16x64_bf16 v[48:51], v[24:27], v[248:255], v2
    s_waitcnt lgkmcnt(1)
    v_permlane16_swap_b32 v30, v31
    v_smfmac_f32_16x16x64_bf16 v[52:55], v[24:27], a[0:7], v2
    s_cbranch_vccnz CH_re_193
CH_re_194:
    v_lshrrev_b32 v29, 1, v0
    v_smfmac_f32_16x16x64_bf16 v[8:11], v[56:59], a[8:15], v2
    s_waitcnt lgkmcnt(0)
    s_barrier
    v_smfmac_f32_16x16x64_bf16 v[12:15], v[56:59], a[16:23], v2
    buffer_store_dwordx2 v[30:31], v29, s[32:35], s96 offen sc1
    v_mov_b32_e64 v24, s84
    v_smfmac_f32_16x16x64_bf16 v[16:19], v[56:59], a[24:31], v2
    buffer_store_dword v24, off, s[32:35], s18 sc1
    v_add_u32_e64 v28, s13, v0
    v_smfmac_f32_16x16x64_bf16 v[20:23], v[56:59], a[32:39], v2
    ds_read_b128 v[28:31], v28 offset:4096
    v_add_u32_e64 v24, s14, v0
    v_smfmac_f32_16x16x64_bf16 v[8:11], v[60:63], a[40:47], v2
    ds_read_b128 v[24:27], v24 offset:4096
    v_smfmac_f32_16x16x64_bf16 v[12:15], v[60:63], v[32:39], v2
    buffer_load_dwordx4 v0, s[32:35], s42 offen offset:0 sc1 lds
    v_smfmac_f32_16x16x64_bf16 v[16:19], v[60:63], a[48:55], v2
    v_add_u32_e64 v32, s15, v0
    v_smfmac_f32_16x16x64_bf16 v[20:23], v[60:63], a[56:63], v2
    s_waitcnt lgkmcnt(1)
    ds_read_b128 v[32:35], v32 offset:4096
    v_smfmac_f32_16x16x64_bf16 v[8:11], v[28:31], v[40:47], v2
    ds_read_b128 v[40:43], v1 offset:18432
    v_smfmac_f32_16x16x64_bf16 v[12:15], v[28:31], a[64:71], v2
    s_waitcnt lgkmcnt(2)
    ds_read_b128 v[44:47], v1 offset:19456
    v_smfmac_f32_16x16x64_bf16 v[8:11], v[24:27], a[72:79], v2
    buffer_load_dwordx4 v0, s[32:35], s42 offen offset:1024 sc1 lds
    v_smfmac_f32_16x16x64_bf16 v[12:15], v[24:27], a[80:87], v2
    s_waitcnt lgkmcnt(2)
    v_smfmac_f32_16x16x64_bf16 v[8:11], v[32:35], a[88:95], v2
    s_add_u32 m0, s64, 0
    s_add_u32 s42, s42, 1048576
    v_smfmac_f32_16x16x64_bf16 v[12:15], v[32:35], a[96:103], v2
    buffer_load_dwordx4 v0, s[32:35], s60 offen offset:0 sc1 lds
    v_smfmac_f32_16x16x64_bf16 v[16:19], v[28:31], a[104:111], v2
    s_waitcnt lgkmcnt(0)
    v_add_f32 v8, v8, v10
    v_smfmac_f32_16x16x64_bf16 v[16:19], v[24:27], v[40:47], v2
    ds_read_b128 v[40:43], v0 offset:24576
    v_add_f32_e64 v9, v9, v11
    v_smfmac_f32_16x16x64_bf16 v[16:19], v[32:35], a[112:119], v2
    ds_read_b128 v[44:47], v0 offset:25600
    v_add_f32_e64 v12, v12, v14
    v_smfmac_f32_16x16x64_bf16 v[20:23], v[28:31], a[120:127], v2
    buffer_load_dwordx4 v0, s[32:35], s60 offen offset:1024 sc1 lds
    v_add_f32_e64 v13, v13, v15
    v_smfmac_f32_16x16x64_bf16 v[20:23], v[24:27], a[128:135], v2
    v_cvt_pk_bf16_f32 v8, v8, v9
    v_cvt_pk_bf16_f32 v9, v12, v13
    v_smfmac_f32_16x16x64_bf16 v[20:23], v[32:35], a[136:143], v2
    ds_write_b64 v3, v[8:9] offset:0
    v_add_f32 v16, v16, v18
    v_add_f32 v17, v17, v19
    v_smfmac_f32_16x16x64_bf16 v[48:51], v[56:59], a[144:151], v2
    v_cvt_pk_bf16_f32 v10, v16, v17
    v_add_f32 v20, v20, v22
    v_add_f32 v21, v21, v23
    v_cvt_pk_bf16_f32 v11, v20, v21
    v_smfmac_f32_16x16x64_bf16 v[52:55], v[56:59], a[152:159], v2
    ds_write_b64 v3, v[10:11] offset:2176
    v_smfmac_f32_16x16x64_bf16 v[48:51], v[60:63], a[160:167], v2
    ds_read_b128 v[56:59], v0 offset:26624
    v_smfmac_f32_16x16x64_bf16 v[52:55], v[60:63], a[168:175], v2
    ds_read_b128 v[60:63], v0 offset:27648
    v_smfmac_f32_16x16x64_bf16 v[48:51], v[28:31], a[176:183], v2
    s_waitcnt lgkmcnt(2)
    s_barrier
    v_smfmac_f32_16x16x64_bf16 v[52:55], v[28:31], a[184:191], v2
    ds_read_b64_tr_b16 v[12:13], v4 offset:0
    ds_read_b64_tr_b16 v[14:15], v4 offset:32
    v_smfmac_f32_16x16x64_bf16 v[48:51], v[24:27], a[192:199], v2
    ds_read_b64_tr_b16 v[16:17], v4 offset:1088
    ds_read_b64_tr_b16 v[18:19], v4 offset:1120
    v_smfmac_f32_16x16x64_bf16 v[52:55], v[24:27], a[200:207], v2
    ds_read_b64_tr_b16 v[20:21], v4 offset:2176
    ds_read_b64_tr_b16 v[22:23], v4 offset:2208
    v_smfmac_f32_16x16x64_bf16 v[48:51], v[32:35], a[208:215], v2
    ds_read_b64_tr_b16 v[36:37], v4 offset:3264
    ds_read_b64_tr_b16 v[38:39], v4 offset:3296
    v_smfmac_f32_16x16x64_bf16 v[52:55], v[32:35], a[216:223], v2
    ds_read_b128 v[28:31], v0 offset:29696
    ds_read_b128 v[24:27], v0 offset:28672
    s_waitcnt lgkmcnt(8)
    v_mfma_f32_16x16x32_bf16 v[8:11], v[40:43], v[12:15], 0
    ds_read_b128 v[32:35], v0 offset:30720
    s_waitcnt lgkmcnt(7)
    v_mfma_f32_16x16x32_bf16 v[8:11], v[44:47], v[16:19], v[8:11]
    ds_read_b128 v[44:47], v0 offset:31744
    v_add_f32 v48, v48, v50
    v_mfma_f32_16x16x32_bf16 v[40:43], v[56:59], v[12:15], 0
    v_add_f32 v49, v49, v51
    v_mfma_f32_16x16x32_bf16 v[40:43], v[60:63], v[16:19], v[40:43]
    s_waitcnt lgkmcnt(6)
    v_add_f32 v52, v52, v54
    v_add_f32_dpp v8, v10, v8 quad_perm:[2,3,2,3] row_mask:0xf bank_mask:0xf
    v_mfma_f32_16x16x32_bf16 v[56:59], v[20:23], v[12:15], 0
    s_waitcnt lgkmcnt(4)
    v_add_f32_dpp v9, v11, v9 quad_perm:[2,3,2,3] row_mask:0xf bank_mask:0xf
    v_max_f32 v10, v8, v9
    v_mfma_f32_16x16x32_bf16 v[56:59], v[36:39], v[16:19], v[56:59]
    s_waitcnt lgkmcnt(2)
    v_add_f32 v53, v53, v55
    v_add_f32_dpp v40, v42, v40 quad_perm:[2,3,2,3] row_mask:0xf bank_mask:0xf
    v_mfma_f32_16x16x32_bf16 v[20:23], v[24:27], v[12:15], 0
    v_add_f32_dpp v41, v43, v41 quad_perm:[2,3,2,3] row_mask:0xf bank_mask:0xf
    v_max3_f32 v10, v10, v40, v41
    v_mfma_f32_16x16x32_bf16 v[20:23], v[28:31], v[16:19], v[20:23]
    s_waitcnt lgkmcnt(1)
    v_cvt_pk_bf16_f32 v50, v48, v49
    v_add_f32_dpp v56, v58, v56 quad_perm:[2,3,2,3] row_mask:0xf bank_mask:0xf
    v_mfma_f32_16x16x32_bf16 v[24:27], v[32:35], v[12:15], 0
    s_waitcnt lgkmcnt(0)
    v_add_f32_dpp v57, v59, v57 quad_perm:[2,3,2,3] row_mask:0xf bank_mask:0xf
    v_max3_f32 v10, v10, v56, v57
    v_mfma_f32_16x16x32_bf16 v[24:27], v[44:47], v[16:19], v[24:27]
    ds_read_b128 v[32:35], v1 offset:2048
    v_add_f32_dpp v20, v22, v20 quad_perm:[2,3,2,3] row_mask:0xf bank_mask:0xf
    v_add_f32_dpp v21, v23, v21 quad_perm:[2,3,2,3] row_mask:0xf bank_mask:0xf
    v_max3_f32 v10, v10, v20, v21
    v_cvt_pk_bf16_f32 v51, v52, v53
    v_mov_b64 v[60:61], s[22:23]
    v_mov_b64 v[62:63], s[22:23]
    s_nop 0
    v_add_f32_dpp v24, v26, v24 quad_perm:[2,3,2,3] row_mask:0xf bank_mask:0xf
    v_add_f32_dpp v25, v27, v25 quad_perm:[2,3,2,3] row_mask:0xf bank_mask:0xf
    v_max3_f32 v10, v10, v24, v25
    v_mov_b32 v11, v10
    v_mov_b32 v29, 0
    v_mov_b32 v30, 0
    v_permlane32_swap_b32 v10, v11
    v_max_f32 v10, v10, v11
    v_mov_b32 v11, v10
    s_cmp_eq_u32 s40, 63
    s_cbranch_scc1 CH_exit_176
    v_permlane16_swap_b32 v10, v11
    v_max_f32 v10, v10, v11
    v_mul_f32 v10, s51, v10
    v_pk_fma_f32 v[56:57], v[56:57], s[16:17], v[10:11] op_sel_hi:[1,1,0] neg_lo:[0,0,1] neg_hi:[0,0,1]
    v_pk_fma_f32 v[8:9], v[8:9], s[16:17], v[10:11] op_sel_hi:[1,1,0] neg_lo:[0,0,1] neg_hi:[0,0,1]
    v_pk_fma_f32 v[40:41], v[40:41], s[16:17], v[10:11] op_sel_hi:[1,1,0] neg_lo:[0,0,1] neg_hi:[0,0,1]
    v_pk_fma_f32 v[20:21], v[20:21], s[16:17], v[10:11] op_sel_hi:[1,1,0] neg_lo:[0,0,1] neg_hi:[0,0,1]
    v_pk_fma_f32 v[24:25], v[24:25], s[16:17], v[10:11] op_sel_hi:[1,1,0] neg_lo:[0,0,1] neg_hi:[0,0,1]
    v_exp_f32_dpp v56, v56 quad_perm:[0,1,0,1] row_mask:0xf bank_mask:0xf
    v_exp_f32_dpp v57, v57 quad_perm:[0,1,0,1] row_mask:0xf bank_mask:0xf
    v_exp_f32_dpp v8, v8 quad_perm:[0,1,0,1] row_mask:0xf bank_mask:0xf
    v_cvt_pk_bf16_f32 v28, v56, v57
    v_cvt_pk_bf16_f32 v31, v56, v57
    v_exp_f32_dpp v9, v9 quad_perm:[0,1,0,1] row_mask:0xf bank_mask:0xf
    v_mfma_f32_16x16x16_bf16 v[36:39], v[60:61], v[28:29], 0
    ds_read_b128 v[44:47], v1 offset:3072
    v_exp_f32_dpp v40, v40 quad_perm:[0,1,0,1] row_mask:0xf bank_mask:0xf
    v_mfma_f32_16x16x16_bf16 v[16:19], v[50:51], v[28:29], 0
    v_exp_f32_dpp v41, v41 quad_perm:[0,1,0,1] row_mask:0xf bank_mask:0xf
    v_mfma_f32_16x16x16_bf16 v[52:55], v[50:51], v[30:31], 0
    v_exp_f32_dpp v20, v20 quad_perm:[0,1,0,1] row_mask:0xf bank_mask:0xf
    v_cvt_pk_bf16_f32 v12, v8, v9
    v_exp_f32_dpp v21, v21 quad_perm:[0,1,0,1] row_mask:0xf bank_mask:0xf
    v_cvt_pk_bf16_f32 v13, v40, v41
    v_exp_f32_dpp v24, v24 quad_perm:[0,1,0,1] row_mask:0xf bank_mask:0xf
    v_exp_f32_dpp v25, v25 quad_perm:[0,1,0,1] row_mask:0xf bank_mask:0xf
    v_cvt_pk_bf16_f32 v14, v20, v21
    v_cvt_pk_bf16_f32 v15, v24, v25
    s_waitcnt lgkmcnt(0)
    s_nop 0
    v_mfma_f32_16x16x32_bf16 v[36:39], v[60:63], v[12:15], v[36:39]
    ds_write_b64 v1, v[50:51] offset:2176
    v_mfma_f32_16x16x32_bf16 v[16:19], v[32:35], v[12:15], v[16:19]
    ds_read_b128 v[56:59], v1 offset:20480
    v_mfma_f32_16x16x32_bf16 v[52:55], v[44:47], v[12:15], v[52:55]
    ds_read_b128 v[60:63], v1 offset:21504
    v_rcp_f32 v10, v36
    v_mov_b64_e64 v[12:13], 0
    s_nop 0
    v_pk_mul_f32 v[16:17], v[16:17], v[10:11] op_sel_hi:[1,0]
    v_pk_mul_f32 v[18:19], v[18:19], v[10:11] op_sel_hi:[1,0]
    s_mov_b64 exec, s[86:87]
    s_nop 0
    v_pk_mul_f32 v[16:17], v[52:53], v[10:11] op_sel_hi:[1,0]
    v_pk_mul_f32 v[18:19], v[54:55], v[10:11] op_sel_hi:[1,0]
    s_mov_b64 exec, -1
    v_cvt_pk_bf16_f32 v16, v16, v17
    v_cvt_pk_bf16_f32 v17, v18, v19
    v_mfma_f32_16x16x16_bf16 v[20:23], v[12:13], v[12:13], 0
    ds_write_b64 v5, v[16:17]
    v_mfma_f32_16x16x16_bf16 v[24:27], v[12:13], v[12:13], 0
    ds_read_b128 v[40:43], v1 offset:22528
    v_mfma_f32_16x16x16_bf16 v[28:31], v[12:13], v[12:13], 0
    ds_read_b128 v[44:47], v1 offset:23552
    v_mfma_f32_16x16x16_bf16 v[48:51], v[12:13], v[12:13], 0
    ds_read_b128 v[32:35], v1 offset:24576
    s_waitcnt lgkmcnt(3)
    s_barrier
    v_mfma_f32_16x16x16_bf16 v[8:11], v[12:13], v[12:13], 0
    ds_read_b128 v[16:19], v0 offset:8192
    ds_read_b128 v[52:55], v0 offset:9216
    ds_read_b128 v[36:39], v1 offset:25600
    v_mfma_f32_16x16x16_bf16 v[28:31], v[12:13], v[12:13], 0
    v_lshlrev_b32 v15, 3, v0
    v_mfma_f32_16x16x16_bf16 v[48:51], v[12:13], v[12:13], 0
    v_bfe_u32 v14, v0, 2, 6
    v_and_or_b32 v14, v15, s94, v14
    s_waitcnt lgkmcnt(2)
    v_smfmac_f32_16x16x64_bf16 v[20:23], v[16:19], v[56:63], v2
    ds_read_b128 v[56:59], v1 offset:26624
    s_waitcnt lgkmcnt(2)
    v_smfmac_f32_16x16x64_bf16 v[20:23], v[52:55], v[40:47], v2
    s_waitcnt lgkmcnt(1)
    ds_read_b128 v[60:63], v1 offset:27648
    v_smfmac_f32_16x16x64_bf16 v[24:27], v[16:19], v[32:39], v2
    ds_read_b128 v[40:43], v1 offset:28672
    v_smfmac_f32_16x16x64_bf16 v[24:27], v[52:55], a[224:231], v2
    ds_read_b128 v[44:47], v1 offset:29696
    v_add_f32 v20, v20, v22
    v_smfmac_f32_16x16x64_bf16 v[28:31], v[16:19], a[232:239], v2
    ds_read_b128 v[32:35], v1 offset:30720
    v_add_f32 v21, v21, v23
    v_smfmac_f32_16x16x64_bf16 v[28:31], v[52:55], a[240:247], v2
    ds_read_b128 v[36:39], v1 offset:31744
    v_add_f32 v24, v24, v26
    v_smfmac_f32_16x16x64_bf16 v[48:51], v[16:19], a[248:255], v2
    s_waitcnt lgkmcnt(4)
    v_add_f32_e64 v25, v25, v27
    v_smfmac_f32_16x16x64_bf16 v[48:51], v[52:55], v[56:63], v2
    s_waitcnt lgkmcnt(2)
    v_cvt_pk_bf16_f32 v20, v20, v24
    v_smfmac_f32_16x16x64_bf16 v[8:11], v[16:19], v[40:47], v2
    s_waitcnt lgkmcnt(0)
    v_cvt_pk_bf16_f32 v21, v21, v25
    v_and_or_b32 v20, v20, -2, 0
    v_smfmac_f32_16x16x64_bf16 v[8:11], v[52:55], v[32:39], v2
    s_cmp_eq_u32 s21, 3
    buffer_store_dwordx2 v[20:21], v7, s[28:31], 0 offen
    v_pk_add_f32 v[28:29], v[28:29], v[30:31]
    v_pk_add_f32 v[48:49], v[48:49], v[50:51]
    v_cvt_pk_bf16_f32 v28, v28, v48
    v_cvt_pk_bf16_f32 v29, v29, v49
    v_and_or_b32 v28, v28, -2, 0
    s_nop 0
    v_pk_add_f32 v[8:9], v[8:9], v[10:11]
    v_cvt_pk_bf16_f32 v8, v8, v9
    v_and_or_b32 v8, v8, -2, 0
    buffer_store_dword v8, v14, s[28:31], s62 offen
    buffer_store_dwordx2 v[28:29], v7, s[28:31], s61 offen
    s_cbranch_scc1 CH_h_195
    v_lshrrev_b32 v56, s91, v0
    v_and_b32 v56, 16, v56
    v_lshlrev_b32_e64 v56, v56, s65
    v_cndmask_b32 v40, 0, v56, s[52:53]
    v_cndmask_b32 v41, 0, v56, s[54:55]
    v_cndmask_b32 v42, 0, v56, s[56:57]
    v_cndmask_b32 v43, 0, v56, s[58:59]
    v_mov_b64 v[58:59], -1
    s_mov_b32 s44, s43
    s_add_u32 s43, s43, 0x2000
    s_and_b32 s43, s43, 0x7fff
    s_add_u32 s43, s43, 163840
    s_mov_b32 s49, 0
    s_add_u32 s40, s40, 1
    s_add_u32 s90, s90, 32768
    s_mov_b32 s96, s97
    s_add_u32 s97, s97, 131072
    s_add_u32 s84, s40, s99
    s_sub_u32 s84, s84, 1
    s_cmp_lg_u32 s95, 0
    s_cbranch_scc1 CH_nt_199
    s_nop 9
    s_cmp_le_u32 s21, 0
    s_cbranch_scc1 CH_d_201
    s_nop 7
CH_d_201:
    buffer_load_dwordx4 v[32:35], v0, s[28:31], s46 offen offset:0 sc1
    buffer_load_dwordx4 v[36:39], v0, s[28:31], s46 offen offset:1024 sc1
    v_mov_b64 v[8:9], 0
    v_mov_b64 v[10:11], 0
    v_mov_b64 v[12:13], 0
    v_mov_b64 v[14:15], 0
    v_mov_b64 v[48:49], 0
    v_mov_b64 v[50:51], 0
    v_mov_b64 v[52:53], 0
    v_mov_b64_e64 v[54:55], 0
    s_cmp_eq_u32 s21, 2
    s_cselect_b32 s47, 1, 0
    s_nop 15
    s_nop 2
    buffer_load_dwordx4 v[24:27], v0, s[28:31], s46 offen offset:0 sc1
    buffer_load_dwordx4 v[28:31], v0, s[28:31], s46 offen offset:1024 sc1
CH_h_198:
    s_waitcnt vmcnt(3)
    v_mfma_f32_16x16x32_bf16 v[44:47], v[40:43], v[32:35], 0
    s_waitcnt vmcnt(2)
    v_mfma_f32_16x16x32_bf16 v[44:47], v[40:43], v[36:39], v[44:47]
    v_bitop3_b32 v56, v33, v35, v37 bitop3:0xfe
    v_bitop3_b32 v57, v32, v34, v36 bitop3:0xfe
    v_bitop3_b32 v56, v56, v39, s47 bitop3:0xa8
    v_bitop3_b32 v56, v56, v57, v38 bitop3:0xfe
    v_and_b32 v56, 1, v56
    v_cmp_ne_u32_e64 vcc, 0, v56
CH_ok_202:
    s_nop 0
    v_add_f32_dpp v44, v44, v44 row_ror:8 row_mask:0xf bank_mask:0xf
    v_add_f32_dpp v45, v45, v45 row_ror:8 row_mask:0xf bank_mask:0xf
    v_add_f32_dpp v46, v46, v46 row_ror:8 row_mask:0xf bank_mask:0xf
    v_add_f32_dpp v47, v47, v47 row_ror:8 row_mask:0xf bank_mask:0xf
    v_add_f32_dpp v44, v44, v44 row_ror:4 row_mask:0xf bank_mask:0xf
    v_add_f32_dpp v45, v45, v45 row_ror:4 row_mask:0xf bank_mask:0xf
    v_add_f32_dpp v46, v46, v46 row_ror:4 row_mask:0xf bank_mask:0xf
    v_add_f32_dpp v47, v47, v47 row_ror:4 row_mask:0xf bank_mask:0xf
    v_cvt_pk_bf16_f32 v56, v44, v45
    v_cvt_pk_bf16_f32 v57, v46, v47
    v_min_u32_e64 v56, -2, v56
    s_cbranch_vccnz CH_h_197
    buffer_store_dwordx2 v[56:57], v6, s[28:31], s43 offen
CH_x0_200:
    s_barrier
    buffer_store_dwordx2 v[56:57], v6, s[36:39], s50 offen sc1
    buffer_store_dwordx2 v[58:59], v6, s[28:31], s44 offen
    s_add_u32 s50, s50, 32768
    s_waitcnt vmcnt(3)
    v_mov_b64 v[16:17], 0
    v_mov_b64 v[18:19], 0
    v_mov_b64 v[20:21], 0
    v_mov_b64 v[22:23], 0
    s_nop 15
    s_nop 15
    s_nop 15
    s_nop 15
    s_nop 2
    s_branch CH_h_196
CH_h_195:
    v_mov_b64 v[48:49], 0
    v_mov_b64 v[50:51], 0
    v_mov_b64 v[52:53], 0
    v_mov_b64 v[54:55], 0
    s_mov_b32 s44, s43
    s_add_u32 s43, s43, 0x2000
    s_and_b32 s43, s43, 0x7fff
    s_add_u32 s43, s43, 163840
    s_mov_b32 s49, 0
    s_add_u32 s40, s40, 1
    s_add_u32 s90, s90, 32768
    s_mov_b32 s96, s97
    s_add_u32 s97, s97, 131072
    s_add_u32 s84, s40, s99
    s_sub_u32 s84, s84, 1
    s_add_u32 s47, s98, 0
    s_load_dword s72, s[32:33], s47 glc
    s_add_u32 s47, s98, 128
    s_load_dword s73, s[32:33], s47 glc
    s_add_u32 s47, s98, 256
    s_load_dword s74, s[32:33], s47 glc
    s_add_u32 s47, s98, 384
    s_load_dword s75, s[32:33], s47 glc
    v_mfma_f32_32x32x2_f32 v[8:23], v48, v48, 0
    v_mfma_f32_32x32x2_f32 v[8:23], v48, v48, v[8:23]
    v_mfma_f32_32x32x2_f32 v[8:23], v48, v48, v[8:23]
    v_mfma_f32_32x32x2_f32 v[8:23], v48, v48, v[8:23]
    v_mfma_f32_32x32x2_f32 v[8:23], v48, v48, v[8:23]
    v_mfma_f32_32x32x2_f32 v[8:23], v48, v48, v[8:23]
    s_waitcnt vmcnt(0)
    s_barrier
    s_nop 15
    s_nop 15
    s_nop 15
    s_nop 15
    s_nop 3
    s_add_u32 s47, s40, 2
    s_min_u32 s47, s47, 64
    s_add_u32 s47, s47, s99
    s_waitcnt lgkmcnt(0)
    s_min_u32 s72, s72, s73
    s_min_u32 s72, s72, s74
    s_min_u32 s72, s72, s75
    s_cmp_lt_u32 s72, s47
    s_cbranch_scc1 CH_fp_203
CH_fb_204:
CH_h_196:
    s_add_u32 s93, s43, s92
    buffer_load_dwordx4 v[24:27], v0, s[28:31], s93 offen sc1
    ds_read_b128 v[32:35], v1 offset:4096
    ds_read_b128 v[36:39], v1 offset:5120
    v_add_u32 v40, s92, v0
    v_xor_b32 v42, 1024, v40
    s_add_u32 s93, s43, 4096
    buffer_load_dwordx4 v[28:31], v0, s[28:31], s93 offen sc1
    s_nop 15
    s_nop 15
    s_nop 11
    s_add_u32 s93, s90, s92
    buffer_load_dwordx4 v[56:59], v0, s[36:39], s93 offen sc1
    s_nop 5
    s_add_u32 s93, s90, 4096
    buffer_load_dwordx4 v[60:63], v0, s[36:39], s93 offen sc1
    s_branch CH_top_175
CH_re_178:
    s_add_u32 s93, s43, s92
    buffer_load_dwordx4 v[24:27], v0, s[28:31], s93 offen sc1
    s_add_u32 s93, s43, 4096
    buffer_load_dwordx4 v[28:31], v0, s[28:31], s93 offen sc1
    s_add_u32 s49, s49, 1
    s_cmp_gt_u32 s49, 400000
    s_cbranch_scc1 L_end
    s_waitcnt vmcnt(0) lgkmcnt(0)
    v_max_u32 v41, v24, v26
    v_max3_u32 v41, v41, v28, v30
    v_cmp_eq_u32 vcc, -1, v41
    s_cbranch_vccnz CH_re_178
    ds_read_b128 v[32:35], v1 offset:4096
    ds_read_b128 v[36:39], v1 offset:5120
    v_mov_b64 v[8:9], 0
    v_mov_b64 v[10:11], 0
    v_mov_b64 v[12:13], 0
    v_mov_b64 v[14:15], 0
    v_mov_b64 v[16:17], 0
    v_mov_b64 v[18:19], 0
    v_mov_b64 v[20:21], 0
    v_mov_b64 v[22:23], 0
    v_mov_b64 v[48:49], 0
    v_mov_b64 v[50:51], 0
    v_mov_b64 v[52:53], 0
    v_mov_b64 v[54:55], 0
    s_waitcnt lgkmcnt(0)
    s_branch CH_st_177
CH_re_179:
    s_add_u32 s93, s90, s92
    buffer_load_dwordx4 v[56:59], v0, s[36:39], s93 offen sc1
    s_add_u32 s93, s90, 4096
    buffer_load_dwordx4 v[60:63], v0, s[36:39], s93 offen sc1
    s_add_u32 s49, s49, 1
    s_cmp_gt_u32 s49, 400000
    s_cbranch_scc1 L_end
    s_waitcnt vmcnt(0)
    v_max_u32 v29, v56, v58
    v_max3_u32 v29, v29, v60, v62
    v_cmp_eq_u32 vcc, -1, v29
    s_cbranch_vccnz CH_re_179
    ds_write_b128 v28, v[56:59] offset:4096
    s_waitcnt lgkmcnt(0)
    s_branch CH_re_180
CH_nt_185:
    v_mov_b64 v[8:9], 0
    v_mov_b64 v[10:11], 0
    v_mov_b64 v[12:13], 0
    v_mov_b64 v[14:15], 0
    v_mov_b64 v[16:17], 0
    v_mov_b64 v[18:19], 0
    v_mov_b64 v[20:21], 0
    v_mov_b64 v[22:23], 0
    v_mov_b64 v[48:49], 0
    v_mov_b64 v[50:51], 0
    v_mov_b64 v[52:53], 0
    v_mov_b64 v[54:55], 0
    s_waitcnt vmcnt(0)
    s_branch CH_x0_186
CH_h_183:
    buffer_load_dwordx4 v[32:35], v0, s[28:31], s46 offen offset:0 sc1
    buffer_load_dwordx4 v[36:39], v0, s[28:31], s46 offen offset:1024 sc1
    s_waitcnt vmcnt(3)
    v_mfma_f32_16x16x32_bf16 v[44:47], v[40:43], v[24:27], 0
    s_waitcnt vmcnt(2)
    v_mfma_f32_16x16x32_bf16 v[44:47], v[40:43], v[28:31], v[44:47]
    v_bitop3_b32 v56, v25, v27, v29 bitop3:0x80
    v_bitop3_b32 v57, v24, v26, v28 bitop3:0x80
    v_bitop3_b32 v56, v56, v31, s47 bitop3:0xea
    v_bitop3_b32 v56, v56, v57, v30 bitop3:0x80
    v_and_b32 v56, 1, v56
    v_cmp_ne_u32 vcc, 1, v56
    s_cbranch_vccz CH_ok_188
    buffer_load_dwordx4 v[24:27], v0, s[28:31], s46 offen offset:0 sc1
    buffer_load_dwordx4 v[28:31], v0, s[28:31], s46 offen offset:1024 sc1
    s_add_u32 s49, s49, 1
    s_cmp_gt_u32 s49, 400000
    s_cbranch_scc1 L_end
    s_branch CH_h_184
CH_fp_189:
    v_and_b32 v40, 0x180, v0
    buffer_load_dword v41, v40, s[32:35], s98 offen sc1
    s_add_u32 s49, s49, 1
    s_cmp_gt_u32 s49, 400000
    s_cbranch_scc1 L_end
    s_waitcnt vmcnt(0)
    v_cmp_gt_u32 vcc, s47, v41
    s_cbranch_vccnz CH_fp_189
    s_branch CH_fb_190
CH_re_192:
    s_add_u32 s93, s43, s92
    buffer_load_dwordx4 v[24:27], v0, s[28:31], s93 offen sc1
    s_add_u32 s93, s43, 4096
    buffer_load_dwordx4 v[28:31], v0, s[28:31], s93 offen sc1
    s_add_u32 s49, s49, 1
    s_cmp_gt_u32 s49, 400000
    s_cbranch_scc1 L_end
    s_waitcnt vmcnt(0) lgkmcnt(0)
    v_max_u32 v41, v24, v26
    v_max3_u32 v41, v41, v28, v30
    v_cmp_eq_u32 vcc, -1, v41
    s_cbranch_vccnz CH_re_192
    ds_read_b128 v[32:35], v1 offset:4096
    ds_read_b128 v[36:39], v1 offset:5120
    v_mov_b64 v[8:9], 0
    v_mov_b64 v[10:11], 0
    v_mov_b64 v[12:13], 0
    v_mov_b64 v[14:15], 0
    v_mov_b64 v[16:17], 0
    v_mov_b64 v[18:19], 0
    v_mov_b64 v[20:21], 0
    v_mov_b64 v[22:23], 0
    v_mov_b64 v[48:49], 0
    v_mov_b64 v[50:51], 0
    v_mov_b64 v[52:53], 0
    v_mov_b64 v[54:55], 0
    s_waitcnt lgkmcnt(0)
    s_branch CH_st_191
CH_re_193:
    s_add_u32 s93, s90, s92
    buffer_load_dwordx4 v[56:59], v0, s[36:39], s93 offen sc1
    s_add_u32 s93, s90, 4096
    buffer_load_dwordx4 v[60:63], v0, s[36:39], s93 offen sc1
    s_add_u32 s49, s49, 1
    s_cmp_gt_u32 s49, 400000
    s_cbranch_scc1 L_end
    s_waitcnt vmcnt(0)
    v_max_u32 v29, v56, v58
    v_max3_u32 v29, v29, v60, v62
    v_cmp_eq_u32 vcc, -1, v29
    s_cbranch_vccnz CH_re_193
    ds_write_b128 v28, v[56:59] offset:4096
    s_waitcnt lgkmcnt(0)
    s_branch CH_re_194
CH_nt_199:
    v_mov_b64 v[8:9], 0
    v_mov_b64 v[10:11], 0
    v_mov_b64 v[12:13], 0
    v_mov_b64 v[14:15], 0
    v_mov_b64 v[16:17], 0
    v_mov_b64 v[18:19], 0
    v_mov_b64 v[20:21], 0
    v_mov_b64 v[22:23], 0
    v_mov_b64 v[48:49], 0
    v_mov_b64 v[50:51], 0
    v_mov_b64 v[52:53], 0
    v_mov_b64 v[54:55], 0
    s_waitcnt vmcnt(0)
    s_branch CH_x0_200
CH_h_197:
    buffer_load_dwordx4 v[32:35], v0, s[28:31], s46 offen offset:0 sc1
    buffer_load_dwordx4 v[36:39], v0, s[28:31], s46 offen offset:1024 sc1
    s_waitcnt vmcnt(3)
    v_mfma_f32_16x16x32_bf16 v[44:47], v[40:43], v[24:27], 0
    s_waitcnt vmcnt(2)
    v_mfma_f32_16x16x32_bf16 v[44:47], v[40:43], v[28:31], v[44:47]
    v_bitop3_b32 v56, v25, v27, v29 bitop3:0xfe
    v_bitop3_b32 v57, v24, v26, v28 bitop3:0xfe
    v_bitop3_b32 v56, v56, v31, s47 bitop3:0xa8
    v_bitop3_b32 v56, v56, v57, v30 bitop3:0xfe
    v_and_b32 v56, 1, v56
    v_cmp_ne_u32 vcc, 0, v56
    s_cbranch_vccz CH_ok_202
    buffer_load_dwordx4 v[24:27], v0, s[28:31], s46 offen offset:0 sc1
    buffer_load_dwordx4 v[28:31], v0, s[28:31], s46 offen offset:1024 sc1
    s_add_u32 s49, s49, 1
    s_cmp_gt_u32 s49, 400000
    s_cbranch_scc1 L_end
    s_branch CH_h_198
CH_fp_203:
    v_and_b32 v40, 0x180, v0
    buffer_load_dword v41, v40, s[32:35], s98 offen sc1
    s_add_u32 s49, s49, 1
    s_cmp_gt_u32 s49, 400000
    s_cbranch_scc1 L_end
    s_waitcnt vmcnt(0)
    v_cmp_gt_u32 vcc, s47, v41
    s_cbranch_vccnz CH_fp_203
    s_branch CH_fb_204
CH_exit_176:
    s_branch CH_fin_160
CH_slow_159:
.p2align 6
CH_top_219:
CH_st_221:
    s_waitcnt vmcnt(3)
    v_smfmac_f32_16x16x64_bf16 v[8:11], v[24:27], v[64:71], v2
    ds_write_b128 v40, v[24:27] offset:0
    v_smfmac_f32_16x16x64_bf16 v[12:15], v[24:27], v[72:79], v2
    s_waitcnt lgkmcnt(1)
    v_max_u32_e64 v41, v24, v26
    v_smfmac_f32_16x16x64_bf16 v[16:19], v[24:27], v[32:39], v2
    v_smfmac_f32_16x16x64_bf16 v[20:23], v[24:27], v[80:87], v2
    ds_read_b128 v[32:35], v1 offset:6144
    v_smfmac_f32_16x16x64_bf16 v[48:51], v[24:27], v[88:95], v2
    ds_read_b128 v[36:39], v1 offset:7168
    s_waitcnt vmcnt(2)
    v_max3_u32 v41, v41, v28, v30
    v_smfmac_f32_16x16x64_bf16 v[52:55], v[24:27], v[96:103], v2
    v_cmp_eq_u32_e64 vcc, -1, v41
    v_smfmac_f32_16x16x64_bf16 v[8:11], v[28:31], v[104:111], v2
    v_smfmac_f32_16x16x64_bf16 v[12:15], v[28:31], v[112:119], v2
    s_cbranch_vccnz CH_re_222
    v_smfmac_f32_16x16x64_bf16 v[16:19], v[28:31], v[120:127], v2
    s_waitcnt lgkmcnt(2)
    s_barrier
    v_smfmac_f32_16x16x64_bf16 v[20:23], v[28:31], v[128:135], v2
    s_waitcnt lgkmcnt(0)
    ds_read_b128 v[24:27], v42 offset:0
    v_smfmac_f32_16x16x64_bf16 v[48:51], v[28:31], v[32:39], v2
    ds_read_b128 v[40:43], v1 offset:8192
    v_smfmac_f32_16x16x64_bf16 v[52:55], v[28:31], v[136:143], v2
    ds_read_b128 v[44:47], v1 offset:9216
    v_add_u32_e64 v28, s14, v0
    s_waitcnt lgkmcnt(2)
    v_smfmac_f32_16x16x64_bf16 v[8:11], v[24:27], v[144:151], v2
    ds_read_b128 v[28:31], v28 offset:0
    v_smfmac_f32_16x16x64_bf16 v[12:15], v[24:27], v[152:159], v2
    ds_read_b128 v[32:35], v1 offset:10240
    v_smfmac_f32_16x16x64_bf16 v[16:19], v[24:27], v[160:167], v2
    s_waitcnt lgkmcnt(2)
    ds_read_b128 v[36:39], v1 offset:11264
    v_smfmac_f32_16x16x64_bf16 v[20:23], v[24:27], v[40:47], v2
    ds_read_b128 v[40:43], v1 offset:12288
    v_smfmac_f32_16x16x64_bf16 v[48:51], v[24:27], v[168:175], v2
    ds_read_b128 v[44:47], v1 offset:13312
    v_smfmac_f32_16x16x64_bf16 v[52:55], v[24:27], v[176:183], v2
    s_waitcnt lgkmcnt(4)
    v_add_u32 v24, s15, v0
    v_smfmac_f32_16x16x64_bf16 v[8:11], v[28:31], v[184:191], v2
    s_waitcnt lgkmcnt(2)
    ds_read_b128 v[24:27], v24 offset:0
    v_smfmac_f32_16x16x64_bf16 v[12:15], v[28:31], v[32:39], v2
    ds_read_b128 v[32:35], v1 offset:14336
    v_smfmac_f32_16x16x64_bf16 v[16:19], v[28:31], v[192:199], v2
    s_waitcnt lgkmcnt(2)
    ds_read_b128 v[36:39], v1 offset:15360
    v_smfmac_f32_16x16x64_bf16 v[20:23], v[28:31], v[40:47], v2
    ds_read_b128 v[40:43], v1 offset:16384
    v_smfmac_f32_16x16x64_bf16 v[48:51], v[28:31], v[200:207], v2
    ds_read_b128 v[44:47], v1 offset:17408
    v_smfmac_f32_16x16x64_bf16 v[52:55], v[28:31], v[208:215], v2
    s_waitcnt lgkmcnt(4)
    v_cndmask_b32 v30, v3, v1, s[82:83]
    v_smfmac_f32_16x16x64_bf16 v[8:11], v[24:27], v[216:223], v2
    ds_read_b64 v[30:31], v30 offset:2176
    v_add_u32 v28, s92, v0
    v_smfmac_f32_16x16x64_bf16 v[12:15], v[24:27], v[224:231], v2
    s_waitcnt vmcnt(1)
    ds_write_b128 v28, v[56:59] offset:4096
    v_max_u32 v29, v56, v58
    v_smfmac_f32_16x16x64_bf16 v[16:19], v[24:27], v[232:239], v2
    s_waitcnt vmcnt(0)
    v_max3_u32 v29, v29, v60, v62
    v_smfmac_f32_16x16x64_bf16 v[20:23], v[24:27], v[240:247], v2
    s_add_u32 m0, s63, 8192
    s_add_u32 s60, s42, 16384
    v_cmp_eq_u32_e64 vcc, -1, v29
    v_smfmac_f32_16x16x64_bf16 v[48:51], v[24:27], v[248:255], v2
    s_waitcnt lgkmcnt(1)
    v_permlane16_swap_b32 v30, v31
    v_smfmac_f32_16x16x64_bf16 v[52:55], v[24:27], a[0:7], v2
    s_cbranch_vccnz CH_re_223
CH_re_224:
    v_lshrrev_b32 v29, 1, v0
    v_smfmac_f32_16x16x64_bf16 v[8:11], v[56:59], a[8:15], v2
    s_waitcnt lgkmcnt(0)
    s_barrier
    v_smfmac_f32_16x16x64_bf16 v[12:15], v[56:59], a[16:23], v2
    buffer_store_dwordx2 v[30:31], v29, s[32:35], s96 offen sc1
    v_mov_b32 v24, s84
    v_smfmac_f32_16x16x64_bf16 v[16:19], v[56:59], a[24:31], v2
    buffer_store_dword v24, off, s[32:35], s18 sc1
    v_add_u32 v28, s13, v0
    v_smfmac_f32_16x16x64_bf16 v[20:23], v[56:59], a[32:39], v2
    ds_read_b128 v[28:31], v28 offset:4096
    v_add_u32_e64 v24, s14, v0
    v_smfmac_f32_16x16x64_bf16 v[8:11], v[60:63], a[40:47], v2
    ds_read_b128 v[24:27], v24 offset:4096
    v_smfmac_f32_16x16x64_bf16 v[12:15], v[60:63], v[32:39], v2
    buffer_load_dwordx4 v0, s[32:35], s42 offen offset:0 sc1 lds
    v_smfmac_f32_16x16x64_bf16 v[16:19], v[60:63], a[48:55], v2
    v_add_u32_e64 v32, s15, v0
    v_smfmac_f32_16x16x64_bf16 v[20:23], v[60:63], a[56:63], v2
    s_waitcnt lgkmcnt(1)
    ds_read_b128 v[32:35], v32 offset:4096
    v_smfmac_f32_16x16x64_bf16 v[8:11], v[28:31], v[40:47], v2
    ds_read_b128 v[40:43], v1 offset:18432
    v_smfmac_f32_16x16x64_bf16 v[12:15], v[28:31], a[64:71], v2
    s_waitcnt lgkmcnt(2)
    ds_read_b128 v[44:47], v1 offset:19456
    v_smfmac_f32_16x16x64_bf16 v[8:11], v[24:27], a[72:79], v2
    buffer_load_dwordx4 v0, s[32:35], s42 offen offset:1024 sc1 lds
    v_smfmac_f32_16x16x64_bf16 v[12:15], v[24:27], a[80:87], v2
    s_waitcnt lgkmcnt(2)
    v_smfmac_f32_16x16x64_bf16 v[8:11], v[32:35], a[88:95], v2
    s_add_u32 m0, s64, 2048
    s_add_u32 s42, s42, 1048576
    s_xor_b32 s42, s42, 8192
    v_smfmac_f32_16x16x64_bf16 v[12:15], v[32:35], a[96:103], v2
    buffer_load_dwordx4 v0, s[32:35], s60 offen offset:0 sc1 lds
    v_smfmac_f32_16x16x64_bf16 v[16:19], v[28:31], a[104:111], v2
    s_waitcnt lgkmcnt(0)
    v_add_f32_e64 v8, v8, v10
    v_smfmac_f32_16x16x64_bf16 v[16:19], v[24:27], v[40:47], v2
    ds_read_b128 v[40:43], v0 offset:16384
    v_add_f32 v9, v9, v11
    v_smfmac_f32_16x16x64_bf16 v[16:19], v[32:35], a[112:119], v2
    ds_read_b128 v[44:47], v0 offset:17408
    v_add_f32 v12, v12, v14
    v_smfmac_f32_16x16x64_bf16 v[20:23], v[28:31], a[120:127], v2
    buffer_load_dwordx4 v0, s[32:35], s60 offen offset:1024 sc1 lds
    v_add_f32_e64 v13, v13, v15
    v_smfmac_f32_16x16x64_bf16 v[20:23], v[24:27], a[128:135], v2
    v_cvt_pk_bf16_f32 v8, v8, v9
    v_cvt_pk_bf16_f32 v9, v12, v13
    v_smfmac_f32_16x16x64_bf16 v[20:23], v[32:35], a[136:143], v2
    ds_write_b64 v3, v[8:9] offset:2176
    v_add_f32 v16, v16, v18
    v_add_f32 v17, v17, v19
    v_smfmac_f32_16x16x64_bf16 v[48:51], v[56:59], a[144:151], v2
    v_cvt_pk_bf16_f32 v10, v16, v17
    v_add_f32 v20, v20, v22
    v_add_f32 v21, v21, v23
    v_cvt_pk_bf16_f32 v11, v20, v21
    v_smfmac_f32_16x16x64_bf16 v[52:55], v[56:59], a[152:159], v2
    ds_write_b64 v3, v[10:11] offset:0
    v_smfmac_f32_16x16x64_bf16 v[48:51], v[60:63], a[160:167], v2
    ds_read_b128 v[56:59], v0 offset:18432
    v_smfmac_f32_16x16x64_bf16 v[52:55], v[60:63], a[168:175], v2
    ds_read_b128 v[60:63], v0 offset:19456
    v_smfmac_f32_16x16x64_bf16 v[48:51], v[28:31], a[176:183], v2
    s_waitcnt lgkmcnt(2)
    s_barrier
    v_smfmac_f32_16x16x64_bf16 v[52:55], v[28:31], a[184:191], v2
    ds_read_b64_tr_b16 v[12:13], v4 offset:2176
    ds_read_b64_tr_b16 v[14:15], v4 offset:2208
    v_smfmac_f32_16x16x64_bf16 v[48:51], v[24:27], a[192:199], v2
    ds_read_b64_tr_b16 v[16:17], v4 offset:3264
    ds_read_b64_tr_b16 v[18:19], v4 offset:3296
    v_smfmac_f32_16x16x64_bf16 v[52:55], v[24:27], a[200:207], v2
    ds_read_b64_tr_b16 v[20:21], v4 offset:0
    ds_read_b64_tr_b16 v[22:23], v4 offset:32
    v_smfmac_f32_16x16x64_bf16 v[48:51], v[32:35], a[208:215], v2
    ds_read_b64_tr_b16 v[36:37], v4 offset:1088
    ds_read_b64_tr_b16 v[38:39], v4 offset:1120
    v_smfmac_f32_16x16x64_bf16 v[52:55], v[32:35], a[216:223], v2
    ds_read_b128 v[28:31], v0 offset:21504
    ds_read_b128 v[24:27], v0 offset:20480
    s_waitcnt lgkmcnt(8)
    v_mfma_f32_16x16x32_bf16 v[8:11], v[40:43], v[12:15], 0
    ds_read_b128 v[32:35], v0 offset:22528
    s_waitcnt lgkmcnt(7)
    v_mfma_f32_16x16x32_bf16 v[8:11], v[44:47], v[16:19], v[8:11]
    ds_read_b128 v[44:47], v0 offset:23552
    v_add_f32 v48, v48, v50
    v_mfma_f32_16x16x32_bf16 v[40:43], v[56:59], v[12:15], 0
    v_add_f32 v49, v49, v51
    v_mfma_f32_16x16x32_bf16 v[40:43], v[60:63], v[16:19], v[40:43]
    s_waitcnt lgkmcnt(6)
    v_add_f32_e64 v52, v52, v54
    v_add_f32_dpp v8, v10, v8 quad_perm:[2,3,2,3] row_mask:0xf bank_mask:0xf
    v_mfma_f32_16x16x32_bf16 v[56:59], v[20:23], v[12:15], 0
    s_waitcnt lgkmcnt(4)
    v_add_f32_dpp v9, v11, v9 quad_perm:[2,3,2,3] row_mask:0xf bank_mask:0xf
    v_max_f32 v10, v8, v9
    v_mfma_f32_16x16x32_bf16 v[56:59], v[36:39], v[16:19], v[56:59]
    s_waitcnt lgkmcnt(2)
    v_add_f32_e64 v53, v53, v55
    v_add_f32_dpp v40, v42, v40 quad_perm:[2,3,2,3] row_mask:0xf bank_mask:0xf
    v_mfma_f32_16x16x32_bf16 v[20:23], v[24:27], v[12:15], 0
    v_add_f32_dpp v41, v43, v41 quad_perm:[2,3,2,3] row_mask:0xf bank_mask:0xf
    v_max3_f32 v10, v10, v40, v41
    v_mfma_f32_16x16x32_bf16 v[20:23], v[28:31], v[16:19], v[20:23]
    s_waitcnt lgkmcnt(1)
    v_cvt_pk_bf16_f32 v50, v48, v49
    v_add_f32_dpp v56, v58, v56 quad_perm:[2,3,2,3] row_mask:0xf bank_mask:0xf
    v_mfma_f32_16x16x32_bf16 v[24:27], v[32:35], v[12:15], 0
    s_waitcnt lgkmcnt(0)
    v_add_f32_dpp v57, v59, v57 quad_perm:[2,3,2,3] row_mask:0xf bank_mask:0xf
    v_max3_f32 v10, v10, v56, v57
    v_mfma_f32_16x16x32_bf16 v[24:27], v[44:47], v[16:19], v[24:27]
    ds_read_b128 v[32:35], v1 offset:0
    v_add_f32_dpp v20, v22, v20 quad_perm:[2,3,2,3] row_mask:0xf bank_mask:0xf
    v_add_f32_dpp v21, v23, v21 quad_perm:[2,3,2,3] row_mask:0xf bank_mask:0xf
    v_max3_f32 v10, v10, v20, v21
    v_cvt_pk_bf16_f32 v51, v52, v53
    v_mov_b64 v[60:61], s[22:23]
    v_mov_b64_e64 v[62:63], s[22:23]
    s_nop 0
    v_add_f32_dpp v24, v26, v24 quad_perm:[2,3,2,3] row_mask:0xf bank_mask:0xf
    v_add_f32_dpp v25, v27, v25 quad_perm:[2,3,2,3] row_mask:0xf bank_mask:0xf
    v_max3_f32 v10, v10, v24, v25
    v_mov_b32 v11, v10
    v_mov_b32 v29, 0
    v_mov_b32 v30, 0
    v_permlane32_swap_b32 v10, v11
    v_max_f32 v10, v10, v11
    v_mov_b32 v11, v10
    s_nop 1
    v_permlane16_swap_b32 v10, v11
    v_max_f32 v10, v10, v11
    v_mul_f32 v10, s51, v10
    v_pk_fma_f32 v[56:57], v[56:57], s[16:17], v[10:11] op_sel_hi:[1,1,0] neg_lo:[0,0,1] neg_hi:[0,0,1]
    v_pk_fma_f32 v[8:9], v[8:9], s[16:17], v[10:11] op_sel_hi:[1,1,0] neg_lo:[0,0,1] neg_hi:[0,0,1]
    v_pk_fma_f32 v[40:41], v[40:41], s[16:17], v[10:11] op_sel_hi:[1,1,0] neg_lo:[0,0,1] neg_hi:[0,0,1]
    v_pk_fma_f32 v[20:21], v[20:21], s[16:17], v[10:11] op_sel_hi:[1,1,0] neg_lo:[0,0,1] neg_hi:[0,0,1]
    v_pk_fma_f32 v[24:25], v[24:25], s[16:17], v[10:11] op_sel_hi:[1,1,0] neg_lo:[0,0,1] neg_hi:[0,0,1]
    v_exp_f32_dpp v56, v56 quad_perm:[0,1,0,1] row_mask:0xf bank_mask:0xf
    v_exp_f32_dpp v57, v57 quad_perm:[0,1,0,1] row_mask:0xf bank_mask:0xf
    v_exp_f32_dpp v8, v8 quad_perm:[0,1,0,1] row_mask:0xf bank_mask:0xf
    v_cvt_pk_bf16_f32 v28, v56, v57
    v_cvt_pk_bf16_f32 v31, v56, v57
    v_exp_f32_dpp v9, v9 quad_perm:[0,1,0,1] row_mask:0xf bank_mask:0xf
    v_mfma_f32_16x16x16_bf16 v[36:39], v[60:61], v[28:29], 0
    ds_read_b128 v[44:47], v1 offset:1024
    v_exp_f32_dpp v40, v40 quad_perm:[0,1,0,1] row_mask:0xf bank_mask:0xf
    v_mfma_f32_16x16x16_bf16 v[16:19], v[50:51], v[28:29], 0
    v_exp_f32_dpp v41, v41 quad_perm:[0,1,0,1] row_mask:0xf bank_mask:0xf
    v_mfma_f32_16x16x16_bf16 v[52:55], v[50:51], v[30:31], 0
    v_exp_f32_dpp v20, v20 quad_perm:[0,1,0,1] row_mask:0xf bank_mask:0xf
    v_cvt_pk_bf16_f32 v12, v8, v9
    v_exp_f32_dpp v21, v21 quad_perm:[0,1,0,1] row_mask:0xf bank_mask:0xf
    v_cvt_pk_bf16_f32 v13, v40, v41
    v_exp_f32_dpp v24, v24 quad_perm:[0,1,0,1] row_mask:0xf bank_mask:0xf
    v_exp_f32_dpp v25, v25 quad_perm:[0,1,0,1] row_mask:0xf bank_mask:0xf
    v_cvt_pk_bf16_f32 v14, v20, v21
    v_cvt_pk_bf16_f32 v15, v24, v25
    s_waitcnt lgkmcnt(0)
    s_nop 0
    v_mfma_f32_16x16x32_bf16 v[36:39], v[60:63], v[12:15], v[36:39]
    ds_write_b64 v1, v[50:51] offset:0
    v_mfma_f32_16x16x32_bf16 v[16:19], v[32:35], v[12:15], v[16:19]
    ds_read_b128 v[56:59], v1 offset:20480
    v_mfma_f32_16x16x32_bf16 v[52:55], v[44:47], v[12:15], v[52:55]
    ds_read_b128 v[60:63], v1 offset:21504
    v_rcp_f32 v10, v36
    v_mov_b64 v[12:13], 0
    s_nop 0
    v_pk_mul_f32 v[16:17], v[16:17], v[10:11] op_sel_hi:[1,0]
    v_pk_mul_f32 v[18:19], v[18:19], v[10:11] op_sel_hi:[1,0]
    s_mov_b64 exec, s[86:87]
    s_nop 0
    v_pk_mul_f32 v[16:17], v[52:53], v[10:11] op_sel_hi:[1,0]
    v_pk_mul_f32 v[18:19], v[54:55], v[10:11] op_sel_hi:[1,0]
    s_mov_b64 exec, -1
    v_cvt_pk_bf16_f32 v16, v16, v17
    v_cvt_pk_bf16_f32 v17, v18, v19
    v_mfma_f32_16x16x16_bf16 v[20:23], v[12:13], v[12:13], 0
    ds_write_b64 v5, v[16:17]
    v_mfma_f32_16x16x16_bf16 v[24:27], v[12:13], v[12:13], 0
    ds_read_b128 v[40:43], v1 offset:22528
    v_mfma_f32_16x16x16_bf16 v[28:31], v[12:13], v[12:13], 0
    ds_read_b128 v[44:47], v1 offset:23552
    v_mfma_f32_16x16x16_bf16 v[48:51], v[12:13], v[12:13], 0
    ds_read_b128 v[32:35], v1 offset:24576
    s_waitcnt lgkmcnt(3)
    s_barrier
    v_mfma_f32_16x16x16_bf16 v[8:11], v[12:13], v[12:13], 0
    ds_read_b128 v[16:19], v0 offset:8192
    ds_read_b128 v[52:55], v0 offset:9216
    ds_read_b128 v[36:39], v1 offset:25600
    v_mfma_f32_16x16x16_bf16 v[28:31], v[12:13], v[12:13], 0
    v_lshlrev_b32_e64 v15, 3, v0
    v_mfma_f32_16x16x16_bf16 v[48:51], v[12:13], v[12:13], 0
    v_bfe_u32 v14, v0, 2, 6
    v_and_or_b32 v14, v15, s94, v14
    s_waitcnt lgkmcnt(2)
    v_smfmac_f32_16x16x64_bf16 v[20:23], v[16:19], v[56:63], v2
    ds_read_b128 v[56:59], v1 offset:26624
    s_waitcnt lgkmcnt(2)
    v_smfmac_f32_16x16x64_bf16 v[20:23], v[52:55], v[40:47], v2
    s_waitcnt lgkmcnt(1)
    ds_read_b128 v[60:63], v1 offset:27648
    v_smfmac_f32_16x16x64_bf16 v[24:27], v[16:19], v[32:39], v2
    ds_read_b128 v[40:43], v1 offset:28672
    v_smfmac_f32_16x16x64_bf16 v[24:27], v[52:55], a[224:231], v2
    ds_read_b128 v[44:47], v1 offset:29696
    v_add_f32 v20, v20, v22
    v_smfmac_f32_16x16x64_bf16 v[28:31], v[16:19], a[232:239], v2
    ds_read_b128 v[32:35], v1 offset:30720
    v_add_f32_e64 v21, v21, v23
    v_smfmac_f32_16x16x64_bf16 v[28:31], v[52:55], a[240:247], v2
    ds_read_b128 v[36:39], v1 offset:31744
    v_add_f32 v24, v24, v26
    v_smfmac_f32_16x16x64_bf16 v[48:51], v[16:19], a[248:255], v2
    s_waitcnt lgkmcnt(4)
    v_add_f32_e64 v25, v25, v27
    v_smfmac_f32_16x16x64_bf16 v[48:51], v[52:55], v[56:63], v2
    s_waitcnt lgkmcnt(2)
    v_cvt_pk_bf16_f32 v20, v20, v24
    v_smfmac_f32_16x16x64_bf16 v[8:11], v[16:19], v[40:47], v2
    s_waitcnt lgkmcnt(0)
    v_cvt_pk_bf16_f32 v21, v21, v25
    v_and_or_b32 v20, v20, -2, 1
    v_smfmac_f32_16x16x64_bf16 v[8:11], v[52:55], v[32:39], v2
    s_cmp_eq_u32 s21, 3
    buffer_store_dwordx2 v[20:21], v7, s[28:31], 0 offen sc1
    v_pk_add_f32 v[28:29], v[28:29], v[30:31]
    v_pk_add_f32 v[48:49], v[48:49], v[50:51]
    v_cvt_pk_bf16_f32 v28, v28, v48
    v_cvt_pk_bf16_f32 v29, v29, v49
    v_and_or_b32 v28, v28, -2, 1
    s_nop 0
    v_pk_add_f32 v[8:9], v[8:9], v[10:11]
    v_cvt_pk_bf16_f32 v8, v8, v9
    v_and_or_b32 v8, v8, -2, 1
    buffer_store_dword v8, v14, s[28:31], s62 offen sc1
    buffer_store_dwordx2 v[28:29], v7, s[28:31], s61 offen sc1
    s_cbranch_scc1 CH_h_225
    v_lshrrev_b32 v56, s91, v0
    v_and_b32_e64 v56, 16, v56
    v_lshlrev_b32_e64 v56, v56, s65
    v_cndmask_b32 v40, 0, v56, s[52:53]
    v_cndmask_b32 v41, 0, v56, s[54:55]
    v_cndmask_b32 v42, 0, v56, s[56:57]
    v_cndmask_b32 v43, 0, v56, s[58:59]
    v_mov_b64 v[58:59], -1
    s_mov_b32 s44, s43
    s_add_u32 s43, s43, 0x2000
    s_and_b32 s43, s43, 0x7fff
    s_add_u32 s43, s43, 163840
    s_mov_b32 s49, 0
    s_add_u32 s40, s40, 1
    s_add_u32 s90, s90, 32768
    s_mov_b32 s96, s97
    s_add_u32 s97, s97, 131072
    s_add_u32 s84, s40, s99
    s_sub_u32 s84, s84, 1
    s_cmp_eq_u32 s40, 63
    s_cselect_b32 s42, 1073741824, s42
    s_cmp_lg_u32 s95, 0
    s_cbranch_scc1 CH_nt_229
    s_nop 9
    s_cmp_le_u32 s21, 0
    s_cbranch_scc1 CH_d_231
    s_nop 7
CH_d_231:
    buffer_load_dwordx4 v[32:35], v0, s[28:31], s46 offen offset:0 sc1
    buffer_load_dwordx4 v[36:39], v0, s[28:31], s46 offen offset:1024 sc1
    v_mov_b64 v[8:9], 0
    v_mov_b64 v[10:11], 0
    v_mov_b64 v[12:13], 0
    v_mov_b64 v[14:15], 0
    v_mov_b64 v[48:49], 0
    v_mov_b64 v[50:51], 0
    v_mov_b64 v[52:53], 0
    v_mov_b64_e64 v[54:55], 0
    s_cmp_eq_u32 s21, 2
    s_cselect_b32 s47, 0, 1
    s_nop 15
    s_nop 2
    buffer_load_dwordx4 v[24:27], v0, s[28:31], s46 offen offset:0 sc1
    buffer_load_dwordx4 v[28:31], v0, s[28:31], s46 offen offset:1024 sc1
CH_h_228:
    s_waitcnt vmcnt(3)
    v_mfma_f32_16x16x32_bf16 v[44:47], v[40:43], v[32:35], 0
    s_waitcnt vmcnt(2)
    v_mfma_f32_16x16x32_bf16 v[44:47], v[40:43], v[36:39], v[44:47]
    v_bitop3_b32 v56, v33, v35, v37 bitop3:0x80
    v_bitop3_b32 v57, v32, v34, v36 bitop3:0x80
    v_bitop3_b32 v56, v56, v39, s47 bitop3:0xea
    v_bitop3_b32 v56, v56, v57, v38 bitop3:0x80
    v_and_b32 v56, 1, v56
    v_cmp_ne_u32_e64 vcc, 1, v56
CH_ok_232:
    s_nop 0
    v_add_f32_dpp v44, v44, v44 row_ror:8 row_mask:0xf bank_mask:0xf
    v_add_f32_dpp v45, v45, v45 row_ror:8 row_mask:0xf bank_mask:0xf
    v_add_f32_dpp v46, v46, v46 row_ror:8 row_mask:0xf bank_mask:0xf
    v_add_f32_dpp v47, v47, v47 row_ror:8 row_mask:0xf bank_mask:0xf
    v_add_f32_dpp v44, v44, v44 row_ror:4 row_mask:0xf bank_mask:0xf
    v_add_f32_dpp v45, v45, v45 row_ror:4 row_mask:0xf bank_mask:0xf
    v_add_f32_dpp v46, v46, v46 row_ror:4 row_mask:0xf bank_mask:0xf
    v_add_f32_dpp v47, v47, v47 row_ror:4 row_mask:0xf bank_mask:0xf
    v_cvt_pk_bf16_f32 v56, v44, v45
    v_cvt_pk_bf16_f32 v57, v46, v47
    v_min_u32_e64 v56, -2, v56
    s_cbranch_vccnz CH_h_227
    buffer_store_dwordx2 v[56:57], v6, s[28:31], s43 offen sc1
CH_x0_230:
    s_barrier
    buffer_store_dwordx2 v[56:57], v6, s[36:39], s50 offen sc1
    buffer_store_dwordx2 v[58:59], v6, s[28:31], s44 offen sc1
    s_add_u32 s50, s50, 32768
    s_waitcnt vmcnt(3)
    v_mov_b64 v[16:17], 0
    v_mov_b64 v[18:19], 0
    v_mov_b64 v[20:21], 0
    v_mov_b64 v[22:23], 0
    s_nop 15
    s_nop 15
    s_nop 15
    s_nop 15
    s_nop 2
    s_branch CH_h_226
CH_h_225:
    v_mov_b64 v[48:49], 0
    v_mov_b64 v[50:51], 0
    v_mov_b64 v[52:53], 0
    v_mov_b64 v[54:55], 0
    s_mov_b32 s44, s43
    s_add_u32 s43, s43, 0x2000
    s_and_b32 s43, s43, 0x7fff
    s_add_u32 s43, s43, 163840
    s_mov_b32 s49, 0
    s_add_u32 s40, s40, 1
    s_add_u32 s90, s90, 32768
    s_mov_b32 s96, s97
    s_add_u32 s97, s97, 131072
    s_add_u32 s84, s40, s99
    s_sub_u32 s84, s84, 1
    s_cmp_eq_u32 s40, 63
    s_cselect_b32 s42, 1073741824, s42
    s_add_u32 s47, s98, 0
    s_load_dword s72, s[32:33], s47 glc
    s_add_u32 s47, s98, 128
    s_load_dword s73, s[32:33], s47 glc
    s_add_u32 s47, s98, 256
    s_load_dword s74, s[32:33], s47 glc
    s_add_u32 s47, s98, 384
    s_load_dword s75, s[32:33], s47 glc
    v_mfma_f32_32x32x2_f32 v[8:23], v48, v48, 0
    v_mfma_f32_32x32x2_f32 v[8:23], v48, v48, v[8:23]
    v_mfma_f32_32x32x2_f32 v[8:23], v48, v48, v[8:23]
    v_mfma_f32_32x32x2_f32 v[8:23], v48, v48, v[8:23]
    v_mfma_f32_32x32x2_f32 v[8:23], v48, v48, v[8:23]
    v_mfma_f32_32x32x2_f32 v[8:23], v48, v48, v[8:23]
    s_waitcnt vmcnt(0)
    s_barrier
    s_nop 15
    s_nop 15
    s_nop 15
    s_nop 15
    s_nop 3
    s_add_u32 s47, s40, 2
    s_min_u32 s47, s47, 64
    s_add_u32 s47, s47, s99
    s_waitcnt lgkmcnt(0)
    s_min_u32 s72, s72, s73
    s_min_u32 s72, s72, s74
    s_min_u32 s72, s72, s75
    s_cmp_lt_u32 s72, s47
    s_cbranch_scc1 CH_fp_233
CH_fb_234:
CH_h_226:
    s_add_u32 s93, s43, s92
    buffer_load_dwordx4 v[24:27], v0, s[28:31], s93 offen sc1
    ds_read_b128 v[32:35], v1 offset:4096
    ds_read_b128 v[36:39], v1 offset:5120
    v_add_u32 v40, s92, v0
    v_xor_b32 v42, 1024, v40
    s_add_u32 s93, s43, 4096
    buffer_load_dwordx4 v[28:31], v0, s[28:31], s93 offen sc1
    s_nop 15
    s_nop 15
    s_nop 11
    s_add_u32 s93, s90, s92
    buffer_load_dwordx4 v[56:59], v0, s[36:39], s93 offen sc1
    s_nop 5
    s_add_u32 s93, s90, 4096
    buffer_load_dwordx4 v[60:63], v0, s[36:39], s93 offen sc1
CH_st_235:
    s_waitcnt vmcnt(3)
    v_smfmac_f32_16x16x64_bf16 v[8:11], v[24:27], v[64:71], v2
    ds_write_b128 v40, v[24:27] offset:0
    v_smfmac_f32_16x16x64_bf16 v[12:15], v[24:27], v[72:79], v2
    s_waitcnt lgkmcnt(1)
    v_max_u32 v41, v24, v26
    v_smfmac_f32_16x16x64_bf16 v[16:19], v[24:27], v[32:39], v2
    v_smfmac_f32_16x16x64_bf16 v[20:23], v[24:27], v[80:87], v2
    ds_read_b128 v[32:35], v1 offset:6144
    v_smfmac_f32_16x16x64_bf16 v[48:51], v[24:27], v[88:95], v2
    ds_read_b128 v[36:39], v1 offset:7168
    s_waitcnt vmcnt(2)
    v_max3_u32 v41, v41, v28, v30
    v_smfmac_f32_16x16x64_bf16 v[52:55], v[24:27], v[96:103], v2
    v_cmp_eq_u32_e64 vcc, -1, v41
    v_smfmac_f32_16x16x64_bf16 v[8:11], v[28:31], v[104:111], v2
    v_smfmac_f32_16x16x64_bf16 v[12:15], v[28:31], v[112:119], v2
    s_cbranch_vccnz CH_re_236
    v_smfmac_f32_16x16x64_bf16 v[16:19], v[28:31], v[120:127], v2
    s_waitcnt lgkmcnt(2)
    s_barrier
    v_smfmac_f32_16x16x64_bf16 v[20:23], v[28:31], v[128:135], v2
    s_waitcnt lgkmcnt(0)
    ds_read_b128 v[24:27], v42 offset:0
    v_smfmac_f32_16x16x64_bf16 v[48:51], v[28:31], v[32:39], v2
    ds_read_b128 v[40:43], v1 offset:8192
    v_smfmac_f32_16x16x64_bf16 v[52:55], v[28:31], v[136:143], v2
    ds_read_b128 v[44:47], v1 offset:9216
    v_add_u32_e64 v28, s14, v0
    s_waitcnt lgkmcnt(2)
    v_smfmac_f32_16x16x64_bf16 v[8:11], v[24:27], v[144:151], v2
    ds_read_b128 v[28:31], v28 offset:0
    v_smfmac_f32_16x16x64_bf16 v[12:15], v[24:27], v[152:159], v2
    ds_read_b128 v[32:35], v1 offset:10240
    v_smfmac_f32_16x16x64_bf16 v[16:19], v[24:27], v[160:167], v2
    s_waitcnt lgkmcnt(2)
    ds_read_b128 v[36:39], v1 offset:11264
    v_smfmac_f32_16x16x64_bf16 v[20:23], v[24:27], v[40:47], v2
    ds_read_b128 v[40:43], v1 offset:12288
    v_smfmac_f32_16x16x64_bf16 v[48:51], v[24:27], v[168:175], v2
    ds_read_b128 v[44:47], v1 offset:13312
    v_smfmac_f32_16x16x64_bf16 v[52:55], v[24:27], v[176:183], v2
    s_waitcnt lgkmcnt(4)
    v_add_u32 v24, s15, v0
    v_smfmac_f32_16x16x64_bf16 v[8:11], v[28:31], v[184:191], v2
    s_waitcnt lgkmcnt(2)
    ds_read_b128 v[24:27], v24 offset:0
    v_smfmac_f32_16x16x64_bf16 v[12:15], v[28:31], v[32:39], v2
    ds_read_b128 v[32:35], v1 offset:14336
    v_smfmac_f32_16x16x64_bf16 v[16:19], v[28:31], v[192:199], v2
    s_waitcnt lgkmcnt(2)
    ds_read_b128 v[36:39], v1 offset:15360
    v_smfmac_f32_16x16x64_bf16 v[20:23], v[28:31], v[40:47], v2
    ds_read_b128 v[40:43], v1 offset:16384
    v_smfmac_f32_16x16x64_bf16 v[48:51], v[28:31], v[200:207], v2
    ds_read_b128 v[44:47], v1 offset:17408
    v_smfmac_f32_16x16x64_bf16 v[52:55], v[28:31], v[208:215], v2
    s_waitcnt lgkmcnt(4)
    v_cndmask_b32 v30, v3, v1, s[82:83]
    v_smfmac_f32_16x16x64_bf16 v[8:11], v[24:27], v[216:223], v2
    ds_read_b64 v[30:31], v30 offset:0
    v_add_u32 v28, s92, v0
    v_smfmac_f32_16x16x64_bf16 v[12:15], v[24:27], v[224:231], v2
    s_waitcnt vmcnt(1)
    ds_write_b128 v28, v[56:59] offset:4096
    v_max_u32 v29, v56, v58
    v_smfmac_f32_16x16x64_bf16 v[16:19], v[24:27], v[232:239], v2
    s_waitcnt vmcnt(0)
    v_max3_u32 v29, v29, v60, v62
    v_smfmac_f32_16x16x64_bf16 v[20:23], v[24:27], v[240:247], v2
    s_add_u32 m0, s63, 0
    s_add_u32 s60, s42, 16384
    v_cmp_eq_u32 vcc, -1, v29
    v_smfmac_f32_16x16x64_bf16 v[48:51], v[24:27], v[248:255], v2
    s_waitcnt lgkmcnt(1)
    v_permlane16_swap_b32 v30, v31
    v_smfmac_f32_16x16x64_bf16 v[52:55], v[24:27], a[0:7], v2
    s_cbranch_vccnz CH_re_237
CH_re_238:
    v_lshrrev_b32 v29, 1, v0
    v_smfmac_f32_16x16x64_bf16 v[8:11], v[56:59], a[8:15], v2
    s_waitcnt lgkmcnt(0)
    s_barrier
    v_smfmac_f32_16x16x64_bf16 v[12:15], v[56:59], a[16:23], v2
    buffer_store_dwordx2 v[30:31], v29, s[32:35], s96 offen sc1
    v_mov_b32_e64 v24, s84
    v_smfmac_f32_16x16x64_bf16 v[16:19], v[56:59], a[24:31], v2
    buffer_store_dword v24, off, s[32:35], s18 sc1
    v_add_u32_e64 v28, s13, v0
    v_smfmac_f32_16x16x64_bf16 v[20:23], v[56:59], a[32:39], v2
    ds_read_b128 v[28:31], v28 offset:4096
    v_add_u32_e64 v24, s14, v0
    v_smfmac_f32_16x16x64_bf16 v[8:11], v[60:63], a[40:47], v2
    ds_read_b128 v[24:27], v24 offset:4096
    v_smfmac_f32_16x16x64_bf16 v[12:15], v[60:63], v[32:39], v2
    buffer_load_dwordx4 v0, s[32:35], s42 offen offset:0 sc1 lds
    v_smfmac_f32_16x16x64_bf16 v[16:19], v[60:63], a[48:55], v2
    v_add_u32_e64 v32, s15, v0
    v_smfmac_f32_16x16x64_bf16 v[20:23], v[60:63], a[56:63], v2
    s_waitcnt lgkmcnt(1)
    ds_read_b128 v[32:35], v32 offset:4096
    v_smfmac_f32_16x16x64_bf16 v[8:11], v[28:31], v[40:47], v2
    ds_read_b128 v[40:43], v1 offset:18432
    v_smfmac_f32_16x16x64_bf16 v[12:15], v[28:31], a[64:71], v2
    s_waitcnt lgkmcnt(2)
    ds_read_b128 v[44:47], v1 offset:19456
    v_smfmac_f32_16x16x64_bf16 v[8:11], v[24:27], a[72:79], v2
    buffer_load_dwordx4 v0, s[32:35], s42 offen offset:1024 sc1 lds
    v_smfmac_f32_16x16x64_bf16 v[12:15], v[24:27], a[80:87], v2
    s_waitcnt lgkmcnt(2)
    v_smfmac_f32_16x16x64_bf16 v[8:11], v[32:35], a[88:95], v2
    s_add_u32 m0, s64, 0
    s_add_u32 s42, s42, 1048576
    v_smfmac_f32_16x16x64_bf16 v[12:15], v[32:35], a[96:103], v2
    buffer_load_dwordx4 v0, s[32:35], s60 offen offset:0 sc1 lds
    v_smfmac_f32_16x16x64_bf16 v[16:19], v[28:31], a[104:111], v2
    s_waitcnt lgkmcnt(0)
    v_add_f32 v8, v8, v10
    v_smfmac_f32_16x16x64_bf16 v[16:19], v[24:27], v[40:47], v2
    ds_read_b128 v[40:43], v0 offset:24576
    v_add_f32_e64 v9, v9, v11
    v_smfmac_f32_16x16x64_bf16 v[16:19], v[32:35], a[112:119], v2
    ds_read_b128 v[44:47], v0 offset:25600
    v_add_f32_e64 v12, v12, v14
    v_smfmac_f32_16x16x64_bf16 v[20:23], v[28:31], a[120:127], v2
    buffer_load_dwordx4 v0, s[32:35], s60 offen offset:1024 sc1 lds
    v_add_f32_e64 v13, v13, v15
    v_smfmac_f32_16x16x64_bf16 v[20:23], v[24:27], a[128:135], v2
    v_cvt_pk_bf16_f32 v8, v8, v9
    v_cvt_pk_bf16_f32 v9, v12, v13
    v_smfmac_f32_16x16x64_bf16 v[20:23], v[32:35], a[136:143], v2
    ds_write_b64 v3, v[8:9] offset:0
    v_add_f32 v16, v16, v18
    v_add_f32 v17, v17, v19
    v_smfmac_f32_16x16x64_bf16 v[48:51], v[56:59], a[144:151], v2
    v_cvt_pk_bf16_f32 v10, v16, v17
    v_add_f32 v20, v20, v22
    v_add_f32 v21, v21, v23
    v_cvt_pk_bf16_f32 v11, v20, v21
    v_smfmac_f32_16x16x64_bf16 v[52:55], v[56:59], a[152:159], v2
    ds_write_b64 v3, v[10:11] offset:2176
    v_smfmac_f32_16x16x64_bf16 v[48:51], v[60:63], a[160:167], v2
    ds_read_b128 v[56:59], v0 offset:26624
    v_smfmac_f32_16x16x64_bf16 v[52:55], v[60:63], a[168:175], v2
    ds_read_b128 v[60:63], v0 offset:27648
    v_smfmac_f32_16x16x64_bf16 v[48:51], v[28:31], a[176:183], v2
    s_waitcnt lgkmcnt(2)
    s_barrier
    v_smfmac_f32_16x16x64_bf16 v[52:55], v[28:31], a[184:191], v2
    ds_read_b64_tr_b16 v[12:13], v4 offset:0
    ds_read_b64_tr_b16 v[14:15], v4 offset:32
    v_smfmac_f32_16x16x64_bf16 v[48:51], v[24:27], a[192:199], v2
    ds_read_b64_tr_b16 v[16:17], v4 offset:1088
    ds_read_b64_tr_b16 v[18:19], v4 offset:1120
    v_smfmac_f32_16x16x64_bf16 v[52:55], v[24:27], a[200:207], v2
    ds_read_b64_tr_b16 v[20:21], v4 offset:2176
    ds_read_b64_tr_b16 v[22:23], v4 offset:2208
    v_smfmac_f32_16x16x64_bf16 v[48:51], v[32:35], a[208:215], v2
    ds_read_b64_tr_b16 v[36:37], v4 offset:3264
    ds_read_b64_tr_b16 v[38:39], v4 offset:3296
    v_smfmac_f32_16x16x64_bf16 v[52:55], v[32:35], a[216:223], v2
    ds_read_b128 v[28:31], v0 offset:29696
    ds_read_b128 v[24:27], v0 offset:28672
    s_waitcnt lgkmcnt(8)
    v_mfma_f32_16x16x32_bf16 v[8:11], v[40:43], v[12:15], 0
    ds_read_b128 v[32:35], v0 offset:30720
    s_waitcnt lgkmcnt(7)
    v_mfma_f32_16x16x32_bf16 v[8:11], v[44:47], v[16:19], v[8:11]
    ds_read_b128 v[44:47], v0 offset:31744
    v_add_f32 v48, v48, v50
    v_mfma_f32_16x16x32_bf16 v[40:43], v[56:59], v[12:15], 0
    v_add_f32 v49, v49, v51
    v_mfma_f32_16x16x32_bf16 v[40:43], v[60:63], v[16:19], v[40:43]
    s_waitcnt lgkmcnt(6)
    v_add_f32 v52, v52, v54
    v_add_f32_dpp v8, v10, v8 quad_perm:[2,3,2,3] row_mask:0xf bank_mask:0xf
    v_mfma_f32_16x16x32_bf16 v[56:59], v[20:23], v[12:15], 0
    s_waitcnt lgkmcnt(4)
    v_add_f32_dpp v9, v11, v9 quad_perm:[2,3,2,3] row_mask:0xf bank_mask:0xf
    v_max_f32 v10, v8, v9
    v_mfma_f32_16x16x32_bf16 v[56:59], v[36:39], v[16:19], v[56:59]
    s_waitcnt lgkmcnt(2)
    v_add_f32 v53, v53, v55
    v_add_f32_dpp v40, v42, v40 quad_perm:[2,3,2,3] row_mask:0xf bank_mask:0xf
    v_mfma_f32_16x16x32_bf16 v[20:23], v[24:27], v[12:15], 0
    v_add_f32_dpp v41, v43, v41 quad_perm:[2,3,2,3] row_mask:0xf bank_mask:0xf
    v_max3_f32 v10, v10, v40, v41
    v_mfma_f32_16x16x32_bf16 v[20:23], v[28:31], v[16:19], v[20:23]
    s_waitcnt lgkmcnt(1)
    v_cvt_pk_bf16_f32 v50, v48, v49
    v_add_f32_dpp v56, v58, v56 quad_perm:[2,3,2,3] row_mask:0xf bank_mask:0xf
    v_mfma_f32_16x16x32_bf16 v[24:27], v[32:35], v[12:15], 0
    s_waitcnt lgkmcnt(0)
    v_add_f32_dpp v57, v59, v57 quad_perm:[2,3,2,3] row_mask:0xf bank_mask:0xf
    v_max3_f32 v10, v10, v56, v57
    v_mfma_f32_16x16x32_bf16 v[24:27], v[44:47], v[16:19], v[24:27]
    ds_read_b128 v[32:35], v1 offset:2048
    v_add_f32_dpp v20, v22, v20 quad_perm:[2,3,2,3] row_mask:0xf bank_mask:0xf
    v_add_f32_dpp v21, v23, v21 quad_perm:[2,3,2,3] row_mask:0xf bank_mask:0xf
    v_max3_f32 v10, v10, v20, v21
    v_cvt_pk_bf16_f32 v51, v52, v53
    v_mov_b64 v[60:61], s[22:23]
    v_mov_b64 v[62:63], s[22:23]
    s_nop 0
    v_add_f32_dpp v24, v26, v24 quad_perm:[2,3,2,3] row_mask:0xf bank_mask:0xf
    v_add_f32_dpp v25, v27, v25 quad_perm:[2,3,2,3] row_mask:0xf bank_mask:0xf
    v_max3_f32 v10, v10, v24, v25
    v_mov_b32 v11, v10
    v_mov_b32 v29, 0
    v_mov_b32 v30, 0
    v_permlane32_swap_b32 v10, v11
    v_max_f32 v10, v10, v11
    v_mov_b32 v11, v10
    s_cmp_eq_u32 s40, 63
    s_cbranch_scc1 CH_exit_220
    v_permlane16_swap_b32 v10, v11
    v_max_f32 v10, v10, v11
    v_mul_f32 v10, s51, v10
    v_pk_fma_f32 v[56:57], v[56:57], s[16:17], v[10:11] op_sel_hi:[1,1,0] neg_lo:[0,0,1] neg_hi:[0,0,1]
    v_pk_fma_f32 v[8:9], v[8:9], s[16:17], v[10:11] op_sel_hi:[1,1,0] neg_lo:[0,0,1] neg_hi:[0,0,1]
    v_pk_fma_f32 v[40:41], v[40:41], s[16:17], v[10:11] op_sel_hi:[1,1,0] neg_lo:[0,0,1] neg_hi:[0,0,1]
    v_pk_fma_f32 v[20:21], v[20:21], s[16:17], v[10:11] op_sel_hi:[1,1,0] neg_lo:[0,0,1] neg_hi:[0,0,1]
    v_pk_fma_f32 v[24:25], v[24:25], s[16:17], v[10:11] op_sel_hi:[1,1,0] neg_lo:[0,0,1] neg_hi:[0,0,1]
    v_exp_f32_dpp v56, v56 quad_perm:[0,1,0,1] row_mask:0xf bank_mask:0xf
    v_exp_f32_dpp v57, v57 quad_perm:[0,1,0,1] row_mask:0xf bank_mask:0xf
    v_exp_f32_dpp v8, v8 quad_perm:[0,1,0,1] row_mask:0xf bank_mask:0xf
    v_cvt_pk_bf16_f32 v28, v56, v57
    v_cvt_pk_bf16_f32 v31, v56, v57
    v_exp_f32_dpp v9, v9 quad_perm:[0,1,0,1] row_mask:0xf bank_mask:0xf
    v_mfma_f32_16x16x16_bf16 v[36:39], v[60:61], v[28:29], 0
    ds_read_b128 v[44:47], v1 offset:3072
    v_exp_f32_dpp v40, v40 quad_perm:[0,1,0,1] row_mask:0xf bank_mask:0xf
    v_mfma_f32_16x16x16_bf16 v[16:19], v[50:51], v[28:29], 0
    v_exp_f32_dpp v41, v41 quad_perm:[0,1,0,1] row_mask:0xf bank_mask:0xf
    v_mfma_f32_16x16x16_bf16 v[52:55], v[50:51], v[30:31], 0
    v_exp_f32_dpp v20, v20 quad_perm:[0,1,0,1] row_mask:0xf bank_mask:0xf
    v_cvt_pk_bf16_f32 v12, v8, v9
    v_exp_f32_dpp v21, v21 quad_perm:[0,1,0,1] row_mask:0xf bank_mask:0xf
    v_cvt_pk_bf16_f32 v13, v40, v41
    v_exp_f32_dpp v24, v24 quad_perm:[0,1,0,1] row_mask:0xf bank_mask:0xf
    v_exp_f32_dpp v25, v25 quad_perm:[0,1,0,1] row_mask:0xf bank_mask:0xf
    v_cvt_pk_bf16_f32 v14, v20, v21
    v_cvt_pk_bf16_f32 v15, v24, v25
    s_waitcnt lgkmcnt(0)
    s_nop 0
    v_mfma_f32_16x16x32_bf16 v[36:39], v[60:63], v[12:15], v[36:39]
    ds_write_b64 v1, v[50:51] offset:2176
    v_mfma_f32_16x16x32_bf16 v[16:19], v[32:35], v[12:15], v[16:19]
    ds_read_b128 v[56:59], v1 offset:20480
    v_mfma_f32_16x16x32_bf16 v[52:55], v[44:47], v[12:15], v[52:55]
    ds_read_b128 v[60:63], v1 offset:21504
    v_rcp_f32 v10, v36
    v_mov_b64_e64 v[12:13], 0
    s_nop 0
    v_pk_mul_f32 v[16:17], v[16:17], v[10:11] op_sel_hi:[1,0]
    v_pk_mul_f32 v[18:19], v[18:19], v[10:11] op_sel_hi:[1,0]
    s_mov_b64 exec, s[86:87]
    s_nop 0
    v_pk_mul_f32 v[16:17], v[52:53], v[10:11] op_sel_hi:[1,0]
    v_pk_mul_f32 v[18:19], v[54:55], v[10:11] op_sel_hi:[1,0]
    s_mov_b64 exec, -1
    v_cvt_pk_bf16_f32 v16, v16, v17
    v_cvt_pk_bf16_f32 v17, v18, v19
    v_mfma_f32_16x16x16_bf16 v[20:23], v[12:13], v[12:13], 0
    ds_write_b64 v5, v[16:17]
    v_mfma_f32_16x16x16_bf16 v[24:27], v[12:13], v[12:13], 0
    ds_read_b128 v[40:43], v1 offset:22528
    v_mfma_f32_16x16x16_bf16 v[28:31], v[12:13], v[12:13], 0
    ds_read_b128 v[44:47], v1 offset:23552
    v_mfma_f32_16x16x16_bf16 v[48:51], v[12:13], v[12:13], 0
    ds_read_b128 v[32:35], v1 offset:24576
    s_waitcnt lgkmcnt(3)
    s_barrier
    v_mfma_f32_16x16x16_bf16 v[8:11], v[12:13], v[12:13], 0
    ds_read_b128 v[16:19], v0 offset:8192
    ds_read_b128 v[52:55], v0 offset:9216
    ds_read_b128 v[36:39], v1 offset:25600
    v_mfma_f32_16x16x16_bf16 v[28:31], v[12:13], v[12:13], 0
    v_lshlrev_b32 v15, 3, v0
    v_mfma_f32_16x16x16_bf16 v[48:51], v[12:13], v[12:13], 0
    v_bfe_u32 v14, v0, 2, 6
    v_and_or_b32 v14, v15, s94, v14
    s_waitcnt lgkmcnt(2)
    v_smfmac_f32_16x16x64_bf16 v[20:23], v[16:19], v[56:63], v2
    ds_read_b128 v[56:59], v1 offset:26624
    s_waitcnt lgkmcnt(2)
    v_smfmac_f32_16x16x64_bf16 v[20:23], v[52:55], v[40:47], v2
    s_waitcnt lgkmcnt(1)
    ds_read_b128 v[60:63], v1 offset:27648
    v_smfmac_f32_16x16x64_bf16 v[24:27], v[16:19], v[32:39], v2
    ds_read_b128 v[40:43], v1 offset:28672
    v_smfmac_f32_16x16x64_bf16 v[24:27], v[52:55], a[224:231], v2
    ds_read_b128 v[44:47], v1 offset:29696
    v_add_f32 v20, v20, v22
    v_smfmac_f32_16x16x64_bf16 v[28:31], v[16:19], a[232:239], v2
    ds_read_b128 v[32:35], v1 offset:30720
    v_add_f32 v21, v21, v23
    v_smfmac_f32_16x16x64_bf16 v[28:31], v[52:55], a[240:247], v2
    ds_read_b128 v[36:39], v1 offset:31744
    v_add_f32 v24, v24, v26
    v_smfmac_f32_16x16x64_bf16 v[48:51], v[16:19], a[248:255], v2
    s_waitcnt lgkmcnt(4)
    v_add_f32_e64 v25, v25, v27
    v_smfmac_f32_16x16x64_bf16 v[48:51], v[52:55], v[56:63], v2
    s_waitcnt lgkmcnt(2)
    v_cvt_pk_bf16_f32 v20, v20, v24
    v_smfmac_f32_16x16x64_bf16 v[8:11], v[16:19], v[40:47], v2
    s_waitcnt lgkmcnt(0)
    v_cvt_pk_bf16_f32 v21, v21, v25
    v_and_or_b32 v20, v20, -2, 0
    v_smfmac_f32_16x16x64_bf16 v[8:11], v[52:55], v[32:39], v2
    s_cmp_eq_u32 s21, 3
    buffer_store_dwordx2 v[20:21], v7, s[28:31], 0 offen sc1
    v_pk_add_f32 v[28:29], v[28:29], v[30:31]
    v_pk_add_f32 v[48:49], v[48:49], v[50:51]
    v_cvt_pk_bf16_f32 v28, v28, v48
    v_cvt_pk_bf16_f32 v29, v29, v49
    v_and_or_b32 v28, v28, -2, 0
    s_nop 0
    v_pk_add_f32 v[8:9], v[8:9], v[10:11]
    v_cvt_pk_bf16_f32 v8, v8, v9
    v_and_or_b32 v8, v8, -2, 0
    buffer_store_dword v8, v14, s[28:31], s62 offen sc1
    buffer_store_dwordx2 v[28:29], v7, s[28:31], s61 offen sc1
    s_cbranch_scc1 CH_h_239
    v_lshrrev_b32 v56, s91, v0
    v_and_b32 v56, 16, v56
    v_lshlrev_b32_e64 v56, v56, s65
    v_cndmask_b32 v40, 0, v56, s[52:53]
    v_cndmask_b32 v41, 0, v56, s[54:55]
    v_cndmask_b32 v42, 0, v56, s[56:57]
    v_cndmask_b32 v43, 0, v56, s[58:59]
    v_mov_b64 v[58:59], -1
    s_mov_b32 s44, s43
    s_add_u32 s43, s43, 0x2000
    s_and_b32 s43, s43, 0x7fff
    s_add_u32 s43, s43, 163840
    s_mov_b32 s49, 0
    s_add_u32 s40, s40, 1
    s_add_u32 s90, s90, 32768
    s_mov_b32 s96, s97
    s_add_u32 s97, s97, 131072
    s_add_u32 s84, s40, s99
    s_sub_u32 s84, s84, 1
    s_cmp_lg_u32 s95, 0
    s_cbranch_scc1 CH_nt_243
    s_nop 9
    s_cmp_le_u32 s21, 0
    s_cbranch_scc1 CH_d_245
    s_nop 7
CH_d_245:
    buffer_load_dwordx4 v[32:35], v0, s[28:31], s46 offen offset:0 sc1
    buffer_load_dwordx4 v[36:39], v0, s[28:31], s46 offen offset:1024 sc1
    v_mov_b64 v[8:9], 0
    v_mov_b64 v[10:11], 0
    v_mov_b64 v[12:13], 0
    v_mov_b64 v[14:15], 0
    v_mov_b64 v[48:49], 0
    v_mov_b64 v[50:51], 0
    v_mov_b64 v[52:53], 0
    v_mov_b64_e64 v[54:55], 0
    s_cmp_eq_u32 s21, 2
    s_cselect_b32 s47, 1, 0
    s_nop 15
    s_nop 2
    buffer_load_dwordx4 v[24:27], v0, s[28:31], s46 offen offset:0 sc1
    buffer_load_dwordx4 v[28:31], v0, s[28:31], s46 offen offset:1024 sc1
CH_h_242:
    s_waitcnt vmcnt(3)
    v_mfma_f32_16x16x32_bf16 v[44:47], v[40:43], v[32:35], 0
    s_waitcnt vmcnt(2)
    v_mfma_f32_16x16x32_bf16 v[44:47], v[40:43], v[36:39], v[44:47]
    v_bitop3_b32 v56, v33, v35, v37 bitop3:0xfe
    v_bitop3_b32 v57, v32, v34, v36 bitop3:0xfe
    v_bitop3_b32 v56, v56, v39, s47 bitop3:0xa8
    v_bitop3_b32 v56, v56, v57, v38 bitop3:0xfe
    v_and_b32 v56, 1, v56
    v_cmp_ne_u32_e64 vcc, 0, v56
CH_ok_246:
    s_nop 0
    v_add_f32_dpp v44, v44, v44 row_ror:8 row_mask:0xf bank_mask:0xf
    v_add_f32_dpp v45, v45, v45 row_ror:8 row_mask:0xf bank_mask:0xf
    v_add_f32_dpp v46, v46, v46 row_ror:8 row_mask:0xf bank_mask:0xf
    v_add_f32_dpp v47, v47, v47 row_ror:8 row_mask:0xf bank_mask:0xf
    v_add_f32_dpp v44, v44, v44 row_ror:4 row_mask:0xf bank_mask:0xf
    v_add_f32_dpp v45, v45, v45 row_ror:4 row_mask:0xf bank_mask:0xf
    v_add_f32_dpp v46, v46, v46 row_ror:4 row_mask:0xf bank_mask:0xf
    v_add_f32_dpp v47, v47, v47 row_ror:4 row_mask:0xf bank_mask:0xf
    v_cvt_pk_bf16_f32 v56, v44, v45
    v_cvt_pk_bf16_f32 v57, v46, v47
    v_min_u32_e64 v56, -2, v56
    s_cbranch_vccnz CH_h_241
    buffer_store_dwordx2 v[56:57], v6, s[28:31], s43 offen sc1
CH_x0_244:
    s_barrier
    buffer_store_dwordx2 v[56:57], v6, s[36:39], s50 offen sc1
    buffer_store_dwordx2 v[58:59], v6, s[28:31], s44 offen sc1
    s_add_u32 s50, s50, 32768
    s_waitcnt vmcnt(3)
    v_mov_b64 v[16:17], 0
    v_mov_b64 v[18:19], 0
    v_mov_b64 v[20:21], 0
    v_mov_b64 v[22:23], 0
    s_nop 15
    s_nop 15
    s_nop 15
    s_nop 15
    s_nop 2
    s_branch CH_h_240
CH_h_239:
    v_mov_b64 v[48:49], 0
    v_mov_b64 v[50:51], 0
    v_mov_b64 v[52:53], 0
    v_mov_b64 v[54:55], 0
    s_mov_b32 s44, s43
    s_add_u32 s43, s43, 0x2000
    s_and_b32 s43, s43, 0x7fff
    s_add_u32 s43, s43, 163840
    s_mov_b32 s49, 0
    s_add_u32 s40, s40, 1
    s_add_u32 s90, s90, 32768
    s_mov_b32 s96, s97
    s_add_u32 s97, s97, 131072
    s_add_u32 s84, s40, s99
    s_sub_u32 s84, s84, 1
    s_add_u32 s47, s98, 0
    s_load_dword s72, s[32:33], s47 glc
    s_add_u32 s47, s98, 128
    s_load_dword s73, s[32:33], s47 glc
    s_add_u32 s47, s98, 256
    s_load_dword s74, s[32:33], s47 glc
    s_add_u32 s47, s98, 384
    s_load_dword s75, s[32:33], s47 glc
    v_mfma_f32_32x32x2_f32 v[8:23], v48, v48, 0
    v_mfma_f32_32x32x2_f32 v[8:23], v48, v48, v[8:23]
    v_mfma_f32_32x32x2_f32 v[8:23], v48, v48, v[8:23]
    v_mfma_f32_32x32x2_f32 v[8:23], v48, v48, v[8:23]
    v_mfma_f32_32x32x2_f32 v[8:23], v48, v48, v[8:23]
    v_mfma_f32_32x32x2_f32 v[8:23], v48, v48, v[8:23]
    s_waitcnt vmcnt(0)
    s_barrier
    s_nop 15
    s_nop 15
    s_nop 15
    s_nop 15
    s_nop 3
    s_add_u32 s47, s40, 2
    s_min_u32 s47, s47, 64
    s_add_u32 s47, s47, s99
    s_waitcnt lgkmcnt(0)
    s_min_u32 s72, s72, s73
    s_min_u32 s72, s72, s74
    s_min_u32 s72, s72, s75
    s_cmp_lt_u32 s72, s47
    s_cbranch_scc1 CH_fp_247
CH_fb_248:
CH_h_240:
    s_add_u32 s93, s43, s92
    buffer_load_dwordx4 v[24:27], v0, s[28:31], s93 offen sc1
    ds_read_b128 v[32:35], v1 offset:4096
    ds_read_b128 v[36:39], v1 offset:5120
    v_add_u32 v40, s92, v0
    v_xor_b32 v42, 1024, v40
    s_add_u32 s93, s43, 4096
    buffer_load_dwordx4 v[28:31], v0, s[28:31], s93 offen sc1
    s_nop 15
    s_nop 15
    s_nop 11
    s_add_u32 s93, s90, s92
    buffer_load_dwordx4 v[56:59], v0, s[36:39], s93 offen sc1
    s_nop 5
    s_add_u32 s93, s90, 4096
    buffer_load_dwordx4 v[60:63], v0, s[36:39], s93 offen sc1
    s_branch CH_top_219
CH_re_222:
    s_add_u32 s93, s43, s92
    buffer_load_dwordx4 v[24:27], v0, s[28:31], s93 offen sc1
    s_add_u32 s93, s43, 4096
    buffer_load_dwordx4 v[28:31], v0, s[28:31], s93 offen sc1
    s_add_u32 s49, s49, 1
    s_cmp_gt_u32 s49, 400000
    s_cbranch_scc1 L_end
    s_waitcnt vmcnt(0) lgkmcnt(0)
    v_max_u32 v41, v24, v26
    v_max3_u32 v41, v41, v28, v30
    v_cmp_eq_u32 vcc, -1, v41
    s_cbranch_vccnz CH_re_222
    ds_read_b128 v[32:35], v1 offset:4096
    ds_read_b128 v[36:39], v1 offset:5120
    v_mov_b64 v[8:9], 0
    v_mov_b64 v[10:11], 0
    v_mov_b64 v[12:13], 0
    v_mov_b64 v[14:15], 0
    v_mov_b64 v[16:17], 0
    v_mov_b64 v[18:19], 0
    v_mov_b64 v[20:21], 0
    v_mov_b64 v[22:23], 0
    v_mov_b64 v[48:49], 0
    v_mov_b64 v[50:51], 0
    v_mov_b64 v[52:53], 0
    v_mov_b64 v[54:55], 0
    s_waitcnt lgkmcnt(0)
    s_branch CH_st_221
CH_re_223:
    s_add_u32 s93, s90, s92
    buffer_load_dwordx4 v[56:59], v0, s[36:39], s93 offen sc1
    s_add_u32 s93, s90, 4096
    buffer_load_dwordx4 v[60:63], v0, s[36:39], s93 offen sc1
    s_add_u32 s49, s49, 1
    s_cmp_gt_u32 s49, 400000
    s_cbranch_scc1 L_end
    s_waitcnt vmcnt(0)
    v_max_u32 v29, v56, v58
    v_max3_u32 v29, v29, v60, v62
    v_cmp_eq_u32 vcc, -1, v29
    s_cbranch_vccnz CH_re_223
    ds_write_b128 v28, v[56:59] offset:4096
    s_waitcnt lgkmcnt(0)
    s_branch CH_re_224
CH_nt_229:
    v_mov_b64 v[8:9], 0
    v_mov_b64 v[10:11], 0
    v_mov_b64 v[12:13], 0
    v_mov_b64 v[14:15], 0
    v_mov_b64 v[16:17], 0
    v_mov_b64 v[18:19], 0
    v_mov_b64 v[20:21], 0
    v_mov_b64 v[22:23], 0
    v_mov_b64 v[48:49], 0
    v_mov_b64 v[50:51], 0
    v_mov_b64 v[52:53], 0
    v_mov_b64 v[54:55], 0
    s_waitcnt vmcnt(0)
    s_branch CH_x0_230
CH_h_227:
    buffer_load_dwordx4 v[32:35], v0, s[28:31], s46 offen offset:0 sc1
    buffer_load_dwordx4 v[36:39], v0, s[28:31], s46 offen offset:1024 sc1
    s_waitcnt vmcnt(3)
    v_mfma_f32_16x16x32_bf16 v[44:47], v[40:43], v[24:27], 0
    s_waitcnt vmcnt(2)
    v_mfma_f32_16x16x32_bf16 v[44:47], v[40:43], v[28:31], v[44:47]
    v_bitop3_b32 v56, v25, v27, v29 bitop3:0x80
    v_bitop3_b32 v57, v24, v26, v28 bitop3:0x80
    v_bitop3_b32 v56, v56, v31, s47 bitop3:0xea
    v_bitop3_b32 v56, v56, v57, v30 bitop3:0x80
    v_and_b32 v56, 1, v56
    v_cmp_ne_u32 vcc, 1, v56
    s_cbranch_vccz CH_ok_232
    buffer_load_dwordx4 v[24:27], v0, s[28:31], s46 offen offset:0 sc1
    buffer_load_dwordx4 v[28:31], v0, s[28:31], s46 offen offset:1024 sc1
    s_add_u32 s49, s49, 1
    s_cmp_gt_u32 s49, 400000
    s_cbranch_scc1 L_end
    s_branch CH_h_228
CH_fp_233:
    v_and_b32 v40, 0x180, v0
    buffer_load_dword v41, v40, s[32:35], s98 offen sc1
    s_add_u32 s49, s49, 1
    s_cmp_gt_u32 s49, 400000
    s_cbranch_scc1 L_end
    s_waitcnt vmcnt(0)
    v_cmp_gt_u32 vcc, s47, v41
    s_cbranch_vccnz CH_fp_233
    s_branch CH_fb_234
CH_re_236:
    s_add_u32 s93, s43, s92
    buffer_load_dwordx4 v[24:27], v0, s[28:31], s93 offen sc1
    s_add_u32 s93, s43, 4096
    buffer_load_dwordx4 v[28:31], v0, s[28:31], s93 offen sc1
    s_add_u32 s49, s49, 1
    s_cmp_gt_u32 s49, 400000
    s_cbranch_scc1 L_end
    s_waitcnt vmcnt(0) lgkmcnt(0)
    v_max_u32 v41, v24, v26
    v_max3_u32 v41, v41, v28, v30
    v_cmp_eq_u32 vcc, -1, v41
    s_cbranch_vccnz CH_re_236
    ds_read_b128 v[32:35], v1 offset:4096
    ds_read_b128 v[36:39], v1 offset:5120
    v_mov_b64 v[8:9], 0
    v_mov_b64 v[10:11], 0
    v_mov_b64 v[12:13], 0
    v_mov_b64 v[14:15], 0
    v_mov_b64 v[16:17], 0
    v_mov_b64 v[18:19], 0
    v_mov_b64 v[20:21], 0
    v_mov_b64 v[22:23], 0
    v_mov_b64 v[48:49], 0
    v_mov_b64 v[50:51], 0
    v_mov_b64 v[52:53], 0
    v_mov_b64 v[54:55], 0
    s_waitcnt lgkmcnt(0)
    s_branch CH_st_235
CH_re_237:
    s_add_u32 s93, s90, s92
    buffer_load_dwordx4 v[56:59], v0, s[36:39], s93 offen sc1
    s_add_u32 s93, s90, 4096
    buffer_load_dwordx4 v[60:63], v0, s[36:39], s93 offen sc1
    s_add_u32 s49, s49, 1
    s_cmp_gt_u32 s49, 400000
    s_cbranch_scc1 L_end
    s_waitcnt vmcnt(0)
    v_max_u32 v29, v56, v58
    v_max3_u32 v29, v29, v60, v62
    v_cmp_eq_u32 vcc, -1, v29
    s_cbranch_vccnz CH_re_237
    ds_write_b128 v28, v[56:59] offset:4096
    s_waitcnt lgkmcnt(0)
    s_branch CH_re_238
CH_nt_243:
    v_mov_b64 v[8:9], 0
    v_mov_b64 v[10:11], 0
    v_mov_b64 v[12:13], 0
    v_mov_b64 v[14:15], 0
    v_mov_b64 v[16:17], 0
    v_mov_b64 v[18:19], 0
    v_mov_b64 v[20:21], 0
    v_mov_b64 v[22:23], 0
    v_mov_b64 v[48:49], 0
    v_mov_b64 v[50:51], 0
    v_mov_b64 v[52:53], 0
    v_mov_b64 v[54:55], 0
    s_waitcnt vmcnt(0)
    s_branch CH_x0_244
CH_h_241:
    buffer_load_dwordx4 v[32:35], v0, s[28:31], s46 offen offset:0 sc1
    buffer_load_dwordx4 v[36:39], v0, s[28:31], s46 offen offset:1024 sc1
    s_waitcnt vmcnt(3)
    v_mfma_f32_16x16x32_bf16 v[44:47], v[40:43], v[24:27], 0
    s_waitcnt vmcnt(2)
    v_mfma_f32_16x16x32_bf16 v[44:47], v[40:43], v[28:31], v[44:47]
    v_bitop3_b32 v56, v25, v27, v29 bitop3:0xfe
    v_bitop3_b32 v57, v24, v26, v28 bitop3:0xfe
    v_bitop3_b32 v56, v56, v31, s47 bitop3:0xa8
    v_bitop3_b32 v56, v56, v57, v30 bitop3:0xfe
    v_and_b32 v56, 1, v56
    v_cmp_ne_u32 vcc, 0, v56
    s_cbranch_vccz CH_ok_246
    buffer_load_dwordx4 v[24:27], v0, s[28:31], s46 offen offset:0 sc1
    buffer_load_dwordx4 v[28:31], v0, s[28:31], s46 offen offset:1024 sc1
    s_add_u32 s49, s49, 1
    s_cmp_gt_u32 s49, 400000
    s_cbranch_scc1 L_end
    s_branch CH_h_242
CH_fp_247:
    v_and_b32 v40, 0x180, v0
    buffer_load_dword v41, v40, s[32:35], s98 offen sc1
    s_add_u32 s49, s49, 1
    s_cmp_gt_u32 s49, 400000
    s_cbranch_scc1 L_end
    s_waitcnt vmcnt(0)
    v_cmp_gt_u32 vcc, s47, v41
    s_cbranch_vccnz CH_fp_247
    s_branch CH_fb_248
CH_exit_220:
CH_fin_160:
    ds_read_b64 v[14:15], v3 offset:2176
    s_waitcnt lgkmcnt(0)
    v_cndmask_b32 v14, v14, v50, s[82:83]
    v_cndmask_b32 v15, v15, v51, s[82:83]
    v_lshrrev_b32 v13, 1, v0
    s_nop 0
    v_permlane16_swap_b32 v14, v15
    buffer_store_dwordx2 v[14:15], v13, s[32:35], s97 offen sc1
    s_add_u32 s47, s99, 64
    v_mov_b32 v8, s47
    s_waitcnt vmcnt(0) lgkmcnt(0)
    s_barrier
    buffer_store_dword v8, off, s[32:35], s18 sc1
    s_add_u32 s100, s100, 1
    s_cmp_ge_u32 s100, 2
    s_cbranch_scc1 L_end
    s_add_u32 s28, s28, 393216
    s_addc_u32 s29, s29, 0
    s_waitcnt vmcnt(0)
    s_branch CH_layer_156
L_end:
    s_endpgm
L_worker:
    s_sub_u32 s3, s3, 2
    s_lshl_b32 s3, s3, 5
    s_add_u32 s28, s3, s2
    v_readfirstlane_b32 s29, v1
    v_and_b32 v1, 63, v0
    v_lshlrev_b32 v0, 4, v1
    s_load_dwordx2 s[4:5], s[0:1], 96
    s_mov_b32 s6, 268435456
    s_mov_b32 s7, 0x20000
    s_waitcnt lgkmcnt(0)
    s_load_dwordx2 s[8:9], s[0:1], 0
    s_mov_b32 s10, 2621440
    s_mov_b32 s11, 0x20000
    s_waitcnt lgkmcnt(0)
    s_load_dwordx2 s[12:13], s[0:1], 80
    s_mov_b32 s14, 2621440
    s_mov_b32 s15, 0x20000
    s_waitcnt lgkmcnt(0)
    s_load_dwordx2 s[24:25], s[0:1], 88
    s_mov_b32 s26, 256
    s_mov_b32 s27, 0x20000
    s_waitcnt lgkmcnt(0)
    s_mul_i32 s60, s29, 20480
    s_add_u32 s60, s60, 69632
    s_mov_b32 s30, 0
    s_mov_b32 s61, 0
    s_cmp_lt_u32 s28, 190
    s_cbranch_scc1 I_249
    v_mov_b64 v[4:5], 0
    v_mov_b64 v[6:7], 0
    v_bfe_u32 v9, v1, 2, 4
    v_mul_u32_u24 v9, 128, v9
    v_bfe_u32 v8, v1, 0, 2
    v_lshl_add_u32 v9, v8, 4, v9
    s_and_b32 s34, s28, 1
    s_lshl_b32 s34, s34, 2
    s_add_u32 s32, s34, s29
    s_mul_i32 s32, s32, 24576
    s_add_u32 s33, s32, 1048576
    buffer_store_dwordx4 v[4:7], v9, s[4:7], s33 offen sc1
    s_add_u32 s33, s32, 1050624
    buffer_store_dwordx4 v[4:7], v9, s[4:7], s33 offen sc1
    s_add_u32 s33, s32, 1052672
    buffer_store_dwordx4 v[4:7], v9, s[4:7], s33 offen sc1
    s_add_u32 s33, s32, 1054720
    buffer_store_dwordx4 v[4:7], v9, s[4:7], s33 offen sc1
    s_add_u32 s33, s32, 1056768
    buffer_store_dwordx4 v[4:7], v9, s[4:7], s33 offen sc1
    s_add_u32 s33, s32, 1058816
    buffer_store_dwordx4 v[4:7], v9, s[4:7], s33 offen sc1
    s_add_u32 s33, s32, 1060864
    buffer_store_dwordx4 v[4:7], v9, s[4:7], s33 offen sc1
    s_add_u32 s33, s32, 1062912
    buffer_store_dwordx4 v[4:7], v9, s[4:7], s33 offen sc1
    s_add_u32 s33, s32, 1064960
    buffer_store_dwordx4 v[4:7], v9, s[4:7], s33 offen sc1
    s_add_u32 s33, s32, 1067008
    buffer_store_dwordx4 v[4:7], v9, s[4:7], s33 offen sc1
    s_add_u32 s33, s32, 1069056
    buffer_store_dwordx4 v[4:7], v9, s[4:7], s33 offen sc1
    s_add_u32 s33, s32, 1071104
    buffer_store_dwordx4 v[4:7], v9, s[4:7], s33 offen sc1
    s_waitcnt vmcnt(0)
    s_barrier
    v_mov_b32 v8, 1
    buffer_store_dword v8, off, s[24:27], s34 offset:8 sc1
I_249:
    s_cmp_lt_u32 s28, 191
    s_cbranch_scc1 R_250
    s_lshl_b32 s32, s29, 8
    s_add_u32 s32, s32, s28
    s_cmp_lg_u32 s32, 191
    s_cbranch_scc1 NP_251
    v_bfe_u32 v8, v0, 2, 6
    v_mov_b32 v9, -1
    s_mov_b32 s38, -1
    s_mov_b32 s39, -1
    s_waitcnt vmcnt(0)
    s_mov_b32 s32, 2103296
    s_memtime s[34:35]
    s_waitcnt lgkmcnt(0)
    buffer_store_dword v9, v8, s[4:7], s32 offen sc1
    s_waitcnt vmcnt(0)
    s_memtime s[36:37]
    s_waitcnt lgkmcnt(0)
    s_sub_u32 s33, s36, s34
    s_min_u32 s38, s38, s33
    s_mov_b32 s32, 2111488
    s_memtime s[34:35]
    s_waitcnt lgkmcnt(0)
    buffer_store_dword v9, v8, s[4:7], s32 offen sc1
    s_waitcnt vmcnt(0)
    s_memtime s[36:37]
    s_waitcnt lgkmcnt(0)
    s_sub_u32 s33, s36, s34
    s_min_u32 s39, s39, s33
    s_mov_b32 s32, 2103296
    s_memtime s[34:35]
    s_waitcnt lgkmcnt(0)
    buffer_store_dword v9, v8, s[4:7], s32 offen sc1
    s_waitcnt vmcnt(0)
    s_memtime s[36:37]
    s_waitcnt lgkmcnt(0)
    s_sub_u32 s33, s36, s34
    s_min_u32 s38, s38, s33
    s_mov_b32 s32, 2111488
    s_memtime s[34:35]
    s_waitcnt lgkmcnt(0)
    buffer_store_dword v9, v8, s[4:7], s32 offen sc1
    s_waitcnt vmcnt(0)
    s_memtime s[36:37]
    s_waitcnt lgkmcnt(0)
    s_sub_u32 s33, s36, s34
    s_min_u32 s39, s39, s33
    s_mov_b32 s32, 2103296
    s_memtime s[34:35]
    s_waitcnt lgkmcnt(0)
    buffer_store_dword v9, v8, s[4:7], s32 offen sc1
    s_waitcnt vmcnt(0)
    s_memtime s[36:37]
    s_waitcnt lgkmcnt(0)
    s_sub_u32 s33, s36, s34
    s_min_u32 s38, s38, s33
    s_mov_b32 s32, 2111488
    s_memtime s[34:35]
    s_waitcnt lgkmcnt(0)
    buffer_store_dword v9, v8, s[4:7], s32 offen sc1
    s_waitcnt vmcnt(0)
    s_memtime s[36:37]
    s_waitcnt lgkmcnt(0)
    s_sub_u32 s33, s36, s34
    s_min_u32 s39, s39, s33
    s_mov_b32 s32, 2103296
    s_memtime s[34:35]
    s_waitcnt lgkmcnt(0)
    buffer_store_dword v9, v8, s[4:7], s32 offen sc1
    s_waitcnt vmcnt(0)
    s_memtime s[36:37]
    s_waitcnt lgkmcnt(0)
    s_sub_u32 s33, s36, s34
    s_min_u32 s38, s38, s33
    s_mov_b32 s32, 2111488
    s_memtime s[34:35]
    s_waitcnt lgkmcnt(0)
    buffer_store_dword v9, v8, s[4:7], s32 offen sc1
    s_waitcnt vmcnt(0)
    s_memtime s[36:37]
    s_waitcnt lgkmcnt(0)
    s_sub_u32 s33, s36, s34
    s_min_u32 s39, s39, s33
    s_mov_b32 s32, 2103296
    s_memtime s[34:35]
    s_waitcnt lgkmcnt(0)
    buffer_store_dword v9, v8, s[4:7], s32 offen sc1
    s_waitcnt vmcnt(0)
    s_memtime s[36:37]
    s_waitcnt lgkmcnt(0)
    s_sub_u32 s33, s36, s34
    s_min_u32 s38, s38, s33
    s_mov_b32 s32, 2111488
    s_memtime s[34:35]
    s_waitcnt lgkmcnt(0)
    buffer_store_dword v9, v8, s[4:7], s32 offen sc1
    s_waitcnt vmcnt(0)
    s_memtime s[36:37]
    s_waitcnt lgkmcnt(0)
    s_sub_u32 s33, s36, s34
    s_min_u32 s39, s39, s33
    s_mov_b32 s32, 2103296
    s_memtime s[34:35]
    s_waitcnt lgkmcnt(0)
    buffer_store_dword v9, v8, s[4:7], s32 offen sc1
    s_waitcnt vmcnt(0)
    s_memtime s[36:37]
    s_waitcnt lgkmcnt(0)
    s_sub_u32 s33, s36, s34
    s_min_u32 s38, s38, s33
    s_mov_b32 s32, 2111488
    s_memtime s[34:35]
    s_waitcnt lgkmcnt(0)
    buffer_store_dword v9, v8, s[4:7], s32 offen sc1
    s_waitcnt vmcnt(0)
    s_memtime s[36:37]
    s_waitcnt lgkmcnt(0)
    s_sub_u32 s33, s36, s34
    s_min_u32 s39, s39, s33
    s_cmp_lt_u32 s39, s38
    s_cselect_b32 s32, 3, 1
    v_mov_b32 v9, s32
    buffer_store_dword v9, off, s[24:27], 0 offset:4 sc1
NP_251:
    s_barrier
R_250:
    s_mul_i32 s66, s28, 6554
    s_lshr_b32 s66, s66, 16
    s_mul_i32 s67, s66, 10
    s_sub_u32 s67, s28, s67
    s_bfe_u32 s63, s28, 0x50001
    s_and_b32 s34, s28, 1
    s_lshr_b32 s35, s28, 7
    s_cmp_lt_u32 s28, 64
    s_cselect_b32 s64, 2, s34
    s_cselect_b32 s65, s34, s35
    s_cmp_ge_u32 s28, 160
    s_cbranch_scc1 R_252
    s_load_dwordx2 s[16:17], s[0:1], 8
    s_mov_b32 s18, 1314816
    s_mov_b32 s19, 0x20000
    s_waitcnt lgkmcnt(0)
    s_load_dwordx2 s[20:21], s[0:1], 16
    s_mov_b32 s22, 1314816
    s_mov_b32 s23, 0x20000
    s_waitcnt lgkmcnt(0)
    s_lshl_b32 s34, s28, 2
    s_add_u32 s34, s34, s29
    s_mul_i32 s35, s34, 13108
    s_lshr_b32 s35, s35, 16
    s_mul_i32 s36, s35, 5
    s_sub_u32 s36, s34, s36
    s_lshr_b32 s37, s35, 1
    s_and_b32 s38, s35, 1
    s_lshl_b32 s38, s38, 8
    s_add_u32 s37, s37, s38
    s_mul_i32 s37, s37, 642
    s_lshl_b32 s38, s36, 7
    s_add_u32 s37, s37, s38
    v_lshlrev_b32 v248, 1, v1
    s_add_u32 s38, s37, 2
    buffer_load_ushort v216, v248, s[16:19], s38 offen
    buffer_load_ushort v232, v248, s[20:23], s38 offen
    s_add_u32 s38, s37, 41090
    buffer_load_ushort v217, v248, s[16:19], s38 offen
    buffer_load_ushort v233, v248, s[20:23], s38 offen
    s_add_u32 s38, s37, 82178
    buffer_load_ushort v218, v248, s[16:19], s38 offen
    buffer_load_ushort v234, v248, s[20:23], s38 offen
    s_add_u32 s38, s37, 123266
    buffer_load_ushort v219, v248, s[16:19], s38 offen
    buffer_load_ushort v235, v248, s[20:23], s38 offen
    s_add_u32 s38, s37, 328706
    buffer_load_ushort v220, v248, s[16:19], s38 offen
    buffer_load_ushort v236, v248, s[20:23], s38 offen
    s_add_u32 s38, s37, 369794
    buffer_load_ushort v221, v248, s[16:19], s38 offen
    buffer_load_ushort v237, v248, s[20:23], s38 offen
    s_add_u32 s38, s37, 410882
    buffer_load_ushort v222, v248, s[16:19], s38 offen
    buffer_load_ushort v238, v248, s[20:23], s38 offen
    s_add_u32 s38, s37, 451970
    buffer_load_ushort v223, v248, s[16:19], s38 offen
    buffer_load_ushort v239, v248, s[20:23], s38 offen
    s_add_u32 s38, s37, 657410
    buffer_load_ushort v224, v248, s[16:19], s38 offen
    buffer_load_ushort v240, v248, s[20:23], s38 offen
    s_add_u32 s38, s37, 698498
    buffer_load_ushort v225, v248, s[16:19], s38 offen
    buffer_load_ushort v241, v248, s[20:23], s38 offen
    s_add_u32 s38, s37, 739586
    buffer_load_ushort v226, v248, s[16:19], s38 offen
    buffer_load_ushort v242, v248, s[20:23], s38 offen
    s_add_u32 s38, s37, 780674
    buffer_load_ushort v227, v248, s[16:19], s38 offen
    buffer_load_ushort v243, v248, s[20:23], s38 offen
    s_add_u32 s38, s37, 986114
    buffer_load_ushort v228, v248, s[16:19], s38 offen
    buffer_load_ushort v244, v248, s[20:23], s38 offen
    s_add_u32 s38, s37, 1027202
    buffer_load_ushort v229, v248, s[16:19], s38 offen
    buffer_load_ushort v245, v248, s[20:23], s38 offen
    s_add_u32 s38, s37, 1068290
    buffer_load_ushort v230, v248, s[16:19], s38 offen
    buffer_load_ushort v246, v248, s[20:23], s38 offen
    s_add_u32 s38, s37, 1109378
    buffer_load_ushort v231, v248, s[16:19], s38 offen
    buffer_load_ushort v247, v248, s[20:23], s38 offen
    s_mul_i32 s62, s35, 20480
    s_lshl_b32 s38, s36, 10
    s_add_u32 s62, s62, s38
    s_add_u32 s62, s62, 8388608
R_252:
    s_mul_i32 s34, s29, 320
    v_bfe_u32 v2, v1, 0, 2
    v_mul_u32_u24 v2, 1280, v2
    v_bfe_u32 v172, v1, 2, 1
    v_mul_u32_u24 v172, 10240, v172
    v_add_u32 v2, v2, v172
    v_bfe_u32 v172, v1, 3, 1
    v_mul_u32_u24 v172, 5120, v172
    v_add_u32 v2, v2, v172
    v_bfe_u32 v172, v1, 4, 1
    v_mul_u32_u24 v172, 20480, v172
    v_add_u32 v2, v2, v172
    v_bfe_u32 v172, v1, 5, 1
    v_lshl_add_u32 v2, v172, 4, v2
    v_add_u32 v2, s34, v2
    s_lshl_b32 s34, s29, 13
    v_add_u32 v4, s34, v0
    s_lshl_b32 s34, s29, 3
    s_add_u32 s34, s34, 65536
    v_bfe_u32 v5, v1, 0, 5
    v_mul_u32_u24 v5, 32, v5
    v_add_u32 v5, s34, v5
    s_lshl_b32 s35, s29, 11
    s_lshl_b32 s36, s29, 8
    s_add_u32 s36, s36, 67584
    s_lshr_b32 s34, s29, 1
    s_lshl_b32 s34, s34, 12
    s_and_b32 s37, s29, 1
    s_lshl_b32 s37, s37, 8
    s_add_u32 s34, s34, s37
    v_bfe_u32 v3, v1, 1, 1
    v_mul_u32_u24 v3, 2048, v3
    v_bfe_u32 v172, v1, 0, 1
    v_lshl_add_u32 v3, v172, 9, v3
    v_bfe_u32 v172, v1, 2, 4
    v_lshl_add_u32 v3, v172, 4, v3
    v_add_u32 v3, s34, v3
    v_bfe_u32 v10, v1, 0, 2
    v_mul_u32_u24 v10, 32, v10
    v_add_u32 v10, s36, v10
    s_lshl_b32 s34, s29, 10
    v_add_u32 v7, s34, v0
    v_bfe_u32 v6, v1, 0, 5
    v_mul_u32_u24 v6, 32, v6
    v_add_u32 v6, 65536, v6
    v_bfe_u32 v9, v1, 0, 2
    v_mul_u32_u24 v9, 4, v9
    v_bfe_u32 v172, v1, 2, 1
    v_lshl_add_u32 v9, v172, 5, v9
    v_bfe_u32 v172, v1, 3, 1
    v_lshl_add_u32 v9, v172, 4, v9
    v_bfe_u32 v172, v1, 4, 1
    v_lshl_add_u32 v9, v172, 6, v9
    v_add_u32 v9, s36, v9
    s_mov_b32 s44, s66
    s_mov_b32 s47, 19
    s_mov_b32 s46, 64
    s_mov_b32 s50, 0
    s_mov_b32 s52, 0
    s_lshl_b32 s51, s67, 12
    s_add_u32 s51, s51, 20971520
    s_mov_b32 s58, 40960
    s_mul_i32 s54, s44, 40960
    s_add_u32 s56, s54, s52
    s_add_u32 s54, s54, s50
    buffer_load_dwordx4 v[16:19], v2, s[8:11], s54 offen offset:0
    buffer_load_dwordx4 v[20:23], v2, s[8:11], s54 offen offset:32
    buffer_load_dwordx4 v[24:27], v2, s[8:11], s54 offen offset:64
    buffer_load_dwordx4 v[28:31], v2, s[8:11], s54 offen offset:96
    buffer_load_dwordx4 v[32:35], v2, s[8:11], s54 offen offset:128
    buffer_load_dwordx4 v[36:39], v2, s[8:11], s54 offen offset:160
    buffer_load_dwordx4 v[40:43], v2, s[8:11], s54 offen offset:192
    buffer_load_dwordx4 v[44:47], v2, s[8:11], s54 offen offset:224
    buffer_load_dwordx4 v[48:51], v2, s[8:11], s54 offen offset:256
    buffer_load_dwordx4 v[52:55], v2, s[8:11], s54 offen offset:288
    s_lshl_b32 s34, s64, 3
    s_add_u32 s34, s34, 48
    s_cmp_eq_u32 s64, 2
    s_cselect_b32 s34, 40, s34
    s_load_dwordx2 s[20:21], s[0:1], s34
    s_mov_b32 s22, 5242880
    s_mov_b32 s23, 0x20000
    s_waitcnt lgkmcnt(0)
    v_bfe_u32 v14, v1, 2, 4
    v_mul_u32_u24 v14, 8192, v14
    v_bfe_u32 v15, v1, 0, 2
    v_lshl_add_u32 v14, v15, 4, v14
    s_lshl_b32 s38, s29, 6
    s_lshl_b32 s35, s63, 8
    s_add_u32 s38, s38, s35
    s_add_u32 m0, s60, 0
    s_add_u32 s39, s38, 0
    buffer_load_dwordx4 v14, s[20:23], s39 offen lds
    s_add_u32 m0, s60, 1024
    s_add_u32 s39, s38, 131072
    buffer_load_dwordx4 v14, s[20:23], s39 offen lds
    s_add_u32 m0, s60, 2048
    s_add_u32 s39, s38, 262144
    buffer_load_dwordx4 v14, s[20:23], s39 offen lds
    s_add_u32 m0, s60, 3072
    s_add_u32 s39, s38, 393216
    buffer_load_dwordx4 v14, s[20:23], s39 offen lds
    s_add_u32 m0, s60, 4096
    s_add_u32 s39, s38, 524288
    buffer_load_dwordx4 v14, s[20:23], s39 offen lds
    s_add_u32 m0, s60, 5120
    s_add_u32 s39, s38, 655360
    buffer_load_dwordx4 v14, s[20:23], s39 offen lds
    s_add_u32 m0, s60, 6144
    s_add_u32 s39, s38, 786432
    buffer_load_dwordx4 v14, s[20:23], s39 offen lds
    s_add_u32 m0, s60, 7168
    s_add_u32 s39, s38, 917504
    buffer_load_dwordx4 v14, s[20:23], s39 offen lds
    s_add_u32 m0, s60, 8192
    s_add_u32 s39, s38, 1048576
    buffer_load_dwordx4 v14, s[20:23], s39 offen lds
    s_add_u32 m0, s60, 9216
    s_add_u32 s39, s38, 1179648
    buffer_load_dwordx4 v14, s[20:23], s39 offen lds
    s_add_u32 m0, s60, 10240
    s_add_u32 s39, s38, 1310720
    buffer_load_dwordx4 v14, s[20:23], s39 offen lds
    s_add_u32 m0, s60, 11264
    s_add_u32 s39, s38, 1441792
    buffer_load_dwordx4 v14, s[20:23], s39 offen lds
    s_add_u32 m0, s60, 12288
    s_add_u32 s39, s38, 1572864
    buffer_load_dwordx4 v14, s[20:23], s39 offen lds
    s_add_u32 m0, s60, 13312
    s_add_u32 s39, s38, 1703936
    buffer_load_dwordx4 v14, s[20:23], s39 offen lds
    s_add_u32 m0, s60, 14336
    s_add_u32 s39, s38, 1835008
    buffer_load_dwordx4 v14, s[20:23], s39 offen lds
    s_add_u32 m0, s60, 15360
    s_add_u32 s39, s38, 1966080
    buffer_load_dwordx4 v14, s[20:23], s39 offen lds
    s_add_u32 m0, s60, 16384
    s_add_u32 s39, s38, 2097152
    buffer_load_dwordx4 v14, s[20:23], s39 offen lds
    s_add_u32 m0, s60, 17408
    s_add_u32 s39, s38, 2228224
    buffer_load_dwordx4 v14, s[20:23], s39 offen lds
    s_add_u32 m0, s60, 18432
    s_add_u32 s39, s38, 2359296
    buffer_load_dwordx4 v14, s[20:23], s39 offen lds
    s_add_u32 m0, s60, 19456
    s_add_u32 s39, s38, 2490368
    buffer_load_dwordx4 v14, s[20:23], s39 offen lds
    s_mov_b32 s35, 0x3acccccd
    s_lshl_b32 s34, s67, 6
    s_add_u32 s34, s34, 0
    s_lshr_b32 s34, s34, 1
    s_add_u32 s34, s34, 1
    v_bfe_u32 v173, v1, 1, 4
    v_add_u32 v173, s34, v173
    s_mul_i32 s36, s29, 160
    v_bfe_u32 v172, v1, 5, 1
    v_mul_u32_u24 v172, 8, v172
    v_add_u32 v172, s36, v172
    v_mul_u32_u24 v172, v172, v173
    v_and_b32 v174, 1, v1
    v_mul_u32_u24 v174, 160, v174
    v_add_u32 v172, v172, v174
    v_cvt_f32_u32 v172, v172
    v_cvt_f32_u32 v173, v173
    v_mul_f32 v172, s35, v172
    v_mul_f32 v173, s35, v173
    v_fract_f32 v172, v172
    v_fmamk_f32 v174, v173, 0x0, v172
    v_fmamk_f32 v175, v173, 0x3f800000, v172
    v_cos_f32 v175, v175
    v_cos_f32 v174, v174
    s_nop 0
    v_cvt_pk_bf16_f32 v178, v174, v175
    v_fmamk_f32 v176, v173, 0x40000000, v172
    v_fmamk_f32 v177, v173, 0x40400000, v172
    v_cos_f32 v177, v177
    v_cos_f32 v176, v176
    v_accvgpr_write_b32 a160, v178
    v_cvt_pk_bf16_f32 v178, v176, v177
    v_fmamk_f32 v174, v173, 0x40800000, v172
    v_fmamk_f32 v175, v173, 0x40a00000, v172
    v_cos_f32 v175, v175
    v_cos_f32 v174, v174
    v_accvgpr_write_b32 a161, v178
    v_cvt_pk_bf16_f32 v178, v174, v175
    v_fmamk_f32 v176, v173, 0x40c00000, v172
    v_fmamk_f32 v177, v173, 0x40e00000, v172
    v_cos_f32 v177, v177
    v_cos_f32 v176, v176
    v_accvgpr_write_b32 a162, v178
    v_cvt_pk_bf16_f32 v178, v176, v177
    v_fmamk_f32 v174, v173, 0x41800000, v172
    v_fmamk_f32 v175, v173, 0x41880000, v172
    v_cos_f32 v175, v175
    v_cos_f32 v174, v174
    v_accvgpr_write_b32 a163, v178
    v_cvt_pk_bf16_f32 v178, v174, v175
    v_fmamk_f32 v176, v173, 0x41900000, v172
    v_fmamk_f32 v177, v173, 0x41980000, v172
    v_cos_f32 v177, v177
    v_cos_f32 v176, v176
    v_accvgpr_write_b32 a164, v178
    v_cvt_pk_bf16_f32 v178, v176, v177
    v_fmamk_f32 v174, v173, 0x41a00000, v172
    v_fmamk_f32 v175, v173, 0x41a80000, v172
    v_cos_f32 v175, v175
    v_cos_f32 v174, v174
    v_accvgpr_write_b32 a165, v178
    v_cvt_pk_bf16_f32 v178, v174, v175
    v_fmamk_f32 v176, v173, 0x41b00000, v172
    v_fmamk_f32 v177, v173, 0x41b80000, v172
    v_cos_f32 v177, v177
    v_cos_f32 v176, v176
    v_accvgpr_write_b32 a166, v178
    v_cvt_pk_bf16_f32 v178, v176, v177
    v_fmamk_f32 v174, v173, 0x42000000, v172
    v_fmamk_f32 v175, v173, 0x42040000, v172
    v_cos_f32 v175, v175
    v_cos_f32 v174, v174
    v_accvgpr_write_b32 a167, v178
    v_cvt_pk_bf16_f32 v178, v174, v175
    v_fmamk_f32 v176, v173, 0x42080000, v172
    v_fmamk_f32 v177, v173, 0x420c0000, v172
    v_cos_f32 v177, v177
    v_cos_f32 v176, v176
    v_accvgpr_write_b32 a168, v178
    v_cvt_pk_bf16_f32 v178, v176, v177
    v_fmamk_f32 v174, v173, 0x42100000, v172
    v_fmamk_f32 v175, v173, 0x42140000, v172
    v_cos_f32 v175, v175
    v_cos_f32 v174, v174
    v_accvgpr_write_b32 a169, v178
    v_cvt_pk_bf16_f32 v178, v174, v175
    v_fmamk_f32 v176, v173, 0x42180000, v172
    v_fmamk_f32 v177, v173, 0x421c0000, v172
    v_cos_f32 v177, v177
    v_cos_f32 v176, v176
    v_accvgpr_write_b32 a170, v178
    v_cvt_pk_bf16_f32 v178, v176, v177
    v_fmamk_f32 v174, v173, 0x42400000, v172
    v_fmamk_f32 v175, v173, 0x42440000, v172
    v_cos_f32 v175, v175
    v_cos_f32 v174, v174
    v_accvgpr_write_b32 a171, v178
    v_cvt_pk_bf16_f32 v178, v174, v175
    v_fmamk_f32 v176, v173, 0x42480000, v172
    v_fmamk_f32 v177, v173, 0x424c0000, v172
    v_cos_f32 v177, v177
    v_cos_f32 v176, v176
    v_accvgpr_write_b32 a172, v178
    v_cvt_pk_bf16_f32 v178, v176, v177
    v_fmamk_f32 v174, v173, 0x42500000, v172
    v_fmamk_f32 v175, v173, 0x42540000, v172
    v_cos_f32 v175, v175
    v_cos_f32 v174, v174
    v_accvgpr_write_b32 a173, v178
    v_cvt_pk_bf16_f32 v178, v174, v175
    v_fmamk_f32 v176, v173, 0x42580000, v172
    v_fmamk_f32 v177, v173, 0x425c0000, v172
    v_cos_f32 v177, v177
    v_cos_f32 v176, v176
    v_accvgpr_write_b32 a174, v178
    v_cvt_pk_bf16_f32 v178, v176, v177
    v_fmamk_f32 v174, v173, 0x42800000, v172
    v_fmamk_f32 v175, v173, 0x42820000, v172
    v_cos_f32 v175, v175
    v_cos_f32 v174, v174
    v_accvgpr_write_b32 a175, v178
    v_cvt_pk_bf16_f32 v178, v174, v175
    v_fmamk_f32 v176, v173, 0x42840000, v172
    v_fmamk_f32 v177, v173, 0x42860000, v172
    v_cos_f32 v177, v177
    v_cos_f32 v176, v176
    v_accvgpr_write_b32 a176, v178
    v_cvt_pk_bf16_f32 v178, v176, v177
    v_fmamk_f32 v174, v173, 0x42880000, v172
    v_fmamk_f32 v175, v173, 0x428a0000, v172
    v_cos_f32 v175, v175
    v_cos_f32 v174, v174
    v_accvgpr_write_b32 a177, v178
    v_cvt_pk_bf16_f32 v178, v174, v175
    v_fmamk_f32 v176, v173, 0x428c0000, v172
    v_fmamk_f32 v177, v173, 0x428e0000, v172
    v_cos_f32 v177, v177
    v_cos_f32 v176, v176
    v_accvgpr_write_b32 a178, v178
    v_cvt_pk_bf16_f32 v178, v176, v177
    v_fmamk_f32 v174, v173, 0x42a00000, v172
    v_fmamk_f32 v175, v173, 0x42a20000, v172
    v_cos_f32 v175, v175
    v_cos_f32 v174, v174
    v_accvgpr_write_b32 a179, v178
    v_cvt_pk_bf16_f32 v178, v174, v175
    v_fmamk_f32 v176, v173, 0x42a40000, v172
    v_fmamk_f32 v177, v173, 0x42a60000, v172
    v_cos_f32 v177, v177
    v_cos_f32 v176, v176
    v_accvgpr_write_b32 a180, v178
    v_cvt_pk_bf16_f32 v178, v176, v177
    v_fmamk_f32 v174, v173, 0x42a80000, v172
    v_fmamk_f32 v175, v173, 0x42aa0000, v172
    v_cos_f32 v175, v175
    v_cos_f32 v174, v174
    v_accvgpr_write_b32 a181, v178
    v_cvt_pk_bf16_f32 v178, v174, v175
    v_fmamk_f32 v176, v173, 0x42ac0000, v172
    v_fmamk_f32 v177, v173, 0x42ae0000, v172
    v_cos_f32 v177, v177
    v_cos_f32 v176, v176
    v_accvgpr_write_b32 a182, v178
    v_cvt_pk_bf16_f32 v178, v176, v177
    v_fmamk_f32 v174, v173, 0x42c00000, v172
    v_fmamk_f32 v175, v173, 0x42c20000, v172
    v_cos_f32 v175, v175
    v_cos_f32 v174, v174
    v_accvgpr_write_b32 a183, v178
    v_cvt_pk_bf16_f32 v178, v174, v175
    v_fmamk_f32 v176, v173, 0x42c40000, v172
    v_fmamk_f32 v177, v173, 0x42c60000, v172
    v_cos_f32 v177, v177
    v_cos_f32 v176, v176
    v_accvgpr_write_b32 a184, v178
    v_cvt_pk_bf16_f32 v178, v176, v177
    v_fmamk_f32 v174, v173, 0x42c80000, v172
    v_fmamk_f32 v175, v173, 0x42ca0000, v172
    v_cos_f32 v175, v175
    v_cos_f32 v174, v174
    v_accvgpr_write_b32 a185, v178
    v_cvt_pk_bf16_f32 v178, v174, v175
    v_fmamk_f32 v176, v173, 0x42cc0000, v172
    v_fmamk_f32 v177, v173, 0x42ce0000, v172
    v_cos_f32 v177, v177
    v_cos_f32 v176, v176
    v_accvgpr_write_b32 a186, v178
    v_cvt_pk_bf16_f32 v178, v176, v177
    v_fmamk_f32 v174, v173, 0x42e00000, v172
    v_fmamk_f32 v175, v173, 0x42e20000, v172
    v_cos_f32 v175, v175
    v_cos_f32 v174, v174
    v_accvgpr_write_b32 a187, v178
    v_cvt_pk_bf16_f32 v178, v174, v175
    v_fmamk_f32 v176, v173, 0x42e40000, v172
    v_fmamk_f32 v177, v173, 0x42e60000, v172
    v_cos_f32 v177, v177
    v_cos_f32 v176, v176
    v_accvgpr_write_b32 a188, v178
    v_cvt_pk_bf16_f32 v178, v176, v177
    v_fmamk_f32 v174, v173, 0x42e80000, v172
    v_fmamk_f32 v175, v173, 0x42ea0000, v172
    v_cos_f32 v175, v175
    v_cos_f32 v174, v174
    v_accvgpr_write_b32 a189, v178
    v_cvt_pk_bf16_f32 v178, v174, v175
    v_fmamk_f32 v176, v173, 0x42ec0000, v172
    v_fmamk_f32 v177, v173, 0x42ee0000, v172
    v_cos_f32 v177, v177
    v_cos_f32 v176, v176
    v_accvgpr_write_b32 a190, v178
    v_cvt_pk_bf16_f32 v178, v176, v177
    v_fmamk_f32 v174, v173, 0x43000000, v172
    v_fmamk_f32 v175, v173, 0x43010000, v172
    v_cos_f32 v175, v175
    v_cos_f32 v174, v174
    v_accvgpr_write_b32 a191, v178
    v_cvt_pk_bf16_f32 v178, v174, v175
    v_fmamk_f32 v176, v173, 0x43020000, v172
    v_fmamk_f32 v177, v173, 0x43030000, v172
    v_cos_f32 v177, v177
    v_cos_f32 v176, v176
    v_accvgpr_write_b32 a192, v178
    v_cvt_pk_bf16_f32 v178, v176, v177
    v_fmamk_f32 v174, v173, 0x43040000, v172
    v_fmamk_f32 v175, v173, 0x43050000, v172
    v_cos_f32 v175, v175
    v_cos_f32 v174, v174
    v_accvgpr_write_b32 a193, v178
    v_cvt_pk_bf16_f32 v178, v174, v175
    v_fmamk_f32 v176, v173, 0x43060000, v172
    v_fmamk_f32 v177, v173, 0x43070000, v172
    v_cos_f32 v177, v177
    v_cos_f32 v176, v176
    v_accvgpr_write_b32 a194, v178
    v_cvt_pk_bf16_f32 v178, v176, v177
    v_fmamk_f32 v174, v173, 0x43100000, v172
    v_fmamk_f32 v175, v173, 0x43110000, v172
    v_cos_f32 v175, v175
    v_cos_f32 v174, v174
    v_accvgpr_write_b32 a195, v178
    v_cvt_pk_bf16_f32 v178, v174, v175
    v_fmamk_f32 v176, v173, 0x43120000, v172
    v_fmamk_f32 v177, v173, 0x43130000, v172
    v_cos_f32 v177, v177
    v_cos_f32 v176, v176
    v_accvgpr_write_b32 a196, v178
    v_cvt_pk_bf16_f32 v178, v176, v177
    v_fmamk_f32 v174, v173, 0x43140000, v172
    v_fmamk_f32 v175, v173, 0x43150000, v172
    v_cos_f32 v175, v175
    v_cos_f32 v174, v174
    v_accvgpr_write_b32 a197, v178
    v_cvt_pk_bf16_f32 v178, v174, v175
    v_fmamk_f32 v176, v173, 0x43160000, v172
    v_fmamk_f32 v177, v173, 0x43170000, v172
    v_cos_f32 v177, v177
    v_cos_f32 v176, v176
    v_accvgpr_write_b32 a198, v178
    v_cvt_pk_bf16_f32 v178, v176, v177
    v_accvgpr_write_b32 a199, v178
    s_lshl_b32 s34, s67, 6
    s_add_u32 s34, s34, 32
    s_lshr_b32 s34, s34, 1
    s_add_u32 s34, s34, 1
    v_bfe_u32 v173, v1, 1, 4
    v_add_u32 v173, s34, v173
    s_mul_i32 s36, s29, 160
    v_bfe_u32 v172, v1, 5, 1
    v_mul_u32_u24 v172, 8, v172
    v_add_u32 v172, s36, v172
    v_mul_u32_u24 v172, v172, v173
    v_and_b32 v174, 1, v1
    v_mul_u32_u24 v174, 160, v174
    v_add_u32 v172, v172, v174
    v_cvt_f32_u32 v172, v172
    v_cvt_f32_u32 v173, v173
    v_mul_f32 v172, s35, v172
    v_mul_f32 v173, s35, v173
    v_fract_f32 v172, v172
    v_fmamk_f32 v174, v173, 0x0, v172
    v_fmamk_f32 v175, v173, 0x3f800000, v172
    v_cos_f32 v175, v175
    v_cos_f32 v174, v174
    s_nop 0
    v_cvt_pk_bf16_f32 v178, v174, v175
    v_fmamk_f32 v176, v173, 0x40000000, v172
    v_fmamk_f32 v177, v173, 0x40400000, v172
    v_cos_f32 v177, v177
    v_cos_f32 v176, v176
    v_accvgpr_write_b32 a200, v178
    v_cvt_pk_bf16_f32 v178, v176, v177
    v_fmamk_f32 v174, v173, 0x40800000, v172
    v_fmamk_f32 v175, v173, 0x40a00000, v172
    v_cos_f32 v175, v175
    v_cos_f32 v174, v174
    v_accvgpr_write_b32 a201, v178
    v_cvt_pk_bf16_f32 v178, v174, v175
    v_fmamk_f32 v176, v173, 0x40c00000, v172
    v_fmamk_f32 v177, v173, 0x40e00000, v172
    v_cos_f32 v177, v177
    v_cos_f32 v176, v176
    v_accvgpr_write_b32 a202, v178
    v_cvt_pk_bf16_f32 v178, v176, v177
    v_fmamk_f32 v174, v173, 0x41800000, v172
    v_fmamk_f32 v175, v173, 0x41880000, v172
    v_cos_f32 v175, v175
    v_cos_f32 v174, v174
    v_accvgpr_write_b32 a203, v178
    v_cvt_pk_bf16_f32 v178, v174, v175
    v_fmamk_f32 v176, v173, 0x41900000, v172
    v_fmamk_f32 v177, v173, 0x41980000, v172
    v_cos_f32 v177, v177
    v_cos_f32 v176, v176
    v_accvgpr_write_b32 a204, v178
    v_cvt_pk_bf16_f32 v178, v176, v177
    v_fmamk_f32 v174, v173, 0x41a00000, v172
    v_fmamk_f32 v175, v173, 0x41a80000, v172
    v_cos_f32 v175, v175
    v_cos_f32 v174, v174
    v_accvgpr_write_b32 a205, v178
    v_cvt_pk_bf16_f32 v178, v174, v175
    v_fmamk_f32 v176, v173, 0x41b00000, v172
    v_fmamk_f32 v177, v173, 0x41b80000, v172
    v_cos_f32 v177, v177
    v_cos_f32 v176, v176
    v_accvgpr_write_b32 a206, v178
    v_cvt_pk_bf16_f32 v178, v176, v177
    v_fmamk_f32 v174, v173, 0x42000000, v172
    v_fmamk_f32 v175, v173, 0x42040000, v172
    v_cos_f32 v175, v175
    v_cos_f32 v174, v174
    v_accvgpr_write_b32 a207, v178
    v_cvt_pk_bf16_f32 v178, v174, v175
    v_fmamk_f32 v176, v173, 0x42080000, v172
    v_fmamk_f32 v177, v173, 0x420c0000, v172
    v_cos_f32 v177, v177
    v_cos_f32 v176, v176
    v_accvgpr_write_b32 a208, v178
    v_cvt_pk_bf16_f32 v178, v176, v177
    v_fmamk_f32 v174, v173, 0x42100000, v172
    v_fmamk_f32 v175, v173, 0x42140000, v172
    v_cos_f32 v175, v175
    v_cos_f32 v174, v174
    v_accvgpr_write_b32 a209, v178
    v_cvt_pk_bf16_f32 v178, v174, v175
    v_fmamk_f32 v176, v173, 0x42180000, v172
    v_fmamk_f32 v177, v173, 0x421c0000, v172
    v_cos_f32 v177, v177
    v_cos_f32 v176, v176
    v_accvgpr_write_b32 a210, v178
    v_cvt_pk_bf16_f32 v178, v176, v177
    v_fmamk_f32 v174, v173, 0x42400000, v172
    v_fmamk_f32 v175, v173, 0x42440000, v172
    v_cos_f32 v175, v175
    v_cos_f32 v174, v174
    v_accvgpr_write_b32 a211, v178
    v_cvt_pk_bf16_f32 v178, v174, v175
    v_fmamk_f32 v176, v173, 0x42480000, v172
    v_fmamk_f32 v177, v173, 0x424c0000, v172
    v_cos_f32 v177, v177
    v_cos_f32 v176, v176
    v_accvgpr_write_b32 a212, v178
    v_cvt_pk_bf16_f32 v178, v176, v177
    v_fmamk_f32 v174, v173, 0x42500000, v172
    v_fmamk_f32 v175, v173, 0x42540000, v172
    v_cos_f32 v175, v175
    v_cos_f32 v174, v174
    v_accvgpr_write_b32 a213, v178
    v_cvt_pk_bf16_f32 v178, v174, v175
    v_fmamk_f32 v176, v173, 0x42580000, v172
    v_fmamk_f32 v177, v173, 0x425c0000, v172
    v_cos_f32 v177, v177
    v_cos_f32 v176, v176
    v_accvgpr_write_b32 a214, v178
    v_cvt_pk_bf16_f32 v178, v176, v177
    v_fmamk_f32 v174, v173, 0x42800000, v172
    v_fmamk_f32 v175, v173, 0x42820000, v172
    v_cos_f32 v175, v175
    v_cos_f32 v174, v174
    v_accvgpr_write_b32 a215, v178
    v_cvt_pk_bf16_f32 v178, v174, v175
    v_fmamk_f32 v176, v173, 0x42840000, v172
    v_fmamk_f32 v177, v173, 0x42860000, v172
    v_cos_f32 v177, v177
    v_cos_f32 v176, v176
    v_accvgpr_write_b32 a216, v178
    v_cvt_pk_bf16_f32 v178, v176, v177
    v_fmamk_f32 v174, v173, 0x42880000, v172
    v_fmamk_f32 v175, v173, 0x428a0000, v172
    v_cos_f32 v175, v175
    v_cos_f32 v174, v174
    v_accvgpr_write_b32 a217, v178
    v_cvt_pk_bf16_f32 v178, v174, v175
    v_fmamk_f32 v176, v173, 0x428c0000, v172
    v_fmamk_f32 v177, v173, 0x428e0000, v172
    v_cos_f32 v177, v177
    v_cos_f32 v176, v176
    v_accvgpr_write_b32 a218, v178
    v_cvt_pk_bf16_f32 v178, v176, v177
    v_fmamk_f32 v174, v173, 0x42a00000, v172
    v_fmamk_f32 v175, v173, 0x42a20000, v172
    v_cos_f32 v175, v175
    v_cos_f32 v174, v174
    v_accvgpr_write_b32 a219, v178
    v_cvt_pk_bf16_f32 v178, v174, v175
    v_fmamk_f32 v176, v173, 0x42a40000, v172
    v_fmamk_f32 v177, v173, 0x42a60000, v172
    v_cos_f32 v177, v177
    v_cos_f32 v176, v176
    v_accvgpr_write_b32 a220, v178
    v_cvt_pk_bf16_f32 v178, v176, v177
    v_fmamk_f32 v174, v173, 0x42a80000, v172
    v_fmamk_f32 v175, v173, 0x42aa0000, v172
    v_cos_f32 v175, v175
    v_cos_f32 v174, v174
    v_accvgpr_write_b32 a221, v178
    v_cvt_pk_bf16_f32 v178, v174, v175
    v_fmamk_f32 v176, v173, 0x42ac0000, v172
    v_fmamk_f32 v177, v173, 0x42ae0000, v172
    v_cos_f32 v177, v177
    v_cos_f32 v176, v176
    v_accvgpr_write_b32 a222, v178
    v_cvt_pk_bf16_f32 v178, v176, v177
    v_fmamk_f32 v174, v173, 0x42c00000, v172
    v_fmamk_f32 v175, v173, 0x42c20000, v172
    v_cos_f32 v175, v175
    v_cos_f32 v174, v174
    v_accvgpr_write_b32 a223, v178
    v_cvt_pk_bf16_f32 v178, v174, v175
    v_fmamk_f32 v176, v173, 0x42c40000, v172
    v_fmamk_f32 v177, v173, 0x42c60000, v172
    v_cos_f32 v177, v177
    v_cos_f32 v176, v176
    v_accvgpr_write_b32 a224, v178
    v_cvt_pk_bf16_f32 v178, v176, v177
    v_fmamk_f32 v174, v173, 0x42c80000, v172
    v_fmamk_f32 v175, v173, 0x42ca0000, v172
    v_cos_f32 v175, v175
    v_cos_f32 v174, v174
    v_accvgpr_write_b32 a225, v178
    v_cvt_pk_bf16_f32 v178, v174, v175
    v_fmamk_f32 v176, v173, 0x42cc0000, v172
    v_fmamk_f32 v177, v173, 0x42ce0000, v172
    v_cos_f32 v177, v177
    v_cos_f32 v176, v176
    v_accvgpr_write_b32 a226, v178
    v_cvt_pk_bf16_f32 v178, v176, v177
    v_fmamk_f32 v174, v173, 0x42e00000, v172
    v_fmamk_f32 v175, v173, 0x42e20000, v172
    v_cos_f32 v175, v175
    v_cos_f32 v174, v174
    v_accvgpr_write_b32 a227, v178
    v_cvt_pk_bf16_f32 v178, v174, v175
    v_fmamk_f32 v176, v173, 0x42e40000, v172
    v_fmamk_f32 v177, v173, 0x42e60000, v172
    v_cos_f32 v177, v177
    v_cos_f32 v176, v176
    v_accvgpr_write_b32 a228, v178
    v_cvt_pk_bf16_f32 v178, v176, v177
    v_fmamk_f32 v174, v173, 0x42e80000, v172
    v_fmamk_f32 v175, v173, 0x42ea0000, v172
    v_cos_f32 v175, v175
    v_cos_f32 v174, v174
    v_accvgpr_write_b32 a229, v178
    v_cvt_pk_bf16_f32 v178, v174, v175
    v_fmamk_f32 v176, v173, 0x42ec0000, v172
    v_fmamk_f32 v177, v173, 0x42ee0000, v172
    v_cos_f32 v177, v177
    v_cos_f32 v176, v176
    v_accvgpr_write_b32 a230, v178
    v_cvt_pk_bf16_f32 v178, v176, v177
    v_fmamk_f32 v174, v173, 0x43000000, v172
    v_fmamk_f32 v175, v173, 0x43010000, v172
    v_cos_f32 v175, v175
    v_cos_f32 v174, v174
    v_accvgpr_write_b32 a231, v178
    v_cvt_pk_bf16_f32 v178, v174, v175
    v_fmamk_f32 v176, v173, 0x43020000, v172
    v_fmamk_f32 v177, v173, 0x43030000, v172
    v_cos_f32 v177, v177
    v_cos_f32 v176, v176
    v_accvgpr_write_b32 a232, v178
    v_cvt_pk_bf16_f32 v178, v176, v177
    v_fmamk_f32 v174, v173, 0x43040000, v172
    v_fmamk_f32 v175, v173, 0x43050000, v172
    v_cos_f32 v175, v175
    v_cos_f32 v174, v174
    v_accvgpr_write_b32 a233, v178
    v_cvt_pk_bf16_f32 v178, v174, v175
    v_fmamk_f32 v176, v173, 0x43060000, v172
    v_fmamk_f32 v177, v173, 0x43070000, v172
    v_cos_f32 v177, v177
    v_cos_f32 v176, v176
    v_accvgpr_write_b32 a234, v178
    v_cvt_pk_bf16_f32 v178, v176, v177
    v_fmamk_f32 v174, v173, 0x43100000, v172
    v_fmamk_f32 v175, v173, 0x43110000, v172
    v_cos_f32 v175, v175
    v_cos_f32 v174, v174
    v_accvgpr_write_b32 a235, v178
    v_cvt_pk_bf16_f32 v178, v174, v175
    v_fmamk_f32 v176, v173, 0x43120000, v172
    v_fmamk_f32 v177, v173, 0x43130000, v172
    v_cos_f32 v177, v177
    v_cos_f32 v176, v176
    v_accvgpr_write_b32 a236, v178
    v_cvt_pk_bf16_f32 v178, v176, v177
    v_fmamk_f32 v174, v173, 0x43140000, v172
    v_fmamk_f32 v175, v173, 0x43150000, v172
    v_cos_f32 v175, v175
    v_cos_f32 v174, v174
    v_accvgpr_write_b32 a237, v178
    v_cvt_pk_bf16_f32 v178, v174, v175
    v_fmamk_f32 v176, v173, 0x43160000, v172
    v_fmamk_f32 v177, v173, 0x43170000, v172
    v_cos_f32 v177, v177
    v_cos_f32 v176, v176
    v_accvgpr_write_b32 a238, v178
    v_cvt_pk_bf16_f32 v178, v176, v177
    v_accvgpr_write_b32 a239, v178
    s_cmp_ge_u32 s28, 160
    s_cbranch_scc1 R_253
    s_waitcnt vmcnt(60)
    v_lshl_or_b32 v216, v232, 16, v216
    s_waitcnt vmcnt(58)
    v_lshl_or_b32 v217, v233, 16, v217
    s_waitcnt vmcnt(56)
    v_lshl_or_b32 v218, v234, 16, v218
    s_waitcnt vmcnt(54)
    v_lshl_or_b32 v219, v235, 16, v219
    s_waitcnt vmcnt(52)
    v_lshl_or_b32 v220, v236, 16, v220
    s_waitcnt vmcnt(50)
    v_lshl_or_b32 v221, v237, 16, v221
    s_waitcnt vmcnt(48)
    v_lshl_or_b32 v222, v238, 16, v222
    s_waitcnt vmcnt(46)
    v_lshl_or_b32 v223, v239, 16, v223
    s_waitcnt vmcnt(44)
    v_lshl_or_b32 v224, v240, 16, v224
    s_waitcnt vmcnt(42)
    v_lshl_or_b32 v225, v241, 16, v225
    s_waitcnt vmcnt(40)
    v_lshl_or_b32 v226, v242, 16, v226
    s_waitcnt vmcnt(38)
    v_lshl_or_b32 v227, v243, 16, v227
    s_waitcnt vmcnt(36)
    v_lshl_or_b32 v228, v244, 16, v228
    s_waitcnt vmcnt(34)
    v_lshl_or_b32 v229, v245, 16, v229
    s_waitcnt vmcnt(32)
    v_lshl_or_b32 v230, v246, 16, v230
    s_waitcnt vmcnt(30)
    v_lshl_or_b32 v231, v247, 16, v231
    s_add_u32 s33, s62, 0
    buffer_store_dwordx4 v[216:219], v0, s[4:7], s33 offen sc1
    s_add_u32 s33, s62, 5120
    buffer_store_dwordx4 v[220:223], v0, s[4:7], s33 offen sc1
    s_add_u32 s33, s62, 10240
    buffer_store_dwordx4 v[224:227], v0, s[4:7], s33 offen sc1
    s_add_u32 s33, s62, 15360
    buffer_store_dwordx4 v[228:231], v0, s[4:7], s33 offen sc1
R_253:
    s_mov_b32 s34, 0x3f803f80
    v_mov_b32 v56, s34
    v_mov_b32 v57, s34
    v_mov_b32 v58, s34
    v_mov_b32 v59, s34
    s_nop 1
    v_mfma_f32_32x32x16_bf16 v[96:111], v[56:59], a[160:163], 0
    v_mfma_f32_32x32x16_bf16 v[112:127], v[56:59], a[200:203], 0
    v_mfma_f32_32x32x16_bf16 v[96:111], v[56:59], a[164:167], v[96:111]
    v_mfma_f32_32x32x16_bf16 v[112:127], v[56:59], a[204:207], v[112:127]
    v_mfma_f32_32x32x16_bf16 v[96:111], v[56:59], a[168:171], v[96:111]
    v_mfma_f32_32x32x16_bf16 v[112:127], v[56:59], a[208:211], v[112:127]
    v_mfma_f32_32x32x16_bf16 v[96:111], v[56:59], a[172:175], v[96:111]
    v_mfma_f32_32x32x16_bf16 v[112:127], v[56:59], a[212:215], v[112:127]
    v_mfma_f32_32x32x16_bf16 v[96:111], v[56:59], a[176:179], v[96:111]
    v_mfma_f32_32x32x16_bf16 v[112:127], v[56:59], a[216:219], v[112:127]
    v_mfma_f32_32x32x16_bf16 v[96:111], v[56:59], a[180:183], v[96:111]
    v_mfma_f32_32x32x16_bf16 v[112:127], v[56:59], a[220:223], v[112:127]
    v_mfma_f32_32x32x16_bf16 v[96:111], v[56:59], a[184:187], v[96:111]
    v_mfma_f32_32x32x16_bf16 v[112:127], v[56:59], a[224:227], v[112:127]
    v_mfma_f32_32x32x16_bf16 v[96:111], v[56:59], a[188:191], v[96:111]
    v_mfma_f32_32x32x16_bf16 v[112:127], v[56:59], a[228:231], v[112:127]
    v_mfma_f32_32x32x16_bf16 v[96:111], v[56:59], a[192:195], v[96:111]
    v_mfma_f32_32x32x16_bf16 v[112:127], v[56:59], a[232:235], v[112:127]
    v_mfma_f32_32x32x16_bf16 v[96:111], v[56:59], a[196:199], v[96:111]
    v_mfma_f32_32x32x16_bf16 v[112:127], v[56:59], a[236:239], v[112:127]
    s_nop 3
    ds_write_b128 v4, v[96:99] offset:32768
    ds_write_b128 v4, v[100:103] offset:33792
    ds_write_b128 v4, v[104:107] offset:34816
    ds_write_b128 v4, v[108:111] offset:35840
    ds_write_b128 v4, v[112:115] offset:36864
    ds_write_b128 v4, v[116:119] offset:37888
    ds_write_b128 v4, v[120:123] offset:38912
    ds_write_b128 v4, v[124:127] offset:39936
    s_waitcnt lgkmcnt(0)
    s_barrier
    ds_read_b128 v[96:99], v3 offset:32768
    ds_read_b128 v[100:103], v3 offset:33792
    ds_read_b128 v[104:107], v3 offset:40960
    ds_read_b128 v[108:111], v3 offset:41984
    ds_read_b128 v[112:115], v3 offset:49152
    ds_read_b128 v[116:119], v3 offset:50176
    ds_read_b128 v[120:123], v3 offset:57344
    ds_read_b128 v[124:127], v3 offset:58368
    s_waitcnt lgkmcnt(5)
    v_pk_add_f32 v[96:97], v[96:97], v[104:105]
    v_pk_add_f32 v[98:99], v[98:99], v[106:107]
    s_waitcnt lgkmcnt(4)
    v_pk_add_f32 v[100:101], v[100:101], v[108:109]
    v_pk_add_f32 v[102:103], v[102:103], v[110:111]
    s_waitcnt lgkmcnt(3)
    v_pk_add_f32 v[96:97], v[96:97], v[112:113]
    v_pk_add_f32 v[98:99], v[98:99], v[114:115]
    s_waitcnt lgkmcnt(2)
    v_pk_add_f32 v[100:101], v[100:101], v[116:117]
    v_pk_add_f32 v[102:103], v[102:103], v[118:119]
    s_waitcnt lgkmcnt(1)
    v_pk_add_f32 v[96:97], v[96:97], v[120:121]
    v_pk_add_f32 v[98:99], v[98:99], v[122:123]
    s_waitcnt lgkmcnt(0)
    v_pk_add_f32 v[100:101], v[100:101], v[124:125]
    v_pk_add_f32 v[102:103], v[102:103], v[126:127]
    v_mov_b64 v[154:155], v[96:97]
    v_mov_b64 v[156:157], v[98:99]
    v_mov_b64 v[158:159], v[100:101]
    v_mov_b64 v[160:161], v[102:103]
    s_barrier
    v_bfe_u32 v173, v1, 0, 1
    v_mul_u32_u24 v173, 4, v173
    v_add_u32 v173, 8, v173
    s_mov_b32 s48, 0
P_254:
    buffer_load_dword v172, v173, s[24:27], 0 offen sc1
    s_waitcnt vmcnt(0)
    v_cmp_gt_u32 vcc, 1, v172
    s_cbranch_vccz P_255
    s_add_u32 s48, s48, 1
    s_cmp_gt_u32 s48, 200000
    s_cbranch_scc1 L_end
    s_sleep 1
    s_branch P_254
P_255:
    s_cmp_ge_u32 s28, 160
    s_cbranch_scc1 R_256
    s_waitcnt vmcnt(0)
    s_barrier
    s_cmp_lg_u32 s29, 0
    s_cbranch_scc1 F_257
    s_lshl_b32 s32, s28, 5
    s_add_u32 s32, s32, s29
    s_lshl_b32 s32, s32, 2
    s_add_u32 s32, s32, 1048576
    v_mov_b32 v172, 1
    s_mov_b64 exec, 1
    buffer_store_dword v172, off, s[4:7], s32 sc1
    s_mov_b64 exec, -1
F_257:
R_256:
    s_cmp_eq_u32 s64, 1
    s_cbranch_scc1 Q_258
    v_bfe_u32 v14, v1, 5, 1
    v_mul_u32_u24 v14, 512, v14
    v_bfe_u32 v15, v1, 2, 2
    v_lshl_add_u32 v14, v15, 6, v14
    v_bfe_u32 v15, v1, 4, 1
    v_lshl_add_u32 v14, v15, 4, v14
    v_bfe_u32 v15, v1, 1, 1
    v_lshl_add_u32 v14, v15, 3, v14
    v_bfe_u32 v15, v1, 0, 1
    v_lshl_add_u32 v14, v15, 5, v14
    v_add_u32 v14, s60, v14
    s_branch Q_259
Q_258:
    v_bfe_u32 v14, v1, 5, 1
    v_mul_u32_u24 v14, 512, v14
    v_bfe_u32 v15, v1, 2, 2
    v_lshl_add_u32 v14, v15, 6, v14
    v_bfe_u32 v15, v1, 4, 1
    v_lshl_add_u32 v14, v15, 5, v14
    v_bfe_u32 v15, v1, 0, 2
    v_lshl_add_u32 v14, v15, 3, v14
    v_add_u32 v14, s60, v14
Q_259:
    s_waitcnt vmcnt(0)
    ds_read_b64_tr_b16 a[0:1], v14 offset:0
    ds_read_b64_tr_b16 a[2:3], v14 offset:256
    ds_read_b64_tr_b16 a[4:5], v14 offset:1024
    ds_read_b64_tr_b16 a[6:7], v14 offset:1280
    ds_read_b64_tr_b16 a[8:9], v14 offset:2048
    ds_read_b64_tr_b16 a[10:11], v14 offset:2304
    ds_read_b64_tr_b16 a[12:13], v14 offset:3072
    ds_read_b64_tr_b16 a[14:15], v14 offset:3328
    ds_read_b64_tr_b16 a[16:17], v14 offset:4096
    ds_read_b64_tr_b16 a[18:19], v14 offset:4352
    ds_read_b64_tr_b16 a[20:21], v14 offset:5120
    ds_read_b64_tr_b16 a[22:23], v14 offset:5376
    ds_read_b64_tr_b16 a[24:25], v14 offset:6144
    ds_read_b64_tr_b16 a[26:27], v14 offset:6400
    ds_read_b64_tr_b16 a[28:29], v14 offset:7168
    ds_read_b64_tr_b16 a[30:31], v14 offset:7424
    ds_read_b64_tr_b16 a[32:33], v14 offset:8192
    ds_read_b64_tr_b16 a[34:35], v14 offset:8448
    ds_read_b64_tr_b16 a[36:37], v14 offset:9216
    ds_read_b64_tr_b16 a[38:39], v14 offset:9472
    ds_read_b64_tr_b16 a[40:41], v14 offset:10240
    ds_read_b64_tr_b16 a[42:43], v14 offset:10496
    ds_read_b64_tr_b16 a[44:45], v14 offset:11264
    ds_read_b64_tr_b16 a[46:47], v14 offset:11520
    ds_read_b64_tr_b16 a[48:49], v14 offset:12288
    ds_read_b64_tr_b16 a[50:51], v14 offset:12544
    ds_read_b64_tr_b16 a[52:53], v14 offset:13312
    ds_read_b64_tr_b16 a[54:55], v14 offset:13568
    ds_read_b64_tr_b16 a[56:57], v14 offset:14336
    ds_read_b64_tr_b16 a[58:59], v14 offset:14592
    ds_read_b64_tr_b16 a[60:61], v14 offset:15360
    ds_read_b64_tr_b16 a[62:63], v14 offset:15616
    ds_read_b64_tr_b16 a[64:65], v14 offset:16384
    ds_read_b64_tr_b16 a[66:67], v14 offset:16640
    ds_read_b64_tr_b16 a[68:69], v14 offset:17408
    ds_read_b64_tr_b16 a[70:71], v14 offset:17664
    ds_read_b64_tr_b16 a[72:73], v14 offset:18432
    ds_read_b64_tr_b16 a[74:75], v14 offset:18688
    ds_read_b64_tr_b16 a[76:77], v14 offset:19456
    ds_read_b64_tr_b16 a[78:79], v14 offset:19712
    s_waitcnt lgkmcnt(0)
    s_cmp_ge_u32 s28, 190
    s_cbranch_scc1 R_260
    s_add_u32 s45, s44, s47
    s_mul_i32 s54, s45, 40960
    s_add_u32 s56, s54, s52
    s_add_u32 s54, s54, s50
    v_mfma_f32_32x32x16_bf16 v[96:111], v[16:19], a[160:163], 0
    v_mfma_f32_32x32x16_bf16 v[96:111], v[20:23], a[164:167], v[96:111]
    v_mfma_f32_32x32x16_bf16 v[96:111], v[24:27], a[168:171], v[96:111]
    v_mfma_f32_32x32x16_bf16 v[96:111], v[28:31], a[172:175], v[96:111]
    v_mfma_f32_32x32x16_bf16 v[96:111], v[32:35], a[176:179], v[96:111]
    v_mfma_f32_32x32x16_bf16 v[96:111], v[36:39], a[180:183], v[96:111]
    v_mfma_f32_32x32x16_bf16 v[96:111], v[40:43], a[184:187], v[96:111]
    v_mfma_f32_32x32x16_bf16 v[96:111], v[44:47], a[188:191], v[96:111]
    v_mfma_f32_32x32x16_bf16 v[96:111], v[48:51], a[192:195], v[96:111]
    buffer_load_dwordx4 v[56:59], v2, s[8:11], s54 offen offset:0
    v_mfma_f32_32x32x16_bf16 v[96:111], v[52:55], a[196:199], v[96:111]
    buffer_load_dwordx4 v[60:63], v2, s[8:11], s54 offen offset:32
    v_mfma_f32_32x32x16_bf16 v[112:127], v[16:19], a[200:203], 0
    buffer_load_dwordx4 v[64:67], v2, s[8:11], s54 offen offset:64
    v_mfma_f32_32x32x16_bf16 v[112:127], v[20:23], a[204:207], v[112:127]
    v_mfma_f32_32x32x16_bf16 v[112:127], v[24:27], a[208:211], v[112:127]
    buffer_load_dwordx4 v[68:71], v2, s[8:11], s54 offen offset:96
    v_mfma_f32_32x32x16_bf16 v[112:127], v[28:31], a[212:215], v[112:127]
    v_mfma_f32_32x32x16_bf16 v[112:127], v[32:35], a[216:219], v[112:127]
    buffer_load_dwordx4 v[72:75], v2, s[8:11], s54 offen offset:128
    v_mfma_f32_32x32x16_bf16 v[112:127], v[36:39], a[220:223], v[112:127]
    v_mfma_f32_32x32x16_bf16 v[112:127], v[40:43], a[224:227], v[112:127]
    buffer_load_dwordx4 v[76:79], v2, s[8:11], s54 offen offset:160
    ds_write_b128 v4, v[96:99] offset:0
    v_mfma_f32_32x32x16_bf16 v[112:127], v[44:47], a[228:231], v[112:127]
    ds_write_b128 v4, v[100:103] offset:1024
    v_mfma_f32_32x32x16_bf16 v[112:127], v[48:51], a[232:235], v[112:127]
    buffer_load_dwordx4 v[80:83], v2, s[8:11], s54 offen offset:192
    ds_write_b128 v4, v[104:107] offset:2048
    v_mfma_f32_32x32x16_bf16 v[112:127], v[52:55], a[236:239], v[112:127]
    ds_write_b128 v4, v[108:111] offset:3072
    s_mov_b32 s59, 1073741824
    s_mul_i32 s55, s44, s58
    s_add_u32 s55, s55, s51
    v_mov_b64 v[128:129], 0
    s_mov_b32 s34, 0x3f803f80
    v_dot2c_f32_bf16 v128, s34, v16
    v_dot2c_f32_bf16 v129, v16, v16
    buffer_load_dwordx4 v[84:87], v2, s[8:11], s54 offen offset:224
    v_dot2c_f32_bf16 v128, s34, v17
    v_dot2c_f32_bf16 v129, v17, v17
    v_dot2c_f32_bf16 v128, s34, v18
    v_dot2c_f32_bf16 v129, v18, v18
    v_dot2c_f32_bf16 v128, s34, v19
    v_dot2c_f32_bf16 v129, v19, v19
    v_dot2c_f32_bf16 v128, s34, v20
    v_dot2c_f32_bf16 v129, v20, v20
    v_dot2c_f32_bf16 v128, s34, v21
    v_dot2c_f32_bf16 v129, v21, v21
    v_dot2c_f32_bf16 v128, s34, v22
    v_dot2c_f32_bf16 v129, v22, v22
    v_dot2c_f32_bf16 v128, s34, v23
    v_dot2c_f32_bf16 v129, v23, v23
    v_dot2c_f32_bf16 v128, s34, v24
    v_dot2c_f32_bf16 v129, v24, v24
    buffer_load_dwordx4 v[88:91], v2, s[8:11], s54 offen offset:256
    v_dot2c_f32_bf16 v128, s34, v25
    v_dot2c_f32_bf16 v129, v25, v25
    v_dot2c_f32_bf16 v128, s34, v26
    v_dot2c_f32_bf16 v129, v26, v26
    v_dot2c_f32_bf16 v128, s34, v27
    v_dot2c_f32_bf16 v129, v27, v27
    v_dot2c_f32_bf16 v128, s34, v28
    v_dot2c_f32_bf16 v129, v28, v28
    v_dot2c_f32_bf16 v128, s34, v29
    v_dot2c_f32_bf16 v129, v29, v29
    v_dot2c_f32_bf16 v128, s34, v30
    v_dot2c_f32_bf16 v129, v30, v30
    v_dot2c_f32_bf16 v128, s34, v31
    v_dot2c_f32_bf16 v129, v31, v31
    v_dot2c_f32_bf16 v128, s34, v32
    v_dot2c_f32_bf16 v129, v32, v32
    buffer_load_dwordx4 v[92:95], v2, s[8:11], s54 offen offset:288
    v_dot2c_f32_bf16 v128, s34, v33
    v_dot2c_f32_bf16 v129, v33, v33
    v_dot2c_f32_bf16 v128, s34, v34
    v_dot2c_f32_bf16 v129, v34, v34
    v_dot2c_f32_bf16 v128, s34, v35
    v_dot2c_f32_bf16 v129, v35, v35
    v_dot2c_f32_bf16 v128, s34, v36
    v_dot2c_f32_bf16 v129, v36, v36
    v_dot2c_f32_bf16 v128, s34, v37
    v_dot2c_f32_bf16 v129, v37, v37
    v_dot2c_f32_bf16 v128, s34, v38
    v_dot2c_f32_bf16 v129, v38, v38
    v_dot2c_f32_bf16 v128, s34, v39
    v_dot2c_f32_bf16 v129, v39, v39
    v_dot2c_f32_bf16 v128, s34, v40
    v_dot2c_f32_bf16 v129, v40, v40
    v_dot2c_f32_bf16 v128, s34, v41
    v_dot2c_f32_bf16 v129, v41, v41
    v_dot2c_f32_bf16 v128, s34, v42
    v_dot2c_f32_bf16 v129, v42, v42
    v_dot2c_f32_bf16 v128, s34, v43
    v_dot2c_f32_bf16 v129, v43, v43
    v_dot2c_f32_bf16 v128, s34, v44
    v_dot2c_f32_bf16 v129, v44, v44
    v_dot2c_f32_bf16 v128, s34, v45
    v_dot2c_f32_bf16 v129, v45, v45
    v_dot2c_f32_bf16 v128, s34, v46
    v_dot2c_f32_bf16 v129, v46, v46
    v_dot2c_f32_bf16 v128, s34, v47
    v_dot2c_f32_bf16 v129, v47, v47
    v_dot2c_f32_bf16 v128, s34, v48
    v_dot2c_f32_bf16 v129, v48, v48
    v_dot2c_f32_bf16 v128, s34, v49
    v_dot2c_f32_bf16 v129, v49, v49
    v_dot2c_f32_bf16 v128, s34, v50
    v_dot2c_f32_bf16 v129, v50, v50
    v_dot2c_f32_bf16 v128, s34, v51
    v_dot2c_f32_bf16 v129, v51, v51
    v_dot2c_f32_bf16 v128, s34, v52
    v_dot2c_f32_bf16 v129, v52, v52
    v_dot2c_f32_bf16 v128, s34, v53
    v_dot2c_f32_bf16 v129, v53, v53
    v_dot2c_f32_bf16 v128, s34, v54
    v_dot2c_f32_bf16 v129, v54, v54
    v_dot2c_f32_bf16 v128, s34, v55
    v_dot2c_f32_bf16 v129, v55, v55
    s_nop 2
    v_mov_b64 v[176:177], v[128:129]
    s_nop 1
    v_permlane32_swap_b32 v128, v176
    v_permlane32_swap_b32 v129, v177
    v_pk_add_f32 v[128:129], v[128:129], v[176:177]
    ds_write_b64 v5, v[128:129] offset:0
G_261:
    s_mov_b32 s44, s45
    s_add_u32 s45, s44, s47
    s_cmp_lt_u32 s45, s46
    s_cbranch_scc0 G_264
    s_mul_i32 s54, s45, 40960
    s_add_u32 s56, s54, s52
    s_add_u32 s54, s54, s50
    s_waitcnt vmcnt(9)
    v_mfma_f32_32x32x16_bf16 v[96:111], v[56:59], a[160:163], 0
    ds_write_b128 v4, v[112:115] offset:4096
    s_waitcnt vmcnt(8)
    v_mfma_f32_32x32x16_bf16 v[96:111], v[60:63], a[164:167], v[96:111]
    ds_write_b128 v4, v[116:119] offset:5120
    s_waitcnt vmcnt(7)
    v_mfma_f32_32x32x16_bf16 v[96:111], v[64:67], a[168:171], v[96:111]
    ds_write_b128 v4, v[120:123] offset:6144
    s_waitcnt vmcnt(6)
    v_mfma_f32_32x32x16_bf16 v[96:111], v[68:71], a[172:175], v[96:111]
    ds_write_b128 v4, v[124:127] offset:7168
    s_waitcnt vmcnt(5)
    v_mfma_f32_32x32x16_bf16 v[96:111], v[72:75], a[176:179], v[96:111]
    s_waitcnt vmcnt(4)
    v_mfma_f32_32x32x16_bf16 v[96:111], v[76:79], a[180:183], v[96:111]
    s_waitcnt lgkmcnt(0)
    s_barrier
    buffer_store_dwordx4 v[172:175], v7, s[4:7], s59 offen sc1
    s_waitcnt vmcnt(4)
    v_mfma_f32_32x32x16_bf16 v[96:111], v[80:83], a[184:187], v[96:111]
    ds_read_b128 v[130:133], v6 offset:0
    ds_read_b128 v[134:137], v6 offset:16
    ds_read_b128 v[184:187], v3 offset:0
    ds_read_b128 v[188:191], v3 offset:1024
    ds_read_b128 v[192:195], v3 offset:8192
    ds_read_b128 v[196:199], v3 offset:9216
    s_waitcnt vmcnt(3)
    v_mfma_f32_32x32x16_bf16 v[96:111], v[84:87], a[188:191], v[96:111]
    ds_read_b128 v[200:203], v3 offset:16384
    ds_read_b128 v[204:207], v3 offset:17408
    ds_read_b128 v[208:211], v3 offset:24576
    ds_read_b128 v[212:215], v3 offset:25600
    s_waitcnt vmcnt(2)
    v_mfma_f32_32x32x16_bf16 v[96:111], v[88:91], a[192:195], v[96:111]
    buffer_load_dwordx4 v[16:19], v2, s[8:11], s54 offen offset:0
    s_waitcnt vmcnt(2)
    v_mfma_f32_32x32x16_bf16 v[96:111], v[92:95], a[196:199], v[96:111]
    buffer_load_dwordx4 v[20:23], v2, s[8:11], s54 offen offset:32
    v_mfma_f32_32x32x16_bf16 v[112:127], v[56:59], a[200:203], 0
    buffer_load_dwordx4 v[24:27], v2, s[8:11], s54 offen offset:64
    s_waitcnt lgkmcnt(9)
    v_add_f32 v130, v130, v132
    v_add_f32 v131, v131, v133
    s_waitcnt lgkmcnt(8)
    v_add_f32 v130, v130, v134
    v_add_f32 v131, v131, v135
    v_add_f32 v130, v130, v136
    v_add_f32 v131, v131, v137
    v_mul_f32 v130, 0x3acccccd, v130
    v_mfma_f32_32x32x16_bf16 v[112:127], v[60:63], a[204:207], v[112:127]
    v_mul_f32 v131, 0x3acccccd, v131
    v_fma_f32 v131, -v130, v130, v131
    v_max_f32 v131, 0, v131
    v_add_f32 v131, 0x3727c5ac, v131
    v_rsq_f32 v131, v131
    s_nop 0
    ds_write2_b32 v9, v130, v131 offset0:0 offset1:32
    ds_read_b128 v[138:141], v10 offset:0
    v_mfma_f32_32x32x16_bf16 v[112:127], v[64:67], a[208:211], v[112:127]
    buffer_load_dwordx4 v[28:31], v2, s[8:11], s54 offen offset:96
    ds_read_b128 v[142:145], v10 offset:16
    ds_read_b128 v[146:149], v10 offset:128
    ds_read_b128 v[150:153], v10 offset:144
    s_waitcnt lgkmcnt(10)
    v_add_f32 v184, v184, v192
    v_add_f32 v185, v185, v193
    v_add_f32 v186, v186, v194
    v_add_f32 v187, v187, v195
    v_mfma_f32_32x32x16_bf16 v[112:127], v[68:71], a[212:215], v[112:127]
    s_waitcnt lgkmcnt(9)
    v_add_f32 v188, v188, v196
    v_add_f32 v189, v189, v197
    v_add_f32 v190, v190, v198
    v_add_f32 v191, v191, v199
    s_waitcnt lgkmcnt(8)
    v_add_f32 v184, v184, v200
    v_add_f32 v185, v185, v201
    v_add_f32 v186, v186, v202
    v_mfma_f32_32x32x16_bf16 v[112:127], v[72:75], a[216:219], v[112:127]
    buffer_load_dwordx4 v[32:35], v2, s[8:11], s54 offen offset:128
    v_add_f32 v187, v187, v203
    s_waitcnt lgkmcnt(7)
    v_add_f32 v188, v188, v204
    v_add_f32 v189, v189, v205
    v_add_f32 v190, v190, v206
    v_add_f32 v191, v191, v207
    s_waitcnt lgkmcnt(6)
    v_add_f32 v184, v184, v208
    v_add_f32 v185, v185, v209
    v_mfma_f32_32x32x16_bf16 v[112:127], v[76:79], a[220:223], v[112:127]
    v_add_f32 v186, v186, v210
    v_add_f32 v187, v187, v211
    s_waitcnt lgkmcnt(5)
    v_add_f32 v188, v188, v212
    v_add_f32 v189, v189, v213
    v_add_f32 v190, v190, v214
    v_add_f32 v191, v191, v215
    s_waitcnt lgkmcnt(3)
    v_fma_f32 v184, -v138, v154, v184
    v_mfma_f32_32x32x16_bf16 v[112:127], v[80:83], a[224:227], v[112:127]
    buffer_load_dwordx4 v[36:39], v2, s[8:11], s54 offen offset:160
    ds_write_b128 v4, v[96:99] offset:32768
    s_waitcnt lgkmcnt(2)
    v_mul_f32 v184, v184, v146
    v_fma_f32 v185, -v139, v155, v185
    v_mul_f32 v185, v185, v147
    v_fma_f32 v186, -v140, v156, v186
    v_mul_f32 v186, v186, v148
    v_fma_f32 v187, -v141, v157, v187
    v_mul_f32 v187, v187, v149
    v_mfma_f32_32x32x16_bf16 v[112:127], v[84:87], a[228:231], v[112:127]
    ds_write_b128 v4, v[100:103] offset:33792
    v_fma_f32 v188, -v142, v158, v188
    s_waitcnt lgkmcnt(2)
    v_mul_f32 v188, v188, v150
    v_fma_f32 v189, -v143, v159, v189
    v_mul_f32 v189, v189, v151
    v_fma_f32 v190, -v144, v160, v190
    v_mul_f32 v190, v190, v152
    v_fma_f32 v191, -v145, v161, v191
    v_mfma_f32_32x32x16_bf16 v[112:127], v[88:91], a[232:235], v[112:127]
    buffer_load_dwordx4 v[40:43], v2, s[8:11], s54 offen offset:192
    ds_write_b128 v4, v[104:107] offset:34816
    v_mul_f32 v191, v191, v153
    v_cvt_pk_bf16_f32 v172, v184, v185
    v_cvt_pk_bf16_f32 v173, v186, v187
    v_cvt_pk_bf16_f32 v174, v188, v189
    v_cvt_pk_bf16_f32 v175, v190, v191
    v_mfma_f32_32x32x16_bf16 v[112:127], v[92:95], a[236:239], v[112:127]
    ds_write_b128 v4, v[108:111] offset:35840
    s_mov_b32 s59, s55
    s_mul_i32 s55, s44, s58
    s_add_u32 s55, s55, s51
    v_mov_b64 v[128:129], 0
    s_mov_b32 s34, 0x3f803f80
    v_dot2c_f32_bf16 v128, s34, v56
    v_dot2c_f32_bf16 v129, v56, v56
    buffer_load_dwordx4 v[44:47], v2, s[8:11], s54 offen offset:224
    v_dot2c_f32_bf16 v128, s34, v57
    v_dot2c_f32_bf16 v129, v57, v57
    v_dot2c_f32_bf16 v128, s34, v58
    v_dot2c_f32_bf16 v129, v58, v58
    v_dot2c_f32_bf16 v128, s34, v59
    v_dot2c_f32_bf16 v129, v59, v59
    v_dot2c_f32_bf16 v128, s34, v60
    v_dot2c_f32_bf16 v129, v60, v60
    v_dot2c_f32_bf16 v128, s34, v61
    v_dot2c_f32_bf16 v129, v61, v61
    v_dot2c_f32_bf16 v128, s34, v62
    v_dot2c_f32_bf16 v129, v62, v62
    v_dot2c_f32_bf16 v128, s34, v63
    v_dot2c_f32_bf16 v129, v63, v63
    v_dot2c_f32_bf16 v128, s34, v64
    v_dot2c_f32_bf16 v129, v64, v64
    buffer_load_dwordx4 v[48:51], v2, s[8:11], s54 offen offset:256
    v_dot2c_f32_bf16 v128, s34, v65
    v_dot2c_f32_bf16 v129, v65, v65
    v_dot2c_f32_bf16 v128, s34, v66
    v_dot2c_f32_bf16 v129, v66, v66
    v_dot2c_f32_bf16 v128, s34, v67
    v_dot2c_f32_bf16 v129, v67, v67
    v_dot2c_f32_bf16 v128, s34, v68
    v_dot2c_f32_bf16 v129, v68, v68
    v_dot2c_f32_bf16 v128, s34, v69
    v_dot2c_f32_bf16 v129, v69, v69
    v_dot2c_f32_bf16 v128, s34, v70
    v_dot2c_f32_bf16 v129, v70, v70
    v_dot2c_f32_bf16 v128, s34, v71
    v_dot2c_f32_bf16 v129, v71, v71
    v_dot2c_f32_bf16 v128, s34, v72
    v_dot2c_f32_bf16 v129, v72, v72
    buffer_load_dwordx4 v[52:55], v2, s[8:11], s54 offen offset:288
    v_dot2c_f32_bf16 v128, s34, v73
    v_dot2c_f32_bf16 v129, v73, v73
    v_dot2c_f32_bf16 v128, s34, v74
    v_dot2c_f32_bf16 v129, v74, v74
    v_dot2c_f32_bf16 v128, s34, v75
    v_dot2c_f32_bf16 v129, v75, v75
    v_dot2c_f32_bf16 v128, s34, v76
    v_dot2c_f32_bf16 v129, v76, v76
    v_dot2c_f32_bf16 v128, s34, v77
    v_dot2c_f32_bf16 v129, v77, v77
    v_dot2c_f32_bf16 v128, s34, v78
    v_dot2c_f32_bf16 v129, v78, v78
    v_dot2c_f32_bf16 v128, s34, v79
    v_dot2c_f32_bf16 v129, v79, v79
    v_dot2c_f32_bf16 v128, s34, v80
    v_dot2c_f32_bf16 v129, v80, v80
    v_dot2c_f32_bf16 v128, s34, v81
    v_dot2c_f32_bf16 v129, v81, v81
    v_dot2c_f32_bf16 v128, s34, v82
    v_dot2c_f32_bf16 v129, v82, v82
    v_dot2c_f32_bf16 v128, s34, v83
    v_dot2c_f32_bf16 v129, v83, v83
    v_dot2c_f32_bf16 v128, s34, v84
    v_dot2c_f32_bf16 v129, v84, v84
    v_dot2c_f32_bf16 v128, s34, v85
    v_dot2c_f32_bf16 v129, v85, v85
    v_dot2c_f32_bf16 v128, s34, v86
    v_dot2c_f32_bf16 v129, v86, v86
    v_dot2c_f32_bf16 v128, s34, v87
    v_dot2c_f32_bf16 v129, v87, v87
    v_dot2c_f32_bf16 v128, s34, v88
    v_dot2c_f32_bf16 v129, v88, v88
    v_dot2c_f32_bf16 v128, s34, v89
    v_dot2c_f32_bf16 v129, v89, v89
    v_dot2c_f32_bf16 v128, s34, v90
    v_dot2c_f32_bf16 v129, v90, v90
    v_dot2c_f32_bf16 v128, s34, v91
    v_dot2c_f32_bf16 v129, v91, v91
    v_dot2c_f32_bf16 v128, s34, v92
    v_dot2c_f32_bf16 v129, v92, v92
    v_dot2c_f32_bf16 v128, s34, v93
    v_dot2c_f32_bf16 v129, v93, v93
    v_dot2c_f32_bf16 v128, s34, v94
    v_dot2c_f32_bf16 v129, v94, v94
    v_dot2c_f32_bf16 v128, s34, v95
    v_dot2c_f32_bf16 v129, v95, v95
    s_nop 2
    v_mov_b64 v[176:177], v[128:129]
    s_nop 1
    v_permlane32_swap_b32 v128, v176
    v_permlane32_swap_b32 v129, v177
    v_pk_add_f32 v[128:129], v[128:129], v[176:177]
    ds_write_b64 v5, v[128:129] offset:1024
    s_mov_b32 s44, s45
    s_add_u32 s45, s44, s47
    s_cmp_lt_u32 s45, s46
    s_cbranch_scc0 G_263
    s_mul_i32 s54, s45, 40960
    s_add_u32 s56, s54, s52
    s_add_u32 s54, s54, s50
    s_waitcnt vmcnt(9)
    v_mfma_f32_32x32x16_bf16 v[96:111], v[16:19], a[160:163], 0
    ds_write_b128 v4, v[112:115] offset:36864
    s_waitcnt vmcnt(8)
    v_mfma_f32_32x32x16_bf16 v[96:111], v[20:23], a[164:167], v[96:111]
    ds_write_b128 v4, v[116:119] offset:37888
    s_waitcnt vmcnt(7)
    v_mfma_f32_32x32x16_bf16 v[96:111], v[24:27], a[168:171], v[96:111]
    ds_write_b128 v4, v[120:123] offset:38912
    s_waitcnt vmcnt(6)
    v_mfma_f32_32x32x16_bf16 v[96:111], v[28:31], a[172:175], v[96:111]
    ds_write_b128 v4, v[124:127] offset:39936
    s_waitcnt vmcnt(5)
    v_mfma_f32_32x32x16_bf16 v[96:111], v[32:35], a[176:179], v[96:111]
    s_waitcnt vmcnt(4)
    v_mfma_f32_32x32x16_bf16 v[96:111], v[36:39], a[180:183], v[96:111]
    s_waitcnt lgkmcnt(0)
    s_barrier
    buffer_store_dwordx4 v[172:175], v7, s[4:7], s59 offen sc1
    s_waitcnt vmcnt(4)
    v_mfma_f32_32x32x16_bf16 v[96:111], v[40:43], a[184:187], v[96:111]
    ds_read_b128 v[130:133], v6 offset:1024
    ds_read_b128 v[134:137], v6 offset:1040
    ds_read_b128 v[184:187], v3 offset:32768
    ds_read_b128 v[188:191], v3 offset:33792
    ds_read_b128 v[192:195], v3 offset:40960
    ds_read_b128 v[196:199], v3 offset:41984
    s_waitcnt vmcnt(3)
    v_mfma_f32_32x32x16_bf16 v[96:111], v[44:47], a[188:191], v[96:111]
    ds_read_b128 v[200:203], v3 offset:49152
    ds_read_b128 v[204:207], v3 offset:50176
    ds_read_b128 v[208:211], v3 offset:57344
    ds_read_b128 v[212:215], v3 offset:58368
    s_waitcnt vmcnt(2)
    v_mfma_f32_32x32x16_bf16 v[96:111], v[48:51], a[192:195], v[96:111]
    buffer_load_dwordx4 v[56:59], v2, s[8:11], s54 offen offset:0
    s_waitcnt vmcnt(2)
    v_mfma_f32_32x32x16_bf16 v[96:111], v[52:55], a[196:199], v[96:111]
    buffer_load_dwordx4 v[60:63], v2, s[8:11], s54 offen offset:32
    v_mfma_f32_32x32x16_bf16 v[112:127], v[16:19], a[200:203], 0
    buffer_load_dwordx4 v[64:67], v2, s[8:11], s54 offen offset:64
    s_waitcnt lgkmcnt(9)
    v_add_f32 v130, v130, v132
    v_add_f32 v131, v131, v133
    s_waitcnt lgkmcnt(8)
    v_add_f32 v130, v130, v134
    v_add_f32 v131, v131, v135
    v_add_f32 v130, v130, v136
    v_add_f32 v131, v131, v137
    v_mul_f32 v130, 0x3acccccd, v130
    v_mfma_f32_32x32x16_bf16 v[112:127], v[20:23], a[204:207], v[112:127]
    v_mul_f32 v131, 0x3acccccd, v131
    v_fma_f32 v131, -v130, v130, v131
    v_max_f32 v131, 0, v131
    v_add_f32 v131, 0x3727c5ac, v131
    v_rsq_f32 v131, v131
    s_nop 0
    ds_write2_b32 v9, v130, v131 offset0:0 offset1:32
    ds_read_b128 v[138:141], v10 offset:0
    v_mfma_f32_32x32x16_bf16 v[112:127], v[24:27], a[208:211], v[112:127]
    buffer_load_dwordx4 v[68:71], v2, s[8:11], s54 offen offset:96
    ds_read_b128 v[142:145], v10 offset:16
    ds_read_b128 v[146:149], v10 offset:128
    ds_read_b128 v[150:153], v10 offset:144
    s_waitcnt lgkmcnt(10)
    v_add_f32 v184, v184, v192
    v_add_f32 v185, v185, v193
    v_add_f32 v186, v186, v194
    v_add_f32 v187, v187, v195
    v_mfma_f32_32x32x16_bf16 v[112:127], v[28:31], a[212:215], v[112:127]
    s_waitcnt lgkmcnt(9)
    v_add_f32 v188, v188, v196
    v_add_f32 v189, v189, v197
    v_add_f32 v190, v190, v198
    v_add_f32 v191, v191, v199
    s_waitcnt lgkmcnt(8)
    v_add_f32 v184, v184, v200
    v_add_f32 v185, v185, v201
    v_add_f32 v186, v186, v202
    v_mfma_f32_32x32x16_bf16 v[112:127], v[32:35], a[216:219], v[112:127]
    buffer_load_dwordx4 v[72:75], v2, s[8:11], s54 offen offset:128
    v_add_f32 v187, v187, v203
    s_waitcnt lgkmcnt(7)
    v_add_f32 v188, v188, v204
    v_add_f32 v189, v189, v205
    v_add_f32 v190, v190, v206
    v_add_f32 v191, v191, v207
    s_waitcnt lgkmcnt(6)
    v_add_f32 v184, v184, v208
    v_add_f32 v185, v185, v209
    v_mfma_f32_32x32x16_bf16 v[112:127], v[36:39], a[220:223], v[112:127]
    v_add_f32 v186, v186, v210
    v_add_f32 v187, v187, v211
    s_waitcnt lgkmcnt(5)
    v_add_f32 v188, v188, v212
    v_add_f32 v189, v189, v213
    v_add_f32 v190, v190, v214
    v_add_f32 v191, v191, v215
    s_waitcnt lgkmcnt(3)
    v_fma_f32 v184, -v138, v154, v184
    v_mfma_f32_32x32x16_bf16 v[112:127], v[40:43], a[224:227], v[112:127]
    buffer_load_dwordx4 v[76:79], v2, s[8:11], s54 offen offset:160
    ds_write_b128 v4, v[96:99] offset:0
    s_waitcnt lgkmcnt(2)
    v_mul_f32 v184, v184, v146
    v_fma_f32 v185, -v139, v155, v185
    v_mul_f32 v185, v185, v147
    v_fma_f32 v186, -v140, v156, v186
    v_mul_f32 v186, v186, v148
    v_fma_f32 v187, -v141, v157, v187
    v_mul_f32 v187, v187, v149
    v_mfma_f32_32x32x16_bf16 v[112:127], v[44:47], a[228:231], v[112:127]
    ds_write_b128 v4, v[100:103] offset:1024
    v_fma_f32 v188, -v142, v158, v188
    s_waitcnt lgkmcnt(2)
    v_mul_f32 v188, v188, v150
    v_fma_f32 v189, -v143, v159, v189
    v_mul_f32 v189, v189, v151
    v_fma_f32 v190, -v144, v160, v190
    v_mul_f32 v190, v190, v152
    v_fma_f32 v191, -v145, v161, v191
    v_mfma_f32_32x32x16_bf16 v[112:127], v[48:51], a[232:235], v[112:127]
    buffer_load_dwordx4 v[80:83], v2, s[8:11], s54 offen offset:192
    ds_write_b128 v4, v[104:107] offset:2048
    v_mul_f32 v191, v191, v153
    v_cvt_pk_bf16_f32 v172, v184, v185
    v_cvt_pk_bf16_f32 v173, v186, v187
    v_cvt_pk_bf16_f32 v174, v188, v189
    v_cvt_pk_bf16_f32 v175, v190, v191
    v_mfma_f32_32x32x16_bf16 v[112:127], v[52:55], a[236:239], v[112:127]
    ds_write_b128 v4, v[108:111] offset:3072
    s_mov_b32 s59, s55
    s_mul_i32 s55, s44, s58
    s_add_u32 s55, s55, s51
    v_mov_b64 v[128:129], 0
    s_mov_b32 s34, 0x3f803f80
    v_dot2c_f32_bf16 v128, s34, v16
    v_dot2c_f32_bf16 v129, v16, v16
    buffer_load_dwordx4 v[84:87], v2, s[8:11], s54 offen offset:224
    v_dot2c_f32_bf16 v128, s34, v17
    v_dot2c_f32_bf16 v129, v17, v17
    v_dot2c_f32_bf16 v128, s34, v18
    v_dot2c_f32_bf16 v129, v18, v18
    v_dot2c_f32_bf16 v128, s34, v19
    v_dot2c_f32_bf16 v129, v19, v19
    v_dot2c_f32_bf16 v128, s34, v20
    v_dot2c_f32_bf16 v129, v20, v20
    v_dot2c_f32_bf16 v128, s34, v21
    v_dot2c_f32_bf16 v129, v21, v21
    v_dot2c_f32_bf16 v128, s34, v22
    v_dot2c_f32_bf16 v129, v22, v22
    v_dot2c_f32_bf16 v128, s34, v23
    v_dot2c_f32_bf16 v129, v23, v23
    v_dot2c_f32_bf16 v128, s34, v24
    v_dot2c_f32_bf16 v129, v24, v24
    buffer_load_dwordx4 v[88:91], v2, s[8:11], s54 offen offset:256
    v_dot2c_f32_bf16 v128, s34, v25
    v_dot2c_f32_bf16 v129, v25, v25
    v_dot2c_f32_bf16 v128, s34, v26
    v_dot2c_f32_bf16 v129, v26, v26
    v_dot2c_f32_bf16 v128, s34, v27
    v_dot2c_f32_bf16 v129, v27, v27
    v_dot2c_f32_bf16 v128, s34, v28
    v_dot2c_f32_bf16 v129, v28, v28
    v_dot2c_f32_bf16 v128, s34, v29
    v_dot2c_f32_bf16 v129, v29, v29
    v_dot2c_f32_bf16 v128, s34, v30
    v_dot2c_f32_bf16 v129, v30, v30
    v_dot2c_f32_bf16 v128, s34, v31
    v_dot2c_f32_bf16 v129, v31, v31
    v_dot2c_f32_bf16 v128, s34, v32
    v_dot2c_f32_bf16 v129, v32, v32
    buffer_load_dwordx4 v[92:95], v2, s[8:11], s54 offen offset:288
    v_dot2c_f32_bf16 v128, s34, v33
    v_dot2c_f32_bf16 v129, v33, v33
    v_dot2c_f32_bf16 v128, s34, v34
    v_dot2c_f32_bf16 v129, v34, v34
    v_dot2c_f32_bf16 v128, s34, v35
    v_dot2c_f32_bf16 v129, v35, v35
    v_dot2c_f32_bf16 v128, s34, v36
    v_dot2c_f32_bf16 v129, v36, v36
    v_dot2c_f32_bf16 v128, s34, v37
    v_dot2c_f32_bf16 v129, v37, v37
    v_dot2c_f32_bf16 v128, s34, v38
    v_dot2c_f32_bf16 v129, v38, v38
    v_dot2c_f32_bf16 v128, s34, v39
    v_dot2c_f32_bf16 v129, v39, v39
    v_dot2c_f32_bf16 v128, s34, v40
    v_dot2c_f32_bf16 v129, v40, v40
    v_dot2c_f32_bf16 v128, s34, v41
    v_dot2c_f32_bf16 v129, v41, v41
    v_dot2c_f32_bf16 v128, s34, v42
    v_dot2c_f32_bf16 v129, v42, v42
    v_dot2c_f32_bf16 v128, s34, v43
    v_dot2c_f32_bf16 v129, v43, v43
    v_dot2c_f32_bf16 v128, s34, v44
    v_dot2c_f32_bf16 v129, v44, v44
    v_dot2c_f32_bf16 v128, s34, v45
    v_dot2c_f32_bf16 v129, v45, v45
    v_dot2c_f32_bf16 v128, s34, v46
    v_dot2c_f32_bf16 v129, v46, v46
    v_dot2c_f32_bf16 v128, s34, v47
    v_dot2c_f32_bf16 v129, v47, v47
    v_dot2c_f32_bf16 v128, s34, v48
    v_dot2c_f32_bf16 v129, v48, v48
    v_dot2c_f32_bf16 v128, s34, v49
    v_dot2c_f32_bf16 v129, v49, v49
    v_dot2c_f32_bf16 v128, s34, v50
    v_dot2c_f32_bf16 v129, v50, v50
    v_dot2c_f32_bf16 v128, s34, v51
    v_dot2c_f32_bf16 v129, v51, v51
    v_dot2c_f32_bf16 v128, s34, v52
    v_dot2c_f32_bf16 v129, v52, v52
    v_dot2c_f32_bf16 v128, s34, v53
    v_dot2c_f32_bf16 v129, v53, v53
    v_dot2c_f32_bf16 v128, s34, v54
    v_dot2c_f32_bf16 v129, v54, v54
    v_dot2c_f32_bf16 v128, s34, v55
    v_dot2c_f32_bf16 v129, v55, v55
    s_nop 2
    v_mov_b64 v[176:177], v[128:129]
    s_nop 1
    v_permlane32_swap_b32 v128, v176
    v_permlane32_swap_b32 v129, v177
    v_pk_add_f32 v[128:129], v[128:129], v[176:177]
    ds_write_b64 v5, v[128:129] offset:0
    s_branch G_261
G_264:
    s_waitcnt vmcnt(9)
    v_mfma_f32_32x32x16_bf16 v[96:111], v[56:59], a[160:163], 0
    ds_write_b128 v4, v[112:115] offset:4096
    s_waitcnt vmcnt(8)
    v_mfma_f32_32x32x16_bf16 v[96:111], v[60:63], a[164:167], v[96:111]
    ds_write_b128 v4, v[116:119] offset:5120
    s_waitcnt vmcnt(7)
    v_mfma_f32_32x32x16_bf16 v[96:111], v[64:67], a[168:171], v[96:111]
    ds_write_b128 v4, v[120:123] offset:6144
    s_waitcnt vmcnt(6)
    v_mfma_f32_32x32x16_bf16 v[96:111], v[68:71], a[172:175], v[96:111]
    ds_write_b128 v4, v[124:127] offset:7168
    s_waitcnt vmcnt(5)
    v_mfma_f32_32x32x16_bf16 v[96:111], v[72:75], a[176:179], v[96:111]
    s_waitcnt vmcnt(4)
    v_mfma_f32_32x32x16_bf16 v[96:111], v[76:79], a[180:183], v[96:111]
    s_waitcnt lgkmcnt(0)
    s_barrier
    buffer_store_dwordx4 v[172:175], v7, s[4:7], s59 offen sc1
    s_waitcnt vmcnt(4)
    v_mfma_f32_32x32x16_bf16 v[96:111], v[80:83], a[184:187], v[96:111]
    ds_read_b128 v[130:133], v6 offset:0
    ds_read_b128 v[134:137], v6 offset:16
    ds_read_b128 v[184:187], v3 offset:0
    ds_read_b128 v[188:191], v3 offset:1024
    ds_read_b128 v[192:195], v3 offset:8192
    ds_read_b128 v[196:199], v3 offset:9216
    s_waitcnt vmcnt(3)
    v_mfma_f32_32x32x16_bf16 v[96:111], v[84:87], a[188:191], v[96:111]
    ds_read_b128 v[200:203], v3 offset:16384
    ds_read_b128 v[204:207], v3 offset:17408
    ds_read_b128 v[208:211], v3 offset:24576
    ds_read_b128 v[212:215], v3 offset:25600
    s_waitcnt vmcnt(2)
    v_mfma_f32_32x32x16_bf16 v[96:111], v[88:91], a[192:195], v[96:111]
    s_waitcnt vmcnt(1)
    v_mfma_f32_32x32x16_bf16 v[96:111], v[92:95], a[196:199], v[96:111]
    v_mfma_f32_32x32x16_bf16 v[112:127], v[56:59], a[200:203], 0
    s_waitcnt lgkmcnt(9)
    v_add_f32 v130, v130, v132
    v_add_f32 v131, v131, v133
    s_waitcnt lgkmcnt(8)
    v_add_f32 v130, v130, v134
    v_add_f32 v131, v131, v135
    v_add_f32 v130, v130, v136
    v_add_f32 v131, v131, v137
    v_mul_f32 v130, 0x3acccccd, v130
    v_mfma_f32_32x32x16_bf16 v[112:127], v[60:63], a[204:207], v[112:127]
    v_mul_f32 v131, 0x3acccccd, v131
    v_fma_f32 v131, -v130, v130, v131
    v_max_f32 v131, 0, v131
    v_add_f32 v131, 0x3727c5ac, v131
    v_rsq_f32 v131, v131
    s_nop 0
    ds_write2_b32 v9, v130, v131 offset0:0 offset1:32
    ds_read_b128 v[138:141], v10 offset:0
    v_mfma_f32_32x32x16_bf16 v[112:127], v[64:67], a[208:211], v[112:127]
    ds_read_b128 v[142:145], v10 offset:16
    ds_read_b128 v[146:149], v10 offset:128
    ds_read_b128 v[150:153], v10 offset:144
    s_waitcnt lgkmcnt(10)
    v_add_f32 v184, v184, v192
    v_add_f32 v185, v185, v193
    v_add_f32 v186, v186, v194
    v_add_f32 v187, v187, v195
    v_mfma_f32_32x32x16_bf16 v[112:127], v[68:71], a[212:215], v[112:127]
    s_waitcnt lgkmcnt(9)
    v_add_f32 v188, v188, v196
    v_add_f32 v189, v189, v197
    v_add_f32 v190, v190, v198
    v_add_f32 v191, v191, v199
    s_waitcnt lgkmcnt(8)
    v_add_f32 v184, v184, v200
    v_add_f32 v185, v185, v201
    v_add_f32 v186, v186, v202
    v_mfma_f32_32x32x16_bf16 v[112:127], v[72:75], a[216:219], v[112:127]
    v_add_f32 v187, v187, v203
    s_waitcnt lgkmcnt(7)
    v_add_f32 v188, v188, v204
    v_add_f32 v189, v189, v205
    v_add_f32 v190, v190, v206
    v_add_f32 v191, v191, v207
    s_waitcnt lgkmcnt(6)
    v_add_f32 v184, v184, v208
    v_add_f32 v185, v185, v209
    v_mfma_f32_32x32x16_bf16 v[112:127], v[76:79], a[220:223], v[112:127]
    v_add_f32 v186, v186, v210
    v_add_f32 v187, v187, v211
    s_waitcnt lgkmcnt(5)
    v_add_f32 v188, v188, v212
    v_add_f32 v189, v189, v213
    v_add_f32 v190, v190, v214
    v_add_f32 v191, v191, v215
    s_waitcnt lgkmcnt(3)
    v_fma_f32 v184, -v138, v154, v184
    v_mfma_f32_32x32x16_bf16 v[112:127], v[80:83], a[224:227], v[112:127]
    ds_write_b128 v4, v[96:99] offset:32768
    s_waitcnt lgkmcnt(2)
    v_mul_f32 v184, v184, v146
    v_fma_f32 v185, -v139, v155, v185
    v_mul_f32 v185, v185, v147
    v_fma_f32 v186, -v140, v156, v186
    v_mul_f32 v186, v186, v148
    v_fma_f32 v187, -v141, v157, v187
    v_mul_f32 v187, v187, v149
    v_mfma_f32_32x32x16_bf16 v[112:127], v[84:87], a[228:231], v[112:127]
    ds_write_b128 v4, v[100:103] offset:33792
    v_fma_f32 v188, -v142, v158, v188
    s_waitcnt lgkmcnt(2)
    v_mul_f32 v188, v188, v150
    v_fma_f32 v189, -v143, v159, v189
    v_mul_f32 v189, v189, v151
    v_fma_f32 v190, -v144, v160, v190
    v_mul_f32 v190, v190, v152
    v_fma_f32 v191, -v145, v161, v191
    v_mfma_f32_32x32x16_bf16 v[112:127], v[88:91], a[232:235], v[112:127]
    ds_write_b128 v4, v[104:107] offset:34816
    v_mul_f32 v191, v191, v153
    v_cvt_pk_bf16_f32 v172, v184, v185
    v_cvt_pk_bf16_f32 v173, v186, v187
    v_cvt_pk_bf16_f32 v174, v188, v189
    v_cvt_pk_bf16_f32 v175, v190, v191
    v_mfma_f32_32x32x16_bf16 v[112:127], v[92:95], a[236:239], v[112:127]
    ds_write_b128 v4, v[108:111] offset:35840
    s_mov_b32 s59, s55
    s_mul_i32 s55, s44, s58
    s_add_u32 s55, s55, s51
    v_mov_b64 v[128:129], 0
    s_mov_b32 s34, 0x3f803f80
    v_dot2c_f32_bf16 v128, s34, v56
    v_dot2c_f32_bf16 v129, v56, v56
    v_dot2c_f32_bf16 v128, s34, v57
    v_dot2c_f32_bf16 v129, v57, v57
    v_dot2c_f32_bf16 v128, s34, v58
    v_dot2c_f32_bf16 v129, v58, v58
    v_dot2c_f32_bf16 v128, s34, v59
    v_dot2c_f32_bf16 v129, v59, v59
    v_dot2c_f32_bf16 v128, s34, v60
    v_dot2c_f32_bf16 v129, v60, v60
    v_dot2c_f32_bf16 v128, s34, v61
    v_dot2c_f32_bf16 v129, v61, v61
    v_dot2c_f32_bf16 v128, s34, v62
    v_dot2c_f32_bf16 v129, v62, v62
    v_dot2c_f32_bf16 v128, s34, v63
    v_dot2c_f32_bf16 v129, v63, v63
    v_dot2c_f32_bf16 v128, s34, v64
    v_dot2c_f32_bf16 v129, v64, v64
    v_dot2c_f32_bf16 v128, s34, v65
    v_dot2c_f32_bf16 v129, v65, v65
    v_dot2c_f32_bf16 v128, s34, v66
    v_dot2c_f32_bf16 v129, v66, v66
    v_dot2c_f32_bf16 v128, s34, v67
    v_dot2c_f32_bf16 v129, v67, v67
    v_dot2c_f32_bf16 v128, s34, v68
    v_dot2c_f32_bf16 v129, v68, v68
    v_dot2c_f32_bf16 v128, s34, v69
    v_dot2c_f32_bf16 v129, v69, v69
    v_dot2c_f32_bf16 v128, s34, v70
    v_dot2c_f32_bf16 v129, v70, v70
    v_dot2c_f32_bf16 v128, s34, v71
    v_dot2c_f32_bf16 v129, v71, v71
    v_dot2c_f32_bf16 v128, s34, v72
    v_dot2c_f32_bf16 v129, v72, v72
    v_dot2c_f32_bf16 v128, s34, v73
    v_dot2c_f32_bf16 v129, v73, v73
    v_dot2c_f32_bf16 v128, s34, v74
    v_dot2c_f32_bf16 v129, v74, v74
    v_dot2c_f32_bf16 v128, s34, v75
    v_dot2c_f32_bf16 v129, v75, v75
    v_dot2c_f32_bf16 v128, s34, v76
    v_dot2c_f32_bf16 v129, v76, v76
    v_dot2c_f32_bf16 v128, s34, v77
    v_dot2c_f32_bf16 v129, v77, v77
    v_dot2c_f32_bf16 v128, s34, v78
    v_dot2c_f32_bf16 v129, v78, v78
    v_dot2c_f32_bf16 v128, s34, v79
    v_dot2c_f32_bf16 v129, v79, v79
    v_dot2c_f32_bf16 v128, s34, v80
    v_dot2c_f32_bf16 v129, v80, v80
    v_dot2c_f32_bf16 v128, s34, v81
    v_dot2c_f32_bf16 v129, v81, v81
    v_dot2c_f32_bf16 v128, s34, v82
    v_dot2c_f32_bf16 v129, v82, v82
    v_dot2c_f32_bf16 v128, s34, v83
    v_dot2c_f32_bf16 v129, v83, v83
    v_dot2c_f32_bf16 v128, s34, v84
    v_dot2c_f32_bf16 v129, v84, v84
    v_dot2c_f32_bf16 v128, s34, v85
    v_dot2c_f32_bf16 v129, v85, v85
    v_dot2c_f32_bf16 v128, s34, v86
    v_dot2c_f32_bf16 v129, v86, v86
    v_dot2c_f32_bf16 v128, s34, v87
    v_dot2c_f32_bf16 v129, v87, v87
    v_dot2c_f32_bf16 v128, s34, v88
    v_dot2c_f32_bf16 v129, v88, v88
    v_dot2c_f32_bf16 v128, s34, v89
    v_dot2c_f32_bf16 v129, v89, v89
    v_dot2c_f32_bf16 v128, s34, v90
    v_dot2c_f32_bf16 v129, v90, v90
    v_dot2c_f32_bf16 v128, s34, v91
    v_dot2c_f32_bf16 v129, v91, v91
    v_dot2c_f32_bf16 v128, s34, v92
    v_dot2c_f32_bf16 v129, v92, v92
    v_dot2c_f32_bf16 v128, s34, v93
    v_dot2c_f32_bf16 v129, v93, v93
    v_dot2c_f32_bf16 v128, s34, v94
    v_dot2c_f32_bf16 v129, v94, v94
    v_dot2c_f32_bf16 v128, s34, v95
    v_dot2c_f32_bf16 v129, v95, v95
    s_nop 2
    v_mov_b64 v[176:177], v[128:129]
    s_nop 1
    v_permlane32_swap_b32 v128, v176
    v_permlane32_swap_b32 v129, v177
    v_pk_add_f32 v[128:129], v[128:129], v[176:177]
    ds_write_b64 v5, v[128:129] offset:1024
    ds_write_b128 v4, v[112:115] offset:36864
    ds_write_b128 v4, v[116:119] offset:37888
    ds_write_b128 v4, v[120:123] offset:38912
    ds_write_b128 v4, v[124:127] offset:39936
    s_waitcnt vmcnt(0)
    s_waitcnt lgkmcnt(0)
    s_barrier
    buffer_store_dwordx4 v[172:175], v7, s[4:7], s59 offen sc1
    ds_read_b128 v[130:133], v6 offset:1024
    ds_read_b128 v[134:137], v6 offset:1040
    ds_read_b128 v[184:187], v3 offset:32768
    ds_read_b128 v[188:191], v3 offset:33792
    ds_read_b128 v[192:195], v3 offset:40960
    ds_read_b128 v[196:199], v3 offset:41984
    ds_read_b128 v[200:203], v3 offset:49152
    ds_read_b128 v[204:207], v3 offset:50176
    ds_read_b128 v[208:211], v3 offset:57344
    ds_read_b128 v[212:215], v3 offset:58368
    s_waitcnt lgkmcnt(9)
    v_add_f32 v130, v130, v132
    v_add_f32 v131, v131, v133
    s_waitcnt lgkmcnt(8)
    v_add_f32 v130, v130, v134
    v_add_f32 v131, v131, v135
    v_add_f32 v130, v130, v136
    v_add_f32 v131, v131, v137
    v_mul_f32 v130, 0x3acccccd, v130
    v_mul_f32 v131, 0x3acccccd, v131
    v_fma_f32 v131, -v130, v130, v131
    v_max_f32 v131, 0, v131
    v_add_f32 v131, 0x3727c5ac, v131
    v_rsq_f32 v131, v131
    s_nop 0
    ds_write2_b32 v9, v130, v131 offset0:0 offset1:32
    ds_read_b128 v[138:141], v10 offset:0
    ds_read_b128 v[142:145], v10 offset:16
    ds_read_b128 v[146:149], v10 offset:128
    ds_read_b128 v[150:153], v10 offset:144
    s_waitcnt lgkmcnt(10)
    v_add_f32 v184, v184, v192
    v_add_f32 v185, v185, v193
    v_add_f32 v186, v186, v194
    v_add_f32 v187, v187, v195
    s_waitcnt lgkmcnt(9)
    v_add_f32 v188, v188, v196
    v_add_f32 v189, v189, v197
    v_add_f32 v190, v190, v198
    v_add_f32 v191, v191, v199
    s_waitcnt lgkmcnt(8)
    v_add_f32 v184, v184, v200
    v_add_f32 v185, v185, v201
    v_add_f32 v186, v186, v202
    v_add_f32 v187, v187, v203
    s_waitcnt lgkmcnt(7)
    v_add_f32 v188, v188, v204
    v_add_f32 v189, v189, v205
    v_add_f32 v190, v190, v206
    v_add_f32 v191, v191, v207
    s_waitcnt lgkmcnt(6)
    v_add_f32 v184, v184, v208
    v_add_f32 v185, v185, v209
    v_add_f32 v186, v186, v210
    v_add_f32 v187, v187, v211
    s_waitcnt lgkmcnt(5)
    v_add_f32 v188, v188, v212
    v_add_f32 v189, v189, v213
    v_add_f32 v190, v190, v214
    v_add_f32 v191, v191, v215
    s_waitcnt lgkmcnt(3)
    v_fma_f32 v184, -v138, v154, v184
    s_waitcnt lgkmcnt(1)
    v_mul_f32 v184, v184, v146
    v_fma_f32 v185, -v139, v155, v185
    v_mul_f32 v185, v185, v147
    v_fma_f32 v186, -v140, v156, v186
    v_mul_f32 v186, v186, v148
    v_fma_f32 v187, -v141, v157, v187
    v_mul_f32 v187, v187, v149
    v_fma_f32 v188, -v142, v158, v188
    s_waitcnt lgkmcnt(0)
    v_mul_f32 v188, v188, v150
    v_fma_f32 v189, -v143, v159, v189
    v_mul_f32 v189, v189, v151
    v_fma_f32 v190, -v144, v160, v190
    v_mul_f32 v190, v190, v152
    v_fma_f32 v191, -v145, v161, v191
    v_mul_f32 v191, v191, v153
    v_cvt_pk_bf16_f32 v172, v184, v185
    v_cvt_pk_bf16_f32 v173, v186, v187
    v_cvt_pk_bf16_f32 v174, v188, v189
    v_cvt_pk_bf16_f32 v175, v190, v191
    s_mov_b32 s59, s55
    buffer_store_dwordx4 v[172:175], v7, s[4:7], s59 offen sc1
    s_branch G_262
G_263:
    s_waitcnt vmcnt(9)
    v_mfma_f32_32x32x16_bf16 v[96:111], v[16:19], a[160:163], 0
    ds_write_b128 v4, v[112:115] offset:36864
    s_waitcnt vmcnt(8)
    v_mfma_f32_32x32x16_bf16 v[96:111], v[20:23], a[164:167], v[96:111]
    ds_write_b128 v4, v[116:119] offset:37888
    s_waitcnt vmcnt(7)
    v_mfma_f32_32x32x16_bf16 v[96:111], v[24:27], a[168:171], v[96:111]
    ds_write_b128 v4, v[120:123] offset:38912
    s_waitcnt vmcnt(6)
    v_mfma_f32_32x32x16_bf16 v[96:111], v[28:31], a[172:175], v[96:111]
    ds_write_b128 v4, v[124:127] offset:39936
    s_waitcnt vmcnt(5)
    v_mfma_f32_32x32x16_bf16 v[96:111], v[32:35], a[176:179], v[96:111]
    s_waitcnt vmcnt(4)
    v_mfma_f32_32x32x16_bf16 v[96:111], v[36:39], a[180:183], v[96:111]
    s_waitcnt lgkmcnt(0)
    s_barrier
    buffer_store_dwordx4 v[172:175], v7, s[4:7], s59 offen sc1
    s_waitcnt vmcnt(4)
    v_mfma_f32_32x32x16_bf16 v[96:111], v[40:43], a[184:187], v[96:111]
    ds_read_b128 v[130:133], v6 offset:1024
    ds_read_b128 v[134:137], v6 offset:1040
    ds_read_b128 v[184:187], v3 offset:32768
    ds_read_b128 v[188:191], v3 offset:33792
    ds_read_b128 v[192:195], v3 offset:40960
    ds_read_b128 v[196:199], v3 offset:41984
    s_waitcnt vmcnt(3)
    v_mfma_f32_32x32x16_bf16 v[96:111], v[44:47], a[188:191], v[96:111]
    ds_read_b128 v[200:203], v3 offset:49152
    ds_read_b128 v[204:207], v3 offset:50176
    ds_read_b128 v[208:211], v3 offset:57344
    ds_read_b128 v[212:215], v3 offset:58368
    s_waitcnt vmcnt(2)
    v_mfma_f32_32x32x16_bf16 v[96:111], v[48:51], a[192:195], v[96:111]
    s_waitcnt vmcnt(1)
    v_mfma_f32_32x32x16_bf16 v[96:111], v[52:55], a[196:199], v[96:111]
    v_mfma_f32_32x32x16_bf16 v[112:127], v[16:19], a[200:203], 0
    s_waitcnt lgkmcnt(9)
    v_add_f32 v130, v130, v132
    v_add_f32 v131, v131, v133
    s_waitcnt lgkmcnt(8)
    v_add_f32 v130, v130, v134
    v_add_f32 v131, v131, v135
    v_add_f32 v130, v130, v136
    v_add_f32 v131, v131, v137
    v_mul_f32 v130, 0x3acccccd, v130
    v_mfma_f32_32x32x16_bf16 v[112:127], v[20:23], a[204:207], v[112:127]
    v_mul_f32 v131, 0x3acccccd, v131
    v_fma_f32 v131, -v130, v130, v131
    v_max_f32 v131, 0, v131
    v_add_f32 v131, 0x3727c5ac, v131
    v_rsq_f32 v131, v131
    s_nop 0
    ds_write2_b32 v9, v130, v131 offset0:0 offset1:32
    ds_read_b128 v[138:141], v10 offset:0
    v_mfma_f32_32x32x16_bf16 v[112:127], v[24:27], a[208:211], v[112:127]
    ds_read_b128 v[142:145], v10 offset:16
    ds_read_b128 v[146:149], v10 offset:128
    ds_read_b128 v[150:153], v10 offset:144
    s_waitcnt lgkmcnt(10)
    v_add_f32 v184, v184, v192
    v_add_f32 v185, v185, v193
    v_add_f32 v186, v186, v194
    v_add_f32 v187, v187, v195
    v_mfma_f32_32x32x16_bf16 v[112:127], v[28:31], a[212:215], v[112:127]
    s_waitcnt lgkmcnt(9)
    v_add_f32 v188, v188, v196
    v_add_f32 v189, v189, v197
    v_add_f32 v190, v190, v198
    v_add_f32 v191, v191, v199
    s_waitcnt lgkmcnt(8)
    v_add_f32 v184, v184, v200
    v_add_f32 v185, v185, v201
    v_add_f32 v186, v186, v202
    v_mfma_f32_32x32x16_bf16 v[112:127], v[32:35], a[216:219], v[112:127]
    v_add_f32 v187, v187, v203
    s_waitcnt lgkmcnt(7)
    v_add_f32 v188, v188, v204
    v_add_f32 v189, v189, v205
    v_add_f32 v190, v190, v206
    v_add_f32 v191, v191, v207
    s_waitcnt lgkmcnt(6)
    v_add_f32 v184, v184, v208
    v_add_f32 v185, v185, v209
    v_mfma_f32_32x32x16_bf16 v[112:127], v[36:39], a[220:223], v[112:127]
    v_add_f32 v186, v186, v210
    v_add_f32 v187, v187, v211
    s_waitcnt lgkmcnt(5)
    v_add_f32 v188, v188, v212
    v_add_f32 v189, v189, v213
    v_add_f32 v190, v190, v214
    v_add_f32 v191, v191, v215
    s_waitcnt lgkmcnt(3)
    v_fma_f32 v184, -v138, v154, v184
    v_mfma_f32_32x32x16_bf16 v[112:127], v[40:43], a[224:227], v[112:127]
    ds_write_b128 v4, v[96:99] offset:0
    s_waitcnt lgkmcnt(2)
    v_mul_f32 v184, v184, v146
    v_fma_f32 v185, -v139, v155, v185
    v_mul_f32 v185, v185, v147
    v_fma_f32 v186, -v140, v156, v186
    v_mul_f32 v186, v186, v148
    v_fma_f32 v187, -v141, v157, v187
    v_mul_f32 v187, v187, v149
    v_mfma_f32_32x32x16_bf16 v[112:127], v[44:47], a[228:231], v[112:127]
    ds_write_b128 v4, v[100:103] offset:1024
    v_fma_f32 v188, -v142, v158, v188
    s_waitcnt lgkmcnt(2)
    v_mul_f32 v188, v188, v150
    v_fma_f32 v189, -v143, v159, v189
    v_mul_f32 v189, v189, v151
    v_fma_f32 v190, -v144, v160, v190
    v_mul_f32 v190, v190, v152
    v_fma_f32 v191, -v145, v161, v191
    v_mfma_f32_32x32x16_bf16 v[112:127], v[48:51], a[232:235], v[112:127]
    ds_write_b128 v4, v[104:107] offset:2048
    v_mul_f32 v191, v191, v153
    v_cvt_pk_bf16_f32 v172, v184, v185
    v_cvt_pk_bf16_f32 v173, v186, v187
    v_cvt_pk_bf16_f32 v174, v188, v189
    v_cvt_pk_bf16_f32 v175, v190, v191
    v_mfma_f32_32x32x16_bf16 v[112:127], v[52:55], a[236:239], v[112:127]
    ds_write_b128 v4, v[108:111] offset:3072
    s_mov_b32 s59, s55
    s_mul_i32 s55, s44, s58
    s_add_u32 s55, s55, s51
    v_mov_b64 v[128:129], 0
    s_mov_b32 s34, 0x3f803f80
    v_dot2c_f32_bf16 v128, s34, v16
    v_dot2c_f32_bf16 v129, v16, v16
    v_dot2c_f32_bf16 v128, s34, v17
    v_dot2c_f32_bf16 v129, v17, v17
    v_dot2c_f32_bf16 v128, s34, v18
    v_dot2c_f32_bf16 v129, v18, v18
    v_dot2c_f32_bf16 v128, s34, v19
    v_dot2c_f32_bf16 v129, v19, v19
    v_dot2c_f32_bf16 v128, s34, v20
    v_dot2c_f32_bf16 v129, v20, v20
    v_dot2c_f32_bf16 v128, s34, v21
    v_dot2c_f32_bf16 v129, v21, v21
    v_dot2c_f32_bf16 v128, s34, v22
    v_dot2c_f32_bf16 v129, v22, v22
    v_dot2c_f32_bf16 v128, s34, v23
    v_dot2c_f32_bf16 v129, v23, v23
    v_dot2c_f32_bf16 v128, s34, v24
    v_dot2c_f32_bf16 v129, v24, v24
    v_dot2c_f32_bf16 v128, s34, v25
    v_dot2c_f32_bf16 v129, v25, v25
    v_dot2c_f32_bf16 v128, s34, v26
    v_dot2c_f32_bf16 v129, v26, v26
    v_dot2c_f32_bf16 v128, s34, v27
    v_dot2c_f32_bf16 v129, v27, v27
    v_dot2c_f32_bf16 v128, s34, v28
    v_dot2c_f32_bf16 v129, v28, v28
    v_dot2c_f32_bf16 v128, s34, v29
    v_dot2c_f32_bf16 v129, v29, v29
    v_dot2c_f32_bf16 v128, s34, v30
    v_dot2c_f32_bf16 v129, v30, v30
    v_dot2c_f32_bf16 v128, s34, v31
    v_dot2c_f32_bf16 v129, v31, v31
    v_dot2c_f32_bf16 v128, s34, v32
    v_dot2c_f32_bf16 v129, v32, v32
    v_dot2c_f32_bf16 v128, s34, v33
    v_dot2c_f32_bf16 v129, v33, v33
    v_dot2c_f32_bf16 v128, s34, v34
    v_dot2c_f32_bf16 v129, v34, v34
    v_dot2c_f32_bf16 v128, s34, v35
    v_dot2c_f32_bf16 v129, v35, v35
    v_dot2c_f32_bf16 v128, s34, v36
    v_dot2c_f32_bf16 v129, v36, v36
    v_dot2c_f32_bf16 v128, s34, v37
    v_dot2c_f32_bf16 v129, v37, v37
    v_dot2c_f32_bf16 v128, s34, v38
    v_dot2c_f32_bf16 v129, v38, v38
    v_dot2c_f32_bf16 v128, s34, v39
    v_dot2c_f32_bf16 v129, v39, v39
    v_dot2c_f32_bf16 v128, s34, v40
    v_dot2c_f32_bf16 v129, v40, v40
    v_dot2c_f32_bf16 v128, s34, v41
    v_dot2c_f32_bf16 v129, v41, v41
    v_dot2c_f32_bf16 v128, s34, v42
    v_dot2c_f32_bf16 v129, v42, v42
    v_dot2c_f32_bf16 v128, s34, v43
    v_dot2c_f32_bf16 v129, v43, v43
    v_dot2c_f32_bf16 v128, s34, v44
    v_dot2c_f32_bf16 v129, v44, v44
    v_dot2c_f32_bf16 v128, s34, v45
    v_dot2c_f32_bf16 v129, v45, v45
    v_dot2c_f32_bf16 v128, s34, v46
    v_dot2c_f32_bf16 v129, v46, v46
    v_dot2c_f32_bf16 v128, s34, v47
    v_dot2c_f32_bf16 v129, v47, v47
    v_dot2c_f32_bf16 v128, s34, v48
    v_dot2c_f32_bf16 v129, v48, v48
    v_dot2c_f32_bf16 v128, s34, v49
    v_dot2c_f32_bf16 v129, v49, v49
    v_dot2c_f32_bf16 v128, s34, v50
    v_dot2c_f32_bf16 v129, v50, v50
    v_dot2c_f32_bf16 v128, s34, v51
    v_dot2c_f32_bf16 v129, v51, v51
    v_dot2c_f32_bf16 v128, s34, v52
    v_dot2c_f32_bf16 v129, v52, v52
    v_dot2c_f32_bf16 v128, s34, v53
    v_dot2c_f32_bf16 v129, v53, v53
    v_dot2c_f32_bf16 v128, s34, v54
    v_dot2c_f32_bf16 v129, v54, v54
    v_dot2c_f32_bf16 v128, s34, v55
    v_dot2c_f32_bf16 v129, v55, v55
    s_nop 2
    v_mov_b64 v[176:177], v[128:129]
    s_nop 1
    v_permlane32_swap_b32 v128, v176
    v_permlane32_swap_b32 v129, v177
    v_pk_add_f32 v[128:129], v[128:129], v[176:177]
    ds_write_b64 v5, v[128:129] offset:0
    ds_write_b128 v4, v[112:115] offset:4096
    ds_write_b128 v4, v[116:119] offset:5120
    ds_write_b128 v4, v[120:123] offset:6144
    ds_write_b128 v4, v[124:127] offset:7168
    s_waitcnt vmcnt(0)
    s_waitcnt lgkmcnt(0)
    s_barrier
    buffer_store_dwordx4 v[172:175], v7, s[4:7], s59 offen sc1
    ds_read_b128 v[130:133], v6 offset:0
    ds_read_b128 v[134:137], v6 offset:16
    ds_read_b128 v[184:187], v3 offset:0
    ds_read_b128 v[188:191], v3 offset:1024
    ds_read_b128 v[192:195], v3 offset:8192
    ds_read_b128 v[196:199], v3 offset:9216
    ds_read_b128 v[200:203], v3 offset:16384
    ds_read_b128 v[204:207], v3 offset:17408
    ds_read_b128 v[208:211], v3 offset:24576
    ds_read_b128 v[212:215], v3 offset:25600
    s_waitcnt lgkmcnt(9)
    v_add_f32 v130, v130, v132
    v_add_f32 v131, v131, v133
    s_waitcnt lgkmcnt(8)
    v_add_f32 v130, v130, v134
    v_add_f32 v131, v131, v135
    v_add_f32 v130, v130, v136
    v_add_f32 v131, v131, v137
    v_mul_f32 v130, 0x3acccccd, v130
    v_mul_f32 v131, 0x3acccccd, v131
    v_fma_f32 v131, -v130, v130, v131
    v_max_f32 v131, 0, v131
    v_add_f32 v131, 0x3727c5ac, v131
    v_rsq_f32 v131, v131
    s_nop 0
    ds_write2_b32 v9, v130, v131 offset0:0 offset1:32
    ds_read_b128 v[138:141], v10 offset:0
    ds_read_b128 v[142:145], v10 offset:16
    ds_read_b128 v[146:149], v10 offset:128
    ds_read_b128 v[150:153], v10 offset:144
    s_waitcnt lgkmcnt(10)
    v_add_f32 v184, v184, v192
    v_add_f32 v185, v185, v193
    v_add_f32 v186, v186, v194
    v_add_f32 v187, v187, v195
    s_waitcnt lgkmcnt(9)
    v_add_f32 v188, v188, v196
    v_add_f32 v189, v189, v197
    v_add_f32 v190, v190, v198
    v_add_f32 v191, v191, v199
    s_waitcnt lgkmcnt(8)
    v_add_f32 v184, v184, v200
    v_add_f32 v185, v185, v201
    v_add_f32 v186, v186, v202
    v_add_f32 v187, v187, v203
    s_waitcnt lgkmcnt(7)
    v_add_f32 v188, v188, v204
    v_add_f32 v189, v189, v205
    v_add_f32 v190, v190, v206
    v_add_f32 v191, v191, v207
    s_waitcnt lgkmcnt(6)
    v_add_f32 v184, v184, v208
    v_add_f32 v185, v185, v209
    v_add_f32 v186, v186, v210
    v_add_f32 v187, v187, v211
    s_waitcnt lgkmcnt(5)
    v_add_f32 v188, v188, v212
    v_add_f32 v189, v189, v213
    v_add_f32 v190, v190, v214
    v_add_f32 v191, v191, v215
    s_waitcnt lgkmcnt(3)
    v_fma_f32 v184, -v138, v154, v184
    s_waitcnt lgkmcnt(1)
    v_mul_f32 v184, v184, v146
    v_fma_f32 v185, -v139, v155, v185
    v_mul_f32 v185, v185, v147
    v_fma_f32 v186, -v140, v156, v186
    v_mul_f32 v186, v186, v148
    v_fma_f32 v187, -v141, v157, v187
    v_mul_f32 v187, v187, v149
    v_fma_f32 v188, -v142, v158, v188
    s_waitcnt lgkmcnt(0)
    v_mul_f32 v188, v188, v150
    v_fma_f32 v189, -v143, v159, v189
    v_mul_f32 v189, v189, v151
    v_fma_f32 v190, -v144, v160, v190
    v_mul_f32 v190, v190, v152
    v_fma_f32 v191, -v145, v161, v191
    v_mul_f32 v191, v191, v153
    v_cvt_pk_bf16_f32 v172, v184, v185
    v_cvt_pk_bf16_f32 v173, v186, v187
    v_cvt_pk_bf16_f32 v174, v188, v189
    v_cvt_pk_bf16_f32 v175, v190, v191
    s_mov_b32 s59, s55
    buffer_store_dwordx4 v[172:175], v7, s[4:7], s59 offen sc1
G_262:
    s_waitcnt vmcnt(0)
    s_barrier
    s_cmp_lg_u32 s29, 0
    s_cbranch_scc1 F_265
    s_lshl_b32 s32, s28, 5
    s_add_u32 s32, s32, s29
    s_lshl_b32 s32, s32, 2
    s_add_u32 s32, s32, 1073152
    v_mov_b32 v172, 1
    s_mov_b64 exec, 1
    buffer_store_dword v172, off, s[4:7], s32 sc1
    s_mov_b64 exec, -1
F_265:
R_260:
    s_cmp_lt_u32 s28, 160
    s_cbranch_scc1 R_266
    v_mov_b64 v[4:5], -1
    v_mov_b64 v[6:7], -1
    s_sub_u32 s34, s28, 160
    s_lshl_b32 s34, s34, 2
    s_add_u32 s34, s34, s29
    s_lshl_b32 s34, s34, 14
    s_add_u32 s35, s34, 2097152
    buffer_store_dwordx4 v[4:7], v0, s[4:7], s35 offen sc1
    s_add_u32 s35, s34, 2098176
    buffer_store_dwordx4 v[4:7], v0, s[4:7], s35 offen sc1
    s_add_u32 s35, s34, 2099200
    buffer_store_dwordx4 v[4:7], v0, s[4:7], s35 offen sc1
    s_add_u32 s35, s34, 2100224
    buffer_store_dwordx4 v[4:7], v0, s[4:7], s35 offen sc1
    s_add_u32 s35, s34, 2101248
    buffer_store_dwordx4 v[4:7], v0, s[4:7], s35 offen sc1
    s_add_u32 s35, s34, 2105344
    buffer_store_dwordx4 v[4:7], v0, s[4:7], s35 offen sc1
    s_add_u32 s35, s34, 2106368
    buffer_store_dwordx4 v[4:7], v0, s[4:7], s35 offen sc1
    s_add_u32 s35, s34, 2107392
    buffer_store_dwordx4 v[4:7], v0, s[4:7], s35 offen sc1
    s_add_u32 s35, s34, 2108416
    buffer_store_dwordx4 v[4:7], v0, s[4:7], s35 offen sc1
    s_add_u32 s35, s34, 2109440
    buffer_store_dwordx4 v[4:7], v0, s[4:7], s35 offen sc1
    s_add_u32 s35, s34, 6291456
    buffer_store_dwordx4 v[4:7], v0, s[4:7], s35 offen sc1
    s_add_u32 s35, s34, 6292480
    buffer_store_dwordx4 v[4:7], v0, s[4:7], s35 offen sc1
    s_add_u32 s35, s34, 6293504
    buffer_store_dwordx4 v[4:7], v0, s[4:7], s35 offen sc1
    s_add_u32 s35, s34, 6294528
    buffer_store_dwordx4 v[4:7], v0, s[4:7], s35 offen sc1
    s_add_u32 s35, s34, 6295552
    buffer_store_dwordx4 v[4:7], v0, s[4:7], s35 offen sc1
    s_add_u32 s35, s34, 6299648
    buffer_store_dwordx4 v[4:7], v0, s[4:7], s35 offen sc1
    s_add_u32 s35, s34, 6300672
    buffer_store_dwordx4 v[4:7], v0, s[4:7], s35 offen sc1
    s_add_u32 s35, s34, 6301696
    buffer_store_dwordx4 v[4:7], v0, s[4:7], s35 offen sc1
    s_add_u32 s35, s34, 6302720
    buffer_store_dwordx4 v[4:7], v0, s[4:7], s35 offen sc1
    s_add_u32 s35, s34, 6303744
    buffer_store_dwordx4 v[4:7], v0, s[4:7], s35 offen sc1
    s_waitcnt vmcnt(0)
    s_barrier
    s_cmp_lg_u32 s29, 0
    s_cbranch_scc1 F_267
    s_lshl_b32 s32, s28, 5
    s_add_u32 s32, s32, s29
    s_lshl_b32 s32, s32, 2
    s_add_u32 s32, s32, 1220608
    v_mov_b32 v8, 1
    s_mov_b64 exec, 1
    buffer_store_dword v8, off, s[4:7], s32 sc1
    s_mov_b64 exec, -1
F_267:
    s_lshl_b32 s34, s64, 3
    s_add_u32 s34, s34, 48
    s_cmp_eq_u32 s64, 2
    s_cselect_b32 s34, 40, s34
    s_load_dwordx2 s[20:21], s[0:1], s34
    s_mov_b32 s22, 5242880
    s_mov_b32 s23, 0x20000
    s_waitcnt lgkmcnt(0)
    v_bfe_u32 v14, v1, 2, 4
    v_mul_u32_u24 v14, 8192, v14
    v_bfe_u32 v15, v1, 0, 2
    v_lshl_add_u32 v14, v15, 4, v14
    s_lshl_b32 s38, s29, 6
    s_lshl_b32 s35, s63, 8
    s_add_u32 s38, s38, s35
    s_add_u32 m0, s60, 0
    s_add_u32 s39, s38, 2621440
    buffer_load_dwordx4 v14, s[20:23], s39 offen lds
    s_add_u32 m0, s60, 1024
    s_add_u32 s39, s38, 2752512
    buffer_load_dwordx4 v14, s[20:23], s39 offen lds
    s_add_u32 m0, s60, 2048
    s_add_u32 s39, s38, 2883584
    buffer_load_dwordx4 v14, s[20:23], s39 offen lds
    s_add_u32 m0, s60, 3072
    s_add_u32 s39, s38, 3014656
    buffer_load_dwordx4 v14, s[20:23], s39 offen lds
    s_add_u32 m0, s60, 4096
    s_add_u32 s39, s38, 3145728
    buffer_load_dwordx4 v14, s[20:23], s39 offen lds
    s_add_u32 m0, s60, 5120
    s_add_u32 s39, s38, 3276800
    buffer_load_dwordx4 v14, s[20:23], s39 offen lds
    s_add_u32 m0, s60, 6144
    s_add_u32 s39, s38, 3407872
    buffer_load_dwordx4 v14, s[20:23], s39 offen lds
    s_add_u32 m0, s60, 7168
    s_add_u32 s39, s38, 3538944
    buffer_load_dwordx4 v14, s[20:23], s39 offen lds
    s_add_u32 m0, s60, 8192
    s_add_u32 s39, s38, 3670016
    buffer_load_dwordx4 v14, s[20:23], s39 offen lds
    s_add_u32 m0, s60, 9216
    s_add_u32 s39, s38, 3801088
    buffer_load_dwordx4 v14, s[20:23], s39 offen lds
    s_add_u32 m0, s60, 10240
    s_add_u32 s39, s38, 3932160
    buffer_load_dwordx4 v14, s[20:23], s39 offen lds
    s_add_u32 m0, s60, 11264
    s_add_u32 s39, s38, 4063232
    buffer_load_dwordx4 v14, s[20:23], s39 offen lds
    s_add_u32 m0, s60, 12288
    s_add_u32 s39, s38, 4194304
    buffer_load_dwordx4 v14, s[20:23], s39 offen lds
    s_add_u32 m0, s60, 13312
    s_add_u32 s39, s38, 4325376
    buffer_load_dwordx4 v14, s[20:23], s39 offen lds
    s_add_u32 m0, s60, 14336
    s_add_u32 s39, s38, 4456448
    buffer_load_dwordx4 v14, s[20:23], s39 offen lds
    s_add_u32 m0, s60, 15360
    s_add_u32 s39, s38, 4587520
    buffer_load_dwordx4 v14, s[20:23], s39 offen lds
    s_add_u32 m0, s60, 16384
    s_add_u32 s39, s38, 4718592
    buffer_load_dwordx4 v14, s[20:23], s39 offen lds
    s_add_u32 m0, s60, 17408
    s_add_u32 s39, s38, 4849664
    buffer_load_dwordx4 v14, s[20:23], s39 offen lds
    s_add_u32 m0, s60, 18432
    s_add_u32 s39, s38, 4980736
    buffer_load_dwordx4 v14, s[20:23], s39 offen lds
    s_add_u32 m0, s60, 19456
    s_add_u32 s39, s38, 5111808
    buffer_load_dwordx4 v14, s[20:23], s39 offen lds
R_266:
    s_waitcnt lgkmcnt(0)
LAYER_268:
    s_cmp_ge_u32 s28, 160
    s_cbranch_scc1 R_273
    s_and_b32 s40, s29, 1
    s_lshr_b32 s41, s29, 1
    s_mul_i32 s32, s29, 40
    v_min_u32 v6, 39, v1
    v_add_u32 v6, s32, v6
    v_min_u32 v6, 159, v6
    v_lshlrev_b32 v6, 7, v6
    s_mov_b32 s32, 1048576
    s_mov_b32 s48, 0
P_274:
    buffer_load_dword v2, v6, s[4:7], s32 offen sc1
    s_waitcnt vmcnt(0)
    v_cmp_gt_u32 vcc, 1, v2
    s_cbranch_vccz P_275
    s_add_u32 s48, s48, 1
    s_cmp_gt_u32 s48, 200000
    s_cbranch_scc1 L_end
    s_sleep 1
    s_branch P_274
P_275:
    s_barrier
    s_lshl_b32 s34, s28, 1
    s_add_u32 s42, s34, s41
    s_lshl_b32 s34, s42, 4
    s_mul_i32 s35, s40, 1310720
    s_add_u32 s34, s34, s35
    s_add_u32 s34, s34, 8388608
    v_bfe_u32 v2, v1, 0, 5
    v_mul_u32_u24 v2, 40960, v2
    v_bfe_u32 v3, v1, 5, 1
    v_mul_u32_u24 v3, 20480, v3
    v_add_u32 v2, v2, v3
    s_add_u32 s35, s34, 0
    buffer_load_dwordx4 v[216:219], v2, s[4:7], s35 offen sc1
    s_add_u32 s35, s34, 5120
    buffer_load_dwordx4 v[220:223], v2, s[4:7], s35 offen sc1
    s_add_u32 s35, s34, 10240
    buffer_load_dwordx4 v[224:227], v2, s[4:7], s35 offen sc1
    s_add_u32 s35, s34, 15360
    buffer_load_dwordx4 v[228:231], v2, s[4:7], s35 offen sc1
    s_lshl_b32 s34, s40, 5
    v_bfe_u32 v3, v1, 0, 5
    v_add_u32 v3, s34, v3
    v_bfe_u32 v4, v1, 5, 1
    v_mul_u32_u24 v4, 4, v4
    v_bfe_u32 v5, v1, 0, 5
    v_add_u32 v7, 0, v4
    v_mul_u32_u24 v7, v7, v3
    v_cvt_f32_u32 v7, v7
    v_cvt_f32_u32 v8, v3
    v_mul_f32 v7, 0x3c800000, v7
    v_mul_f32 v8, 0x3c800000, v8
    v_fmamk_f32 v10, v8, 0x0, v7
    v_sin_f32 v12, v10
    v_cos_f32 v10, v10
    v_fmamk_f32 v11, v8, 0x3f800000, v7
    v_sin_f32 v13, v11
    v_cos_f32 v11, v11
    v_cvt_pk_bf16_f32 v32, v12, v13
    v_cvt_pk_bf16_f32 v16, v10, v11
    v_xor_b32 v48, 0x80008000, v32
    v_fmamk_f32 v10, v8, 0x40000000, v7
    v_sin_f32 v12, v10
    v_cos_f32 v10, v10
    v_fmamk_f32 v11, v8, 0x40400000, v7
    v_sin_f32 v13, v11
    v_cos_f32 v11, v11
    v_cvt_pk_bf16_f32 v33, v12, v13
    v_cvt_pk_bf16_f32 v17, v10, v11
    v_xor_b32 v49, 0x80008000, v33
    v_fmamk_f32 v10, v8, 0x41000000, v7
    v_sin_f32 v12, v10
    v_cos_f32 v10, v10
    v_fmamk_f32 v11, v8, 0x41100000, v7
    v_sin_f32 v13, v11
    v_cos_f32 v11, v11
    v_cvt_pk_bf16_f32 v34, v12, v13
    v_cvt_pk_bf16_f32 v18, v10, v11
    v_xor_b32 v50, 0x80008000, v34
    v_fmamk_f32 v10, v8, 0x41200000, v7
    v_sin_f32 v12, v10
    v_cos_f32 v10, v10
    v_fmamk_f32 v11, v8, 0x41300000, v7
    v_sin_f32 v13, v11
    v_cos_f32 v11, v11
    v_cvt_pk_bf16_f32 v35, v12, v13
    v_cvt_pk_bf16_f32 v19, v10, v11
    v_xor_b32 v51, 0x80008000, v35
    v_fmamk_f32 v10, v8, 0x41800000, v7
    v_sin_f32 v12, v10
    v_cos_f32 v10, v10
    v_fmamk_f32 v11, v8, 0x41880000, v7
    v_sin_f32 v13, v11
    v_cos_f32 v11, v11
    v_cvt_pk_bf16_f32 v36, v12, v13
    v_cvt_pk_bf16_f32 v20, v10, v11
    v_xor_b32 v52, 0x80008000, v36
    v_fmamk_f32 v10, v8, 0x41900000, v7
    v_sin_f32 v12, v10
    v_cos_f32 v10, v10
    v_fmamk_f32 v11, v8, 0x41980000, v7
    v_sin_f32 v13, v11
    v_cos_f32 v11, v11
    v_cvt_pk_bf16_f32 v37, v12, v13
    v_cvt_pk_bf16_f32 v21, v10, v11
    v_xor_b32 v53, 0x80008000, v37
    v_fmamk_f32 v10, v8, 0x41c00000, v7
    v_sin_f32 v12, v10
    v_cos_f32 v10, v10
    v_fmamk_f32 v11, v8, 0x41c80000, v7
    v_sin_f32 v13, v11
    v_cos_f32 v11, v11
    v_cvt_pk_bf16_f32 v38, v12, v13
    v_cvt_pk_bf16_f32 v22, v10, v11
    v_xor_b32 v54, 0x80008000, v38
    v_fmamk_f32 v10, v8, 0x41d00000, v7
    v_sin_f32 v12, v10
    v_cos_f32 v10, v10
    v_fmamk_f32 v11, v8, 0x41d80000, v7
    v_sin_f32 v13, v11
    v_cos_f32 v11, v11
    v_cvt_pk_bf16_f32 v39, v12, v13
    v_cvt_pk_bf16_f32 v23, v10, v11
    v_xor_b32 v55, 0x80008000, v39
    v_fmamk_f32 v10, v8, 0x42000000, v7
    v_sin_f32 v12, v10
    v_cos_f32 v10, v10
    v_fmamk_f32 v11, v8, 0x42040000, v7
    v_sin_f32 v13, v11
    v_cos_f32 v11, v11
    v_cvt_pk_bf16_f32 v40, v12, v13
    v_cvt_pk_bf16_f32 v24, v10, v11
    v_xor_b32 v56, 0x80008000, v40
    v_fmamk_f32 v10, v8, 0x42080000, v7
    v_sin_f32 v12, v10
    v_cos_f32 v10, v10
    v_fmamk_f32 v11, v8, 0x420c0000, v7
    v_sin_f32 v13, v11
    v_cos_f32 v11, v11
    v_cvt_pk_bf16_f32 v41, v12, v13
    v_cvt_pk_bf16_f32 v25, v10, v11
    v_xor_b32 v57, 0x80008000, v41
    v_fmamk_f32 v10, v8, 0x42200000, v7
    v_sin_f32 v12, v10
    v_cos_f32 v10, v10
    v_fmamk_f32 v11, v8, 0x42240000, v7
    v_sin_f32 v13, v11
    v_cos_f32 v11, v11
    v_cvt_pk_bf16_f32 v42, v12, v13
    v_cvt_pk_bf16_f32 v26, v10, v11
    v_xor_b32 v58, 0x80008000, v42
    v_fmamk_f32 v10, v8, 0x42280000, v7
    v_sin_f32 v12, v10
    v_cos_f32 v10, v10
    v_fmamk_f32 v11, v8, 0x422c0000, v7
    v_sin_f32 v13, v11
    v_cos_f32 v11, v11
    v_cvt_pk_bf16_f32 v43, v12, v13
    v_cvt_pk_bf16_f32 v27, v10, v11
    v_xor_b32 v59, 0x80008000, v43
    v_fmamk_f32 v10, v8, 0x42400000, v7
    v_sin_f32 v12, v10
    v_cos_f32 v10, v10
    v_fmamk_f32 v11, v8, 0x42440000, v7
    v_sin_f32 v13, v11
    v_cos_f32 v11, v11
    v_cvt_pk_bf16_f32 v44, v12, v13
    v_cvt_pk_bf16_f32 v28, v10, v11
    v_xor_b32 v60, 0x80008000, v44
    v_fmamk_f32 v10, v8, 0x42480000, v7
    v_sin_f32 v12, v10
    v_cos_f32 v10, v10
    v_fmamk_f32 v11, v8, 0x424c0000, v7
    v_sin_f32 v13, v11
    v_cos_f32 v11, v11
    v_cvt_pk_bf16_f32 v45, v12, v13
    v_cvt_pk_bf16_f32 v29, v10, v11
    v_xor_b32 v61, 0x80008000, v45
    v_fmamk_f32 v10, v8, 0x42600000, v7
    v_sin_f32 v12, v10
    v_cos_f32 v10, v10
    v_fmamk_f32 v11, v8, 0x42640000, v7
    v_sin_f32 v13, v11
    v_cos_f32 v11, v11
    v_cvt_pk_bf16_f32 v46, v12, v13
    v_cvt_pk_bf16_f32 v30, v10, v11
    v_xor_b32 v62, 0x80008000, v46
    v_fmamk_f32 v10, v8, 0x42680000, v7
    v_sin_f32 v12, v10
    v_cos_f32 v10, v10
    v_fmamk_f32 v11, v8, 0x426c0000, v7
    v_sin_f32 v13, v11
    v_cos_f32 v11, v11
    v_cvt_pk_bf16_f32 v47, v12, v13
    v_cvt_pk_bf16_f32 v31, v10, v11
    v_xor_b32 v63, 0x80008000, v47
    v_add_u32 v7, 0, v4
    v_mul_u32_u24 v7, v7, v5
    v_cvt_f32_u32 v7, v7
    v_cvt_f32_u32 v8, v5
    v_mul_f32 v7, 0x3d000000, v7
    v_mul_f32 v8, 0x3d000000, v8
    v_fmamk_f32 v10, v8, 0x0, v7
    v_sin_f32 v12, v10
    v_cos_f32 v10, v10
    v_fmamk_f32 v11, v8, 0x3f800000, v7
    v_sin_f32 v13, v11
    v_cos_f32 v11, v11
    v_cvt_pk_bf16_f32 v72, v12, v13
    v_cvt_pk_bf16_f32 v64, v10, v11
    v_xor_b32 v80, 0x80008000, v72
    v_fmamk_f32 v10, v8, 0x40000000, v7
    v_sin_f32 v12, v10
    v_cos_f32 v10, v10
    v_fmamk_f32 v11, v8, 0x40400000, v7
    v_sin_f32 v13, v11
    v_cos_f32 v11, v11
    v_cvt_pk_bf16_f32 v73, v12, v13
    v_cvt_pk_bf16_f32 v65, v10, v11
    v_xor_b32 v81, 0x80008000, v73
    v_fmamk_f32 v10, v8, 0x41000000, v7
    v_sin_f32 v12, v10
    v_cos_f32 v10, v10
    v_fmamk_f32 v11, v8, 0x41100000, v7
    v_sin_f32 v13, v11
    v_cos_f32 v11, v11
    v_cvt_pk_bf16_f32 v74, v12, v13
    v_cvt_pk_bf16_f32 v66, v10, v11
    v_xor_b32 v82, 0x80008000, v74
    v_fmamk_f32 v10, v8, 0x41200000, v7
    v_sin_f32 v12, v10
    v_cos_f32 v10, v10
    v_fmamk_f32 v11, v8, 0x41300000, v7
    v_sin_f32 v13, v11
    v_cos_f32 v11, v11
    v_cvt_pk_bf16_f32 v75, v12, v13
    v_cvt_pk_bf16_f32 v67, v10, v11
    v_xor_b32 v83, 0x80008000, v75
    v_fmamk_f32 v10, v8, 0x41800000, v7
    v_sin_f32 v12, v10
    v_cos_f32 v10, v10
    v_fmamk_f32 v11, v8, 0x41880000, v7
    v_sin_f32 v13, v11
    v_cos_f32 v11, v11
    v_cvt_pk_bf16_f32 v76, v12, v13
    v_cvt_pk_bf16_f32 v68, v10, v11
    v_xor_b32 v84, 0x80008000, v76
    v_fmamk_f32 v10, v8, 0x41900000, v7
    v_sin_f32 v12, v10
    v_cos_f32 v10, v10
    v_fmamk_f32 v11, v8, 0x41980000, v7
    v_sin_f32 v13, v11
    v_cos_f32 v11, v11
    v_cvt_pk_bf16_f32 v77, v12, v13
    v_cvt_pk_bf16_f32 v69, v10, v11
    v_xor_b32 v85, 0x80008000, v77
    v_fmamk_f32 v10, v8, 0x41c00000, v7
    v_sin_f32 v12, v10
    v_cos_f32 v10, v10
    v_fmamk_f32 v11, v8, 0x41c80000, v7
    v_sin_f32 v13, v11
    v_cos_f32 v11, v11
    v_cvt_pk_bf16_f32 v78, v12, v13
    v_cvt_pk_bf16_f32 v70, v10, v11
    v_xor_b32 v86, 0x80008000, v78
    v_fmamk_f32 v10, v8, 0x41d00000, v7
    v_sin_f32 v12, v10
    v_cos_f32 v10, v10
    v_fmamk_f32 v11, v8, 0x41d80000, v7
    v_sin_f32 v13, v11
    v_cos_f32 v11, v11
    v_cvt_pk_bf16_f32 v79, v12, v13
    v_cvt_pk_bf16_f32 v71, v10, v11
    v_xor_b32 v87, 0x80008000, v79
    v_add_u32 v7, 0, v4
    v_mul_u32_u24 v7, v7, v3
    v_cvt_f32_u32 v7, v7
    v_cvt_f32_u32 v8, v3
    v_mul_f32 v7, 0x3a000000, v7
    v_mul_f32 v8, 0x3a000000, v8
    v_fmamk_f32 v88, v8, 0x0, v7
    v_sin_f32 v104, v88
    v_cos_f32 v88, v88
    v_fmamk_f32 v89, v8, 0x3f800000, v7
    v_sin_f32 v105, v89
    v_cos_f32 v89, v89
    v_fmamk_f32 v90, v8, 0x40000000, v7
    v_sin_f32 v106, v90
    v_cos_f32 v90, v90
    v_fmamk_f32 v91, v8, 0x40400000, v7
    v_sin_f32 v107, v91
    v_cos_f32 v91, v91
    v_fmamk_f32 v92, v8, 0x41000000, v7
    v_sin_f32 v108, v92
    v_cos_f32 v92, v92
    v_fmamk_f32 v93, v8, 0x41100000, v7
    v_sin_f32 v109, v93
    v_cos_f32 v93, v93
    v_fmamk_f32 v94, v8, 0x41200000, v7
    v_sin_f32 v110, v94
    v_cos_f32 v94, v94
    v_fmamk_f32 v95, v8, 0x41300000, v7
    v_sin_f32 v111, v95
    v_cos_f32 v95, v95
    v_fmamk_f32 v96, v8, 0x41800000, v7
    v_sin_f32 v112, v96
    v_cos_f32 v96, v96
    v_fmamk_f32 v97, v8, 0x41880000, v7
    v_sin_f32 v113, v97
    v_cos_f32 v97, v97
    v_fmamk_f32 v98, v8, 0x41900000, v7
    v_sin_f32 v114, v98
    v_cos_f32 v98, v98
    v_fmamk_f32 v99, v8, 0x41980000, v7
    v_sin_f32 v115, v99
    v_cos_f32 v99, v99
    v_fmamk_f32 v100, v8, 0x41c00000, v7
    v_sin_f32 v116, v100
    v_cos_f32 v100, v100
    v_fmamk_f32 v101, v8, 0x41c80000, v7
    v_sin_f32 v117, v101
    v_cos_f32 v101, v101
    v_fmamk_f32 v102, v8, 0x41d00000, v7
    v_sin_f32 v118, v102
    v_cos_f32 v102, v102
    v_fmamk_f32 v103, v8, 0x41d80000, v7
    v_sin_f32 v119, v103
    v_cos_f32 v103, v103
    v_add_u32 v7, s34, v4
    v_mul_u32_u24 v7, v7, v5
    v_cvt_f32_u32 v7, v7
    v_cvt_f32_u32 v8, v5
    v_mul_f32 v7, 0x3a000000, v7
    v_mul_f32 v8, 0x3a000000, v8
    v_fmamk_f32 v120, v8, 0x0, v7
    v_sin_f32 v136, v120
    v_cos_f32 v120, v120
    v_fmamk_f32 v121, v8, 0x3f800000, v7
    v_sin_f32 v137, v121
    v_cos_f32 v121, v121
    v_fmamk_f32 v122, v8, 0x40000000, v7
    v_sin_f32 v138, v122
    v_cos_f32 v122, v122
    v_fmamk_f32 v123, v8, 0x40400000, v7
    v_sin_f32 v139, v123
    v_cos_f32 v123, v123
    v_fmamk_f32 v124, v8, 0x41000000, v7
    v_sin_f32 v140, v124
    v_cos_f32 v124, v124
    v_fmamk_f32 v125, v8, 0x41100000, v7
    v_sin_f32 v141, v125
    v_cos_f32 v125, v125
    v_fmamk_f32 v126, v8, 0x41200000, v7
    v_sin_f32 v142, v126
    v_cos_f32 v126, v126
    v_fmamk_f32 v127, v8, 0x41300000, v7
    v_sin_f32 v143, v127
    v_cos_f32 v127, v127
    v_fmamk_f32 v128, v8, 0x41800000, v7
    v_sin_f32 v144, v128
    v_cos_f32 v128, v128
    v_fmamk_f32 v129, v8, 0x41880000, v7
    v_sin_f32 v145, v129
    v_cos_f32 v129, v129
    v_fmamk_f32 v130, v8, 0x41900000, v7
    v_sin_f32 v146, v130
    v_cos_f32 v130, v130
    v_fmamk_f32 v131, v8, 0x41980000, v7
    v_sin_f32 v147, v131
    v_cos_f32 v131, v131
    v_fmamk_f32 v132, v8, 0x41c00000, v7
    v_sin_f32 v148, v132
    v_cos_f32 v132, v132
    v_fmamk_f32 v133, v8, 0x41c80000, v7
    v_sin_f32 v149, v133
    v_cos_f32 v133, v133
    v_fmamk_f32 v134, v8, 0x41d00000, v7
    v_sin_f32 v150, v134
    v_cos_f32 v134, v134
    v_fmamk_f32 v135, v8, 0x41d80000, v7
    v_sin_f32 v151, v135
    v_cos_f32 v135, v135
    s_mov_b32 s36, 0x35cccccd
    s_cmp_eq_u32 s42, 319
    s_cselect_b32 s35, 0x354ccccd, s36
    s_waitcnt vmcnt(3)
    v_lshlrev_b32 v152, 16, v216
    v_and_b32 v168, 0xffff0000, v216
    v_mul_f32 v152, s35, v152
    v_mul_f32 v168, s35, v168
    v_lshlrev_b32 v153, 16, v217
    v_and_b32 v169, 0xffff0000, v217
    v_mul_f32 v153, s35, v153
    v_mul_f32 v169, s35, v169
    v_lshlrev_b32 v154, 16, v218
    v_and_b32 v170, 0xffff0000, v218
    v_mul_f32 v154, s35, v154
    v_mul_f32 v170, s35, v170
    v_lshlrev_b32 v155, 16, v219
    v_and_b32 v171, 0xffff0000, v219
    v_mul_f32 v155, s35, v155
    v_mul_f32 v171, s35, v171
    s_waitcnt vmcnt(2)
    v_lshlrev_b32 v156, 16, v220
    v_and_b32 v172, 0xffff0000, v220
    v_mul_f32 v156, s35, v156
    v_mul_f32 v172, s35, v172
    v_lshlrev_b32 v157, 16, v221
    v_and_b32 v173, 0xffff0000, v221
    v_mul_f32 v157, s35, v157
    v_mul_f32 v173, s35, v173
    v_lshlrev_b32 v158, 16, v222
    v_and_b32 v174, 0xffff0000, v222
    v_mul_f32 v158, s35, v158
    v_mul_f32 v174, s35, v174
    v_lshlrev_b32 v159, 16, v223
    v_and_b32 v175, 0xffff0000, v223
    v_mul_f32 v159, s35, v159
    v_mul_f32 v175, s35, v175
    s_waitcnt vmcnt(1)
    v_lshlrev_b32 v160, 16, v224
    v_and_b32 v176, 0xffff0000, v224
    v_mul_f32 v160, s35, v160
    v_mul_f32 v176, s35, v176
    v_lshlrev_b32 v161, 16, v225
    v_and_b32 v177, 0xffff0000, v225
    v_mul_f32 v161, s35, v161
    v_mul_f32 v177, s35, v177
    v_lshlrev_b32 v162, 16, v226
    v_and_b32 v178, 0xffff0000, v226
    v_mul_f32 v162, s35, v162
    v_mul_f32 v178, s35, v178
    v_lshlrev_b32 v163, 16, v227
    v_and_b32 v179, 0xffff0000, v227
    v_mul_f32 v163, s35, v163
    v_mul_f32 v179, s35, v179
    s_waitcnt vmcnt(0)
    v_lshlrev_b32 v164, 16, v228
    v_and_b32 v180, 0xffff0000, v228
    v_mul_f32 v164, s35, v164
    v_mul_f32 v180, s35, v180
    v_lshlrev_b32 v165, 16, v229
    v_and_b32 v181, 0xffff0000, v229
    v_mul_f32 v165, s35, v165
    v_mul_f32 v181, s35, v181
    v_lshlrev_b32 v166, 16, v230
    v_and_b32 v182, 0xffff0000, v230
    v_mul_f32 v166, s35, v166
    v_mul_f32 v182, s35, v182
    v_lshlrev_b32 v167, 16, v231
    v_and_b32 v183, 0xffff0000, v231
    v_mul_f32 v167, s35, v167
    v_mul_f32 v183, s35, v183
    v_bfe_u32 v2, v1, 4, 2
    v_mul_u32_u24 v2, 64, v2
    v_xor_b32 v2, v2, v0
    v_and_b32 v2, 255, v2
    v_bfe_u32 v8, v1, 4, 2
    v_mul_u32_u24 v8, 40960, v8
    v_add_u32 v2, v2, v8
    s_lshl_b32 s34, s41, 7
    v_bfe_u32 v3, v1, 4, 1
    v_mul_u32_u24 v3, 32, v3
    v_bfe_u32 v7, v1, 0, 2
    v_lshl_add_u32 v3, v7, 3, v3
    v_add_u32 v3, s34, v3
    v_bfe_u32 v8, v1, 2, 2
    v_mul_u32_u24 v8, 64, v8
    v_xor_b32 v3, v3, v8
    v_bfe_u32 v8, v1, 5, 1
    v_mul_u32_u24 v8, 1024, v8
    v_bfe_u32 v7, v1, 2, 2
    v_lshl_add_u32 v8, v7, 8, v8
    v_add_u32 v3, v3, v8
    v_xor_b32 v6, 64, v3
    s_lshl_b32 s34, s64, 3
    s_add_u32 s34, s34, 48
    s_cmp_eq_u32 s64, 2
    s_cselect_b32 s34, 40, s34
    s_load_dwordx2 s[20:21], s[0:1], s34
    s_mov_b32 s22, 5242880
    s_mov_b32 s23, 0x20000
    s_waitcnt lgkmcnt(0)
    v_bfe_u32 v250, v1, 2, 4
    v_mul_u32_u24 v250, 8192, v250
    v_bfe_u32 v251, v1, 0, 2
    v_lshl_add_u32 v250, v251, 4, v250
    s_lshl_b32 s38, s29, 6
    s_lshl_b32 s35, s63, 8
    s_add_u32 s38, s38, s35
    s_cmp_eq_u32 s30, 0
    s_cselect_b32 s38, s38, 0x40000000
    s_cmp_eq_u32 s30, 0
    s_cselect_b32 s34, 18, 2
    s_cselect_b32 s35, 0, 20480
    v_min_u32 v12, s34, v1
    v_mul_u32_u24 v12, 1280, v12
    s_lshr_b32 s34, s28, 4
    s_lshl_b32 s34, s34, 7
    s_add_u32 s35, s35, s34
    s_add_u32 s35, s35, 1073152
    s_add_u32 s57, s30, 1
    s_mov_b32 s48, 0
P_276:
    buffer_load_dword v8, v12, s[4:7], s35 offen sc1
    s_waitcnt vmcnt(0)
    v_cmp_gt_u32 vcc, s57, v8
    s_cbranch_vccz P_277
    s_add_u32 s48, s48, 1
    s_cmp_gt_u32 s48, 200000
    s_cbranch_scc1 L_end
    s_sleep 1
    s_branch P_276
P_277:
    s_mul_i32 s34, s30, 3145728
    s_add_u32 s34, s34, 20971520
    s_lshl_b32 s35, s28, 8
    s_mul_i32 s36, s29, 655360
    s_add_u32 s43, s35, s36
    s_add_u32 s34, s34, s43
    s_lshl_b32 s35, s29, 12
    s_add_u32 m0, s35, 0
    s_add_u32 s36, s34, 0
    buffer_load_dwordx4 v2, s[4:7], s36 offen sc1 lds
    s_add_u32 m0, s35, 1024
    s_add_u32 s36, s34, 163840
    buffer_load_dwordx4 v2, s[4:7], s36 offen sc1 lds
    s_add_u32 m0, s35, 2048
    s_add_u32 s36, s34, 327680
    buffer_load_dwordx4 v2, s[4:7], s36 offen sc1 lds
    s_add_u32 m0, s35, 3072
    s_add_u32 s36, s34, 491520
    buffer_load_dwordx4 v2, s[4:7], s36 offen sc1 lds
    s_lshl_b32 s34, s29, 12
    s_add_u32 s34, s34, 16384
    v_add_u32 v4, s34, v0
    s_lshl_b32 s34, s41, 13
    s_add_u32 s34, s34, 16384
    v_bfe_u32 v7, v1, 0, 2
    v_mul_u32_u24 v7, 16, v7
    v_bfe_u32 v8, v1, 2, 1
    v_lshl_add_u32 v7, v8, 7, v7
    v_bfe_u32 v8, v1, 3, 1
    v_lshl_add_u32 v7, v8, 6, v7
    v_bfe_u32 v8, v1, 4, 2
    v_lshl_add_u32 v7, v8, 8, v7
    v_add_u32 v7, s34, v7
    s_lshl_b32 s34, s41, 7
    v_bfe_u32 v5, v1, 5, 1
    v_mul_u32_u24 v5, 16, v5
    v_add_u32 v5, s34, v5
    v_bfe_u32 v9, v1, 0, 3
    v_mul_u32_u24 v9, 16, v9
    v_xor_b32 v5, v5, v9
    s_lshl_b32 s34, s40, 13
    s_add_u32 s34, s34, 32768
    v_bfe_u32 v9, v1, 0, 5
    v_mul_u32_u24 v9, 256, v9
    v_add_u32 v9, s34, v9
    v_add_u32 v5, v5, v9
    s_waitcnt vmcnt(0)
    s_barrier
    ds_read_b64_tr_b16 v[216:217], v3 offset:0
    ds_read_b64_tr_b16 v[232:233], v6 offset:0
    ds_read_b64_tr_b16 v[218:219], v3 offset:2048
    ds_read_b64_tr_b16 v[234:235], v6 offset:2048
    ds_read_b64_tr_b16 v[220:221], v3 offset:4096
    ds_read_b64_tr_b16 v[236:237], v6 offset:4096
    ds_read_b64_tr_b16 v[222:223], v3 offset:6144
    ds_read_b64_tr_b16 v[238:239], v6 offset:6144
    ds_read_b64_tr_b16 v[224:225], v3 offset:8192
    ds_read_b64_tr_b16 v[240:241], v6 offset:8192
    ds_read_b64_tr_b16 v[226:227], v3 offset:10240
    ds_read_b64_tr_b16 v[242:243], v6 offset:10240
    ds_read_b64_tr_b16 v[228:229], v3 offset:12288
    ds_read_b64_tr_b16 v[244:245], v6 offset:12288
    ds_read_b64_tr_b16 v[230:231], v3 offset:14336
    ds_read_b64_tr_b16 v[246:247], v6 offset:14336
    s_waitcnt lgkmcnt(13)
    v_mfma_f32_32x32x16_bf16 v[184:199], v[216:219], v[16:19], 0
    s_waitcnt lgkmcnt(12)
    v_mfma_f32_32x32x16_bf16 v[200:215], v[232:235], v[16:19], 0
    s_add_u32 m0, s60, 0
    s_add_u32 s39, s38, 2621440
    buffer_load_dwordx4 v250, s[20:23], s39 offen lds
    v_mfma_f32_32x32x16_bf16 v[184:199], v[232:235], v[32:35], v[184:199]
    v_mfma_f32_32x32x16_bf16 v[200:215], v[216:219], v[48:51], v[200:215]
    s_add_u32 m0, s60, 1024
    s_add_u32 s39, s38, 2752512
    buffer_load_dwordx4 v250, s[20:23], s39 offen lds
    s_waitcnt lgkmcnt(9)
    v_mfma_f32_32x32x16_bf16 v[184:199], v[220:223], v[20:23], v[184:199]
    s_waitcnt lgkmcnt(8)
    v_mfma_f32_32x32x16_bf16 v[200:215], v[236:239], v[20:23], v[200:215]
    s_add_u32 m0, s60, 2048
    s_add_u32 s39, s38, 2883584
    buffer_load_dwordx4 v250, s[20:23], s39 offen lds
    v_mfma_f32_32x32x16_bf16 v[184:199], v[236:239], v[36:39], v[184:199]
    v_mfma_f32_32x32x16_bf16 v[200:215], v[220:223], v[52:55], v[200:215]
    s_add_u32 m0, s60, 3072
    s_add_u32 s39, s38, 3014656
    buffer_load_dwordx4 v250, s[20:23], s39 offen lds
    s_waitcnt lgkmcnt(5)
    v_mfma_f32_32x32x16_bf16 v[184:199], v[224:227], v[24:27], v[184:199]
    s_waitcnt lgkmcnt(4)
    v_mfma_f32_32x32x16_bf16 v[200:215], v[240:243], v[24:27], v[200:215]
    s_add_u32 m0, s60, 4096
    s_add_u32 s39, s38, 3145728
    buffer_load_dwordx4 v250, s[20:23], s39 offen lds
    v_mfma_f32_32x32x16_bf16 v[184:199], v[240:243], v[40:43], v[184:199]
    v_mfma_f32_32x32x16_bf16 v[200:215], v[224:227], v[56:59], v[200:215]
    s_add_u32 m0, s60, 5120
    s_add_u32 s39, s38, 3276800
    buffer_load_dwordx4 v250, s[20:23], s39 offen lds
    s_waitcnt lgkmcnt(1)
    v_mfma_f32_32x32x16_bf16 v[184:199], v[228:231], v[28:31], v[184:199]
    s_waitcnt lgkmcnt(0)
    v_mfma_f32_32x32x16_bf16 v[200:215], v[244:247], v[28:31], v[200:215]
    s_add_u32 m0, s60, 6144
    s_add_u32 s39, s38, 3407872
    buffer_load_dwordx4 v250, s[20:23], s39 offen lds
    v_mfma_f32_32x32x16_bf16 v[184:199], v[244:247], v[44:47], v[184:199]
    v_mfma_f32_32x32x16_bf16 v[200:215], v[228:231], v[60:63], v[200:215]
    s_add_u32 m0, s60, 7168
    s_add_u32 s39, s38, 3538944
    buffer_load_dwordx4 v250, s[20:23], s39 offen lds
    s_nop 0
    v_pk_mul_f32 v[10:11], v[184:185], v[88:89]
    s_nop 6
    v_pk_mul_f32 v[12:13], v[200:201], v[88:89]
    v_pk_fma_f32 v[10:11], v[200:201], v[104:105], v[10:11]
    v_pk_fma_f32 v[12:13], v[184:185], v[104:105], v[12:13] neg_lo:[1,0,0] neg_hi:[1,0,0]
    v_cvt_pk_bf16_f32 v216, v10, v11
    v_cvt_pk_bf16_f32 v232, v12, v13
    v_pk_mul_f32 v[10:11], v[186:187], v[90:91]
    v_pk_mul_f32 v[12:13], v[202:203], v[90:91]
    v_pk_fma_f32 v[10:11], v[202:203], v[106:107], v[10:11]
    v_pk_fma_f32 v[12:13], v[186:187], v[106:107], v[12:13] neg_lo:[1,0,0] neg_hi:[1,0,0]
    v_cvt_pk_bf16_f32 v217, v10, v11
    v_cvt_pk_bf16_f32 v233, v12, v13
    v_pk_mul_f32 v[10:11], v[188:189], v[92:93]
    v_pk_mul_f32 v[12:13], v[204:205], v[92:93]
    v_pk_fma_f32 v[10:11], v[204:205], v[108:109], v[10:11]
    v_pk_fma_f32 v[12:13], v[188:189], v[108:109], v[12:13] neg_lo:[1,0,0] neg_hi:[1,0,0]
    v_cvt_pk_bf16_f32 v218, v10, v11
    v_cvt_pk_bf16_f32 v234, v12, v13
    v_pk_mul_f32 v[10:11], v[190:191], v[94:95]
    v_pk_mul_f32 v[12:13], v[206:207], v[94:95]
    v_pk_fma_f32 v[10:11], v[206:207], v[110:111], v[10:11]
    v_pk_fma_f32 v[12:13], v[190:191], v[110:111], v[12:13] neg_lo:[1,0,0] neg_hi:[1,0,0]
    v_cvt_pk_bf16_f32 v219, v10, v11
    v_cvt_pk_bf16_f32 v235, v12, v13
    v_pk_mul_f32 v[10:11], v[192:193], v[96:97]
    v_pk_mul_f32 v[12:13], v[208:209], v[96:97]
    v_pk_fma_f32 v[10:11], v[208:209], v[112:113], v[10:11]
    v_pk_fma_f32 v[12:13], v[192:193], v[112:113], v[12:13] neg_lo:[1,0,0] neg_hi:[1,0,0]
    v_cvt_pk_bf16_f32 v220, v10, v11
    v_cvt_pk_bf16_f32 v236, v12, v13
    v_pk_mul_f32 v[10:11], v[194:195], v[98:99]
    v_pk_mul_f32 v[12:13], v[210:211], v[98:99]
    v_pk_fma_f32 v[10:11], v[210:211], v[114:115], v[10:11]
    v_pk_fma_f32 v[12:13], v[194:195], v[114:115], v[12:13] neg_lo:[1,0,0] neg_hi:[1,0,0]
    v_cvt_pk_bf16_f32 v221, v10, v11
    v_cvt_pk_bf16_f32 v237, v12, v13
    v_pk_mul_f32 v[10:11], v[196:197], v[100:101]
    v_pk_mul_f32 v[12:13], v[212:213], v[100:101]
    v_pk_fma_f32 v[10:11], v[212:213], v[116:117], v[10:11]
    v_pk_fma_f32 v[12:13], v[196:197], v[116:117], v[12:13] neg_lo:[1,0,0] neg_hi:[1,0,0]
    v_cvt_pk_bf16_f32 v222, v10, v11
    v_cvt_pk_bf16_f32 v238, v12, v13
    v_pk_mul_f32 v[10:11], v[198:199], v[102:103]
    v_pk_mul_f32 v[12:13], v[214:215], v[102:103]
    v_pk_fma_f32 v[10:11], v[214:215], v[118:119], v[10:11]
    v_pk_fma_f32 v[12:13], v[198:199], v[118:119], v[12:13] neg_lo:[1,0,0] neg_hi:[1,0,0]
    v_cvt_pk_bf16_f32 v223, v10, v11
    v_cvt_pk_bf16_f32 v239, v12, v13
    v_mfma_f32_32x32x16_bf16 v[184:199], v[64:67], v[216:219], 0
    v_mfma_f32_32x32x16_bf16 v[200:215], v[64:67], v[232:235], 0
    s_add_u32 m0, s60, 8192
    s_add_u32 s39, s38, 3670016
    buffer_load_dwordx4 v250, s[20:23], s39 offen lds
    v_mfma_f32_32x32x16_bf16 v[184:199], v[72:75], v[232:235], v[184:199]
    v_mfma_f32_32x32x16_bf16 v[200:215], v[80:83], v[216:219], v[200:215]
    s_add_u32 m0, s60, 9216
    s_add_u32 s39, s38, 3801088
    buffer_load_dwordx4 v250, s[20:23], s39 offen lds
    v_mfma_f32_32x32x16_bf16 v[184:199], v[68:71], v[220:223], v[184:199]
    v_mfma_f32_32x32x16_bf16 v[200:215], v[68:71], v[236:239], v[200:215]
    s_add_u32 m0, s60, 10240
    s_add_u32 s39, s38, 3932160
    buffer_load_dwordx4 v250, s[20:23], s39 offen lds
    v_mfma_f32_32x32x16_bf16 v[184:199], v[76:79], v[236:239], v[184:199]
    v_mfma_f32_32x32x16_bf16 v[200:215], v[84:87], v[220:223], v[200:215]
    s_add_u32 m0, s60, 11264
    s_add_u32 s39, s38, 4063232
    buffer_load_dwordx4 v250, s[20:23], s39 offen lds
    s_nop 0
    v_pk_mul_f32 v[10:11], v[184:185], v[152:153]
    s_nop 6
    v_pk_mul_f32 v[12:13], v[200:201], v[152:153]
    v_pk_fma_f32 v[10:11], v[200:201], v[168:169], v[10:11] neg_lo:[1,0,0] neg_hi:[1,0,0]
    v_pk_fma_f32 v[12:13], v[184:185], v[168:169], v[12:13]
    v_cvt_pk_bf16_f32 v216, v10, v11
    v_cvt_pk_bf16_f32 v232, v12, v13
    v_pk_mul_f32 v[10:11], v[186:187], v[154:155]
    v_pk_mul_f32 v[12:13], v[202:203], v[154:155]
    v_pk_fma_f32 v[10:11], v[202:203], v[170:171], v[10:11] neg_lo:[1,0,0] neg_hi:[1,0,0]
    v_pk_fma_f32 v[12:13], v[186:187], v[170:171], v[12:13]
    v_cvt_pk_bf16_f32 v217, v10, v11
    v_cvt_pk_bf16_f32 v233, v12, v13
    v_pk_mul_f32 v[10:11], v[188:189], v[156:157]
    v_pk_mul_f32 v[12:13], v[204:205], v[156:157]
    v_pk_fma_f32 v[10:11], v[204:205], v[172:173], v[10:11] neg_lo:[1,0,0] neg_hi:[1,0,0]
    v_pk_fma_f32 v[12:13], v[188:189], v[172:173], v[12:13]
    v_cvt_pk_bf16_f32 v218, v10, v11
    v_cvt_pk_bf16_f32 v234, v12, v13
    v_pk_mul_f32 v[10:11], v[190:191], v[158:159]
    v_pk_mul_f32 v[12:13], v[206:207], v[158:159]
    v_pk_fma_f32 v[10:11], v[206:207], v[174:175], v[10:11] neg_lo:[1,0,0] neg_hi:[1,0,0]
    v_pk_fma_f32 v[12:13], v[190:191], v[174:175], v[12:13]
    v_cvt_pk_bf16_f32 v219, v10, v11
    v_cvt_pk_bf16_f32 v235, v12, v13
    v_pk_mul_f32 v[10:11], v[192:193], v[160:161]
    v_pk_mul_f32 v[12:13], v[208:209], v[160:161]
    v_pk_fma_f32 v[10:11], v[208:209], v[176:177], v[10:11] neg_lo:[1,0,0] neg_hi:[1,0,0]
    v_pk_fma_f32 v[12:13], v[192:193], v[176:177], v[12:13]
    v_cvt_pk_bf16_f32 v220, v10, v11
    v_cvt_pk_bf16_f32 v236, v12, v13
    v_pk_mul_f32 v[10:11], v[194:195], v[162:163]
    v_pk_mul_f32 v[12:13], v[210:211], v[162:163]
    v_pk_fma_f32 v[10:11], v[210:211], v[178:179], v[10:11] neg_lo:[1,0,0] neg_hi:[1,0,0]
    v_pk_fma_f32 v[12:13], v[194:195], v[178:179], v[12:13]
    v_cvt_pk_bf16_f32 v221, v10, v11
    v_cvt_pk_bf16_f32 v237, v12, v13
    v_pk_mul_f32 v[10:11], v[196:197], v[164:165]
    v_pk_mul_f32 v[12:13], v[212:213], v[164:165]
    v_pk_fma_f32 v[10:11], v[212:213], v[180:181], v[10:11] neg_lo:[1,0,0] neg_hi:[1,0,0]
    v_pk_fma_f32 v[12:13], v[196:197], v[180:181], v[12:13]
    v_cvt_pk_bf16_f32 v222, v10, v11
    v_cvt_pk_bf16_f32 v238, v12, v13
    v_pk_mul_f32 v[10:11], v[198:199], v[166:167]
    v_pk_mul_f32 v[12:13], v[214:215], v[166:167]
    v_pk_fma_f32 v[10:11], v[214:215], v[182:183], v[10:11] neg_lo:[1,0,0] neg_hi:[1,0,0]
    v_pk_fma_f32 v[12:13], v[198:199], v[182:183], v[12:13]
    v_cvt_pk_bf16_f32 v223, v10, v11
    v_cvt_pk_bf16_f32 v239, v12, v13
    v_mfma_f32_32x32x16_bf16 v[184:199], v[216:219], v[64:67], 0
    s_add_u32 m0, s60, 12288
    s_add_u32 s39, s38, 4194304
    buffer_load_dwordx4 v250, s[20:23], s39 offen lds
    v_mfma_f32_32x32x16_bf16 v[200:215], v[232:235], v[64:67], 0
    s_add_u32 m0, s60, 13312
    s_add_u32 s39, s38, 4325376
    buffer_load_dwordx4 v250, s[20:23], s39 offen lds
    v_mfma_f32_32x32x16_bf16 v[184:199], v[232:235], v[80:83], v[184:199]
    s_add_u32 m0, s60, 14336
    s_add_u32 s39, s38, 4456448
    buffer_load_dwordx4 v250, s[20:23], s39 offen lds
    v_mfma_f32_32x32x16_bf16 v[200:215], v[216:219], v[72:75], v[200:215]
    s_add_u32 m0, s60, 15360
    s_add_u32 s39, s38, 4587520
    buffer_load_dwordx4 v250, s[20:23], s39 offen lds
    v_mfma_f32_32x32x16_bf16 v[184:199], v[220:223], v[68:71], v[184:199]
    s_add_u32 m0, s60, 16384
    s_add_u32 s39, s38, 4718592
    buffer_load_dwordx4 v250, s[20:23], s39 offen lds
    v_mfma_f32_32x32x16_bf16 v[200:215], v[236:239], v[68:71], v[200:215]
    s_add_u32 m0, s60, 17408
    s_add_u32 s39, s38, 4849664
    buffer_load_dwordx4 v250, s[20:23], s39 offen lds
    v_mfma_f32_32x32x16_bf16 v[184:199], v[236:239], v[84:87], v[184:199]
    s_add_u32 m0, s60, 18432
    s_add_u32 s39, s38, 4980736
    buffer_load_dwordx4 v250, s[20:23], s39 offen lds
    v_mfma_f32_32x32x16_bf16 v[200:215], v[220:223], v[76:79], v[200:215]
    s_add_u32 m0, s60, 19456
    s_add_u32 s39, s38, 5111808
    buffer_load_dwordx4 v250, s[20:23], s39 offen lds
    s_nop 0
    v_pk_mul_f32 v[10:11], v[184:185], v[120:121]
    s_nop 6
    v_pk_mul_f32 v[12:13], v[200:201], v[120:121]
    v_pk_fma_f32 v[10:11], v[200:201], v[136:137], v[10:11] neg_lo:[1,0,0] neg_hi:[1,0,0]
    v_pk_fma_f32 v[12:13], v[184:185], v[136:137], v[12:13]
    v_cvt_pk_bf16_f32 v216, v10, v11
    v_cvt_pk_bf16_f32 v232, v12, v13
    v_pk_mul_f32 v[10:11], v[186:187], v[122:123]
    v_pk_mul_f32 v[12:13], v[202:203], v[122:123]
    v_pk_fma_f32 v[10:11], v[202:203], v[138:139], v[10:11] neg_lo:[1,0,0] neg_hi:[1,0,0]
    v_pk_fma_f32 v[12:13], v[186:187], v[138:139], v[12:13]
    v_cvt_pk_bf16_f32 v217, v10, v11
    v_cvt_pk_bf16_f32 v233, v12, v13
    v_pk_mul_f32 v[10:11], v[188:189], v[124:125]
    v_pk_mul_f32 v[12:13], v[204:205], v[124:125]
    v_pk_fma_f32 v[10:11], v[204:205], v[140:141], v[10:11] neg_lo:[1,0,0] neg_hi:[1,0,0]
    v_pk_fma_f32 v[12:13], v[188:189], v[140:141], v[12:13]
    v_cvt_pk_bf16_f32 v218, v10, v11
    v_cvt_pk_bf16_f32 v234, v12, v13
    v_pk_mul_f32 v[10:11], v[190:191], v[126:127]
    v_pk_mul_f32 v[12:13], v[206:207], v[126:127]
    v_pk_fma_f32 v[10:11], v[206:207], v[142:143], v[10:11] neg_lo:[1,0,0] neg_hi:[1,0,0]
    v_pk_fma_f32 v[12:13], v[190:191], v[142:143], v[12:13]
    v_cvt_pk_bf16_f32 v219, v10, v11
    v_cvt_pk_bf16_f32 v235, v12, v13
    v_pk_mul_f32 v[10:11], v[192:193], v[128:129]
    v_pk_mul_f32 v[12:13], v[208:209], v[128:129]
    v_pk_fma_f32 v[10:11], v[208:209], v[144:145], v[10:11] neg_lo:[1,0,0] neg_hi:[1,0,0]
    v_pk_fma_f32 v[12:13], v[192:193], v[144:145], v[12:13]
    v_cvt_pk_bf16_f32 v220, v10, v11
    v_cvt_pk_bf16_f32 v236, v12, v13
    v_pk_mul_f32 v[10:11], v[194:195], v[130:131]
    v_pk_mul_f32 v[12:13], v[210:211], v[130:131]
    v_pk_fma_f32 v[10:11], v[210:211], v[146:147], v[10:11] neg_lo:[1,0,0] neg_hi:[1,0,0]
    v_pk_fma_f32 v[12:13], v[194:195], v[146:147], v[12:13]
    v_cvt_pk_bf16_f32 v221, v10, v11
    v_cvt_pk_bf16_f32 v237, v12, v13
    v_pk_mul_f32 v[10:11], v[196:197], v[132:133]
    v_pk_mul_f32 v[12:13], v[212:213], v[132:133]
    v_pk_fma_f32 v[10:11], v[212:213], v[148:149], v[10:11] neg_lo:[1,0,0] neg_hi:[1,0,0]
    v_pk_fma_f32 v[12:13], v[196:197], v[148:149], v[12:13]
    v_cvt_pk_bf16_f32 v222, v10, v11
    v_cvt_pk_bf16_f32 v238, v12, v13
    v_pk_mul_f32 v[10:11], v[198:199], v[134:135]
    v_pk_mul_f32 v[12:13], v[214:215], v[134:135]
    v_pk_fma_f32 v[10:11], v[214:215], v[150:151], v[10:11] neg_lo:[1,0,0] neg_hi:[1,0,0]
    v_pk_fma_f32 v[12:13], v[198:199], v[150:151], v[12:13]
    v_cvt_pk_bf16_f32 v223, v10, v11
    v_cvt_pk_bf16_f32 v239, v12, v13
    ds_write_b128 v4, v[216:219] offset:0
    ds_write_b128 v4, v[220:223] offset:1024
    ds_write_b128 v4, v[232:235] offset:2048
    ds_write_b128 v4, v[236:239] offset:3072
    s_waitcnt lgkmcnt(0)
    s_barrier
    ds_read_b128 v[216:219], v7 offset:0
    ds_read_b128 v[232:235], v7 offset:2048
    ds_read_b128 v[220:223], v7 offset:1024
    ds_read_b128 v[236:239], v7 offset:3072
    ds_read_b128 v[224:227], v7 offset:4096
    ds_read_b128 v[240:243], v7 offset:6144
    ds_read_b128 v[228:231], v7 offset:5120
    ds_read_b128 v[244:247], v7 offset:7168
    s_waitcnt lgkmcnt(7)
    v_mfma_f32_32x32x16_bf16 v[184:199], v[216:219], v[16:19], 0
    s_waitcnt lgkmcnt(6)
    v_mfma_f32_32x32x16_bf16 v[200:215], v[232:235], v[16:19], 0
    v_mfma_f32_32x32x16_bf16 v[184:199], v[232:235], v[48:51], v[184:199]
    v_mfma_f32_32x32x16_bf16 v[200:215], v[216:219], v[32:35], v[200:215]
    s_waitcnt lgkmcnt(5)
    v_mfma_f32_32x32x16_bf16 v[184:199], v[220:223], v[20:23], v[184:199]
    s_waitcnt lgkmcnt(4)
    v_mfma_f32_32x32x16_bf16 v[200:215], v[236:239], v[20:23], v[200:215]
    v_mfma_f32_32x32x16_bf16 v[184:199], v[236:239], v[52:55], v[184:199]
    v_mfma_f32_32x32x16_bf16 v[200:215], v[220:223], v[36:39], v[200:215]
    s_waitcnt lgkmcnt(3)
    v_mfma_f32_32x32x16_bf16 v[184:199], v[224:227], v[24:27], v[184:199]
    s_waitcnt lgkmcnt(2)
    v_mfma_f32_32x32x16_bf16 v[200:215], v[240:243], v[24:27], v[200:215]
    v_mfma_f32_32x32x16_bf16 v[184:199], v[240:243], v[56:59], v[184:199]
    v_mfma_f32_32x32x16_bf16 v[200:215], v[224:227], v[40:43], v[200:215]
    s_waitcnt lgkmcnt(1)
    v_mfma_f32_32x32x16_bf16 v[184:199], v[228:231], v[28:31], v[184:199]
    s_waitcnt lgkmcnt(0)
    v_mfma_f32_32x32x16_bf16 v[200:215], v[244:247], v[28:31], v[200:215]
    v_mfma_f32_32x32x16_bf16 v[184:199], v[244:247], v[60:63], v[184:199]
    v_mfma_f32_32x32x16_bf16 v[200:215], v[228:231], v[44:47], v[200:215]
    v_bfe_u32 v2, v1, 4, 2
    v_mul_u32_u24 v2, 16, v2
    v_xor_b32 v2, v2, v0
    s_lshl_b32 s34, s29, 12
    s_add_u32 s34, s34, 32768
    v_add_u32 v2, s34, v2
    v_xor_b32 v6, 64, v2
    v_bfe_u32 v3, v1, 4, 2
    v_mul_u32_u24 v3, 40960, v3
    v_bfe_u32 v8, v1, 0, 4
    v_lshl_add_u32 v3, v8, 4, v3
    v_cvt_pk_bf16_f32 v216, v184, v185
    v_cvt_pk_bf16_f32 v217, v186, v187
    v_cvt_pk_bf16_f32 v218, v188, v189
    v_cvt_pk_bf16_f32 v219, v190, v191
    v_xor_b32 v10, 0, v5
    ds_write_b128 v10, v[216:219]
    v_cvt_pk_bf16_f32 v220, v192, v193
    v_cvt_pk_bf16_f32 v221, v194, v195
    v_cvt_pk_bf16_f32 v222, v196, v197
    v_cvt_pk_bf16_f32 v223, v198, v199
    v_xor_b32 v11, 32, v5
    ds_write_b128 v11, v[220:223]
    v_cvt_pk_bf16_f32 v224, v200, v201
    v_cvt_pk_bf16_f32 v225, v202, v203
    v_cvt_pk_bf16_f32 v226, v204, v205
    v_cvt_pk_bf16_f32 v227, v206, v207
    v_xor_b32 v12, 64, v5
    ds_write_b128 v12, v[224:227]
    v_cvt_pk_bf16_f32 v228, v208, v209
    v_cvt_pk_bf16_f32 v229, v210, v211
    v_cvt_pk_bf16_f32 v230, v212, v213
    v_cvt_pk_bf16_f32 v231, v214, v215
    v_xor_b32 v13, 96, v5
    ds_write_b128 v13, v[228:231]
    s_mul_i32 s34, s30, 3145728
    s_add_u32 s34, s34, 27262976
    s_add_u32 s34, s34, s43
    s_waitcnt lgkmcnt(0)
    s_barrier
    ds_read_b128 v[232:235], v2 offset:0
    ds_read_b128 v[236:239], v6 offset:1024
    ds_read_b128 v[240:243], v2 offset:2048
    ds_read_b128 v[244:247], v6 offset:3072
    s_add_u32 s36, s34, 0
    s_waitcnt lgkmcnt(3)
    buffer_store_dwordx4 v[232:235], v3, s[4:7], s36 offen sc1
    s_add_u32 s36, s34, 163840
    s_waitcnt lgkmcnt(2)
    buffer_store_dwordx4 v[236:239], v3, s[4:7], s36 offen sc1
    s_add_u32 s36, s34, 327680
    s_waitcnt lgkmcnt(1)
    buffer_store_dwordx4 v[240:243], v3, s[4:7], s36 offen sc1
    s_add_u32 s36, s34, 491520
    s_waitcnt lgkmcnt(0)
    buffer_store_dwordx4 v[244:247], v3, s[4:7], s36 offen sc1
    s_add_u32 s57, s30, 1
    s_waitcnt vmcnt(0)
    s_barrier
    s_cmp_lg_u32 s29, 0
    s_cbranch_scc1 F_278
    s_lshl_b32 s32, s28, 5
    s_add_u32 s32, s32, s29
    s_lshl_b32 s32, s32, 2
    s_add_u32 s32, s32, 1097728
    v_mov_b32 v8, s57
    s_mov_b64 exec, 1
    buffer_store_dword v8, off, s[4:7], s32 sc1
    s_mov_b64 exec, -1
F_278:
R_273:
    s_cmp_lg_u32 s30, 0
    s_cbranch_scc1 LAYER_272
    s_cmp_eq_u32 s64, 1
    s_cbranch_scc1 Q_279
    v_bfe_u32 v2, v1, 5, 1
    v_mul_u32_u24 v2, 512, v2
    v_bfe_u32 v3, v1, 2, 2
    v_lshl_add_u32 v2, v3, 6, v2
    v_bfe_u32 v3, v1, 4, 1
    v_lshl_add_u32 v2, v3, 4, v2
    v_bfe_u32 v3, v1, 1, 1
    v_lshl_add_u32 v2, v3, 3, v2
    v_bfe_u32 v3, v1, 0, 1
    v_lshl_add_u32 v2, v3, 5, v2
    v_add_u32 v2, s60, v2
    s_branch Q_280
Q_279:
    v_bfe_u32 v2, v1, 5, 1
    v_mul_u32_u24 v2, 512, v2
    v_bfe_u32 v3, v1, 2, 2
    v_lshl_add_u32 v2, v3, 6, v2
    v_bfe_u32 v3, v1, 4, 1
    v_lshl_add_u32 v2, v3, 5, v2
    v_bfe_u32 v3, v1, 0, 2
    v_lshl_add_u32 v2, v3, 3, v2
    v_add_u32 v2, s60, v2
Q_280:
    s_waitcnt vmcnt(0)
    ds_read_b64_tr_b16 a[80:81], v2 offset:0
    ds_read_b64_tr_b16 a[82:83], v2 offset:256
    ds_read_b64_tr_b16 a[84:85], v2 offset:1024
    ds_read_b64_tr_b16 a[86:87], v2 offset:1280
    ds_read_b64_tr_b16 a[88:89], v2 offset:2048
    ds_read_b64_tr_b16 a[90:91], v2 offset:2304
    ds_read_b64_tr_b16 a[92:93], v2 offset:3072
    ds_read_b64_tr_b16 a[94:95], v2 offset:3328
    ds_read_b64_tr_b16 a[96:97], v2 offset:4096
    ds_read_b64_tr_b16 a[98:99], v2 offset:4352
    ds_read_b64_tr_b16 a[100:101], v2 offset:5120
    ds_read_b64_tr_b16 a[102:103], v2 offset:5376
    ds_read_b64_tr_b16 a[104:105], v2 offset:6144
    ds_read_b64_tr_b16 a[106:107], v2 offset:6400
    ds_read_b64_tr_b16 a[108:109], v2 offset:7168
    ds_read_b64_tr_b16 a[110:111], v2 offset:7424
    ds_read_b64_tr_b16 a[112:113], v2 offset:8192
    ds_read_b64_tr_b16 a[114:115], v2 offset:8448
    ds_read_b64_tr_b16 a[116:117], v2 offset:9216
    ds_read_b64_tr_b16 a[118:119], v2 offset:9472
    ds_read_b64_tr_b16 a[120:121], v2 offset:10240
    ds_read_b64_tr_b16 a[122:123], v2 offset:10496
    ds_read_b64_tr_b16 a[124:125], v2 offset:11264
    ds_read_b64_tr_b16 a[126:127], v2 offset:11520
    ds_read_b64_tr_b16 a[128:129], v2 offset:12288
    ds_read_b64_tr_b16 a[130:131], v2 offset:12544
    ds_read_b64_tr_b16 a[132:133], v2 offset:13312
    ds_read_b64_tr_b16 a[134:135], v2 offset:13568
    ds_read_b64_tr_b16 a[136:137], v2 offset:14336
    ds_read_b64_tr_b16 a[138:139], v2 offset:14592
    ds_read_b64_tr_b16 a[140:141], v2 offset:15360
    ds_read_b64_tr_b16 a[142:143], v2 offset:15616
    ds_read_b64_tr_b16 a[144:145], v2 offset:16384
    ds_read_b64_tr_b16 a[146:147], v2 offset:16640
    ds_read_b64_tr_b16 a[148:149], v2 offset:17408
    ds_read_b64_tr_b16 a[150:151], v2 offset:17664
    ds_read_b64_tr_b16 a[152:153], v2 offset:18432
    ds_read_b64_tr_b16 a[154:155], v2 offset:18688
    ds_read_b64_tr_b16 a[156:157], v2 offset:19456
    ds_read_b64_tr_b16 a[158:159], v2 offset:19712
    s_waitcnt lgkmcnt(0)
    v_mov_b32 v5, 4
    s_mov_b32 s48, 0
P_281:
    buffer_load_dword v4, v5, s[24:27], 0 offen sc1
    s_waitcnt vmcnt(0)
    v_cmp_gt_u32 vcc, 1, v4
    s_cbranch_vccz P_282
    s_add_u32 s48, s48, 1
    s_cmp_gt_u32 s48, 200000
    s_cbranch_scc1 L_end
    s_sleep 1
    s_branch P_281
P_282:
    v_readfirstlane_b32 s31, v4
    s_nop 0
    s_and_b32 s31, s31, 2
    s_mov_b32 s35, 0x3acccccd
    s_lshl_b32 s34, s67, 6
    s_add_u32 s34, s34, 0
    v_bfe_u32 v5, v1, 0, 2
    v_bfe_u32 v6, v1, 2, 1
    v_lshl_add_u32 v5, v6, 3, v5
    v_bfe_u32 v6, v1, 3, 1
    v_lshl_add_u32 v5, v6, 2, v5
    v_bfe_u32 v6, v1, 4, 1
    v_lshl_add_u32 v5, v6, 4, v5
    v_add_u32 v5, s34, v5
    s_mul_i32 s36, s29, 80
    s_add_u32 s36, s36, 1
    v_bfe_u32 v4, v1, 5, 1
    v_mul_u32_u24 v4, 4, v4
    v_add_u32 v4, s36, v4
    v_mul_u32_u24 v4, v4, v5
    v_cvt_f32_u32 v4, v4
    v_cvt_f32_u32 v5, v5
    v_mul_f32 v4, s35, v4
    v_mul_f32 v5, s35, v5
    v_fract_f32 v4, v4
    v_fmamk_f32 v6, v5, 0x0, v4
    v_sin_f32 v7, -v6
    v_cos_f32 v6, v6
    s_nop 0
    v_cvt_pk_bf16_f32 v10, v6, v7
    v_fmamk_f32 v8, v5, 0x3f800000, v4
    v_sin_f32 v9, -v8
    v_cos_f32 v8, v8
    v_accvgpr_write_b32 a160, v10
    v_cvt_pk_bf16_f32 v10, v8, v9
    v_fmamk_f32 v6, v5, 0x40000000, v4
    v_sin_f32 v7, -v6
    v_cos_f32 v6, v6
    v_accvgpr_write_b32 a161, v10
    v_cvt_pk_bf16_f32 v10, v6, v7
    v_fmamk_f32 v8, v5, 0x40400000, v4
    v_sin_f32 v9, -v8
    v_cos_f32 v8, v8
    v_accvgpr_write_b32 a162, v10
    v_cvt_pk_bf16_f32 v10, v8, v9
    v_fmamk_f32 v6, v5, 0x41000000, v4
    v_sin_f32 v7, -v6
    v_cos_f32 v6, v6
    v_accvgpr_write_b32 a163, v10
    v_cvt_pk_bf16_f32 v10, v6, v7
    v_fmamk_f32 v8, v5, 0x41100000, v4
    v_sin_f32 v9, -v8
    v_cos_f32 v8, v8
    v_accvgpr_write_b32 a164, v10
    v_cvt_pk_bf16_f32 v10, v8, v9
    v_fmamk_f32 v6, v5, 0x41200000, v4
    v_sin_f32 v7, -v6
    v_cos_f32 v6, v6
    v_accvgpr_write_b32 a165, v10
    v_cvt_pk_bf16_f32 v10, v6, v7
    v_fmamk_f32 v8, v5, 0x41300000, v4
    v_sin_f32 v9, -v8
    v_cos_f32 v8, v8
    v_accvgpr_write_b32 a166, v10
    v_cvt_pk_bf16_f32 v10, v8, v9
    v_fmamk_f32 v6, v5, 0x41800000, v4
    v_sin_f32 v7, -v6
    v_cos_f32 v6, v6
    v_accvgpr_write_b32 a167, v10
    v_cvt_pk_bf16_f32 v10, v6, v7
    v_fmamk_f32 v8, v5, 0x41880000, v4
    v_sin_f32 v9, -v8
    v_cos_f32 v8, v8
    v_accvgpr_write_b32 a168, v10
    v_cvt_pk_bf16_f32 v10, v8, v9
    v_fmamk_f32 v6, v5, 0x41900000, v4
    v_sin_f32 v7, -v6
    v_cos_f32 v6, v6
    v_accvgpr_write_b32 a169, v10
    v_cvt_pk_bf16_f32 v10, v6, v7
    v_fmamk_f32 v8, v5, 0x41980000, v4
    v_sin_f32 v9, -v8
    v_cos_f32 v8, v8
    v_accvgpr_write_b32 a170, v10
    v_cvt_pk_bf16_f32 v10, v8, v9
    v_fmamk_f32 v6, v5, 0x41c00000, v4
    v_sin_f32 v7, -v6
    v_cos_f32 v6, v6
    v_accvgpr_write_b32 a171, v10
    v_cvt_pk_bf16_f32 v10, v6, v7
    v_fmamk_f32 v8, v5, 0x41c80000, v4
    v_sin_f32 v9, -v8
    v_cos_f32 v8, v8
    v_accvgpr_write_b32 a172, v10
    v_cvt_pk_bf16_f32 v10, v8, v9
    v_fmamk_f32 v6, v5, 0x41d00000, v4
    v_sin_f32 v7, -v6
    v_cos_f32 v6, v6
    v_accvgpr_write_b32 a173, v10
    v_cvt_pk_bf16_f32 v10, v6, v7
    v_fmamk_f32 v8, v5, 0x41d80000, v4
    v_sin_f32 v9, -v8
    v_cos_f32 v8, v8
    v_accvgpr_write_b32 a174, v10
    v_cvt_pk_bf16_f32 v10, v8, v9
    v_fmamk_f32 v6, v5, 0x42000000, v4
    v_sin_f32 v7, -v6
    v_cos_f32 v6, v6
    v_accvgpr_write_b32 a175, v10
    v_cvt_pk_bf16_f32 v10, v6, v7
    v_fmamk_f32 v8, v5, 0x42040000, v4
    v_sin_f32 v9, -v8
    v_cos_f32 v8, v8
    v_accvgpr_write_b32 a176, v10
    v_cvt_pk_bf16_f32 v10, v8, v9
    v_fmamk_f32 v6, v5, 0x42080000, v4
    v_sin_f32 v7, -v6
    v_cos_f32 v6, v6
    v_accvgpr_write_b32 a177, v10
    v_cvt_pk_bf16_f32 v10, v6, v7
    v_fmamk_f32 v8, v5, 0x420c0000, v4
    v_sin_f32 v9, -v8
    v_cos_f32 v8, v8
    v_accvgpr_write_b32 a178, v10
    v_cvt_pk_bf16_f32 v10, v8, v9
    v_fmamk_f32 v6, v5, 0x42200000, v4
    v_sin_f32 v7, -v6
    v_cos_f32 v6, v6
    v_accvgpr_write_b32 a179, v10
    v_cvt_pk_bf16_f32 v10, v6, v7
    v_fmamk_f32 v8, v5, 0x42240000, v4
    v_sin_f32 v9, -v8
    v_cos_f32 v8, v8
    v_accvgpr_write_b32 a180, v10
    v_cvt_pk_bf16_f32 v10, v8, v9
    v_fmamk_f32 v6, v5, 0x42280000, v4
    v_sin_f32 v7, -v6
    v_cos_f32 v6, v6
    v_accvgpr_write_b32 a181, v10
    v_cvt_pk_bf16_f32 v10, v6, v7
    v_fmamk_f32 v8, v5, 0x422c0000, v4
    v_sin_f32 v9, -v8
    v_cos_f32 v8, v8
    v_accvgpr_write_b32 a182, v10
    v_cvt_pk_bf16_f32 v10, v8, v9
    v_fmamk_f32 v6, v5, 0x42400000, v4
    v_sin_f32 v7, -v6
    v_cos_f32 v6, v6
    v_accvgpr_write_b32 a183, v10
    v_cvt_pk_bf16_f32 v10, v6, v7
    v_fmamk_f32 v8, v5, 0x42440000, v4
    v_sin_f32 v9, -v8
    v_cos_f32 v8, v8
    v_accvgpr_write_b32 a184, v10
    v_cvt_pk_bf16_f32 v10, v8, v9
    v_fmamk_f32 v6, v5, 0x42480000, v4
    v_sin_f32 v7, -v6
    v_cos_f32 v6, v6
    v_accvgpr_write_b32 a185, v10
    v_cvt_pk_bf16_f32 v10, v6, v7
    v_fmamk_f32 v8, v5, 0x424c0000, v4
    v_sin_f32 v9, -v8
    v_cos_f32 v8, v8
    v_accvgpr_write_b32 a186, v10
    v_cvt_pk_bf16_f32 v10, v8, v9
    v_fmamk_f32 v6, v5, 0x42600000, v4
    v_sin_f32 v7, -v6
    v_cos_f32 v6, v6
    v_accvgpr_write_b32 a187, v10
    v_cvt_pk_bf16_f32 v10, v6, v7
    v_fmamk_f32 v8, v5, 0x42640000, v4
    v_sin_f32 v9, -v8
    v_cos_f32 v8, v8
    v_accvgpr_write_b32 a188, v10
    v_cvt_pk_bf16_f32 v10, v8, v9
    v_fmamk_f32 v6, v5, 0x42680000, v4
    v_sin_f32 v7, -v6
    v_cos_f32 v6, v6
    v_accvgpr_write_b32 a189, v10
    v_cvt_pk_bf16_f32 v10, v6, v7
    v_fmamk_f32 v8, v5, 0x426c0000, v4
    v_sin_f32 v9, -v8
    v_cos_f32 v8, v8
    v_accvgpr_write_b32 a190, v10
    v_cvt_pk_bf16_f32 v10, v8, v9
    v_fmamk_f32 v6, v5, 0x42800000, v4
    v_sin_f32 v7, -v6
    v_cos_f32 v6, v6
    v_accvgpr_write_b32 a191, v10
    v_cvt_pk_bf16_f32 v10, v6, v7
    v_fmamk_f32 v8, v5, 0x42820000, v4
    v_sin_f32 v9, -v8
    v_cos_f32 v8, v8
    v_accvgpr_write_b32 a192, v10
    v_cvt_pk_bf16_f32 v10, v8, v9
    v_fmamk_f32 v6, v5, 0x42840000, v4
    v_sin_f32 v7, -v6
    v_cos_f32 v6, v6
    v_accvgpr_write_b32 a193, v10
    v_cvt_pk_bf16_f32 v10, v6, v7
    v_fmamk_f32 v8, v5, 0x42860000, v4
    v_sin_f32 v9, -v8
    v_cos_f32 v8, v8
    v_accvgpr_write_b32 a194, v10
    v_cvt_pk_bf16_f32 v10, v8, v9
    v_fmamk_f32 v6, v5, 0x42900000, v4
    v_sin_f32 v7, -v6
    v_cos_f32 v6, v6
    v_accvgpr_write_b32 a195, v10
    v_cvt_pk_bf16_f32 v10, v6, v7
    v_fmamk_f32 v8, v5, 0x42920000, v4
    v_sin_f32 v9, -v8
    v_cos_f32 v8, v8
    v_accvgpr_write_b32 a196, v10
    v_cvt_pk_bf16_f32 v10, v8, v9
    v_fmamk_f32 v6, v5, 0x42940000, v4
    v_sin_f32 v7, -v6
    v_cos_f32 v6, v6
    v_accvgpr_write_b32 a197, v10
    v_cvt_pk_bf16_f32 v10, v6, v7
    v_fmamk_f32 v8, v5, 0x42960000, v4
    v_sin_f32 v9, -v8
    v_cos_f32 v8, v8
    v_accvgpr_write_b32 a198, v10
    v_cvt_pk_bf16_f32 v10, v8, v9
    v_accvgpr_write_b32 a199, v10
    s_lshl_b32 s34, s67, 6
    s_add_u32 s34, s34, 32
    v_bfe_u32 v5, v1, 0, 2
    v_bfe_u32 v6, v1, 2, 1
    v_lshl_add_u32 v5, v6, 3, v5
    v_bfe_u32 v6, v1, 3, 1
    v_lshl_add_u32 v5, v6, 2, v5
    v_bfe_u32 v6, v1, 4, 1
    v_lshl_add_u32 v5, v6, 4, v5
    v_add_u32 v5, s34, v5
    s_mul_i32 s36, s29, 80
    s_add_u32 s36, s36, 1
    v_bfe_u32 v4, v1, 5, 1
    v_mul_u32_u24 v4, 4, v4
    v_add_u32 v4, s36, v4
    v_mul_u32_u24 v4, v4, v5
    v_cvt_f32_u32 v4, v4
    v_cvt_f32_u32 v5, v5
    v_mul_f32 v4, s35, v4
    v_mul_f32 v5, s35, v5
    v_fract_f32 v4, v4
    v_fmamk_f32 v6, v5, 0x0, v4
    v_sin_f32 v7, -v6
    v_cos_f32 v6, v6
    s_nop 0
    v_cvt_pk_bf16_f32 v10, v6, v7
    v_fmamk_f32 v8, v5, 0x3f800000, v4
    v_sin_f32 v9, -v8
    v_cos_f32 v8, v8
    v_accvgpr_write_b32 a200, v10
    v_cvt_pk_bf16_f32 v10, v8, v9
    v_fmamk_f32 v6, v5, 0x40000000, v4
    v_sin_f32 v7, -v6
    v_cos_f32 v6, v6
    v_accvgpr_write_b32 a201, v10
    v_cvt_pk_bf16_f32 v10, v6, v7
    v_fmamk_f32 v8, v5, 0x40400000, v4
    v_sin_f32 v9, -v8
    v_cos_f32 v8, v8
    v_accvgpr_write_b32 a202, v10
    v_cvt_pk_bf16_f32 v10, v8, v9
    v_fmamk_f32 v6, v5, 0x41000000, v4
    v_sin_f32 v7, -v6
    v_cos_f32 v6, v6
    v_accvgpr_write_b32 a203, v10
    v_cvt_pk_bf16_f32 v10, v6, v7
    v_fmamk_f32 v8, v5, 0x41100000, v4
    v_sin_f32 v9, -v8
    v_cos_f32 v8, v8
    v_accvgpr_write_b32 a204, v10
    v_cvt_pk_bf16_f32 v10, v8, v9
    v_fmamk_f32 v6, v5, 0x41200000, v4
    v_sin_f32 v7, -v6
    v_cos_f32 v6, v6
    v_accvgpr_write_b32 a205, v10
    v_cvt_pk_bf16_f32 v10, v6, v7
    v_fmamk_f32 v8, v5, 0x41300000, v4
    v_sin_f32 v9, -v8
    v_cos_f32 v8, v8
    v_accvgpr_write_b32 a206, v10
    v_cvt_pk_bf16_f32 v10, v8, v9
    v_fmamk_f32 v6, v5, 0x41800000, v4
    v_sin_f32 v7, -v6
    v_cos_f32 v6, v6
    v_accvgpr_write_b32 a207, v10
    v_cvt_pk_bf16_f32 v10, v6, v7
    v_fmamk_f32 v8, v5, 0x41880000, v4
    v_sin_f32 v9, -v8
    v_cos_f32 v8, v8
    v_accvgpr_write_b32 a208, v10
    v_cvt_pk_bf16_f32 v10, v8, v9
    v_fmamk_f32 v6, v5, 0x41900000, v4
    v_sin_f32 v7, -v6
    v_cos_f32 v6, v6
    v_accvgpr_write_b32 a209, v10
    v_cvt_pk_bf16_f32 v10, v6, v7
    v_fmamk_f32 v8, v5, 0x41980000, v4
    v_sin_f32 v9, -v8
    v_cos_f32 v8, v8
    v_accvgpr_write_b32 a210, v10
    v_cvt_pk_bf16_f32 v10, v8, v9
    v_fmamk_f32 v6, v5, 0x41c00000, v4
    v_sin_f32 v7, -v6
    v_cos_f32 v6, v6
    v_accvgpr_write_b32 a211, v10
    v_cvt_pk_bf16_f32 v10, v6, v7
    v_fmamk_f32 v8, v5, 0x41c80000, v4
    v_sin_f32 v9, -v8
    v_cos_f32 v8, v8
    v_accvgpr_write_b32 a212, v10
    v_cvt_pk_bf16_f32 v10, v8, v9
    v_fmamk_f32 v6, v5, 0x41d00000, v4
    v_sin_f32 v7, -v6
    v_cos_f32 v6, v6
    v_accvgpr_write_b32 a213, v10
    v_cvt_pk_bf16_f32 v10, v6, v7
    v_fmamk_f32 v8, v5, 0x41d80000, v4
    v_sin_f32 v9, -v8
    v_cos_f32 v8, v8
    v_accvgpr_write_b32 a214, v10
    v_cvt_pk_bf16_f32 v10, v8, v9
    v_fmamk_f32 v6, v5, 0x42000000, v4
    v_sin_f32 v7, -v6
    v_cos_f32 v6, v6
    v_accvgpr_write_b32 a215, v10
    v_cvt_pk_bf16_f32 v10, v6, v7
    v_fmamk_f32 v8, v5, 0x42040000, v4
    v_sin_f32 v9, -v8
    v_cos_f32 v8, v8
    v_accvgpr_write_b32 a216, v10
    v_cvt_pk_bf16_f32 v10, v8, v9
    v_fmamk_f32 v6, v5, 0x42080000, v4
    v_sin_f32 v7, -v6
    v_cos_f32 v6, v6
    v_accvgpr_write_b32 a217, v10
    v_cvt_pk_bf16_f32 v10, v6, v7
    v_fmamk_f32 v8, v5, 0x420c0000, v4
    v_sin_f32 v9, -v8
    v_cos_f32 v8, v8
    v_accvgpr_write_b32 a218, v10
    v_cvt_pk_bf16_f32 v10, v8, v9
    v_fmamk_f32 v6, v5, 0x42200000, v4
    v_sin_f32 v7, -v6
    v_cos_f32 v6, v6
    v_accvgpr_write_b32 a219, v10
    v_cvt_pk_bf16_f32 v10, v6, v7
    v_fmamk_f32 v8, v5, 0x42240000, v4
    v_sin_f32 v9, -v8
    v_cos_f32 v8, v8
    v_accvgpr_write_b32 a220, v10
    v_cvt_pk_bf16_f32 v10, v8, v9
    v_fmamk_f32 v6, v5, 0x42280000, v4
    v_sin_f32 v7, -v6
    v_cos_f32 v6, v6
    v_accvgpr_write_b32 a221, v10
    v_cvt_pk_bf16_f32 v10, v6, v7
    v_fmamk_f32 v8, v5, 0x422c0000, v4
    v_sin_f32 v9, -v8
    v_cos_f32 v8, v8
    v_accvgpr_write_b32 a222, v10
    v_cvt_pk_bf16_f32 v10, v8, v9
    v_fmamk_f32 v6, v5, 0x42400000, v4
    v_sin_f32 v7, -v6
    v_cos_f32 v6, v6
    v_accvgpr_write_b32 a223, v10
    v_cvt_pk_bf16_f32 v10, v6, v7
    v_fmamk_f32 v8, v5, 0x42440000, v4
    v_sin_f32 v9, -v8
    v_cos_f32 v8, v8
    v_accvgpr_write_b32 a224, v10
    v_cvt_pk_bf16_f32 v10, v8, v9
    v_fmamk_f32 v6, v5, 0x42480000, v4
    v_sin_f32 v7, -v6
    v_cos_f32 v6, v6
    v_accvgpr_write_b32 a225, v10
    v_cvt_pk_bf16_f32 v10, v6, v7
    v_fmamk_f32 v8, v5, 0x424c0000, v4
    v_sin_f32 v9, -v8
    v_cos_f32 v8, v8
    v_accvgpr_write_b32 a226, v10
    v_cvt_pk_bf16_f32 v10, v8, v9
    v_fmamk_f32 v6, v5, 0x42600000, v4
    v_sin_f32 v7, -v6
    v_cos_f32 v6, v6
    v_accvgpr_write_b32 a227, v10
    v_cvt_pk_bf16_f32 v10, v6, v7
    v_fmamk_f32 v8, v5, 0x42640000, v4
    v_sin_f32 v9, -v8
    v_cos_f32 v8, v8
    v_accvgpr_write_b32 a228, v10
    v_cvt_pk_bf16_f32 v10, v8, v9
    v_fmamk_f32 v6, v5, 0x42680000, v4
    v_sin_f32 v7, -v6
    v_cos_f32 v6, v6
    v_accvgpr_write_b32 a229, v10
    v_cvt_pk_bf16_f32 v10, v6, v7
    v_fmamk_f32 v8, v5, 0x426c0000, v4
    v_sin_f32 v9, -v8
    v_cos_f32 v8, v8
    v_accvgpr_write_b32 a230, v10
    v_cvt_pk_bf16_f32 v10, v8, v9
    v_fmamk_f32 v6, v5, 0x42800000, v4
    v_sin_f32 v7, -v6
    v_cos_f32 v6, v6
    v_accvgpr_write_b32 a231, v10
    v_cvt_pk_bf16_f32 v10, v6, v7
    v_fmamk_f32 v8, v5, 0x42820000, v4
    v_sin_f32 v9, -v8
    v_cos_f32 v8, v8
    v_accvgpr_write_b32 a232, v10
    v_cvt_pk_bf16_f32 v10, v8, v9
    v_fmamk_f32 v6, v5, 0x42840000, v4
    v_sin_f32 v7, -v6
    v_cos_f32 v6, v6
    v_accvgpr_write_b32 a233, v10
    v_cvt_pk_bf16_f32 v10, v6, v7
    v_fmamk_f32 v8, v5, 0x42860000, v4
    v_sin_f32 v9, -v8
    v_cos_f32 v8, v8
    v_accvgpr_write_b32 a234, v10
    v_cvt_pk_bf16_f32 v10, v8, v9
    v_fmamk_f32 v6, v5, 0x42900000, v4
    v_sin_f32 v7, -v6
    v_cos_f32 v6, v6
    v_accvgpr_write_b32 a235, v10
    v_cvt_pk_bf16_f32 v10, v6, v7
    v_fmamk_f32 v8, v5, 0x42920000, v4
    v_sin_f32 v9, -v8
    v_cos_f32 v8, v8
    v_accvgpr_write_b32 a236, v10
    v_cvt_pk_bf16_f32 v10, v8, v9
    v_fmamk_f32 v6, v5, 0x42940000, v4
    v_sin_f32 v7, -v6
    v_cos_f32 v6, v6
    v_accvgpr_write_b32 a237, v10
    v_cvt_pk_bf16_f32 v10, v6, v7
    v_fmamk_f32 v8, v5, 0x42960000, v4
    v_sin_f32 v9, -v8
    v_cos_f32 v8, v8
    v_accvgpr_write_b32 a238, v10
    v_cvt_pk_bf16_f32 v10, v8, v9
    v_accvgpr_write_b32 a239, v10
LAYER_272:
    s_cmp_ge_u32 s28, 190
    s_cbranch_scc1 R_283
    s_add_u32 s44, s66, 0
    s_mov_b32 s47, 6
    s_mov_b32 s46, 64
    s_mul_i32 s50, s30, 3145728
    s_add_u32 s50, s50, 27262976
    s_mul_i32 s34, s29, 10240
    s_add_u32 s50, s50, s34
    s_mul_i32 s51, s30, 6291456
    s_add_u32 s51, s51, 11534336
    s_lshl_b32 s34, s67, 12
    s_add_u32 s51, s51, s34
    s_add_u32 s52, s34, 14680064
    s_mov_b32 s58, 40960
    v_bfe_u32 v2, v1, 5, 1
    v_mul_u32_u24 v2, 512, v2
    v_bfe_u32 v172, v1, 2, 2
    v_lshl_add_u32 v2, v172, 6, v2
    v_bfe_u32 v172, v1, 4, 1
    v_lshl_add_u32 v2, v172, 5, v2
    v_bfe_u32 v172, v1, 0, 1
    v_lshl_add_u32 v2, v172, 4, v2
    v_bfe_u32 v172, v1, 1, 1
    v_lshl_add_u32 v2, v172, 3, v2
    v_add_u32 v2, s60, v2
    s_lshl_b32 s34, s29, 13
    v_add_u32 v4, s34, v0
    s_lshl_b32 s34, s29, 3
    s_add_u32 s34, s34, 65536
    v_bfe_u32 v5, v1, 0, 5
    v_mul_u32_u24 v5, 32, v5
    v_add_u32 v5, s34, v5
    s_lshl_b32 s35, s29, 11
    s_lshl_b32 s36, s29, 8
    s_add_u32 s36, s36, 67584
    v_add_u32 v3, s35, v0
    s_lshl_b32 s34, s29, 10
    v_add_u32 v7, s34, v0
    v_bfe_u32 v6, v1, 0, 5
    v_mul_u32_u24 v6, 32, v6
    v_add_u32 v6, 65536, v6
    s_lshl_b32 s34, s29, 5
    v_bfe_u32 v8, v1, 0, 2
    v_mul_u32_u24 v8, 1280, v8
    v_bfe_u32 v172, v1, 2, 1
    v_mul_u32_u24 v172, 10240, v172
    v_add_u32 v8, v8, v172
    v_bfe_u32 v172, v1, 3, 1
    v_mul_u32_u24 v172, 5120, v172
    v_add_u32 v8, v8, v172
    v_bfe_u32 v172, v1, 4, 1
    v_mul_u32_u24 v172, 20480, v172
    v_add_u32 v8, v8, v172
    v_bfe_u32 v172, v1, 5, 1
    v_lshl_add_u32 v8, v172, 4, v8
    v_add_u32 v8, s34, v8
    s_cmp_lg_u32 s30, 0
    s_cbranch_scc1 F3_284
    s_lshl_b32 s52, s67, 7
    s_load_dwordx2 s[16:17], s[0:1], 0
    s_mov_b32 s18, 2621440
    s_mov_b32 s19, 0x20000
    s_waitcnt lgkmcnt(0)
    s_branch F3_285
F3_284:
    v_mov_b32 v8, v7
    s_load_dwordx2 s[16:17], s[0:1], 96
    s_mov_b32 s18, 268435456
    s_mov_b32 s19, 0x20000
    s_waitcnt lgkmcnt(0)
F3_285:
    s_add_u32 s57, s30, 1
    s_mul_i32 s37, s29, 40
    v_min_u32 v176, 39, v1
    v_lshlrev_b32 v176, 7, v176
    s_lshl_b32 s32, s37, 7
    s_add_u32 s32, s32, 1097728
    s_mov_b32 s48, 0
P_286:
    buffer_load_dword v172, v176, s[4:7], s32 offen sc1
    s_waitcnt vmcnt(0)
    v_cmp_gt_u32 vcc, s57, v172
    s_cbranch_vccz P_287
    s_add_u32 s48, s48, 1
    s_cmp_gt_u32 s48, 200000
    s_cbranch_scc1 L_end
    s_sleep 1
    s_branch P_286
P_287:
    s_mul_i32 s54, s44, 40960
    s_add_u32 s56, s54, s52
    s_add_u32 s54, s54, s50
    s_add_u32 m0, s60, 0
    s_nop 0
    buffer_load_dwordx4 v0, s[4:7], s54 offen offset:0 sc1 lds
    buffer_load_dwordx4 v0, s[4:7], s54 offen offset:1024 sc1 lds
    buffer_load_dwordx4 v0, s[4:7], s54 offen offset:2048 sc1 lds
    buffer_load_dwordx4 v0, s[4:7], s54 offen offset:3072 sc1 lds
    s_add_u32 s54, s54, 4096
    s_add_u32 m0, s60, 4096
    s_nop 0
    buffer_load_dwordx4 v0, s[4:7], s54 offen offset:0 sc1 lds
    buffer_load_dwordx4 v0, s[4:7], s54 offen offset:1024 sc1 lds
    buffer_load_dwordx4 v0, s[4:7], s54 offen offset:2048 sc1 lds
    buffer_load_dwordx4 v0, s[4:7], s54 offen offset:3072 sc1 lds
    s_add_u32 s54, s54, 4096
    s_add_u32 m0, s60, 8192
    s_nop 0
    buffer_load_dwordx4 v0, s[4:7], s54 offen offset:0 sc1 lds
    buffer_load_dwordx4 v0, s[4:7], s54 offen offset:1024 sc1 lds
    buffer_load_dwordx4 v[164:167], v8, s[16:19], s56 offen sc1
    s_waitcnt vmcnt(0)
    ds_read_b64_tr_b16 v[16:17], v2 offset:0
    ds_read_b64_tr_b16 v[18:19], v2 offset:256
    ds_read_b64_tr_b16 v[20:21], v2 offset:1024
    ds_read_b64_tr_b16 v[22:23], v2 offset:1280
    ds_read_b64_tr_b16 v[24:25], v2 offset:2048
    ds_read_b64_tr_b16 v[26:27], v2 offset:2304
    ds_read_b64_tr_b16 v[28:29], v2 offset:3072
    ds_read_b64_tr_b16 v[30:31], v2 offset:3328
    ds_read_b64_tr_b16 v[32:33], v2 offset:4096
    ds_read_b64_tr_b16 v[34:35], v2 offset:4352
    ds_read_b64_tr_b16 v[36:37], v2 offset:5120
    ds_read_b64_tr_b16 v[38:39], v2 offset:5376
    ds_read_b64_tr_b16 v[40:41], v2 offset:6144
    ds_read_b64_tr_b16 v[42:43], v2 offset:6400
    ds_read_b64_tr_b16 v[44:45], v2 offset:7168
    ds_read_b64_tr_b16 v[46:47], v2 offset:7424
    ds_read_b64_tr_b16 v[48:49], v2 offset:8192
    ds_read_b64_tr_b16 v[50:51], v2 offset:8448
    ds_read_b64_tr_b16 v[52:53], v2 offset:9216
    ds_read_b64_tr_b16 v[54:55], v2 offset:9472
    s_waitcnt lgkmcnt(15)
    v_mfma_f32_32x32x16_bf16 v[96:111], a[160:163], v[16:19], 0
    v_mfma_f32_32x32x16_bf16 v[112:127], a[200:203], v[16:19], 0
    v_mfma_f32_32x32x16_bf16 v[96:111], a[164:167], v[20:23], v[96:111]
    v_mfma_f32_32x32x16_bf16 v[112:127], a[204:207], v[20:23], v[112:127]
    s_waitcnt lgkmcnt(14)
    v_mfma_f32_32x32x16_bf16 v[96:111], a[168:171], v[24:27], v[96:111]
    v_mfma_f32_32x32x16_bf16 v[112:127], a[208:211], v[24:27], v[112:127]
    s_waitcnt lgkmcnt(12)
    v_mfma_f32_32x32x16_bf16 v[96:111], a[172:175], v[28:31], v[96:111]
    v_mfma_f32_32x32x16_bf16 v[112:127], a[212:215], v[28:31], v[112:127]
    s_waitcnt lgkmcnt(10)
    v_mfma_f32_32x32x16_bf16 v[96:111], a[176:179], v[32:35], v[96:111]
    v_mfma_f32_32x32x16_bf16 v[112:127], a[216:219], v[32:35], v[112:127]
    s_waitcnt lgkmcnt(8)
    v_mfma_f32_32x32x16_bf16 v[96:111], a[180:183], v[36:39], v[96:111]
    v_mfma_f32_32x32x16_bf16 v[112:127], a[220:223], v[36:39], v[112:127]
    s_waitcnt lgkmcnt(6)
    v_mfma_f32_32x32x16_bf16 v[96:111], a[184:187], v[40:43], v[96:111]
    v_mfma_f32_32x32x16_bf16 v[112:127], a[224:227], v[40:43], v[112:127]
    s_waitcnt lgkmcnt(4)
    v_mfma_f32_32x32x16_bf16 v[96:111], a[188:191], v[44:47], v[96:111]
    v_mfma_f32_32x32x16_bf16 v[112:127], a[228:231], v[44:47], v[112:127]
    s_waitcnt lgkmcnt(2)
    v_mfma_f32_32x32x16_bf16 v[96:111], a[192:195], v[48:51], v[96:111]
    v_mfma_f32_32x32x16_bf16 v[112:127], a[232:235], v[48:51], v[112:127]
    s_waitcnt lgkmcnt(0)
    v_mfma_f32_32x32x16_bf16 v[96:111], a[196:199], v[52:55], v[96:111]
    v_mfma_f32_32x32x16_bf16 v[112:127], a[236:239], v[52:55], v[112:127]
    s_mul_i32 s55, s44, s58
    s_add_u32 s55, s55, s51
    s_nop 1
    ds_write_b128 v4, v[96:99] offset:0
    ds_write_b128 v4, v[100:103] offset:1024
    ds_write_b128 v4, v[104:107] offset:2048
    ds_write_b128 v4, v[108:111] offset:3072
    ds_write_b128 v4, v[112:115] offset:4096
    ds_write_b128 v4, v[116:119] offset:5120
    ds_write_b128 v4, v[120:123] offset:6144
    ds_write_b128 v4, v[124:127] offset:7168
    s_waitcnt lgkmcnt(0)
    s_barrier
    ds_read_b128 v[96:99], v3 offset:0
    ds_read_b128 v[100:103], v3 offset:1024
    ds_read_b128 v[104:107], v3 offset:8192
    ds_read_b128 v[108:111], v3 offset:9216
    ds_read_b128 v[112:115], v3 offset:16384
    ds_read_b128 v[116:119], v3 offset:17408
    ds_read_b128 v[120:123], v3 offset:24576
    ds_read_b128 v[124:127], v3 offset:25600
    s_waitcnt lgkmcnt(5)
    v_pk_add_f32 v[96:97], v[96:97], v[104:105]
    v_pk_add_f32 v[98:99], v[98:99], v[106:107]
    s_waitcnt lgkmcnt(4)
    v_pk_add_f32 v[100:101], v[100:101], v[108:109]
    v_pk_add_f32 v[102:103], v[102:103], v[110:111]
    s_waitcnt lgkmcnt(3)
    v_pk_add_f32 v[96:97], v[96:97], v[112:113]
    v_pk_add_f32 v[98:99], v[98:99], v[114:115]
    s_waitcnt lgkmcnt(2)
    v_pk_add_f32 v[100:101], v[100:101], v[116:117]
    v_pk_add_f32 v[102:103], v[102:103], v[118:119]
    s_waitcnt lgkmcnt(1)
    v_pk_add_f32 v[96:97], v[96:97], v[120:121]
    v_pk_add_f32 v[98:99], v[98:99], v[122:123]
    s_waitcnt lgkmcnt(0)
    v_pk_add_f32 v[100:101], v[100:101], v[124:125]
    v_pk_add_f32 v[102:103], v[102:103], v[126:127]
    v_cvt_pk_bf16_f32 v172, v96, v97
    v_cvt_pk_bf16_f32 v173, v98, v99
    v_cvt_pk_bf16_f32 v174, v100, v101
    v_cvt_pk_bf16_f32 v175, v102, v103
    v_lshlrev_b32 v96, 16, v172
    v_lshlrev_b32 v97, 16, v164
    v_and_b32 v98, 0xffff0000, v172
    v_and_b32 v99, 0xffff0000, v164
    v_add_f32 v96, v96, v97
    v_add_f32 v98, v98, v99
    v_cvt_pk_bf16_f32 v172, v96, v98
    v_lshlrev_b32 v96, 16, v173
    v_lshlrev_b32 v97, 16, v165
    v_and_b32 v98, 0xffff0000, v173
    v_and_b32 v99, 0xffff0000, v165
    v_add_f32 v96, v96, v97
    v_add_f32 v98, v98, v99
    v_cvt_pk_bf16_f32 v173, v96, v98
    v_lshlrev_b32 v96, 16, v174
    v_lshlrev_b32 v97, 16, v166
    v_and_b32 v98, 0xffff0000, v174
    v_and_b32 v99, 0xffff0000, v166
    v_add_f32 v96, v96, v97
    v_add_f32 v98, v98, v99
    v_cvt_pk_bf16_f32 v174, v96, v98
    v_lshlrev_b32 v96, 16, v175
    v_lshlrev_b32 v97, 16, v167
    v_and_b32 v98, 0xffff0000, v175
    v_and_b32 v99, 0xffff0000, v167
    v_add_f32 v96, v96, v97
    v_add_f32 v98, v98, v99
    v_cvt_pk_bf16_f32 v175, v96, v98
    buffer_store_dwordx4 v[172:175], v7, s[4:7], s55 offen sc1
    s_lshl_b32 s57, s30, 1
    s_add_u32 s57, s57, 1
    s_waitcnt vmcnt(0)
    s_barrier
    s_cmp_lg_u32 s29, 0
    s_cbranch_scc1 F_288
    s_lshl_b32 s32, s28, 5
    s_add_u32 s32, s32, s29
    s_lshl_b32 s32, s32, 2
    s_add_u32 s32, s32, 1122304
    v_mov_b32 v172, s57
    s_mov_b64 exec, 1
    buffer_store_dword v172, off, s[4:7], s32 sc1
    s_mov_b64 exec, -1
F_288:
R_283:
    s_mov_b32 s68, 0
    s_cmp_lt_u32 s28, 128
    s_cselect_b32 s46, 18, 2
    s_lshl_b32 s57, s30, 1
    s_add_u32 s57, s57, 1
LAYER_271:
    s_waitcnt vmcnt(0) lgkmcnt(0)
    s_add_u32 s44, s68, s65
    s_cmp_eq_u32 s64, 2
    s_cselect_b32 s47, 64, 2
    s_cselect_b32 s74, 0, 2
    s_mul_i32 s52, s29, 10240
    s_mul_i32 s50, s30, 6291456
    s_add_u32 s50, s50, 11534336
    s_add_u32 s50, s50, s52
    s_add_u32 s49, s61, s44
    s_mul_i32 s53, s63, 3
    s_add_u32 s53, s53, s64
    s_lshl_b32 s53, s53, 1
    s_add_u32 s53, s53, s65
    s_lshl_b32 s53, s53, 7
    s_add_u32 s53, s53, 1146880
    s_cmp_eq_u32 s29, 0
    s_cselect_b32 s53, s53, 0x40000000
    v_add_u32 v2, s52, v0
    v_add_u32 v8, 0x10000, v0
    s_lshl_b32 s34, s29, 3
    s_add_u32 s34, s34, 81920
    v_bfe_u32 v3, v1, 0, 5
    v_mul_u32_u24 v3, 32, v3
    v_add_u32 v3, s34, v3
    v_bfe_u32 v4, v1, 0, 5
    v_mul_u32_u24 v4, 32, v4
    v_add_u32 v4, 81920, v4
    s_lshl_b32 s36, s29, 8
    s_add_u32 s37, s36, 151552
    s_cmp_eq_u32 s64, 1
    s_cbranch_scc1 G1_289
    s_cmp_eq_u32 s64, 2
    s_cbranch_scc1 G1_290
    s_mul_i32 s51, s30, 67108864
    s_add_u32 s51, s51, 119537664
    s_lshl_b32 s34, s63, 15
    s_lshl_b32 s35, s29, 9
    s_add_u32 s51, s51, s34
    s_add_u32 s51, s51, s35
    s_mov_b32 s58, 1048576
    s_mov_b32 s59, 256
    v_bfe_u32 v5, v1, 1, 1
    v_mul_u32_u24 v5, 2048, v5
    v_bfe_u32 v176, v1, 3, 1
    v_lshl_add_u32 v5, v176, 12, v5
    v_bfe_u32 v176, v1, 2, 1
    v_lshl_add_u32 v5, v176, 6, v5
    v_bfe_u32 v176, v1, 4, 1
    v_lshl_add_u32 v5, v176, 7, v5
    v_bfe_u32 v176, v1, 5, 1
    v_lshl_add_u32 v5, v176, 5, v5
    v_bfe_u32 v176, v1, 0, 1
    v_lshl_add_u32 v5, v176, 4, v5
    s_branch G1_291
G1_289:
    s_mul_i32 s51, s30, 67108864
    s_add_u32 s51, s51, 119554048
    s_lshl_b32 s34, s63, 15
    s_lshl_b32 s35, s29, 11
    s_add_u32 s51, s51, s34
    s_add_u32 s51, s51, s35
    s_mov_b32 s58, 1048576
    s_mov_b32 s59, 512
    v_bfe_u32 v5, v1, 4, 1
    v_mul_u32_u24 v5, 1024, v5
    v_bfe_u32 v176, v1, 5, 1
    v_lshl_add_u32 v5, v176, 8, v5
    v_bfe_u32 v176, v1, 0, 4
    v_lshl_add_u32 v5, v176, 4, v5
    s_add_u32 s36, s36, 83968
    v_bfe_u32 v6, v1, 0, 2
    v_mul_u32_u24 v6, 4, v6
    v_bfe_u32 v176, v1, 2, 1
    v_lshl_add_u32 v6, v176, 5, v6
    v_bfe_u32 v176, v1, 3, 1
    v_lshl_add_u32 v6, v176, 4, v6
    v_bfe_u32 v176, v1, 4, 1
    v_lshl_add_u32 v6, v176, 6, v6
    v_add_u32 v6, s36, v6
    v_bfe_u32 v7, v1, 5, 1
    v_mul_u32_u24 v7, 32, v7
    v_add_u32 v7, s36, v7
    v_bfe_u32 v184, v1, 0, 6
    v_mul_u32_u24 v184, 4, v184
    v_add_u32 v184, s37, v184
    s_cmp_gt_u32 s49, 1
    s_cbranch_scc1 G1_293
    s_mov_b32 s34, 0x3f803f80
    v_mov_b32 v16, s34
    v_mov_b32 v17, s34
    v_mov_b32 v18, s34
    v_mov_b32 v19, s34
    s_nop 1
    v_mfma_f32_32x32x16_bf16 v[88:103], v[16:19], a[0:3], 0
    v_mfma_f32_32x32x16_bf16 v[88:103], v[16:19], a[4:7], v[88:103]
    v_mfma_f32_32x32x16_bf16 v[88:103], v[16:19], a[8:11], v[88:103]
    v_mfma_f32_32x32x16_bf16 v[88:103], v[16:19], a[12:15], v[88:103]
    v_mfma_f32_32x32x16_bf16 v[88:103], v[16:19], a[16:19], v[88:103]
    v_mfma_f32_32x32x16_bf16 v[88:103], v[16:19], a[20:23], v[88:103]
    v_mfma_f32_32x32x16_bf16 v[88:103], v[16:19], a[24:27], v[88:103]
    v_mfma_f32_32x32x16_bf16 v[88:103], v[16:19], a[28:31], v[88:103]
    v_mfma_f32_32x32x16_bf16 v[88:103], v[16:19], a[32:35], v[88:103]
    v_mfma_f32_32x32x16_bf16 v[88:103], v[16:19], a[36:39], v[88:103]
    v_mfma_f32_32x32x16_bf16 v[88:103], v[16:19], a[40:43], v[88:103]
    v_mfma_f32_32x32x16_bf16 v[88:103], v[16:19], a[44:47], v[88:103]
    v_mfma_f32_32x32x16_bf16 v[88:103], v[16:19], a[48:51], v[88:103]
    v_mfma_f32_32x32x16_bf16 v[88:103], v[16:19], a[52:55], v[88:103]
    v_mfma_f32_32x32x16_bf16 v[88:103], v[16:19], a[56:59], v[88:103]
    v_mfma_f32_32x32x16_bf16 v[88:103], v[16:19], a[60:63], v[88:103]
    v_mfma_f32_32x32x16_bf16 v[88:103], v[16:19], a[64:67], v[88:103]
    v_mfma_f32_32x32x16_bf16 v[88:103], v[16:19], a[68:71], v[88:103]
    v_mfma_f32_32x32x16_bf16 v[88:103], v[16:19], a[72:75], v[88:103]
    v_mfma_f32_32x32x16_bf16 v[88:103], v[16:19], a[76:79], v[88:103]
    v_mfma_f32_32x32x16_bf16 v[88:103], v[16:19], a[80:83], v[88:103]
    v_mfma_f32_32x32x16_bf16 v[88:103], v[16:19], a[84:87], v[88:103]
    v_mfma_f32_32x32x16_bf16 v[88:103], v[16:19], a[88:91], v[88:103]
    v_mfma_f32_32x32x16_bf16 v[88:103], v[16:19], a[92:95], v[88:103]
    v_mfma_f32_32x32x16_bf16 v[88:103], v[16:19], a[96:99], v[88:103]
    v_mfma_f32_32x32x16_bf16 v[88:103], v[16:19], a[100:103], v[88:103]
    v_mfma_f32_32x32x16_bf16 v[88:103], v[16:19], a[104:107], v[88:103]
    v_mfma_f32_32x32x16_bf16 v[88:103], v[16:19], a[108:111], v[88:103]
    v_mfma_f32_32x32x16_bf16 v[88:103], v[16:19], a[112:115], v[88:103]
    v_mfma_f32_32x32x16_bf16 v[88:103], v[16:19], a[116:119], v[88:103]
    v_mfma_f32_32x32x16_bf16 v[88:103], v[16:19], a[120:123], v[88:103]
    v_mfma_f32_32x32x16_bf16 v[88:103], v[16:19], a[124:127], v[88:103]
    v_mfma_f32_32x32x16_bf16 v[88:103], v[16:19], a[128:131], v[88:103]
    v_mfma_f32_32x32x16_bf16 v[88:103], v[16:19], a[132:135], v[88:103]
    v_mfma_f32_32x32x16_bf16 v[88:103], v[16:19], a[136:139], v[88:103]
    v_mfma_f32_32x32x16_bf16 v[88:103], v[16:19], a[140:143], v[88:103]
    v_mfma_f32_32x32x16_bf16 v[88:103], v[16:19], a[144:147], v[88:103]
    v_mfma_f32_32x32x16_bf16 v[88:103], v[16:19], a[148:151], v[88:103]
    v_mfma_f32_32x32x16_bf16 v[88:103], v[16:19], a[152:155], v[88:103]
    v_mfma_f32_32x32x16_bf16 v[88:103], v[16:19], a[156:159], v[88:103]
    s_nop 11
    ds_write_b32 v184, v88
G1_293:
    ds_read_b32 v116, v184
    s_cmp_eq_u32 s68, 0
    s_cselect_b32 s34, 45, 15
    s_cselect_b32 s35, 0, 16640
    s_add_u32 s35, s35, 1122304
    s_mul_i32 s38, s34, s29
    s_sub_u32 s34, s34, 1
    v_min_u32 v180, s34, v1
    v_add_lshl_u32 v180, v180, s38, 7
    s_mov_b32 s48, 0
P_294:
    buffer_load_dword v176, v180, s[4:7], s35 offen sc1
    s_waitcnt vmcnt(0)
    v_cmp_gt_u32 vcc, s57, v176
    s_cbranch_vccz P_295
    s_add_u32 s48, s48, 1
    s_cmp_gt_u32 s48, 200000
    s_cbranch_scc1 L_end
    s_sleep 1
    s_branch P_294
P_295:
    s_barrier
    s_mul_i32 s54, s44, 40960
    s_add_u32 s56, s54, s52
    s_add_u32 s54, s54, s50
    s_waitcnt vmcnt(0) lgkmcnt(0)
    s_add_u32 m0, s52, 0
    s_add_u32 s35, s54, 0
    buffer_load_dwordx4 v0, s[4:7], s35 offen offset:0 sc1 lds
    buffer_load_dwordx4 v0, s[4:7], s35 offen offset:1024 sc1 lds
    buffer_load_dwordx4 v0, s[4:7], s35 offen offset:2048 sc1 lds
    buffer_load_dwordx4 v0, s[4:7], s35 offen offset:3072 sc1 lds
    s_add_u32 m0, s52, 4096
    s_add_u32 s35, s54, 4096
    buffer_load_dwordx4 v0, s[4:7], s35 offen offset:0 sc1 lds
    buffer_load_dwordx4 v0, s[4:7], s35 offen offset:1024 sc1 lds
    buffer_load_dwordx4 v0, s[4:7], s35 offen offset:2048 sc1 lds
    buffer_load_dwordx4 v0, s[4:7], s35 offen offset:3072 sc1 lds
    s_add_u32 m0, s52, 8192
    s_add_u32 s35, s54, 8192
    buffer_load_dwordx4 v0, s[4:7], s35 offen offset:0 sc1 lds
    buffer_load_dwordx4 v0, s[4:7], s35 offen offset:1024 sc1 lds
    buffer_load_dword v185, off, s[8:11], 0
    buffer_load_dword v185, off, s[8:11], 0
    buffer_load_dword v185, off, s[8:11], 0
G1_296:
    v_mov_b64 v[104:105], 0
    s_mov_b32 s34, 0x3f803f80
    s_waitcnt vmcnt(11)
    ds_read_b128 v[16:19], v2 offset:0
    ds_read_b128 v[20:23], v2 offset:1024
    s_waitcnt vmcnt(9)
    ds_read_b128 v[24:27], v2 offset:2048
    ds_read_b128 v[28:31], v2 offset:3072
    s_waitcnt vmcnt(7)
    ds_read_b128 v[32:35], v2 offset:4096
    ds_read_b128 v[36:39], v2 offset:5120
    s_waitcnt lgkmcnt(5)
    v_dot2c_f32_bf16 v104, s34, v16
    v_dot2c_f32_bf16 v105, v16, v16
    v_dot2c_f32_bf16 v104, s34, v17
    v_dot2c_f32_bf16 v105, v17, v17
    v_dot2c_f32_bf16 v104, s34, v18
    v_dot2c_f32_bf16 v105, v18, v18
    v_dot2c_f32_bf16 v104, s34, v19
    v_dot2c_f32_bf16 v105, v19, v19
    s_waitcnt lgkmcnt(4)
    v_dot2c_f32_bf16 v104, s34, v20
    v_dot2c_f32_bf16 v105, v20, v20
    v_dot2c_f32_bf16 v104, s34, v21
    v_dot2c_f32_bf16 v105, v21, v21
    v_dot2c_f32_bf16 v104, s34, v22
    v_dot2c_f32_bf16 v105, v22, v22
    v_dot2c_f32_bf16 v104, s34, v23
    v_dot2c_f32_bf16 v105, v23, v23
    s_waitcnt vmcnt(5)
    ds_read_b128 v[40:43], v2 offset:6144
    ds_read_b128 v[44:47], v2 offset:7168
    s_waitcnt lgkmcnt(5)
    v_dot2c_f32_bf16 v104, s34, v24
    v_dot2c_f32_bf16 v105, v24, v24
    v_dot2c_f32_bf16 v104, s34, v25
    v_dot2c_f32_bf16 v105, v25, v25
    v_dot2c_f32_bf16 v104, s34, v26
    v_dot2c_f32_bf16 v105, v26, v26
    v_dot2c_f32_bf16 v104, s34, v27
    v_dot2c_f32_bf16 v105, v27, v27
    s_waitcnt lgkmcnt(4)
    v_dot2c_f32_bf16 v104, s34, v28
    v_dot2c_f32_bf16 v105, v28, v28
    v_dot2c_f32_bf16 v104, s34, v29
    v_dot2c_f32_bf16 v105, v29, v29
    v_dot2c_f32_bf16 v104, s34, v30
    v_dot2c_f32_bf16 v105, v30, v30
    v_dot2c_f32_bf16 v104, s34, v31
    v_dot2c_f32_bf16 v105, v31, v31
    s_waitcnt vmcnt(3)
    ds_read_b128 v[48:51], v2 offset:8192
    ds_read_b128 v[52:55], v2 offset:9216
    s_waitcnt lgkmcnt(5)
    v_dot2c_f32_bf16 v104, s34, v32
    v_dot2c_f32_bf16 v105, v32, v32
    v_dot2c_f32_bf16 v104, s34, v33
    v_dot2c_f32_bf16 v105, v33, v33
    v_dot2c_f32_bf16 v104, s34, v34
    v_dot2c_f32_bf16 v105, v34, v34
    v_dot2c_f32_bf16 v104, s34, v35
    v_dot2c_f32_bf16 v105, v35, v35
    s_waitcnt lgkmcnt(4)
    v_dot2c_f32_bf16 v104, s34, v36
    v_dot2c_f32_bf16 v105, v36, v36
    v_dot2c_f32_bf16 v104, s34, v37
    v_dot2c_f32_bf16 v105, v37, v37
    v_dot2c_f32_bf16 v104, s34, v38
    v_dot2c_f32_bf16 v105, v38, v38
    v_dot2c_f32_bf16 v104, s34, v39
    v_dot2c_f32_bf16 v105, v39, v39
    s_waitcnt lgkmcnt(3)
    v_dot2c_f32_bf16 v104, s34, v40
    v_dot2c_f32_bf16 v105, v40, v40
    v_dot2c_f32_bf16 v104, s34, v41
    v_dot2c_f32_bf16 v105, v41, v41
    v_dot2c_f32_bf16 v104, s34, v42
    v_dot2c_f32_bf16 v105, v42, v42
    v_dot2c_f32_bf16 v104, s34, v43
    v_dot2c_f32_bf16 v105, v43, v43
    s_waitcnt lgkmcnt(2)
    v_dot2c_f32_bf16 v104, s34, v44
    v_dot2c_f32_bf16 v105, v44, v44
    v_dot2c_f32_bf16 v104, s34, v45
    v_dot2c_f32_bf16 v105, v45, v45
    v_dot2c_f32_bf16 v104, s34, v46
    v_dot2c_f32_bf16 v105, v46, v46
    v_dot2c_f32_bf16 v104, s34, v47
    v_dot2c_f32_bf16 v105, v47, v47
    s_waitcnt lgkmcnt(1)
    v_dot2c_f32_bf16 v104, s34, v48
    v_dot2c_f32_bf16 v105, v48, v48
    v_dot2c_f32_bf16 v104, s34, v49
    v_dot2c_f32_bf16 v105, v49, v49
    v_dot2c_f32_bf16 v104, s34, v50
    v_dot2c_f32_bf16 v105, v50, v50
    v_dot2c_f32_bf16 v104, s34, v51
    v_dot2c_f32_bf16 v105, v51, v51
    s_waitcnt lgkmcnt(0)
    v_dot2c_f32_bf16 v104, s34, v52
    v_dot2c_f32_bf16 v105, v52, v52
    v_dot2c_f32_bf16 v104, s34, v53
    v_dot2c_f32_bf16 v105, v53, v53
    v_dot2c_f32_bf16 v104, s34, v54
    v_dot2c_f32_bf16 v105, v54, v54
    v_dot2c_f32_bf16 v104, s34, v55
    v_dot2c_f32_bf16 v105, v55, v55
    s_nop 2
    v_mov_b64 v[106:107], v[104:105]
    s_nop 1
    v_permlane32_swap_b32 v104, v106
    v_permlane32_swap_b32 v105, v107
    v_pk_add_f32 v[104:105], v[104:105], v[106:107]
    ds_write_b64 v3, v[104:105] offset:0
    v_mov_b32 v172, s49
    s_cmp_lt_u32 s44, s47
    s_addc_u32 s45, s44, 1
    s_mul_i32 s54, s45, 40960
    s_add_u32 s56, s54, s52
    s_add_u32 s54, s54, s50
    s_cmp_lt_u32 s45, s46
    s_cselect_b32 s54, s54, 0x40000000
    s_cmp_lt_u32 s44, 5
    s_cbranch_scc0 G1e_297
    s_waitcnt vmcnt(0) lgkmcnt(0)
    s_barrier
    s_mov_b64 exec, 1
    buffer_store_dword v172, off, s[4:7], s53 sc1
    s_mov_b64 exec, -1
    s_branch G1e_298
G1e_297:
    s_waitcnt lgkmcnt(0)
    s_barrier
G1e_298:
    ds_read_b128 v[56:59], v0 offset:0
    ds_read_b128 v[60:63], v0 offset:1024
    ds_read_b128 v[64:67], v0 offset:2048
    ds_read_b128 v[68:71], v0 offset:3072
    ds_read_b128 v[106:109], v4 offset:0
    ds_read_b128 v[110:113], v4 offset:16
    s_waitcnt lgkmcnt(5)
    v_mfma_f32_32x32x16_bf16 v[88:103], v[56:59], a[0:3], 0
    ds_read_b128 v[72:75], v0 offset:4096
    s_waitcnt lgkmcnt(5)
    v_mfma_f32_32x32x16_bf16 v[88:103], v[60:63], a[4:7], v[88:103]
    ds_read_b128 v[76:79], v0 offset:5120
    s_add_u32 m0, s52, 40960
    s_add_u32 s35, s54, 0
    buffer_load_dwordx4 v0, s[4:7], s35 offen offset:0 sc1 lds
    s_waitcnt lgkmcnt(5)
    v_mfma_f32_32x32x16_bf16 v[88:103], v[64:67], a[8:11], v[88:103]
    ds_read_b128 v[80:83], v0 offset:6144
    s_waitcnt lgkmcnt(5)
    v_mfma_f32_32x32x16_bf16 v[88:103], v[68:71], a[12:15], v[88:103]
    ds_read_b128 v[84:87], v0 offset:7168
    buffer_load_dwordx4 v0, s[4:7], s35 offen offset:1024 sc1 lds
    s_waitcnt lgkmcnt(3)
    v_mfma_f32_32x32x16_bf16 v[88:103], v[72:75], a[16:19], v[88:103]
    ds_read_b128 v[56:59], v0 offset:8192
    s_waitcnt lgkmcnt(3)
    v_mfma_f32_32x32x16_bf16 v[88:103], v[76:79], a[20:23], v[88:103]
    ds_read_b128 v[60:63], v0 offset:9216
    buffer_load_dwordx4 v0, s[4:7], s35 offen offset:2048 sc1 lds
    s_waitcnt lgkmcnt(3)
    v_mfma_f32_32x32x16_bf16 v[88:103], v[80:83], a[24:27], v[88:103]
    ds_read_b128 v[64:67], v0 offset:10240
    s_waitcnt lgkmcnt(3)
    v_mfma_f32_32x32x16_bf16 v[88:103], v[84:87], a[28:31], v[88:103]
    ds_read_b128 v[68:71], v0 offset:11264
    buffer_load_dwordx4 v0, s[4:7], s35 offen offset:3072 sc1 lds
    s_waitcnt lgkmcnt(3)
    v_mfma_f32_32x32x16_bf16 v[88:103], v[56:59], a[32:35], v[88:103]
    ds_read_b128 v[72:75], v0 offset:12288
    s_waitcnt lgkmcnt(3)
    v_mfma_f32_32x32x16_bf16 v[88:103], v[60:63], a[36:39], v[88:103]
    ds_read_b128 v[76:79], v0 offset:13312
    s_add_u32 m0, s52, 45056
    s_add_u32 s35, s54, 4096
    buffer_load_dwordx4 v0, s[4:7], s35 offen offset:0 sc1 lds
    s_waitcnt lgkmcnt(3)
    v_mfma_f32_32x32x16_bf16 v[88:103], v[64:67], a[40:43], v[88:103]
    ds_read_b128 v[80:83], v0 offset:14336
    s_waitcnt lgkmcnt(3)
    v_mfma_f32_32x32x16_bf16 v[88:103], v[68:71], a[44:47], v[88:103]
    ds_read_b128 v[84:87], v0 offset:15360
    buffer_load_dwordx4 v0, s[4:7], s35 offen offset:1024 sc1 lds
    s_waitcnt lgkmcnt(3)
    v_mfma_f32_32x32x16_bf16 v[88:103], v[72:75], a[48:51], v[88:103]
    ds_read_b128 v[56:59], v0 offset:16384
    s_waitcnt lgkmcnt(3)
    v_mfma_f32_32x32x16_bf16 v[88:103], v[76:79], a[52:55], v[88:103]
    ds_read_b128 v[60:63], v0 offset:17408
    buffer_load_dwordx4 v0, s[4:7], s35 offen offset:2048 sc1 lds
    s_waitcnt lgkmcnt(3)
    v_mfma_f32_32x32x16_bf16 v[88:103], v[80:83], a[56:59], v[88:103]
    ds_read_b128 v[64:67], v0 offset:18432
    s_waitcnt lgkmcnt(3)
    v_mfma_f32_32x32x16_bf16 v[88:103], v[84:87], a[60:63], v[88:103]
    ds_read_b128 v[68:71], v0 offset:19456
    buffer_load_dwordx4 v0, s[4:7], s35 offen offset:3072 sc1 lds
    s_waitcnt lgkmcnt(3)
    v_mfma_f32_32x32x16_bf16 v[88:103], v[56:59], a[64:67], v[88:103]
    ds_read_b128 v[72:75], v0 offset:20480
    s_waitcnt lgkmcnt(3)
    v_mfma_f32_32x32x16_bf16 v[88:103], v[60:63], a[68:71], v[88:103]
    ds_read_b128 v[76:79], v0 offset:21504
    s_add_u32 m0, s52, 49152
    s_add_u32 s35, s54, 8192
    buffer_load_dwordx4 v0, s[4:7], s35 offen offset:0 sc1 lds
    s_waitcnt lgkmcnt(3)
    v_mfma_f32_32x32x16_bf16 v[88:103], v[64:67], a[72:75], v[88:103]
    ds_read_b128 v[80:83], v0 offset:22528
    s_waitcnt lgkmcnt(3)
    v_mfma_f32_32x32x16_bf16 v[88:103], v[68:71], a[76:79], v[88:103]
    ds_read_b128 v[84:87], v0 offset:23552
    buffer_load_dwordx4 v0, s[4:7], s35 offen offset:1024 sc1 lds
    s_waitcnt lgkmcnt(3)
    v_mfma_f32_32x32x16_bf16 v[88:103], v[72:75], a[80:83], v[88:103]
    ds_read_b128 v[56:59], v0 offset:24576
    v_add_f32 v106, v106, v108
    v_add_f32 v107, v107, v109
    s_waitcnt lgkmcnt(3)
    v_mfma_f32_32x32x16_bf16 v[88:103], v[76:79], a[84:87], v[88:103]
    ds_read_b128 v[60:63], v0 offset:25600
    v_add_f32 v106, v106, v110
    v_add_f32 v107, v107, v111
    s_waitcnt lgkmcnt(3)
    v_mfma_f32_32x32x16_bf16 v[88:103], v[80:83], a[88:91], v[88:103]
    ds_read_b128 v[64:67], v0 offset:26624
    v_add_f32 v106, v106, v112
    v_add_f32 v107, v107, v113
    s_waitcnt lgkmcnt(3)
    v_mfma_f32_32x32x16_bf16 v[88:103], v[84:87], a[92:95], v[88:103]
    ds_read_b128 v[68:71], v0 offset:27648
    v_mul_f32 v106, 0x3acccccd, v106
    v_mul_f32 v107, 0x3acccccd, v107
    s_waitcnt lgkmcnt(3)
    v_mfma_f32_32x32x16_bf16 v[88:103], v[56:59], a[96:99], v[88:103]
    ds_read_b128 v[72:75], v0 offset:28672
    v_fma_f32 v107, -v106, v106, v107
    v_max_f32 v107, 0, v107
    s_waitcnt lgkmcnt(3)
    v_mfma_f32_32x32x16_bf16 v[88:103], v[60:63], a[100:103], v[88:103]
    ds_read_b128 v[76:79], v0 offset:29696
    v_add_f32 v107, 0x3727c5ac, v107
    v_rsq_f32 v107, v107
    s_waitcnt lgkmcnt(3)
    v_mfma_f32_32x32x16_bf16 v[88:103], v[64:67], a[104:107], v[88:103]
    ds_read_b128 v[80:83], v0 offset:30720
    ds_write2_b32 v6, v106, v107 offset0:0 offset1:32
    ds_read_b128 v[132:135], v7 offset:0
    s_waitcnt lgkmcnt(5)
    v_mfma_f32_32x32x16_bf16 v[88:103], v[68:71], a[108:111], v[88:103]
    ds_read_b128 v[84:87], v0 offset:31744
    ds_read_b128 v[136:139], v7 offset:16
    ds_read_b128 v[140:143], v7 offset:64
    s_waitcnt lgkmcnt(7)
    v_mfma_f32_32x32x16_bf16 v[88:103], v[72:75], a[112:115], v[88:103]
    ds_read_b128 v[56:59], v0 offset:32768
    ds_read_b128 v[144:147], v7 offset:80
    ds_read_b128 v[148:151], v7 offset:128
    s_waitcnt lgkmcnt(9)
    v_mfma_f32_32x32x16_bf16 v[88:103], v[76:79], a[116:119], v[88:103]
    ds_read_b128 v[60:63], v0 offset:33792
    ds_read_b128 v[152:155], v7 offset:144
    ds_read_b128 v[156:159], v7 offset:192
    s_waitcnt lgkmcnt(11)
    v_mfma_f32_32x32x16_bf16 v[88:103], v[80:83], a[120:123], v[88:103]
    ds_read_b128 v[64:67], v0 offset:34816
    ds_read_b128 v[160:163], v7 offset:208
    s_waitcnt lgkmcnt(10)
    v_mfma_f32_32x32x16_bf16 v[88:103], v[84:87], a[124:127], v[88:103]
    ds_read_b128 v[68:71], v0 offset:35840
    s_waitcnt lgkmcnt(8)
    v_mfma_f32_32x32x16_bf16 v[88:103], v[56:59], a[128:131], v[88:103]
    ds_read_b128 v[72:75], v0 offset:36864
    s_waitcnt lgkmcnt(6)
    v_mfma_f32_32x32x16_bf16 v[88:103], v[60:63], a[132:135], v[88:103]
    ds_read_b128 v[76:79], v0 offset:37888
    s_waitcnt lgkmcnt(4)
    v_mfma_f32_32x32x16_bf16 v[88:103], v[64:67], a[136:139], v[88:103]
    ds_read_b128 v[80:83], v0 offset:38912
    s_waitcnt lgkmcnt(3)
    v_mfma_f32_32x32x16_bf16 v[88:103], v[68:71], a[140:143], v[88:103]
    ds_read_b128 v[84:87], v0 offset:39936
    s_waitcnt lgkmcnt(3)
    v_mfma_f32_32x32x16_bf16 v[88:103], v[72:75], a[144:147], v[88:103]
    s_waitcnt lgkmcnt(2)
    v_mfma_f32_32x32x16_bf16 v[88:103], v[76:79], a[148:151], v[88:103]
    s_waitcnt vmcnt(10)
    s_barrier
    s_waitcnt lgkmcnt(1)
    v_mfma_f32_32x32x16_bf16 v[88:103], v[80:83], a[152:155], v[88:103]
    s_waitcnt lgkmcnt(0)
    v_mfma_f32_32x32x16_bf16 v[88:103], v[84:87], a[156:159], v[88:103]
    s_mul_i32 s55, s44, s58
    s_add_u32 s55, s55, s51
    s_xor_b32 s35, s44, s31
    s_and_b32 s35, s35, s74
    s_lshl_b32 s35, s35, 12
    s_add_u32 s55, s55, s35
    s_add_u32 s35, s55, s59
    s_add_u32 s49, s45, s61
    s_mov_b32 s44, s45
    s_nop 2
    v_pk_fma_f32 v[88:89], v[132:133], v[116:117], v[88:89] op_sel_hi:[1,0,1] neg_lo:[1,0,0] neg_hi:[1,0,0]
    s_nop 0
    v_pk_mul_f32 v[88:89], v[88:89], v[148:149]
    v_pk_fma_f32 v[90:91], v[134:135], v[116:117], v[90:91] op_sel_hi:[1,0,1] neg_lo:[1,0,0] neg_hi:[1,0,0]
    s_nop 0
    v_pk_mul_f32 v[90:91], v[90:91], v[150:151]
    v_pk_fma_f32 v[92:93], v[136:137], v[116:117], v[92:93] op_sel_hi:[1,0,1] neg_lo:[1,0,0] neg_hi:[1,0,0]
    s_nop 0
    v_pk_mul_f32 v[92:93], v[92:93], v[152:153]
    v_pk_fma_f32 v[94:95], v[138:139], v[116:117], v[94:95] op_sel_hi:[1,0,1] neg_lo:[1,0,0] neg_hi:[1,0,0]
    s_nop 0
    v_pk_mul_f32 v[94:95], v[94:95], v[154:155]
    v_pk_fma_f32 v[96:97], v[140:141], v[116:117], v[96:97] op_sel_hi:[1,0,1] neg_lo:[1,0,0] neg_hi:[1,0,0]
    s_nop 0
    v_pk_mul_f32 v[96:97], v[96:97], v[156:157]
    v_pk_fma_f32 v[98:99], v[142:143], v[116:117], v[98:99] op_sel_hi:[1,0,1] neg_lo:[1,0,0] neg_hi:[1,0,0]
    s_nop 0
    v_pk_mul_f32 v[98:99], v[98:99], v[158:159]
    v_pk_fma_f32 v[100:101], v[144:145], v[116:117], v[100:101] op_sel_hi:[1,0,1] neg_lo:[1,0,0] neg_hi:[1,0,0]
    s_nop 0
    v_pk_mul_f32 v[100:101], v[100:101], v[160:161]
    v_pk_fma_f32 v[102:103], v[146:147], v[116:117], v[102:103] op_sel_hi:[1,0,1] neg_lo:[1,0,0] neg_hi:[1,0,0]
    s_nop 0
    v_pk_mul_f32 v[102:103], v[102:103], v[162:163]
    v_cvt_pk_bf16_f32 v164, v88, v89
    v_cvt_pk_bf16_f32 v165, v90, v91
    v_cvt_pk_bf16_f32 v166, v92, v93
    v_cvt_pk_bf16_f32 v167, v94, v95
    v_cvt_pk_bf16_f32 v168, v96, v97
    v_cvt_pk_bf16_f32 v169, v98, v99
    v_cvt_pk_bf16_f32 v170, v100, v101
    v_cvt_pk_bf16_f32 v171, v102, v103
    buffer_store_dwordx4 v[164:167], v5, s[4:7], s55 offen sc1
    buffer_store_dwordx4 v[168:171], v5, s[4:7], s35 offen sc1
    s_mov_b64 exec, 1
    buffer_store_dword v172, off, s[4:7], s53 sc1
    s_mov_b64 exec, -1
    s_cmp_lt_u32 s44, s46
    s_cbranch_scc0 G1_292
    v_mov_b64 v[104:105], 0
    s_mov_b32 s34, 0x3f803f80
    s_waitcnt vmcnt(11)
    ds_read_b128 v[16:19], v2 offset:40960
    ds_read_b128 v[20:23], v2 offset:41984
    s_waitcnt vmcnt(9)
    ds_read_b128 v[24:27], v2 offset:43008
    ds_read_b128 v[28:31], v2 offset:44032
    s_waitcnt vmcnt(7)
    ds_read_b128 v[32:35], v2 offset:45056
    ds_read_b128 v[36:39], v2 offset:46080
    s_waitcnt lgkmcnt(5)
    v_dot2c_f32_bf16 v104, s34, v16
    v_dot2c_f32_bf16 v105, v16, v16
    v_dot2c_f32_bf16 v104, s34, v17
    v_dot2c_f32_bf16 v105, v17, v17
    v_dot2c_f32_bf16 v104, s34, v18
    v_dot2c_f32_bf16 v105, v18, v18
    v_dot2c_f32_bf16 v104, s34, v19
    v_dot2c_f32_bf16 v105, v19, v19
    s_waitcnt lgkmcnt(4)
    v_dot2c_f32_bf16 v104, s34, v20
    v_dot2c_f32_bf16 v105, v20, v20
    v_dot2c_f32_bf16 v104, s34, v21
    v_dot2c_f32_bf16 v105, v21, v21
    v_dot2c_f32_bf16 v104, s34, v22
    v_dot2c_f32_bf16 v105, v22, v22
    v_dot2c_f32_bf16 v104, s34, v23
    v_dot2c_f32_bf16 v105, v23, v23
    s_waitcnt vmcnt(5)
    ds_read_b128 v[40:43], v2 offset:47104
    ds_read_b128 v[44:47], v2 offset:48128
    s_waitcnt lgkmcnt(5)
    v_dot2c_f32_bf16 v104, s34, v24
    v_dot2c_f32_bf16 v105, v24, v24
    v_dot2c_f32_bf16 v104, s34, v25
    v_dot2c_f32_bf16 v105, v25, v25
    v_dot2c_f32_bf16 v104, s34, v26
    v_dot2c_f32_bf16 v105, v26, v26
    v_dot2c_f32_bf16 v104, s34, v27
    v_dot2c_f32_bf16 v105, v27, v27
    s_waitcnt lgkmcnt(4)
    v_dot2c_f32_bf16 v104, s34, v28
    v_dot2c_f32_bf16 v105, v28, v28
    v_dot2c_f32_bf16 v104, s34, v29
    v_dot2c_f32_bf16 v105, v29, v29
    v_dot2c_f32_bf16 v104, s34, v30
    v_dot2c_f32_bf16 v105, v30, v30
    v_dot2c_f32_bf16 v104, s34, v31
    v_dot2c_f32_bf16 v105, v31, v31
    s_waitcnt vmcnt(3)
    ds_read_b128 v[48:51], v2 offset:49152
    ds_read_b128 v[52:55], v2 offset:50176
    s_waitcnt lgkmcnt(5)
    v_dot2c_f32_bf16 v104, s34, v32
    v_dot2c_f32_bf16 v105, v32, v32
    v_dot2c_f32_bf16 v104, s34, v33
    v_dot2c_f32_bf16 v105, v33, v33
    v_dot2c_f32_bf16 v104, s34, v34
    v_dot2c_f32_bf16 v105, v34, v34
    v_dot2c_f32_bf16 v104, s34, v35
    v_dot2c_f32_bf16 v105, v35, v35
    s_waitcnt lgkmcnt(4)
    v_dot2c_f32_bf16 v104, s34, v36
    v_dot2c_f32_bf16 v105, v36, v36
    v_dot2c_f32_bf16 v104, s34, v37
    v_dot2c_f32_bf16 v105, v37, v37
    v_dot2c_f32_bf16 v104, s34, v38
    v_dot2c_f32_bf16 v105, v38, v38
    v_dot2c_f32_bf16 v104, s34, v39
    v_dot2c_f32_bf16 v105, v39, v39
    s_waitcnt lgkmcnt(3)
    v_dot2c_f32_bf16 v104, s34, v40
    v_dot2c_f32_bf16 v105, v40, v40
    v_dot2c_f32_bf16 v104, s34, v41
    v_dot2c_f32_bf16 v105, v41, v41
    v_dot2c_f32_bf16 v104, s34, v42
    v_dot2c_f32_bf16 v105, v42, v42
    v_dot2c_f32_bf16 v104, s34, v43
    v_dot2c_f32_bf16 v105, v43, v43
    s_waitcnt lgkmcnt(2)
    v_dot2c_f32_bf16 v104, s34, v44
    v_dot2c_f32_bf16 v105, v44, v44
    v_dot2c_f32_bf16 v104, s34, v45
    v_dot2c_f32_bf16 v105, v45, v45
    v_dot2c_f32_bf16 v104, s34, v46
    v_dot2c_f32_bf16 v105, v46, v46
    v_dot2c_f32_bf16 v104, s34, v47
    v_dot2c_f32_bf16 v105, v47, v47
    s_waitcnt lgkmcnt(1)
    v_dot2c_f32_bf16 v104, s34, v48
    v_dot2c_f32_bf16 v105, v48, v48
    v_dot2c_f32_bf16 v104, s34, v49
    v_dot2c_f32_bf16 v105, v49, v49
    v_dot2c_f32_bf16 v104, s34, v50
    v_dot2c_f32_bf16 v105, v50, v50
    v_dot2c_f32_bf16 v104, s34, v51
    v_dot2c_f32_bf16 v105, v51, v51
    s_waitcnt lgkmcnt(0)
    v_dot2c_f32_bf16 v104, s34, v52
    v_dot2c_f32_bf16 v105, v52, v52
    v_dot2c_f32_bf16 v104, s34, v53
    v_dot2c_f32_bf16 v105, v53, v53
    v_dot2c_f32_bf16 v104, s34, v54
    v_dot2c_f32_bf16 v105, v54, v54
    v_dot2c_f32_bf16 v104, s34, v55
    v_dot2c_f32_bf16 v105, v55, v55
    s_nop 2
    v_mov_b64 v[106:107], v[104:105]
    s_nop 1
    v_permlane32_swap_b32 v104, v106
    v_permlane32_swap_b32 v105, v107
    v_pk_add_f32 v[104:105], v[104:105], v[106:107]
    ds_write_b64 v3, v[104:105] offset:1024
    v_mov_b32 v172, s49
    s_cmp_lt_u32 s44, s47
    s_addc_u32 s45, s44, 1
    s_mul_i32 s54, s45, 40960
    s_add_u32 s56, s54, s52
    s_add_u32 s54, s54, s50
    s_cmp_lt_u32 s45, s46
    s_cselect_b32 s54, s54, 0x40000000
    s_cmp_lt_u32 s44, 5
    s_cbranch_scc0 G1e_299
    s_waitcnt vmcnt(0) lgkmcnt(0)
    s_barrier
    s_mov_b64 exec, 1
    buffer_store_dword v172, off, s[4:7], s53 sc1
    s_mov_b64 exec, -1
    s_branch G1e_300
G1e_299:
    s_waitcnt lgkmcnt(0)
    s_barrier
G1e_300:
    ds_read_b128 v[56:59], v0 offset:40960
    ds_read_b128 v[60:63], v0 offset:41984
    ds_read_b128 v[64:67], v0 offset:43008
    ds_read_b128 v[68:71], v0 offset:44032
    ds_read_b128 v[106:109], v4 offset:1024
    ds_read_b128 v[110:113], v4 offset:1040
    s_waitcnt lgkmcnt(5)
    v_mfma_f32_32x32x16_bf16 v[88:103], v[56:59], a[0:3], 0
    ds_read_b128 v[72:75], v0 offset:45056
    s_waitcnt lgkmcnt(5)
    v_mfma_f32_32x32x16_bf16 v[88:103], v[60:63], a[4:7], v[88:103]
    ds_read_b128 v[76:79], v0 offset:46080
    s_add_u32 m0, s52, 0
    s_add_u32 s35, s54, 0
    buffer_load_dwordx4 v0, s[4:7], s35 offen offset:0 sc1 lds
    s_waitcnt lgkmcnt(5)
    v_mfma_f32_32x32x16_bf16 v[88:103], v[64:67], a[8:11], v[88:103]
    ds_read_b128 v[80:83], v0 offset:47104
    s_waitcnt lgkmcnt(5)
    v_mfma_f32_32x32x16_bf16 v[88:103], v[68:71], a[12:15], v[88:103]
    ds_read_b128 v[84:87], v0 offset:48128
    buffer_load_dwordx4 v0, s[4:7], s35 offen offset:1024 sc1 lds
    s_waitcnt lgkmcnt(3)
    v_mfma_f32_32x32x16_bf16 v[88:103], v[72:75], a[16:19], v[88:103]
    ds_read_b128 v[56:59], v0 offset:49152
    s_waitcnt lgkmcnt(3)
    v_mfma_f32_32x32x16_bf16 v[88:103], v[76:79], a[20:23], v[88:103]
    ds_read_b128 v[60:63], v0 offset:50176
    buffer_load_dwordx4 v0, s[4:7], s35 offen offset:2048 sc1 lds
    s_waitcnt lgkmcnt(3)
    v_mfma_f32_32x32x16_bf16 v[88:103], v[80:83], a[24:27], v[88:103]
    ds_read_b128 v[64:67], v0 offset:51200
    s_waitcnt lgkmcnt(3)
    v_mfma_f32_32x32x16_bf16 v[88:103], v[84:87], a[28:31], v[88:103]
    ds_read_b128 v[68:71], v0 offset:52224
    buffer_load_dwordx4 v0, s[4:7], s35 offen offset:3072 sc1 lds
    s_waitcnt lgkmcnt(3)
    v_mfma_f32_32x32x16_bf16 v[88:103], v[56:59], a[32:35], v[88:103]
    ds_read_b128 v[72:75], v0 offset:53248
    s_waitcnt lgkmcnt(3)
    v_mfma_f32_32x32x16_bf16 v[88:103], v[60:63], a[36:39], v[88:103]
    ds_read_b128 v[76:79], v0 offset:54272
    s_add_u32 m0, s52, 4096
    s_add_u32 s35, s54, 4096
    buffer_load_dwordx4 v0, s[4:7], s35 offen offset:0 sc1 lds
    s_waitcnt lgkmcnt(3)
    v_mfma_f32_32x32x16_bf16 v[88:103], v[64:67], a[40:43], v[88:103]
    ds_read_b128 v[80:83], v0 offset:55296
    s_waitcnt lgkmcnt(3)
    v_mfma_f32_32x32x16_bf16 v[88:103], v[68:71], a[44:47], v[88:103]
    ds_read_b128 v[84:87], v0 offset:56320
    buffer_load_dwordx4 v0, s[4:7], s35 offen offset:1024 sc1 lds
    s_waitcnt lgkmcnt(3)
    v_mfma_f32_32x32x16_bf16 v[88:103], v[72:75], a[48:51], v[88:103]
    ds_read_b128 v[56:59], v0 offset:57344
    s_waitcnt lgkmcnt(3)
    v_mfma_f32_32x32x16_bf16 v[88:103], v[76:79], a[52:55], v[88:103]
    ds_read_b128 v[60:63], v0 offset:58368
    buffer_load_dwordx4 v0, s[4:7], s35 offen offset:2048 sc1 lds
    s_waitcnt lgkmcnt(3)
    v_mfma_f32_32x32x16_bf16 v[88:103], v[80:83], a[56:59], v[88:103]
    ds_read_b128 v[64:67], v0 offset:59392
    s_waitcnt lgkmcnt(3)
    v_mfma_f32_32x32x16_bf16 v[88:103], v[84:87], a[60:63], v[88:103]
    ds_read_b128 v[68:71], v0 offset:60416
    buffer_load_dwordx4 v0, s[4:7], s35 offen offset:3072 sc1 lds
    s_waitcnt lgkmcnt(3)
    v_mfma_f32_32x32x16_bf16 v[88:103], v[56:59], a[64:67], v[88:103]
    ds_read_b128 v[72:75], v0 offset:61440
    s_waitcnt lgkmcnt(3)
    v_mfma_f32_32x32x16_bf16 v[88:103], v[60:63], a[68:71], v[88:103]
    ds_read_b128 v[76:79], v0 offset:62464
    s_add_u32 m0, s52, 8192
    s_add_u32 s35, s54, 8192
    buffer_load_dwordx4 v0, s[4:7], s35 offen offset:0 sc1 lds
    s_waitcnt lgkmcnt(3)
    v_mfma_f32_32x32x16_bf16 v[88:103], v[64:67], a[72:75], v[88:103]
    ds_read_b128 v[80:83], v0 offset:63488
    s_waitcnt lgkmcnt(3)
    v_mfma_f32_32x32x16_bf16 v[88:103], v[68:71], a[76:79], v[88:103]
    ds_read_b128 v[84:87], v0 offset:64512
    buffer_load_dwordx4 v0, s[4:7], s35 offen offset:1024 sc1 lds
    s_waitcnt lgkmcnt(3)
    v_mfma_f32_32x32x16_bf16 v[88:103], v[72:75], a[80:83], v[88:103]
    ds_read_b128 v[56:59], v8 offset:0
    v_add_f32 v106, v106, v108
    v_add_f32 v107, v107, v109
    s_waitcnt lgkmcnt(3)
    v_mfma_f32_32x32x16_bf16 v[88:103], v[76:79], a[84:87], v[88:103]
    ds_read_b128 v[60:63], v8 offset:1024
    v_add_f32 v106, v106, v110
    v_add_f32 v107, v107, v111
    s_waitcnt lgkmcnt(3)
    v_mfma_f32_32x32x16_bf16 v[88:103], v[80:83], a[88:91], v[88:103]
    ds_read_b128 v[64:67], v8 offset:2048
    v_add_f32 v106, v106, v112
    v_add_f32 v107, v107, v113
    s_waitcnt lgkmcnt(3)
    v_mfma_f32_32x32x16_bf16 v[88:103], v[84:87], a[92:95], v[88:103]
    ds_read_b128 v[68:71], v8 offset:3072
    v_mul_f32 v106, 0x3acccccd, v106
    v_mul_f32 v107, 0x3acccccd, v107
    s_waitcnt lgkmcnt(3)
    v_mfma_f32_32x32x16_bf16 v[88:103], v[56:59], a[96:99], v[88:103]
    ds_read_b128 v[72:75], v8 offset:4096
    v_fma_f32 v107, -v106, v106, v107
    v_max_f32 v107, 0, v107
    s_waitcnt lgkmcnt(3)
    v_mfma_f32_32x32x16_bf16 v[88:103], v[60:63], a[100:103], v[88:103]
    ds_read_b128 v[76:79], v8 offset:5120
    v_add_f32 v107, 0x3727c5ac, v107
    v_rsq_f32 v107, v107
    s_waitcnt lgkmcnt(3)
    v_mfma_f32_32x32x16_bf16 v[88:103], v[64:67], a[104:107], v[88:103]
    ds_read_b128 v[80:83], v8 offset:6144
    ds_write2_b32 v6, v106, v107 offset0:0 offset1:32
    ds_read_b128 v[132:135], v7 offset:0
    s_waitcnt lgkmcnt(5)
    v_mfma_f32_32x32x16_bf16 v[88:103], v[68:71], a[108:111], v[88:103]
    ds_read_b128 v[84:87], v8 offset:7168
    ds_read_b128 v[136:139], v7 offset:16
    ds_read_b128 v[140:143], v7 offset:64
    s_waitcnt lgkmcnt(7)
    v_mfma_f32_32x32x16_bf16 v[88:103], v[72:75], a[112:115], v[88:103]
    ds_read_b128 v[56:59], v8 offset:8192
    ds_read_b128 v[144:147], v7 offset:80
    ds_read_b128 v[148:151], v7 offset:128
    s_waitcnt lgkmcnt(9)
    v_mfma_f32_32x32x16_bf16 v[88:103], v[76:79], a[116:119], v[88:103]
    ds_read_b128 v[60:63], v8 offset:9216
    ds_read_b128 v[152:155], v7 offset:144
    ds_read_b128 v[156:159], v7 offset:192
    s_waitcnt lgkmcnt(11)
    v_mfma_f32_32x32x16_bf16 v[88:103], v[80:83], a[120:123], v[88:103]
    ds_read_b128 v[64:67], v8 offset:10240
    ds_read_b128 v[160:163], v7 offset:208
    s_waitcnt lgkmcnt(10)
    v_mfma_f32_32x32x16_bf16 v[88:103], v[84:87], a[124:127], v[88:103]
    ds_read_b128 v[68:71], v8 offset:11264
    s_waitcnt lgkmcnt(8)
    v_mfma_f32_32x32x16_bf16 v[88:103], v[56:59], a[128:131], v[88:103]
    ds_read_b128 v[72:75], v8 offset:12288
    s_waitcnt lgkmcnt(6)
    v_mfma_f32_32x32x16_bf16 v[88:103], v[60:63], a[132:135], v[88:103]
    ds_read_b128 v[76:79], v8 offset:13312
    s_waitcnt lgkmcnt(4)
    v_mfma_f32_32x32x16_bf16 v[88:103], v[64:67], a[136:139], v[88:103]
    ds_read_b128 v[80:83], v8 offset:14336
    s_waitcnt lgkmcnt(3)
    v_mfma_f32_32x32x16_bf16 v[88:103], v[68:71], a[140:143], v[88:103]
    ds_read_b128 v[84:87], v8 offset:15360
    s_waitcnt lgkmcnt(3)
    v_mfma_f32_32x32x16_bf16 v[88:103], v[72:75], a[144:147], v[88:103]
    s_waitcnt lgkmcnt(2)
    v_mfma_f32_32x32x16_bf16 v[88:103], v[76:79], a[148:151], v[88:103]
    s_waitcnt vmcnt(10)
    s_barrier
    s_waitcnt lgkmcnt(1)
    v_mfma_f32_32x32x16_bf16 v[88:103], v[80:83], a[152:155], v[88:103]
    s_waitcnt lgkmcnt(0)
    v_mfma_f32_32x32x16_bf16 v[88:103], v[84:87], a[156:159], v[88:103]
    s_mul_i32 s55, s44, s58
    s_add_u32 s55, s55, s51
    s_xor_b32 s35, s44, s31
    s_and_b32 s35, s35, s74
    s_lshl_b32 s35, s35, 12
    s_add_u32 s55, s55, s35
    s_add_u32 s35, s55, s59
    s_add_u32 s49, s45, s61
    s_mov_b32 s44, s45
    s_nop 2
    v_pk_fma_f32 v[88:89], v[132:133], v[116:117], v[88:89] op_sel_hi:[1,0,1] neg_lo:[1,0,0] neg_hi:[1,0,0]
    s_nop 0
    v_pk_mul_f32 v[88:89], v[88:89], v[148:149]
    v_pk_fma_f32 v[90:91], v[134:135], v[116:117], v[90:91] op_sel_hi:[1,0,1] neg_lo:[1,0,0] neg_hi:[1,0,0]
    s_nop 0
    v_pk_mul_f32 v[90:91], v[90:91], v[150:151]
    v_pk_fma_f32 v[92:93], v[136:137], v[116:117], v[92:93] op_sel_hi:[1,0,1] neg_lo:[1,0,0] neg_hi:[1,0,0]
    s_nop 0
    v_pk_mul_f32 v[92:93], v[92:93], v[152:153]
    v_pk_fma_f32 v[94:95], v[138:139], v[116:117], v[94:95] op_sel_hi:[1,0,1] neg_lo:[1,0,0] neg_hi:[1,0,0]
    s_nop 0
    v_pk_mul_f32 v[94:95], v[94:95], v[154:155]
    v_pk_fma_f32 v[96:97], v[140:141], v[116:117], v[96:97] op_sel_hi:[1,0,1] neg_lo:[1,0,0] neg_hi:[1,0,0]
    s_nop 0
    v_pk_mul_f32 v[96:97], v[96:97], v[156:157]
    v_pk_fma_f32 v[98:99], v[142:143], v[116:117], v[98:99] op_sel_hi:[1,0,1] neg_lo:[1,0,0] neg_hi:[1,0,0]
    s_nop 0
    v_pk_mul_f32 v[98:99], v[98:99], v[158:159]
    v_pk_fma_f32 v[100:101], v[144:145], v[116:117], v[100:101] op_sel_hi:[1,0,1] neg_lo:[1,0,0] neg_hi:[1,0,0]
    s_nop 0
    v_pk_mul_f32 v[100:101], v[100:101], v[160:161]
    v_pk_fma_f32 v[102:103], v[146:147], v[116:117], v[102:103] op_sel_hi:[1,0,1] neg_lo:[1,0,0] neg_hi:[1,0,0]
    s_nop 0
    v_pk_mul_f32 v[102:103], v[102:103], v[162:163]
    v_cvt_pk_bf16_f32 v164, v88, v89
    v_cvt_pk_bf16_f32 v165, v90, v91
    v_cvt_pk_bf16_f32 v166, v92, v93
    v_cvt_pk_bf16_f32 v167, v94, v95
    v_cvt_pk_bf16_f32 v168, v96, v97
    v_cvt_pk_bf16_f32 v169, v98, v99
    v_cvt_pk_bf16_f32 v170, v100, v101
    v_cvt_pk_bf16_f32 v171, v102, v103
    buffer_store_dwordx4 v[164:167], v5, s[4:7], s55 offen sc1
    buffer_store_dwordx4 v[168:171], v5, s[4:7], s35 offen sc1
    s_mov_b64 exec, 1
    buffer_store_dword v172, off, s[4:7], s53 sc1
    s_mov_b64 exec, -1
    s_cmp_lt_u32 s44, s46
    s_cbranch_scc1 G1_296
    s_branch G1_292
G1_290:
    s_mul_i32 s51, s30, 16777216
    s_add_u32 s51, s51, 33554432
    s_lshl_b32 s34, s63, 13
    s_lshl_b32 s35, s29, 11
    s_add_u32 s51, s51, s34
    s_add_u32 s51, s51, s35
    s_mov_b32 s58, 262144
    s_mov_b32 s59, 1024
    v_mov_b32 v5, v0
G1_291:
    v_bfe_u32 v184, v1, 5, 1
    v_mul_u32_u24 v184, 64, v184
    v_add_u32 v184, s37, v184
    s_cmp_gt_u32 s49, 1
    s_cbranch_scc1 G1_301
    s_mov_b32 s34, 0x3f803f80
    v_mov_b32 v16, s34
    v_mov_b32 v17, s34
    v_mov_b32 v18, s34
    v_mov_b32 v19, s34
    s_nop 1
    v_mfma_f32_32x32x16_bf16 v[88:103], a[0:3], v[16:19], 0
    v_mfma_f32_32x32x16_bf16 v[88:103], a[4:7], v[16:19], v[88:103]
    v_mfma_f32_32x32x16_bf16 v[88:103], a[8:11], v[16:19], v[88:103]
    v_mfma_f32_32x32x16_bf16 v[88:103], a[12:15], v[16:19], v[88:103]
    v_mfma_f32_32x32x16_bf16 v[88:103], a[16:19], v[16:19], v[88:103]
    v_mfma_f32_32x32x16_bf16 v[88:103], a[20:23], v[16:19], v[88:103]
    v_mfma_f32_32x32x16_bf16 v[88:103], a[24:27], v[16:19], v[88:103]
    v_mfma_f32_32x32x16_bf16 v[88:103], a[28:31], v[16:19], v[88:103]
    v_mfma_f32_32x32x16_bf16 v[88:103], a[32:35], v[16:19], v[88:103]
    v_mfma_f32_32x32x16_bf16 v[88:103], a[36:39], v[16:19], v[88:103]
    v_mfma_f32_32x32x16_bf16 v[88:103], a[40:43], v[16:19], v[88:103]
    v_mfma_f32_32x32x16_bf16 v[88:103], a[44:47], v[16:19], v[88:103]
    v_mfma_f32_32x32x16_bf16 v[88:103], a[48:51], v[16:19], v[88:103]
    v_mfma_f32_32x32x16_bf16 v[88:103], a[52:55], v[16:19], v[88:103]
    v_mfma_f32_32x32x16_bf16 v[88:103], a[56:59], v[16:19], v[88:103]
    v_mfma_f32_32x32x16_bf16 v[88:103], a[60:63], v[16:19], v[88:103]
    v_mfma_f32_32x32x16_bf16 v[88:103], a[64:67], v[16:19], v[88:103]
    v_mfma_f32_32x32x16_bf16 v[88:103], a[68:71], v[16:19], v[88:103]
    v_mfma_f32_32x32x16_bf16 v[88:103], a[72:75], v[16:19], v[88:103]
    v_mfma_f32_32x32x16_bf16 v[88:103], a[76:79], v[16:19], v[88:103]
    v_mfma_f32_32x32x16_bf16 v[88:103], a[80:83], v[16:19], v[88:103]
    v_mfma_f32_32x32x16_bf16 v[88:103], a[84:87], v[16:19], v[88:103]
    v_mfma_f32_32x32x16_bf16 v[88:103], a[88:91], v[16:19], v[88:103]
    v_mfma_f32_32x32x16_bf16 v[88:103], a[92:95], v[16:19], v[88:103]
    v_mfma_f32_32x32x16_bf16 v[88:103], a[96:99], v[16:19], v[88:103]
    v_mfma_f32_32x32x16_bf16 v[88:103], a[100:103], v[16:19], v[88:103]
    v_mfma_f32_32x32x16_bf16 v[88:103], a[104:107], v[16:19], v[88:103]
    v_mfma_f32_32x32x16_bf16 v[88:103], a[108:111], v[16:19], v[88:103]
    v_mfma_f32_32x32x16_bf16 v[88:103], a[112:115], v[16:19], v[88:103]
    v_mfma_f32_32x32x16_bf16 v[88:103], a[116:119], v[16:19], v[88:103]
    v_mfma_f32_32x32x16_bf16 v[88:103], a[120:123], v[16:19], v[88:103]
    v_mfma_f32_32x32x16_bf16 v[88:103], a[124:127], v[16:19], v[88:103]
    v_mfma_f32_32x32x16_bf16 v[88:103], a[128:131], v[16:19], v[88:103]
    v_mfma_f32_32x32x16_bf16 v[88:103], a[132:135], v[16:19], v[88:103]
    v_mfma_f32_32x32x16_bf16 v[88:103], a[136:139], v[16:19], v[88:103]
    v_mfma_f32_32x32x16_bf16 v[88:103], a[140:143], v[16:19], v[88:103]
    v_mfma_f32_32x32x16_bf16 v[88:103], a[144:147], v[16:19], v[88:103]
    v_mfma_f32_32x32x16_bf16 v[88:103], a[148:151], v[16:19], v[88:103]
    v_mfma_f32_32x32x16_bf16 v[88:103], a[152:155], v[16:19], v[88:103]
    v_mfma_f32_32x32x16_bf16 v[88:103], a[156:159], v[16:19], v[88:103]
    s_nop 11
    ds_write_b128 v184, v[88:91] offset:0
    ds_write_b128 v184, v[92:95] offset:16
    ds_write_b128 v184, v[96:99] offset:32
    ds_write_b128 v184, v[100:103] offset:48
G1_301:
    ds_read_b128 v[116:119], v184 offset:0
    ds_read_b128 v[120:123], v184 offset:16
    ds_read_b128 v[124:127], v184 offset:32
    ds_read_b128 v[128:131], v184 offset:48
    s_cmp_eq_u32 s68, 0
    s_cselect_b32 s34, 45, 15
    s_cselect_b32 s35, 0, 16640
    s_add_u32 s35, s35, 1122304
    s_mul_i32 s38, s34, s29
    s_sub_u32 s34, s34, 1
    v_min_u32 v180, s34, v1
    v_add_lshl_u32 v180, v180, s38, 7
    s_mov_b32 s48, 0
P_302:
    buffer_load_dword v176, v180, s[4:7], s35 offen sc1
    s_waitcnt vmcnt(0)
    v_cmp_gt_u32 vcc, s57, v176
    s_cbranch_vccz P_303
    s_add_u32 s48, s48, 1
    s_cmp_gt_u32 s48, 200000
    s_cbranch_scc1 L_end
    s_sleep 1
    s_branch P_302
P_303:
    s_barrier
    s_mul_i32 s54, s44, 40960
    s_add_u32 s56, s54, s52
    s_add_u32 s54, s54, s50
    s_waitcnt vmcnt(0) lgkmcnt(0)
    s_add_u32 m0, s52, 0
    s_add_u32 s35, s54, 0
    buffer_load_dwordx4 v0, s[4:7], s35 offen offset:0 sc1 lds
    buffer_load_dwordx4 v0, s[4:7], s35 offen offset:1024 sc1 lds
    buffer_load_dwordx4 v0, s[4:7], s35 offen offset:2048 sc1 lds
    buffer_load_dwordx4 v0, s[4:7], s35 offen offset:3072 sc1 lds
    s_add_u32 m0, s52, 4096
    s_add_u32 s35, s54, 4096
    buffer_load_dwordx4 v0, s[4:7], s35 offen offset:0 sc1 lds
    buffer_load_dwordx4 v0, s[4:7], s35 offen offset:1024 sc1 lds
    buffer_load_dwordx4 v0, s[4:7], s35 offen offset:2048 sc1 lds
    buffer_load_dwordx4 v0, s[4:7], s35 offen offset:3072 sc1 lds
    s_add_u32 m0, s52, 8192
    s_add_u32 s35, s54, 8192
    buffer_load_dwordx4 v0, s[4:7], s35 offen offset:0 sc1 lds
    buffer_load_dwordx4 v0, s[4:7], s35 offen offset:1024 sc1 lds
    buffer_load_dword v185, off, s[8:11], 0
    buffer_load_dword v185, off, s[8:11], 0
    buffer_load_dword v185, off, s[8:11], 0
G1_304:
    v_mov_b64 v[104:105], 0
    s_mov_b32 s34, 0x3f803f80
    s_waitcnt vmcnt(11)
    ds_read_b128 v[16:19], v2 offset:0
    ds_read_b128 v[20:23], v2 offset:1024
    s_waitcnt vmcnt(9)
    ds_read_b128 v[24:27], v2 offset:2048
    ds_read_b128 v[28:31], v2 offset:3072
    s_waitcnt vmcnt(7)
    ds_read_b128 v[32:35], v2 offset:4096
    ds_read_b128 v[36:39], v2 offset:5120
    s_waitcnt lgkmcnt(5)
    v_dot2c_f32_bf16 v104, s34, v16
    v_dot2c_f32_bf16 v105, v16, v16
    v_dot2c_f32_bf16 v104, s34, v17
    v_dot2c_f32_bf16 v105, v17, v17
    v_dot2c_f32_bf16 v104, s34, v18
    v_dot2c_f32_bf16 v105, v18, v18
    v_dot2c_f32_bf16 v104, s34, v19
    v_dot2c_f32_bf16 v105, v19, v19
    s_waitcnt lgkmcnt(4)
    v_dot2c_f32_bf16 v104, s34, v20
    v_dot2c_f32_bf16 v105, v20, v20
    v_dot2c_f32_bf16 v104, s34, v21
    v_dot2c_f32_bf16 v105, v21, v21
    v_dot2c_f32_bf16 v104, s34, v22
    v_dot2c_f32_bf16 v105, v22, v22
    v_dot2c_f32_bf16 v104, s34, v23
    v_dot2c_f32_bf16 v105, v23, v23
    s_waitcnt vmcnt(5)
    ds_read_b128 v[40:43], v2 offset:6144
    ds_read_b128 v[44:47], v2 offset:7168
    s_waitcnt lgkmcnt(5)
    v_dot2c_f32_bf16 v104, s34, v24
    v_dot2c_f32_bf16 v105, v24, v24
    v_dot2c_f32_bf16 v104, s34, v25
    v_dot2c_f32_bf16 v105, v25, v25
    v_dot2c_f32_bf16 v104, s34, v26
    v_dot2c_f32_bf16 v105, v26, v26
    v_dot2c_f32_bf16 v104, s34, v27
    v_dot2c_f32_bf16 v105, v27, v27
    s_waitcnt lgkmcnt(4)
    v_dot2c_f32_bf16 v104, s34, v28
    v_dot2c_f32_bf16 v105, v28, v28
    v_dot2c_f32_bf16 v104, s34, v29
    v_dot2c_f32_bf16 v105, v29, v29
    v_dot2c_f32_bf16 v104, s34, v30
    v_dot2c_f32_bf16 v105, v30, v30
    v_dot2c_f32_bf16 v104, s34, v31
    v_dot2c_f32_bf16 v105, v31, v31
    s_waitcnt vmcnt(3)
    ds_read_b128 v[48:51], v2 offset:8192
    ds_read_b128 v[52:55], v2 offset:9216
    s_waitcnt lgkmcnt(5)
    v_dot2c_f32_bf16 v104, s34, v32
    v_dot2c_f32_bf16 v105, v32, v32
    v_dot2c_f32_bf16 v104, s34, v33
    v_dot2c_f32_bf16 v105, v33, v33
    v_dot2c_f32_bf16 v104, s34, v34
    v_dot2c_f32_bf16 v105, v34, v34
    v_dot2c_f32_bf16 v104, s34, v35
    v_dot2c_f32_bf16 v105, v35, v35
    s_waitcnt lgkmcnt(4)
    v_dot2c_f32_bf16 v104, s34, v36
    v_dot2c_f32_bf16 v105, v36, v36
    v_dot2c_f32_bf16 v104, s34, v37
    v_dot2c_f32_bf16 v105, v37, v37
    v_dot2c_f32_bf16 v104, s34, v38
    v_dot2c_f32_bf16 v105, v38, v38
    v_dot2c_f32_bf16 v104, s34, v39
    v_dot2c_f32_bf16 v105, v39, v39
    s_waitcnt lgkmcnt(3)
    v_dot2c_f32_bf16 v104, s34, v40
    v_dot2c_f32_bf16 v105, v40, v40
    v_dot2c_f32_bf16 v104, s34, v41
    v_dot2c_f32_bf16 v105, v41, v41
    v_dot2c_f32_bf16 v104, s34, v42
    v_dot2c_f32_bf16 v105, v42, v42
    v_dot2c_f32_bf16 v104, s34, v43
    v_dot2c_f32_bf16 v105, v43, v43
    s_waitcnt lgkmcnt(2)
    v_dot2c_f32_bf16 v104, s34, v44
    v_dot2c_f32_bf16 v105, v44, v44
    v_dot2c_f32_bf16 v104, s34, v45
    v_dot2c_f32_bf16 v105, v45, v45
    v_dot2c_f32_bf16 v104, s34, v46
    v_dot2c_f32_bf16 v105, v46, v46
    v_dot2c_f32_bf16 v104, s34, v47
    v_dot2c_f32_bf16 v105, v47, v47
    s_waitcnt lgkmcnt(1)
    v_dot2c_f32_bf16 v104, s34, v48
    v_dot2c_f32_bf16 v105, v48, v48
    v_dot2c_f32_bf16 v104, s34, v49
    v_dot2c_f32_bf16 v105, v49, v49
    v_dot2c_f32_bf16 v104, s34, v50
    v_dot2c_f32_bf16 v105, v50, v50
    v_dot2c_f32_bf16 v104, s34, v51
    v_dot2c_f32_bf16 v105, v51, v51
    s_waitcnt lgkmcnt(0)
    v_dot2c_f32_bf16 v104, s34, v52
    v_dot2c_f32_bf16 v105, v52, v52
    v_dot2c_f32_bf16 v104, s34, v53
    v_dot2c_f32_bf16 v105, v53, v53
    v_dot2c_f32_bf16 v104, s34, v54
    v_dot2c_f32_bf16 v105, v54, v54
    v_dot2c_f32_bf16 v104, s34, v55
    v_dot2c_f32_bf16 v105, v55, v55
    s_nop 2
    v_mov_b64 v[106:107], v[104:105]
    s_nop 1
    v_permlane32_swap_b32 v104, v106
    v_permlane32_swap_b32 v105, v107
    v_pk_add_f32 v[104:105], v[104:105], v[106:107]
    ds_write_b64 v3, v[104:105] offset:0
    v_mov_b32 v172, s49
    s_cmp_lt_u32 s44, s47
    s_addc_u32 s45, s44, 1
    s_mul_i32 s54, s45, 40960
    s_add_u32 s56, s54, s52
    s_add_u32 s54, s54, s50
    s_cmp_lt_u32 s45, s46
    s_cselect_b32 s54, s54, 0x40000000
    s_cmp_lt_u32 s44, 5
    s_cbranch_scc0 G1e_305
    s_waitcnt vmcnt(0) lgkmcnt(0)
    s_barrier
    s_mov_b64 exec, 1
    buffer_store_dword v172, off, s[4:7], s53 sc1
    s_mov_b64 exec, -1
    s_branch G1e_306
G1e_305:
    s_waitcnt lgkmcnt(0)
    s_barrier
G1e_306:
    ds_read_b128 v[56:59], v0 offset:0
    ds_read_b128 v[60:63], v0 offset:1024
    ds_read_b128 v[64:67], v0 offset:2048
    ds_read_b128 v[68:71], v0 offset:3072
    ds_read_b128 v[106:109], v4 offset:0
    ds_read_b128 v[110:113], v4 offset:16
    s_waitcnt lgkmcnt(5)
    v_mfma_f32_32x32x16_bf16 v[88:103], a[0:3], v[56:59], 0
    ds_read_b128 v[72:75], v0 offset:4096
    s_waitcnt lgkmcnt(5)
    v_mfma_f32_32x32x16_bf16 v[88:103], a[4:7], v[60:63], v[88:103]
    ds_read_b128 v[76:79], v0 offset:5120
    s_add_u32 m0, s52, 40960
    s_add_u32 s35, s54, 0
    buffer_load_dwordx4 v0, s[4:7], s35 offen offset:0 sc1 lds
    s_waitcnt lgkmcnt(5)
    v_mfma_f32_32x32x16_bf16 v[88:103], a[8:11], v[64:67], v[88:103]
    ds_read_b128 v[80:83], v0 offset:6144
    s_waitcnt lgkmcnt(5)
    v_mfma_f32_32x32x16_bf16 v[88:103], a[12:15], v[68:71], v[88:103]
    ds_read_b128 v[84:87], v0 offset:7168
    buffer_load_dwordx4 v0, s[4:7], s35 offen offset:1024 sc1 lds
    s_waitcnt lgkmcnt(3)
    v_mfma_f32_32x32x16_bf16 v[88:103], a[16:19], v[72:75], v[88:103]
    ds_read_b128 v[56:59], v0 offset:8192
    s_waitcnt lgkmcnt(3)
    v_mfma_f32_32x32x16_bf16 v[88:103], a[20:23], v[76:79], v[88:103]
    ds_read_b128 v[60:63], v0 offset:9216
    buffer_load_dwordx4 v0, s[4:7], s35 offen offset:2048 sc1 lds
    s_waitcnt lgkmcnt(3)
    v_mfma_f32_32x32x16_bf16 v[88:103], a[24:27], v[80:83], v[88:103]
    ds_read_b128 v[64:67], v0 offset:10240
    s_waitcnt lgkmcnt(3)
    v_mfma_f32_32x32x16_bf16 v[88:103], a[28:31], v[84:87], v[88:103]
    ds_read_b128 v[68:71], v0 offset:11264
    buffer_load_dwordx4 v0, s[4:7], s35 offen offset:3072 sc1 lds
    s_waitcnt lgkmcnt(3)
    v_mfma_f32_32x32x16_bf16 v[88:103], a[32:35], v[56:59], v[88:103]
    ds_read_b128 v[72:75], v0 offset:12288
    s_waitcnt lgkmcnt(3)
    v_mfma_f32_32x32x16_bf16 v[88:103], a[36:39], v[60:63], v[88:103]
    ds_read_b128 v[76:79], v0 offset:13312
    s_add_u32 m0, s52, 45056
    s_add_u32 s35, s54, 4096
    buffer_load_dwordx4 v0, s[4:7], s35 offen offset:0 sc1 lds
    s_waitcnt lgkmcnt(3)
    v_mfma_f32_32x32x16_bf16 v[88:103], a[40:43], v[64:67], v[88:103]
    ds_read_b128 v[80:83], v0 offset:14336
    s_waitcnt lgkmcnt(3)
    v_mfma_f32_32x32x16_bf16 v[88:103], a[44:47], v[68:71], v[88:103]
    ds_read_b128 v[84:87], v0 offset:15360
    buffer_load_dwordx4 v0, s[4:7], s35 offen offset:1024 sc1 lds
    s_waitcnt lgkmcnt(3)
    v_mfma_f32_32x32x16_bf16 v[88:103], a[48:51], v[72:75], v[88:103]
    ds_read_b128 v[56:59], v0 offset:16384
    s_waitcnt lgkmcnt(3)
    v_mfma_f32_32x32x16_bf16 v[88:103], a[52:55], v[76:79], v[88:103]
    ds_read_b128 v[60:63], v0 offset:17408
    buffer_load_dwordx4 v0, s[4:7], s35 offen offset:2048 sc1 lds
    s_waitcnt lgkmcnt(3)
    v_mfma_f32_32x32x16_bf16 v[88:103], a[56:59], v[80:83], v[88:103]
    ds_read_b128 v[64:67], v0 offset:18432
    s_waitcnt lgkmcnt(3)
    v_mfma_f32_32x32x16_bf16 v[88:103], a[60:63], v[84:87], v[88:103]
    ds_read_b128 v[68:71], v0 offset:19456
    buffer_load_dwordx4 v0, s[4:7], s35 offen offset:3072 sc1 lds
    s_waitcnt lgkmcnt(3)
    v_mfma_f32_32x32x16_bf16 v[88:103], a[64:67], v[56:59], v[88:103]
    ds_read_b128 v[72:75], v0 offset:20480
    s_waitcnt lgkmcnt(3)
    v_mfma_f32_32x32x16_bf16 v[88:103], a[68:71], v[60:63], v[88:103]
    ds_read_b128 v[76:79], v0 offset:21504
    s_add_u32 m0, s52, 49152
    s_add_u32 s35, s54, 8192
    buffer_load_dwordx4 v0, s[4:7], s35 offen offset:0 sc1 lds
    s_waitcnt lgkmcnt(3)
    v_mfma_f32_32x32x16_bf16 v[88:103], a[72:75], v[64:67], v[88:103]
    ds_read_b128 v[80:83], v0 offset:22528
    s_waitcnt lgkmcnt(3)
    v_mfma_f32_32x32x16_bf16 v[88:103], a[76:79], v[68:71], v[88:103]
    ds_read_b128 v[84:87], v0 offset:23552
    buffer_load_dwordx4 v0, s[4:7], s35 offen offset:1024 sc1 lds
    s_waitcnt lgkmcnt(3)
    v_mfma_f32_32x32x16_bf16 v[88:103], a[80:83], v[72:75], v[88:103]
    ds_read_b128 v[56:59], v0 offset:24576
    v_add_f32 v106, v106, v108
    v_add_f32 v107, v107, v109
    s_waitcnt lgkmcnt(3)
    v_mfma_f32_32x32x16_bf16 v[88:103], a[84:87], v[76:79], v[88:103]
    ds_read_b128 v[60:63], v0 offset:25600
    v_add_f32 v106, v106, v110
    v_add_f32 v107, v107, v111
    s_waitcnt lgkmcnt(3)
    v_mfma_f32_32x32x16_bf16 v[88:103], a[88:91], v[80:83], v[88:103]
    ds_read_b128 v[64:67], v0 offset:26624
    v_add_f32 v106, v106, v112
    v_add_f32 v107, v107, v113
    s_waitcnt lgkmcnt(3)
    v_mfma_f32_32x32x16_bf16 v[88:103], a[92:95], v[84:87], v[88:103]
    ds_read_b128 v[68:71], v0 offset:27648
    v_mul_f32 v106, 0x3acccccd, v106
    v_mul_f32 v107, 0x3acccccd, v107
    s_waitcnt lgkmcnt(3)
    v_mfma_f32_32x32x16_bf16 v[88:103], a[96:99], v[56:59], v[88:103]
    ds_read_b128 v[72:75], v0 offset:28672
    v_fma_f32 v107, -v106, v106, v107
    v_max_f32 v107, 0, v107
    s_waitcnt lgkmcnt(3)
    v_mfma_f32_32x32x16_bf16 v[88:103], a[100:103], v[60:63], v[88:103]
    ds_read_b128 v[76:79], v0 offset:29696
    v_add_f32 v107, 0x3727c5ac, v107
    v_rsq_f32 v107, v107
    s_waitcnt lgkmcnt(3)
    v_mfma_f32_32x32x16_bf16 v[88:103], a[104:107], v[64:67], v[88:103]
    ds_read_b128 v[80:83], v0 offset:30720
    s_waitcnt lgkmcnt(3)
    v_mfma_f32_32x32x16_bf16 v[88:103], a[108:111], v[68:71], v[88:103]
    ds_read_b128 v[84:87], v0 offset:31744
    s_waitcnt lgkmcnt(3)
    v_mfma_f32_32x32x16_bf16 v[88:103], a[112:115], v[72:75], v[88:103]
    ds_read_b128 v[56:59], v0 offset:32768
    s_waitcnt lgkmcnt(3)
    v_mfma_f32_32x32x16_bf16 v[88:103], a[116:119], v[76:79], v[88:103]
    ds_read_b128 v[60:63], v0 offset:33792
    s_waitcnt lgkmcnt(3)
    v_mfma_f32_32x32x16_bf16 v[88:103], a[120:123], v[80:83], v[88:103]
    ds_read_b128 v[64:67], v0 offset:34816
    s_waitcnt lgkmcnt(3)
    v_mfma_f32_32x32x16_bf16 v[88:103], a[124:127], v[84:87], v[88:103]
    ds_read_b128 v[68:71], v0 offset:35840
    s_waitcnt lgkmcnt(3)
    v_mfma_f32_32x32x16_bf16 v[88:103], a[128:131], v[56:59], v[88:103]
    ds_read_b128 v[72:75], v0 offset:36864
    s_waitcnt lgkmcnt(3)
    v_mfma_f32_32x32x16_bf16 v[88:103], a[132:135], v[60:63], v[88:103]
    ds_read_b128 v[76:79], v0 offset:37888
    s_waitcnt lgkmcnt(3)
    v_mfma_f32_32x32x16_bf16 v[88:103], a[136:139], v[64:67], v[88:103]
    ds_read_b128 v[80:83], v0 offset:38912
    s_waitcnt lgkmcnt(3)
    v_mfma_f32_32x32x16_bf16 v[88:103], a[140:143], v[68:71], v[88:103]
    ds_read_b128 v[84:87], v0 offset:39936
    s_waitcnt lgkmcnt(3)
    v_mfma_f32_32x32x16_bf16 v[88:103], a[144:147], v[72:75], v[88:103]
    s_waitcnt lgkmcnt(2)
    v_mfma_f32_32x32x16_bf16 v[88:103], a[148:151], v[76:79], v[88:103]
    s_waitcnt vmcnt(10)
    s_barrier
    s_waitcnt lgkmcnt(1)
    v_mfma_f32_32x32x16_bf16 v[88:103], a[152:155], v[80:83], v[88:103]
    s_waitcnt lgkmcnt(0)
    v_mfma_f32_32x32x16_bf16 v[88:103], a[156:159], v[84:87], v[88:103]
    s_mul_i32 s55, s44, s58
    s_add_u32 s55, s55, s51
    s_xor_b32 s35, s44, s31
    s_and_b32 s35, s35, s74
    s_lshl_b32 s35, s35, 12
    s_add_u32 s55, s55, s35
    s_add_u32 s35, s55, s59
    s_add_u32 s49, s45, s61
    s_mov_b32 s44, s45
    s_nop 2
    v_pk_fma_f32 v[88:89], v[106:107], v[116:117], v[88:89] op_sel_hi:[0,1,1] neg_lo:[1,0,0] neg_hi:[1,0,0]
    s_nop 0
    v_pk_mul_f32 v[88:89], v[88:89], v[106:107] op_sel:[0,1]
    v_pk_fma_f32 v[90:91], v[106:107], v[118:119], v[90:91] op_sel_hi:[0,1,1] neg_lo:[1,0,0] neg_hi:[1,0,0]
    s_nop 0
    v_pk_mul_f32 v[90:91], v[90:91], v[106:107] op_sel:[0,1]
    v_pk_fma_f32 v[92:93], v[106:107], v[120:121], v[92:93] op_sel_hi:[0,1,1] neg_lo:[1,0,0] neg_hi:[1,0,0]
    s_nop 0
    v_pk_mul_f32 v[92:93], v[92:93], v[106:107] op_sel:[0,1]
    v_pk_fma_f32 v[94:95], v[106:107], v[122:123], v[94:95] op_sel_hi:[0,1,1] neg_lo:[1,0,0] neg_hi:[1,0,0]
    s_nop 0
    v_pk_mul_f32 v[94:95], v[94:95], v[106:107] op_sel:[0,1]
    v_pk_fma_f32 v[96:97], v[106:107], v[124:125], v[96:97] op_sel_hi:[0,1,1] neg_lo:[1,0,0] neg_hi:[1,0,0]
    s_nop 0
    v_pk_mul_f32 v[96:97], v[96:97], v[106:107] op_sel:[0,1]
    v_pk_fma_f32 v[98:99], v[106:107], v[126:127], v[98:99] op_sel_hi:[0,1,1] neg_lo:[1,0,0] neg_hi:[1,0,0]
    s_nop 0
    v_pk_mul_f32 v[98:99], v[98:99], v[106:107] op_sel:[0,1]
    v_pk_fma_f32 v[100:101], v[106:107], v[128:129], v[100:101] op_sel_hi:[0,1,1] neg_lo:[1,0,0] neg_hi:[1,0,0]
    s_nop 0
    v_pk_mul_f32 v[100:101], v[100:101], v[106:107] op_sel:[0,1]
    v_pk_fma_f32 v[102:103], v[106:107], v[130:131], v[102:103] op_sel_hi:[0,1,1] neg_lo:[1,0,0] neg_hi:[1,0,0]
    s_nop 0
    v_pk_mul_f32 v[102:103], v[102:103], v[106:107] op_sel:[0,1]
    v_cvt_pk_bf16_f32 v164, v88, v89
    v_cvt_pk_bf16_f32 v165, v90, v91
    v_cvt_pk_bf16_f32 v166, v92, v93
    v_cvt_pk_bf16_f32 v167, v94, v95
    v_cvt_pk_bf16_f32 v168, v96, v97
    v_cvt_pk_bf16_f32 v169, v98, v99
    v_cvt_pk_bf16_f32 v170, v100, v101
    v_cvt_pk_bf16_f32 v171, v102, v103
    buffer_store_dwordx4 v[164:167], v5, s[4:7], s55 offen sc1
    buffer_store_dwordx4 v[168:171], v5, s[4:7], s35 offen sc1
    s_mov_b64 exec, 1
    buffer_store_dword v172, off, s[4:7], s53 sc1
    s_mov_b64 exec, -1
    s_cmp_lt_u32 s44, s46
    s_cbranch_scc0 G1_292
    v_mov_b64 v[104:105], 0
    s_mov_b32 s34, 0x3f803f80
    s_waitcnt vmcnt(11)
    ds_read_b128 v[16:19], v2 offset:40960
    ds_read_b128 v[20:23], v2 offset:41984
    s_waitcnt vmcnt(9)
    ds_read_b128 v[24:27], v2 offset:43008
    ds_read_b128 v[28:31], v2 offset:44032
    s_waitcnt vmcnt(7)
    ds_read_b128 v[32:35], v2 offset:45056
    ds_read_b128 v[36:39], v2 offset:46080
    s_waitcnt lgkmcnt(5)
    v_dot2c_f32_bf16 v104, s34, v16
    v_dot2c_f32_bf16 v105, v16, v16
    v_dot2c_f32_bf16 v104, s34, v17
    v_dot2c_f32_bf16 v105, v17, v17
    v_dot2c_f32_bf16 v104, s34, v18
    v_dot2c_f32_bf16 v105, v18, v18
    v_dot2c_f32_bf16 v104, s34, v19
    v_dot2c_f32_bf16 v105, v19, v19
    s_waitcnt lgkmcnt(4)
    v_dot2c_f32_bf16 v104, s34, v20
    v_dot2c_f32_bf16 v105, v20, v20
    v_dot2c_f32_bf16 v104, s34, v21
    v_dot2c_f32_bf16 v105, v21, v21
    v_dot2c_f32_bf16 v104, s34, v22
    v_dot2c_f32_bf16 v105, v22, v22
    v_dot2c_f32_bf16 v104, s34, v23
    v_dot2c_f32_bf16 v105, v23, v23
    s_waitcnt vmcnt(5)
    ds_read_b128 v[40:43], v2 offset:47104
    ds_read_b128 v[44:47], v2 offset:48128
    s_waitcnt lgkmcnt(5)
    v_dot2c_f32_bf16 v104, s34, v24
    v_dot2c_f32_bf16 v105, v24, v24
    v_dot2c_f32_bf16 v104, s34, v25
    v_dot2c_f32_bf16 v105, v25, v25
    v_dot2c_f32_bf16 v104, s34, v26
    v_dot2c_f32_bf16 v105, v26, v26
    v_dot2c_f32_bf16 v104, s34, v27
    v_dot2c_f32_bf16 v105, v27, v27
    s_waitcnt lgkmcnt(4)
    v_dot2c_f32_bf16 v104, s34, v28
    v_dot2c_f32_bf16 v105, v28, v28
    v_dot2c_f32_bf16 v104, s34, v29
    v_dot2c_f32_bf16 v105, v29, v29
    v_dot2c_f32_bf16 v104, s34, v30
    v_dot2c_f32_bf16 v105, v30, v30
    v_dot2c_f32_bf16 v104, s34, v31
    v_dot2c_f32_bf16 v105, v31, v31
    s_waitcnt vmcnt(3)
    ds_read_b128 v[48:51], v2 offset:49152
    ds_read_b128 v[52:55], v2 offset:50176
    s_waitcnt lgkmcnt(5)
    v_dot2c_f32_bf16 v104, s34, v32
    v_dot2c_f32_bf16 v105, v32, v32
    v_dot2c_f32_bf16 v104, s34, v33
    v_dot2c_f32_bf16 v105, v33, v33
    v_dot2c_f32_bf16 v104, s34, v34
    v_dot2c_f32_bf16 v105, v34, v34
    v_dot2c_f32_bf16 v104, s34, v35
    v_dot2c_f32_bf16 v105, v35, v35
    s_waitcnt lgkmcnt(4)
    v_dot2c_f32_bf16 v104, s34, v36
    v_dot2c_f32_bf16 v105, v36, v36
    v_dot2c_f32_bf16 v104, s34, v37
    v_dot2c_f32_bf16 v105, v37, v37
    v_dot2c_f32_bf16 v104, s34, v38
    v_dot2c_f32_bf16 v105, v38, v38
    v_dot2c_f32_bf16 v104, s34, v39
    v_dot2c_f32_bf16 v105, v39, v39
    s_waitcnt lgkmcnt(3)
    v_dot2c_f32_bf16 v104, s34, v40
    v_dot2c_f32_bf16 v105, v40, v40
    v_dot2c_f32_bf16 v104, s34, v41
    v_dot2c_f32_bf16 v105, v41, v41
    v_dot2c_f32_bf16 v104, s34, v42
    v_dot2c_f32_bf16 v105, v42, v42
    v_dot2c_f32_bf16 v104, s34, v43
    v_dot2c_f32_bf16 v105, v43, v43
    s_waitcnt lgkmcnt(2)
    v_dot2c_f32_bf16 v104, s34, v44
    v_dot2c_f32_bf16 v105, v44, v44
    v_dot2c_f32_bf16 v104, s34, v45
    v_dot2c_f32_bf16 v105, v45, v45
    v_dot2c_f32_bf16 v104, s34, v46
    v_dot2c_f32_bf16 v105, v46, v46
    v_dot2c_f32_bf16 v104, s34, v47
    v_dot2c_f32_bf16 v105, v47, v47
    s_waitcnt lgkmcnt(1)
    v_dot2c_f32_bf16 v104, s34, v48
    v_dot2c_f32_bf16 v105, v48, v48
    v_dot2c_f32_bf16 v104, s34, v49
    v_dot2c_f32_bf16 v105, v49, v49
    v_dot2c_f32_bf16 v104, s34, v50
    v_dot2c_f32_bf16 v105, v50, v50
    v_dot2c_f32_bf16 v104, s34, v51
    v_dot2c_f32_bf16 v105, v51, v51
    s_waitcnt lgkmcnt(0)
    v_dot2c_f32_bf16 v104, s34, v52
    v_dot2c_f32_bf16 v105, v52, v52
    v_dot2c_f32_bf16 v104, s34, v53
    v_dot2c_f32_bf16 v105, v53, v53
    v_dot2c_f32_bf16 v104, s34, v54
    v_dot2c_f32_bf16 v105, v54, v54
    v_dot2c_f32_bf16 v104, s34, v55
    v_dot2c_f32_bf16 v105, v55, v55
    s_nop 2
    v_mov_b64 v[106:107], v[104:105]
    s_nop 1
    v_permlane32_swap_b32 v104, v106
    v_permlane32_swap_b32 v105, v107
    v_pk_add_f32 v[104:105], v[104:105], v[106:107]
    ds_write_b64 v3, v[104:105] offset:1024
    v_mov_b32 v172, s49
    s_cmp_lt_u32 s44, s47
    s_addc_u32 s45, s44, 1
    s_mul_i32 s54, s45, 40960
    s_add_u32 s56, s54, s52
    s_add_u32 s54, s54, s50
    s_cmp_lt_u32 s45, s46
    s_cselect_b32 s54, s54, 0x40000000
    s_cmp_lt_u32 s44, 5
    s_cbranch_scc0 G1e_307
    s_waitcnt vmcnt(0) lgkmcnt(0)
    s_barrier
    s_mov_b64 exec, 1
    buffer_store_dword v172, off, s[4:7], s53 sc1
    s_mov_b64 exec, -1
    s_branch G1e_308
G1e_307:
    s_waitcnt lgkmcnt(0)
    s_barrier
G1e_308:
    ds_read_b128 v[56:59], v0 offset:40960
    ds_read_b128 v[60:63], v0 offset:41984
    ds_read_b128 v[64:67], v0 offset:43008
    ds_read_b128 v[68:71], v0 offset:44032
    ds_read_b128 v[106:109], v4 offset:1024
    ds_read_b128 v[110:113], v4 offset:1040
    s_waitcnt lgkmcnt(5)
    v_mfma_f32_32x32x16_bf16 v[88:103], a[0:3], v[56:59], 0
    ds_read_b128 v[72:75], v0 offset:45056
    s_waitcnt lgkmcnt(5)
    v_mfma_f32_32x32x16_bf16 v[88:103], a[4:7], v[60:63], v[88:103]
    ds_read_b128 v[76:79], v0 offset:46080
    s_add_u32 m0, s52, 0
    s_add_u32 s35, s54, 0
    buffer_load_dwordx4 v0, s[4:7], s35 offen offset:0 sc1 lds
    s_waitcnt lgkmcnt(5)
    v_mfma_f32_32x32x16_bf16 v[88:103], a[8:11], v[64:67], v[88:103]
    ds_read_b128 v[80:83], v0 offset:47104
    s_waitcnt lgkmcnt(5)
    v_mfma_f32_32x32x16_bf16 v[88:103], a[12:15], v[68:71], v[88:103]
    ds_read_b128 v[84:87], v0 offset:48128
    buffer_load_dwordx4 v0, s[4:7], s35 offen offset:1024 sc1 lds
    s_waitcnt lgkmcnt(3)
    v_mfma_f32_32x32x16_bf16 v[88:103], a[16:19], v[72:75], v[88:103]
    ds_read_b128 v[56:59], v0 offset:49152
    s_waitcnt lgkmcnt(3)
    v_mfma_f32_32x32x16_bf16 v[88:103], a[20:23], v[76:79], v[88:103]
    ds_read_b128 v[60:63], v0 offset:50176
    buffer_load_dwordx4 v0, s[4:7], s35 offen offset:2048 sc1 lds
    s_waitcnt lgkmcnt(3)
    v_mfma_f32_32x32x16_bf16 v[88:103], a[24:27], v[80:83], v[88:103]
    ds_read_b128 v[64:67], v0 offset:51200
    s_waitcnt lgkmcnt(3)
    v_mfma_f32_32x32x16_bf16 v[88:103], a[28:31], v[84:87], v[88:103]
    ds_read_b128 v[68:71], v0 offset:52224
    buffer_load_dwordx4 v0, s[4:7], s35 offen offset:3072 sc1 lds
    s_waitcnt lgkmcnt(3)
    v_mfma_f32_32x32x16_bf16 v[88:103], a[32:35], v[56:59], v[88:103]
    ds_read_b128 v[72:75], v0 offset:53248
    s_waitcnt lgkmcnt(3)
    v_mfma_f32_32x32x16_bf16 v[88:103], a[36:39], v[60:63], v[88:103]
    ds_read_b128 v[76:79], v0 offset:54272
    s_add_u32 m0, s52, 4096
    s_add_u32 s35, s54, 4096
    buffer_load_dwordx4 v0, s[4:7], s35 offen offset:0 sc1 lds
    s_waitcnt lgkmcnt(3)
    v_mfma_f32_32x32x16_bf16 v[88:103], a[40:43], v[64:67], v[88:103]
    ds_read_b128 v[80:83], v0 offset:55296
    s_waitcnt lgkmcnt(3)
    v_mfma_f32_32x32x16_bf16 v[88:103], a[44:47], v[68:71], v[88:103]
    ds_read_b128 v[84:87], v0 offset:56320
    buffer_load_dwordx4 v0, s[4:7], s35 offen offset:1024 sc1 lds
    s_waitcnt lgkmcnt(3)
    v_mfma_f32_32x32x16_bf16 v[88:103], a[48:51], v[72:75], v[88:103]
    ds_read_b128 v[56:59], v0 offset:57344
    s_waitcnt lgkmcnt(3)
    v_mfma_f32_32x32x16_bf16 v[88:103], a[52:55], v[76:79], v[88:103]
    ds_read_b128 v[60:63], v0 offset:58368
    buffer_load_dwordx4 v0, s[4:7], s35 offen offset:2048 sc1 lds
    s_waitcnt lgkmcnt(3)
    v_mfma_f32_32x32x16_bf16 v[88:103], a[56:59], v[80:83], v[88:103]
    ds_read_b128 v[64:67], v0 offset:59392
    s_waitcnt lgkmcnt(3)
    v_mfma_f32_32x32x16_bf16 v[88:103], a[60:63], v[84:87], v[88:103]
    ds_read_b128 v[68:71], v0 offset:60416
    buffer_load_dwordx4 v0, s[4:7], s35 offen offset:3072 sc1 lds
    s_waitcnt lgkmcnt(3)
    v_mfma_f32_32x32x16_bf16 v[88:103], a[64:67], v[56:59], v[88:103]
    ds_read_b128 v[72:75], v0 offset:61440
    s_waitcnt lgkmcnt(3)
    v_mfma_f32_32x32x16_bf16 v[88:103], a[68:71], v[60:63], v[88:103]
    ds_read_b128 v[76:79], v0 offset:62464
    s_add_u32 m0, s52, 8192
    s_add_u32 s35, s54, 8192
    buffer_load_dwordx4 v0, s[4:7], s35 offen offset:0 sc1 lds
    s_waitcnt lgkmcnt(3)
    v_mfma_f32_32x32x16_bf16 v[88:103], a[72:75], v[64:67], v[88:103]
    ds_read_b128 v[80:83], v0 offset:63488
    s_waitcnt lgkmcnt(3)
    v_mfma_f32_32x32x16_bf16 v[88:103], a[76:79], v[68:71], v[88:103]
    ds_read_b128 v[84:87], v0 offset:64512
    buffer_load_dwordx4 v0, s[4:7], s35 offen offset:1024 sc1 lds
    s_waitcnt lgkmcnt(3)
    v_mfma_f32_32x32x16_bf16 v[88:103], a[80:83], v[72:75], v[88:103]
    ds_read_b128 v[56:59], v8 offset:0
    v_add_f32 v106, v106, v108
    v_add_f32 v107, v107, v109
    s_waitcnt lgkmcnt(3)
    v_mfma_f32_32x32x16_bf16 v[88:103], a[84:87], v[76:79], v[88:103]
    ds_read_b128 v[60:63], v8 offset:1024
    v_add_f32 v106, v106, v110
    v_add_f32 v107, v107, v111
    s_waitcnt lgkmcnt(3)
    v_mfma_f32_32x32x16_bf16 v[88:103], a[88:91], v[80:83], v[88:103]
    ds_read_b128 v[64:67], v8 offset:2048
    v_add_f32 v106, v106, v112
    v_add_f32 v107, v107, v113
    s_waitcnt lgkmcnt(3)
    v_mfma_f32_32x32x16_bf16 v[88:103], a[92:95], v[84:87], v[88:103]
    ds_read_b128 v[68:71], v8 offset:3072
    v_mul_f32 v106, 0x3acccccd, v106
    v_mul_f32 v107, 0x3acccccd, v107
    s_waitcnt lgkmcnt(3)
    v_mfma_f32_32x32x16_bf16 v[88:103], a[96:99], v[56:59], v[88:103]
    ds_read_b128 v[72:75], v8 offset:4096
    v_fma_f32 v107, -v106, v106, v107
    v_max_f32 v107, 0, v107
    s_waitcnt lgkmcnt(3)
    v_mfma_f32_32x32x16_bf16 v[88:103], a[100:103], v[60:63], v[88:103]
    ds_read_b128 v[76:79], v8 offset:5120
    v_add_f32 v107, 0x3727c5ac, v107
    v_rsq_f32 v107, v107
    s_waitcnt lgkmcnt(3)
    v_mfma_f32_32x32x16_bf16 v[88:103], a[104:107], v[64:67], v[88:103]
    ds_read_b128 v[80:83], v8 offset:6144
    s_waitcnt lgkmcnt(3)
    v_mfma_f32_32x32x16_bf16 v[88:103], a[108:111], v[68:71], v[88:103]
    ds_read_b128 v[84:87], v8 offset:7168
    s_waitcnt lgkmcnt(3)
    v_mfma_f32_32x32x16_bf16 v[88:103], a[112:115], v[72:75], v[88:103]
    ds_read_b128 v[56:59], v8 offset:8192
    s_waitcnt lgkmcnt(3)
    v_mfma_f32_32x32x16_bf16 v[88:103], a[116:119], v[76:79], v[88:103]
    ds_read_b128 v[60:63], v8 offset:9216
    s_waitcnt lgkmcnt(3)
    v_mfma_f32_32x32x16_bf16 v[88:103], a[120:123], v[80:83], v[88:103]
    ds_read_b128 v[64:67], v8 offset:10240
    s_waitcnt lgkmcnt(3)
    v_mfma_f32_32x32x16_bf16 v[88:103], a[124:127], v[84:87], v[88:103]
    ds_read_b128 v[68:71], v8 offset:11264
    s_waitcnt lgkmcnt(3)
    v_mfma_f32_32x32x16_bf16 v[88:103], a[128:131], v[56:59], v[88:103]
    ds_read_b128 v[72:75], v8 offset:12288
    s_waitcnt lgkmcnt(3)
    v_mfma_f32_32x32x16_bf16 v[88:103], a[132:135], v[60:63], v[88:103]
    ds_read_b128 v[76:79], v8 offset:13312
    s_waitcnt lgkmcnt(3)
    v_mfma_f32_32x32x16_bf16 v[88:103], a[136:139], v[64:67], v[88:103]
    ds_read_b128 v[80:83], v8 offset:14336
    s_waitcnt lgkmcnt(3)
    v_mfma_f32_32x32x16_bf16 v[88:103], a[140:143], v[68:71], v[88:103]
    ds_read_b128 v[84:87], v8 offset:15360
    s_waitcnt lgkmcnt(3)
    v_mfma_f32_32x32x16_bf16 v[88:103], a[144:147], v[72:75], v[88:103]
    s_waitcnt lgkmcnt(2)
    v_mfma_f32_32x32x16_bf16 v[88:103], a[148:151], v[76:79], v[88:103]
    s_waitcnt vmcnt(10)
    s_barrier
    s_waitcnt lgkmcnt(1)
    v_mfma_f32_32x32x16_bf16 v[88:103], a[152:155], v[80:83], v[88:103]
    s_waitcnt lgkmcnt(0)
    v_mfma_f32_32x32x16_bf16 v[88:103], a[156:159], v[84:87], v[88:103]
    s_mul_i32 s55, s44, s58
    s_add_u32 s55, s55, s51
    s_xor_b32 s35, s44, s31
    s_and_b32 s35, s35, s74
    s_lshl_b32 s35, s35, 12
    s_add_u32 s55, s55, s35
    s_add_u32 s35, s55, s59
    s_add_u32 s49, s45, s61
    s_mov_b32 s44, s45
    s_nop 2
    v_pk_fma_f32 v[88:89], v[106:107], v[116:117], v[88:89] op_sel_hi:[0,1,1] neg_lo:[1,0,0] neg_hi:[1,0,0]
    s_nop 0
    v_pk_mul_f32 v[88:89], v[88:89], v[106:107] op_sel:[0,1]
    v_pk_fma_f32 v[90:91], v[106:107], v[118:119], v[90:91] op_sel_hi:[0,1,1] neg_lo:[1,0,0] neg_hi:[1,0,0]
    s_nop 0
    v_pk_mul_f32 v[90:91], v[90:91], v[106:107] op_sel:[0,1]
    v_pk_fma_f32 v[92:93], v[106:107], v[120:121], v[92:93] op_sel_hi:[0,1,1] neg_lo:[1,0,0] neg_hi:[1,0,0]
    s_nop 0
    v_pk_mul_f32 v[92:93], v[92:93], v[106:107] op_sel:[0,1]
    v_pk_fma_f32 v[94:95], v[106:107], v[122:123], v[94:95] op_sel_hi:[0,1,1] neg_lo:[1,0,0] neg_hi:[1,0,0]
    s_nop 0
    v_pk_mul_f32 v[94:95], v[94:95], v[106:107] op_sel:[0,1]
    v_pk_fma_f32 v[96:97], v[106:107], v[124:125], v[96:97] op_sel_hi:[0,1,1] neg_lo:[1,0,0] neg_hi:[1,0,0]
    s_nop 0
    v_pk_mul_f32 v[96:97], v[96:97], v[106:107] op_sel:[0,1]
    v_pk_fma_f32 v[98:99], v[106:107], v[126:127], v[98:99] op_sel_hi:[0,1,1] neg_lo:[1,0,0] neg_hi:[1,0,0]
    s_nop 0
    v_pk_mul_f32 v[98:99], v[98:99], v[106:107] op_sel:[0,1]
    v_pk_fma_f32 v[100:101], v[106:107], v[128:129], v[100:101] op_sel_hi:[0,1,1] neg_lo:[1,0,0] neg_hi:[1,0,0]
    s_nop 0
    v_pk_mul_f32 v[100:101], v[100:101], v[106:107] op_sel:[0,1]
    v_pk_fma_f32 v[102:103], v[106:107], v[130:131], v[102:103] op_sel_hi:[0,1,1] neg_lo:[1,0,0] neg_hi:[1,0,0]
    s_nop 0
    v_pk_mul_f32 v[102:103], v[102:103], v[106:107] op_sel:[0,1]
    v_cvt_pk_bf16_f32 v164, v88, v89
    v_cvt_pk_bf16_f32 v165, v90, v91
    v_cvt_pk_bf16_f32 v166, v92, v93
    v_cvt_pk_bf16_f32 v167, v94, v95
    v_cvt_pk_bf16_f32 v168, v96, v97
    v_cvt_pk_bf16_f32 v169, v98, v99
    v_cvt_pk_bf16_f32 v170, v100, v101
    v_cvt_pk_bf16_f32 v171, v102, v103
    buffer_store_dwordx4 v[164:167], v5, s[4:7], s55 offen sc1
    buffer_store_dwordx4 v[168:171], v5, s[4:7], s35 offen sc1
    s_mov_b64 exec, 1
    buffer_store_dword v172, off, s[4:7], s53 sc1
    s_mov_b64 exec, -1
    s_cmp_lt_u32 s44, s46
    s_cbranch_scc1 G1_304
G1_292:
    s_add_u32 s34, s61, 64
    s_cmp_ge_u32 s28, 128
    s_cselect_b32 s49, s34, s49
    v_mov_b32 v176, s49
    s_waitcnt vmcnt(0)
    s_barrier
    buffer_store_dword v176, off, s[4:7], s53 sc1
    s_waitcnt vmcnt(0) lgkmcnt(0)
    s_cmp_ge_u32 s28, 128
    s_cbranch_scc1 LAYER_270
    s_cmp_lg_u32 s68, 0
    s_cbranch_scc1 LAYER_269
    s_mov_b32 s68, 18
    s_mov_b32 s46, 64
    s_add_u32 s57, s57, 1
    s_branch LAYER_271
LAYER_270:
    s_cmp_lt_u32 s28, 130
    s_cbranch_scc1 R_309
    s_cmp_ge_u32 s28, 190
    s_cbranch_scc1 R_309
    s_add_u32 s44, s66, 6
    s_mov_b32 s47, 6
    s_mov_b32 s46, 64
    s_mul_i32 s50, s30, 3145728
    s_add_u32 s50, s50, 27262976
    s_mul_i32 s34, s29, 10240
    s_add_u32 s50, s50, s34
    s_mul_i32 s51, s30, 6291456
    s_add_u32 s51, s51, 11534336
    s_lshl_b32 s34, s67, 12
    s_add_u32 s51, s51, s34
    s_add_u32 s52, s34, 14680064
    s_mov_b32 s58, 40960
    v_bfe_u32 v2, v1, 5, 1
    v_mul_u32_u24 v2, 512, v2
    v_bfe_u32 v172, v1, 2, 2
    v_lshl_add_u32 v2, v172, 6, v2
    v_bfe_u32 v172, v1, 4, 1
    v_lshl_add_u32 v2, v172, 5, v2
    v_bfe_u32 v172, v1, 0, 1
    v_lshl_add_u32 v2, v172, 4, v2
    v_bfe_u32 v172, v1, 1, 1
    v_lshl_add_u32 v2, v172, 3, v2
    v_add_u32 v2, s60, v2
    s_lshl_b32 s34, s29, 13
    v_add_u32 v4, s34, v0
    s_lshl_b32 s34, s29, 3
    s_add_u32 s34, s34, 65536
    v_bfe_u32 v5, v1, 0, 5
    v_mul_u32_u24 v5, 32, v5
    v_add_u32 v5, s34, v5
    s_lshl_b32 s35, s29, 11
    s_lshl_b32 s36, s29, 8
    s_add_u32 s36, s36, 67584
    v_add_u32 v3, s35, v0
    s_lshl_b32 s34, s29, 10
    v_add_u32 v7, s34, v0
    v_bfe_u32 v6, v1, 0, 5
    v_mul_u32_u24 v6, 32, v6
    v_add_u32 v6, 65536, v6
    s_lshl_b32 s34, s29, 5
    v_bfe_u32 v8, v1, 0, 2
    v_mul_u32_u24 v8, 1280, v8
    v_bfe_u32 v172, v1, 2, 1
    v_mul_u32_u24 v172, 10240, v172
    v_add_u32 v8, v8, v172
    v_bfe_u32 v172, v1, 3, 1
    v_mul_u32_u24 v172, 5120, v172
    v_add_u32 v8, v8, v172
    v_bfe_u32 v172, v1, 4, 1
    v_mul_u32_u24 v172, 20480, v172
    v_add_u32 v8, v8, v172
    v_bfe_u32 v172, v1, 5, 1
    v_lshl_add_u32 v8, v172, 4, v8
    v_add_u32 v8, s34, v8
    s_cmp_lg_u32 s30, 0
    s_cbranch_scc1 F3_310
    s_lshl_b32 s52, s67, 7
    s_load_dwordx2 s[16:17], s[0:1], 0
    s_mov_b32 s18, 2621440
    s_mov_b32 s19, 0x20000
    s_waitcnt lgkmcnt(0)
    s_branch F3_311
F3_310:
    v_mov_b32 v8, v7
    s_load_dwordx2 s[16:17], s[0:1], 96
    s_mov_b32 s18, 268435456
    s_mov_b32 s19, 0x20000
    s_waitcnt lgkmcnt(0)
F3_311:
    s_mul_i32 s54, s44, 40960
    s_add_u32 s56, s54, s52
    s_add_u32 s54, s54, s50
    s_waitcnt vmcnt(0) lgkmcnt(0)
    s_add_u32 m0, s60, 0
    s_nop 0
    buffer_load_dwordx4 v0, s[4:7], s54 offen offset:0 sc1 lds
    buffer_load_dwordx4 v0, s[4:7], s54 offen offset:1024 sc1 lds
    buffer_load_dwordx4 v0, s[4:7], s54 offen offset:2048 sc1 lds
    buffer_load_dwordx4 v0, s[4:7], s54 offen offset:3072 sc1 lds
    s_add_u32 s54, s54, 4096
    s_add_u32 m0, s60, 4096
    s_nop 0
    buffer_load_dwordx4 v0, s[4:7], s54 offen offset:0 sc1 lds
    buffer_load_dwordx4 v0, s[4:7], s54 offen offset:1024 sc1 lds
    buffer_load_dwordx4 v0, s[4:7], s54 offen offset:2048 sc1 lds
    buffer_load_dwordx4 v0, s[4:7], s54 offen offset:3072 sc1 lds
    s_add_u32 s54, s54, 4096
    s_add_u32 m0, s60, 8192
    s_nop 0
    buffer_load_dwordx4 v0, s[4:7], s54 offen offset:0 sc1 lds
    buffer_load_dwordx4 v0, s[4:7], s54 offen offset:1024 sc1 lds
    buffer_load_dwordx4 v[164:167], v8, s[16:19], s56 offen sc1
    s_add_u32 s45, s44, s47
    s_mul_i32 s54, s45, 40960
    s_add_u32 s56, s54, s52
    s_add_u32 s54, s54, s50
    s_waitcnt vmcnt(0)
    ds_read_b64_tr_b16 v[16:17], v2 offset:0
    ds_read_b64_tr_b16 v[18:19], v2 offset:256
    ds_read_b64_tr_b16 v[20:21], v2 offset:1024
    ds_read_b64_tr_b16 v[22:23], v2 offset:1280
    ds_read_b64_tr_b16 v[24:25], v2 offset:2048
    ds_read_b64_tr_b16 v[26:27], v2 offset:2304
    ds_read_b64_tr_b16 v[28:29], v2 offset:3072
    ds_read_b64_tr_b16 v[30:31], v2 offset:3328
    ds_read_b64_tr_b16 v[32:33], v2 offset:4096
    ds_read_b64_tr_b16 v[34:35], v2 offset:4352
    ds_read_b64_tr_b16 v[36:37], v2 offset:5120
    ds_read_b64_tr_b16 v[38:39], v2 offset:5376
    ds_read_b64_tr_b16 v[40:41], v2 offset:6144
    ds_read_b64_tr_b16 v[42:43], v2 offset:6400
    ds_read_b64_tr_b16 v[44:45], v2 offset:7168
    ds_read_b64_tr_b16 v[46:47], v2 offset:7424
    ds_read_b64_tr_b16 v[48:49], v2 offset:8192
    ds_read_b64_tr_b16 v[50:51], v2 offset:8448
    ds_read_b64_tr_b16 v[52:53], v2 offset:9216
    ds_read_b64_tr_b16 v[54:55], v2 offset:9472
    s_waitcnt lgkmcnt(15)
    v_mfma_f32_32x32x16_bf16 v[96:111], a[160:163], v[16:19], 0
    v_mfma_f32_32x32x16_bf16 v[96:111], a[164:167], v[20:23], v[96:111]
    s_waitcnt lgkmcnt(14)
    v_mfma_f32_32x32x16_bf16 v[96:111], a[168:171], v[24:27], v[96:111]
    s_waitcnt lgkmcnt(12)
    v_mfma_f32_32x32x16_bf16 v[96:111], a[172:175], v[28:31], v[96:111]
    s_waitcnt lgkmcnt(10)
    v_mfma_f32_32x32x16_bf16 v[96:111], a[176:179], v[32:35], v[96:111]
    s_waitcnt lgkmcnt(8)
    v_mfma_f32_32x32x16_bf16 v[96:111], a[180:183], v[36:39], v[96:111]
    s_waitcnt lgkmcnt(6)
    v_mfma_f32_32x32x16_bf16 v[96:111], a[184:187], v[40:43], v[96:111]
    s_waitcnt lgkmcnt(4)
    v_mfma_f32_32x32x16_bf16 v[96:111], a[188:191], v[44:47], v[96:111]
    s_waitcnt lgkmcnt(2)
    v_mfma_f32_32x32x16_bf16 v[96:111], a[192:195], v[48:51], v[96:111]
    s_add_u32 m0, s60, 10240
    s_nop 0
    buffer_load_dwordx4 v0, s[4:7], s54 offen offset:0 sc1 lds
    s_waitcnt lgkmcnt(0)
    v_mfma_f32_32x32x16_bf16 v[96:111], a[196:199], v[52:55], v[96:111]
    buffer_load_dwordx4 v0, s[4:7], s54 offen offset:1024 sc1 lds
    v_mfma_f32_32x32x16_bf16 v[112:127], a[200:203], v[16:19], 0
    buffer_load_dwordx4 v0, s[4:7], s54 offen offset:2048 sc1 lds
    v_mfma_f32_32x32x16_bf16 v[112:127], a[204:207], v[20:23], v[112:127]
    buffer_load_dwordx4 v0, s[4:7], s54 offen offset:3072 sc1 lds
    v_mfma_f32_32x32x16_bf16 v[112:127], a[208:211], v[24:27], v[112:127]
    s_add_u32 s54, s54, 4096
    s_add_u32 m0, s60, 14336
    s_nop 0
    buffer_load_dwordx4 v0, s[4:7], s54 offen offset:0 sc1 lds
    v_mfma_f32_32x32x16_bf16 v[112:127], a[212:215], v[28:31], v[112:127]
    buffer_load_dwordx4 v0, s[4:7], s54 offen offset:1024 sc1 lds
    v_mfma_f32_32x32x16_bf16 v[112:127], a[216:219], v[32:35], v[112:127]
    buffer_load_dwordx4 v0, s[4:7], s54 offen offset:2048 sc1 lds
    v_mfma_f32_32x32x16_bf16 v[112:127], a[220:223], v[36:39], v[112:127]
    buffer_load_dwordx4 v0, s[4:7], s54 offen offset:3072 sc1 lds
    v_mfma_f32_32x32x16_bf16 v[112:127], a[224:227], v[40:43], v[112:127]
    s_add_u32 s54, s54, 4096
    s_add_u32 m0, s60, 18432
    s_nop 0
    buffer_load_dwordx4 v0, s[4:7], s54 offen offset:0 sc1 lds
    ds_write_b128 v4, v[96:99] offset:0
    v_mfma_f32_32x32x16_bf16 v[112:127], a[228:231], v[44:47], v[112:127]
    buffer_load_dwordx4 v0, s[4:7], s54 offen offset:1024 sc1 lds
    ds_write_b128 v4, v[100:103] offset:1024
    v_mfma_f32_32x32x16_bf16 v[112:127], a[232:235], v[48:51], v[112:127]
    ds_write_b128 v4, v[104:107] offset:2048
    v_mfma_f32_32x32x16_bf16 v[112:127], a[236:239], v[52:55], v[112:127]
    ds_write_b128 v4, v[108:111] offset:3072
    s_mov_b32 s59, 1073741824
    s_mul_i32 s55, s44, s58
    s_add_u32 s55, s55, s51
    buffer_load_dwordx4 v[168:171], v8, s[16:19], s56 offen sc1
G_312:
    s_mov_b32 s44, s45
    s_add_u32 s45, s44, s47
    s_cmp_lt_u32 s45, s46
    s_cbranch_scc0 G_315
    s_mul_i32 s54, s45, 40960
    s_add_u32 s56, s54, s52
    s_add_u32 s54, s54, s50
    s_waitcnt vmcnt(0)
    ds_read_b64_tr_b16 v[56:57], v2 offset:10240
    ds_read_b64_tr_b16 v[58:59], v2 offset:10496
    ds_read_b64_tr_b16 v[60:61], v2 offset:11264
    ds_read_b64_tr_b16 v[62:63], v2 offset:11520
    ds_read_b64_tr_b16 v[64:65], v2 offset:12288
    ds_read_b64_tr_b16 v[66:67], v2 offset:12544
    ds_read_b64_tr_b16 v[68:69], v2 offset:13312
    ds_read_b64_tr_b16 v[70:71], v2 offset:13568
    ds_read_b64_tr_b16 v[72:73], v2 offset:14336
    ds_read_b64_tr_b16 v[74:75], v2 offset:14592
    ds_read_b64_tr_b16 v[76:77], v2 offset:15360
    ds_read_b64_tr_b16 v[78:79], v2 offset:15616
    ds_read_b64_tr_b16 v[80:81], v2 offset:16384
    ds_read_b64_tr_b16 v[82:83], v2 offset:16640
    ds_read_b64_tr_b16 v[84:85], v2 offset:17408
    ds_read_b64_tr_b16 v[86:87], v2 offset:17664
    ds_read_b64_tr_b16 v[88:89], v2 offset:18432
    ds_read_b64_tr_b16 v[90:91], v2 offset:18688
    ds_read_b64_tr_b16 v[92:93], v2 offset:19456
    ds_read_b64_tr_b16 v[94:95], v2 offset:19712
    s_waitcnt lgkmcnt(15)
    v_mfma_f32_32x32x16_bf16 v[96:111], a[160:163], v[56:59], 0
    ds_write_b128 v4, v[112:115] offset:4096
    v_mfma_f32_32x32x16_bf16 v[96:111], a[164:167], v[60:63], v[96:111]
    ds_write_b128 v4, v[116:119] offset:5120
    s_waitcnt lgkmcnt(15)
    v_mfma_f32_32x32x16_bf16 v[96:111], a[168:171], v[64:67], v[96:111]
    ds_write_b128 v4, v[120:123] offset:6144
    s_waitcnt lgkmcnt(15)
    v_mfma_f32_32x32x16_bf16 v[96:111], a[172:175], v[68:71], v[96:111]
    ds_write_b128 v4, v[124:127] offset:7168
    s_waitcnt lgkmcnt(14)
    v_mfma_f32_32x32x16_bf16 v[96:111], a[176:179], v[72:75], v[96:111]
    s_waitcnt lgkmcnt(12)
    v_mfma_f32_32x32x16_bf16 v[96:111], a[180:183], v[76:79], v[96:111]
    s_waitcnt lgkmcnt(0)
    s_barrier
    buffer_store_dwordx4 v[172:175], v7, s[4:7], s59 offen sc1
    v_mfma_f32_32x32x16_bf16 v[96:111], a[184:187], v[80:83], v[96:111]
    ds_read_b128 v[184:187], v3 offset:0
    ds_read_b128 v[188:191], v3 offset:1024
    ds_read_b128 v[192:195], v3 offset:8192
    ds_read_b128 v[196:199], v3 offset:9216
    v_mfma_f32_32x32x16_bf16 v[96:111], a[188:191], v[84:87], v[96:111]
    ds_read_b128 v[200:203], v3 offset:16384
    ds_read_b128 v[204:207], v3 offset:17408
    ds_read_b128 v[208:211], v3 offset:24576
    ds_read_b128 v[212:215], v3 offset:25600
    v_mfma_f32_32x32x16_bf16 v[96:111], a[192:195], v[88:91], v[96:111]
    s_add_u32 m0, s60, 0
    s_nop 0
    buffer_load_dwordx4 v0, s[4:7], s54 offen offset:0 sc1 lds
    v_mfma_f32_32x32x16_bf16 v[96:111], a[196:199], v[92:95], v[96:111]
    buffer_load_dwordx4 v0, s[4:7], s54 offen offset:1024 sc1 lds
    v_mfma_f32_32x32x16_bf16 v[112:127], a[200:203], v[56:59], 0
    buffer_load_dwordx4 v0, s[4:7], s54 offen offset:2048 sc1 lds
    s_waitcnt lgkmcnt(5)
    v_add_f32 v184, v184, v192
    v_add_f32 v185, v185, v193
    v_add_f32 v186, v186, v194
    v_add_f32 v187, v187, v195
    s_waitcnt lgkmcnt(4)
    v_add_f32 v188, v188, v196
    v_add_f32 v189, v189, v197
    v_mfma_f32_32x32x16_bf16 v[112:127], a[204:207], v[60:63], v[112:127]
    buffer_load_dwordx4 v0, s[4:7], s54 offen offset:3072 sc1 lds
    v_add_f32 v190, v190, v198
    v_add_f32 v191, v191, v199
    s_waitcnt lgkmcnt(3)
    v_add_f32 v184, v184, v200
    v_add_f32 v185, v185, v201
    v_add_f32 v186, v186, v202
    v_add_f32 v187, v187, v203
    v_mfma_f32_32x32x16_bf16 v[112:127], a[208:211], v[64:67], v[112:127]
    s_add_u32 s54, s54, 4096
    s_add_u32 m0, s60, 4096
    s_nop 0
    buffer_load_dwordx4 v0, s[4:7], s54 offen offset:0 sc1 lds
    s_waitcnt lgkmcnt(2)
    v_add_f32 v188, v188, v204
    v_add_f32 v189, v189, v205
    v_add_f32 v190, v190, v206
    v_add_f32 v191, v191, v207
    s_waitcnt lgkmcnt(1)
    v_add_f32 v184, v184, v208
    v_add_f32 v185, v185, v209
    v_mfma_f32_32x32x16_bf16 v[112:127], a[212:215], v[68:71], v[112:127]
    buffer_load_dwordx4 v0, s[4:7], s54 offen offset:1024 sc1 lds
    v_add_f32 v186, v186, v210
    v_add_f32 v187, v187, v211
    s_waitcnt lgkmcnt(0)
    v_add_f32 v188, v188, v212
    v_add_f32 v189, v189, v213
    v_add_f32 v190, v190, v214
    v_add_f32 v191, v191, v215
    v_mfma_f32_32x32x16_bf16 v[112:127], a[216:219], v[72:75], v[112:127]
    buffer_load_dwordx4 v0, s[4:7], s54 offen offset:2048 sc1 lds
    v_cvt_pk_bf16_f32 v172, v184, v185
    v_cvt_pk_bf16_f32 v173, v186, v187
    v_cvt_pk_bf16_f32 v174, v188, v189
    v_cvt_pk_bf16_f32 v175, v190, v191
    v_lshlrev_b32 v184, 16, v172
    v_lshlrev_b32 v185, 16, v164
    v_mfma_f32_32x32x16_bf16 v[112:127], a[220:223], v[76:79], v[112:127]
    buffer_load_dwordx4 v0, s[4:7], s54 offen offset:3072 sc1 lds
    v_and_b32 v186, 0xffff0000, v172
    v_and_b32 v187, 0xffff0000, v164
    v_add_f32 v184, v184, v185
    v_add_f32 v186, v186, v187
    v_cvt_pk_bf16_f32 v172, v184, v186
    v_lshlrev_b32 v184, 16, v173
    v_mfma_f32_32x32x16_bf16 v[112:127], a[224:227], v[80:83], v[112:127]
    s_add_u32 s54, s54, 4096
    s_add_u32 m0, s60, 8192
    s_nop 0
    buffer_load_dwordx4 v0, s[4:7], s54 offen offset:0 sc1 lds
    ds_write_b128 v4, v[96:99] offset:32768
    v_lshlrev_b32 v185, 16, v165
    v_and_b32 v186, 0xffff0000, v173
    v_and_b32 v187, 0xffff0000, v165
    v_add_f32 v184, v184, v185
    v_add_f32 v186, v186, v187
    v_cvt_pk_bf16_f32 v173, v184, v186
    v_mfma_f32_32x32x16_bf16 v[112:127], a[228:231], v[84:87], v[112:127]
    buffer_load_dwordx4 v0, s[4:7], s54 offen offset:1024 sc1 lds
    ds_write_b128 v4, v[100:103] offset:33792
    v_lshlrev_b32 v184, 16, v174
    v_lshlrev_b32 v185, 16, v166
    v_and_b32 v186, 0xffff0000, v174
    v_and_b32 v187, 0xffff0000, v166
    v_add_f32 v184, v184, v185
    v_add_f32 v186, v186, v187
    v_mfma_f32_32x32x16_bf16 v[112:127], a[232:235], v[88:91], v[112:127]
    ds_write_b128 v4, v[104:107] offset:34816
    v_cvt_pk_bf16_f32 v174, v184, v186
    v_lshlrev_b32 v184, 16, v175
    v_lshlrev_b32 v185, 16, v167
    v_and_b32 v186, 0xffff0000, v175
    v_and_b32 v187, 0xffff0000, v167
    v_add_f32 v184, v184, v185
    v_mfma_f32_32x32x16_bf16 v[112:127], a[236:239], v[92:95], v[112:127]
    ds_write_b128 v4, v[108:111] offset:35840
    v_add_f32 v186, v186, v187
    v_cvt_pk_bf16_f32 v175, v184, v186
    s_mov_b32 s59, s55
    s_mul_i32 s55, s44, s58
    s_add_u32 s55, s55, s51
    buffer_load_dwordx4 v[164:167], v8, s[16:19], s56 offen sc1
    s_mov_b32 s44, s45
    s_add_u32 s45, s44, s47
    s_cmp_lt_u32 s45, s46
    s_cbranch_scc0 G_314
    s_mul_i32 s54, s45, 40960
    s_add_u32 s56, s54, s52
    s_add_u32 s54, s54, s50
    s_waitcnt vmcnt(0)
    ds_read_b64_tr_b16 v[16:17], v2 offset:0
    ds_read_b64_tr_b16 v[18:19], v2 offset:256
    ds_read_b64_tr_b16 v[20:21], v2 offset:1024
    ds_read_b64_tr_b16 v[22:23], v2 offset:1280
    ds_read_b64_tr_b16 v[24:25], v2 offset:2048
    ds_read_b64_tr_b16 v[26:27], v2 offset:2304
    ds_read_b64_tr_b16 v[28:29], v2 offset:3072
    ds_read_b64_tr_b16 v[30:31], v2 offset:3328
    ds_read_b64_tr_b16 v[32:33], v2 offset:4096
    ds_read_b64_tr_b16 v[34:35], v2 offset:4352
    ds_read_b64_tr_b16 v[36:37], v2 offset:5120
    ds_read_b64_tr_b16 v[38:39], v2 offset:5376
    ds_read_b64_tr_b16 v[40:41], v2 offset:6144
    ds_read_b64_tr_b16 v[42:43], v2 offset:6400
    ds_read_b64_tr_b16 v[44:45], v2 offset:7168
    ds_read_b64_tr_b16 v[46:47], v2 offset:7424
    ds_read_b64_tr_b16 v[48:49], v2 offset:8192
    ds_read_b64_tr_b16 v[50:51], v2 offset:8448
    ds_read_b64_tr_b16 v[52:53], v2 offset:9216
    ds_read_b64_tr_b16 v[54:55], v2 offset:9472
    s_waitcnt lgkmcnt(15)
    v_mfma_f32_32x32x16_bf16 v[96:111], a[160:163], v[16:19], 0
    ds_write_b128 v4, v[112:115] offset:36864
    v_mfma_f32_32x32x16_bf16 v[96:111], a[164:167], v[20:23], v[96:111]
    ds_write_b128 v4, v[116:119] offset:37888
    s_waitcnt lgkmcnt(15)
    v_mfma_f32_32x32x16_bf16 v[96:111], a[168:171], v[24:27], v[96:111]
    ds_write_b128 v4, v[120:123] offset:38912
    s_waitcnt lgkmcnt(15)
    v_mfma_f32_32x32x16_bf16 v[96:111], a[172:175], v[28:31], v[96:111]
    ds_write_b128 v4, v[124:127] offset:39936
    s_waitcnt lgkmcnt(14)
    v_mfma_f32_32x32x16_bf16 v[96:111], a[176:179], v[32:35], v[96:111]
    s_waitcnt lgkmcnt(12)
    v_mfma_f32_32x32x16_bf16 v[96:111], a[180:183], v[36:39], v[96:111]
    s_waitcnt lgkmcnt(0)
    s_barrier
    buffer_store_dwordx4 v[172:175], v7, s[4:7], s59 offen sc1
    v_mfma_f32_32x32x16_bf16 v[96:111], a[184:187], v[40:43], v[96:111]
    ds_read_b128 v[184:187], v3 offset:32768
    ds_read_b128 v[188:191], v3 offset:33792
    ds_read_b128 v[192:195], v3 offset:40960
    ds_read_b128 v[196:199], v3 offset:41984
    v_mfma_f32_32x32x16_bf16 v[96:111], a[188:191], v[44:47], v[96:111]
    ds_read_b128 v[200:203], v3 offset:49152
    ds_read_b128 v[204:207], v3 offset:50176
    ds_read_b128 v[208:211], v3 offset:57344
    ds_read_b128 v[212:215], v3 offset:58368
    v_mfma_f32_32x32x16_bf16 v[96:111], a[192:195], v[48:51], v[96:111]
    s_add_u32 m0, s60, 10240
    s_nop 0
    buffer_load_dwordx4 v0, s[4:7], s54 offen offset:0 sc1 lds
    v_mfma_f32_32x32x16_bf16 v[96:111], a[196:199], v[52:55], v[96:111]
    buffer_load_dwordx4 v0, s[4:7], s54 offen offset:1024 sc1 lds
    v_mfma_f32_32x32x16_bf16 v[112:127], a[200:203], v[16:19], 0
    buffer_load_dwordx4 v0, s[4:7], s54 offen offset:2048 sc1 lds
    s_waitcnt lgkmcnt(5)
    v_add_f32 v184, v184, v192
    v_add_f32 v185, v185, v193
    v_add_f32 v186, v186, v194
    v_add_f32 v187, v187, v195
    s_waitcnt lgkmcnt(4)
    v_add_f32 v188, v188, v196
    v_add_f32 v189, v189, v197
    v_mfma_f32_32x32x16_bf16 v[112:127], a[204:207], v[20:23], v[112:127]
    buffer_load_dwordx4 v0, s[4:7], s54 offen offset:3072 sc1 lds
    v_add_f32 v190, v190, v198
    v_add_f32 v191, v191, v199
    s_waitcnt lgkmcnt(3)
    v_add_f32 v184, v184, v200
    v_add_f32 v185, v185, v201
    v_add_f32 v186, v186, v202
    v_add_f32 v187, v187, v203
    v_mfma_f32_32x32x16_bf16 v[112:127], a[208:211], v[24:27], v[112:127]
    s_add_u32 s54, s54, 4096
    s_add_u32 m0, s60, 14336
    s_nop 0
    buffer_load_dwordx4 v0, s[4:7], s54 offen offset:0 sc1 lds
    s_waitcnt lgkmcnt(2)
    v_add_f32 v188, v188, v204
    v_add_f32 v189, v189, v205
    v_add_f32 v190, v190, v206
    v_add_f32 v191, v191, v207
    s_waitcnt lgkmcnt(1)
    v_add_f32 v184, v184, v208
    v_add_f32 v185, v185, v209
    v_mfma_f32_32x32x16_bf16 v[112:127], a[212:215], v[28:31], v[112:127]
    buffer_load_dwordx4 v0, s[4:7], s54 offen offset:1024 sc1 lds
    v_add_f32 v186, v186, v210
    v_add_f32 v187, v187, v211
    s_waitcnt lgkmcnt(0)
    v_add_f32 v188, v188, v212
    v_add_f32 v189, v189, v213
    v_add_f32 v190, v190, v214
    v_add_f32 v191, v191, v215
    v_mfma_f32_32x32x16_bf16 v[112:127], a[216:219], v[32:35], v[112:127]
    buffer_load_dwordx4 v0, s[4:7], s54 offen offset:2048 sc1 lds
    v_cvt_pk_bf16_f32 v172, v184, v185
    v_cvt_pk_bf16_f32 v173, v186, v187
    v_cvt_pk_bf16_f32 v174, v188, v189
    v_cvt_pk_bf16_f32 v175, v190, v191
    v_lshlrev_b32 v184, 16, v172
    v_lshlrev_b32 v185, 16, v168
    v_mfma_f32_32x32x16_bf16 v[112:127], a[220:223], v[36:39], v[112:127]
    buffer_load_dwordx4 v0, s[4:7], s54 offen offset:3072 sc1 lds
    v_and_b32 v186, 0xffff0000, v172
    v_and_b32 v187, 0xffff0000, v168
    v_add_f32 v184, v184, v185
    v_add_f32 v186, v186, v187
    v_cvt_pk_bf16_f32 v172, v184, v186
    v_lshlrev_b32 v184, 16, v173
    v_mfma_f32_32x32x16_bf16 v[112:127], a[224:227], v[40:43], v[112:127]
    s_add_u32 s54, s54, 4096
    s_add_u32 m0, s60, 18432
    s_nop 0
    buffer_load_dwordx4 v0, s[4:7], s54 offen offset:0 sc1 lds
    ds_write_b128 v4, v[96:99] offset:0
    v_lshlrev_b32 v185, 16, v169
    v_and_b32 v186, 0xffff0000, v173
    v_and_b32 v187, 0xffff0000, v169
    v_add_f32 v184, v184, v185
    v_add_f32 v186, v186, v187
    v_cvt_pk_bf16_f32 v173, v184, v186
    v_mfma_f32_32x32x16_bf16 v[112:127], a[228:231], v[44:47], v[112:127]
    buffer_load_dwordx4 v0, s[4:7], s54 offen offset:1024 sc1 lds
    ds_write_b128 v4, v[100:103] offset:1024
    v_lshlrev_b32 v184, 16, v174
    v_lshlrev_b32 v185, 16, v170
    v_and_b32 v186, 0xffff0000, v174
    v_and_b32 v187, 0xffff0000, v170
    v_add_f32 v184, v184, v185
    v_add_f32 v186, v186, v187
    v_mfma_f32_32x32x16_bf16 v[112:127], a[232:235], v[48:51], v[112:127]
    ds_write_b128 v4, v[104:107] offset:2048
    v_cvt_pk_bf16_f32 v174, v184, v186
    v_lshlrev_b32 v184, 16, v175
    v_lshlrev_b32 v185, 16, v171
    v_and_b32 v186, 0xffff0000, v175
    v_and_b32 v187, 0xffff0000, v171
    v_add_f32 v184, v184, v185
    v_mfma_f32_32x32x16_bf16 v[112:127], a[236:239], v[52:55], v[112:127]
    ds_write_b128 v4, v[108:111] offset:3072
    v_add_f32 v186, v186, v187
    v_cvt_pk_bf16_f32 v175, v184, v186
    s_mov_b32 s59, s55
    s_mul_i32 s55, s44, s58
    s_add_u32 s55, s55, s51
    buffer_load_dwordx4 v[168:171], v8, s[16:19], s56 offen sc1
    s_branch G_312
G_315:
    s_waitcnt vmcnt(0)
    ds_read_b64_tr_b16 v[56:57], v2 offset:10240
    ds_read_b64_tr_b16 v[58:59], v2 offset:10496
    ds_read_b64_tr_b16 v[60:61], v2 offset:11264
    ds_read_b64_tr_b16 v[62:63], v2 offset:11520
    ds_read_b64_tr_b16 v[64:65], v2 offset:12288
    ds_read_b64_tr_b16 v[66:67], v2 offset:12544
    ds_read_b64_tr_b16 v[68:69], v2 offset:13312
    ds_read_b64_tr_b16 v[70:71], v2 offset:13568
    ds_read_b64_tr_b16 v[72:73], v2 offset:14336
    ds_read_b64_tr_b16 v[74:75], v2 offset:14592
    ds_read_b64_tr_b16 v[76:77], v2 offset:15360
    ds_read_b64_tr_b16 v[78:79], v2 offset:15616
    ds_read_b64_tr_b16 v[80:81], v2 offset:16384
    ds_read_b64_tr_b16 v[82:83], v2 offset:16640
    ds_read_b64_tr_b16 v[84:85], v2 offset:17408
    ds_read_b64_tr_b16 v[86:87], v2 offset:17664
    ds_read_b64_tr_b16 v[88:89], v2 offset:18432
    ds_read_b64_tr_b16 v[90:91], v2 offset:18688
    ds_read_b64_tr_b16 v[92:93], v2 offset:19456
    ds_read_b64_tr_b16 v[94:95], v2 offset:19712
    s_waitcnt lgkmcnt(15)
    v_mfma_f32_32x32x16_bf16 v[96:111], a[160:163], v[56:59], 0
    ds_write_b128 v4, v[112:115] offset:4096
    v_mfma_f32_32x32x16_bf16 v[96:111], a[164:167], v[60:63], v[96:111]
    ds_write_b128 v4, v[116:119] offset:5120
    s_waitcnt lgkmcnt(15)
    v_mfma_f32_32x32x16_bf16 v[96:111], a[168:171], v[64:67], v[96:111]
    ds_write_b128 v4, v[120:123] offset:6144
    s_waitcnt lgkmcnt(15)
    v_mfma_f32_32x32x16_bf16 v[96:111], a[172:175], v[68:71], v[96:111]
    ds_write_b128 v4, v[124:127] offset:7168
    s_waitcnt lgkmcnt(14)
    v_mfma_f32_32x32x16_bf16 v[96:111], a[176:179], v[72:75], v[96:111]
    s_waitcnt lgkmcnt(12)
    v_mfma_f32_32x32x16_bf16 v[96:111], a[180:183], v[76:79], v[96:111]
    s_waitcnt lgkmcnt(0)
    s_barrier
    buffer_store_dwordx4 v[172:175], v7, s[4:7], s59 offen sc1
    v_mfma_f32_32x32x16_bf16 v[96:111], a[184:187], v[80:83], v[96:111]
    ds_read_b128 v[184:187], v3 offset:0
    ds_read_b128 v[188:191], v3 offset:1024
    ds_read_b128 v[192:195], v3 offset:8192
    ds_read_b128 v[196:199], v3 offset:9216
    v_mfma_f32_32x32x16_bf16 v[96:111], a[188:191], v[84:87], v[96:111]
    ds_read_b128 v[200:203], v3 offset:16384
    ds_read_b128 v[204:207], v3 offset:17408
    ds_read_b128 v[208:211], v3 offset:24576
    ds_read_b128 v[212:215], v3 offset:25600
    v_mfma_f32_32x32x16_bf16 v[96:111], a[192:195], v[88:91], v[96:111]
    v_mfma_f32_32x32x16_bf16 v[96:111], a[196:199], v[92:95], v[96:111]
    v_mfma_f32_32x32x16_bf16 v[112:127], a[200:203], v[56:59], 0
    s_waitcnt lgkmcnt(5)
    v_add_f32 v184, v184, v192
    v_add_f32 v185, v185, v193
    v_add_f32 v186, v186, v194
    v_add_f32 v187, v187, v195
    s_waitcnt lgkmcnt(4)
    v_add_f32 v188, v188, v196
    v_add_f32 v189, v189, v197
    v_mfma_f32_32x32x16_bf16 v[112:127], a[204:207], v[60:63], v[112:127]
    v_add_f32 v190, v190, v198
    v_add_f32 v191, v191, v199
    s_waitcnt lgkmcnt(3)
    v_add_f32 v184, v184, v200
    v_add_f32 v185, v185, v201
    v_add_f32 v186, v186, v202
    v_add_f32 v187, v187, v203
    v_mfma_f32_32x32x16_bf16 v[112:127], a[208:211], v[64:67], v[112:127]
    s_waitcnt lgkmcnt(2)
    v_add_f32 v188, v188, v204
    v_add_f32 v189, v189, v205
    v_add_f32 v190, v190, v206
    v_add_f32 v191, v191, v207
    s_waitcnt lgkmcnt(1)
    v_add_f32 v184, v184, v208
    v_add_f32 v185, v185, v209
    v_mfma_f32_32x32x16_bf16 v[112:127], a[212:215], v[68:71], v[112:127]
    v_add_f32 v186, v186, v210
    v_add_f32 v187, v187, v211
    s_waitcnt lgkmcnt(0)
    v_add_f32 v188, v188, v212
    v_add_f32 v189, v189, v213
    v_add_f32 v190, v190, v214
    v_add_f32 v191, v191, v215
    v_mfma_f32_32x32x16_bf16 v[112:127], a[216:219], v[72:75], v[112:127]
    v_cvt_pk_bf16_f32 v172, v184, v185
    v_cvt_pk_bf16_f32 v173, v186, v187
    v_cvt_pk_bf16_f32 v174, v188, v189
    v_cvt_pk_bf16_f32 v175, v190, v191
    v_lshlrev_b32 v184, 16, v172
    v_lshlrev_b32 v185, 16, v164
    v_mfma_f32_32x32x16_bf16 v[112:127], a[220:223], v[76:79], v[112:127]
    v_and_b32 v186, 0xffff0000, v172
    v_and_b32 v187, 0xffff0000, v164
    v_add_f32 v184, v184, v185
    v_add_f32 v186, v186, v187
    v_cvt_pk_bf16_f32 v172, v184, v186
    v_lshlrev_b32 v184, 16, v173
    v_mfma_f32_32x32x16_bf16 v[112:127], a[224:227], v[80:83], v[112:127]
    ds_write_b128 v4, v[96:99] offset:32768
    v_lshlrev_b32 v185, 16, v165
    v_and_b32 v186, 0xffff0000, v173
    v_and_b32 v187, 0xffff0000, v165
    v_add_f32 v184, v184, v185
    v_add_f32 v186, v186, v187
    v_cvt_pk_bf16_f32 v173, v184, v186
    v_mfma_f32_32x32x16_bf16 v[112:127], a[228:231], v[84:87], v[112:127]
    ds_write_b128 v4, v[100:103] offset:33792
    v_lshlrev_b32 v184, 16, v174
    v_lshlrev_b32 v185, 16, v166
    v_and_b32 v186, 0xffff0000, v174
    v_and_b32 v187, 0xffff0000, v166
    v_add_f32 v184, v184, v185
    v_add_f32 v186, v186, v187
    v_mfma_f32_32x32x16_bf16 v[112:127], a[232:235], v[88:91], v[112:127]
    ds_write_b128 v4, v[104:107] offset:34816
    v_cvt_pk_bf16_f32 v174, v184, v186
    v_lshlrev_b32 v184, 16, v175
    v_lshlrev_b32 v185, 16, v167
    v_and_b32 v186, 0xffff0000, v175
    v_and_b32 v187, 0xffff0000, v167
    v_add_f32 v184, v184, v185
    v_mfma_f32_32x32x16_bf16 v[112:127], a[236:239], v[92:95], v[112:127]
    ds_write_b128 v4, v[108:111] offset:35840
    v_add_f32 v186, v186, v187
    v_cvt_pk_bf16_f32 v175, v184, v186
    s_mov_b32 s59, s55
    s_mul_i32 s55, s44, s58
    s_add_u32 s55, s55, s51
    s_nop 3
    ds_write_b128 v4, v[112:115] offset:36864
    ds_write_b128 v4, v[116:119] offset:37888
    ds_write_b128 v4, v[120:123] offset:38912
    ds_write_b128 v4, v[124:127] offset:39936
    s_waitcnt vmcnt(0)
    s_waitcnt lgkmcnt(0)
    s_barrier
    buffer_store_dwordx4 v[172:175], v7, s[4:7], s59 offen sc1
    ds_read_b128 v[184:187], v3 offset:32768
    ds_read_b128 v[188:191], v3 offset:33792
    ds_read_b128 v[192:195], v3 offset:40960
    ds_read_b128 v[196:199], v3 offset:41984
    ds_read_b128 v[200:203], v3 offset:49152
    ds_read_b128 v[204:207], v3 offset:50176
    ds_read_b128 v[208:211], v3 offset:57344
    ds_read_b128 v[212:215], v3 offset:58368
    s_waitcnt lgkmcnt(5)
    v_add_f32 v184, v184, v192
    v_add_f32 v185, v185, v193
    v_add_f32 v186, v186, v194
    v_add_f32 v187, v187, v195
    s_waitcnt lgkmcnt(4)
    v_add_f32 v188, v188, v196
    v_add_f32 v189, v189, v197
    v_add_f32 v190, v190, v198
    v_add_f32 v191, v191, v199
    s_waitcnt lgkmcnt(3)
    v_add_f32 v184, v184, v200
    v_add_f32 v185, v185, v201
    v_add_f32 v186, v186, v202
    v_add_f32 v187, v187, v203
    s_waitcnt lgkmcnt(2)
    v_add_f32 v188, v188, v204
    v_add_f32 v189, v189, v205
    v_add_f32 v190, v190, v206
    v_add_f32 v191, v191, v207
    s_waitcnt lgkmcnt(1)
    v_add_f32 v184, v184, v208
    v_add_f32 v185, v185, v209
    v_add_f32 v186, v186, v210
    v_add_f32 v187, v187, v211
    s_waitcnt lgkmcnt(0)
    v_add_f32 v188, v188, v212
    v_add_f32 v189, v189, v213
    v_add_f32 v190, v190, v214
    v_add_f32 v191, v191, v215
    v_cvt_pk_bf16_f32 v172, v184, v185
    v_cvt_pk_bf16_f32 v173, v186, v187
    v_cvt_pk_bf16_f32 v174, v188, v189
    v_cvt_pk_bf16_f32 v175, v190, v191
    v_lshlrev_b32 v184, 16, v172
    v_lshlrev_b32 v185, 16, v168
    v_and_b32 v186, 0xffff0000, v172
    v_and_b32 v187, 0xffff0000, v168
    v_add_f32 v184, v184, v185
    v_add_f32 v186, v186, v187
    v_cvt_pk_bf16_f32 v172, v184, v186
    v_lshlrev_b32 v184, 16, v173
    v_lshlrev_b32 v185, 16, v169
    v_and_b32 v186, 0xffff0000, v173
    v_and_b32 v187, 0xffff0000, v169
    v_add_f32 v184, v184, v185
    v_add_f32 v186, v186, v187
    v_cvt_pk_bf16_f32 v173, v184, v186
    v_lshlrev_b32 v184, 16, v174
    v_lshlrev_b32 v185, 16, v170
    v_and_b32 v186, 0xffff0000, v174
    v_and_b32 v187, 0xffff0000, v170
    v_add_f32 v184, v184, v185
    v_add_f32 v186, v186, v187
    v_cvt_pk_bf16_f32 v174, v184, v186
    v_lshlrev_b32 v184, 16, v175
    v_lshlrev_b32 v185, 16, v171
    v_and_b32 v186, 0xffff0000, v175
    v_and_b32 v187, 0xffff0000, v171
    v_add_f32 v184, v184, v185
    v_add_f32 v186, v186, v187
    v_cvt_pk_bf16_f32 v175, v184, v186
    s_mov_b32 s59, s55
    buffer_store_dwordx4 v[172:175], v7, s[4:7], s59 offen sc1
    s_branch G_313
G_314:
    s_waitcnt vmcnt(0)
    ds_read_b64_tr_b16 v[16:17], v2 offset:0
    ds_read_b64_tr_b16 v[18:19], v2 offset:256
    ds_read_b64_tr_b16 v[20:21], v2 offset:1024
    ds_read_b64_tr_b16 v[22:23], v2 offset:1280
    ds_read_b64_tr_b16 v[24:25], v2 offset:2048
    ds_read_b64_tr_b16 v[26:27], v2 offset:2304
    ds_read_b64_tr_b16 v[28:29], v2 offset:3072
    ds_read_b64_tr_b16 v[30:31], v2 offset:3328
    ds_read_b64_tr_b16 v[32:33], v2 offset:4096
    ds_read_b64_tr_b16 v[34:35], v2 offset:4352
    ds_read_b64_tr_b16 v[36:37], v2 offset:5120
    ds_read_b64_tr_b16 v[38:39], v2 offset:5376
    ds_read_b64_tr_b16 v[40:41], v2 offset:6144
    ds_read_b64_tr_b16 v[42:43], v2 offset:6400
    ds_read_b64_tr_b16 v[44:45], v2 offset:7168
    ds_read_b64_tr_b16 v[46:47], v2 offset:7424
    ds_read_b64_tr_b16 v[48:49], v2 offset:8192
    ds_read_b64_tr_b16 v[50:51], v2 offset:8448
    ds_read_b64_tr_b16 v[52:53], v2 offset:9216
    ds_read_b64_tr_b16 v[54:55], v2 offset:9472
    s_waitcnt lgkmcnt(15)
    v_mfma_f32_32x32x16_bf16 v[96:111], a[160:163], v[16:19], 0
    ds_write_b128 v4, v[112:115] offset:36864
    v_mfma_f32_32x32x16_bf16 v[96:111], a[164:167], v[20:23], v[96:111]
    ds_write_b128 v4, v[116:119] offset:37888
    s_waitcnt lgkmcnt(15)
    v_mfma_f32_32x32x16_bf16 v[96:111], a[168:171], v[24:27], v[96:111]
    ds_write_b128 v4, v[120:123] offset:38912
    s_waitcnt lgkmcnt(15)
    v_mfma_f32_32x32x16_bf16 v[96:111], a[172:175], v[28:31], v[96:111]
    ds_write_b128 v4, v[124:127] offset:39936
    s_waitcnt lgkmcnt(14)
    v_mfma_f32_32x32x16_bf16 v[96:111], a[176:179], v[32:35], v[96:111]
    s_waitcnt lgkmcnt(12)
    v_mfma_f32_32x32x16_bf16 v[96:111], a[180:183], v[36:39], v[96:111]
    s_waitcnt lgkmcnt(0)
    s_barrier
    buffer_store_dwordx4 v[172:175], v7, s[4:7], s59 offen sc1
    v_mfma_f32_32x32x16_bf16 v[96:111], a[184:187], v[40:43], v[96:111]
    ds_read_b128 v[184:187], v3 offset:32768
    ds_read_b128 v[188:191], v3 offset:33792
    ds_read_b128 v[192:195], v3 offset:40960
    ds_read_b128 v[196:199], v3 offset:41984
    v_mfma_f32_32x32x16_bf16 v[96:111], a[188:191], v[44:47], v[96:111]
    ds_read_b128 v[200:203], v3 offset:49152
    ds_read_b128 v[204:207], v3 offset:50176
    ds_read_b128 v[208:211], v3 offset:57344
    ds_read_b128 v[212:215], v3 offset:58368
    v_mfma_f32_32x32x16_bf16 v[96:111], a[192:195], v[48:51], v[96:111]
    v_mfma_f32_32x32x16_bf16 v[96:111], a[196:199], v[52:55], v[96:111]
    v_mfma_f32_32x32x16_bf16 v[112:127], a[200:203], v[16:19], 0
    s_waitcnt lgkmcnt(5)
    v_add_f32 v184, v184, v192
    v_add_f32 v185, v185, v193
    v_add_f32 v186, v186, v194
    v_add_f32 v187, v187, v195
    s_waitcnt lgkmcnt(4)
    v_add_f32 v188, v188, v196
    v_add_f32 v189, v189, v197
    v_mfma_f32_32x32x16_bf16 v[112:127], a[204:207], v[20:23], v[112:127]
    v_add_f32 v190, v190, v198
    v_add_f32 v191, v191, v199
    s_waitcnt lgkmcnt(3)
    v_add_f32 v184, v184, v200
    v_add_f32 v185, v185, v201
    v_add_f32 v186, v186, v202
    v_add_f32 v187, v187, v203
    v_mfma_f32_32x32x16_bf16 v[112:127], a[208:211], v[24:27], v[112:127]
    s_waitcnt lgkmcnt(2)
    v_add_f32 v188, v188, v204
    v_add_f32 v189, v189, v205
    v_add_f32 v190, v190, v206
    v_add_f32 v191, v191, v207
    s_waitcnt lgkmcnt(1)
    v_add_f32 v184, v184, v208
    v_add_f32 v185, v185, v209
    v_mfma_f32_32x32x16_bf16 v[112:127], a[212:215], v[28:31], v[112:127]
    v_add_f32 v186, v186, v210
    v_add_f32 v187, v187, v211
    s_waitcnt lgkmcnt(0)
    v_add_f32 v188, v188, v212
    v_add_f32 v189, v189, v213
    v_add_f32 v190, v190, v214
    v_add_f32 v191, v191, v215
    v_mfma_f32_32x32x16_bf16 v[112:127], a[216:219], v[32:35], v[112:127]
    v_cvt_pk_bf16_f32 v172, v184, v185
    v_cvt_pk_bf16_f32 v173, v186, v187
    v_cvt_pk_bf16_f32 v174, v188, v189
    v_cvt_pk_bf16_f32 v175, v190, v191
    v_lshlrev_b32 v184, 16, v172
    v_lshlrev_b32 v185, 16, v168
    v_mfma_f32_32x32x16_bf16 v[112:127], a[220:223], v[36:39], v[112:127]
    v_and_b32 v186, 0xffff0000, v172
    v_and_b32 v187, 0xffff0000, v168
    v_add_f32 v184, v184, v185
    v_add_f32 v186, v186, v187
    v_cvt_pk_bf16_f32 v172, v184, v186
    v_lshlrev_b32 v184, 16, v173
    v_mfma_f32_32x32x16_bf16 v[112:127], a[224:227], v[40:43], v[112:127]
    ds_write_b128 v4, v[96:99] offset:0
    v_lshlrev_b32 v185, 16, v169
    v_and_b32 v186, 0xffff0000, v173
    v_and_b32 v187, 0xffff0000, v169
    v_add_f32 v184, v184, v185
    v_add_f32 v186, v186, v187
    v_cvt_pk_bf16_f32 v173, v184, v186
    v_mfma_f32_32x32x16_bf16 v[112:127], a[228:231], v[44:47], v[112:127]
    ds_write_b128 v4, v[100:103] offset:1024
    v_lshlrev_b32 v184, 16, v174
    v_lshlrev_b32 v185, 16, v170
    v_and_b32 v186, 0xffff0000, v174
    v_and_b32 v187, 0xffff0000, v170
    v_add_f32 v184, v184, v185
    v_add_f32 v186, v186, v187
    v_mfma_f32_32x32x16_bf16 v[112:127], a[232:235], v[48:51], v[112:127]
    ds_write_b128 v4, v[104:107] offset:2048
    v_cvt_pk_bf16_f32 v174, v184, v186
    v_lshlrev_b32 v184, 16, v175
    v_lshlrev_b32 v185, 16, v171
    v_and_b32 v186, 0xffff0000, v175
    v_and_b32 v187, 0xffff0000, v171
    v_add_f32 v184, v184, v185
    v_mfma_f32_32x32x16_bf16 v[112:127], a[236:239], v[52:55], v[112:127]
    ds_write_b128 v4, v[108:111] offset:3072
    v_add_f32 v186, v186, v187
    v_cvt_pk_bf16_f32 v175, v184, v186
    s_mov_b32 s59, s55
    s_mul_i32 s55, s44, s58
    s_add_u32 s55, s55, s51
    s_nop 3
    ds_write_b128 v4, v[112:115] offset:4096
    ds_write_b128 v4, v[116:119] offset:5120
    ds_write_b128 v4, v[120:123] offset:6144
    ds_write_b128 v4, v[124:127] offset:7168
    s_waitcnt vmcnt(0)
    s_waitcnt lgkmcnt(0)
    s_barrier
    buffer_store_dwordx4 v[172:175], v7, s[4:7], s59 offen sc1
    ds_read_b128 v[184:187], v3 offset:0
    ds_read_b128 v[188:191], v3 offset:1024
    ds_read_b128 v[192:195], v3 offset:8192
    ds_read_b128 v[196:199], v3 offset:9216
    ds_read_b128 v[200:203], v3 offset:16384
    ds_read_b128 v[204:207], v3 offset:17408
    ds_read_b128 v[208:211], v3 offset:24576
    ds_read_b128 v[212:215], v3 offset:25600
    s_waitcnt lgkmcnt(5)
    v_add_f32 v184, v184, v192
    v_add_f32 v185, v185, v193
    v_add_f32 v186, v186, v194
    v_add_f32 v187, v187, v195
    s_waitcnt lgkmcnt(4)
    v_add_f32 v188, v188, v196
    v_add_f32 v189, v189, v197
    v_add_f32 v190, v190, v198
    v_add_f32 v191, v191, v199
    s_waitcnt lgkmcnt(3)
    v_add_f32 v184, v184, v200
    v_add_f32 v185, v185, v201
    v_add_f32 v186, v186, v202
    v_add_f32 v187, v187, v203
    s_waitcnt lgkmcnt(2)
    v_add_f32 v188, v188, v204
    v_add_f32 v189, v189, v205
    v_add_f32 v190, v190, v206
    v_add_f32 v191, v191, v207
    s_waitcnt lgkmcnt(1)
    v_add_f32 v184, v184, v208
    v_add_f32 v185, v185, v209
    v_add_f32 v186, v186, v210
    v_add_f32 v187, v187, v211
    s_waitcnt lgkmcnt(0)
    v_add_f32 v188, v188, v212
    v_add_f32 v189, v189, v213
    v_add_f32 v190, v190, v214
    v_add_f32 v191, v191, v215
    v_cvt_pk_bf16_f32 v172, v184, v185
    v_cvt_pk_bf16_f32 v173, v186, v187
    v_cvt_pk_bf16_f32 v174, v188, v189
    v_cvt_pk_bf16_f32 v175, v190, v191
    v_lshlrev_b32 v184, 16, v172
    v_lshlrev_b32 v185, 16, v164
    v_and_b32 v186, 0xffff0000, v172
    v_and_b32 v187, 0xffff0000, v164
    v_add_f32 v184, v184, v185
    v_add_f32 v186, v186, v187
    v_cvt_pk_bf16_f32 v172, v184, v186
    v_lshlrev_b32 v184, 16, v173
    v_lshlrev_b32 v185, 16, v165
    v_and_b32 v186, 0xffff0000, v173
    v_and_b32 v187, 0xffff0000, v165
    v_add_f32 v184, v184, v185
    v_add_f32 v186, v186, v187
    v_cvt_pk_bf16_f32 v173, v184, v186
    v_lshlrev_b32 v184, 16, v174
    v_lshlrev_b32 v185, 16, v166
    v_and_b32 v186, 0xffff0000, v174
    v_and_b32 v187, 0xffff0000, v166
    v_add_f32 v184, v184, v185
    v_add_f32 v186, v186, v187
    v_cvt_pk_bf16_f32 v174, v184, v186
    v_lshlrev_b32 v184, 16, v175
    v_lshlrev_b32 v185, 16, v167
    v_and_b32 v186, 0xffff0000, v175
    v_and_b32 v187, 0xffff0000, v167
    v_add_f32 v184, v184, v185
    v_add_f32 v186, v186, v187
    v_cvt_pk_bf16_f32 v175, v184, v186
    s_mov_b32 s59, s55
    buffer_store_dwordx4 v[172:175], v7, s[4:7], s59 offen sc1
G_313:
    s_lshl_b32 s57, s30, 1
    s_add_u32 s57, s57, 2
    s_waitcnt vmcnt(0)
    s_barrier
    s_cmp_lg_u32 s29, 0
    s_cbranch_scc1 F_316
    s_lshl_b32 s32, s28, 5
    s_add_u32 s32, s32, s29
    s_lshl_b32 s32, s32, 2
    s_add_u32 s32, s32, 1122304
    v_mov_b32 v172, s57
    s_mov_b64 exec, 1
    buffer_store_dword v172, off, s[4:7], s32 sc1
    s_mov_b64 exec, -1
F_316:
R_309:
LAYER_269:
    s_sub_u32 s32, s28, 128
    s_cmp_lt_u32 s32, 32
    s_cbranch_scc1 R_317
    v_add_u32 v2, s60, v0
    ds_write_b128 v2, a[160:163] offset:0
    ds_write_b128 v2, a[164:167] offset:1024
    ds_write_b128 v2, a[168:171] offset:2048
    ds_write_b128 v2, a[172:175] offset:3072
    ds_write_b128 v2, a[176:179] offset:4096
    ds_write_b128 v2, a[180:183] offset:5120
    ds_write_b128 v2, a[184:187] offset:6144
    ds_write_b128 v2, a[188:191] offset:7168
    ds_write_b128 v2, a[192:195] offset:8192
    ds_write_b128 v2, a[196:199] offset:9216
    ds_write_b128 v2, a[200:203] offset:10240
    ds_write_b128 v2, a[204:207] offset:11264
    ds_write_b128 v2, a[208:211] offset:12288
    ds_write_b128 v2, a[212:215] offset:13312
    ds_write_b128 v2, a[216:219] offset:14336
    ds_write_b128 v2, a[220:223] offset:15360
    ds_write_b128 v2, a[224:227] offset:16384
    ds_write_b128 v2, a[228:231] offset:17408
    ds_write_b128 v2, a[232:235] offset:18432
    ds_write_b128 v2, a[236:239] offset:19456
    s_waitcnt lgkmcnt(0)
R_317:
    s_cmp_lt_u32 s28, 128
    s_cbranch_scc1 R_318
    s_cmp_ge_u32 s28, 160
    s_cbranch_scc1 R_318
    s_sub_u32 s40, s28, 128
    v_bfe_u32 v2, v1, 1, 1
    v_mul_u32_u24 v2, 2048, v2
    v_bfe_u32 v8, v1, 3, 1
    v_lshl_add_u32 v2, v8, 12, v2
    v_bfe_u32 v8, v1, 2, 1
    v_lshl_add_u32 v2, v8, 6, v2
    v_bfe_u32 v8, v1, 4, 1
    v_lshl_add_u32 v2, v8, 7, v2
    v_bfe_u32 v8, v1, 5, 1
    v_lshl_add_u32 v2, v8, 5, v2
    v_bfe_u32 v8, v1, 0, 1
    v_lshl_add_u32 v2, v8, 4, v2
    v_bfe_u32 v3, v1, 4, 1
    v_mul_u32_u24 v3, 1024, v3
    v_bfe_u32 v8, v1, 5, 1
    v_lshl_add_u32 v3, v8, 8, v3
    v_bfe_u32 v8, v1, 0, 2
    v_lshl_add_u32 v3, v8, 4, v3
    v_bfe_u32 v8, v1, 2, 1
    v_lshl_add_u32 v3, v8, 7, v3
    v_bfe_u32 v8, v1, 3, 1
    v_lshl_add_u32 v3, v8, 6, v3
    v_bfe_u32 v4, v1, 0, 1
    v_mul_u32_u24 v4, 256, v4
    v_bfe_u32 v8, v1, 5, 1
    v_lshl_add_u32 v4, v8, 7, v4
    v_bfe_u32 v8, v1, 2, 2
    v_lshl_add_u32 v4, v8, 3, v4
    v_add_u32 v4, s60, v4
    s_mov_b32 m0, s60
    v_bfe_u32 v5, v1, 0, 2
    v_mul_u32_u24 v5, 8, v5
    v_bfe_u32 v8, v1, 2, 1
    v_lshl_add_u32 v5, v8, 6, v5
    v_bfe_u32 v8, v1, 3, 1
    v_lshl_add_u32 v5, v8, 5, v5
    v_bfe_u32 v8, v1, 4, 2
    v_lshl_add_u32 v5, v8, 7, v5
    v_add_u32 v5, 2048, v5
    v_bfe_u32 v6, v1, 4, 1
    v_mul_u32_u24 v6, 131072, v6
    v_bfe_u32 v8, v1, 5, 1
    v_lshl_add_u32 v6, v8, 8, v6
    v_bfe_u32 v8, v1, 0, 4
    v_lshl_add_u32 v6, v8, 4, v6
    v_bfe_u32 v9, v1, 0, 2
    v_bfe_u32 v8, v1, 2, 1
    v_lshl_add_u32 v9, v8, 3, v9
    v_bfe_u32 v8, v1, 3, 1
    v_lshl_add_u32 v9, v8, 2, v9
    v_bfe_u32 v8, v1, 4, 1
    v_lshl_add_u32 v9, v8, 4, v9
    v_bfe_u32 v10, v1, 5, 1
    v_mul_u32_u24 v10, 8, v10
    v_sub_u32 v9, v9, v10
    v_mov_b32 v10, 0xf149f2ca
    v_cmp_gt_i32 vcc, 0, v9
    s_nop 1
    v_cndmask_b32 v152, 0, v10, vcc
    v_cmp_gt_i32 vcc, 1, v9
    s_nop 1
    v_cndmask_b32 v153, 0, v10, vcc
    v_cmp_gt_i32 vcc, 2, v9
    s_nop 1
    v_cndmask_b32 v154, 0, v10, vcc
    v_cmp_gt_i32 vcc, 3, v9
    s_nop 1
    v_cndmask_b32 v155, 0, v10, vcc
    v_cmp_gt_i32 vcc, 4, v9
    s_nop 1
    v_cndmask_b32 v156, 0, v10, vcc
    v_cmp_gt_i32 vcc, 5, v9
    s_nop 1
    v_cndmask_b32 v157, 0, v10, vcc
    v_cmp_gt_i32 vcc, 6, v9
    s_nop 1
    v_cndmask_b32 v158, 0, v10, vcc
    v_cmp_gt_i32 vcc, 7, v9
    s_nop 1
    v_cndmask_b32 v159, 0, v10, vcc
    v_cmp_gt_i32 vcc, 16, v9
    s_nop 1
    v_cndmask_b32 v160, 0, v10, vcc
    v_cmp_gt_i32 vcc, 17, v9
    s_nop 1
    v_cndmask_b32 v161, 0, v10, vcc
    v_cmp_gt_i32 vcc, 18, v9
    s_nop 1
    v_cndmask_b32 v162, 0, v10, vcc
    v_cmp_gt_i32 vcc, 19, v9
    s_nop 1
    v_cndmask_b32 v163, 0, v10, vcc
    v_cmp_gt_i32 vcc, 20, v9
    s_nop 1
    v_cndmask_b32 v164, 0, v10, vcc
    v_cmp_gt_i32 vcc, 21, v9
    s_nop 1
    v_cndmask_b32 v165, 0, v10, vcc
    v_cmp_gt_i32 vcc, 22, v9
    s_nop 1
    v_cndmask_b32 v166, 0, v10, vcc
    v_cmp_gt_i32 vcc, 23, v9
    s_nop 1
    v_cndmask_b32 v167, 0, v10, vcc
    s_lshl_b32 s34, s40, 8
    s_add_u32 s34, s34, 1220608
    v_bfe_u32 v7, v1, 0, 1
    v_mul_u32_u24 v7, 128, v7
    v_add_u32 v7, s34, v7
    s_mul_i32 s34, s40, 768
    s_add_u32 s34, s34, 1146880
    v_min_u32 v14, 5, v1
    v_lshlrev_b32 v14, 7, v14
    v_add_u32 v14, s34, v14
    s_mov_b32 s44, s29
    s_add_u32 s49, s61, 1
    s_mov_b32 s68, 0x3e0293ee
    s_waitcnt vmcnt(0) lgkmcnt(0)
AT_319:
    s_add_u32 s57, s44, s61
    s_add_u32 s57, s57, 1
    s_mov_b32 s48, 0
P_320:
    buffer_load_dword v8, v14, s[4:7], 0 offen sc1
    s_waitcnt vmcnt(0)
    v_cmp_gt_u32 vcc, s57, v8
    s_cbranch_vccz P_321
    s_add_u32 s48, s48, 1
    s_cmp_gt_u32 s48, 200000
    s_cbranch_scc1 L_end
    s_sleep 8
    s_branch P_320
P_321:
    s_lshl_b32 s34, s44, 5
    s_add_u32 s34, s34, s40
    s_mul_i32 s35, s30, 16777216
    s_add_u32 s35, s35, 33554432
    s_lshl_b32 s36, s34, 13
    s_add_u32 s35, s35, s36
    s_mul_i32 s37, s30, 67108864
    s_add_u32 s37, s37, 119537664
    s_lshl_b32 s36, s34, 15
    s_add_u32 s37, s37, s36
    s_xor_b32 s36, s44, s31
    s_and_b32 s36, s36, 2
    s_lshl_b32 s36, s36, 12
    s_add_u32 s37, s37, s36
    buffer_load_dwordx4 v[16:19], v0, s[4:7], s35 offen offset:0 sc1
    buffer_load_dwordx4 v[48:51], v2, s[4:7], s37 offen offset:0 sc1
    buffer_load_dwordx4 v[20:23], v0, s[4:7], s35 offen offset:1024 sc1
    buffer_load_dwordx4 v[52:55], v2, s[4:7], s37 offen offset:256 sc1
    buffer_load_dwordx4 v[24:27], v0, s[4:7], s35 offen offset:2048 sc1
    buffer_load_dwordx4 v[56:59], v2, s[4:7], s37 offen offset:512 sc1
    buffer_load_dwordx4 v[28:31], v0, s[4:7], s35 offen offset:3072 sc1
    buffer_load_dwordx4 v[60:63], v2, s[4:7], s37 offen offset:768 sc1
    s_add_u32 s35, s35, 4096
    buffer_load_dwordx4 v[32:35], v0, s[4:7], s35 offen offset:0 sc1
    buffer_load_dwordx4 v[64:67], v2, s[4:7], s37 offen offset:1024 sc1
    buffer_load_dwordx4 v[36:39], v0, s[4:7], s35 offen offset:1024 sc1
    buffer_load_dwordx4 v[68:71], v2, s[4:7], s37 offen offset:1280 sc1
    buffer_load_dwordx4 v[40:43], v0, s[4:7], s35 offen offset:2048 sc1
    buffer_load_dwordx4 v[72:75], v2, s[4:7], s37 offen offset:1536 sc1
    buffer_load_dwordx4 v[44:47], v0, s[4:7], s35 offen offset:3072 sc1
    buffer_load_dwordx4 v[76:79], v2, s[4:7], s37 offen offset:1792 sc1
    s_add_u32 s37, s37, 16384
    buffer_load_dwordx4 v[80:83], v3, s[4:7], s37 offen offset:0 sc1
    buffer_load_dwordx4 v[84:87], v3, s[4:7], s37 offen offset:512 sc1
    buffer_load_dwordx4 v[88:91], v3, s[4:7], s37 offen offset:2048 sc1
    buffer_load_dwordx4 v[92:95], v3, s[4:7], s37 offen offset:2560 sc1
    s_add_u32 s37, s37, 4096
    buffer_load_dwordx4 v[96:99], v3, s[4:7], s37 offen offset:0 sc1
    buffer_load_dwordx4 v[100:103], v3, s[4:7], s37 offen offset:512 sc1
    buffer_load_dwordx4 v[104:107], v3, s[4:7], s37 offen offset:2048 sc1
    buffer_load_dwordx4 v[108:111], v3, s[4:7], s37 offen offset:2560 sc1
    s_waitcnt vmcnt(22)
    v_mfma_f32_32x32x16_bf16 v[168:183], v[48:51], v[16:19], v[152:167]
    s_waitcnt vmcnt(20)
    v_mfma_f32_32x32x16_bf16 v[168:183], v[52:55], v[20:23], v[168:183]
    s_waitcnt vmcnt(18)
    v_mfma_f32_32x32x16_bf16 v[168:183], v[56:59], v[24:27], v[168:183]
    s_waitcnt vmcnt(16)
    v_mfma_f32_32x32x16_bf16 v[168:183], v[60:63], v[28:31], v[168:183]
    s_waitcnt vmcnt(14)
    v_mfma_f32_32x32x16_bf16 v[168:183], v[64:67], v[32:35], v[168:183]
    s_waitcnt vmcnt(12)
    v_mfma_f32_32x32x16_bf16 v[168:183], v[68:71], v[36:39], v[168:183]
    s_waitcnt vmcnt(10)
    v_mfma_f32_32x32x16_bf16 v[168:183], v[72:75], v[40:43], v[168:183]
    s_waitcnt vmcnt(8)
    v_mfma_f32_32x32x16_bf16 v[168:183], v[76:79], v[44:47], v[168:183]
    s_mov_b32 s48, 0
P_322:
    buffer_load_dword v8, v7, s[4:7], 0 offen sc1
    s_waitcnt vmcnt(0)
    v_cmp_gt_u32 vcc, s57, v8
    s_cbranch_vccz P_323
    s_add_u32 s48, s48, 1
    s_cmp_gt_u32 s48, 200000
    s_cbranch_scc1 L_end
    s_sleep 2
    v_add_u32 v8, 2, v8
    v_cmp_gt_u32 vcc, s57, v8
    s_cbranch_vccz P_322
    s_sleep 32
    s_branch P_322
P_323:
    s_mul_i32 s35, s30, 8388608
    s_add_u32 s35, s35, 100663296
    s_lshl_b32 s36, s34, 12
    s_add_u32 s35, s35, s36
    buffer_load_dwordx4 v0, s[4:7], s35 offen offset:0 sc1 lds
    buffer_load_dwordx4 v0, s[4:7], s35 offen offset:1024 sc1 lds
    buffer_load_dwordx2 v[144:145], v5, s[4:7], s35 offen offset:0 sc1
    buffer_load_dwordx2 v[146:147], v5, s[4:7], s35 offen offset:512 sc1
    buffer_load_dwordx2 v[148:149], v5, s[4:7], s35 offen offset:1024 sc1
    buffer_load_dwordx2 v[150:151], v5, s[4:7], s35 offen offset:1536 sc1
    v_max3_f32 v8, v168, v169, v170
    v_max3_f32 v8, v8, v171, v172
    v_max3_f32 v8, v8, v173, v174
    v_max3_f32 v8, v8, v175, v176
    v_max3_f32 v8, v8, v177, v178
    v_max3_f32 v8, v8, v179, v180
    v_max3_f32 v8, v8, v181, v182
    v_max_f32 v8, v8, v183
    s_waitcnt vmcnt(4)
    ds_read_b64_tr_b16 v[112:113], v4 offset:0
    ds_read_b64_tr_b16 v[114:115], v4 offset:32
    ds_read_b64_tr_b16 v[116:117], v4 offset:64
    ds_read_b64_tr_b16 v[118:119], v4 offset:96
    ds_read_b64_tr_b16 v[120:121], v4 offset:512
    ds_read_b64_tr_b16 v[122:123], v4 offset:544
    ds_read_b64_tr_b16 v[124:125], v4 offset:576
    ds_read_b64_tr_b16 v[126:127], v4 offset:608
    ds_read_b64_tr_b16 v[128:129], v4 offset:1024
    ds_read_b64_tr_b16 v[130:131], v4 offset:1056
    ds_read_b64_tr_b16 v[132:133], v4 offset:1088
    ds_read_b64_tr_b16 v[134:135], v4 offset:1120
    ds_read_b64_tr_b16 v[136:137], v4 offset:1536
    ds_read_b64_tr_b16 v[138:139], v4 offset:1568
    ds_read_b64_tr_b16 v[140:141], v4 offset:1600
    ds_read_b64_tr_b16 v[142:143], v4 offset:1632
    s_waitcnt lgkmcnt(14)
    v_mfma_f32_32x32x16_bf16 v[184:199], v[112:115], v[16:19], 0
    s_waitcnt lgkmcnt(12)
    v_mfma_f32_32x32x16_bf16 v[184:199], v[116:119], v[20:23], v[184:199]
    s_waitcnt lgkmcnt(10)
    v_mfma_f32_32x32x16_bf16 v[184:199], v[120:123], v[24:27], v[184:199]
    s_waitcnt lgkmcnt(8)
    v_mfma_f32_32x32x16_bf16 v[184:199], v[124:127], v[28:31], v[184:199]
    s_waitcnt lgkmcnt(6)
    v_mfma_f32_32x32x16_bf16 v[184:199], v[128:131], v[32:35], v[184:199]
    s_waitcnt lgkmcnt(4)
    v_mfma_f32_32x32x16_bf16 v[184:199], v[132:135], v[36:39], v[184:199]
    s_waitcnt lgkmcnt(2)
    v_mfma_f32_32x32x16_bf16 v[184:199], v[136:139], v[40:43], v[184:199]
    s_waitcnt lgkmcnt(0)
    v_mfma_f32_32x32x16_bf16 v[184:199], v[140:143], v[44:47], v[184:199]
    s_nop 11
    v_max3_f32 v8, v8, v184, v185
    v_max3_f32 v8, v8, v186, v187
    v_mov_b32 v9, v8
    s_nop 1
    v_permlane32_swap_b32 v8, v9
    v_max_f32 v8, v8, v9
    v_mul_f32 v8, s68, v8
    v_fma_f32 v168, v168, s68, -v8
    v_fma_f32 v169, v169, s68, -v8
    v_fma_f32 v170, v170, s68, -v8
    v_fma_f32 v171, v171, s68, -v8
    v_fma_f32 v172, v172, s68, -v8
    v_fma_f32 v173, v173, s68, -v8
    v_fma_f32 v174, v174, s68, -v8
    v_fma_f32 v175, v175, s68, -v8
    v_fma_f32 v176, v176, s68, -v8
    v_fma_f32 v177, v177, s68, -v8
    v_fma_f32 v178, v178, s68, -v8
    v_fma_f32 v179, v179, s68, -v8
    v_fma_f32 v180, v180, s68, -v8
    v_fma_f32 v181, v181, s68, -v8
    v_fma_f32 v182, v182, s68, -v8
    v_fma_f32 v183, v183, s68, -v8
    v_fma_f32 v184, v184, s68, -v8
    v_fma_f32 v185, v185, s68, -v8
    v_fma_f32 v186, v186, s68, -v8
    v_fma_f32 v187, v187, s68, -v8
    v_exp_f32 v168, v168
    v_exp_f32 v169, v169
    v_exp_f32 v170, v170
    v_exp_f32 v171, v171
    v_exp_f32 v172, v172
    v_exp_f32 v173, v173
    v_exp_f32 v174, v174
    v_exp_f32 v175, v175
    v_exp_f32 v176, v176
    v_exp_f32 v177, v177
    v_exp_f32 v178, v178
    v_exp_f32 v179, v179
    v_exp_f32 v180, v180
    v_exp_f32 v181, v181
    v_exp_f32 v182, v182
    v_exp_f32 v183, v183
    v_exp_f32 v184, v184
    v_exp_f32 v185, v185
    v_exp_f32 v186, v186
    v_exp_f32 v187, v187
    v_pk_add_f32 v[8:9], v[168:169], v[170:171]
    v_pk_add_f32 v[8:9], v[8:9], v[172:173]
    v_pk_add_f32 v[8:9], v[8:9], v[174:175]
    v_pk_add_f32 v[8:9], v[8:9], v[176:177]
    v_pk_add_f32 v[8:9], v[8:9], v[178:179]
    v_pk_add_f32 v[8:9], v[8:9], v[180:181]
    v_pk_add_f32 v[8:9], v[8:9], v[182:183]
    v_pk_add_f32 v[8:9], v[8:9], v[184:185]
    v_pk_add_f32 v[8:9], v[8:9], v[186:187]
    v_add_f32 v8, v8, v9
    v_mov_b32 v9, v8
    s_nop 1
    v_permlane32_swap_b32 v8, v9
    v_add_f32 v8, v8, v9
    v_rcp_f32 v8, v8
    s_nop 0
    v_pk_mul_f32 v[168:169], v[168:169], v[8:9] op_sel_hi:[1,0]
    s_nop 0
    v_cvt_pk_bf16_f32 v188, v168, v169
    v_pk_mul_f32 v[170:171], v[170:171], v[8:9] op_sel_hi:[1,0]
    s_nop 0
    v_cvt_pk_bf16_f32 v189, v170, v171
    v_pk_mul_f32 v[172:173], v[172:173], v[8:9] op_sel_hi:[1,0]
    s_nop 0
    v_cvt_pk_bf16_f32 v190, v172, v173
    v_pk_mul_f32 v[174:175], v[174:175], v[8:9] op_sel_hi:[1,0]
    s_nop 0
    v_cvt_pk_bf16_f32 v191, v174, v175
    v_pk_mul_f32 v[176:177], v[176:177], v[8:9] op_sel_hi:[1,0]
    s_nop 0
    v_cvt_pk_bf16_f32 v192, v176, v177
    v_pk_mul_f32 v[178:179], v[178:179], v[8:9] op_sel_hi:[1,0]
    s_nop 0
    v_cvt_pk_bf16_f32 v193, v178, v179
    v_pk_mul_f32 v[180:181], v[180:181], v[8:9] op_sel_hi:[1,0]
    s_nop 0
    v_cvt_pk_bf16_f32 v194, v180, v181
    v_pk_mul_f32 v[182:183], v[182:183], v[8:9] op_sel_hi:[1,0]
    s_nop 0
    v_cvt_pk_bf16_f32 v195, v182, v183
    v_pk_mul_f32 v[184:185], v[184:185], v[8:9] op_sel_hi:[1,0]
    s_nop 0
    v_cvt_pk_bf16_f32 v196, v184, v185
    v_pk_mul_f32 v[186:187], v[186:187], v[8:9] op_sel_hi:[1,0]
    s_nop 0
    v_cvt_pk_bf16_f32 v197, v186, v187
    s_waitcnt vmcnt(3)
    s_nop 0
    v_mfma_f32_32x32x8_bf16 v[16:31], v[144:145], v[196:197], 0
    s_waitcnt vmcnt(2)
    v_mfma_f32_32x32x8_bf16 v[32:47], v[146:147], v[196:197], 0
    s_waitcnt vmcnt(1)
    v_mfma_f32_32x32x8_bf16 v[48:63], v[148:149], v[196:197], 0
    s_waitcnt vmcnt(0)
    v_mfma_f32_32x32x8_bf16 v[64:79], v[150:151], v[196:197], 0
    v_mfma_f32_32x32x16_bf16 v[16:31], v[80:83], v[188:191], v[16:31]
    v_mfma_f32_32x32x16_bf16 v[16:31], v[84:87], v[192:195], v[16:31]
    v_mfma_f32_32x32x16_bf16 v[32:47], v[88:91], v[188:191], v[32:47]
    v_mfma_f32_32x32x16_bf16 v[32:47], v[92:95], v[192:195], v[32:47]
    v_mfma_f32_32x32x16_bf16 v[48:63], v[96:99], v[188:191], v[48:63]
    v_mfma_f32_32x32x16_bf16 v[48:63], v[100:103], v[192:195], v[48:63]
    v_mfma_f32_32x32x16_bf16 v[64:79], v[104:107], v[188:191], v[64:79]
    v_mfma_f32_32x32x16_bf16 v[64:79], v[108:111], v[192:195], v[64:79]
    s_mul_i32 s35, s30, 16777216
    s_add_u32 s35, s35, 67108864
    s_lshl_b32 s36, s44, 18
    s_add_u32 s35, s35, s36
    s_lshl_b32 s36, s40, 12
    s_add_u32 s35, s35, s36
    v_cvt_pk_bf16_f32 v112, v16, v17
    v_cvt_pk_bf16_f32 v113, v18, v19
    v_cvt_pk_bf16_f32 v114, v20, v21
    v_cvt_pk_bf16_f32 v115, v22, v23
    v_cvt_pk_bf16_f32 v116, v24, v25
    v_cvt_pk_bf16_f32 v117, v26, v27
    v_cvt_pk_bf16_f32 v118, v28, v29
    v_cvt_pk_bf16_f32 v119, v30, v31
    v_cvt_pk_bf16_f32 v120, v32, v33
    v_cvt_pk_bf16_f32 v121, v34, v35
    v_cvt_pk_bf16_f32 v122, v36, v37
    v_cvt_pk_bf16_f32 v123, v38, v39
    v_cvt_pk_bf16_f32 v124, v40, v41
    v_cvt_pk_bf16_f32 v125, v42, v43
    v_cvt_pk_bf16_f32 v126, v44, v45
    v_cvt_pk_bf16_f32 v127, v46, v47
    v_cvt_pk_bf16_f32 v128, v48, v49
    v_cvt_pk_bf16_f32 v129, v50, v51
    v_cvt_pk_bf16_f32 v130, v52, v53
    v_cvt_pk_bf16_f32 v131, v54, v55
    v_cvt_pk_bf16_f32 v132, v56, v57
    v_cvt_pk_bf16_f32 v133, v58, v59
    v_cvt_pk_bf16_f32 v134, v60, v61
    v_cvt_pk_bf16_f32 v135, v62, v63
    v_cvt_pk_bf16_f32 v136, v64, v65
    v_cvt_pk_bf16_f32 v137, v66, v67
    v_cvt_pk_bf16_f32 v138, v68, v69
    v_cvt_pk_bf16_f32 v139, v70, v71
    v_cvt_pk_bf16_f32 v140, v72, v73
    v_cvt_pk_bf16_f32 v141, v74, v75
    v_cvt_pk_bf16_f32 v142, v76, v77
    v_cvt_pk_bf16_f32 v143, v78, v79
    buffer_store_dwordx4 v[112:115], v6, s[4:7], s35 offen offset:0 sc1
    buffer_store_dwordx4 v[116:119], v6, s[4:7], s35 offen offset:512 sc1
    buffer_store_dwordx4 v[120:123], v6, s[4:7], s35 offen offset:1024 sc1
    buffer_store_dwordx4 v[124:127], v6, s[4:7], s35 offen offset:1536 sc1
    buffer_store_dwordx4 v[128:131], v6, s[4:7], s35 offen offset:2048 sc1
    buffer_store_dwordx4 v[132:135], v6, s[4:7], s35 offen offset:2560 sc1
    buffer_store_dwordx4 v[136:139], v6, s[4:7], s35 offen offset:3072 sc1
    buffer_store_dwordx4 v[140:143], v6, s[4:7], s35 offen offset:3584 sc1
    s_waitcnt vmcnt(0)
    s_lshl_b32 s32, s28, 5
    s_add_u32 s32, s32, s29
    s_lshl_b32 s32, s32, 2
    s_add_u32 s32, s32, 1171456
    v_mov_b32 v8, s49
    s_mov_b64 exec, 1
    buffer_store_dword v8, off, s[4:7], s32 sc1
    s_mov_b64 exec, -1
F_324:
    s_add_u32 s49, s49, 1
    s_add_u32 s44, s44, 4
    s_cmp_lt_u32 s44, 64
    s_cbranch_scc1 AT_319
R_318:
    s_and_b32 s32, s28, 0xbf
    s_cmp_ge_u32 s32, 60
    s_cbranch_scc1 R_325
    s_and_b32 s34, s28, 63
    s_mul_i32 s68, s34, 3277
    s_lshr_b32 s68, s68, 16
    s_mul_i32 s69, s68, 20
    s_sub_u32 s69, s34, s69
    s_cmp_ge_u32 s28, 64
    s_cselect_b32 s34, 75, 0
    s_add_u32 s68, s68, s34
    s_load_dwordx2 s[16:17], s[0:1], 64
    s_mov_b32 s18, 5242880
    s_mov_b32 s19, 0x20000
    s_waitcnt lgkmcnt(0)
    v_bfe_u32 v2, v1, 2, 4
    v_mul_u32_u24 v2, 1280, v2
    v_bfe_u32 v8, v1, 0, 2
    v_lshl_add_u32 v2, v8, 4, v2
    s_lshl_b32 s36, s29, 14
    v_bfe_u32 v3, v1, 4, 2
    v_mul_u32_u24 v3, 512, v3
    v_bfe_u32 v8, v1, 2, 2
    v_lshl_add_u32 v3, v8, 6, v3
    v_bfe_u32 v8, v1, 0, 2
    v_lshl_add_u32 v3, v8, 4, v3
    v_add_u32 v3, s36, v3
    s_mul_i32 s34, s29, 1310720
    s_lshl_b32 s35, s69, 6
    s_add_u32 s34, s34, s35
    s_add_u32 m0, s36, 0
    s_add_u32 s35, s34, 0
    buffer_load_dwordx4 v2, s[16:19], s35 offen lds
    s_add_u32 m0, s36, 1024
    s_add_u32 s35, s34, 20480
    buffer_load_dwordx4 v2, s[16:19], s35 offen lds
    s_add_u32 m0, s36, 2048
    s_add_u32 s35, s34, 40960
    buffer_load_dwordx4 v2, s[16:19], s35 offen lds
    s_add_u32 m0, s36, 3072
    s_add_u32 s35, s34, 61440
    buffer_load_dwordx4 v2, s[16:19], s35 offen lds
    s_add_u32 m0, s36, 4096
    s_add_u32 s35, s34, 81920
    buffer_load_dwordx4 v2, s[16:19], s35 offen lds
    s_add_u32 m0, s36, 5120
    s_add_u32 s35, s34, 102400
    buffer_load_dwordx4 v2, s[16:19], s35 offen lds
    s_add_u32 m0, s36, 6144
    s_add_u32 s35, s34, 122880
    buffer_load_dwordx4 v2, s[16:19], s35 offen lds
    s_add_u32 m0, s36, 7168
    s_add_u32 s35, s34, 143360
    buffer_load_dwordx4 v2, s[16:19], s35 offen lds
    s_add_u32 m0, s36, 8192
    s_add_u32 s35, s34, 163840
    buffer_load_dwordx4 v2, s[16:19], s35 offen lds
    s_add_u32 m0, s36, 9216
    s_add_u32 s35, s34, 184320
    buffer_load_dwordx4 v2, s[16:19], s35 offen lds
    s_add_u32 m0, s36, 10240
    s_add_u32 s35, s34, 204800
    buffer_load_dwordx4 v2, s[16:19], s35 offen lds
    s_add_u32 m0, s36, 11264
    s_add_u32 s35, s34, 225280
    buffer_load_dwordx4 v2, s[16:19], s35 offen lds
    s_add_u32 m0, s36, 12288
    s_add_u32 s35, s34, 245760
    buffer_load_dwordx4 v2, s[16:19], s35 offen lds
    s_add_u32 m0, s36, 13312
    s_add_u32 s35, s34, 266240
    buffer_load_dwordx4 v2, s[16:19], s35 offen lds
    s_add_u32 m0, s36, 14336
    s_add_u32 s35, s34, 286720
    buffer_load_dwordx4 v2, s[16:19], s35 offen lds
    s_add_u32 m0, s36, 15360
    s_add_u32 s35, s34, 307200
    buffer_load_dwordx4 v2, s[16:19], s35 offen lds
    s_waitcnt vmcnt(0)
    ds_read_b64_tr_b16 v[96:97], v3 offset:0
    ds_read_b64_tr_b16 v[98:99], v3 offset:256
    ds_read_b64_tr_b16 v[100:101], v3 offset:8
    ds_read_b64_tr_b16 v[102:103], v3 offset:264
    ds_read_b64_tr_b16 v[104:105], v3 offset:2048
    ds_read_b64_tr_b16 v[106:107], v3 offset:2304
    ds_read_b64_tr_b16 v[108:109], v3 offset:2056
    ds_read_b64_tr_b16 v[110:111], v3 offset:2312
    ds_read_b64_tr_b16 v[112:113], v3 offset:4096
    ds_read_b64_tr_b16 v[114:115], v3 offset:4352
    ds_read_b64_tr_b16 v[116:117], v3 offset:4104
    ds_read_b64_tr_b16 v[118:119], v3 offset:4360
    ds_read_b64_tr_b16 v[120:121], v3 offset:6144
    ds_read_b64_tr_b16 v[122:123], v3 offset:6400
    ds_read_b64_tr_b16 v[124:125], v3 offset:6152
    ds_read_b64_tr_b16 v[126:127], v3 offset:6408
    ds_read_b64_tr_b16 v[128:129], v3 offset:8192
    ds_read_b64_tr_b16 v[130:131], v3 offset:8448
    ds_read_b64_tr_b16 v[132:133], v3 offset:8200
    ds_read_b64_tr_b16 v[134:135], v3 offset:8456
    ds_read_b64_tr_b16 v[136:137], v3 offset:10240
    ds_read_b64_tr_b16 v[138:139], v3 offset:10496
    ds_read_b64_tr_b16 v[140:141], v3 offset:10248
    ds_read_b64_tr_b16 v[142:143], v3 offset:10504
    ds_read_b64_tr_b16 v[144:145], v3 offset:12288
    ds_read_b64_tr_b16 v[146:147], v3 offset:12544
    ds_read_b64_tr_b16 v[148:149], v3 offset:12296
    ds_read_b64_tr_b16 v[150:151], v3 offset:12552
    ds_read_b64_tr_b16 v[152:153], v3 offset:14336
    ds_read_b64_tr_b16 v[154:155], v3 offset:14592
    ds_read_b64_tr_b16 v[156:157], v3 offset:14344
    ds_read_b64_tr_b16 v[158:159], v3 offset:14600
    s_waitcnt lgkmcnt(0)
    s_add_u32 m0, s36, 0
    s_add_u32 s35, s34, 327680
    buffer_load_dwordx4 v2, s[16:19], s35 offen lds
    s_add_u32 m0, s36, 1024
    s_add_u32 s35, s34, 348160
    buffer_load_dwordx4 v2, s[16:19], s35 offen lds
    s_add_u32 m0, s36, 2048
    s_add_u32 s35, s34, 368640
    buffer_load_dwordx4 v2, s[16:19], s35 offen lds
    s_add_u32 m0, s36, 3072
    s_add_u32 s35, s34, 389120
    buffer_load_dwordx4 v2, s[16:19], s35 offen lds
    s_add_u32 m0, s36, 4096
    s_add_u32 s35, s34, 409600
    buffer_load_dwordx4 v2, s[16:19], s35 offen lds
    s_add_u32 m0, s36, 5120
    s_add_u32 s35, s34, 430080
    buffer_load_dwordx4 v2, s[16:19], s35 offen lds
    s_add_u32 m0, s36, 6144
    s_add_u32 s35, s34, 450560
    buffer_load_dwordx4 v2, s[16:19], s35 offen lds
    s_add_u32 m0, s36, 7168
    s_add_u32 s35, s34, 471040
    buffer_load_dwordx4 v2, s[16:19], s35 offen lds
    s_add_u32 m0, s36, 8192
    s_add_u32 s35, s34, 491520
    buffer_load_dwordx4 v2, s[16:19], s35 offen lds
    s_add_u32 m0, s36, 9216
    s_add_u32 s35, s34, 512000
    buffer_load_dwordx4 v2, s[16:19], s35 offen lds
    s_add_u32 m0, s36, 10240
    s_add_u32 s35, s34, 532480
    buffer_load_dwordx4 v2, s[16:19], s35 offen lds
    s_add_u32 m0, s36, 11264
    s_add_u32 s35, s34, 552960
    buffer_load_dwordx4 v2, s[16:19], s35 offen lds
    s_add_u32 m0, s36, 12288
    s_add_u32 s35, s34, 573440
    buffer_load_dwordx4 v2, s[16:19], s35 offen lds
    s_add_u32 m0, s36, 13312
    s_add_u32 s35, s34, 593920
    buffer_load_dwordx4 v2, s[16:19], s35 offen lds
    s_add_u32 m0, s36, 14336
    s_add_u32 s35, s34, 614400
    buffer_load_dwordx4 v2, s[16:19], s35 offen lds
    s_add_u32 m0, s36, 15360
    s_add_u32 s35, s34, 634880
    buffer_load_dwordx4 v2, s[16:19], s35 offen lds
    s_waitcnt vmcnt(0)
    ds_read_b64_tr_b16 v[160:161], v3 offset:0
    ds_read_b64_tr_b16 v[162:163], v3 offset:256
    ds_read_b64_tr_b16 v[164:165], v3 offset:8
    ds_read_b64_tr_b16 v[166:167], v3 offset:264
    ds_read_b64_tr_b16 v[168:169], v3 offset:2048
    ds_read_b64_tr_b16 v[170:171], v3 offset:2304
    ds_read_b64_tr_b16 v[172:173], v3 offset:2056
    ds_read_b64_tr_b16 v[174:175], v3 offset:2312
    ds_read_b64_tr_b16 v[176:177], v3 offset:4096
    ds_read_b64_tr_b16 v[178:179], v3 offset:4352
    ds_read_b64_tr_b16 v[180:181], v3 offset:4104
    ds_read_b64_tr_b16 v[182:183], v3 offset:4360
    ds_read_b64_tr_b16 v[184:185], v3 offset:6144
    ds_read_b64_tr_b16 v[186:187], v3 offset:6400
    ds_read_b64_tr_b16 v[188:189], v3 offset:6152
    ds_read_b64_tr_b16 v[190:191], v3 offset:6408
    ds_read_b64_tr_b16 v[192:193], v3 offset:8192
    ds_read_b64_tr_b16 v[194:195], v3 offset:8448
    ds_read_b64_tr_b16 v[196:197], v3 offset:8200
    ds_read_b64_tr_b16 v[198:199], v3 offset:8456
    ds_read_b64_tr_b16 v[200:201], v3 offset:10240
    ds_read_b64_tr_b16 v[202:203], v3 offset:10496
    ds_read_b64_tr_b16 v[204:205], v3 offset:10248
    ds_read_b64_tr_b16 v[206:207], v3 offset:10504
    ds_read_b64_tr_b16 v[208:209], v3 offset:12288
    ds_read_b64_tr_b16 v[210:211], v3 offset:12544
    ds_read_b64_tr_b16 v[212:213], v3 offset:12296
    ds_read_b64_tr_b16 v[214:215], v3 offset:12552
    ds_read_b64_tr_b16 v[216:217], v3 offset:14336
    ds_read_b64_tr_b16 v[218:219], v3 offset:14592
    ds_read_b64_tr_b16 v[220:221], v3 offset:14344
    ds_read_b64_tr_b16 v[222:223], v3 offset:14600
    s_waitcnt lgkmcnt(0)
    s_add_u32 m0, s36, 0
    s_add_u32 s35, s34, 655360
    buffer_load_dwordx4 v2, s[16:19], s35 offen lds
    s_add_u32 m0, s36, 1024
    s_add_u32 s35, s34, 675840
    buffer_load_dwordx4 v2, s[16:19], s35 offen lds
    s_add_u32 m0, s36, 2048
    s_add_u32 s35, s34, 696320
    buffer_load_dwordx4 v2, s[16:19], s35 offen lds
    s_add_u32 m0, s36, 3072
    s_add_u32 s35, s34, 716800
    buffer_load_dwordx4 v2, s[16:19], s35 offen lds
    s_add_u32 m0, s36, 4096
    s_add_u32 s35, s34, 737280
    buffer_load_dwordx4 v2, s[16:19], s35 offen lds
    s_add_u32 m0, s36, 5120
    s_add_u32 s35, s34, 757760
    buffer_load_dwordx4 v2, s[16:19], s35 offen lds
    s_add_u32 m0, s36, 6144
    s_add_u32 s35, s34, 778240
    buffer_load_dwordx4 v2, s[16:19], s35 offen lds
    s_add_u32 m0, s36, 7168
    s_add_u32 s35, s34, 798720
    buffer_load_dwordx4 v2, s[16:19], s35 offen lds
    s_add_u32 m0, s36, 8192
    s_add_u32 s35, s34, 819200
    buffer_load_dwordx4 v2, s[16:19], s35 offen lds
    s_add_u32 m0, s36, 9216
    s_add_u32 s35, s34, 839680
    buffer_load_dwordx4 v2, s[16:19], s35 offen lds
    s_add_u32 m0, s36, 10240
    s_add_u32 s35, s34, 860160
    buffer_load_dwordx4 v2, s[16:19], s35 offen lds
    s_add_u32 m0, s36, 11264
    s_add_u32 s35, s34, 880640
    buffer_load_dwordx4 v2, s[16:19], s35 offen lds
    s_add_u32 m0, s36, 12288
    s_add_u32 s35, s34, 901120
    buffer_load_dwordx4 v2, s[16:19], s35 offen lds
    s_add_u32 m0, s36, 13312
    s_add_u32 s35, s34, 921600
    buffer_load_dwordx4 v2, s[16:19], s35 offen lds
    s_add_u32 m0, s36, 14336
    s_add_u32 s35, s34, 942080
    buffer_load_dwordx4 v2, s[16:19], s35 offen lds
    s_add_u32 m0, s36, 15360
    s_add_u32 s35, s34, 962560
    buffer_load_dwordx4 v2, s[16:19], s35 offen lds
    s_waitcnt vmcnt(0)
    ds_read_b64_tr_b16 v[224:225], v3 offset:0
    ds_read_b64_tr_b16 v[226:227], v3 offset:256
    ds_read_b64_tr_b16 v[228:229], v3 offset:8
    ds_read_b64_tr_b16 v[230:231], v3 offset:264
    ds_read_b64_tr_b16 v[232:233], v3 offset:2048
    ds_read_b64_tr_b16 v[234:235], v3 offset:2304
    ds_read_b64_tr_b16 v[236:237], v3 offset:2056
    ds_read_b64_tr_b16 v[238:239], v3 offset:2312
    ds_read_b64_tr_b16 v[240:241], v3 offset:4096
    ds_read_b64_tr_b16 v[242:243], v3 offset:4352
    ds_read_b64_tr_b16 v[244:245], v3 offset:4104
    ds_read_b64_tr_b16 v[246:247], v3 offset:4360
    ds_read_b64_tr_b16 v[248:249], v3 offset:6144
    ds_read_b64_tr_b16 v[250:251], v3 offset:6400
    ds_read_b64_tr_b16 v[252:253], v3 offset:6152
    ds_read_b64_tr_b16 v[254:255], v3 offset:6408
    ds_read_b64_tr_b16 a[160:161], v3 offset:8192
    ds_read_b64_tr_b16 a[162:163], v3 offset:8448
    ds_read_b64_tr_b16 a[164:165], v3 offset:8200
    ds_read_b64_tr_b16 a[166:167], v3 offset:8456
    ds_read_b64_tr_b16 a[168:169], v3 offset:10240
    ds_read_b64_tr_b16 a[170:171], v3 offset:10496
    ds_read_b64_tr_b16 a[172:173], v3 offset:10248
    ds_read_b64_tr_b16 a[174:175], v3 offset:10504
    ds_read_b64_tr_b16 a[176:177], v3 offset:12288
    ds_read_b64_tr_b16 a[178:179], v3 offset:12544
    ds_read_b64_tr_b16 a[180:181], v3 offset:12296
    ds_read_b64_tr_b16 a[182:183], v3 offset:12552
    ds_read_b64_tr_b16 a[184:185], v3 offset:14336
    ds_read_b64_tr_b16 a[186:187], v3 offset:14592
    ds_read_b64_tr_b16 a[188:189], v3 offset:14344
    ds_read_b64_tr_b16 a[190:191], v3 offset:14600
    s_waitcnt lgkmcnt(0)
    s_add_u32 m0, s36, 0
    s_add_u32 s35, s34, 983040
    buffer_load_dwordx4 v2, s[16:19], s35 offen lds
    s_add_u32 m0, s36, 1024
    s_add_u32 s35, s34, 1003520
    buffer_load_dwordx4 v2, s[16:19], s35 offen lds
    s_add_u32 m0, s36, 2048
    s_add_u32 s35, s34, 1024000
    buffer_load_dwordx4 v2, s[16:19], s35 offen lds
    s_add_u32 m0, s36, 3072
    s_add_u32 s35, s34, 1044480
    buffer_load_dwordx4 v2, s[16:19], s35 offen lds
    s_add_u32 m0, s36, 4096
    s_add_u32 s35, s34, 1064960
    buffer_load_dwordx4 v2, s[16:19], s35 offen lds
    s_add_u32 m0, s36, 5120
    s_add_u32 s35, s34, 1085440
    buffer_load_dwordx4 v2, s[16:19], s35 offen lds
    s_add_u32 m0, s36, 6144
    s_add_u32 s35, s34, 1105920
    buffer_load_dwordx4 v2, s[16:19], s35 offen lds
    s_add_u32 m0, s36, 7168
    s_add_u32 s35, s34, 1126400
    buffer_load_dwordx4 v2, s[16:19], s35 offen lds
    s_add_u32 m0, s36, 8192
    s_add_u32 s35, s34, 1146880
    buffer_load_dwordx4 v2, s[16:19], s35 offen lds
    s_add_u32 m0, s36, 9216
    s_add_u32 s35, s34, 1167360
    buffer_load_dwordx4 v2, s[16:19], s35 offen lds
    s_add_u32 m0, s36, 10240
    s_add_u32 s35, s34, 1187840
    buffer_load_dwordx4 v2, s[16:19], s35 offen lds
    s_add_u32 m0, s36, 11264
    s_add_u32 s35, s34, 1208320
    buffer_load_dwordx4 v2, s[16:19], s35 offen lds
    s_add_u32 m0, s36, 12288
    s_add_u32 s35, s34, 1228800
    buffer_load_dwordx4 v2, s[16:19], s35 offen lds
    s_add_u32 m0, s36, 13312
    s_add_u32 s35, s34, 1249280
    buffer_load_dwordx4 v2, s[16:19], s35 offen lds
    s_add_u32 m0, s36, 14336
    s_add_u32 s35, s34, 1269760
    buffer_load_dwordx4 v2, s[16:19], s35 offen lds
    s_add_u32 m0, s36, 15360
    s_add_u32 s35, s34, 1290240
    buffer_load_dwordx4 v2, s[16:19], s35 offen lds
    s_waitcnt vmcnt(0)
    ds_read_b64_tr_b16 a[192:193], v3 offset:0
    ds_read_b64_tr_b16 a[194:195], v3 offset:256
    ds_read_b64_tr_b16 a[196:197], v3 offset:8
    ds_read_b64_tr_b16 a[198:199], v3 offset:264
    ds_read_b64_tr_b16 a[200:201], v3 offset:2048
    ds_read_b64_tr_b16 a[202:203], v3 offset:2304
    ds_read_b64_tr_b16 a[204:205], v3 offset:2056
    ds_read_b64_tr_b16 a[206:207], v3 offset:2312
    ds_read_b64_tr_b16 a[208:209], v3 offset:4096
    ds_read_b64_tr_b16 a[210:211], v3 offset:4352
    ds_read_b64_tr_b16 a[212:213], v3 offset:4104
    ds_read_b64_tr_b16 a[214:215], v3 offset:4360
    ds_read_b64_tr_b16 a[216:217], v3 offset:6144
    ds_read_b64_tr_b16 a[218:219], v3 offset:6400
    ds_read_b64_tr_b16 a[220:221], v3 offset:6152
    ds_read_b64_tr_b16 a[222:223], v3 offset:6408
    ds_read_b64_tr_b16 a[224:225], v3 offset:8192
    ds_read_b64_tr_b16 a[226:227], v3 offset:8448
    ds_read_b64_tr_b16 a[228:229], v3 offset:8200
    ds_read_b64_tr_b16 a[230:231], v3 offset:8456
    ds_read_b64_tr_b16 a[232:233], v3 offset:10240
    ds_read_b64_tr_b16 a[234:235], v3 offset:10496
    ds_read_b64_tr_b16 a[236:237], v3 offset:10248
    ds_read_b64_tr_b16 a[238:239], v3 offset:10504
    ds_read_b64_tr_b16 a[240:241], v3 offset:12288
    ds_read_b64_tr_b16 a[242:243], v3 offset:12544
    ds_read_b64_tr_b16 a[244:245], v3 offset:12296
    ds_read_b64_tr_b16 a[246:247], v3 offset:12552
    ds_read_b64_tr_b16 a[248:249], v3 offset:14336
    ds_read_b64_tr_b16 a[250:251], v3 offset:14592
    ds_read_b64_tr_b16 a[252:253], v3 offset:14344
    ds_read_b64_tr_b16 a[254:255], v3 offset:14600
    s_waitcnt lgkmcnt(0)
    v_bfe_u32 v4, v1, 4, 2
    v_mul_u32_u24 v4, 512, v4
    v_bfe_u32 v8, v1, 0, 4
    v_lshl_add_u32 v4, v8, 4, v4
    v_bfe_u32 v5, v1, 0, 2
    v_mul_u32_u24 v5, 1280, v5
    v_bfe_u32 v8, v1, 2, 1
    v_mul_u32_u24 v8, 10240, v8
    v_add_u32 v5, v5, v8
    v_bfe_u32 v8, v1, 3, 1
    v_mul_u32_u24 v8, 5120, v8
    v_add_u32 v5, v5, v8
    v_bfe_u32 v8, v1, 4, 2
    v_lshl_add_u32 v5, v8, 4, v5
    s_lshl_b32 s34, s29, 10
    s_add_u32 s34, s34, 1187840
    v_bfe_u32 v6, v1, 0, 3
    v_mul_u32_u24 v6, 128, v6
    v_add_u32 v6, s34, v6
    s_lshl_b32 s34, s29, 11
    v_add_u32 v7, s34, v0
    s_mov_b32 s45, s68
    s_mov_b32 s56, 0
    s_mov_b32 s75, 0
    s_lshl_b32 s53, s28, 7
    s_add_u32 s53, s53, 1196032
    s_lshr_b32 s57, s45, 3
    s_add_u32 s57, s57, s61
    s_add_u32 s57, s57, 1
    s_and_b32 s59, s45, 6
    s_lshl_b32 s59, s59, 1
    s_waitcnt vmcnt(0) lgkmcnt(0)
    s_barrier
G4_329:
    s_mov_b32 s48, 0
P_332:
    buffer_load_dword v8, v6, s[4:7], s59 offen sc1
    s_waitcnt vmcnt(0)
    v_cmp_gt_u32 vcc, s57, v8
    s_cbranch_vccz P_333
    s_add_u32 s48, s48, 1
    s_cmp_gt_u32 s48, 200000
    s_cbranch_scc1 L_end
    s_sleep 1
    s_branch P_332
P_333:
G4_326:
    s_mov_b32 s44, s45
    s_mul_i32 s54, s30, 16777216
    s_add_u32 s54, s54, 67108864
    s_lshl_b32 s34, s44, 17
    s_add_u32 s54, s54, s34
    s_lshl_b32 s34, s29, 15
    s_add_u32 s54, s54, s34
    buffer_load_dwordx4 v[32:35], v0, s[4:7], s54 offen offset:0 sc1
    buffer_load_dwordx4 v[36:39], v0, s[4:7], s54 offen offset:1024 sc1
    buffer_load_dwordx4 v[40:43], v0, s[4:7], s54 offen offset:2048 sc1
    buffer_load_dwordx4 v[44:47], v0, s[4:7], s54 offen offset:3072 sc1
    s_add_u32 s54, s54, 4096
    buffer_load_dwordx4 v[48:51], v0, s[4:7], s54 offen offset:0 sc1
    buffer_load_dwordx4 v[52:55], v0, s[4:7], s54 offen offset:1024 sc1
    buffer_load_dwordx4 v[56:59], v0, s[4:7], s54 offen offset:2048 sc1
    buffer_load_dwordx4 v[60:63], v0, s[4:7], s54 offen offset:3072 sc1
    s_add_u32 s54, s54, 4096
    buffer_load_dwordx4 v[64:67], v0, s[4:7], s54 offen offset:0 sc1
    buffer_load_dwordx4 v[68:71], v0, s[4:7], s54 offen offset:1024 sc1
    buffer_load_dwordx4 v[72:75], v0, s[4:7], s54 offen offset:2048 sc1
    buffer_load_dwordx4 v[76:79], v0, s[4:7], s54 offen offset:3072 sc1
    s_add_u32 s54, s54, 4096
    buffer_load_dwordx4 v[80:83], v0, s[4:7], s54 offen offset:0 sc1
    buffer_load_dwordx4 v[84:87], v0, s[4:7], s54 offen offset:1024 sc1
    buffer_load_dwordx4 v[88:91], v0, s[4:7], s54 offen offset:2048 sc1
    buffer_load_dwordx4 v[92:95], v0, s[4:7], s54 offen offset:3072 sc1
    s_lshr_b32 s40, s44, 1
    s_and_b32 s41, s44, 1
    s_mul_i32 s42, s40, 40960
    s_lshl_b32 s34, s69, 11
    s_add_u32 s43, s42, s34
    s_lshl_b32 s34, s41, 8
    s_add_u32 s43, s43, s34
    s_mul_i32 s34, s30, 6291456
    s_add_u32 s34, s34, 11534336
    s_add_u32 s34, s34, s43
    buffer_load_dwordx4 v[24:27], v4, s[4:7], s34 offen sc1
    s_cmp_lt_u32 s44, 72
    s_cselect_b32 s34, 3, 6
    s_add_u32 s45, s44, s34
    s_lshr_b32 s57, s45, 3
    s_add_u32 s57, s57, s61
    s_add_u32 s57, s57, 1
    s_and_b32 s59, s45, 6
    s_lshl_b32 s59, s59, 1
    s_waitcnt vmcnt(16)
    v_mfma_f32_16x16x32_bf16 v[16:19], v[96:99], v[32:35], 0
    v_mfma_f32_16x16x32_bf16 v[20:23], v[100:103], v[32:35], 0
    s_add_u32 s54, s54, 4096
    buffer_load_dwordx4 v[32:35], v0, s[4:7], s54 offen offset:0 sc1
    s_waitcnt vmcnt(16)
    v_mfma_f32_16x16x32_bf16 v[16:19], v[104:107], v[36:39], v[16:19]
    v_mfma_f32_16x16x32_bf16 v[20:23], v[108:111], v[36:39], v[20:23]
    buffer_load_dwordx4 v[36:39], v0, s[4:7], s54 offen offset:1024 sc1
    s_waitcnt vmcnt(16)
    v_mfma_f32_16x16x32_bf16 v[16:19], v[112:115], v[40:43], v[16:19]
    v_mfma_f32_16x16x32_bf16 v[20:23], v[116:119], v[40:43], v[20:23]
    buffer_load_dwordx4 v[40:43], v0, s[4:7], s54 offen offset:2048 sc1
    s_waitcnt vmcnt(16)
    v_mfma_f32_16x16x32_bf16 v[16:19], v[120:123], v[44:47], v[16:19]
    v_mfma_f32_16x16x32_bf16 v[20:23], v[124:127], v[44:47], v[20:23]
    buffer_load_dwordx4 v[44:47], v0, s[4:7], s54 offen offset:3072 sc1
    s_waitcnt vmcnt(16)
    v_mfma_f32_16x16x32_bf16 v[16:19], v[128:131], v[48:51], v[16:19]
    v_mfma_f32_16x16x32_bf16 v[20:23], v[132:135], v[48:51], v[20:23]
    s_add_u32 s54, s54, 4096
    buffer_load_dwordx4 v[48:51], v0, s[4:7], s54 offen offset:0 sc1
    s_waitcnt vmcnt(16)
    v_mfma_f32_16x16x32_bf16 v[16:19], v[136:139], v[52:55], v[16:19]
    v_mfma_f32_16x16x32_bf16 v[20:23], v[140:143], v[52:55], v[20:23]
    buffer_load_dwordx4 v[52:55], v0, s[4:7], s54 offen offset:1024 sc1
    s_waitcnt vmcnt(16)
    v_mfma_f32_16x16x32_bf16 v[16:19], v[144:147], v[56:59], v[16:19]
    v_mfma_f32_16x16x32_bf16 v[20:23], v[148:151], v[56:59], v[20:23]
    buffer_load_dwordx4 v[56:59], v0, s[4:7], s54 offen offset:2048 sc1
    s_waitcnt vmcnt(16)
    v_mfma_f32_16x16x32_bf16 v[16:19], v[152:155], v[60:63], v[16:19]
    v_mfma_f32_16x16x32_bf16 v[20:23], v[156:159], v[60:63], v[20:23]
    buffer_load_dwordx4 v[60:63], v0, s[4:7], s54 offen offset:3072 sc1
    s_waitcnt vmcnt(16)
    v_mfma_f32_16x16x32_bf16 v[16:19], v[160:163], v[64:67], v[16:19]
    v_mfma_f32_16x16x32_bf16 v[20:23], v[164:167], v[64:67], v[20:23]
    s_add_u32 s54, s54, 4096
    buffer_load_dwordx4 v[64:67], v0, s[4:7], s54 offen offset:0 sc1
    s_waitcnt vmcnt(16)
    v_mfma_f32_16x16x32_bf16 v[16:19], v[168:171], v[68:71], v[16:19]
    v_mfma_f32_16x16x32_bf16 v[20:23], v[172:175], v[68:71], v[20:23]
    buffer_load_dwordx4 v[68:71], v0, s[4:7], s54 offen offset:1024 sc1
    s_waitcnt vmcnt(16)
    v_mfma_f32_16x16x32_bf16 v[16:19], v[176:179], v[72:75], v[16:19]
    v_mfma_f32_16x16x32_bf16 v[20:23], v[180:183], v[72:75], v[20:23]
    buffer_load_dwordx4 v[72:75], v0, s[4:7], s54 offen offset:2048 sc1
    s_waitcnt vmcnt(16)
    v_mfma_f32_16x16x32_bf16 v[16:19], v[184:187], v[76:79], v[16:19]
    v_mfma_f32_16x16x32_bf16 v[20:23], v[188:191], v[76:79], v[20:23]
    buffer_load_dwordx4 v[76:79], v0, s[4:7], s54 offen offset:3072 sc1
    s_waitcnt vmcnt(16)
    v_mfma_f32_16x16x32_bf16 v[16:19], v[192:195], v[80:83], v[16:19]
    v_mfma_f32_16x16x32_bf16 v[20:23], v[196:199], v[80:83], v[20:23]
    s_add_u32 s54, s54, 4096
    buffer_load_dwordx4 v[80:83], v0, s[4:7], s54 offen offset:0 sc1
    s_waitcnt vmcnt(16)
    v_mfma_f32_16x16x32_bf16 v[16:19], v[200:203], v[84:87], v[16:19]
    v_mfma_f32_16x16x32_bf16 v[20:23], v[204:207], v[84:87], v[20:23]
    buffer_load_dwordx4 v[84:87], v0, s[4:7], s54 offen offset:1024 sc1
    s_waitcnt vmcnt(16)
    v_mfma_f32_16x16x32_bf16 v[16:19], v[208:211], v[88:91], v[16:19]
    v_mfma_f32_16x16x32_bf16 v[20:23], v[212:215], v[88:91], v[20:23]
    buffer_load_dwordx4 v[88:91], v0, s[4:7], s54 offen offset:2048 sc1
    s_waitcnt vmcnt(16)
    v_mfma_f32_16x16x32_bf16 v[16:19], v[216:219], v[92:95], v[16:19]
    v_mfma_f32_16x16x32_bf16 v[20:23], v[220:223], v[92:95], v[20:23]
    buffer_load_dwordx4 v[92:95], v0, s[4:7], s54 offen offset:3072 sc1
    buffer_load_dword v28, v6, s[4:7], s59 offen sc1
    s_waitcnt vmcnt(16)
    v_mfma_f32_16x16x32_bf16 v[16:19], v[224:227], v[32:35], v[16:19]
    v_mfma_f32_16x16x32_bf16 v[20:23], v[228:231], v[32:35], v[20:23]
    s_waitcnt vmcnt(15)
    v_mfma_f32_16x16x32_bf16 v[16:19], v[232:235], v[36:39], v[16:19]
    v_mfma_f32_16x16x32_bf16 v[20:23], v[236:239], v[36:39], v[20:23]
    s_waitcnt vmcnt(14)
    v_mfma_f32_16x16x32_bf16 v[16:19], v[240:243], v[40:43], v[16:19]
    v_mfma_f32_16x16x32_bf16 v[20:23], v[244:247], v[40:43], v[20:23]
    s_waitcnt vmcnt(13)
    v_mfma_f32_16x16x32_bf16 v[16:19], v[248:251], v[44:47], v[16:19]
    v_mfma_f32_16x16x32_bf16 v[20:23], v[252:255], v[44:47], v[20:23]
    s_waitcnt vmcnt(12)
    v_mfma_f32_16x16x32_bf16 v[16:19], a[160:163], v[48:51], v[16:19]
    v_mfma_f32_16x16x32_bf16 v[20:23], a[164:167], v[48:51], v[20:23]
    s_waitcnt vmcnt(11)
    v_mfma_f32_16x16x32_bf16 v[16:19], a[168:171], v[52:55], v[16:19]
    v_mfma_f32_16x16x32_bf16 v[20:23], a[172:175], v[52:55], v[20:23]
    s_waitcnt vmcnt(10)
    v_mfma_f32_16x16x32_bf16 v[16:19], a[176:179], v[56:59], v[16:19]
    v_mfma_f32_16x16x32_bf16 v[20:23], a[180:183], v[56:59], v[20:23]
    s_waitcnt vmcnt(9)
    v_mfma_f32_16x16x32_bf16 v[16:19], a[184:187], v[60:63], v[16:19]
    v_mfma_f32_16x16x32_bf16 v[20:23], a[188:191], v[60:63], v[20:23]
    s_waitcnt vmcnt(8)
    v_mfma_f32_16x16x32_bf16 v[16:19], a[192:195], v[64:67], v[16:19]
    v_mfma_f32_16x16x32_bf16 v[20:23], a[196:199], v[64:67], v[20:23]
    s_waitcnt vmcnt(7)
    v_mfma_f32_16x16x32_bf16 v[16:19], a[200:203], v[68:71], v[16:19]
    v_mfma_f32_16x16x32_bf16 v[20:23], a[204:207], v[68:71], v[20:23]
    s_waitcnt vmcnt(6)
    v_mfma_f32_16x16x32_bf16 v[16:19], a[208:211], v[72:75], v[16:19]
    v_mfma_f32_16x16x32_bf16 v[20:23], a[212:215], v[72:75], v[20:23]
    s_waitcnt vmcnt(5)
    v_mfma_f32_16x16x32_bf16 v[16:19], a[216:219], v[76:79], v[16:19]
    v_mfma_f32_16x16x32_bf16 v[20:23], a[220:223], v[76:79], v[20:23]
    s_waitcnt vmcnt(4)
    v_mfma_f32_16x16x32_bf16 v[16:19], a[224:227], v[80:83], v[16:19]
    v_mfma_f32_16x16x32_bf16 v[20:23], a[228:231], v[80:83], v[20:23]
    s_waitcnt vmcnt(3)
    v_mfma_f32_16x16x32_bf16 v[16:19], a[232:235], v[84:87], v[16:19]
    v_mfma_f32_16x16x32_bf16 v[20:23], a[236:239], v[84:87], v[20:23]
    s_waitcnt vmcnt(2)
    v_mfma_f32_16x16x32_bf16 v[16:19], a[240:243], v[88:91], v[16:19]
    v_mfma_f32_16x16x32_bf16 v[20:23], a[244:247], v[88:91], v[20:23]
    s_waitcnt vmcnt(1)
    v_mfma_f32_16x16x32_bf16 v[16:19], a[248:251], v[92:95], v[16:19]
    v_mfma_f32_16x16x32_bf16 v[20:23], a[252:255], v[92:95], v[20:23]
    v_add_u32 v8, s56, v7
    s_nop 1
    ds_write_b128 v8, v[16:19]
    s_nop 0
    ds_write_b128 v8, v[20:23] offset:1024
    s_waitcnt vmcnt(0)
    v_cmp_gt_u32 vcc, s57, v28
    s_waitcnt lgkmcnt(0)
    s_barrier
    s_cmp_lg_u32 s29, 0
    s_cbranch_scc1 G4_327
    ds_read_b128 v[32:35], v8 offset:2048
    ds_read_b128 v[36:39], v8 offset:3072
    ds_read_b128 v[40:43], v8 offset:4096
    ds_read_b128 v[44:47], v8 offset:5120
    ds_read_b128 v[48:51], v8 offset:6144
    ds_read_b128 v[52:55], v8 offset:7168
    s_waitcnt lgkmcnt(5)
    v_pk_add_f32 v[16:17], v[16:17], v[32:33]
    v_pk_add_f32 v[18:19], v[18:19], v[34:35]
    s_waitcnt lgkmcnt(4)
    v_pk_add_f32 v[20:21], v[20:21], v[36:37]
    v_pk_add_f32 v[22:23], v[22:23], v[38:39]
    s_waitcnt lgkmcnt(3)
    v_pk_add_f32 v[16:17], v[16:17], v[40:41]
    v_pk_add_f32 v[18:19], v[18:19], v[42:43]
    s_waitcnt lgkmcnt(2)
    v_pk_add_f32 v[20:21], v[20:21], v[44:45]
    v_pk_add_f32 v[22:23], v[22:23], v[46:47]
    s_waitcnt lgkmcnt(1)
    v_pk_add_f32 v[16:17], v[16:17], v[48:49]
    v_pk_add_f32 v[18:19], v[18:19], v[50:51]
    s_waitcnt lgkmcnt(0)
    v_pk_add_f32 v[20:21], v[20:21], v[52:53]
    v_pk_add_f32 v[22:23], v[22:23], v[54:55]
    v_cvt_pk_bf16_f32 v10, v16, v17
    v_cvt_pk_bf16_f32 v11, v18, v19
    v_cvt_pk_bf16_f32 v12, v20, v21
    v_cvt_pk_bf16_f32 v13, v22, v23
    v_lshlrev_b32 v32, 16, v10
    v_lshlrev_b32 v33, 16, v24
    v_and_b32 v34, 0xffff0000, v10
    v_and_b32 v35, 0xffff0000, v24
    v_add_f32 v32, v32, v33
    v_add_f32 v34, v34, v35
    v_cvt_pk_bf16_f32 v10, v32, v34
    v_lshlrev_b32 v32, 16, v11
    v_lshlrev_b32 v33, 16, v25
    v_and_b32 v34, 0xffff0000, v11
    v_and_b32 v35, 0xffff0000, v25
    v_add_f32 v32, v32, v33
    v_add_f32 v34, v34, v35
    v_cvt_pk_bf16_f32 v11, v32, v34
    v_lshlrev_b32 v32, 16, v12
    v_lshlrev_b32 v33, 16, v26
    v_and_b32 v34, 0xffff0000, v12
    v_and_b32 v35, 0xffff0000, v26
    v_add_f32 v32, v32, v33
    v_add_f32 v34, v34, v35
    v_cvt_pk_bf16_f32 v12, v32, v34
    v_lshlrev_b32 v32, 16, v13
    v_lshlrev_b32 v33, 16, v27
    v_and_b32 v34, 0xffff0000, v13
    v_and_b32 v35, 0xffff0000, v27
    v_add_f32 v32, v32, v33
    v_add_f32 v34, v34, v35
    v_cvt_pk_bf16_f32 v13, v32, v34
    s_cmp_lg_u32 s30, 0
    s_cbranch_scc1 G4_328
    s_add_u32 s34, s43, 14680064
    v_mov_b32 v29, s75
    buffer_store_dwordx4 v[10:13], v4, s[4:7], s34 offen sc1
    s_add_u32 s75, s44, 1
    s_cbranch_vccz G4_330
    v_mov_b32 v29, s75
    s_waitcnt vmcnt(0)
G4_330:
    s_mov_b64 exec, 1
    buffer_store_dword v29, off, s[4:7], s53 sc1
    s_mov_b64 exec, -1
    s_branch G4_327
G4_328:
    s_mul_i32 s34, s41, 20480
    s_add_u32 s34, s34, s42
    s_lshl_b32 s35, s69, 6
    s_add_u32 s34, s34, s35
    buffer_store_dwordx4 v[10:13], v5, s[12:15], s34 offen
G4_327:
    s_xor_b32 s56, s56, 8192
    s_cmp_ge_u32 s45, 128
    s_cbranch_scc1 G4_331
    s_cbranch_vccz G4_326
    s_branch G4_329
G4_331:
    s_waitcnt vmcnt(0)
    s_barrier
R_325:
    s_cmp_lg_u32 s30, 0
    s_cbranch_scc1 L_end
    s_cmp_lt_u32 s28, 160
    s_cbranch_scc1 R_334
    s_cmp_ge_u32 s28, 190
    s_cbranch_scc1 R_334
    s_mov_b32 s35, 0x3acccccd
    s_lshl_b32 s34, s67, 6
    s_add_u32 s34, s34, 0
    s_lshr_b32 s34, s34, 1
    s_add_u32 s34, s34, 1
    v_bfe_u32 v173, v1, 1, 4
    v_add_u32 v173, s34, v173
    s_mul_i32 s36, s29, 160
    v_bfe_u32 v172, v1, 5, 1
    v_mul_u32_u24 v172, 8, v172
    v_add_u32 v172, s36, v172
    v_mul_u32_u24 v172, v172, v173
    v_and_b32 v174, 1, v1
    v_mul_u32_u24 v174, 160, v174
    v_add_u32 v172, v172, v174
    v_cvt_f32_u32 v172, v172
    v_cvt_f32_u32 v173, v173
    v_mul_f32 v172, s35, v172
    v_mul_f32 v173, s35, v173
    v_fract_f32 v172, v172
    v_fmamk_f32 v174, v173, 0x0, v172
    v_fmamk_f32 v175, v173, 0x3f800000, v172
    v_cos_f32 v175, v175
    v_cos_f32 v174, v174
    s_nop 0
    v_cvt_pk_bf16_f32 v178, v174, v175
    v_fmamk_f32 v176, v173, 0x40000000, v172
    v_fmamk_f32 v177, v173, 0x40400000, v172
    v_cos_f32 v177, v177
    v_cos_f32 v176, v176
    v_accvgpr_write_b32 a160, v178
    v_cvt_pk_bf16_f32 v178, v176, v177
    v_fmamk_f32 v174, v173, 0x40800000, v172
    v_fmamk_f32 v175, v173, 0x40a00000, v172
    v_cos_f32 v175, v175
    v_cos_f32 v174, v174
    v_accvgpr_write_b32 a161, v178
    v_cvt_pk_bf16_f32 v178, v174, v175
    v_fmamk_f32 v176, v173, 0x40c00000, v172
    v_fmamk_f32 v177, v173, 0x40e00000, v172
    v_cos_f32 v177, v177
    v_cos_f32 v176, v176
    v_accvgpr_write_b32 a162, v178
    v_cvt_pk_bf16_f32 v178, v176, v177
    v_fmamk_f32 v174, v173, 0x41800000, v172
    v_fmamk_f32 v175, v173, 0x41880000, v172
    v_cos_f32 v175, v175
    v_cos_f32 v174, v174
    v_accvgpr_write_b32 a163, v178
    v_cvt_pk_bf16_f32 v178, v174, v175
    v_fmamk_f32 v176, v173, 0x41900000, v172
    v_fmamk_f32 v177, v173, 0x41980000, v172
    v_cos_f32 v177, v177
    v_cos_f32 v176, v176
    v_accvgpr_write_b32 a164, v178
    v_cvt_pk_bf16_f32 v178, v176, v177
    v_fmamk_f32 v174, v173, 0x41a00000, v172
    v_fmamk_f32 v175, v173, 0x41a80000, v172
    v_cos_f32 v175, v175
    v_cos_f32 v174, v174
    v_accvgpr_write_b32 a165, v178
    v_cvt_pk_bf16_f32 v178, v174, v175
    v_fmamk_f32 v176, v173, 0x41b00000, v172
    v_fmamk_f32 v177, v173, 0x41b80000, v172
    v_cos_f32 v177, v177
    v_cos_f32 v176, v176
    v_accvgpr_write_b32 a166, v178
    v_cvt_pk_bf16_f32 v178, v176, v177
    v_fmamk_f32 v174, v173, 0x42000000, v172
    v_fmamk_f32 v175, v173, 0x42040000, v172
    v_cos_f32 v175, v175
    v_cos_f32 v174, v174
    v_accvgpr_write_b32 a167, v178
    v_cvt_pk_bf16_f32 v178, v174, v175
    v_fmamk_f32 v176, v173, 0x42080000, v172
    v_fmamk_f32 v177, v173, 0x420c0000, v172
    v_cos_f32 v177, v177
    v_cos_f32 v176, v176
    v_accvgpr_write_b32 a168, v178
    v_cvt_pk_bf16_f32 v178, v176, v177
    v_fmamk_f32 v174, v173, 0x42100000, v172
    v_fmamk_f32 v175, v173, 0x42140000, v172
    v_cos_f32 v175, v175
    v_cos_f32 v174, v174
    v_accvgpr_write_b32 a169, v178
    v_cvt_pk_bf16_f32 v178, v174, v175
    v_fmamk_f32 v176, v173, 0x42180000, v172
    v_fmamk_f32 v177, v173, 0x421c0000, v172
    v_cos_f32 v177, v177
    v_cos_f32 v176, v176
    v_accvgpr_write_b32 a170, v178
    v_cvt_pk_bf16_f32 v178, v176, v177
    v_fmamk_f32 v174, v173, 0x42400000, v172
    v_fmamk_f32 v175, v173, 0x42440000, v172
    v_cos_f32 v175, v175
    v_cos_f32 v174, v174
    v_accvgpr_write_b32 a171, v178
    v_cvt_pk_bf16_f32 v178, v174, v175
    v_fmamk_f32 v176, v173, 0x42480000, v172
    v_fmamk_f32 v177, v173, 0x424c0000, v172
    v_cos_f32 v177, v177
    v_cos_f32 v176, v176
    v_accvgpr_write_b32 a172, v178
    v_cvt_pk_bf16_f32 v178, v176, v177
    v_fmamk_f32 v174, v173, 0x42500000, v172
    v_fmamk_f32 v175, v173, 0x42540000, v172
    v_cos_f32 v175, v175
    v_cos_f32 v174, v174
    v_accvgpr_write_b32 a173, v178
    v_cvt_pk_bf16_f32 v178, v174, v175
    v_fmamk_f32 v176, v173, 0x42580000, v172
    v_fmamk_f32 v177, v173, 0x425c0000, v172
    v_cos_f32 v177, v177
    v_cos_f32 v176, v176
    v_accvgpr_write_b32 a174, v178
    v_cvt_pk_bf16_f32 v178, v176, v177
    v_fmamk_f32 v174, v173, 0x42800000, v172
    v_fmamk_f32 v175, v173, 0x42820000, v172
    v_cos_f32 v175, v175
    v_cos_f32 v174, v174
    v_accvgpr_write_b32 a175, v178
    v_cvt_pk_bf16_f32 v178, v174, v175
    v_fmamk_f32 v176, v173, 0x42840000, v172
    v_fmamk_f32 v177, v173, 0x42860000, v172
    v_cos_f32 v177, v177
    v_cos_f32 v176, v176
    v_accvgpr_write_b32 a176, v178
    v_cvt_pk_bf16_f32 v178, v176, v177
    v_fmamk_f32 v174, v173, 0x42880000, v172
    v_fmamk_f32 v175, v173, 0x428a0000, v172
    v_cos_f32 v175, v175
    v_cos_f32 v174, v174
    v_accvgpr_write_b32 a177, v178
    v_cvt_pk_bf16_f32 v178, v174, v175
    v_fmamk_f32 v176, v173, 0x428c0000, v172
    v_fmamk_f32 v177, v173, 0x428e0000, v172
    v_cos_f32 v177, v177
    v_cos_f32 v176, v176
    v_accvgpr_write_b32 a178, v178
    v_cvt_pk_bf16_f32 v178, v176, v177
    v_fmamk_f32 v174, v173, 0x42a00000, v172
    v_fmamk_f32 v175, v173, 0x42a20000, v172
    v_cos_f32 v175, v175
    v_cos_f32 v174, v174
    v_accvgpr_write_b32 a179, v178
    v_cvt_pk_bf16_f32 v178, v174, v175
    v_fmamk_f32 v176, v173, 0x42a40000, v172
    v_fmamk_f32 v177, v173, 0x42a60000, v172
    v_cos_f32 v177, v177
    v_cos_f32 v176, v176
    v_accvgpr_write_b32 a180, v178
    v_cvt_pk_bf16_f32 v178, v176, v177
    v_fmamk_f32 v174, v173, 0x42a80000, v172
    v_fmamk_f32 v175, v173, 0x42aa0000, v172
    v_cos_f32 v175, v175
    v_cos_f32 v174, v174
    v_accvgpr_write_b32 a181, v178
    v_cvt_pk_bf16_f32 v178, v174, v175
    v_fmamk_f32 v176, v173, 0x42ac0000, v172
    v_fmamk_f32 v177, v173, 0x42ae0000, v172
    v_cos_f32 v177, v177
    v_cos_f32 v176, v176
    v_accvgpr_write_b32 a182, v178
    v_cvt_pk_bf16_f32 v178, v176, v177
    v_fmamk_f32 v174, v173, 0x42c00000, v172
    v_fmamk_f32 v175, v173, 0x42c20000, v172
    v_cos_f32 v175, v175
    v_cos_f32 v174, v174
    v_accvgpr_write_b32 a183, v178
    v_cvt_pk_bf16_f32 v178, v174, v175
    v_fmamk_f32 v176, v173, 0x42c40000, v172
    v_fmamk_f32 v177, v173, 0x42c60000, v172
    v_cos_f32 v177, v177
    v_cos_f32 v176, v176
    v_accvgpr_write_b32 a184, v178
    v_cvt_pk_bf16_f32 v178, v176, v177
    v_fmamk_f32 v174, v173, 0x42c80000, v172
    v_fmamk_f32 v175, v173, 0x42ca0000, v172
    v_cos_f32 v175, v175
    v_cos_f32 v174, v174
    v_accvgpr_write_b32 a185, v178
    v_cvt_pk_bf16_f32 v178, v174, v175
    v_fmamk_f32 v176, v173, 0x42cc0000, v172
    v_fmamk_f32 v177, v173, 0x42ce0000, v172
    v_cos_f32 v177, v177
    v_cos_f32 v176, v176
    v_accvgpr_write_b32 a186, v178
    v_cvt_pk_bf16_f32 v178, v176, v177
    v_fmamk_f32 v174, v173, 0x42e00000, v172
    v_fmamk_f32 v175, v173, 0x42e20000, v172
    v_cos_f32 v175, v175
    v_cos_f32 v174, v174
    v_accvgpr_write_b32 a187, v178
    v_cvt_pk_bf16_f32 v178, v174, v175
    v_fmamk_f32 v176, v173, 0x42e40000, v172
    v_fmamk_f32 v177, v173, 0x42e60000, v172
    v_cos_f32 v177, v177
    v_cos_f32 v176, v176
    v_accvgpr_write_b32 a188, v178
    v_cvt_pk_bf16_f32 v178, v176, v177
    v_fmamk_f32 v174, v173, 0x42e80000, v172
    v_fmamk_f32 v175, v173, 0x42ea0000, v172
    v_cos_f32 v175, v175
    v_cos_f32 v174, v174
    v_accvgpr_write_b32 a189, v178
    v_cvt_pk_bf16_f32 v178, v174, v175
    v_fmamk_f32 v176, v173, 0x42ec0000, v172
    v_fmamk_f32 v177, v173, 0x42ee0000, v172
    v_cos_f32 v177, v177
    v_cos_f32 v176, v176
    v_accvgpr_write_b32 a190, v178
    v_cvt_pk_bf16_f32 v178, v176, v177
    v_fmamk_f32 v174, v173, 0x43000000, v172
    v_fmamk_f32 v175, v173, 0x43010000, v172
    v_cos_f32 v175, v175
    v_cos_f32 v174, v174
    v_accvgpr_write_b32 a191, v178
    v_cvt_pk_bf16_f32 v178, v174, v175
    v_fmamk_f32 v176, v173, 0x43020000, v172
    v_fmamk_f32 v177, v173, 0x43030000, v172
    v_cos_f32 v177, v177
    v_cos_f32 v176, v176
    v_accvgpr_write_b32 a192, v178
    v_cvt_pk_bf16_f32 v178, v176, v177
    v_fmamk_f32 v174, v173, 0x43040000, v172
    v_fmamk_f32 v175, v173, 0x43050000, v172
    v_cos_f32 v175, v175
    v_cos_f32 v174, v174
    v_accvgpr_write_b32 a193, v178
    v_cvt_pk_bf16_f32 v178, v174, v175
    v_fmamk_f32 v176, v173, 0x43060000, v172
    v_fmamk_f32 v177, v173, 0x43070000, v172
    v_cos_f32 v177, v177
    v_cos_f32 v176, v176
    v_accvgpr_write_b32 a194, v178
    v_cvt_pk_bf16_f32 v178, v176, v177
    v_fmamk_f32 v174, v173, 0x43100000, v172
    v_fmamk_f32 v175, v173, 0x43110000, v172
    v_cos_f32 v175, v175
    v_cos_f32 v174, v174
    v_accvgpr_write_b32 a195, v178
    v_cvt_pk_bf16_f32 v178, v174, v175
    v_fmamk_f32 v176, v173, 0x43120000, v172
    v_fmamk_f32 v177, v173, 0x43130000, v172
    v_cos_f32 v177, v177
    v_cos_f32 v176, v176
    v_accvgpr_write_b32 a196, v178
    v_cvt_pk_bf16_f32 v178, v176, v177
    v_fmamk_f32 v174, v173, 0x43140000, v172
    v_fmamk_f32 v175, v173, 0x43150000, v172
    v_cos_f32 v175, v175
    v_cos_f32 v174, v174
    v_accvgpr_write_b32 a197, v178
    v_cvt_pk_bf16_f32 v178, v174, v175
    v_fmamk_f32 v176, v173, 0x43160000, v172
    v_fmamk_f32 v177, v173, 0x43170000, v172
    v_cos_f32 v177, v177
    v_cos_f32 v176, v176
    v_accvgpr_write_b32 a198, v178
    v_cvt_pk_bf16_f32 v178, v176, v177
    v_accvgpr_write_b32 a199, v178
    s_lshl_b32 s34, s67, 6
    s_add_u32 s34, s34, 32
    s_lshr_b32 s34, s34, 1
    s_add_u32 s34, s34, 1
    v_bfe_u32 v173, v1, 1, 4
    v_add_u32 v173, s34, v173
    s_mul_i32 s36, s29, 160
    v_bfe_u32 v172, v1, 5, 1
    v_mul_u32_u24 v172, 8, v172
    v_add_u32 v172, s36, v172
    v_mul_u32_u24 v172, v172, v173
    v_and_b32 v174, 1, v1
    v_mul_u32_u24 v174, 160, v174
    v_add_u32 v172, v172, v174
    v_cvt_f32_u32 v172, v172
    v_cvt_f32_u32 v173, v173
    v_mul_f32 v172, s35, v172
    v_mul_f32 v173, s35, v173
    v_fract_f32 v172, v172
    v_fmamk_f32 v174, v173, 0x0, v172
    v_fmamk_f32 v175, v173, 0x3f800000, v172
    v_cos_f32 v175, v175
    v_cos_f32 v174, v174
    s_nop 0
    v_cvt_pk_bf16_f32 v178, v174, v175
    v_fmamk_f32 v176, v173, 0x40000000, v172
    v_fmamk_f32 v177, v173, 0x40400000, v172
    v_cos_f32 v177, v177
    v_cos_f32 v176, v176
    v_accvgpr_write_b32 a200, v178
    v_cvt_pk_bf16_f32 v178, v176, v177
    v_fmamk_f32 v174, v173, 0x40800000, v172
    v_fmamk_f32 v175, v173, 0x40a00000, v172
    v_cos_f32 v175, v175
    v_cos_f32 v174, v174
    v_accvgpr_write_b32 a201, v178
    v_cvt_pk_bf16_f32 v178, v174, v175
    v_fmamk_f32 v176, v173, 0x40c00000, v172
    v_fmamk_f32 v177, v173, 0x40e00000, v172
    v_cos_f32 v177, v177
    v_cos_f32 v176, v176
    v_accvgpr_write_b32 a202, v178
    v_cvt_pk_bf16_f32 v178, v176, v177
    v_fmamk_f32 v174, v173, 0x41800000, v172
    v_fmamk_f32 v175, v173, 0x41880000, v172
    v_cos_f32 v175, v175
    v_cos_f32 v174, v174
    v_accvgpr_write_b32 a203, v178
    v_cvt_pk_bf16_f32 v178, v174, v175
    v_fmamk_f32 v176, v173, 0x41900000, v172
    v_fmamk_f32 v177, v173, 0x41980000, v172
    v_cos_f32 v177, v177
    v_cos_f32 v176, v176
    v_accvgpr_write_b32 a204, v178
    v_cvt_pk_bf16_f32 v178, v176, v177
    v_fmamk_f32 v174, v173, 0x41a00000, v172
    v_fmamk_f32 v175, v173, 0x41a80000, v172
    v_cos_f32 v175, v175
    v_cos_f32 v174, v174
    v_accvgpr_write_b32 a205, v178
    v_cvt_pk_bf16_f32 v178, v174, v175
    v_fmamk_f32 v176, v173, 0x41b00000, v172
    v_fmamk_f32 v177, v173, 0x41b80000, v172
    v_cos_f32 v177, v177
    v_cos_f32 v176, v176
    v_accvgpr_write_b32 a206, v178
    v_cvt_pk_bf16_f32 v178, v176, v177
    v_fmamk_f32 v174, v173, 0x42000000, v172
    v_fmamk_f32 v175, v173, 0x42040000, v172
    v_cos_f32 v175, v175
    v_cos_f32 v174, v174
    v_accvgpr_write_b32 a207, v178
    v_cvt_pk_bf16_f32 v178, v174, v175
    v_fmamk_f32 v176, v173, 0x42080000, v172
    v_fmamk_f32 v177, v173, 0x420c0000, v172
    v_cos_f32 v177, v177
    v_cos_f32 v176, v176
    v_accvgpr_write_b32 a208, v178
    v_cvt_pk_bf16_f32 v178, v176, v177
    v_fmamk_f32 v174, v173, 0x42100000, v172
    v_fmamk_f32 v175, v173, 0x42140000, v172
    v_cos_f32 v175, v175
    v_cos_f32 v174, v174
    v_accvgpr_write_b32 a209, v178
    v_cvt_pk_bf16_f32 v178, v174, v175
    v_fmamk_f32 v176, v173, 0x42180000, v172
    v_fmamk_f32 v177, v173, 0x421c0000, v172
    v_cos_f32 v177, v177
    v_cos_f32 v176, v176
    v_accvgpr_write_b32 a210, v178
    v_cvt_pk_bf16_f32 v178, v176, v177
    v_fmamk_f32 v174, v173, 0x42400000, v172
    v_fmamk_f32 v175, v173, 0x42440000, v172
    v_cos_f32 v175, v175
    v_cos_f32 v174, v174
    v_accvgpr_write_b32 a211, v178
    v_cvt_pk_bf16_f32 v178, v174, v175
    v_fmamk_f32 v176, v173, 0x42480000, v172
    v_fmamk_f32 v177, v173, 0x424c0000, v172
    v_cos_f32 v177, v177
    v_cos_f32 v176, v176
    v_accvgpr_write_b32 a212, v178
    v_cvt_pk_bf16_f32 v178, v176, v177
    v_fmamk_f32 v174, v173, 0x42500000, v172
    v_fmamk_f32 v175, v173, 0x42540000, v172
    v_cos_f32 v175, v175
    v_cos_f32 v174, v174
    v_accvgpr_write_b32 a213, v178
    v_cvt_pk_bf16_f32 v178, v174, v175
    v_fmamk_f32 v176, v173, 0x42580000, v172
    v_fmamk_f32 v177, v173, 0x425c0000, v172
    v_cos_f32 v177, v177
    v_cos_f32 v176, v176
    v_accvgpr_write_b32 a214, v178
    v_cvt_pk_bf16_f32 v178, v176, v177
    v_fmamk_f32 v174, v173, 0x42800000, v172
    v_fmamk_f32 v175, v173, 0x42820000, v172
    v_cos_f32 v175, v175
    v_cos_f32 v174, v174
    v_accvgpr_write_b32 a215, v178
    v_cvt_pk_bf16_f32 v178, v174, v175
    v_fmamk_f32 v176, v173, 0x42840000, v172
    v_fmamk_f32 v177, v173, 0x42860000, v172
    v_cos_f32 v177, v177
    v_cos_f32 v176, v176
    v_accvgpr_write_b32 a216, v178
    v_cvt_pk_bf16_f32 v178, v176, v177
    v_fmamk_f32 v174, v173, 0x42880000, v172
    v_fmamk_f32 v175, v173, 0x428a0000, v172
    v_cos_f32 v175, v175
    v_cos_f32 v174, v174
    v_accvgpr_write_b32 a217, v178
    v_cvt_pk_bf16_f32 v178, v174, v175
    v_fmamk_f32 v176, v173, 0x428c0000, v172
    v_fmamk_f32 v177, v173, 0x428e0000, v172
    v_cos_f32 v177, v177
    v_cos_f32 v176, v176
    v_accvgpr_write_b32 a218, v178
    v_cvt_pk_bf16_f32 v178, v176, v177
    v_fmamk_f32 v174, v173, 0x42a00000, v172
    v_fmamk_f32 v175, v173, 0x42a20000, v172
    v_cos_f32 v175, v175
    v_cos_f32 v174, v174
    v_accvgpr_write_b32 a219, v178
    v_cvt_pk_bf16_f32 v178, v174, v175
    v_fmamk_f32 v176, v173, 0x42a40000, v172
    v_fmamk_f32 v177, v173, 0x42a60000, v172
    v_cos_f32 v177, v177
    v_cos_f32 v176, v176
    v_accvgpr_write_b32 a220, v178
    v_cvt_pk_bf16_f32 v178, v176, v177
    v_fmamk_f32 v174, v173, 0x42a80000, v172
    v_fmamk_f32 v175, v173, 0x42aa0000, v172
    v_cos_f32 v175, v175
    v_cos_f32 v174, v174
    v_accvgpr_write_b32 a221, v178
    v_cvt_pk_bf16_f32 v178, v174, v175
    v_fmamk_f32 v176, v173, 0x42ac0000, v172
    v_fmamk_f32 v177, v173, 0x42ae0000, v172
    v_cos_f32 v177, v177
    v_cos_f32 v176, v176
    v_accvgpr_write_b32 a222, v178
    v_cvt_pk_bf16_f32 v178, v176, v177
    v_fmamk_f32 v174, v173, 0x42c00000, v172
    v_fmamk_f32 v175, v173, 0x42c20000, v172
    v_cos_f32 v175, v175
    v_cos_f32 v174, v174
    v_accvgpr_write_b32 a223, v178
    v_cvt_pk_bf16_f32 v178, v174, v175
    v_fmamk_f32 v176, v173, 0x42c40000, v172
    v_fmamk_f32 v177, v173, 0x42c60000, v172
    v_cos_f32 v177, v177
    v_cos_f32 v176, v176
    v_accvgpr_write_b32 a224, v178
    v_cvt_pk_bf16_f32 v178, v176, v177
    v_fmamk_f32 v174, v173, 0x42c80000, v172
    v_fmamk_f32 v175, v173, 0x42ca0000, v172
    v_cos_f32 v175, v175
    v_cos_f32 v174, v174
    v_accvgpr_write_b32 a225, v178
    v_cvt_pk_bf16_f32 v178, v174, v175
    v_fmamk_f32 v176, v173, 0x42cc0000, v172
    v_fmamk_f32 v177, v173, 0x42ce0000, v172
    v_cos_f32 v177, v177
    v_cos_f32 v176, v176
    v_accvgpr_write_b32 a226, v178
    v_cvt_pk_bf16_f32 v178, v176, v177
    v_fmamk_f32 v174, v173, 0x42e00000, v172
    v_fmamk_f32 v175, v173, 0x42e20000, v172
    v_cos_f32 v175, v175
    v_cos_f32 v174, v174
    v_accvgpr_write_b32 a227, v178
    v_cvt_pk_bf16_f32 v178, v174, v175
    v_fmamk_f32 v176, v173, 0x42e40000, v172
    v_fmamk_f32 v177, v173, 0x42e60000, v172
    v_cos_f32 v177, v177
    v_cos_f32 v176, v176
    v_accvgpr_write_b32 a228, v178
    v_cvt_pk_bf16_f32 v178, v176, v177
    v_fmamk_f32 v174, v173, 0x42e80000, v172
    v_fmamk_f32 v175, v173, 0x42ea0000, v172
    v_cos_f32 v175, v175
    v_cos_f32 v174, v174
    v_accvgpr_write_b32 a229, v178
    v_cvt_pk_bf16_f32 v178, v174, v175
    v_fmamk_f32 v176, v173, 0x42ec0000, v172
    v_fmamk_f32 v177, v173, 0x42ee0000, v172
    v_cos_f32 v177, v177
    v_cos_f32 v176, v176
    v_accvgpr_write_b32 a230, v178
    v_cvt_pk_bf16_f32 v178, v176, v177
    v_fmamk_f32 v174, v173, 0x43000000, v172
    v_fmamk_f32 v175, v173, 0x43010000, v172
    v_cos_f32 v175, v175
    v_cos_f32 v174, v174
    v_accvgpr_write_b32 a231, v178
    v_cvt_pk_bf16_f32 v178, v174, v175
    v_fmamk_f32 v176, v173, 0x43020000, v172
    v_fmamk_f32 v177, v173, 0x43030000, v172
    v_cos_f32 v177, v177
    v_cos_f32 v176, v176
    v_accvgpr_write_b32 a232, v178
    v_cvt_pk_bf16_f32 v178, v176, v177
    v_fmamk_f32 v174, v173, 0x43040000, v172
    v_fmamk_f32 v175, v173, 0x43050000, v172
    v_cos_f32 v175, v175
    v_cos_f32 v174, v174
    v_accvgpr_write_b32 a233, v178
    v_cvt_pk_bf16_f32 v178, v174, v175
    v_fmamk_f32 v176, v173, 0x43060000, v172
    v_fmamk_f32 v177, v173, 0x43070000, v172
    v_cos_f32 v177, v177
    v_cos_f32 v176, v176
    v_accvgpr_write_b32 a234, v178
    v_cvt_pk_bf16_f32 v178, v176, v177
    v_fmamk_f32 v174, v173, 0x43100000, v172
    v_fmamk_f32 v175, v173, 0x43110000, v172
    v_cos_f32 v175, v175
    v_cos_f32 v174, v174
    v_accvgpr_write_b32 a235, v178
    v_cvt_pk_bf16_f32 v178, v174, v175
    v_fmamk_f32 v176, v173, 0x43120000, v172
    v_fmamk_f32 v177, v173, 0x43130000, v172
    v_cos_f32 v177, v177
    v_cos_f32 v176, v176
    v_accvgpr_write_b32 a236, v178
    v_cvt_pk_bf16_f32 v178, v176, v177
    v_fmamk_f32 v174, v173, 0x43140000, v172
    v_fmamk_f32 v175, v173, 0x43150000, v172
    v_cos_f32 v175, v175
    v_cos_f32 v174, v174
    v_accvgpr_write_b32 a237, v178
    v_cvt_pk_bf16_f32 v178, v174, v175
    v_fmamk_f32 v176, v173, 0x43160000, v172
    v_fmamk_f32 v177, v173, 0x43170000, v172
    v_cos_f32 v177, v177
    v_cos_f32 v176, v176
    v_accvgpr_write_b32 a238, v178
    v_cvt_pk_bf16_f32 v178, v176, v177
    v_accvgpr_write_b32 a239, v178
    s_lshl_b32 s34, s29, 13
    v_add_u32 v4, s34, v0
    s_lshl_b32 s34, s29, 3
    s_add_u32 s34, s34, 65536
    v_bfe_u32 v5, v1, 0, 5
    v_mul_u32_u24 v5, 32, v5
    v_add_u32 v5, s34, v5
    s_lshl_b32 s35, s29, 11
    s_lshl_b32 s36, s29, 8
    s_add_u32 s36, s36, 67584
    s_lshr_b32 s34, s29, 1
    s_lshl_b32 s34, s34, 12
    s_and_b32 s37, s29, 1
    s_lshl_b32 s37, s37, 8
    s_add_u32 s34, s34, s37
    v_bfe_u32 v3, v1, 1, 1
    v_mul_u32_u24 v3, 2048, v3
    v_bfe_u32 v172, v1, 0, 1
    v_lshl_add_u32 v3, v172, 9, v3
    v_bfe_u32 v172, v1, 2, 4
    v_lshl_add_u32 v3, v172, 4, v3
    v_add_u32 v3, s34, v3
    v_bfe_u32 v10, v1, 0, 2
    v_mul_u32_u24 v10, 32, v10
    v_add_u32 v10, s36, v10
    s_lshl_b32 s34, s29, 10
    v_add_u32 v7, s34, v0
    v_bfe_u32 v6, v1, 0, 5
    v_mul_u32_u24 v6, 32, v6
    v_add_u32 v6, 65536, v6
    v_bfe_u32 v9, v1, 0, 2
    v_mul_u32_u24 v9, 4, v9
    v_bfe_u32 v172, v1, 2, 1
    v_lshl_add_u32 v9, v172, 5, v9
    v_bfe_u32 v172, v1, 3, 1
    v_lshl_add_u32 v9, v172, 4, v9
    v_bfe_u32 v172, v1, 4, 1
    v_lshl_add_u32 v9, v172, 6, v9
    v_add_u32 v9, s36, v9
    s_mov_b32 s34, 0x3f803f80
    v_mov_b32 v56, s34
    v_mov_b32 v57, s34
    v_mov_b32 v58, s34
    v_mov_b32 v59, s34
    s_nop 1
    v_mfma_f32_32x32x16_bf16 v[96:111], v[56:59], a[160:163], 0
    v_mfma_f32_32x32x16_bf16 v[112:127], v[56:59], a[200:203], 0
    v_mfma_f32_32x32x16_bf16 v[96:111], v[56:59], a[164:167], v[96:111]
    v_mfma_f32_32x32x16_bf16 v[112:127], v[56:59], a[204:207], v[112:127]
    v_mfma_f32_32x32x16_bf16 v[96:111], v[56:59], a[168:171], v[96:111]
    v_mfma_f32_32x32x16_bf16 v[112:127], v[56:59], a[208:211], v[112:127]
    v_mfma_f32_32x32x16_bf16 v[96:111], v[56:59], a[172:175], v[96:111]
    v_mfma_f32_32x32x16_bf16 v[112:127], v[56:59], a[212:215], v[112:127]
    v_mfma_f32_32x32x16_bf16 v[96:111], v[56:59], a[176:179], v[96:111]
    v_mfma_f32_32x32x16_bf16 v[112:127], v[56:59], a[216:219], v[112:127]
    v_mfma_f32_32x32x16_bf16 v[96:111], v[56:59], a[180:183], v[96:111]
    v_mfma_f32_32x32x16_bf16 v[112:127], v[56:59], a[220:223], v[112:127]
    v_mfma_f32_32x32x16_bf16 v[96:111], v[56:59], a[184:187], v[96:111]
    v_mfma_f32_32x32x16_bf16 v[112:127], v[56:59], a[224:227], v[112:127]
    v_mfma_f32_32x32x16_bf16 v[96:111], v[56:59], a[188:191], v[96:111]
    v_mfma_f32_32x32x16_bf16 v[112:127], v[56:59], a[228:231], v[112:127]
    v_mfma_f32_32x32x16_bf16 v[96:111], v[56:59], a[192:195], v[96:111]
    v_mfma_f32_32x32x16_bf16 v[112:127], v[56:59], a[232:235], v[112:127]
    v_mfma_f32_32x32x16_bf16 v[96:111], v[56:59], a[196:199], v[96:111]
    v_mfma_f32_32x32x16_bf16 v[112:127], v[56:59], a[236:239], v[112:127]
    s_nop 3
    ds_write_b128 v4, v[96:99] offset:32768
    ds_write_b128 v4, v[100:103] offset:33792
    ds_write_b128 v4, v[104:107] offset:34816
    ds_write_b128 v4, v[108:111] offset:35840
    ds_write_b128 v4, v[112:115] offset:36864
    ds_write_b128 v4, v[116:119] offset:37888
    ds_write_b128 v4, v[120:123] offset:38912
    ds_write_b128 v4, v[124:127] offset:39936
    s_waitcnt lgkmcnt(0)
    s_barrier
    ds_read_b128 v[96:99], v3 offset:32768
    ds_read_b128 v[100:103], v3 offset:33792
    ds_read_b128 v[104:107], v3 offset:40960
    ds_read_b128 v[108:111], v3 offset:41984
    ds_read_b128 v[112:115], v3 offset:49152
    ds_read_b128 v[116:119], v3 offset:50176
    ds_read_b128 v[120:123], v3 offset:57344
    ds_read_b128 v[124:127], v3 offset:58368
    s_waitcnt lgkmcnt(5)
    v_pk_add_f32 v[96:97], v[96:97], v[104:105]
    v_pk_add_f32 v[98:99], v[98:99], v[106:107]
    s_waitcnt lgkmcnt(4)
    v_pk_add_f32 v[100:101], v[100:101], v[108:109]
    v_pk_add_f32 v[102:103], v[102:103], v[110:111]
    s_waitcnt lgkmcnt(3)
    v_pk_add_f32 v[96:97], v[96:97], v[112:113]
    v_pk_add_f32 v[98:99], v[98:99], v[114:115]
    s_waitcnt lgkmcnt(2)
    v_pk_add_f32 v[100:101], v[100:101], v[116:117]
    v_pk_add_f32 v[102:103], v[102:103], v[118:119]
    s_waitcnt lgkmcnt(1)
    v_pk_add_f32 v[96:97], v[96:97], v[120:121]
    v_pk_add_f32 v[98:99], v[98:99], v[122:123]
    s_waitcnt lgkmcnt(0)
    v_pk_add_f32 v[100:101], v[100:101], v[124:125]
    v_pk_add_f32 v[102:103], v[102:103], v[126:127]
    v_mov_b64 v[154:155], v[96:97]
    v_mov_b64 v[156:157], v[98:99]
    v_mov_b64 v[158:159], v[100:101]
    v_mov_b64 v[160:161], v[102:103]
    s_barrier
    s_sub_u32 s44, s66, 16
    s_mov_b32 s47, 3
    s_mul_i32 s50, s29, 10240
    s_add_u32 s50, s50, 14680064
    s_mov_b32 s52, 0
    s_lshl_b32 s51, s67, 12
    s_add_u32 s51, s51, 24117248
    s_mov_b32 s58, 40960
    s_mul_i32 s34, s29, 640
    s_add_u32 s34, s34, 1196032
    v_lshrrev_b32 v181, 1, v1
    v_min_u32 v181, 4, v181
    v_lshlrev_b32 v181, 7, v181
    v_add_u32 v181, s34, v181
    s_waitcnt vmcnt(0) lgkmcnt(0)
G_335:
    s_lshl_b32 s37, s44, 1
    s_mul_i32 s38, s37, 10923
    s_lshr_b32 s38, s38, 16
    s_mul_i32 s39, s38, 6
    s_sub_u32 s39, s37, s39
    v_and_b32 v180, 1, v1
    v_add_u32 v182, s39, v180
    s_cmp_lt_u32 s37, 72
    s_cselect_b32 s38, -60, 4
    s_lshl_b32 s38, s38, 7
    v_cmp_lt_u32 vcc, 2, v182
    v_mov_b32 v183, s38
    s_nop 0
    v_cndmask_b32 v183, 0, v183, vcc
    v_mul_u32_u24 v182, 2560, v182
    v_add3_u32 v182, v182, v183, v181
    s_add_u32 s37, s37, 1
    v_add_u32 v180, s37, v180
    s_mov_b32 s48, 0
P_337:
    buffer_load_dword v172, v182, s[4:7], 0 offen sc1
    s_waitcnt vmcnt(0)
    v_cmp_gt_u32 vcc, v180, v172
    s_cbranch_vccz P_338
    s_add_u32 s48, s48, 1
    s_cmp_gt_u32 s48, 200000
    s_cbranch_scc1 L_end
    s_sleep 1
    v_add_u32 v172, 12, v172
    v_cmp_gt_u32 vcc, v180, v172
    s_cbranch_vccz P_337
    s_sleep 24
    s_branch P_337
P_338:
    s_mul_i32 s54, s44, 40960
    s_add_u32 s56, s54, s52
    s_add_u32 s54, s54, s50
    buffer_load_dwordx4 v[16:19], v0, s[4:7], s54 offen offset:0 sc1
    buffer_load_dwordx4 v[20:23], v0, s[4:7], s54 offen offset:1024 sc1
    buffer_load_dwordx4 v[24:27], v0, s[4:7], s54 offen offset:2048 sc1
    buffer_load_dwordx4 v[28:31], v0, s[4:7], s54 offen offset:3072 sc1
    s_add_u32 s54, s54, 4096
    buffer_load_dwordx4 v[32:35], v0, s[4:7], s54 offen offset:0 sc1
    buffer_load_dwordx4 v[36:39], v0, s[4:7], s54 offen offset:1024 sc1
    buffer_load_dwordx4 v[40:43], v0, s[4:7], s54 offen offset:2048 sc1
    buffer_load_dwordx4 v[44:47], v0, s[4:7], s54 offen offset:3072 sc1
    s_add_u32 s54, s54, 4096
    buffer_load_dwordx4 v[48:51], v0, s[4:7], s54 offen offset:0 sc1
    buffer_load_dwordx4 v[52:55], v0, s[4:7], s54 offen offset:1024 sc1
    s_waitcnt vmcnt(9)
    v_mfma_f32_32x32x16_bf16 v[96:111], v[16:19], a[160:163], 0
    v_mfma_f32_32x32x16_bf16 v[112:127], v[16:19], a[200:203], 0
    s_waitcnt vmcnt(8)
    v_mfma_f32_32x32x16_bf16 v[96:111], v[20:23], a[164:167], v[96:111]
    v_mfma_f32_32x32x16_bf16 v[112:127], v[20:23], a[204:207], v[112:127]
    s_waitcnt vmcnt(7)
    v_mfma_f32_32x32x16_bf16 v[96:111], v[24:27], a[168:171], v[96:111]
    v_mfma_f32_32x32x16_bf16 v[112:127], v[24:27], a[208:211], v[112:127]
    s_waitcnt vmcnt(6)
    v_mfma_f32_32x32x16_bf16 v[96:111], v[28:31], a[172:175], v[96:111]
    v_mfma_f32_32x32x16_bf16 v[112:127], v[28:31], a[212:215], v[112:127]
    s_waitcnt vmcnt(5)
    v_mfma_f32_32x32x16_bf16 v[96:111], v[32:35], a[176:179], v[96:111]
    v_mfma_f32_32x32x16_bf16 v[112:127], v[32:35], a[216:219], v[112:127]
    s_waitcnt vmcnt(4)
    v_mfma_f32_32x32x16_bf16 v[96:111], v[36:39], a[180:183], v[96:111]
    v_mfma_f32_32x32x16_bf16 v[112:127], v[36:39], a[220:223], v[112:127]
    s_waitcnt vmcnt(3)
    v_mfma_f32_32x32x16_bf16 v[96:111], v[40:43], a[184:187], v[96:111]
    v_mfma_f32_32x32x16_bf16 v[112:127], v[40:43], a[224:227], v[112:127]
    s_waitcnt vmcnt(2)
    v_mfma_f32_32x32x16_bf16 v[96:111], v[44:47], a[188:191], v[96:111]
    v_mfma_f32_32x32x16_bf16 v[112:127], v[44:47], a[228:231], v[112:127]
    s_waitcnt vmcnt(1)
    v_mfma_f32_32x32x16_bf16 v[96:111], v[48:51], a[192:195], v[96:111]
    v_mfma_f32_32x32x16_bf16 v[112:127], v[48:51], a[232:235], v[112:127]
    s_waitcnt vmcnt(0)
    v_mfma_f32_32x32x16_bf16 v[96:111], v[52:55], a[196:199], v[96:111]
    v_mfma_f32_32x32x16_bf16 v[112:127], v[52:55], a[236:239], v[112:127]
    s_mul_i32 s55, s44, s58
    s_add_u32 s55, s55, s51
    s_nop 1
    ds_write_b128 v4, v[96:99] offset:0
    v_mov_b64 v[128:129], 0
    s_mov_b32 s34, 0x3f803f80
    v_dot2c_f32_bf16 v128, s34, v16
    v_dot2c_f32_bf16 v129, v16, v16
    v_dot2c_f32_bf16 v128, s34, v17
    v_dot2c_f32_bf16 v129, v17, v17
    v_dot2c_f32_bf16 v128, s34, v18
    v_dot2c_f32_bf16 v129, v18, v18
    v_dot2c_f32_bf16 v128, s34, v19
    v_dot2c_f32_bf16 v129, v19, v19
    v_dot2c_f32_bf16 v128, s34, v20
    v_dot2c_f32_bf16 v129, v20, v20
    ds_write_b128 v4, v[100:103] offset:1024
    v_dot2c_f32_bf16 v128, s34, v21
    v_dot2c_f32_bf16 v129, v21, v21
    v_dot2c_f32_bf16 v128, s34, v22
    v_dot2c_f32_bf16 v129, v22, v22
    v_dot2c_f32_bf16 v128, s34, v23
    v_dot2c_f32_bf16 v129, v23, v23
    v_dot2c_f32_bf16 v128, s34, v24
    v_dot2c_f32_bf16 v129, v24, v24
    v_dot2c_f32_bf16 v128, s34, v25
    v_dot2c_f32_bf16 v129, v25, v25
    ds_write_b128 v4, v[104:107] offset:2048
    v_dot2c_f32_bf16 v128, s34, v26
    v_dot2c_f32_bf16 v129, v26, v26
    v_dot2c_f32_bf16 v128, s34, v27
    v_dot2c_f32_bf16 v129, v27, v27
    v_dot2c_f32_bf16 v128, s34, v28
    v_dot2c_f32_bf16 v129, v28, v28
    v_dot2c_f32_bf16 v128, s34, v29
    v_dot2c_f32_bf16 v129, v29, v29
    v_dot2c_f32_bf16 v128, s34, v30
    v_dot2c_f32_bf16 v129, v30, v30
    ds_write_b128 v4, v[108:111] offset:3072
    v_dot2c_f32_bf16 v128, s34, v31
    v_dot2c_f32_bf16 v129, v31, v31
    v_dot2c_f32_bf16 v128, s34, v32
    v_dot2c_f32_bf16 v129, v32, v32
    v_dot2c_f32_bf16 v128, s34, v33
    v_dot2c_f32_bf16 v129, v33, v33
    v_dot2c_f32_bf16 v128, s34, v34
    v_dot2c_f32_bf16 v129, v34, v34
    v_dot2c_f32_bf16 v128, s34, v35
    v_dot2c_f32_bf16 v129, v35, v35
    ds_write_b128 v4, v[112:115] offset:4096
    v_dot2c_f32_bf16 v128, s34, v36
    v_dot2c_f32_bf16 v129, v36, v36
    v_dot2c_f32_bf16 v128, s34, v37
    v_dot2c_f32_bf16 v129, v37, v37
    v_dot2c_f32_bf16 v128, s34, v38
    v_dot2c_f32_bf16 v129, v38, v38
    v_dot2c_f32_bf16 v128, s34, v39
    v_dot2c_f32_bf16 v129, v39, v39
    v_dot2c_f32_bf16 v128, s34, v40
    v_dot2c_f32_bf16 v129, v40, v40
    ds_write_b128 v4, v[116:119] offset:5120
    v_dot2c_f32_bf16 v128, s34, v41
    v_dot2c_f32_bf16 v129, v41, v41
    v_dot2c_f32_bf16 v128, s34, v42
    v_dot2c_f32_bf16 v129, v42, v42
    v_dot2c_f32_bf16 v128, s34, v43
    v_dot2c_f32_bf16 v129, v43, v43
    v_dot2c_f32_bf16 v128, s34, v44
    v_dot2c_f32_bf16 v129, v44, v44
    v_dot2c_f32_bf16 v128, s34, v45
    v_dot2c_f32_bf16 v129, v45, v45
    ds_write_b128 v4, v[120:123] offset:6144
    v_dot2c_f32_bf16 v128, s34, v46
    v_dot2c_f32_bf16 v129, v46, v46
    v_dot2c_f32_bf16 v128, s34, v47
    v_dot2c_f32_bf16 v129, v47, v47
    v_dot2c_f32_bf16 v128, s34, v48
    v_dot2c_f32_bf16 v129, v48, v48
    v_dot2c_f32_bf16 v128, s34, v49
    v_dot2c_f32_bf16 v129, v49, v49
    v_dot2c_f32_bf16 v128, s34, v50
    v_dot2c_f32_bf16 v129, v50, v50
    ds_write_b128 v4, v[124:127] offset:7168
    v_dot2c_f32_bf16 v128, s34, v51
    v_dot2c_f32_bf16 v129, v51, v51
    v_dot2c_f32_bf16 v128, s34, v52
    v_dot2c_f32_bf16 v129, v52, v52
    v_dot2c_f32_bf16 v128, s34, v53
    v_dot2c_f32_bf16 v129, v53, v53
    v_dot2c_f32_bf16 v128, s34, v54
    v_dot2c_f32_bf16 v129, v54, v54
    v_dot2c_f32_bf16 v128, s34, v55
    v_dot2c_f32_bf16 v129, v55, v55
    s_nop 2
    v_mov_b64 v[172:173], v[128:129]
    s_nop 1
    v_permlane32_swap_b32 v128, v172
    v_permlane32_swap_b32 v129, v173
    v_pk_add_f32 v[128:129], v[128:129], v[172:173]
    ds_write_b64 v5, v[128:129] offset:0
    s_waitcnt lgkmcnt(0)
    s_barrier
    ds_read_b128 v[130:133], v6 offset:0
    ds_read_b128 v[134:137], v6 offset:16
    ds_read_b128 v[96:99], v3 offset:0
    ds_read_b128 v[100:103], v3 offset:1024
    ds_read_b128 v[104:107], v3 offset:8192
    ds_read_b128 v[108:111], v3 offset:9216
    ds_read_b128 v[112:115], v3 offset:16384
    ds_read_b128 v[116:119], v3 offset:17408
    ds_read_b128 v[120:123], v3 offset:24576
    ds_read_b128 v[124:127], v3 offset:25600
    s_waitcnt lgkmcnt(9)
    v_pk_add_f32 v[130:131], v[130:131], v[132:133]
    s_waitcnt lgkmcnt(8)
    v_pk_add_f32 v[134:135], v[134:135], v[136:137]
    v_pk_add_f32 v[130:131], v[130:131], v[134:135]
    v_mul_f32 v130, 0x3acccccd, v130
    v_mul_f32 v131, 0x3acccccd, v131
    v_fma_f32 v131, -v130, v130, v131
    v_max_f32 v131, 0, v131
    v_add_f32 v131, 0x3727c5ac, v131
    v_rsq_f32 v131, v131
    s_nop 0
    ds_write2_b32 v9, v130, v131 offset0:0 offset1:32
    ds_read_b128 v[138:141], v10 offset:0
    ds_read_b128 v[142:145], v10 offset:16
    ds_read_b128 v[146:149], v10 offset:128
    ds_read_b128 v[150:153], v10 offset:144
    s_waitcnt lgkmcnt(10)
    v_pk_add_f32 v[96:97], v[96:97], v[104:105]
    v_pk_add_f32 v[98:99], v[98:99], v[106:107]
    s_waitcnt lgkmcnt(9)
    v_pk_add_f32 v[100:101], v[100:101], v[108:109]
    v_pk_add_f32 v[102:103], v[102:103], v[110:111]
    s_waitcnt lgkmcnt(8)
    v_pk_add_f32 v[96:97], v[96:97], v[112:113]
    v_pk_add_f32 v[98:99], v[98:99], v[114:115]
    s_waitcnt lgkmcnt(7)
    v_pk_add_f32 v[100:101], v[100:101], v[116:117]
    v_pk_add_f32 v[102:103], v[102:103], v[118:119]
    s_waitcnt lgkmcnt(6)
    v_pk_add_f32 v[96:97], v[96:97], v[120:121]
    v_pk_add_f32 v[98:99], v[98:99], v[122:123]
    s_waitcnt lgkmcnt(5)
    v_pk_add_f32 v[100:101], v[100:101], v[124:125]
    v_pk_add_f32 v[102:103], v[102:103], v[126:127]
    s_waitcnt lgkmcnt(3)
    v_fma_f32 v96, -v138, v154, v96
    s_waitcnt lgkmcnt(1)
    v_mul_f32 v96, v96, v146
    v_fma_f32 v97, -v139, v155, v97
    v_mul_f32 v97, v97, v147
    v_fma_f32 v98, -v140, v156, v98
    v_mul_f32 v98, v98, v148
    v_fma_f32 v99, -v141, v157, v99
    v_mul_f32 v99, v99, v149
    v_fma_f32 v100, -v142, v158, v100
    s_waitcnt lgkmcnt(0)
    v_mul_f32 v100, v100, v150
    v_fma_f32 v101, -v143, v159, v101
    v_mul_f32 v101, v101, v151
    v_fma_f32 v102, -v144, v160, v102
    v_mul_f32 v102, v102, v152
    v_fma_f32 v103, -v145, v161, v103
    v_mul_f32 v103, v103, v153
    v_cvt_pk_bf16_f32 v172, v96, v97
    v_cvt_pk_bf16_f32 v173, v98, v99
    v_cvt_pk_bf16_f32 v174, v100, v101
    v_cvt_pk_bf16_f32 v175, v102, v103
    buffer_store_dwordx4 v[172:175], v7, s[4:7], s55 offen sc1
    s_add_u32 s44, s44, s47
    s_cmp_lt_u32 s44, 64
    s_cbranch_scc0 G_336
    s_lshl_b32 s37, s44, 1
    s_mul_i32 s38, s37, 10923
    s_lshr_b32 s38, s38, 16
    s_mul_i32 s39, s38, 6
    s_sub_u32 s39, s37, s39
    v_and_b32 v180, 1, v1
    v_add_u32 v182, s39, v180
    s_cmp_lt_u32 s37, 72
    s_cselect_b32 s38, -60, 4
    s_lshl_b32 s38, s38, 7
    v_cmp_lt_u32 vcc, 2, v182
    v_mov_b32 v183, s38
    s_nop 0
    v_cndmask_b32 v183, 0, v183, vcc
    v_mul_u32_u24 v182, 2560, v182
    v_add3_u32 v182, v182, v183, v181
    s_add_u32 s37, s37, 1
    v_add_u32 v180, s37, v180
    s_mov_b32 s48, 0
P_339:
    buffer_load_dword v172, v182, s[4:7], 0 offen sc1
    s_waitcnt vmcnt(0)
    v_cmp_gt_u32 vcc, v180, v172
    s_cbranch_vccz P_340
    s_add_u32 s48, s48, 1
    s_cmp_gt_u32 s48, 200000
    s_cbranch_scc1 L_end
    s_sleep 1
    v_add_u32 v172, 12, v172
    v_cmp_gt_u32 vcc, v180, v172
    s_cbranch_vccz P_339
    s_sleep 24
    s_branch P_339
P_340:
    s_mul_i32 s54, s44, 40960
    s_add_u32 s56, s54, s52
    s_add_u32 s54, s54, s50
    buffer_load_dwordx4 v[56:59], v0, s[4:7], s54 offen offset:0 sc1
    buffer_load_dwordx4 v[60:63], v0, s[4:7], s54 offen offset:1024 sc1
    buffer_load_dwordx4 v[64:67], v0, s[4:7], s54 offen offset:2048 sc1
    buffer_load_dwordx4 v[68:71], v0, s[4:7], s54 offen offset:3072 sc1
    s_add_u32 s54, s54, 4096
    buffer_load_dwordx4 v[72:75], v0, s[4:7], s54 offen offset:0 sc1
    buffer_load_dwordx4 v[76:79], v0, s[4:7], s54 offen offset:1024 sc1
    buffer_load_dwordx4 v[80:83], v0, s[4:7], s54 offen offset:2048 sc1
    buffer_load_dwordx4 v[84:87], v0, s[4:7], s54 offen offset:3072 sc1
    s_add_u32 s54, s54, 4096
    buffer_load_dwordx4 v[88:91], v0, s[4:7], s54 offen offset:0 sc1
    buffer_load_dwordx4 v[92:95], v0, s[4:7], s54 offen offset:1024 sc1
    s_waitcnt vmcnt(9)
    v_mfma_f32_32x32x16_bf16 v[96:111], v[56:59], a[160:163], 0
    v_mfma_f32_32x32x16_bf16 v[112:127], v[56:59], a[200:203], 0
    s_waitcnt vmcnt(8)
    v_mfma_f32_32x32x16_bf16 v[96:111], v[60:63], a[164:167], v[96:111]
    v_mfma_f32_32x32x16_bf16 v[112:127], v[60:63], a[204:207], v[112:127]
    s_waitcnt vmcnt(7)
    v_mfma_f32_32x32x16_bf16 v[96:111], v[64:67], a[168:171], v[96:111]
    v_mfma_f32_32x32x16_bf16 v[112:127], v[64:67], a[208:211], v[112:127]
    s_waitcnt vmcnt(6)
    v_mfma_f32_32x32x16_bf16 v[96:111], v[68:71], a[172:175], v[96:111]
    v_mfma_f32_32x32x16_bf16 v[112:127], v[68:71], a[212:215], v[112:127]
    s_waitcnt vmcnt(5)
    v_mfma_f32_32x32x16_bf16 v[96:111], v[72:75], a[176:179], v[96:111]
    v_mfma_f32_32x32x16_bf16 v[112:127], v[72:75], a[216:219], v[112:127]
    s_waitcnt vmcnt(4)
    v_mfma_f32_32x32x16_bf16 v[96:111], v[76:79], a[180:183], v[96:111]
    v_mfma_f32_32x32x16_bf16 v[112:127], v[76:79], a[220:223], v[112:127]
    s_waitcnt vmcnt(3)
    v_mfma_f32_32x32x16_bf16 v[96:111], v[80:83], a[184:187], v[96:111]
    v_mfma_f32_32x32x16_bf16 v[112:127], v[80:83], a[224:227], v[112:127]
    s_waitcnt vmcnt(2)
    v_mfma_f32_32x32x16_bf16 v[96:111], v[84:87], a[188:191], v[96:111]
    v_mfma_f32_32x32x16_bf16 v[112:127], v[84:87], a[228:231], v[112:127]
    s_waitcnt vmcnt(1)
    v_mfma_f32_32x32x16_bf16 v[96:111], v[88:91], a[192:195], v[96:111]
    v_mfma_f32_32x32x16_bf16 v[112:127], v[88:91], a[232:235], v[112:127]
    s_waitcnt vmcnt(0)
    v_mfma_f32_32x32x16_bf16 v[96:111], v[92:95], a[196:199], v[96:111]
    v_mfma_f32_32x32x16_bf16 v[112:127], v[92:95], a[236:239], v[112:127]
    s_mul_i32 s55, s44, s58
    s_add_u32 s55, s55, s51
    s_nop 1
    ds_write_b128 v4, v[96:99] offset:32768
    v_mov_b64 v[128:129], 0
    s_mov_b32 s34, 0x3f803f80
    v_dot2c_f32_bf16 v128, s34, v56
    v_dot2c_f32_bf16 v129, v56, v56
    v_dot2c_f32_bf16 v128, s34, v57
    v_dot2c_f32_bf16 v129, v57, v57
    v_dot2c_f32_bf16 v128, s34, v58
    v_dot2c_f32_bf16 v129, v58, v58
    v_dot2c_f32_bf16 v128, s34, v59
    v_dot2c_f32_bf16 v129, v59, v59
    v_dot2c_f32_bf16 v128, s34, v60
    v_dot2c_f32_bf16 v129, v60, v60
    ds_write_b128 v4, v[100:103] offset:33792
    v_dot2c_f32_bf16 v128, s34, v61
    v_dot2c_f32_bf16 v129, v61, v61
    v_dot2c_f32_bf16 v128, s34, v62
    v_dot2c_f32_bf16 v129, v62, v62
    v_dot2c_f32_bf16 v128, s34, v63
    v_dot2c_f32_bf16 v129, v63, v63
    v_dot2c_f32_bf16 v128, s34, v64
    v_dot2c_f32_bf16 v129, v64, v64
    v_dot2c_f32_bf16 v128, s34, v65
    v_dot2c_f32_bf16 v129, v65, v65
    ds_write_b128 v4, v[104:107] offset:34816
    v_dot2c_f32_bf16 v128, s34, v66
    v_dot2c_f32_bf16 v129, v66, v66
    v_dot2c_f32_bf16 v128, s34, v67
    v_dot2c_f32_bf16 v129, v67, v67
    v_dot2c_f32_bf16 v128, s34, v68
    v_dot2c_f32_bf16 v129, v68, v68
    v_dot2c_f32_bf16 v128, s34, v69
    v_dot2c_f32_bf16 v129, v69, v69
    v_dot2c_f32_bf16 v128, s34, v70
    v_dot2c_f32_bf16 v129, v70, v70
    ds_write_b128 v4, v[108:111] offset:35840
    v_dot2c_f32_bf16 v128, s34, v71
    v_dot2c_f32_bf16 v129, v71, v71
    v_dot2c_f32_bf16 v128, s34, v72
    v_dot2c_f32_bf16 v129, v72, v72
    v_dot2c_f32_bf16 v128, s34, v73
    v_dot2c_f32_bf16 v129, v73, v73
    v_dot2c_f32_bf16 v128, s34, v74
    v_dot2c_f32_bf16 v129, v74, v74
    v_dot2c_f32_bf16 v128, s34, v75
    v_dot2c_f32_bf16 v129, v75, v75
    ds_write_b128 v4, v[112:115] offset:36864
    v_dot2c_f32_bf16 v128, s34, v76
    v_dot2c_f32_bf16 v129, v76, v76
    v_dot2c_f32_bf16 v128, s34, v77
    v_dot2c_f32_bf16 v129, v77, v77
    v_dot2c_f32_bf16 v128, s34, v78
    v_dot2c_f32_bf16 v129, v78, v78
    v_dot2c_f32_bf16 v128, s34, v79
    v_dot2c_f32_bf16 v129, v79, v79
    v_dot2c_f32_bf16 v128, s34, v80
    v_dot2c_f32_bf16 v129, v80, v80
    ds_write_b128 v4, v[116:119] offset:37888
    v_dot2c_f32_bf16 v128, s34, v81
    v_dot2c_f32_bf16 v129, v81, v81
    v_dot2c_f32_bf16 v128, s34, v82
    v_dot2c_f32_bf16 v129, v82, v82
    v_dot2c_f32_bf16 v128, s34, v83
    v_dot2c_f32_bf16 v129, v83, v83
    v_dot2c_f32_bf16 v128, s34, v84
    v_dot2c_f32_bf16 v129, v84, v84
    v_dot2c_f32_bf16 v128, s34, v85
    v_dot2c_f32_bf16 v129, v85, v85
    ds_write_b128 v4, v[120:123] offset:38912
    v_dot2c_f32_bf16 v128, s34, v86
    v_dot2c_f32_bf16 v129, v86, v86
    v_dot2c_f32_bf16 v128, s34, v87
    v_dot2c_f32_bf16 v129, v87, v87
    v_dot2c_f32_bf16 v128, s34, v88
    v_dot2c_f32_bf16 v129, v88, v88
    v_dot2c_f32_bf16 v128, s34, v89
    v_dot2c_f32_bf16 v129, v89, v89
    v_dot2c_f32_bf16 v128, s34, v90
    v_dot2c_f32_bf16 v129, v90, v90
    ds_write_b128 v4, v[124:127] offset:39936
    v_dot2c_f32_bf16 v128, s34, v91
    v_dot2c_f32_bf16 v129, v91, v91
    v_dot2c_f32_bf16 v128, s34, v92
    v_dot2c_f32_bf16 v129, v92, v92
    v_dot2c_f32_bf16 v128, s34, v93
    v_dot2c_f32_bf16 v129, v93, v93
    v_dot2c_f32_bf16 v128, s34, v94
    v_dot2c_f32_bf16 v129, v94, v94
    v_dot2c_f32_bf16 v128, s34, v95
    v_dot2c_f32_bf16 v129, v95, v95
    s_nop 2
    v_mov_b64 v[172:173], v[128:129]
    s_nop 1
    v_permlane32_swap_b32 v128, v172
    v_permlane32_swap_b32 v129, v173
    v_pk_add_f32 v[128:129], v[128:129], v[172:173]
    ds_write_b64 v5, v[128:129] offset:1024
    s_waitcnt lgkmcnt(0)
    s_barrier
    ds_read_b128 v[130:133], v6 offset:1024
    ds_read_b128 v[134:137], v6 offset:1040
    ds_read_b128 v[96:99], v3 offset:32768
    ds_read_b128 v[100:103], v3 offset:33792
    ds_read_b128 v[104:107], v3 offset:40960
    ds_read_b128 v[108:111], v3 offset:41984
    ds_read_b128 v[112:115], v3 offset:49152
    ds_read_b128 v[116:119], v3 offset:50176
    ds_read_b128 v[120:123], v3 offset:57344
    ds_read_b128 v[124:127], v3 offset:58368
    s_waitcnt lgkmcnt(9)
    v_pk_add_f32 v[130:131], v[130:131], v[132:133]
    s_waitcnt lgkmcnt(8)
    v_pk_add_f32 v[134:135], v[134:135], v[136:137]
    v_pk_add_f32 v[130:131], v[130:131], v[134:135]
    v_mul_f32 v130, 0x3acccccd, v130
    v_mul_f32 v131, 0x3acccccd, v131
    v_fma_f32 v131, -v130, v130, v131
    v_max_f32 v131, 0, v131
    v_add_f32 v131, 0x3727c5ac, v131
    v_rsq_f32 v131, v131
    s_nop 0
    ds_write2_b32 v9, v130, v131 offset0:0 offset1:32
    ds_read_b128 v[138:141], v10 offset:0
    ds_read_b128 v[142:145], v10 offset:16
    ds_read_b128 v[146:149], v10 offset:128
    ds_read_b128 v[150:153], v10 offset:144
    s_waitcnt lgkmcnt(10)
    v_pk_add_f32 v[96:97], v[96:97], v[104:105]
    v_pk_add_f32 v[98:99], v[98:99], v[106:107]
    s_waitcnt lgkmcnt(9)
    v_pk_add_f32 v[100:101], v[100:101], v[108:109]
    v_pk_add_f32 v[102:103], v[102:103], v[110:111]
    s_waitcnt lgkmcnt(8)
    v_pk_add_f32 v[96:97], v[96:97], v[112:113]
    v_pk_add_f32 v[98:99], v[98:99], v[114:115]
    s_waitcnt lgkmcnt(7)
    v_pk_add_f32 v[100:101], v[100:101], v[116:117]
    v_pk_add_f32 v[102:103], v[102:103], v[118:119]
    s_waitcnt lgkmcnt(6)
    v_pk_add_f32 v[96:97], v[96:97], v[120:121]
    v_pk_add_f32 v[98:99], v[98:99], v[122:123]
    s_waitcnt lgkmcnt(5)
    v_pk_add_f32 v[100:101], v[100:101], v[124:125]
    v_pk_add_f32 v[102:103], v[102:103], v[126:127]
    s_waitcnt lgkmcnt(3)
    v_fma_f32 v96, -v138, v154, v96
    s_waitcnt lgkmcnt(1)
    v_mul_f32 v96, v96, v146
    v_fma_f32 v97, -v139, v155, v97
    v_mul_f32 v97, v97, v147
    v_fma_f32 v98, -v140, v156, v98
    v_mul_f32 v98, v98, v148
    v_fma_f32 v99, -v141, v157, v99
    v_mul_f32 v99, v99, v149
    v_fma_f32 v100, -v142, v158, v100
    s_waitcnt lgkmcnt(0)
    v_mul_f32 v100, v100, v150
    v_fma_f32 v101, -v143, v159, v101
    v_mul_f32 v101, v101, v151
    v_fma_f32 v102, -v144, v160, v102
    v_mul_f32 v102, v102, v152
    v_fma_f32 v103, -v145, v161, v103
    v_mul_f32 v103, v103, v153
    v_cvt_pk_bf16_f32 v172, v96, v97
    v_cvt_pk_bf16_f32 v173, v98, v99
    v_cvt_pk_bf16_f32 v174, v100, v101
    v_cvt_pk_bf16_f32 v175, v102, v103
    buffer_store_dwordx4 v[172:175], v7, s[4:7], s55 offen sc1
    s_add_u32 s44, s44, s47
    s_cmp_lt_u32 s44, 64
    s_cbranch_scc1 G_335
G_336:
    s_waitcnt vmcnt(0)
    s_barrier
    s_cmp_lg_u32 s29, 0
    s_cbranch_scc1 F_341
    s_lshl_b32 s32, s28, 5
    s_add_u32 s32, s32, s29
    s_lshl_b32 s32, s32, 2
    s_add_u32 s32, s32, 1073152
    v_mov_b32 v172, 2
    s_mov_b64 exec, 1
    buffer_store_dword v172, off, s[4:7], s32 sc1
    s_mov_b64 exec, -1
F_341:
R_334:
    s_sub_u32 s32, s28, 128
    s_cmp_lt_u32 s32, 32
    s_cbranch_scc1 R_342
    v_add_u32 v2, s60, v0
    ds_read_b128 a[160:163], v2 offset:0
    ds_read_b128 a[164:167], v2 offset:1024
    ds_read_b128 a[168:171], v2 offset:2048
    ds_read_b128 a[172:175], v2 offset:3072
    ds_read_b128 a[176:179], v2 offset:4096
    ds_read_b128 a[180:183], v2 offset:5120
    ds_read_b128 a[184:187], v2 offset:6144
    ds_read_b128 a[188:191], v2 offset:7168
    ds_read_b128 a[192:195], v2 offset:8192
    ds_read_b128 a[196:199], v2 offset:9216
    ds_read_b128 a[200:203], v2 offset:10240
    ds_read_b128 a[204:207], v2 offset:11264
    ds_read_b128 a[208:211], v2 offset:12288
    ds_read_b128 a[212:215], v2 offset:13312
    ds_read_b128 a[216:219], v2 offset:14336
    ds_read_b128 a[220:223], v2 offset:15360
    ds_read_b128 a[224:227], v2 offset:16384
    ds_read_b128 a[228:231], v2 offset:17408
    ds_read_b128 a[232:235], v2 offset:18432
    ds_read_b128 a[236:239], v2 offset:19456
    s_waitcnt lgkmcnt(0)
R_342:
    s_mov_b32 s30, 1
    s_mov_b32 s61, 64
    s_waitcnt vmcnt(0) lgkmcnt(0)
    s_branch LAYER_268

s_endpgm
.section .rodata,"a"
.p2align 6
.amdhsa_kernel interleave_layers__spectral_gfnet__memory_aug_recurrent_mem_tr__prompt_kernel
  .amdhsa_next_free_vgpr 512
  .amdhsa_next_free_sgpr 102
  .amdhsa_accum_offset 256
  .amdhsa_group_segment_fixed_size 0
  .amdhsa_kernarg_size 104
  .amdhsa_user_sgpr_count 2
  .amdhsa_user_sgpr_kernarg_segment_ptr 1
  .amdhsa_system_sgpr_workgroup_id_x 1
  .amdhsa_float_denorm_mode_32 3
.end_amdhsa_kernel
```

```asm
; @launch grid=(256,1,1) block=(256,1,1) lds=163840
.amdgcn_target "amdgcn-amd-amdhsa--gfx950"
.text
.globl interleave_layers__spectral_gfnet__memory_aug_recurrent_mem_tr__prompt_kernel
.p2align 8
.type interleave_layers__spectral_gfnet__memory_aug_recurrent_mem_tr__prompt_kernel,@function
interleave_layers__spectral_gfnet__memory_aug_recurrent_mem_tr__prompt_kernel:
    s_cmp_ge_u32 s2, 256
    s_cbranch_scc1 L_end0
    v_lshrrev_b32 v1, 6, v0
    s_and_b32 s3, s2, 7
    s_lshr_b32 s2, s2, 3
    s_lshl_b32 s3, s3, 2
    s_lshr_b32 s3, 0x54321706, s3
    s_and_b32 s3, s3, 15
    s_cmp_ge_u32 s3, 2
    s_cbranch_scc1 L_worker0
    s_mov_b32 s19, s3
    s_mov_b32 s20, s2
    v_readfirstlane_b32 s21, v1
    s_branch L_chain
L_worker0:
    s_branch L_worker
L_end0:
    s_endpgm
L_chain:
    s_getpc_b64 s[4:5]
L_c0:
    s_mov_b32 s6, L_end - L_c0
    s_mov_b32 s7, 0x20000
    v_and_b32 v2, 63, v0
    v_lshlrev_b32 v2, 6, v2
    s_lshl_b32 s3, s2, 12
    buffer_load_dword v63, v2, s[4:7], s3 offen
    s_load_dwordx2 s[32:33], s[0:1], 96
    s_mov_b32 s34, 268435456
    s_mov_b32 s35, 0x20000
    s_load_dwordx2 s[36:37], s[0:1], 96
    s_mov_b32 s38, 268435456
    s_mov_b32 s39, 0x20000
    s_load_dwordx2 s[28:29], s[0:1], 96
    s_mov_b32 s30, 196608
    s_mov_b32 s31, 0x20000
    s_load_dwordx2 s[4:5], s[0:1], 88
    s_mov_b32 s6, 256
    s_mov_b32 s7, 0x20000
    v_and_b32 v12, 63, v0
    v_lshrrev_b32 v13, 4, v12
    v_and_b32 v14, 15, v12
    v_lshlrev_b32 v0, 4, v12
    s_lshl_b32 s64, s21, 15
    s_add_u32 s64, s64, 32768
    v_add_u32 v1, s64, v0
    v_bfe_u32 v8, v14, 1, 1
    v_mul_u32_u24 v8, 0xAAAA, v8
    v_add_u32 v2, 0x4444, v8
    s_mul_i32 s47, s21, 544
    s_add_u32 s47, s47, 10240
    v_lshrrev_b32 v8, 1, v13
    v_and_b32 v9, 1, v13
    v_lshlrev_b32 v10, 3, v12
    v_lshl_add_u32 v10, v8, 5, v10
    v_add_u32 v3, s47, v10
    v_mul_u32_u24 v10, 544, v8
    v_and_b32 v11, 3, v14
    v_lshl_add_u32 v10, v11, 7, v10
    v_bfe_u32 v11, v14, 1, 1
    v_lshl_add_u32 v10, v11, 5, v10
    v_lshl_add_u32 v10, v9, 6, v10
    v_lshrrev_b32 v4, 2, v14
    v_lshl_add_u32 v10, v4, 3, v10
    v_add_u32 v4, 10240, v10
    s_lshl_b32 s47, s21, 9
    s_add_u32 s47, s47, 8192
    v_mul_u32_u24 v10, 8, v11
    v_and_b32 v11, 13, v14
    v_lshl_add_u32 v11, v9, 1, v11
    v_lshl_add_u32 v11, v8, 4, v11
    v_lshl_add_u32 v11, v11, 4, v10
    v_add_u32 v5, s47, v11
    s_lshl_b32 s47, s21, 14
    s_lshl_b32 s48, s20, 6
    s_add_u32 s47, s47, s48
    v_lshrrev_b32 v8, 3, v12
    v_and_b32 v9, 7, v12
    v_lshlrev_b32 v9, 3, v9
    v_lshl_add_u32 v8, v8, 11, v9
    v_add_u32 v7, s47, v8
    v_and_b32 v8, 1, v14
    v_lshlrev_b32 v8, 3, v8
    v_lshl_add_u32 v9, v13, 4, v8
    v_and_b32 v8, 2, v14
    v_lshl_add_u32 v9, v8, 4, v9
    v_lshrrev_b32 v11, 3, v14
    s_cmp_ge_u32 s21, 2
    s_cbranch_scc1 CH_s_1
    s_lshl_b32 s46, s21, 16
    s_lshl_b32 s47, s20, 11
    s_add_u32 s46, s46, s47
    s_lshl_b32 s47, s21, 11
    s_lshr_b32 s48, s20, 3
    s_lshl_b32 s48, s48, 9
    s_add_u32 s47, s47, s48
    s_and_b32 s48, s20, 1
    s_lshl_b32 s48, s48, 8
    s_add_u32 s47, s47, s48
    s_bfe_u32 s48, s20, 0x20001
    s_lshl_b32 s48, s48, 6
    s_add_u32 s47, s47, s48
    v_bfe_u32 v10, v14, 2, 1
    v_or_b32 v10, v10, v8
    s_mov_b32 s91, 0
    s_mov_b32 s95, 0
    s_branch CH_s_2
CH_s_1:
    s_and_b32 s48, s20, 15
    s_lshl_b32 s46, s48, 11
    s_add_u32 s46, s46, 131072
    s_lshl_b32 s47, s48, 6
    s_add_u32 s47, s47, 4096
    v_and_b32 v10, 3, v14
    s_mov_b32 s91, 2
    s_and_b32 s95, s20, 16
CH_s_2:
    v_add_u32 v9, s47, v9
    v_lshl_add_u32 v10, v11, 2, v10
    v_and_b32 v8, 0x2c, v12
    v_or_b32 v8, s95, v8
    v_cmp_eq_u32 vcc, 0, v8
    v_mov_b32 v11, 1073741824
    s_nop 0
    v_cndmask_b32 v6, v11, v9, vcc
    v_cmp_eq_u32 s[52:53], 0, v10
    v_cmp_eq_u32 s[54:55], 1, v10
    v_cmp_eq_u32 s[56:57], 2, v10
    v_cmp_eq_u32 s[58:59], 3, v10
    s_lshl_b32 s47, s19, 5
    s_add_u32 s47, s47, s20
    s_lshl_b32 s47, s47, 2
    s_add_u32 s47, s47, s21
    s_mul_i32 s45, s47, 143360
    s_lshl_b32 s63, s21, 11
    s_add_u32 s63, s63, 16384
    s_mov_b32 s51, 0x3e0293ee
    s_mov_b32 s61, 65536
    s_lshl_b32 s47, s21, 13
    s_lshl_b32 s48, s20, 6
    s_add_u32 s47, s47, s48
    s_add_u32 s62, s47, 131072
    s_mov_b32 s94, 0x7ffff800
    s_mov_b32 s65, 0x3f80
    s_mov_b32 s22, 0x3f803f80
    s_mov_b32 s23, 0x3f803f80
    s_lshl_b32 s92, s21, 10
    s_mov_b32 s86, 0xcccccccc
    s_mov_b32 s87, 0xcccccccc
    s_mov_b32 s16, s51
    s_mov_b32 s17, s51
    s_waitcnt lgkmcnt(0)
    v_mov_b64 v[8:9], 0
    v_mov_b64 v[10:11], 0
    v_mov_b64 v[12:13], -1
    v_mov_b64 v[14:15], -1
    s_lshr_b32 s47, s21, 1
    s_lshl_b32 s47, s47, 1
    s_add_u32 s47, s47, s19
    s_mul_i32 s47, s47, 196608
    s_lshl_b32 s48, s20, 10
    s_add_u32 s47, s47, s48
    s_add_u32 s47, s47, 65536
    s_bitcmp1_b32 s21, 0
    s_cbranch_scc1 CH_i_3
    s_add_u32 s48, s47, 0
    buffer_store_dwordx4 v[8:11], v0, s[32:35], s48 offen sc1
    s_add_u32 s48, s47, 32768
    buffer_store_dwordx4 v[8:11], v0, s[32:35], s48 offen sc1
    s_add_u32 s48, s47, 65536
    buffer_store_dwordx4 v[8:11], v0, s[32:35], s48 offen sc1
    s_branch CH_i_4
CH_i_3:
    s_add_u32 s48, s47, 98304
    buffer_store_dwordx4 v[8:11], v0, s[32:35], s48 offen sc1
    s_add_u32 s48, s47, 131072
    buffer_store_dwordx4 v[8:11], v0, s[32:35], s48 offen sc1
    s_add_u32 s48, s47, 163840
    buffer_store_dwordx4 v[12:15], v0, s[32:35], s48 offen sc1
CH_i_4:
    s_waitcnt vmcnt(0)
    s_barrier
    s_getreg_b32 s101, hwreg(HW_REG_XCC_ID, 0, 3)
    s_mul_i32 s101, s101, 6
    s_cmp_lg_u32 s21, 0
    s_cbranch_scc1 CH_i_5
    s_lshl_b64 s[66:67], 1, s101
    s_or_b32 s67, s67, 0x10000
    v_mov_b64 v[8:9], s[66:67]
    s_lshl_b32 s47, s19, 3
    s_mov_b64 exec, 1
    buffer_atomic_add_x2 v[8:9], off, s[4:7], s47 offset:128
    s_mov_b64 exec, -1
CH_i_5:
    s_waitcnt vmcnt(0)
    s_load_dwordx2 s[4:5], s[0:1], 40
    s_mov_b32 s6, 5242880
    s_mov_b32 s7, 0x20000
    s_load_dwordx2 s[8:9], s[0:1], 48
    s_mov_b32 s10, 5242880
    s_mov_b32 s11, 0x20000
    s_load_dwordx2 s[12:13], s[0:1], 56
    s_mov_b32 s14, 5242880
    s_mov_b32 s15, 0x20000
    s_load_dwordx2 s[24:25], s[0:1], 64
    s_mov_b32 s26, 5242880
    s_mov_b32 s27, 0x20000
    v_lshrrev_b32 v8, 4, v0
    v_bfe_u32 v9, v8, 4, 2
    v_mul_u32_u24 v9, 8192, v9
    v_bfe_u32 v10, v8, 4, 2
    v_mul_u32_u24 v10, 1280, v10
    v_xor_b32 v20, 0, v0
    v_and_b32 v20, 255, v20
    v_add_u32 v40, v9, v20
    v_add_u32 v44, v10, v20
    v_xor_b32 v20, 64, v0
    v_and_b32 v20, 255, v20
    v_add_u32 v41, v9, v20
    v_add_u32 v45, v10, v20
    v_xor_b32 v20, 128, v0
    v_and_b32 v20, 255, v20
    v_add_u32 v42, v9, v20
    v_add_u32 v46, v10, v20
    v_xor_b32 v20, 192, v0
    v_and_b32 v20, 255, v20
    v_add_u32 v43, v9, v20
    v_add_u32 v47, v10, v20
    v_bfe_u32 v11, v8, 3, 3
    v_mul_u32_u24 v11, 1280, v11
    v_bfe_u32 v20, v8, 0, 3
    v_lshl_add_u32 v11, v20, 4, v11
    s_lshl_b32 s47, s21, 6
    v_bfe_u32 v18, v8, 3, 1
    v_mul_u32_u24 v18, 128, v18
    v_bfe_u32 v20, v8, 2, 1
    v_lshl_add_u32 v18, v20, 6, v18
    v_xor_b32 v18, s47, v18
    v_bfe_u32 v12, v8, 3, 1
    v_mul_u32_u24 v12, 2048, v12
    v_bfe_u32 v20, v8, 2, 1
    v_lshl_add_u32 v12, v20, 10, v12
    v_bfe_u32 v20, v8, 4, 1
    v_lshl_add_u32 v12, v20, 9, v12
    v_bfe_u32 v20, v8, 0, 2
    v_lshl_add_u32 v12, v20, 3, v12
    v_add_u32 v12, v12, v18
    v_bfe_u32 v18, v8, 3, 1
    v_mul_u32_u24 v18, 128, v18
    v_bfe_u32 v20, v8, 4, 1
    v_lshl_add_u32 v18, v20, 6, v18
    v_xor_b32 v18, s47, v18
    v_bfe_u32 v13, v8, 3, 1
    v_mul_u32_u24 v13, 2048, v13
    v_bfe_u32 v20, v8, 4, 1
    v_lshl_add_u32 v13, v20, 10, v13
    v_bfe_u32 v20, v8, 2, 1
    v_lshl_add_u32 v13, v20, 8, v13
    v_bfe_u32 v20, v8, 0, 2
    v_lshl_add_u32 v13, v20, 3, v13
    v_add_u32 v13, v13, v18
    v_bfe_u32 v18, v8, 5, 1
    v_mul_u32_u24 v18, 128, v18
    v_bfe_u32 v20, v8, 3, 1
    v_lshl_add_u32 v18, v20, 6, v18
    v_xor_b32 v18, s47, v18
    v_bfe_u32 v14, v8, 5, 1
    v_mul_u32_u24 v14, 2048, v14
    v_bfe_u32 v20, v8, 3, 1
    v_lshl_add_u32 v14, v20, 10, v14
    v_bfe_u32 v20, v8, 2, 1
    v_lshl_add_u32 v14, v20, 8, v14
    v_bfe_u32 v20, v8, 0, 2
    v_lshl_add_u32 v14, v20, 4, v14
    v_add_u32 v14, v14, v18
    s_lshl_b32 s47, s21, 5
    v_bfe_u32 v15, v8, 4, 1
    v_mul_u32_u24 v15, 2048, v15
    v_bfe_u32 v20, v8, 5, 1
    v_lshl_add_u32 v15, v20, 10, v15
    v_bfe_u32 v20, v8, 3, 1
    v_lshl_add_u32 v15, v20, 9, v15
    v_bfe_u32 v20, v8, 2, 1
    v_lshl_add_u32 v15, v20, 7, v15
    v_bfe_u32 v20, v8, 0, 2
    v_lshl_add_u32 v15, v20, 3, v15
    v_add_u32 v15, s47, v15
    v_bfe_u32 v16, v8, 4, 1
    v_bfe_u32 v17, v8, 5, 1
    s_lshl_b32 s47, s20, 8
    s_lshl_b32 s48, s21, 17
    s_add_u32 s47, s47, s48
    s_mul_i32 s48, s19, 2621440
    s_add_u32 s66, s47, s48
    s_sub_u32 s67, s47, s48
    s_add_u32 s67, s67, 2621440
    s_mul_i32 s47, s20, 163840
    s_mul_i32 s48, s19, 640
    s_add_u32 s47, s47, s48
    s_mul_i32 s48, s21, 20480
    s_add_u32 s68, s47, s48
    s_add_u32 s69, s68, s48
    s_add_u32 s69, s69, 512
    s_lshl_b32 s70, s21, 13
    s_waitcnt lgkmcnt(0)
    s_add_u32 m0, s64, 4096
    s_add_u32 s47, s66, 2097152
    buffer_load_dwordx4 v40, s[4:7], s47 offen  lds
    s_add_u32 m0, s64, 5120
    s_add_u32 s47, s66, 2129920
    buffer_load_dwordx4 v41, s[4:7], s47 offen  lds
    s_add_u32 m0, s64, 6144
    s_add_u32 s47, s66, 2162688
    buffer_load_dwordx4 v42, s[4:7], s47 offen  lds
    s_add_u32 m0, s64, 7168
    s_add_u32 s47, s66, 2195456
    buffer_load_dwordx4 v43, s[4:7], s47 offen  lds
    s_add_u32 m0, s64, 8192
    s_add_u32 s47, s66, 2097152
    buffer_load_dwordx4 v40, s[8:11], s47 offen  lds
    s_add_u32 m0, s64, 9216
    s_add_u32 s47, s66, 2129920
    buffer_load_dwordx4 v41, s[8:11], s47 offen  lds
    s_add_u32 m0, s64, 10240
    s_add_u32 s47, s66, 2162688
    buffer_load_dwordx4 v42, s[8:11], s47 offen  lds
    s_add_u32 m0, s64, 11264
    s_add_u32 s47, s66, 2195456
    buffer_load_dwordx4 v43, s[8:11], s47 offen  lds
    s_add_u32 m0, s64, 12288
    s_add_u32 s47, s67, 2097152
    buffer_load_dwordx4 v40, s[8:11], s47 offen  lds
    s_add_u32 m0, s64, 13312
    s_add_u32 s47, s67, 2129920
    buffer_load_dwordx4 v41, s[8:11], s47 offen  lds
    s_add_u32 m0, s64, 14336
    s_add_u32 s47, s67, 2162688
    buffer_load_dwordx4 v42, s[8:11], s47 offen  lds
    s_add_u32 m0, s64, 15360
    s_add_u32 s47, s67, 2195456
    buffer_load_dwordx4 v43, s[8:11], s47 offen  lds
    s_add_u32 m0, s64, 16384
    s_add_u32 s47, s66, 0
    buffer_load_dwordx4 v40, s[12:15], s47 offen  lds
    s_add_u32 m0, s64, 17408
    s_add_u32 s47, s66, 32768
    buffer_load_dwordx4 v41, s[12:15], s47 offen  lds
    s_add_u32 m0, s64, 18432
    s_add_u32 s47, s66, 65536
    buffer_load_dwordx4 v42, s[12:15], s47 offen  lds
    s_add_u32 m0, s64, 19456
    s_add_u32 s47, s66, 98304
    buffer_load_dwordx4 v43, s[12:15], s47 offen  lds
    s_add_u32 m0, s64, 20480
    s_add_u32 s47, s66, 524288
    buffer_load_dwordx4 v40, s[12:15], s47 offen  lds
    s_add_u32 m0, s64, 21504
    s_add_u32 s47, s66, 557056
    buffer_load_dwordx4 v41, s[12:15], s47 offen  lds
    s_add_u32 m0, s64, 22528
    s_add_u32 s47, s66, 589824
    buffer_load_dwordx4 v42, s[12:15], s47 offen  lds
    s_add_u32 m0, s64, 23552
    s_add_u32 s47, s66, 622592
    buffer_load_dwordx4 v43, s[12:15], s47 offen  lds
    v_lshl_add_u32 v18, v17, 15, v13
    v_add_u32 v18, 32768, v18
    v_add_u32 v19, 65536, v18
    s_waitcnt vmcnt(16)
    s_barrier
    s_add_u32 m0, s64, 24576
    s_add_u32 s47, s66, 1048576
    buffer_load_dwordx4 v40, s[12:15], s47 offen  lds
    s_add_u32 m0, s64, 25600
    s_add_u32 s47, s66, 1081344
    buffer_load_dwordx4 v41, s[12:15], s47 offen  lds
    s_add_u32 m0, s64, 26624
    s_add_u32 s47, s66, 1114112
    buffer_load_dwordx4 v42, s[12:15], s47 offen  lds
    s_add_u32 m0, s64, 27648
    s_add_u32 s47, s66, 1146880
    buffer_load_dwordx4 v43, s[12:15], s47 offen  lds
    ds_read_b64_tr_b16 v[104:105], v18 offset:4096
    ds_read_b64_tr_b16 v[106:107], v18 offset:4608
    ds_read_b64_tr_b16 v[108:109], v19 offset:4096
    ds_read_b64_tr_b16 v[110:111], v19 offset:4608
    ds_read_b64_tr_b16 v[112:113], v18 offset:4128
    ds_read_b64_tr_b16 v[114:115], v18 offset:4640
    ds_read_b64_tr_b16 v[116:117], v19 offset:4128
    ds_read_b64_tr_b16 v[118:119], v19 offset:4640
    s_waitcnt lgkmcnt(0)
CH_u_6:
    v_lshl_add_u32 v18, v17, 15, v13
    v_add_u32 v18, 32768, v18
    v_add_u32 v19, 65536, v18
    s_waitcnt vmcnt(16)
    s_barrier
    s_add_u32 m0, s64, 4096
    s_add_u32 s47, s66, 1572864
    buffer_load_dwordx4 v40, s[12:15], s47 offen  lds
    s_add_u32 m0, s64, 5120
    s_add_u32 s47, s66, 1605632
    buffer_load_dwordx4 v41, s[12:15], s47 offen  lds
    s_add_u32 m0, s64, 6144
    s_add_u32 s47, s66, 1638400
    buffer_load_dwordx4 v42, s[12:15], s47 offen  lds
    s_add_u32 m0, s64, 7168
    s_add_u32 s47, s66, 1671168
    buffer_load_dwordx4 v43, s[12:15], s47 offen  lds
    ds_read_b64_tr_b16 v[120:121], v18 offset:8192
    ds_read_b64_tr_b16 v[122:123], v18 offset:8704
    ds_read_b64_tr_b16 v[124:125], v19 offset:8192
    ds_read_b64_tr_b16 v[126:127], v19 offset:8704
    ds_read_b64_tr_b16 v[128:129], v18 offset:8224
    ds_read_b64_tr_b16 v[130:131], v18 offset:8736
    ds_read_b64_tr_b16 v[132:133], v19 offset:8224
    ds_read_b64_tr_b16 v[134:135], v19 offset:8736
    s_waitcnt lgkmcnt(0)
CH_u_8:
    v_lshl_add_u32 v18, v17, 15, v13
    v_add_u32 v18, 32768, v18
    v_add_u32 v19, 65536, v18
    s_waitcnt vmcnt(16)
    s_barrier
    s_add_u32 m0, s64, 8192
    s_add_u32 s47, s67, 0
    buffer_load_dwordx4 v40, s[12:15], s47 offen  lds
    s_add_u32 m0, s64, 9216
    s_add_u32 s47, s67, 32768
    buffer_load_dwordx4 v41, s[12:15], s47 offen  lds
    s_add_u32 m0, s64, 10240
    s_add_u32 s47, s67, 65536
    buffer_load_dwordx4 v42, s[12:15], s47 offen  lds
    s_add_u32 m0, s64, 11264
    s_add_u32 s47, s67, 98304
    buffer_load_dwordx4 v43, s[12:15], s47 offen  lds
    ds_read_b64_tr_b16 a[48:49], v18 offset:12288
    ds_read_b64_tr_b16 a[50:51], v18 offset:12800
    ds_read_b64_tr_b16 a[52:53], v19 offset:12288
    ds_read_b64_tr_b16 a[54:55], v19 offset:12800
    ds_read_b64_tr_b16 a[56:57], v18 offset:12320
    ds_read_b64_tr_b16 a[58:59], v18 offset:12832
    ds_read_b64_tr_b16 a[60:61], v19 offset:12320
    ds_read_b64_tr_b16 a[62:63], v19 offset:12832
    s_waitcnt lgkmcnt(0)
CH_u_10:
    v_lshl_add_u32 v18, v17, 15, v12
    v_add_u32 v18, 32768, v18
    v_add_u32 v19, 65536, v18
    s_waitcnt vmcnt(16)
    s_barrier
    s_add_u32 m0, s64, 12288
    s_add_u32 s47, s67, 524288
    buffer_load_dwordx4 v40, s[12:15], s47 offen  lds
    s_add_u32 m0, s64, 13312
    s_add_u32 s47, s67, 557056
    buffer_load_dwordx4 v41, s[12:15], s47 offen  lds
    s_add_u32 m0, s64, 14336
    s_add_u32 s47, s67, 589824
    buffer_load_dwordx4 v42, s[12:15], s47 offen  lds
    s_add_u32 m0, s64, 15360
    s_add_u32 s47, s67, 622592
    buffer_load_dwordx4 v43, s[12:15], s47 offen  lds
    s_cmp_lg_u32 s21, 0
    s_cbranch_scc1 CH_u_13
    ds_read_b64_tr_b16 v[88:89], v18 offset:16384
    ds_read_b64_tr_b16 v[90:91], v18 offset:16640
    ds_read_b64_tr_b16 v[92:93], v19 offset:16384
    ds_read_b64_tr_b16 v[94:95], v19 offset:16640
    ds_read_b64_tr_b16 v[96:97], v18 offset:16416
    ds_read_b64_tr_b16 v[98:99], v18 offset:16672
    ds_read_b64_tr_b16 v[100:101], v19 offset:16416
    ds_read_b64_tr_b16 v[102:103], v19 offset:16672
    s_waitcnt lgkmcnt(0)
    s_branch CH_u_12
CH_u_13:
    s_cmp_lg_u32 s21, 1
    s_cbranch_scc1 CH_u_14
    ds_read_b64_tr_b16 v[168:169], v18 offset:16384
    ds_read_b64_tr_b16 v[170:171], v18 offset:16640
    ds_read_b64_tr_b16 v[172:173], v19 offset:16384
    ds_read_b64_tr_b16 v[174:175], v19 offset:16640
    ds_read_b64_tr_b16 v[176:177], v18 offset:16416
    ds_read_b64_tr_b16 v[178:179], v18 offset:16672
    ds_read_b64_tr_b16 v[180:181], v19 offset:16416
    ds_read_b64_tr_b16 v[182:183], v19 offset:16672
    s_waitcnt lgkmcnt(0)
    s_branch CH_u_12
CH_u_14:
    s_cmp_lg_u32 s21, 2
    s_cbranch_scc1 CH_u_15
    ds_read_b64_tr_b16 v[200:201], v18 offset:16384
    ds_read_b64_tr_b16 v[202:203], v18 offset:16640
    ds_read_b64_tr_b16 v[204:205], v19 offset:16384
    ds_read_b64_tr_b16 v[206:207], v19 offset:16640
    ds_read_b64_tr_b16 v[208:209], v18 offset:16416
    ds_read_b64_tr_b16 v[210:211], v18 offset:16672
    ds_read_b64_tr_b16 v[212:213], v19 offset:16416
    ds_read_b64_tr_b16 v[214:215], v19 offset:16672
    s_waitcnt lgkmcnt(0)
    s_branch CH_u_12
CH_u_15:
    ds_read_b64_tr_b16 v[248:249], v18 offset:16384
    ds_read_b64_tr_b16 v[250:251], v18 offset:16640
    ds_read_b64_tr_b16 v[252:253], v19 offset:16384
    ds_read_b64_tr_b16 v[254:255], v19 offset:16640
    ds_read_b64_tr_b16 a[0:1], v18 offset:16416
    ds_read_b64_tr_b16 a[2:3], v18 offset:16672
    ds_read_b64_tr_b16 a[4:5], v19 offset:16416
    ds_read_b64_tr_b16 a[6:7], v19 offset:16672
    s_waitcnt lgkmcnt(0)
CH_u_12:
    v_lshl_add_u32 v18, v17, 15, v12
    v_add_u32 v18, 32768, v18
    v_add_u32 v19, 65536, v18
    s_waitcnt vmcnt(16)
    s_barrier
    s_add_u32 m0, s64, 16384
    s_add_u32 s47, s67, 1048576
    buffer_load_dwordx4 v40, s[12:15], s47 offen  lds
    s_add_u32 m0, s64, 17408
    s_add_u32 s47, s67, 1081344
    buffer_load_dwordx4 v41, s[12:15], s47 offen  lds
    s_add_u32 m0, s64, 18432
    s_add_u32 s47, s67, 1114112
    buffer_load_dwordx4 v42, s[12:15], s47 offen  lds
    s_add_u32 m0, s64, 19456
    s_add_u32 s47, s67, 1146880
    buffer_load_dwordx4 v43, s[12:15], s47 offen  lds
    s_cmp_lg_u32 s21, 0
    s_cbranch_scc1 CH_u_18
    ds_read_b64_tr_b16 v[168:169], v18 offset:20480
    ds_read_b64_tr_b16 v[170:171], v18 offset:20736
    ds_read_b64_tr_b16 v[172:173], v19 offset:20480
    ds_read_b64_tr_b16 v[174:175], v19 offset:20736
    ds_read_b64_tr_b16 v[176:177], v18 offset:20512
    ds_read_b64_tr_b16 v[178:179], v18 offset:20768
    ds_read_b64_tr_b16 v[180:181], v19 offset:20512
    ds_read_b64_tr_b16 v[182:183], v19 offset:20768
    s_waitcnt lgkmcnt(0)
    s_branch CH_u_17
CH_u_18:
    s_cmp_lg_u32 s21, 1
    s_cbranch_scc1 CH_u_19
    ds_read_b64_tr_b16 v[88:89], v18 offset:20480
    ds_read_b64_tr_b16 v[90:91], v18 offset:20736
    ds_read_b64_tr_b16 v[92:93], v19 offset:20480
    ds_read_b64_tr_b16 v[94:95], v19 offset:20736
    ds_read_b64_tr_b16 v[96:97], v18 offset:20512
    ds_read_b64_tr_b16 v[98:99], v18 offset:20768
    ds_read_b64_tr_b16 v[100:101], v19 offset:20512
    ds_read_b64_tr_b16 v[102:103], v19 offset:20768
    s_waitcnt lgkmcnt(0)
    s_branch CH_u_17
CH_u_19:
    s_cmp_lg_u32 s21, 2
    s_cbranch_scc1 CH_u_20
    ds_read_b64_tr_b16 v[248:249], v18 offset:20480
    ds_read_b64_tr_b16 v[250:251], v18 offset:20736
    ds_read_b64_tr_b16 v[252:253], v19 offset:20480
    ds_read_b64_tr_b16 v[254:255], v19 offset:20736
    ds_read_b64_tr_b16 a[0:1], v18 offset:20512
    ds_read_b64_tr_b16 a[2:3], v18 offset:20768
    ds_read_b64_tr_b16 a[4:5], v19 offset:20512
    ds_read_b64_tr_b16 a[6:7], v19 offset:20768
    s_waitcnt lgkmcnt(0)
    s_branch CH_u_17
CH_u_20:
    ds_read_b64_tr_b16 v[200:201], v18 offset:20480
    ds_read_b64_tr_b16 v[202:203], v18 offset:20736
    ds_read_b64_tr_b16 v[204:205], v19 offset:20480
    ds_read_b64_tr_b16 v[206:207], v19 offset:20736
    ds_read_b64_tr_b16 v[208:209], v18 offset:20512
    ds_read_b64_tr_b16 v[210:211], v18 offset:20768
    ds_read_b64_tr_b16 v[212:213], v19 offset:20512
    ds_read_b64_tr_b16 v[214:215], v19 offset:20768
    s_waitcnt lgkmcnt(0)
CH_u_17:
    v_lshl_add_u32 v18, v17, 15, v12
    v_add_u32 v18, 32768, v18
    v_add_u32 v19, 65536, v18
    s_waitcnt vmcnt(16)
    s_barrier
    s_add_u32 m0, s64, 20480
    s_add_u32 s47, s67, 1572864
    buffer_load_dwordx4 v40, s[12:15], s47 offen  lds
    s_add_u32 m0, s64, 21504
    s_add_u32 s47, s67, 1605632
    buffer_load_dwordx4 v41, s[12:15], s47 offen  lds
    s_add_u32 m0, s64, 22528
    s_add_u32 s47, s67, 1638400
    buffer_load_dwordx4 v42, s[12:15], s47 offen  lds
    s_add_u32 m0, s64, 23552
    s_add_u32 s47, s67, 1671168
    buffer_load_dwordx4 v43, s[12:15], s47 offen  lds
    s_cmp_lg_u32 s21, 0
    s_cbranch_scc1 CH_u_23
    ds_read_b64_tr_b16 v[200:201], v18 offset:24576
    ds_read_b64_tr_b16 v[202:203], v18 offset:24832
    ds_read_b64_tr_b16 v[204:205], v19 offset:24576
    ds_read_b64_tr_b16 v[206:207], v19 offset:24832
    ds_read_b64_tr_b16 v[208:209], v18 offset:24608
    ds_read_b64_tr_b16 v[210:211], v18 offset:24864
    ds_read_b64_tr_b16 v[212:213], v19 offset:24608
    ds_read_b64_tr_b16 v[214:215], v19 offset:24864
    s_waitcnt lgkmcnt(0)
    s_branch CH_u_22
CH_u_23:
    s_cmp_lg_u32 s21, 1
    s_cbranch_scc1 CH_u_24
    ds_read_b64_tr_b16 v[248:249], v18 offset:24576
    ds_read_b64_tr_b16 v[250:251], v18 offset:24832
    ds_read_b64_tr_b16 v[252:253], v19 offset:24576
    ds_read_b64_tr_b16 v[254:255], v19 offset:24832
    ds_read_b64_tr_b16 a[0:1], v18 offset:24608
    ds_read_b64_tr_b16 a[2:3], v18 offset:24864
    ds_read_b64_tr_b16 a[4:5], v19 offset:24608
    ds_read_b64_tr_b16 a[6:7], v19 offset:24864
    s_waitcnt lgkmcnt(0)
    s_branch CH_u_22
CH_u_24:
    s_cmp_lg_u32 s21, 2
    s_cbranch_scc1 CH_u_25
    ds_read_b64_tr_b16 v[88:89], v18 offset:24576
    ds_read_b64_tr_b16 v[90:91], v18 offset:24832
    ds_read_b64_tr_b16 v[92:93], v19 offset:24576
    ds_read_b64_tr_b16 v[94:95], v19 offset:24832
    ds_read_b64_tr_b16 v[96:97], v18 offset:24608
    ds_read_b64_tr_b16 v[98:99], v18 offset:24864
    ds_read_b64_tr_b16 v[100:101], v19 offset:24608
    ds_read_b64_tr_b16 v[102:103], v19 offset:24864
    s_waitcnt lgkmcnt(0)
    s_branch CH_u_22
CH_u_25:
    ds_read_b64_tr_b16 v[168:169], v18 offset:24576
    ds_read_b64_tr_b16 v[170:171], v18 offset:24832
    ds_read_b64_tr_b16 v[172:173], v19 offset:24576
    ds_read_b64_tr_b16 v[174:175], v19 offset:24832
    ds_read_b64_tr_b16 v[176:177], v18 offset:24608
    ds_read_b64_tr_b16 v[178:179], v18 offset:24864
    ds_read_b64_tr_b16 v[180:181], v19 offset:24608
    ds_read_b64_tr_b16 v[182:183], v19 offset:24864
    s_waitcnt lgkmcnt(0)
CH_u_22:
    v_lshl_add_u32 v18, v17, 15, v12
    v_add_u32 v18, 32768, v18
    v_add_u32 v19, 65536, v18
    s_waitcnt vmcnt(16)
    s_barrier
    s_add_u32 m0, s64, 24576
    s_add_u32 s47, s67, 2097152
    buffer_load_dwordx4 v40, s[12:15], s47 offen  lds
    s_add_u32 m0, s64, 25600
    s_add_u32 s47, s67, 2129920
    buffer_load_dwordx4 v41, s[12:15], s47 offen  lds
    s_add_u32 m0, s64, 26624
    s_add_u32 s47, s67, 2162688
    buffer_load_dwordx4 v42, s[12:15], s47 offen  lds
    s_add_u32 m0, s64, 27648
    s_add_u32 s47, s67, 2195456
    buffer_load_dwordx4 v43, s[12:15], s47 offen  lds
    s_cmp_lg_u32 s21, 0
    s_cbranch_scc1 CH_u_28
    ds_read_b64_tr_b16 v[248:249], v18 offset:4096
    ds_read_b64_tr_b16 v[250:251], v18 offset:4352
    ds_read_b64_tr_b16 v[252:253], v19 offset:4096
    ds_read_b64_tr_b16 v[254:255], v19 offset:4352
    ds_read_b64_tr_b16 a[0:1], v18 offset:4128
    ds_read_b64_tr_b16 a[2:3], v18 offset:4384
    ds_read_b64_tr_b16 a[4:5], v19 offset:4128
    ds_read_b64_tr_b16 a[6:7], v19 offset:4384
    s_waitcnt lgkmcnt(0)
    s_branch CH_u_27
CH_u_28:
    s_cmp_lg_u32 s21, 1
    s_cbranch_scc1 CH_u_29
    ds_read_b64_tr_b16 v[200:201], v18 offset:4096
    ds_read_b64_tr_b16 v[202:203], v18 offset:4352
    ds_read_b64_tr_b16 v[204:205], v19 offset:4096
    ds_read_b64_tr_b16 v[206:207], v19 offset:4352
    ds_read_b64_tr_b16 v[208:209], v18 offset:4128
    ds_read_b64_tr_b16 v[210:211], v18 offset:4384
    ds_read_b64_tr_b16 v[212:213], v19 offset:4128
    ds_read_b64_tr_b16 v[214:215], v19 offset:4384
    s_waitcnt lgkmcnt(0)
    s_branch CH_u_27
CH_u_29:
    s_cmp_lg_u32 s21, 2
    s_cbranch_scc1 CH_u_30
    ds_read_b64_tr_b16 v[168:169], v18 offset:4096
    ds_read_b64_tr_b16 v[170:171], v18 offset:4352
    ds_read_b64_tr_b16 v[172:173], v19 offset:4096
    ds_read_b64_tr_b16 v[174:175], v19 offset:4352
    ds_read_b64_tr_b16 v[176:177], v18 offset:4128
    ds_read_b64_tr_b16 v[178:179], v18 offset:4384
    ds_read_b64_tr_b16 v[180:181], v19 offset:4128
    ds_read_b64_tr_b16 v[182:183], v19 offset:4384
    s_waitcnt lgkmcnt(0)
    s_branch CH_u_27
CH_u_30:
    ds_read_b64_tr_b16 v[88:89], v18 offset:4096
    ds_read_b64_tr_b16 v[90:91], v18 offset:4352
    ds_read_b64_tr_b16 v[92:93], v19 offset:4096
    ds_read_b64_tr_b16 v[94:95], v19 offset:4352
    ds_read_b64_tr_b16 v[96:97], v18 offset:4128
    ds_read_b64_tr_b16 v[98:99], v18 offset:4384
    ds_read_b64_tr_b16 v[100:101], v19 offset:4128
    ds_read_b64_tr_b16 v[102:103], v19 offset:4384
    s_waitcnt lgkmcnt(0)
CH_u_27:
    v_lshl_add_u32 v18, v17, 15, v12
    v_add_u32 v18, 32768, v18
    v_add_u32 v19, 65536, v18
    s_waitcnt vmcnt(16)
    s_barrier
    s_add_u32 m0, s64, 4096
    s_add_u32 s47, s68, 256
    buffer_load_dwordx4 v44, s[24:27], s47 offen  lds
    s_add_u32 m0, s64, 5120
    s_add_u32 s47, s68, 5376
    buffer_load_dwordx4 v45, s[24:27], s47 offen  lds
    s_add_u32 m0, s64, 6144
    s_add_u32 s47, s68, 10496
    buffer_load_dwordx4 v46, s[24:27], s47 offen  lds
    s_add_u32 m0, s64, 7168
    s_add_u32 s47, s68, 15616
    buffer_load_dwordx4 v47, s[24:27], s47 offen  lds
    s_cmp_lg_u32 s21, 0
    s_cbranch_scc1 CH_u_33
    ds_read_b64_tr_b16 a[144:145], v18 offset:8192
    ds_read_b64_tr_b16 a[146:147], v18 offset:8448
    ds_read_b64_tr_b16 a[148:149], v19 offset:8192
    ds_read_b64_tr_b16 a[150:151], v19 offset:8448
    ds_read_b64_tr_b16 a[152:153], v18 offset:8224
    ds_read_b64_tr_b16 a[154:155], v18 offset:8480
    ds_read_b64_tr_b16 a[156:157], v19 offset:8224
    ds_read_b64_tr_b16 a[158:159], v19 offset:8480
    s_waitcnt lgkmcnt(0)
    s_branch CH_u_32
CH_u_33:
    s_cmp_lg_u32 s21, 1
    s_cbranch_scc1 CH_u_34
    ds_read_b64_tr_b16 a[176:177], v18 offset:8192
    ds_read_b64_tr_b16 a[178:179], v18 offset:8448
    ds_read_b64_tr_b16 a[180:181], v19 offset:8192
    ds_read_b64_tr_b16 a[182:183], v19 offset:8448
    ds_read_b64_tr_b16 a[184:185], v18 offset:8224
    ds_read_b64_tr_b16 a[186:187], v18 offset:8480
    ds_read_b64_tr_b16 a[188:189], v19 offset:8224
    ds_read_b64_tr_b16 a[190:191], v19 offset:8480
    s_waitcnt lgkmcnt(0)
    s_branch CH_u_32
CH_u_34:
    s_cmp_lg_u32 s21, 2
    s_cbranch_scc1 CH_u_35
    ds_read_b64_tr_b16 a[192:193], v18 offset:8192
    ds_read_b64_tr_b16 a[194:195], v18 offset:8448
    ds_read_b64_tr_b16 a[196:197], v19 offset:8192
    ds_read_b64_tr_b16 a[198:199], v19 offset:8448
    ds_read_b64_tr_b16 a[200:201], v18 offset:8224
    ds_read_b64_tr_b16 a[202:203], v18 offset:8480
    ds_read_b64_tr_b16 a[204:205], v19 offset:8224
    ds_read_b64_tr_b16 a[206:207], v19 offset:8480
    s_waitcnt lgkmcnt(0)
    s_branch CH_u_32
CH_u_35:
    ds_read_b64_tr_b16 a[208:209], v18 offset:8192
    ds_read_b64_tr_b16 a[210:211], v18 offset:8448
    ds_read_b64_tr_b16 a[212:213], v19 offset:8192
    ds_read_b64_tr_b16 a[214:215], v19 offset:8448
    ds_read_b64_tr_b16 a[216:217], v18 offset:8224
    ds_read_b64_tr_b16 a[218:219], v18 offset:8480
    ds_read_b64_tr_b16 a[220:221], v19 offset:8224
    ds_read_b64_tr_b16 a[222:223], v19 offset:8480
    s_waitcnt lgkmcnt(0)
CH_u_32:
    v_lshl_add_u32 v18, v17, 15, v12
    v_add_u32 v18, 32768, v18
    v_add_u32 v19, 65536, v18
    s_waitcnt vmcnt(16)
    s_barrier
    s_add_u32 m0, s64, 8192
    s_add_u32 s47, s66, 2097152
    buffer_load_dwordx4 v40, s[12:15], s47 offen  lds
    s_add_u32 m0, s64, 9216
    s_add_u32 s47, s66, 2129920
    buffer_load_dwordx4 v41, s[12:15], s47 offen  lds
    s_add_u32 m0, s64, 10240
    s_add_u32 s47, s66, 2162688
    buffer_load_dwordx4 v42, s[12:15], s47 offen  lds
    s_add_u32 m0, s64, 11264
    s_add_u32 s47, s66, 2195456
    buffer_load_dwordx4 v43, s[12:15], s47 offen  lds
    s_cmp_lg_u32 s21, 0
    s_cbranch_scc1 CH_u_38
    ds_read_b64_tr_b16 a[176:177], v18 offset:12288
    ds_read_b64_tr_b16 a[178:179], v18 offset:12544
    ds_read_b64_tr_b16 a[180:181], v19 offset:12288
    ds_read_b64_tr_b16 a[182:183], v19 offset:12544
    ds_read_b64_tr_b16 a[184:185], v18 offset:12320
    ds_read_b64_tr_b16 a[186:187], v18 offset:12576
    ds_read_b64_tr_b16 a[188:189], v19 offset:12320
    ds_read_b64_tr_b16 a[190:191], v19 offset:12576
    s_waitcnt lgkmcnt(0)
    s_branch CH_u_37
CH_u_38:
    s_cmp_lg_u32 s21, 1
    s_cbranch_scc1 CH_u_39
    ds_read_b64_tr_b16 a[144:145], v18 offset:12288
    ds_read_b64_tr_b16 a[146:147], v18 offset:12544
    ds_read_b64_tr_b16 a[148:149], v19 offset:12288
    ds_read_b64_tr_b16 a[150:151], v19 offset:12544
    ds_read_b64_tr_b16 a[152:153], v18 offset:12320
    ds_read_b64_tr_b16 a[154:155], v18 offset:12576
    ds_read_b64_tr_b16 a[156:157], v19 offset:12320
    ds_read_b64_tr_b16 a[158:159], v19 offset:12576
    s_waitcnt lgkmcnt(0)
    s_branch CH_u_37
CH_u_39:
    s_cmp_lg_u32 s21, 2
    s_cbranch_scc1 CH_u_40
    ds_read_b64_tr_b16 a[208:209], v18 offset:12288
    ds_read_b64_tr_b16 a[210:211], v18 offset:12544
    ds_read_b64_tr_b16 a[212:213], v19 offset:12288
    ds_read_b64_tr_b16 a[214:215], v19 offset:12544
    ds_read_b64_tr_b16 a[216:217], v18 offset:12320
    ds_read_b64_tr_b16 a[218:219], v18 offset:12576
    ds_read_b64_tr_b16 a[220:221], v19 offset:12320
    ds_read_b64_tr_b16 a[222:223], v19 offset:12576
    s_waitcnt lgkmcnt(0)
    s_branch CH_u_37
CH_u_40:
    ds_read_b64_tr_b16 a[192:193], v18 offset:12288
    ds_read_b64_tr_b16 a[194:195], v18 offset:12544
    ds_read_b64_tr_b16 a[196:197], v19 offset:12288
    ds_read_b64_tr_b16 a[198:199], v19 offset:12544
    ds_read_b64_tr_b16 a[200:201], v18 offset:12320
    ds_read_b64_tr_b16 a[202:203], v18 offset:12576
    ds_read_b64_tr_b16 a[204:205], v19 offset:12320
    ds_read_b64_tr_b16 a[206:207], v19 offset:12576
    s_waitcnt lgkmcnt(0)
CH_u_37:
    v_lshl_add_u32 v18, v17, 15, v12
    v_add_u32 v18, 32768, v18
    v_add_u32 v19, 65536, v18
    s_waitcnt vmcnt(16)
    s_barrier
    s_add_u32 m0, s64, 12288
    s_add_u32 s47, s66, 0
    buffer_load_dwordx4 v40, s[4:7], s47 offen  lds
    s_add_u32 m0, s64, 13312
    s_add_u32 s47, s66, 32768
    buffer_load_dwordx4 v41, s[4:7], s47 offen  lds
    s_add_u32 m0, s64, 14336
    s_add_u32 s47, s66, 65536
    buffer_load_dwordx4 v42, s[4:7], s47 offen  lds
    s_add_u32 m0, s64, 15360
    s_add_u32 s47, s66, 98304
    buffer_load_dwordx4 v43, s[4:7], s47 offen  lds
    s_cmp_lg_u32 s21, 0
    s_cbranch_scc1 CH_u_43
    ds_read_b64_tr_b16 a[192:193], v18 offset:16384
    ds_read_b64_tr_b16 a[194:195], v18 offset:16640
    ds_read_b64_tr_b16 a[196:197], v19 offset:16384
    ds_read_b64_tr_b16 a[198:199], v19 offset:16640
    ds_read_b64_tr_b16 a[200:201], v18 offset:16416
    ds_read_b64_tr_b16 a[202:203], v18 offset:16672
    ds_read_b64_tr_b16 a[204:205], v19 offset:16416
    ds_read_b64_tr_b16 a[206:207], v19 offset:16672
    s_waitcnt lgkmcnt(0)
    s_branch CH_u_42
CH_u_43:
    s_cmp_lg_u32 s21, 1
    s_cbranch_scc1 CH_u_44
    ds_read_b64_tr_b16 a[208:209], v18 offset:16384
    ds_read_b64_tr_b16 a[210:211], v18 offset:16640
    ds_read_b64_tr_b16 a[212:213], v19 offset:16384
    ds_read_b64_tr_b16 a[214:215], v19 offset:16640
    ds_read_b64_tr_b16 a[216:217], v18 offset:16416
    ds_read_b64_tr_b16 a[218:219], v18 offset:16672
    ds_read_b64_tr_b16 a[220:221], v19 offset:16416
    ds_read_b64_tr_b16 a[222:223], v19 offset:16672
    s_waitcnt lgkmcnt(0)
    s_branch CH_u_42
CH_u_44:
    s_cmp_lg_u32 s21, 2
    s_cbranch_scc1 CH_u_45
    ds_read_b64_tr_b16 a[144:145], v18 offset:16384
    ds_read_b64_tr_b16 a[146:147], v18 offset:16640
    ds_read_b64_tr_b16 a[148:149], v19 offset:16384
    ds_read_b64_tr_b16 a[150:151], v19 offset:16640
    ds_read_b64_tr_b16 a[152:153], v18 offset:16416
    ds_read_b64_tr_b16 a[154:155], v18 offset:16672
    ds_read_b64_tr_b16 a[156:157], v19 offset:16416
    ds_read_b64_tr_b16 a[158:159], v19 offset:16672
    s_waitcnt lgkmcnt(0)
    s_branch CH_u_42
CH_u_45:
    ds_read_b64_tr_b16 a[176:177], v18 offset:16384
    ds_read_b64_tr_b16 a[178:179], v18 offset:16640
    ds_read_b64_tr_b16 a[180:181], v19 offset:16384
    ds_read_b64_tr_b16 a[182:183], v19 offset:16640
    ds_read_b64_tr_b16 a[184:185], v18 offset:16416
    ds_read_b64_tr_b16 a[186:187], v18 offset:16672
    ds_read_b64_tr_b16 a[188:189], v19 offset:16416
    ds_read_b64_tr_b16 a[190:191], v19 offset:16672
    s_waitcnt lgkmcnt(0)
CH_u_42:
    v_lshl_add_u32 v18, v17, 15, v12
    v_add_u32 v18, 32768, v18
    v_add_u32 v19, 65536, v18
    s_waitcnt vmcnt(16)
    s_barrier
    s_add_u32 m0, s64, 16384
    s_add_u32 s47, s66, 524288
    buffer_load_dwordx4 v40, s[4:7], s47 offen  lds
    s_add_u32 m0, s64, 17408
    s_add_u32 s47, s66, 557056
    buffer_load_dwordx4 v41, s[4:7], s47 offen  lds
    s_add_u32 m0, s64, 18432
    s_add_u32 s47, s66, 589824
    buffer_load_dwordx4 v42, s[4:7], s47 offen  lds
    s_add_u32 m0, s64, 19456
    s_add_u32 s47, s66, 622592
    buffer_load_dwordx4 v43, s[4:7], s47 offen  lds
    s_cmp_lg_u32 s21, 0
    s_cbranch_scc1 CH_u_48
    ds_read_b64_tr_b16 a[208:209], v18 offset:20480
    ds_read_b64_tr_b16 a[210:211], v18 offset:20736
    ds_read_b64_tr_b16 a[212:213], v19 offset:20480
    ds_read_b64_tr_b16 a[214:215], v19 offset:20736
    ds_read_b64_tr_b16 a[216:217], v18 offset:20512
    ds_read_b64_tr_b16 a[218:219], v18 offset:20768
    ds_read_b64_tr_b16 a[220:221], v19 offset:20512
    ds_read_b64_tr_b16 a[222:223], v19 offset:20768
    s_waitcnt lgkmcnt(0)
    s_branch CH_u_47
CH_u_48:
    s_cmp_lg_u32 s21, 1
    s_cbranch_scc1 CH_u_49
    ds_read_b64_tr_b16 a[192:193], v18 offset:20480
    ds_read_b64_tr_b16 a[194:195], v18 offset:20736
    ds_read_b64_tr_b16 a[196:197], v19 offset:20480
    ds_read_b64_tr_b16 a[198:199], v19 offset:20736
    ds_read_b64_tr_b16 a[200:201], v18 offset:20512
    ds_read_b64_tr_b16 a[202:203], v18 offset:20768
    ds_read_b64_tr_b16 a[204:205], v19 offset:20512
    ds_read_b64_tr_b16 a[206:207], v19 offset:20768
    s_waitcnt lgkmcnt(0)
    s_branch CH_u_47
CH_u_49:
    s_cmp_lg_u32 s21, 2
    s_cbranch_scc1 CH_u_50
    ds_read_b64_tr_b16 a[176:177], v18 offset:20480
    ds_read_b64_tr_b16 a[178:179], v18 offset:20736
    ds_read_b64_tr_b16 a[180:181], v19 offset:20480
    ds_read_b64_tr_b16 a[182:183], v19 offset:20736
    ds_read_b64_tr_b16 a[184:185], v18 offset:20512
    ds_read_b64_tr_b16 a[186:187], v18 offset:20768
    ds_read_b64_tr_b16 a[188:189], v19 offset:20512
    ds_read_b64_tr_b16 a[190:191], v19 offset:20768
    s_waitcnt lgkmcnt(0)
    s_branch CH_u_47
CH_u_50:
    ds_read_b64_tr_b16 a[144:145], v18 offset:20480
    ds_read_b64_tr_b16 a[146:147], v18 offset:20736
    ds_read_b64_tr_b16 a[148:149], v19 offset:20480
    ds_read_b64_tr_b16 a[150:151], v19 offset:20736
    ds_read_b64_tr_b16 a[152:153], v18 offset:20512
    ds_read_b64_tr_b16 a[154:155], v18 offset:20768
    ds_read_b64_tr_b16 a[156:157], v19 offset:20512
    ds_read_b64_tr_b16 a[158:159], v19 offset:20768
    s_waitcnt lgkmcnt(0)
CH_u_47:
    v_lshl_add_u32 v18, v17, 15, v13
    v_add_u32 v18, 32768, v18
    v_add_u32 v19, 65536, v18
    s_waitcnt vmcnt(16)
    s_barrier
    s_add_u32 m0, s64, 20480
    s_add_u32 s47, s66, 1048576
    buffer_load_dwordx4 v40, s[4:7], s47 offen  lds
    s_add_u32 m0, s64, 21504
    s_add_u32 s47, s66, 1081344
    buffer_load_dwordx4 v41, s[4:7], s47 offen  lds
    s_add_u32 m0, s64, 22528
    s_add_u32 s47, s66, 1114112
    buffer_load_dwordx4 v42, s[4:7], s47 offen  lds
    s_add_u32 m0, s64, 23552
    s_add_u32 s47, s66, 1146880
    buffer_load_dwordx4 v43, s[4:7], s47 offen  lds
    ds_read_b64_tr_b16 a[160:161], v18 offset:24576
    ds_read_b64_tr_b16 a[162:163], v18 offset:25088
    ds_read_b64_tr_b16 a[164:165], v19 offset:24576
    ds_read_b64_tr_b16 a[166:167], v19 offset:25088
    ds_read_b64_tr_b16 a[168:169], v18 offset:24608
    ds_read_b64_tr_b16 a[170:171], v18 offset:25120
    ds_read_b64_tr_b16 a[172:173], v19 offset:24608
    ds_read_b64_tr_b16 a[174:175], v19 offset:25120
    s_waitcnt lgkmcnt(0)
CH_u_52:
    v_lshl_add_u32 v18, v16, 15, v14
    v_add_u32 v18, 32768, v18
    v_add_u32 v19, 65536, v18
    s_waitcnt vmcnt(16)
    s_barrier
    s_add_u32 m0, s64, 24576
    s_add_u32 s47, s66, 1572864
    buffer_load_dwordx4 v40, s[4:7], s47 offen  lds
    s_add_u32 m0, s64, 25600
    s_add_u32 s47, s66, 1605632
    buffer_load_dwordx4 v41, s[4:7], s47 offen  lds
    s_add_u32 m0, s64, 26624
    s_add_u32 s47, s66, 1638400
    buffer_load_dwordx4 v42, s[4:7], s47 offen  lds
    s_add_u32 m0, s64, 27648
    s_add_u32 s47, s66, 1671168
    buffer_load_dwordx4 v43, s[4:7], s47 offen  lds
    ds_read_b64_tr_b16 a[232:233], v18 offset:4096
    ds_read_b64_tr_b16 a[234:235], v18 offset:4608
    ds_read_b64_tr_b16 a[236:237], v19 offset:4096
    ds_read_b64_tr_b16 a[238:239], v19 offset:4608
    ds_read_b64_tr_b16 a[248:249], v18 offset:4104
    ds_read_b64_tr_b16 a[250:251], v18 offset:4616
    ds_read_b64_tr_b16 a[252:253], v19 offset:4104
    ds_read_b64_tr_b16 a[254:255], v19 offset:4616
    s_waitcnt lgkmcnt(0)
CH_u_54:
    v_lshl_add_u32 v18, v17, 15, v13
    v_add_u32 v18, 32768, v18
    v_add_u32 v19, 65536, v18
    s_waitcnt vmcnt(16)
    s_barrier
    s_add_u32 m0, s64, 28672
    s_add_u32 s47, s66, 0
    buffer_load_dwordx4 v40, s[8:11], s47 offen  lds
    s_add_u32 m0, s64, 29696
    s_add_u32 s47, s66, 32768
    buffer_load_dwordx4 v41, s[8:11], s47 offen  lds
    s_add_u32 m0, s64, 30720
    s_add_u32 s47, s66, 65536
    buffer_load_dwordx4 v42, s[8:11], s47 offen  lds
    s_add_u32 m0, s64, 31744
    s_add_u32 s47, s66, 98304
    buffer_load_dwordx4 v43, s[8:11], s47 offen  lds
    ds_read_b64_tr_b16 v[24:25], v18 offset:8192
    ds_read_b64_tr_b16 v[26:27], v18 offset:8704
    ds_read_b64_tr_b16 v[28:29], v19 offset:8192
    ds_read_b64_tr_b16 v[30:31], v19 offset:8704
    ds_read_b64_tr_b16 v[136:137], v18 offset:8224
    ds_read_b64_tr_b16 v[138:139], v18 offset:8736
    ds_read_b64_tr_b16 v[140:141], v19 offset:8224
    ds_read_b64_tr_b16 v[142:143], v19 offset:8736
    s_waitcnt lgkmcnt(6)
    ds_write_b128 v1, v[24:27] offset:6144
    s_waitcnt lgkmcnt(5)
    ds_write_b128 v1, v[28:31] offset:7168
    s_waitcnt lgkmcnt(0)
CH_u_56:
    v_lshl_add_u32 v18, v17, 15, v12
    v_add_u32 v18, 32768, v18
    v_add_u32 v19, 65536, v18
    s_waitcnt vmcnt(16)
    s_barrier
    s_add_u32 m0, s70, 0
    s_add_u32 s47, s66, 524288
    buffer_load_dwordx4 v40, s[8:11], s47 offen  lds
    s_add_u32 m0, s70, 1024
    s_add_u32 s47, s66, 557056
    buffer_load_dwordx4 v41, s[8:11], s47 offen  lds
    s_add_u32 m0, s70, 2048
    s_add_u32 s47, s66, 589824
    buffer_load_dwordx4 v42, s[8:11], s47 offen  lds
    s_add_u32 m0, s70, 3072
    s_add_u32 s47, s66, 622592
    buffer_load_dwordx4 v43, s[8:11], s47 offen  lds
    s_cmp_lg_u32 s21, 0
    s_cbranch_scc1 CH_u_59
    ds_read_b64_tr_b16 v[64:65], v18 offset:12288
    ds_read_b64_tr_b16 v[66:67], v18 offset:12544
    ds_read_b64_tr_b16 v[68:69], v19 offset:12288
    ds_read_b64_tr_b16 v[70:71], v19 offset:12544
    ds_read_b64_tr_b16 v[72:73], v18 offset:12320
    ds_read_b64_tr_b16 v[74:75], v18 offset:12576
    ds_read_b64_tr_b16 v[76:77], v19 offset:12320
    ds_read_b64_tr_b16 v[78:79], v19 offset:12576
    s_waitcnt lgkmcnt(0)
    s_branch CH_u_58
CH_u_59:
    s_cmp_lg_u32 s21, 1
    s_cbranch_scc1 CH_u_60
    ds_read_b64_tr_b16 v[144:145], v18 offset:12288
    ds_read_b64_tr_b16 v[146:147], v18 offset:12544
    ds_read_b64_tr_b16 v[148:149], v19 offset:12288
    ds_read_b64_tr_b16 v[150:151], v19 offset:12544
    ds_read_b64_tr_b16 v[152:153], v18 offset:12320
    ds_read_b64_tr_b16 v[154:155], v18 offset:12576
    ds_read_b64_tr_b16 v[156:157], v19 offset:12320
    ds_read_b64_tr_b16 v[158:159], v19 offset:12576
    s_waitcnt lgkmcnt(0)
    s_branch CH_u_58
CH_u_60:
    s_cmp_lg_u32 s21, 2
    s_cbranch_scc1 CH_u_61
    ds_read_b64_tr_b16 v[184:185], v18 offset:12288
    ds_read_b64_tr_b16 v[186:187], v18 offset:12544
    ds_read_b64_tr_b16 v[188:189], v19 offset:12288
    ds_read_b64_tr_b16 v[190:191], v19 offset:12544
    ds_read_b64_tr_b16 v[32:33], v18 offset:12320
    ds_read_b64_tr_b16 v[34:35], v18 offset:12576
    ds_read_b64_tr_b16 v[36:37], v19 offset:12320
    ds_read_b64_tr_b16 v[38:39], v19 offset:12576
    s_waitcnt lgkmcnt(2)
    ds_write_b128 v1, v[32:35] offset:10240
    s_waitcnt lgkmcnt(1)
    ds_write_b128 v1, v[36:39] offset:11264
    s_waitcnt lgkmcnt(0)
    s_branch CH_u_58
CH_u_61:
    ds_read_b64_tr_b16 v[216:217], v18 offset:12288
    ds_read_b64_tr_b16 v[218:219], v18 offset:12544
    ds_read_b64_tr_b16 v[220:221], v19 offset:12288
    ds_read_b64_tr_b16 v[222:223], v19 offset:12544
    ds_read_b64_tr_b16 v[224:225], v18 offset:12320
    ds_read_b64_tr_b16 v[226:227], v18 offset:12576
    ds_read_b64_tr_b16 v[228:229], v19 offset:12320
    ds_read_b64_tr_b16 v[230:231], v19 offset:12576
    s_waitcnt lgkmcnt(0)
CH_u_58:
    v_lshl_add_u32 v18, v17, 15, v12
    v_add_u32 v18, 32768, v18
    v_add_u32 v19, 65536, v18
    s_waitcnt vmcnt(16)
    s_barrier
    s_add_u32 m0, s70, 4096
    s_add_u32 s47, s66, 1048576
    buffer_load_dwordx4 v40, s[8:11], s47 offen  lds
    s_add_u32 m0, s70, 5120
    s_add_u32 s47, s66, 1081344
    buffer_load_dwordx4 v41, s[8:11], s47 offen  lds
    s_add_u32 m0, s70, 6144
    s_add_u32 s47, s66, 1114112
    buffer_load_dwordx4 v42, s[8:11], s47 offen  lds
    s_add_u32 m0, s70, 7168
    s_add_u32 s47, s66, 1146880
    buffer_load_dwordx4 v43, s[8:11], s47 offen  lds
    s_cmp_lg_u32 s21, 0
    s_cbranch_scc1 CH_u_64
    ds_read_b64_tr_b16 v[144:145], v18 offset:16384
    ds_read_b64_tr_b16 v[146:147], v18 offset:16640
    ds_read_b64_tr_b16 v[148:149], v19 offset:16384
    ds_read_b64_tr_b16 v[150:151], v19 offset:16640
    ds_read_b64_tr_b16 v[152:153], v18 offset:16416
    ds_read_b64_tr_b16 v[154:155], v18 offset:16672
    ds_read_b64_tr_b16 v[156:157], v19 offset:16416
    ds_read_b64_tr_b16 v[158:159], v19 offset:16672
    s_waitcnt lgkmcnt(0)
    s_branch CH_u_63
CH_u_64:
    s_cmp_lg_u32 s21, 1
    s_cbranch_scc1 CH_u_65
    ds_read_b64_tr_b16 v[64:65], v18 offset:16384
    ds_read_b64_tr_b16 v[66:67], v18 offset:16640
    ds_read_b64_tr_b16 v[68:69], v19 offset:16384
    ds_read_b64_tr_b16 v[70:71], v19 offset:16640
    ds_read_b64_tr_b16 v[72:73], v18 offset:16416
    ds_read_b64_tr_b16 v[74:75], v18 offset:16672
    ds_read_b64_tr_b16 v[76:77], v19 offset:16416
    ds_read_b64_tr_b16 v[78:79], v19 offset:16672
    s_waitcnt lgkmcnt(0)
    s_branch CH_u_63
CH_u_65:
    s_cmp_lg_u32 s21, 2
    s_cbranch_scc1 CH_u_66
    ds_read_b64_tr_b16 v[216:217], v18 offset:16384
    ds_read_b64_tr_b16 v[218:219], v18 offset:16640
    ds_read_b64_tr_b16 v[220:221], v19 offset:16384
    ds_read_b64_tr_b16 v[222:223], v19 offset:16640
    ds_read_b64_tr_b16 v[224:225], v18 offset:16416
    ds_read_b64_tr_b16 v[226:227], v18 offset:16672
    ds_read_b64_tr_b16 v[228:229], v19 offset:16416
    ds_read_b64_tr_b16 v[230:231], v19 offset:16672
    s_waitcnt lgkmcnt(0)
    s_branch CH_u_63
CH_u_66:
    ds_read_b64_tr_b16 v[184:185], v18 offset:16384
    ds_read_b64_tr_b16 v[186:187], v18 offset:16640
    ds_read_b64_tr_b16 v[188:189], v19 offset:16384
    ds_read_b64_tr_b16 v[190:191], v19 offset:16640
    ds_read_b64_tr_b16 v[32:33], v18 offset:16416
    ds_read_b64_tr_b16 v[34:35], v18 offset:16672
    ds_read_b64_tr_b16 v[36:37], v19 offset:16416
    ds_read_b64_tr_b16 v[38:39], v19 offset:16672
    s_waitcnt lgkmcnt(2)
    ds_write_b128 v1, v[32:35] offset:10240
    s_waitcnt lgkmcnt(1)
    ds_write_b128 v1, v[36:39] offset:11264
    s_waitcnt lgkmcnt(0)
CH_u_63:
    v_lshl_add_u32 v18, v17, 15, v12
    v_add_u32 v18, 32768, v18
    v_add_u32 v19, 65536, v18
    s_waitcnt vmcnt(16)
    s_barrier
    s_add_u32 m0, s64, 16384
    s_add_u32 s47, s66, 1572864
    buffer_load_dwordx4 v40, s[8:11], s47 offen  lds
    s_add_u32 m0, s64, 17408
    s_add_u32 s47, s66, 1605632
    buffer_load_dwordx4 v41, s[8:11], s47 offen  lds
    s_add_u32 m0, s64, 18432
    s_add_u32 s47, s66, 1638400
    buffer_load_dwordx4 v42, s[8:11], s47 offen  lds
    s_add_u32 m0, s64, 19456
    s_add_u32 s47, s66, 1671168
    buffer_load_dwordx4 v43, s[8:11], s47 offen  lds
    s_cmp_lg_u32 s21, 0
    s_cbranch_scc1 CH_u_69
    ds_read_b64_tr_b16 v[184:185], v18 offset:20480
    ds_read_b64_tr_b16 v[186:187], v18 offset:20736
    ds_read_b64_tr_b16 v[188:189], v19 offset:20480
    ds_read_b64_tr_b16 v[190:191], v19 offset:20736
    ds_read_b64_tr_b16 v[32:33], v18 offset:20512
    ds_read_b64_tr_b16 v[34:35], v18 offset:20768
    ds_read_b64_tr_b16 v[36:37], v19 offset:20512
    ds_read_b64_tr_b16 v[38:39], v19 offset:20768
    s_waitcnt lgkmcnt(2)
    ds_write_b128 v1, v[32:35] offset:10240
    s_waitcnt lgkmcnt(1)
    ds_write_b128 v1, v[36:39] offset:11264
    s_waitcnt lgkmcnt(0)
    s_branch CH_u_68
CH_u_69:
    s_cmp_lg_u32 s21, 1
    s_cbranch_scc1 CH_u_70
    ds_read_b64_tr_b16 v[216:217], v18 offset:20480
    ds_read_b64_tr_b16 v[218:219], v18 offset:20736
    ds_read_b64_tr_b16 v[220:221], v19 offset:20480
    ds_read_b64_tr_b16 v[222:223], v19 offset:20736
    ds_read_b64_tr_b16 v[224:225], v18 offset:20512
    ds_read_b64_tr_b16 v[226:227], v18 offset:20768
    ds_read_b64_tr_b16 v[228:229], v19 offset:20512
    ds_read_b64_tr_b16 v[230:231], v19 offset:20768
    s_waitcnt lgkmcnt(0)
    s_branch CH_u_68
CH_u_70:
    s_cmp_lg_u32 s21, 2
    s_cbranch_scc1 CH_u_71
    ds_read_b64_tr_b16 v[64:65], v18 offset:20480
    ds_read_b64_tr_b16 v[66:67], v18 offset:20736
    ds_read_b64_tr_b16 v[68:69], v19 offset:20480
    ds_read_b64_tr_b16 v[70:71], v19 offset:20736
    ds_read_b64_tr_b16 v[72:73], v18 offset:20512
    ds_read_b64_tr_b16 v[74:75], v18 offset:20768
    ds_read_b64_tr_b16 v[76:77], v19 offset:20512
    ds_read_b64_tr_b16 v[78:79], v19 offset:20768
    s_waitcnt lgkmcnt(0)
    s_branch CH_u_68
CH_u_71:
    ds_read_b64_tr_b16 v[144:145], v18 offset:20480
    ds_read_b64_tr_b16 v[146:147], v18 offset:20736
    ds_read_b64_tr_b16 v[148:149], v19 offset:20480
    ds_read_b64_tr_b16 v[150:151], v19 offset:20736
    ds_read_b64_tr_b16 v[152:153], v18 offset:20512
    ds_read_b64_tr_b16 v[154:155], v18 offset:20768
    ds_read_b64_tr_b16 v[156:157], v19 offset:20512
    ds_read_b64_tr_b16 v[158:159], v19 offset:20768
    s_waitcnt lgkmcnt(0)
CH_u_68:
    v_lshl_add_u32 v18, v17, 15, v12
    v_add_u32 v18, 32768, v18
    v_add_u32 v19, 65536, v18
    s_waitcnt vmcnt(16)
    s_barrier
    s_add_u32 m0, s64, 20480
    s_add_u32 s47, s67, 2097152
    buffer_load_dwordx4 v40, s[4:7], s47 offen  lds
    s_add_u32 m0, s64, 21504
    s_add_u32 s47, s67, 2129920
    buffer_load_dwordx4 v41, s[4:7], s47 offen  lds
    s_add_u32 m0, s64, 22528
    s_add_u32 s47, s67, 2162688
    buffer_load_dwordx4 v42, s[4:7], s47 offen  lds
    s_add_u32 m0, s64, 23552
    s_add_u32 s47, s67, 2195456
    buffer_load_dwordx4 v43, s[4:7], s47 offen  lds
    s_cmp_lg_u32 s21, 0
    s_cbranch_scc1 CH_u_74
    ds_read_b64_tr_b16 v[216:217], v18 offset:24576
    ds_read_b64_tr_b16 v[218:219], v18 offset:24832
    ds_read_b64_tr_b16 v[220:221], v19 offset:24576
    ds_read_b64_tr_b16 v[222:223], v19 offset:24832
    ds_read_b64_tr_b16 v[224:225], v18 offset:24608
    ds_read_b64_tr_b16 v[226:227], v18 offset:24864
    ds_read_b64_tr_b16 v[228:229], v19 offset:24608
    ds_read_b64_tr_b16 v[230:231], v19 offset:24864
    s_waitcnt lgkmcnt(0)
    s_branch CH_u_73
CH_u_74:
    s_cmp_lg_u32 s21, 1
    s_cbranch_scc1 CH_u_75
    ds_read_b64_tr_b16 v[184:185], v18 offset:24576
    ds_read_b64_tr_b16 v[186:187], v18 offset:24832
    ds_read_b64_tr_b16 v[188:189], v19 offset:24576
    ds_read_b64_tr_b16 v[190:191], v19 offset:24832
    ds_read_b64_tr_b16 v[32:33], v18 offset:24608
    ds_read_b64_tr_b16 v[34:35], v18 offset:24864
    ds_read_b64_tr_b16 v[36:37], v19 offset:24608
    ds_read_b64_tr_b16 v[38:39], v19 offset:24864
    s_waitcnt lgkmcnt(2)
    ds_write_b128 v1, v[32:35] offset:10240
    s_waitcnt lgkmcnt(1)
    ds_write_b128 v1, v[36:39] offset:11264
    s_waitcnt lgkmcnt(0)
    s_branch CH_u_73
CH_u_75:
    s_cmp_lg_u32 s21, 2
    s_cbranch_scc1 CH_u_76
    ds_read_b64_tr_b16 v[144:145], v18 offset:24576
    ds_read_b64_tr_b16 v[146:147], v18 offset:24832
    ds_read_b64_tr_b16 v[148:149], v19 offset:24576
    ds_read_b64_tr_b16 v[150:151], v19 offset:24832
    ds_read_b64_tr_b16 v[152:153], v18 offset:24608
    ds_read_b64_tr_b16 v[154:155], v18 offset:24864
    ds_read_b64_tr_b16 v[156:157], v19 offset:24608
    ds_read_b64_tr_b16 v[158:159], v19 offset:24864
    s_waitcnt lgkmcnt(0)
    s_branch CH_u_73
CH_u_76:
    ds_read_b64_tr_b16 v[64:65], v18 offset:24576
    ds_read_b64_tr_b16 v[66:67], v18 offset:24832
    ds_read_b64_tr_b16 v[68:69], v19 offset:24576
    ds_read_b64_tr_b16 v[70:71], v19 offset:24832
    ds_read_b64_tr_b16 v[72:73], v18 offset:24608
    ds_read_b64_tr_b16 v[74:75], v18 offset:24864
    ds_read_b64_tr_b16 v[76:77], v19 offset:24608
    ds_read_b64_tr_b16 v[78:79], v19 offset:24864
    s_waitcnt lgkmcnt(0)
CH_u_73:
    v_lshl_add_u32 v18, v17, 15, v12
    v_add_u32 v18, 32768, v18
    v_add_u32 v19, 65536, v18
    s_waitcnt vmcnt(16)
    s_barrier
    s_add_u32 m0, s64, 24576
    s_add_u32 s47, s67, 0
    buffer_load_dwordx4 v40, s[4:7], s47 offen  lds
    s_add_u32 m0, s64, 25600
    s_add_u32 s47, s67, 32768
    buffer_load_dwordx4 v41, s[4:7], s47 offen  lds
    s_add_u32 m0, s64, 26624
    s_add_u32 s47, s67, 65536
    buffer_load_dwordx4 v42, s[4:7], s47 offen  lds
    s_add_u32 m0, s64, 27648
    s_add_u32 s47, s67, 98304
    buffer_load_dwordx4 v43, s[4:7], s47 offen  lds
    s_cmp_lg_u32 s21, 0
    s_cbranch_scc1 CH_u_79
    ds_read_b64_tr_b16 v[24:25], v18 offset:28672
    ds_read_b64_tr_b16 v[26:27], v18 offset:28928
    ds_read_b64_tr_b16 v[28:29], v19 offset:28672
    ds_read_b64_tr_b16 v[30:31], v19 offset:28928
    ds_read_b64_tr_b16 v[80:81], v18 offset:28704
    ds_read_b64_tr_b16 v[82:83], v18 offset:28960
    ds_read_b64_tr_b16 v[84:85], v19 offset:28704
    ds_read_b64_tr_b16 v[86:87], v19 offset:28960
    s_waitcnt lgkmcnt(6)
    ds_write_b128 v1, v[24:27] offset:4096
    s_waitcnt lgkmcnt(5)
    ds_write_b128 v1, v[28:31] offset:5120
    s_waitcnt lgkmcnt(0)
    s_branch CH_u_78
CH_u_79:
    s_cmp_lg_u32 s21, 1
    s_cbranch_scc1 CH_u_80
    ds_read_b64_tr_b16 v[160:161], v18 offset:28672
    ds_read_b64_tr_b16 v[162:163], v18 offset:28928
    ds_read_b64_tr_b16 v[164:165], v19 offset:28672
    ds_read_b64_tr_b16 v[166:167], v19 offset:28928
    ds_read_b64_tr_b16 v[32:33], v18 offset:28704
    ds_read_b64_tr_b16 v[34:35], v18 offset:28960
    ds_read_b64_tr_b16 v[36:37], v19 offset:28704
    ds_read_b64_tr_b16 v[38:39], v19 offset:28960
    s_waitcnt lgkmcnt(2)
    ds_write_b128 v1, v[32:35] offset:8192
    s_waitcnt lgkmcnt(1)
    ds_write_b128 v1, v[36:39] offset:9216
    s_waitcnt lgkmcnt(0)
    s_branch CH_u_78
CH_u_80:
    s_cmp_lg_u32 s21, 2
    s_cbranch_scc1 CH_u_81
    ds_read_b64_tr_b16 v[192:193], v18 offset:28672
    ds_read_b64_tr_b16 v[194:195], v18 offset:28928
    ds_read_b64_tr_b16 v[196:197], v19 offset:28672
    ds_read_b64_tr_b16 v[198:199], v19 offset:28928
    ds_read_b64_tr_b16 v[32:33], v18 offset:28704
    ds_read_b64_tr_b16 v[34:35], v18 offset:28960
    ds_read_b64_tr_b16 v[36:37], v19 offset:28704
    ds_read_b64_tr_b16 v[38:39], v19 offset:28960
    s_waitcnt lgkmcnt(2)
    ds_write_b128 v1, v[32:35] offset:12288
    s_waitcnt lgkmcnt(1)
    ds_write_b128 v1, v[36:39] offset:13312
    s_waitcnt lgkmcnt(0)
    s_branch CH_u_78
CH_u_81:
    ds_read_b64_tr_b16 v[232:233], v18 offset:28672
    ds_read_b64_tr_b16 v[234:235], v18 offset:28928
    ds_read_b64_tr_b16 v[236:237], v19 offset:28672
    ds_read_b64_tr_b16 v[238:239], v19 offset:28928
    ds_read_b64_tr_b16 v[240:241], v18 offset:28704
    ds_read_b64_tr_b16 v[242:243], v18 offset:28960
    ds_read_b64_tr_b16 v[244:245], v19 offset:28704
    ds_read_b64_tr_b16 v[246:247], v19 offset:28960
    s_waitcnt lgkmcnt(0)
CH_u_78:
    v_lshl_add_u32 v18, v17, 13, v12
    v_add_u32 v18, 0, v18
    v_add_u32 v19, 16384, v18
    s_waitcnt vmcnt(16)
    s_barrier
    s_add_u32 m0, s64, 28672
    s_add_u32 s47, s67, 524288
    buffer_load_dwordx4 v40, s[4:7], s47 offen  lds
    s_add_u32 m0, s64, 29696
    s_add_u32 s47, s67, 557056
    buffer_load_dwordx4 v41, s[4:7], s47 offen  lds
    s_add_u32 m0, s64, 30720
    s_add_u32 s47, s67, 589824
    buffer_load_dwordx4 v42, s[4:7], s47 offen  lds
    s_add_u32 m0, s64, 31744
    s_add_u32 s47, s67, 622592
    buffer_load_dwordx4 v43, s[4:7], s47 offen  lds
    s_cmp_lg_u32 s21, 0
    s_cbranch_scc1 CH_u_84
    ds_read_b64_tr_b16 v[160:161], v18 offset:0
    ds_read_b64_tr_b16 v[162:163], v18 offset:256
    ds_read_b64_tr_b16 v[164:165], v19 offset:0
    ds_read_b64_tr_b16 v[166:167], v19 offset:256
    ds_read_b64_tr_b16 v[32:33], v18 offset:32
    ds_read_b64_tr_b16 v[34:35], v18 offset:288
    ds_read_b64_tr_b16 v[36:37], v19 offset:32
    ds_read_b64_tr_b16 v[38:39], v19 offset:288
    s_waitcnt lgkmcnt(2)
    ds_write_b128 v1, v[32:35] offset:8192
    s_waitcnt lgkmcnt(1)
    ds_write_b128 v1, v[36:39] offset:9216
    s_waitcnt lgkmcnt(0)
    s_branch CH_u_83
CH_u_84:
    s_cmp_lg_u32 s21, 1
    s_cbranch_scc1 CH_u_85
    ds_read_b64_tr_b16 v[24:25], v18 offset:0
    ds_read_b64_tr_b16 v[26:27], v18 offset:256
    ds_read_b64_tr_b16 v[28:29], v19 offset:0
    ds_read_b64_tr_b16 v[30:31], v19 offset:256
    ds_read_b64_tr_b16 v[80:81], v18 offset:32
    ds_read_b64_tr_b16 v[82:83], v18 offset:288
    ds_read_b64_tr_b16 v[84:85], v19 offset:32
    ds_read_b64_tr_b16 v[86:87], v19 offset:288
    s_waitcnt lgkmcnt(6)
    ds_write_b128 v1, v[24:27] offset:4096
    s_waitcnt lgkmcnt(5)
    ds_write_b128 v1, v[28:31] offset:5120
    s_waitcnt lgkmcnt(0)
    s_branch CH_u_83
CH_u_85:
    s_cmp_lg_u32 s21, 2
    s_cbranch_scc1 CH_u_86
    ds_read_b64_tr_b16 v[232:233], v18 offset:0
    ds_read_b64_tr_b16 v[234:235], v18 offset:256
    ds_read_b64_tr_b16 v[236:237], v19 offset:0
    ds_read_b64_tr_b16 v[238:239], v19 offset:256
    ds_read_b64_tr_b16 v[240:241], v18 offset:32
    ds_read_b64_tr_b16 v[242:243], v18 offset:288
    ds_read_b64_tr_b16 v[244:245], v19 offset:32
    ds_read_b64_tr_b16 v[246:247], v19 offset:288
    s_waitcnt lgkmcnt(0)
    s_branch CH_u_83
CH_u_86:
    ds_read_b64_tr_b16 v[192:193], v18 offset:0
    ds_read_b64_tr_b16 v[194:195], v18 offset:256
    ds_read_b64_tr_b16 v[196:197], v19 offset:0
    ds_read_b64_tr_b16 v[198:199], v19 offset:256
    ds_read_b64_tr_b16 v[32:33], v18 offset:32
    ds_read_b64_tr_b16 v[34:35], v18 offset:288
    ds_read_b64_tr_b16 v[36:37], v19 offset:32
    ds_read_b64_tr_b16 v[38:39], v19 offset:288
    s_waitcnt lgkmcnt(2)
    ds_write_b128 v1, v[32:35] offset:12288
    s_waitcnt lgkmcnt(1)
    ds_write_b128 v1, v[36:39] offset:13312
    s_waitcnt lgkmcnt(0)
CH_u_83:
    v_lshl_add_u32 v18, v17, 13, v12
    v_add_u32 v18, 0, v18
    v_add_u32 v19, 16384, v18
    s_waitcnt vmcnt(16)
    s_barrier
    s_add_u32 m0, s64, 0
    s_add_u32 s47, s67, 1048576
    buffer_load_dwordx4 v40, s[4:7], s47 offen  lds
    s_add_u32 m0, s64, 1024
    s_add_u32 s47, s67, 1081344
    buffer_load_dwordx4 v41, s[4:7], s47 offen  lds
    s_add_u32 m0, s64, 2048
    s_add_u32 s47, s67, 1114112
    buffer_load_dwordx4 v42, s[4:7], s47 offen  lds
    s_add_u32 m0, s64, 3072
    s_add_u32 s47, s67, 1146880
    buffer_load_dwordx4 v43, s[4:7], s47 offen  lds
    s_cmp_lg_u32 s21, 0
    s_cbranch_scc1 CH_u_89
    ds_read_b64_tr_b16 v[192:193], v18 offset:4096
    ds_read_b64_tr_b16 v[194:195], v18 offset:4352
    ds_read_b64_tr_b16 v[196:197], v19 offset:4096
    ds_read_b64_tr_b16 v[198:199], v19 offset:4352
    ds_read_b64_tr_b16 v[32:33], v18 offset:4128
    ds_read_b64_tr_b16 v[34:35], v18 offset:4384
    ds_read_b64_tr_b16 v[36:37], v19 offset:4128
    ds_read_b64_tr_b16 v[38:39], v19 offset:4384
    s_waitcnt lgkmcnt(2)
    ds_write_b128 v1, v[32:35] offset:12288
    s_waitcnt lgkmcnt(1)
    ds_write_b128 v1, v[36:39] offset:13312
    s_waitcnt lgkmcnt(0)
    s_branch CH_u_88
CH_u_89:
    s_cmp_lg_u32 s21, 1
    s_cbranch_scc1 CH_u_90
    ds_read_b64_tr_b16 v[232:233], v18 offset:4096
    ds_read_b64_tr_b16 v[234:235], v18 offset:4352
    ds_read_b64_tr_b16 v[236:237], v19 offset:4096
    ds_read_b64_tr_b16 v[238:239], v19 offset:4352
    ds_read_b64_tr_b16 v[240:241], v18 offset:4128
    ds_read_b64_tr_b16 v[242:243], v18 offset:4384
    ds_read_b64_tr_b16 v[244:245], v19 offset:4128
    ds_read_b64_tr_b16 v[246:247], v19 offset:4384
    s_waitcnt lgkmcnt(0)
    s_branch CH_u_88
CH_u_90:
    s_cmp_lg_u32 s21, 2
    s_cbranch_scc1 CH_u_91
    ds_read_b64_tr_b16 v[24:25], v18 offset:4096
    ds_read_b64_tr_b16 v[26:27], v18 offset:4352
    ds_read_b64_tr_b16 v[28:29], v19 offset:4096
    ds_read_b64_tr_b16 v[30:31], v19 offset:4352
    ds_read_b64_tr_b16 v[80:81], v18 offset:4128
    ds_read_b64_tr_b16 v[82:83], v18 offset:4384
    ds_read_b64_tr_b16 v[84:85], v19 offset:4128
    ds_read_b64_tr_b16 v[86:87], v19 offset:4384
    s_waitcnt lgkmcnt(6)
    ds_write_b128 v1, v[24:27] offset:4096
    s_waitcnt lgkmcnt(5)
    ds_write_b128 v1, v[28:31] offset:5120
    s_waitcnt lgkmcnt(0)
    s_branch CH_u_88
CH_u_91:
    ds_read_b64_tr_b16 v[160:161], v18 offset:4096
    ds_read_b64_tr_b16 v[162:163], v18 offset:4352
    ds_read_b64_tr_b16 v[164:165], v19 offset:4096
    ds_read_b64_tr_b16 v[166:167], v19 offset:4352
    ds_read_b64_tr_b16 v[32:33], v18 offset:4128
    ds_read_b64_tr_b16 v[34:35], v18 offset:4384
    ds_read_b64_tr_b16 v[36:37], v19 offset:4128
    ds_read_b64_tr_b16 v[38:39], v19 offset:4384
    s_waitcnt lgkmcnt(2)
    ds_write_b128 v1, v[32:35] offset:8192
    s_waitcnt lgkmcnt(1)
    ds_write_b128 v1, v[36:39] offset:9216
    s_waitcnt lgkmcnt(0)
CH_u_88:
    v_lshl_add_u32 v18, v17, 15, v12
    v_add_u32 v18, 32768, v18
    v_add_u32 v19, 65536, v18
    s_waitcnt vmcnt(16)
    s_barrier
    s_add_u32 m0, s70, 0
    s_add_u32 s47, s67, 1572864
    buffer_load_dwordx4 v40, s[4:7], s47 offen  lds
    s_add_u32 m0, s70, 1024
    s_add_u32 s47, s67, 1605632
    buffer_load_dwordx4 v41, s[4:7], s47 offen  lds
    s_add_u32 m0, s70, 2048
    s_add_u32 s47, s67, 1638400
    buffer_load_dwordx4 v42, s[4:7], s47 offen  lds
    s_add_u32 m0, s70, 3072
    s_add_u32 s47, s67, 1671168
    buffer_load_dwordx4 v43, s[4:7], s47 offen  lds
    s_cmp_lg_u32 s21, 0
    s_cbranch_scc1 CH_u_94
    ds_read_b64_tr_b16 v[232:233], v18 offset:16384
    ds_read_b64_tr_b16 v[234:235], v18 offset:16640
    ds_read_b64_tr_b16 v[236:237], v19 offset:16384
    ds_read_b64_tr_b16 v[238:239], v19 offset:16640
    ds_read_b64_tr_b16 v[240:241], v18 offset:16416
    ds_read_b64_tr_b16 v[242:243], v18 offset:16672
    ds_read_b64_tr_b16 v[244:245], v19 offset:16416
    ds_read_b64_tr_b16 v[246:247], v19 offset:16672
    s_waitcnt lgkmcnt(0)
    s_branch CH_u_93
CH_u_94:
    s_cmp_lg_u32 s21, 1
    s_cbranch_scc1 CH_u_95
    ds_read_b64_tr_b16 v[192:193], v18 offset:16384
    ds_read_b64_tr_b16 v[194:195], v18 offset:16640
    ds_read_b64_tr_b16 v[196:197], v19 offset:16384
    ds_read_b64_tr_b16 v[198:199], v19 offset:16640
    ds_read_b64_tr_b16 v[32:33], v18 offset:16416
    ds_read_b64_tr_b16 v[34:35], v18 offset:16672
    ds_read_b64_tr_b16 v[36:37], v19 offset:16416
    ds_read_b64_tr_b16 v[38:39], v19 offset:16672
    s_waitcnt lgkmcnt(2)
    ds_write_b128 v1, v[32:35] offset:12288
    s_waitcnt lgkmcnt(1)
    ds_write_b128 v1, v[36:39] offset:13312
    s_waitcnt lgkmcnt(0)
    s_branch CH_u_93
CH_u_95:
    s_cmp_lg_u32 s21, 2
    s_cbranch_scc1 CH_u_96
    ds_read_b64_tr_b16 v[160:161], v18 offset:16384
    ds_read_b64_tr_b16 v[162:163], v18 offset:16640
    ds_read_b64_tr_b16 v[164:165], v19 offset:16384
    ds_read_b64_tr_b16 v[166:167], v19 offset:16640
    ds_read_b64_tr_b16 v[32:33], v18 offset:16416
    ds_read_b64_tr_b16 v[34:35], v18 offset:16672
    ds_read_b64_tr_b16 v[36:37], v19 offset:16416
    ds_read_b64_tr_b16 v[38:39], v19 offset:16672
    s_waitcnt lgkmcnt(2)
    ds_write_b128 v1, v[32:35] offset:8192
    s_waitcnt lgkmcnt(1)
    ds_write_b128 v1, v[36:39] offset:9216
    s_waitcnt lgkmcnt(0)
    s_branch CH_u_93
CH_u_96:
    ds_read_b64_tr_b16 v[24:25], v18 offset:16384
    ds_read_b64_tr_b16 v[26:27], v18 offset:16640
    ds_read_b64_tr_b16 v[28:29], v19 offset:16384
    ds_read_b64_tr_b16 v[30:31], v19 offset:16640
    ds_read_b64_tr_b16 v[80:81], v18 offset:16416
    ds_read_b64_tr_b16 v[82:83], v18 offset:16672
    ds_read_b64_tr_b16 v[84:85], v19 offset:16416
    ds_read_b64_tr_b16 v[86:87], v19 offset:16672
    s_waitcnt lgkmcnt(6)
    ds_write_b128 v1, v[24:27] offset:4096
    s_waitcnt lgkmcnt(5)
    ds_write_b128 v1, v[28:31] offset:5120
    s_waitcnt lgkmcnt(0)
CH_u_93:
    v_lshl_add_u32 v18, v17, 15, v13
    v_add_u32 v18, 32768, v18
    v_add_u32 v19, 65536, v18
    s_waitcnt vmcnt(16)
    s_barrier
    s_add_u32 m0, s70, 4096
    s_add_u32 s47, s67, 0
    buffer_load_dwordx4 v40, s[8:11], s47 offen  lds
    s_add_u32 m0, s70, 5120
    s_add_u32 s47, s67, 32768
    buffer_load_dwordx4 v41, s[8:11], s47 offen  lds
    s_add_u32 m0, s70, 6144
    s_add_u32 s47, s67, 65536
    buffer_load_dwordx4 v42, s[8:11], s47 offen  lds
    s_add_u32 m0, s70, 7168
    s_add_u32 s47, s67, 98304
    buffer_load_dwordx4 v43, s[8:11], s47 offen  lds
    ds_read_b64_tr_b16 a[40:41], v18 offset:20480
    ds_read_b64_tr_b16 a[42:43], v18 offset:20992
    ds_read_b64_tr_b16 a[44:45], v19 offset:20480
    ds_read_b64_tr_b16 a[46:47], v19 offset:20992
    ds_read_b64_tr_b16 v[32:33], v18 offset:20512
    ds_read_b64_tr_b16 v[34:35], v18 offset:21024
    ds_read_b64_tr_b16 v[36:37], v19 offset:20512
    ds_read_b64_tr_b16 v[38:39], v19 offset:21024
    s_waitcnt lgkmcnt(2)
    ds_write_b128 v1, v[32:35] offset:14336
    s_waitcnt lgkmcnt(1)
    ds_write_b128 v1, v[36:39] offset:15360
    s_waitcnt lgkmcnt(0)
CH_u_98:
    v_lshl_add_u32 v18, v17, 15, v12
    v_add_u32 v18, 32768, v18
    v_add_u32 v19, 65536, v18
    s_waitcnt vmcnt(16)
    s_barrier
    s_add_u32 m0, s64, 20480
    s_add_u32 s47, s67, 524288
    buffer_load_dwordx4 v40, s[8:11], s47 offen  lds
    s_add_u32 m0, s64, 21504
    s_add_u32 s47, s67, 557056
    buffer_load_dwordx4 v41, s[8:11], s47 offen  lds
    s_add_u32 m0, s64, 22528
    s_add_u32 s47, s67, 589824
    buffer_load_dwordx4 v42, s[8:11], s47 offen  lds
    s_add_u32 m0, s64, 23552
    s_add_u32 s47, s67, 622592
    buffer_load_dwordx4 v43, s[8:11], s47 offen  lds
    s_cmp_lg_u32 s21, 0
    s_cbranch_scc1 CH_u_101
    ds_read_b64_tr_b16 a[8:9], v18 offset:24576
    ds_read_b64_tr_b16 a[10:11], v18 offset:24832
    ds_read_b64_tr_b16 a[12:13], v19 offset:24576
    ds_read_b64_tr_b16 a[14:15], v19 offset:24832
    ds_read_b64_tr_b16 a[16:17], v18 offset:24608
    ds_read_b64_tr_b16 a[18:19], v18 offset:24864
    ds_read_b64_tr_b16 a[20:21], v19 offset:24608
    ds_read_b64_tr_b16 a[22:23], v19 offset:24864
    s_waitcnt lgkmcnt(0)
    s_branch CH_u_100
CH_u_101:
    s_cmp_lg_u32 s21, 1
    s_cbranch_scc1 CH_u_102
    ds_read_b64_tr_b16 v[24:25], v18 offset:24576
    ds_read_b64_tr_b16 v[26:27], v18 offset:24832
    ds_read_b64_tr_b16 v[28:29], v19 offset:24576
    ds_read_b64_tr_b16 v[30:31], v19 offset:24832
    ds_read_b64_tr_b16 a[64:65], v18 offset:24608
    ds_read_b64_tr_b16 a[66:67], v18 offset:24864
    ds_read_b64_tr_b16 a[68:69], v19 offset:24608
    ds_read_b64_tr_b16 a[70:71], v19 offset:24864
    s_waitcnt lgkmcnt(6)
    ds_write_b128 v1, v[24:27] offset:16384
    s_waitcnt lgkmcnt(5)
    ds_write_b128 v1, v[28:31] offset:17408
    s_waitcnt lgkmcnt(0)
    s_branch CH_u_100
CH_u_102:
    s_cmp_lg_u32 s21, 2
    s_cbranch_scc1 CH_u_103
    ds_read_b64_tr_b16 a[72:73], v18 offset:24576
    ds_read_b64_tr_b16 a[74:75], v18 offset:24832
    ds_read_b64_tr_b16 a[76:77], v19 offset:24576
    ds_read_b64_tr_b16 a[78:79], v19 offset:24832
    ds_read_b64_tr_b16 a[80:81], v18 offset:24608
    ds_read_b64_tr_b16 a[82:83], v18 offset:24864
    ds_read_b64_tr_b16 a[84:85], v19 offset:24608
    ds_read_b64_tr_b16 a[86:87], v19 offset:24864
    s_waitcnt lgkmcnt(0)
    s_branch CH_u_100
CH_u_103:
    ds_read_b64_tr_b16 a[88:89], v18 offset:24576
    ds_read_b64_tr_b16 a[90:91], v18 offset:24832
    ds_read_b64_tr_b16 a[92:93], v19 offset:24576
    ds_read_b64_tr_b16 a[94:95], v19 offset:24832
    ds_read_b64_tr_b16 a[96:97], v18 offset:24608
    ds_read_b64_tr_b16 a[98:99], v18 offset:24864
    ds_read_b64_tr_b16 a[100:101], v19 offset:24608
    ds_read_b64_tr_b16 a[102:103], v19 offset:24864
    s_waitcnt lgkmcnt(0)
CH_u_100:
    v_lshl_add_u32 v18, v17, 15, v12
    v_add_u32 v18, 32768, v18
    v_add_u32 v19, 65536, v18
    s_waitcnt vmcnt(16)
    s_barrier
    s_add_u32 m0, s64, 24576
    s_add_u32 s47, s67, 1048576
    buffer_load_dwordx4 v40, s[8:11], s47 offen  lds
    s_add_u32 m0, s64, 25600
    s_add_u32 s47, s67, 1081344
    buffer_load_dwordx4 v41, s[8:11], s47 offen  lds
    s_add_u32 m0, s64, 26624
    s_add_u32 s47, s67, 1114112
    buffer_load_dwordx4 v42, s[8:11], s47 offen  lds
    s_add_u32 m0, s64, 27648
    s_add_u32 s47, s67, 1146880
    buffer_load_dwordx4 v43, s[8:11], s47 offen  lds
    s_cmp_lg_u32 s21, 0
    s_cbranch_scc1 CH_u_106
    ds_read_b64_tr_b16 v[24:25], v18 offset:28672
    ds_read_b64_tr_b16 v[26:27], v18 offset:28928
    ds_read_b64_tr_b16 v[28:29], v19 offset:28672
    ds_read_b64_tr_b16 v[30:31], v19 offset:28928
    ds_read_b64_tr_b16 a[64:65], v18 offset:28704
    ds_read_b64_tr_b16 a[66:67], v18 offset:28960
    ds_read_b64_tr_b16 a[68:69], v19 offset:28704
    ds_read_b64_tr_b16 a[70:71], v19 offset:28960
    s_waitcnt lgkmcnt(6)
    ds_write_b128 v1, v[24:27] offset:16384
    s_waitcnt lgkmcnt(5)
    ds_write_b128 v1, v[28:31] offset:17408
    s_waitcnt lgkmcnt(0)
    s_branch CH_u_105
CH_u_106:
    s_cmp_lg_u32 s21, 1
    s_cbranch_scc1 CH_u_107
    ds_read_b64_tr_b16 a[8:9], v18 offset:28672
    ds_read_b64_tr_b16 a[10:11], v18 offset:28928
    ds_read_b64_tr_b16 a[12:13], v19 offset:28672
    ds_read_b64_tr_b16 a[14:15], v19 offset:28928
    ds_read_b64_tr_b16 a[16:17], v18 offset:28704
    ds_read_b64_tr_b16 a[18:19], v18 offset:28960
    ds_read_b64_tr_b16 a[20:21], v19 offset:28704
    ds_read_b64_tr_b16 a[22:23], v19 offset:28960
    s_waitcnt lgkmcnt(0)
    s_branch CH_u_105
CH_u_107:
    s_cmp_lg_u32 s21, 2
    s_cbranch_scc1 CH_u_108
    ds_read_b64_tr_b16 a[88:89], v18 offset:28672
    ds_read_b64_tr_b16 a[90:91], v18 offset:28928
    ds_read_b64_tr_b16 a[92:93], v19 offset:28672
    ds_read_b64_tr_b16 a[94:95], v19 offset:28928
    ds_read_b64_tr_b16 a[96:97], v18 offset:28704
    ds_read_b64_tr_b16 a[98:99], v18 offset:28960
    ds_read_b64_tr_b16 a[100:101], v19 offset:28704
    ds_read_b64_tr_b16 a[102:103], v19 offset:28960
    s_waitcnt lgkmcnt(0)
    s_branch CH_u_105
CH_u_108:
    ds_read_b64_tr_b16 a[72:73], v18 offset:28672
    ds_read_b64_tr_b16 a[74:75], v18 offset:28928
    ds_read_b64_tr_b16 a[76:77], v19 offset:28672
    ds_read_b64_tr_b16 a[78:79], v19 offset:28928
    ds_read_b64_tr_b16 a[80:81], v18 offset:28704
    ds_read_b64_tr_b16 a[82:83], v18 offset:28960
    ds_read_b64_tr_b16 a[84:85], v19 offset:28704
    ds_read_b64_tr_b16 a[86:87], v19 offset:28960
    s_waitcnt lgkmcnt(0)
CH_u_105:
    v_lshl_add_u32 v18, v17, 15, v12
    v_add_u32 v18, 32768, v18
    v_add_u32 v19, 65536, v18
    s_waitcnt vmcnt(16)
    s_barrier
    s_add_u32 m0, s64, 28672
    s_add_u32 s47, s67, 1572864
    buffer_load_dwordx4 v40, s[8:11], s47 offen  lds
    s_add_u32 m0, s64, 29696
    s_add_u32 s47, s67, 1605632
    buffer_load_dwordx4 v41, s[8:11], s47 offen  lds
    s_add_u32 m0, s64, 30720
    s_add_u32 s47, s67, 1638400
    buffer_load_dwordx4 v42, s[8:11], s47 offen  lds
    s_add_u32 m0, s64, 31744
    s_add_u32 s47, s67, 1671168
    buffer_load_dwordx4 v43, s[8:11], s47 offen  lds
    s_cmp_lg_u32 s21, 0
    s_cbranch_scc1 CH_u_111
    ds_read_b64_tr_b16 a[72:73], v18 offset:0
    ds_read_b64_tr_b16 a[74:75], v18 offset:256
    ds_read_b64_tr_b16 a[76:77], v19 offset:0
    ds_read_b64_tr_b16 a[78:79], v19 offset:256
    ds_read_b64_tr_b16 a[80:81], v18 offset:32
    ds_read_b64_tr_b16 a[82:83], v18 offset:288
    ds_read_b64_tr_b16 a[84:85], v19 offset:32
    ds_read_b64_tr_b16 a[86:87], v19 offset:288
    s_waitcnt lgkmcnt(0)
    s_branch CH_u_110
CH_u_111:
    s_cmp_lg_u32 s21, 1
    s_cbranch_scc1 CH_u_112
    ds_read_b64_tr_b16 a[88:89], v18 offset:0
    ds_read_b64_tr_b16 a[90:91], v18 offset:256
    ds_read_b64_tr_b16 a[92:93], v19 offset:0
    ds_read_b64_tr_b16 a[94:95], v19 offset:256
    ds_read_b64_tr_b16 a[96:97], v18 offset:32
    ds_read_b64_tr_b16 a[98:99], v18 offset:288
    ds_read_b64_tr_b16 a[100:101], v19 offset:32
    ds_read_b64_tr_b16 a[102:103], v19 offset:288
    s_waitcnt lgkmcnt(0)
    s_branch CH_u_110
CH_u_112:
    s_cmp_lg_u32 s21, 2
    s_cbranch_scc1 CH_u_113
    ds_read_b64_tr_b16 a[8:9], v18 offset:0
    ds_read_b64_tr_b16 a[10:11], v18 offset:256
    ds_read_b64_tr_b16 a[12:13], v19 offset:0
    ds_read_b64_tr_b16 a[14:15], v19 offset:256
    ds_read_b64_tr_b16 a[16:17], v18 offset:32
    ds_read_b64_tr_b16 a[18:19], v18 offset:288
    ds_read_b64_tr_b16 a[20:21], v19 offset:32
    ds_read_b64_tr_b16 a[22:23], v19 offset:288
    s_waitcnt lgkmcnt(0)
    s_branch CH_u_110
CH_u_113:
    ds_read_b64_tr_b16 v[24:25], v18 offset:0
    ds_read_b64_tr_b16 v[26:27], v18 offset:256
    ds_read_b64_tr_b16 v[28:29], v19 offset:0
    ds_read_b64_tr_b16 v[30:31], v19 offset:256
    ds_read_b64_tr_b16 a[64:65], v18 offset:32
    ds_read_b64_tr_b16 a[66:67], v18 offset:288
    ds_read_b64_tr_b16 a[68:69], v19 offset:32
    ds_read_b64_tr_b16 a[70:71], v19 offset:288
    s_waitcnt lgkmcnt(6)
    ds_write_b128 v1, v[24:27] offset:16384
    s_waitcnt lgkmcnt(5)
    ds_write_b128 v1, v[28:31] offset:17408
    s_waitcnt lgkmcnt(0)
CH_u_110:
    v_lshl_add_u32 v18, v17, 13, v12
    v_add_u32 v18, 0, v18
    v_add_u32 v19, 16384, v18
    s_waitcnt vmcnt(16)
    s_barrier
    s_add_u32 m0, s64, 0
    s_add_u32 s47, s68, 81920
    buffer_load_dwordx4 v44, s[24:27], s47 offen  lds
    s_add_u32 m0, s64, 1024
    s_add_u32 s47, s68, 87040
    buffer_load_dwordx4 v45, s[24:27], s47 offen  lds
    s_add_u32 m0, s64, 2048
    s_add_u32 s47, s68, 92160
    buffer_load_dwordx4 v46, s[24:27], s47 offen  lds
    s_add_u32 m0, s64, 3072
    s_add_u32 s47, s68, 97280
    buffer_load_dwordx4 v47, s[24:27], s47 offen  lds
    s_cmp_lg_u32 s21, 0
    s_cbranch_scc1 CH_u_116
    ds_read_b64_tr_b16 a[88:89], v18 offset:0
    ds_read_b64_tr_b16 a[90:91], v18 offset:256
    ds_read_b64_tr_b16 a[92:93], v19 offset:0
    ds_read_b64_tr_b16 a[94:95], v19 offset:256
    ds_read_b64_tr_b16 a[96:97], v18 offset:32
    ds_read_b64_tr_b16 a[98:99], v18 offset:288
    ds_read_b64_tr_b16 a[100:101], v19 offset:32
    ds_read_b64_tr_b16 a[102:103], v19 offset:288
    s_waitcnt lgkmcnt(0)
    s_branch CH_u_115
CH_u_116:
    s_cmp_lg_u32 s21, 1
    s_cbranch_scc1 CH_u_117
    ds_read_b64_tr_b16 a[72:73], v18 offset:0
    ds_read_b64_tr_b16 a[74:75], v18 offset:256
    ds_read_b64_tr_b16 a[76:77], v19 offset:0
    ds_read_b64_tr_b16 a[78:79], v19 offset:256
    ds_read_b64_tr_b16 a[80:81], v18 offset:32
    ds_read_b64_tr_b16 a[82:83], v18 offset:288
    ds_read_b64_tr_b16 a[84:85], v19 offset:32
    ds_read_b64_tr_b16 a[86:87], v19 offset:288
    s_waitcnt lgkmcnt(0)
    s_branch CH_u_115
CH_u_117:
    s_cmp_lg_u32 s21, 2
    s_cbranch_scc1 CH_u_118
    ds_read_b64_tr_b16 v[24:25], v18 offset:0
    ds_read_b64_tr_b16 v[26:27], v18 offset:256
    ds_read_b64_tr_b16 v[28:29], v19 offset:0
    ds_read_b64_tr_b16 v[30:31], v19 offset:256
    ds_read_b64_tr_b16 a[64:65], v18 offset:32
    ds_read_b64_tr_b16 a[66:67], v18 offset:288
    ds_read_b64_tr_b16 a[68:69], v19 offset:32
    ds_read_b64_tr_b16 a[70:71], v19 offset:288
    s_waitcnt lgkmcnt(6)
    ds_write_b128 v1, v[24:27] offset:16384
    s_waitcnt lgkmcnt(5)
    ds_write_b128 v1, v[28:31] offset:17408
    s_waitcnt lgkmcnt(0)
    s_branch CH_u_115
CH_u_118:
    ds_read_b64_tr_b16 a[8:9], v18 offset:0
    ds_read_b64_tr_b16 a[10:11], v18 offset:256
    ds_read_b64_tr_b16 a[12:13], v19 offset:0
    ds_read_b64_tr_b16 a[14:15], v19 offset:256
    ds_read_b64_tr_b16 a[16:17], v18 offset:32
    ds_read_b64_tr_b16 a[18:19], v18 offset:288
    ds_read_b64_tr_b16 a[20:21], v19 offset:32
    ds_read_b64_tr_b16 a[22:23], v19 offset:288
    s_waitcnt lgkmcnt(0)
CH_u_115:
    v_lshl_add_u32 v18, v17, 13, v12
    v_add_u32 v18, 0, v18
    v_add_u32 v19, 16384, v18
    s_waitcnt vmcnt(16)
    s_barrier
    s_add_u32 m0, s70, 0
    s_add_u32 s47, s68, 0
    buffer_load_dwordx4 v44, s[24:27], s47 offen  lds
    s_add_u32 m0, s70, 1024
    s_add_u32 s47, s68, 5120
    buffer_load_dwordx4 v45, s[24:27], s47 offen  lds
    s_add_u32 m0, s70, 2048
    s_add_u32 s47, s68, 10240
    buffer_load_dwordx4 v46, s[24:27], s47 offen  lds
    s_add_u32 m0, s70, 3072
    s_add_u32 s47, s68, 15360
    buffer_load_dwordx4 v47, s[24:27], s47 offen  lds
    s_cmp_lg_u32 s21, 0
    s_cbranch_scc1 CH_u_121
    ds_read_b64_tr_b16 a[24:25], v18 offset:4096
    ds_read_b64_tr_b16 a[26:27], v18 offset:4352
    ds_read_b64_tr_b16 a[28:29], v19 offset:4096
    ds_read_b64_tr_b16 a[30:31], v19 offset:4352
    ds_read_b64_tr_b16 a[32:33], v18 offset:4128
    ds_read_b64_tr_b16 a[34:35], v18 offset:4384
    ds_read_b64_tr_b16 a[36:37], v19 offset:4128
    ds_read_b64_tr_b16 a[38:39], v19 offset:4384
    s_waitcnt lgkmcnt(0)
    s_branch CH_u_120
CH_u_121:
    s_cmp_lg_u32 s21, 1
    s_cbranch_scc1 CH_u_122
    ds_read_b64_tr_b16 a[104:105], v18 offset:4096
    ds_read_b64_tr_b16 a[106:107], v18 offset:4352
    ds_read_b64_tr_b16 a[108:109], v19 offset:4096
    ds_read_b64_tr_b16 a[110:111], v19 offset:4352
    ds_read_b64_tr_b16 a[120:121], v18 offset:4128
    ds_read_b64_tr_b16 a[122:123], v18 offset:4384
    ds_read_b64_tr_b16 a[124:125], v19 offset:4128
    ds_read_b64_tr_b16 a[126:127], v19 offset:4384
    s_waitcnt lgkmcnt(0)
    s_branch CH_u_120
CH_u_122:
    s_cmp_lg_u32 s21, 2
    s_cbranch_scc1 CH_u_123
    ds_read_b64_tr_b16 v[24:25], v18 offset:4096
    ds_read_b64_tr_b16 v[26:27], v18 offset:4352
    ds_read_b64_tr_b16 v[28:29], v19 offset:4096
    ds_read_b64_tr_b16 v[30:31], v19 offset:4352
    ds_read_b64_tr_b16 a[128:129], v18 offset:4128
    ds_read_b64_tr_b16 a[130:131], v18 offset:4384
    ds_read_b64_tr_b16 a[132:133], v19 offset:4128
    ds_read_b64_tr_b16 a[134:135], v19 offset:4384
    s_waitcnt lgkmcnt(6)
    ds_write_b128 v1, v[24:27] offset:18432
    s_waitcnt lgkmcnt(5)
    ds_write_b128 v1, v[28:31] offset:19456
    s_waitcnt lgkmcnt(0)
    s_branch CH_u_120
CH_u_123:
    ds_read_b64_tr_b16 a[112:113], v18 offset:4096
    ds_read_b64_tr_b16 a[114:115], v18 offset:4352
    ds_read_b64_tr_b16 a[116:117], v19 offset:4096
    ds_read_b64_tr_b16 a[118:119], v19 offset:4352
    ds_read_b64_tr_b16 a[136:137], v18 offset:4128
    ds_read_b64_tr_b16 a[138:139], v18 offset:4384
    ds_read_b64_tr_b16 a[140:141], v19 offset:4128
    ds_read_b64_tr_b16 a[142:143], v19 offset:4384
    s_waitcnt lgkmcnt(0)
CH_u_120:
    v_lshl_add_u32 v18, v17, 15, v12
    v_add_u32 v18, 32768, v18
    v_add_u32 v19, 65536, v18
    s_waitcnt vmcnt(16)
    s_barrier
    s_add_u32 m0, s70, 4096
    s_add_u32 s47, s68, 82176
    buffer_load_dwordx4 v44, s[24:27], s47 offen  lds
    s_add_u32 m0, s70, 5120
    s_add_u32 s47, s68, 87296
    buffer_load_dwordx4 v45, s[24:27], s47 offen  lds
    s_add_u32 m0, s70, 6144
    s_add_u32 s47, s68, 92416
    buffer_load_dwordx4 v46, s[24:27], s47 offen  lds
    s_add_u32 m0, s70, 7168
    s_add_u32 s47, s68, 97536
    buffer_load_dwordx4 v47, s[24:27], s47 offen  lds
    s_cmp_lg_u32 s21, 0
    s_cbranch_scc1 CH_u_126
    ds_read_b64_tr_b16 a[104:105], v18 offset:20480
    ds_read_b64_tr_b16 a[106:107], v18 offset:20736
    ds_read_b64_tr_b16 a[108:109], v19 offset:20480
    ds_read_b64_tr_b16 a[110:111], v19 offset:20736
    ds_read_b64_tr_b16 a[120:121], v18 offset:20512
    ds_read_b64_tr_b16 a[122:123], v18 offset:20768
    ds_read_b64_tr_b16 a[124:125], v19 offset:20512
    ds_read_b64_tr_b16 a[126:127], v19 offset:20768
    s_waitcnt lgkmcnt(0)
    s_branch CH_u_125
CH_u_126:
    s_cmp_lg_u32 s21, 1
    s_cbranch_scc1 CH_u_127
    ds_read_b64_tr_b16 a[24:25], v18 offset:20480
    ds_read_b64_tr_b16 a[26:27], v18 offset:20736
    ds_read_b64_tr_b16 a[28:29], v19 offset:20480
    ds_read_b64_tr_b16 a[30:31], v19 offset:20736
    ds_read_b64_tr_b16 a[32:33], v18 offset:20512
    ds_read_b64_tr_b16 a[34:35], v18 offset:20768
    ds_read_b64_tr_b16 a[36:37], v19 offset:20512
    ds_read_b64_tr_b16 a[38:39], v19 offset:20768
    s_waitcnt lgkmcnt(0)
    s_branch CH_u_125
CH_u_127:
    s_cmp_lg_u32 s21, 2
    s_cbranch_scc1 CH_u_128
    ds_read_b64_tr_b16 a[112:113], v18 offset:20480
    ds_read_b64_tr_b16 a[114:115], v18 offset:20736
    ds_read_b64_tr_b16 a[116:117], v19 offset:20480
    ds_read_b64_tr_b16 a[118:119], v19 offset:20736
    ds_read_b64_tr_b16 a[136:137], v18 offset:20512
    ds_read_b64_tr_b16 a[138:139], v18 offset:20768
    ds_read_b64_tr_b16 a[140:141], v19 offset:20512
    ds_read_b64_tr_b16 a[142:143], v19 offset:20768
    s_waitcnt lgkmcnt(0)
    s_branch CH_u_125
CH_u_128:
    ds_read_b64_tr_b16 v[24:25], v18 offset:20480
    ds_read_b64_tr_b16 v[26:27], v18 offset:20736
    ds_read_b64_tr_b16 v[28:29], v19 offset:20480
    ds_read_b64_tr_b16 v[30:31], v19 offset:20736
    ds_read_b64_tr_b16 a[128:129], v18 offset:20512
    ds_read_b64_tr_b16 a[130:131], v18 offset:20768
    ds_read_b64_tr_b16 a[132:133], v19 offset:20512
    ds_read_b64_tr_b16 a[134:135], v19 offset:20768
    s_waitcnt lgkmcnt(6)
    ds_write_b128 v1, v[24:27] offset:18432
    s_waitcnt lgkmcnt(5)
    ds_write_b128 v1, v[28:31] offset:19456
    s_waitcnt lgkmcnt(0)
CH_u_125:
    v_lshl_add_u32 v18, v17, 15, v12
    v_add_u32 v18, 32768, v18
    v_add_u32 v19, 65536, v18
    s_waitcnt vmcnt(16)
    s_barrier
    s_cmp_lg_u32 s21, 0
    s_cbranch_scc1 CH_u_131
    ds_read_b64_tr_b16 v[24:25], v18 offset:24576
    ds_read_b64_tr_b16 v[26:27], v18 offset:24832
    ds_read_b64_tr_b16 v[28:29], v19 offset:24576
    ds_read_b64_tr_b16 v[30:31], v19 offset:24832
    ds_read_b64_tr_b16 a[128:129], v18 offset:24608
    ds_read_b64_tr_b16 a[130:131], v18 offset:24864
    ds_read_b64_tr_b16 a[132:133], v19 offset:24608
    ds_read_b64_tr_b16 a[134:135], v19 offset:24864
    s_waitcnt lgkmcnt(6)
    ds_write_b128 v1, v[24:27] offset:18432
    s_waitcnt lgkmcnt(5)
    ds_write_b128 v1, v[28:31] offset:19456
    s_waitcnt lgkmcnt(0)
    s_branch CH_u_130
CH_u_131:
    s_cmp_lg_u32 s21, 1
    s_cbranch_scc1 CH_u_132
    ds_read_b64_tr_b16 a[112:113], v18 offset:24576
    ds_read_b64_tr_b16 a[114:115], v18 offset:24832
    ds_read_b64_tr_b16 a[116:117], v19 offset:24576
    ds_read_b64_tr_b16 a[118:119], v19 offset:24832
    ds_read_b64_tr_b16 a[136:137], v18 offset:24608
    ds_read_b64_tr_b16 a[138:139], v18 offset:24864
    ds_read_b64_tr_b16 a[140:141], v19 offset:24608
    ds_read_b64_tr_b16 a[142:143], v19 offset:24864
    s_waitcnt lgkmcnt(0)
    s_branch CH_u_130
CH_u_132:
    s_cmp_lg_u32 s21, 2
    s_cbranch_scc1 CH_u_133
    ds_read_b64_tr_b16 a[24:25], v18 offset:24576
    ds_read_b64_tr_b16 a[26:27], v18 offset:24832
    ds_read_b64_tr_b16 a[28:29], v19 offset:24576
    ds_read_b64_tr_b16 a[30:31], v19 offset:24832
    ds_read_b64_tr_b16 a[32:33], v18 offset:24608
    ds_read_b64_tr_b16 a[34:35], v18 offset:24864
    ds_read_b64_tr_b16 a[36:37], v19 offset:24608
    ds_read_b64_tr_b16 a[38:39], v19 offset:24864
    s_waitcnt lgkmcnt(0)
    s_branch CH_u_130
CH_u_133:
    ds_read_b64_tr_b16 a[104:105], v18 offset:24576
    ds_read_b64_tr_b16 a[106:107], v18 offset:24832
    ds_read_b64_tr_b16 a[108:109], v19 offset:24576
    ds_read_b64_tr_b16 a[110:111], v19 offset:24832
    ds_read_b64_tr_b16 a[120:121], v18 offset:24608
    ds_read_b64_tr_b16 a[122:123], v18 offset:24864
    ds_read_b64_tr_b16 a[124:125], v19 offset:24608
    ds_read_b64_tr_b16 a[126:127], v19 offset:24864
    s_waitcnt lgkmcnt(0)
CH_u_130:
    v_lshl_add_u32 v18, v17, 15, v12
    v_add_u32 v18, 32768, v18
    v_add_u32 v19, 65536, v18
    s_waitcnt vmcnt(12)
    s_barrier
    s_cmp_lg_u32 s21, 0
    s_cbranch_scc1 CH_u_136
    ds_read_b64_tr_b16 a[112:113], v18 offset:28672
    ds_read_b64_tr_b16 a[114:115], v18 offset:28928
    ds_read_b64_tr_b16 a[116:117], v19 offset:28672
    ds_read_b64_tr_b16 a[118:119], v19 offset:28928
    ds_read_b64_tr_b16 a[136:137], v18 offset:28704
    ds_read_b64_tr_b16 a[138:139], v18 offset:28960
    ds_read_b64_tr_b16 a[140:141], v19 offset:28704
    ds_read_b64_tr_b16 a[142:143], v19 offset:28960
    s_waitcnt lgkmcnt(0)
    s_branch CH_u_135
CH_u_136:
    s_cmp_lg_u32 s21, 1
    s_cbranch_scc1 CH_u_137
    ds_read_b64_tr_b16 v[24:25], v18 offset:28672
    ds_read_b64_tr_b16 v[26:27], v18 offset:28928
    ds_read_b64_tr_b16 v[28:29], v19 offset:28672
    ds_read_b64_tr_b16 v[30:31], v19 offset:28928
    ds_read_b64_tr_b16 a[128:129], v18 offset:28704
    ds_read_b64_tr_b16 a[130:131], v18 offset:28960
    ds_read_b64_tr_b16 a[132:133], v19 offset:28704
    ds_read_b64_tr_b16 a[134:135], v19 offset:28960
    s_waitcnt lgkmcnt(6)
    ds_write_b128 v1, v[24:27] offset:18432
    s_waitcnt lgkmcnt(5)
    ds_write_b128 v1, v[28:31] offset:19456
    s_waitcnt lgkmcnt(0)
    s_branch CH_u_135
CH_u_137:
    s_cmp_lg_u32 s21, 2
    s_cbranch_scc1 CH_u_138
    ds_read_b64_tr_b16 a[104:105], v18 offset:28672
    ds_read_b64_tr_b16 a[106:107], v18 offset:28928
    ds_read_b64_tr_b16 a[108:109], v19 offset:28672
    ds_read_b64_tr_b16 a[110:111], v19 offset:28928
    ds_read_b64_tr_b16 a[120:121], v18 offset:28704
    ds_read_b64_tr_b16 a[122:123], v18 offset:28960
    ds_read_b64_tr_b16 a[124:125], v19 offset:28704
    ds_read_b64_tr_b16 a[126:127], v19 offset:28960
    s_waitcnt lgkmcnt(0)
    s_branch CH_u_135
CH_u_138:
    ds_read_b64_tr_b16 a[24:25], v18 offset:28672
    ds_read_b64_tr_b16 a[26:27], v18 offset:28928
    ds_read_b64_tr_b16 a[28:29], v19 offset:28672
    ds_read_b64_tr_b16 a[30:31], v19 offset:28928
    ds_read_b64_tr_b16 a[32:33], v18 offset:28704
    ds_read_b64_tr_b16 a[34:35], v18 offset:28960
    ds_read_b64_tr_b16 a[36:37], v19 offset:28704
    ds_read_b64_tr_b16 a[38:39], v19 offset:28960
    s_waitcnt lgkmcnt(0)
CH_u_135:
    v_lshl_add_u32 v18, v16, 15, v14
    v_add_u32 v18, 32768, v18
    v_add_u32 v19, 65536, v18
    s_waitcnt vmcnt(8)
    s_barrier
    ds_read_b64_tr_b16 v[24:25], v18 offset:0
    ds_read_b64_tr_b16 v[26:27], v18 offset:512
    ds_read_b64_tr_b16 v[28:29], v19 offset:0
    ds_read_b64_tr_b16 v[30:31], v19 offset:512
    ds_read_b64_tr_b16 a[224:225], v18 offset:8
    ds_read_b64_tr_b16 a[226:227], v18 offset:520
    ds_read_b64_tr_b16 a[228:229], v19 offset:8
    ds_read_b64_tr_b16 a[230:231], v19 offset:520
    s_waitcnt lgkmcnt(6)
    ds_write_b128 v1, v[24:27] offset:22528
    s_waitcnt lgkmcnt(5)
    ds_write_b128 v1, v[28:31] offset:23552
    s_waitcnt lgkmcnt(0)
CH_u_140:
    v_lshl_add_u32 v18, v16, 13, v14
    v_add_u32 v18, 0, v18
    v_add_u32 v19, 16384, v18
    s_waitcnt vmcnt(4)
    s_barrier
    s_add_u32 m0, s64, 0
    s_add_u32 s47, s69, 0
    buffer_load_dwordx4 v11, s[24:27], s47 offen  lds
    s_add_u32 m0, s64, 1024
    s_add_u32 s47, s69, 10240
    buffer_load_dwordx4 v11, s[24:27], s47 offen  lds
    s_add_u32 m0, s64, 2048
    s_add_u32 s47, s69, 20480
    buffer_load_dwordx4 v11, s[24:27], s47 offen  lds
    s_add_u32 m0, s64, 3072
    s_add_u32 s47, s69, 30720
    buffer_load_dwordx4 v11, s[24:27], s47 offen  lds
    ds_read_b64_tr_b16 v[24:25], v18 offset:0
    ds_read_b64_tr_b16 v[26:27], v18 offset:512
    ds_read_b64_tr_b16 v[28:29], v19 offset:0
    ds_read_b64_tr_b16 v[30:31], v19 offset:512
    ds_read_b64_tr_b16 v[32:33], v18 offset:8
    ds_read_b64_tr_b16 v[34:35], v18 offset:520
    ds_read_b64_tr_b16 v[36:37], v19 offset:8
    ds_read_b64_tr_b16 v[38:39], v19 offset:520
    s_waitcnt lgkmcnt(6)
    ds_write_b128 v1, v[24:27] offset:20480
    s_waitcnt lgkmcnt(5)
    ds_write_b128 v1, v[28:31] offset:21504
    s_waitcnt lgkmcnt(4)
    ds_write_b128 v1, v[32:35] offset:24576
    s_waitcnt lgkmcnt(3)
    ds_write_b128 v1, v[36:39] offset:25600
    s_waitcnt lgkmcnt(0)
CH_u_142:
    v_lshl_add_u32 v18, v16, 13, v14
    v_add_u32 v18, 0, v18
    v_add_u32 v19, 16384, v18
    s_waitcnt vmcnt(4)
    s_barrier
    ds_read_b64_tr_b16 a[240:241], v18 offset:4096
    ds_read_b64_tr_b16 a[242:243], v18 offset:4608
    ds_read_b64_tr_b16 a[244:245], v19 offset:4096
    ds_read_b64_tr_b16 a[246:247], v19 offset:4608
    ds_read_b64_tr_b16 v[32:33], v18 offset:4104
    ds_read_b64_tr_b16 v[34:35], v18 offset:4616
    ds_read_b64_tr_b16 v[36:37], v19 offset:4104
    ds_read_b64_tr_b16 v[38:39], v19 offset:4616
    s_waitcnt lgkmcnt(2)
    ds_write_b128 v1, v[32:35] offset:26624
    s_waitcnt lgkmcnt(1)
    ds_write_b128 v1, v[36:39] offset:27648
    s_waitcnt lgkmcnt(0)
CH_u_144:
    v_add_u32 v18, 32768, v15
    v_add_u32 v19, 65536, v18
    s_waitcnt vmcnt(0)
    s_barrier
    ds_read_b64_tr_b16 v[24:25], v18 offset:0
    ds_read_b64_tr_b16 v[26:27], v18 offset:256
    ds_read_b64_tr_b16 v[28:29], v18 offset:32768
    ds_read_b64_tr_b16 v[30:31], v18 offset:33024
    ds_read_b64_tr_b16 v[32:33], v19 offset:0
    ds_read_b64_tr_b16 v[34:35], v19 offset:256
    ds_read_b64_tr_b16 v[36:37], v19 offset:32768
    ds_read_b64_tr_b16 v[38:39], v19 offset:33024
    s_waitcnt lgkmcnt(6)
    ds_write_b128 v1, v[24:27] offset:28672
    s_waitcnt lgkmcnt(5)
    ds_write_b128 v1, v[28:31] offset:29696
    s_waitcnt lgkmcnt(4)
    ds_write_b128 v1, v[32:35] offset:30720
    s_waitcnt lgkmcnt(3)
    ds_write_b128 v1, v[36:39] offset:31744
    s_waitcnt lgkmcnt(0)
CH_u_146:
    s_mul_i32 s47, s19, 1024
    s_add_u32 s63, s63, s47
    s_add_u32 s12, s64, s47
    s_xor_b32 s13, s92, 1024
    s_xor_b32 s14, s92, 2048
    s_xor_b32 s15, s92, 3072
    s_load_dwordx2 s[4:5], s[0:1], 88
    s_mov_b32 s6, 256
    s_mov_b32 s7, 0x20000
    s_load_dwordx2 s[8:9], s[0:1], 32
    s_mov_b32 s10, 10240
    s_mov_b32 s11, 0x20000
    s_waitcnt lgkmcnt(0)
    s_lshl_b32 s47, s19, 3
    v_mov_b32 v8, 132
    s_mov_b32 s49, 0
CP_148:
    buffer_load_dword v9, v8, s[4:7], s47 offen sc1
    s_waitcnt vmcnt(0)
    v_cmp_gt_u32 vcc, 2097152, v9
    s_cbranch_vccz CP_149
    s_add_u32 s49, s49, 1
    s_cmp_gt_u32 s49, 400000
    s_cbranch_scc1 L_end
    s_sleep 1
    s_branch CP_148
CP_149:
    buffer_load_dwordx2 v[8:9], off, s[4:7], s47 offset:128 sc1
    s_waitcnt vmcnt(0)
    v_readfirstlane_b32 s66, v8
    v_readfirstlane_b32 s67, v9
    s_nop 0
    s_lshr_b64 s[66:67], s[66:67], s101
    s_and_b32 s101, s66, 63
    v_mov_b32 v8, 4
    s_mov_b32 s49, 0
CP_150:
    buffer_load_dword v9, v8, s[4:7], 0 offen sc1
    s_waitcnt vmcnt(0)
    v_cmp_gt_u32 vcc, 1, v9
    s_cbranch_vccz CP_151
    s_add_u32 s49, s49, 1
    s_cmp_gt_u32 s49, 400000
    s_cbranch_scc1 L_end
    s_sleep 1
    s_branch CP_150
CP_151:
    v_readfirstlane_b32 s41, v9
    s_nop 0
    s_and_b32 s41, s41, 2
    s_lshl_b32 s41, s41, 12
    v_bfe_u32 v8, v0, 2, 3
    v_add_u32 v8, 8, v8
    s_mov_b32 s49, 0
CP_152:
    buffer_load_dword v9, v8, s[4:7], 0 offen sc1
    s_waitcnt vmcnt(0)
    v_cmp_gt_u32 vcc, 1, v9
    s_cbranch_vccz CP_153
    s_add_u32 s49, s49, 1
    s_cmp_gt_u32 s49, 400000
    s_cbranch_scc1 L_end
    s_sleep 1
    s_branch CP_152
CP_153:
    v_and_b32 v8, 511, v0
    v_lshlrev_b32 v8, 3, v8
    s_mov_b32 s47, 1241088
    s_mov_b32 s49, 0
CP_154:
    buffer_load_dword v9, v8, s[32:35], s47 offen sc1
    s_waitcnt vmcnt(0)
    v_cmp_gt_u32 vcc, 1, v9
    s_cbranch_vccz CP_155
    s_add_u32 s49, s49, 1
    s_cmp_gt_u32 s49, 400000
    s_cbranch_scc1 L_end
    s_sleep 1
    s_branch CP_154
CP_155:
    s_mul_i32 s47, s19, 196608
    s_add_u32 s47, s47, 65536
    s_add_u32 s28, s28, s47
    s_addc_u32 s29, s29, 0
    s_mul_i32 s98, s20, 768
    s_add_u32 s98, s98, 1146880
    s_lshl_b32 s47, s20, 1
    s_add_u32 s47, s47, s19
    s_lshl_b32 s47, s47, 7
    s_add_u32 s47, s47, 1220608
    s_add_u32 s47, s47, s41
    s_cmp_eq_u32 s21, 0
    s_cselect_b32 s18, s47, 1073741824
    s_mov_b32 s100, 0
    s_barrier
CH_layer_156:
    s_mul_i32 s42, s100, 67108864
    s_add_u32 s42, s42, 119537664
    s_mul_i32 s50, s100, 4194304
    s_add_u32 s50, s50, 2097152
    s_mul_i32 s97, s100, 67108864
    s_add_u32 s97, s97, 35651584
    s_lshl_b32 s47, s20, 14
    s_lshl_b32 s48, s21, 11
    s_add_u32 s47, s47, s48
    s_add_u32 s42, s42, s47
    s_lshl_b32 s48, s20, 14
    s_add_u32 s42, s42, s48
    s_add_u32 s42, s42, s41
    s_and_b32 s48, s20, 1
    s_lshl_b32 s48, s48, 14
    s_add_u32 s42, s42, s48
    s_and_b32 s48, s12, 1024
    s_add_u32 s42, s42, s48
    s_lshr_b32 s47, s20, 1
    s_lshl_b32 s47, s47, 14
    s_and_b32 s48, s20, 1
    s_lshl_b32 s48, s48, 12
    s_add_u32 s47, s47, s48
    s_lshl_b32 s48, s21, 9
    s_add_u32 s47, s47, s48
    s_add_u32 s47, s47, s41
    s_add_u32 s97, s97, s47
    s_lshl_b32 s47, s19, 11
    s_add_u32 s97, s97, s47
    s_mov_b32 s96, 1073741824
    s_mov_b32 s72, 0
    s_lshl_b32 s84, s100, 6
    s_cmp_eq_u32 s19, 0
    s_cselect_b64 s[82:83], 0, -1
    s_lshl_b32 s47, s19, 14
    s_add_u32 s47, s47, s41
    s_add_u32 s50, s50, s47
    s_xor_b32 s90, s50, 0x4000
    s_sub_u32 s90, s90, 32768
    s_mov_b32 s40, 0
    s_mov_b32 s43, 163840
    s_lshl_b32 s99, s100, 6
    v_lshrrev_b32 v8, 4, v0
    v_bfe_u32 v9, v8, 2, 2
    v_mul_u32_u24 v9, 2560, v9
    v_bfe_u32 v11, v8, 0, 1
    v_mul_u32_u24 v11, 1280, v11
    v_add_u32 v9, v9, v11
    v_bfe_u32 v11, v8, 4, 2
    v_lshl_add_u32 v9, v11, 5, v9
    v_bfe_u32 v11, v8, 1, 1
    v_lshl_add_u32 v9, v11, 4, v9
    s_mov_b32 s66, 0x05040100
    s_mov_b32 s67, 0x07060302
    s_xor_b32 s47, s19, 0
    s_mul_i32 s47, s47, 640
    s_lshl_b32 s48, s21, 7
    s_add_u32 s48, s48, s47
    buffer_load_dwordx4 v[12:15], v9, s[8:11], s48 offen
    buffer_load_dwordx4 v[28:31], v9, s[8:11], s47 offen offset:512
    s_waitcnt vmcnt(1)
    v_perm_b32 v24, v14, v12, s66
    v_perm_b32 v25, v14, v12, s67
    v_perm_b32 v26, v15, v13, s66
    v_perm_b32 v27, v15, v13, s67
    v_min_u32 v24, -2, v24
    v_min_u32 v26, -2, v26
    s_waitcnt vmcnt(0)
    v_min_u32 v28, -2, v28
    v_min_u32 v30, -2, v30
    s_xor_b32 s47, s19, 1
    s_mul_i32 s47, s47, 640
    s_lshl_b32 s48, s21, 7
    s_add_u32 s48, s48, s47
    buffer_load_dwordx4 v[12:15], v9, s[8:11], s48 offen
    buffer_load_dwordx4 v[60:63], v9, s[8:11], s47 offen offset:512
    s_waitcnt vmcnt(1)
    v_perm_b32 v56, v14, v12, s66
    v_perm_b32 v57, v14, v12, s67
    v_perm_b32 v58, v15, v13, s66
    v_perm_b32 v59, v15, v13, s67
    v_min_u32 v56, -2, v56
    v_min_u32 v58, -2, v58
    s_waitcnt vmcnt(0)
    v_min_u32 v60, -2, v60
    v_min_u32 v62, -2, v62
    v_add_u32 v40, s92, v0
    v_xor_b32 v42, 1024, v40
    s_lshl_b32 s47, s19, 5
    s_add_u32 s47, s47, s20
    s_lshl_b32 s47, s47, 2
    s_add_u32 s47, s47, s21
    s_lshl_b32 s47, s47, 11
    s_add_u32 s93, s47, 4194304
    s_add_u32 s89, s93, 1024
    buffer_store_dwordx4 v[56:59], v0, s[36:39], s93 offen
    buffer_store_dwordx4 v[60:63], v0, s[36:39], s89 offen
    v_and_b32 v8, 0x180, v0
    s_add_u32 s47, s99, 2
    s_mov_b32 s49, 0
CP_157:
    buffer_load_dword v9, v8, s[32:35], s98 offen sc1
    s_waitcnt vmcnt(0)
    v_cmp_gt_u32 vcc, s47, v9
    s_cbranch_vccz CP_158
    s_add_u32 s49, s49, 1
    s_cmp_gt_u32 s49, 400000
    s_cbranch_scc1 L_end
    s_sleep 1
    s_branch CP_157
CP_158:
    s_add_u32 m0, s63, 0
    s_nop 0
    buffer_load_dwordx4 v0, s[32:35], s42 offen sc1 lds
    s_xor_b32 m0, m0, 1024
    s_xor_b32 s60, s42, 1024
    buffer_load_dwordx4 v0, s[32:35], s60 offen sc1 lds
    s_add_u32 m0, s12, 0
    s_xor_b32 s60, s42, 16384
    buffer_load_dwordx4 v0, s[32:35], s60 offen sc1 lds
    s_xor_b32 m0, m0, 1024
    s_xor_b32 s60, s60, 1024
    buffer_load_dwordx4 v0, s[32:35], s60 offen sc1 lds
    s_add_u32 s42, s42, 1048576
    ds_read_b128 v[32:35], v1 offset:4096
    ds_read_b128 v[36:39], v1 offset:5120
    v_mov_b64 v[8:9], 0
    v_mov_b64 v[10:11], 0
    v_mov_b64 v[12:13], 0
    v_mov_b64 v[14:15], 0
    v_mov_b64 v[16:17], 0
    v_mov_b64 v[18:19], 0
    v_mov_b64 v[20:21], 0
    v_mov_b64 v[22:23], 0
    v_mov_b64 v[48:49], 0
    v_mov_b64 v[50:51], 0
    v_mov_b64 v[52:53], 0
    v_mov_b64 v[54:55], 0
    s_mov_b32 s49, 0
    s_waitcnt vmcnt(0) lgkmcnt(0)
    s_cmp_lg_u32 s101, 32
    s_cbranch_scc1 CH_slow_159
.p2align 6
CH_top_174:
CH_st_176:
    s_waitcnt vmcnt(1)
    v_smfmac_f32_16x16x64_bf16 v[8:11], v[24:27], v[64:71], v2
    ds_write_b128 v40, v[24:27] offset:0
    v_smfmac_f32_16x16x64_bf16 v[12:15], v[24:27], v[72:79], v2
    v_max_u32 v41, v24, v26
    v_smfmac_f32_16x16x64_bf16 v[16:19], v[24:27], v[32:39], v2
    v_smfmac_f32_16x16x64_bf16 v[20:23], v[24:27], v[80:87], v2
    ds_read_b128 v[32:35], v1 offset:6144
    v_smfmac_f32_16x16x64_bf16 v[48:51], v[24:27], v[88:95], v2
    buffer_load_dwordx4 v[56:59], v0, s[36:39], s93 offen sc1
    ds_read_b128 v[36:39], v1 offset:7168
    s_waitcnt vmcnt(1)
    v_max3_u32 v41, v41, v28, v30
    v_smfmac_f32_16x16x64_bf16 v[52:55], v[24:27], v[96:103], v2
    buffer_load_dwordx4 v[60:63], v0, s[36:39], s89 offen sc1
    v_cmp_eq_u32 vcc, -1, v41
    v_smfmac_f32_16x16x64_bf16 v[8:11], v[28:31], v[104:111], v2
    v_smfmac_f32_16x16x64_bf16 v[12:15], v[28:31], v[112:119], v2
    s_cbranch_vccnz CH_re_177
    v_smfmac_f32_16x16x64_bf16 v[16:19], v[28:31], v[120:127], v2
    s_waitcnt lgkmcnt(2)
    s_barrier
    v_smfmac_f32_16x16x64_bf16 v[20:23], v[28:31], v[128:135], v2
    s_waitcnt lgkmcnt(0)
    ds_read_b128 v[24:27], v42 offset:0
    v_smfmac_f32_16x16x64_bf16 v[48:51], v[28:31], v[32:39], v2
    ds_read_b128 v[40:43], v1 offset:8192
    v_smfmac_f32_16x16x64_bf16 v[52:55], v[28:31], v[136:143], v2
    ds_read_b128 v[44:47], v1 offset:9216
    v_add_u32 v28, s14, v0
    s_waitcnt lgkmcnt(2)
    v_smfmac_f32_16x16x64_bf16 v[8:11], v[24:27], v[144:151], v2
    ds_read_b128 v[28:31], v28 offset:0
    v_smfmac_f32_16x16x64_bf16 v[12:15], v[24:27], v[152:159], v2
    ds_read_b128 v[32:35], v1 offset:10240
    v_smfmac_f32_16x16x64_bf16 v[16:19], v[24:27], v[160:167], v2
    s_waitcnt lgkmcnt(2)
    ds_read_b128 v[36:39], v1 offset:11264
    v_smfmac_f32_16x16x64_bf16 v[20:23], v[24:27], v[40:47], v2
    ds_read_b128 v[40:43], v1 offset:12288
    v_smfmac_f32_16x16x64_bf16 v[48:51], v[24:27], v[168:175], v2
    ds_read_b128 v[44:47], v1 offset:13312
    v_smfmac_f32_16x16x64_bf16 v[52:55], v[24:27], v[176:183], v2
    s_waitcnt lgkmcnt(4)
    v_add_u32 v24, s15, v0
    v_smfmac_f32_16x16x64_bf16 v[8:11], v[28:31], v[184:191], v2
    s_waitcnt lgkmcnt(2)
    ds_read_b128 v[24:27], v24 offset:0
    v_smfmac_f32_16x16x64_bf16 v[12:15], v[28:31], v[32:39], v2
    ds_read_b128 v[32:35], v1 offset:14336
    v_smfmac_f32_16x16x64_bf16 v[16:19], v[28:31], v[192:199], v2
    s_waitcnt lgkmcnt(2)
    ds_read_b128 v[36:39], v1 offset:15360
    v_smfmac_f32_16x16x64_bf16 v[20:23], v[28:31], v[40:47], v2
    ds_read_b128 v[40:43], v1 offset:16384
    v_smfmac_f32_16x16x64_bf16 v[48:51], v[28:31], v[200:207], v2
    ds_read_b128 v[44:47], v1 offset:17408
    v_smfmac_f32_16x16x64_bf16 v[52:55], v[28:31], v[208:215], v2
    s_waitcnt lgkmcnt(4)
    v_smfmac_f32_16x16x64_bf16 v[8:11], v[24:27], v[216:223], v2
    v_add_u32 v28, s92, v0
    v_smfmac_f32_16x16x64_bf16 v[12:15], v[24:27], v[224:231], v2
    s_waitcnt vmcnt(1)
    ds_write_b128 v28, v[56:59] offset:4096
    v_max3_u32 v29, v56, v58, s72
    v_smfmac_f32_16x16x64_bf16 v[16:19], v[24:27], v[232:239], v2
    s_waitcnt vmcnt(0)
    v_max3_u32 v29, v29, v60, v62
    v_smfmac_f32_16x16x64_bf16 v[20:23], v[24:27], v[240:247], v2
    s_add_u32 m0, s63, 8192
    v_cmp_eq_u32_e64 vcc, -1, v29
    v_smfmac_f32_16x16x64_bf16 v[48:51], v[24:27], v[248:255], v2
    v_smfmac_f32_16x16x64_bf16 v[52:55], v[24:27], a[0:7], v2
    s_cbranch_vccnz CH_fp_180
CH_re_179:
    v_smfmac_f32_16x16x64_bf16 v[8:11], v[56:59], a[8:15], v2
    s_waitcnt lgkmcnt(0)
    s_barrier
    v_smfmac_f32_16x16x64_bf16 v[12:15], v[56:59], a[16:23], v2
    buffer_load_dwordx4 v0, s[32:35], s42 offen sc1 lds
    v_add_u32 v28, s13, v0
    v_smfmac_f32_16x16x64_bf16 v[16:19], v[56:59], a[24:31], v2
    ds_read_b128 v[28:31], v28 offset:4096
    v_add_u32 v24, s14, v0
    v_smfmac_f32_16x16x64_bf16 v[20:23], v[56:59], a[32:39], v2
    ds_read_b128 v[24:27], v24 offset:4096
    v_smfmac_f32_16x16x64_bf16 v[8:11], v[60:63], a[40:47], v2
    s_xor_b32 m0, m0, 1024
    s_xor_b32 s60, s42, 1024
    v_smfmac_f32_16x16x64_bf16 v[12:15], v[60:63], v[32:39], v2
    buffer_load_dwordx4 v0, s[32:35], s60 offen sc1 lds
    v_cndmask_b32 v38, v3, v1, s[82:83]
    v_smfmac_f32_16x16x64_bf16 v[16:19], v[60:63], a[48:55], v2
    ds_read_b64 v[38:39], v38 offset:2176
    v_add_u32 v32, s15, v0
    v_smfmac_f32_16x16x64_bf16 v[20:23], v[60:63], a[56:63], v2
    s_waitcnt lgkmcnt(2)
    ds_read_b128 v[32:35], v32 offset:4096
    v_smfmac_f32_16x16x64_bf16 v[8:11], v[28:31], v[40:47], v2
    ds_read_b128 v[40:43], v1 offset:18432
    v_lshrrev_b32 v37, 1, v0
    v_smfmac_f32_16x16x64_bf16 v[12:15], v[28:31], a[64:71], v2
    s_waitcnt lgkmcnt(3)
    ds_read_b128 v[44:47], v1 offset:19456
    v_smfmac_f32_16x16x64_bf16 v[8:11], v[24:27], a[72:79], v2
    s_add_u32 m0, s12, 2048
    s_xor_b32 s60, s42, 16384
    v_mov_b32 v36, s84
    v_smfmac_f32_16x16x64_bf16 v[12:15], v[24:27], a[80:87], v2
    s_waitcnt lgkmcnt(2)
    buffer_load_dwordx4 v0, s[32:35], s60 offen sc1 lds
    v_smfmac_f32_16x16x64_bf16 v[8:11], v[32:35], a[88:95], v2
    s_add_u32 s42, s42, 1048576
    s_xor_b32 s42, s42, 8192
    v_permlane16_swap_b32 v38, v39
    v_smfmac_f32_16x16x64_bf16 v[12:15], v[32:35], a[96:103], v2
    s_xor_b32 m0, m0, 1024
    s_xor_b32 s60, s60, 1024
    v_smfmac_f32_16x16x64_bf16 v[16:19], v[28:31], a[104:111], v2
    s_waitcnt lgkmcnt(0)
    buffer_load_dwordx4 v0, s[32:35], s60 offen sc1 lds
    v_add_f32 v8, v8, v10
    v_smfmac_f32_16x16x64_bf16 v[16:19], v[24:27], v[40:47], v2
    ds_read_b128 v[40:43], v0 offset:16384
    v_add_f32 v9, v9, v11
    v_smfmac_f32_16x16x64_bf16 v[16:19], v[32:35], a[112:119], v2
    ds_read_b128 v[44:47], v0 offset:17408
    v_add_f32 v12, v12, v14
    v_smfmac_f32_16x16x64_bf16 v[20:23], v[28:31], a[120:127], v2
    buffer_store_dwordx2 v[38:39], v37, s[32:35], s96 offen sc1
    v_add_f32 v13, v13, v15
    v_smfmac_f32_16x16x64_bf16 v[20:23], v[24:27], a[128:135], v2
    buffer_store_dword v36, off, s[32:35], s18 sc1
    v_cvt_pk_bf16_f32 v8, v8, v9
    v_cvt_pk_bf16_f32 v9, v12, v13
    v_smfmac_f32_16x16x64_bf16 v[20:23], v[32:35], a[136:143], v2
    ds_write_b64 v3, v[8:9] offset:2176
    v_add_f32 v16, v16, v18
    v_add_f32 v17, v17, v19
    v_smfmac_f32_16x16x64_bf16 v[48:51], v[56:59], a[144:151], v2
    v_cvt_pk_bf16_f32 v10, v16, v17
    v_add_f32 v20, v20, v22
    v_add_f32 v21, v21, v23
    v_cvt_pk_bf16_f32 v11, v20, v21
    v_smfmac_f32_16x16x64_bf16 v[52:55], v[56:59], a[152:159], v2
    ds_write_b64 v3, v[10:11] offset:0
    v_smfmac_f32_16x16x64_bf16 v[48:51], v[60:63], a[160:167], v2
    ds_read_b128 v[56:59], v0 offset:18432
    v_smfmac_f32_16x16x64_bf16 v[52:55], v[60:63], a[168:175], v2
    ds_read_b128 v[60:63], v0 offset:19456
    v_smfmac_f32_16x16x64_bf16 v[48:51], v[28:31], a[176:183], v2
    s_waitcnt lgkmcnt(2)
    s_barrier
    v_smfmac_f32_16x16x64_bf16 v[52:55], v[28:31], a[184:191], v2
    ds_read_b64_tr_b16 v[12:13], v4 offset:2176
    ds_read_b64_tr_b16 v[14:15], v4 offset:2208
    v_smfmac_f32_16x16x64_bf16 v[48:51], v[24:27], a[192:199], v2
    ds_read_b64_tr_b16 v[16:17], v4 offset:3264
    ds_read_b64_tr_b16 v[18:19], v4 offset:3296
    v_smfmac_f32_16x16x64_bf16 v[52:55], v[24:27], a[200:207], v2
    ds_read_b64_tr_b16 v[20:21], v4 offset:0
    ds_read_b64_tr_b16 v[22:23], v4 offset:32
    v_smfmac_f32_16x16x64_bf16 v[48:51], v[32:35], a[208:215], v2
    ds_read_b64_tr_b16 v[36:37], v4 offset:1088
    ds_read_b64_tr_b16 v[38:39], v4 offset:1120
    v_smfmac_f32_16x16x64_bf16 v[52:55], v[32:35], a[216:223], v2
    ds_read_b128 v[28:31], v0 offset:21504
    ds_read_b128 v[24:27], v0 offset:20480
    s_waitcnt lgkmcnt(8)
    v_mfma_f32_16x16x32_bf16 v[8:11], v[40:43], v[12:15], 0
    ds_read_b128 v[32:35], v0 offset:22528
    s_waitcnt lgkmcnt(7)
    v_mfma_f32_16x16x32_bf16 v[8:11], v[44:47], v[16:19], v[8:11]
    ds_read_b128 v[44:47], v0 offset:23552
    v_add_f32_e64 v48, v48, v50
    v_mfma_f32_16x16x32_bf16 v[40:43], v[56:59], v[12:15], 0
    v_add_f32 v49, v49, v51
    v_mfma_f32_16x16x32_bf16 v[40:43], v[60:63], v[16:19], v[40:43]
    s_waitcnt lgkmcnt(6)
    v_add_f32_e64 v52, v52, v54
    v_add_f32_dpp v8, v10, v8 quad_perm:[2,3,2,3] row_mask:0xf bank_mask:0xf
    v_mfma_f32_16x16x32_bf16 v[56:59], v[20:23], v[12:15], 0
    s_waitcnt lgkmcnt(4)
    v_add_f32_dpp v9, v11, v9 quad_perm:[2,3,2,3] row_mask:0xf bank_mask:0xf
    v_max_f32 v10, v8, v9
    v_mfma_f32_16x16x32_bf16 v[56:59], v[36:39], v[16:19], v[56:59]
    s_waitcnt lgkmcnt(2)
    v_add_f32 v53, v53, v55
    v_add_f32_dpp v40, v42, v40 quad_perm:[2,3,2,3] row_mask:0xf bank_mask:0xf
    v_mfma_f32_16x16x32_bf16 v[20:23], v[24:27], v[12:15], 0
    v_add_f32_dpp v41, v43, v41 quad_perm:[2,3,2,3] row_mask:0xf bank_mask:0xf
    v_max3_f32 v10, v10, v40, v41
    v_mfma_f32_16x16x32_bf16 v[20:23], v[28:31], v[16:19], v[20:23]
    s_waitcnt lgkmcnt(1)
    v_cvt_pk_bf16_f32 v50, v48, v49
    v_add_f32_dpp v56, v58, v56 quad_perm:[2,3,2,3] row_mask:0xf bank_mask:0xf
    v_mfma_f32_16x16x32_bf16 v[24:27], v[32:35], v[12:15], 0
    s_waitcnt lgkmcnt(0)
    v_add_f32_dpp v57, v59, v57 quad_perm:[2,3,2,3] row_mask:0xf bank_mask:0xf
    v_max3_f32 v10, v10, v56, v57
    v_mfma_f32_16x16x32_bf16 v[24:27], v[44:47], v[16:19], v[24:27]
    ds_read_b128 v[32:35], v1 offset:0
    v_add_f32_dpp v20, v22, v20 quad_perm:[2,3,2,3] row_mask:0xf bank_mask:0xf
    v_add_f32_dpp v21, v23, v21 quad_perm:[2,3,2,3] row_mask:0xf bank_mask:0xf
    v_max3_f32 v10, v10, v20, v21
    v_cvt_pk_bf16_f32 v51, v52, v53
    v_mov_b64 v[60:61], s[22:23]
    v_mov_b64 v[62:63], s[22:23]
    s_nop 0
    v_add_f32_dpp v24, v26, v24 quad_perm:[2,3,2,3] row_mask:0xf bank_mask:0xf
    v_add_f32_dpp v25, v27, v25 quad_perm:[2,3,2,3] row_mask:0xf bank_mask:0xf
    v_max3_f32 v10, v10, v24, v25
    v_mov_b32 v11, v10
    v_mov_b32 v29, 0
    v_mov_b32 v30, 0
    v_permlane32_swap_b32 v10, v11
    v_max_f32 v10, v10, v11
    v_mov_b32 v11, v10
    s_nop 1
    v_permlane16_swap_b32 v10, v11
    v_max_f32 v10, v10, v11
    v_mul_f32_e64 v10, s51, v10
    v_pk_fma_f32 v[56:57], v[56:57], s[16:17], v[10:11] op_sel_hi:[1,1,0] neg_lo:[0,0,1] neg_hi:[0,0,1]
    v_pk_fma_f32 v[8:9], v[8:9], s[16:17], v[10:11] op_sel_hi:[1,1,0] neg_lo:[0,0,1] neg_hi:[0,0,1]
    v_pk_fma_f32 v[40:41], v[40:41], s[16:17], v[10:11] op_sel_hi:[1,1,0] neg_lo:[0,0,1] neg_hi:[0,0,1]
    v_pk_fma_f32 v[20:21], v[20:21], s[16:17], v[10:11] op_sel_hi:[1,1,0] neg_lo:[0,0,1] neg_hi:[0,0,1]
    v_pk_fma_f32 v[24:25], v[24:25], s[16:17], v[10:11] op_sel_hi:[1,1,0] neg_lo:[0,0,1] neg_hi:[0,0,1]
    v_exp_f32_dpp v56, v56 quad_perm:[0,1,0,1] row_mask:0xf bank_mask:0xf
    v_exp_f32_dpp v57, v57 quad_perm:[0,1,0,1] row_mask:0xf bank_mask:0xf
    v_exp_f32_dpp v8, v8 quad_perm:[0,1,0,1] row_mask:0xf bank_mask:0xf
    v_cvt_pk_bf16_f32 v28, v56, v57
    v_cvt_pk_bf16_f32 v31, v56, v57
    v_exp_f32_dpp v9, v9 quad_perm:[0,1,0,1] row_mask:0xf bank_mask:0xf
    v_mfma_f32_16x16x16_bf16 v[36:39], v[60:61], v[28:29], 0
    ds_read_b128 v[44:47], v1 offset:1024
    v_exp_f32_dpp v40, v40 quad_perm:[0,1,0,1] row_mask:0xf bank_mask:0xf
    v_mfma_f32_16x16x16_bf16 v[16:19], v[50:51], v[28:29], 0
    v_exp_f32_dpp v41, v41 quad_perm:[0,1,0,1] row_mask:0xf bank_mask:0xf
    v_mfma_f32_16x16x16_bf16 v[52:55], v[50:51], v[30:31], 0
    v_exp_f32_dpp v20, v20 quad_perm:[0,1,0,1] row_mask:0xf bank_mask:0xf
    v_cvt_pk_bf16_f32 v12, v8, v9
    v_exp_f32_dpp v21, v21 quad_perm:[0,1,0,1] row_mask:0xf bank_mask:0xf
    v_cvt_pk_bf16_f32 v13, v40, v41
    v_exp_f32_dpp v24, v24 quad_perm:[0,1,0,1] row_mask:0xf bank_mask:0xf
    v_exp_f32_dpp v25, v25 quad_perm:[0,1,0,1] row_mask:0xf bank_mask:0xf
    v_cvt_pk_bf16_f32 v14, v20, v21
    v_cvt_pk_bf16_f32 v15, v24, v25
    s_waitcnt lgkmcnt(0)
    s_nop 0
    v_mfma_f32_16x16x32_bf16 v[36:39], v[60:63], v[12:15], v[36:39]
    ds_write_b64 v1, v[50:51] offset:0
    v_mfma_f32_16x16x32_bf16 v[16:19], v[32:35], v[12:15], v[16:19]
    ds_read_b128 v[56:59], v1 offset:20480
    v_mfma_f32_16x16x32_bf16 v[52:55], v[44:47], v[12:15], v[52:55]
    ds_read_b128 v[60:63], v1 offset:21504
    v_rcp_f32 v10, v36
    v_mov_b64_e64 v[12:13], 0
    s_nop 0
    v_pk_mul_f32 v[16:17], v[16:17], v[10:11] op_sel_hi:[1,0]
    v_pk_mul_f32 v[18:19], v[18:19], v[10:11] op_sel_hi:[1,0]
    s_mov_b64 exec, s[86:87]
    s_nop 0
    v_pk_mul_f32 v[16:17], v[52:53], v[10:11] op_sel_hi:[1,0]
    v_pk_mul_f32 v[18:19], v[54:55], v[10:11] op_sel_hi:[1,0]
    s_mov_b64 exec, -1
    v_cvt_pk_bf16_f32 v16, v16, v17
    v_cvt_pk_bf16_f32 v17, v18, v19
    v_mfma_f32_16x16x16_bf16 v[20:23], v[12:13], v[12:13], 0
    ds_write_b64 v5, v[16:17]
    v_mfma_f32_16x16x16_bf16 v[24:27], v[12:13], v[12:13], 0
    ds_read_b128 v[40:43], v1 offset:22528
    v_mfma_f32_16x16x16_bf16 v[28:31], v[12:13], v[12:13], 0
    ds_read_b128 v[44:47], v1 offset:23552
    v_mfma_f32_16x16x16_bf16 v[48:51], v[12:13], v[12:13], 0
    ds_read_b128 v[32:35], v1 offset:24576
    s_waitcnt lgkmcnt(3)
    s_barrier
    v_mfma_f32_16x16x16_bf16 v[8:11], v[12:13], v[12:13], 0
    ds_read_b128 v[16:19], v0 offset:8192
    ds_read_b128 v[52:55], v0 offset:9216
    ds_read_b128 v[36:39], v1 offset:25600
    v_mfma_f32_16x16x16_bf16 v[28:31], v[12:13], v[12:13], 0
    v_lshlrev_b32 v15, 3, v0
    v_mfma_f32_16x16x16_bf16 v[48:51], v[12:13], v[12:13], 0
    v_bfe_u32 v14, v0, 2, 6
    v_and_or_b32 v14, v15, s94, v14
    s_waitcnt lgkmcnt(2)
    v_smfmac_f32_16x16x64_bf16 v[20:23], v[16:19], v[56:63], v2
    ds_read_b128 v[56:59], v1 offset:26624
    s_waitcnt lgkmcnt(2)
    v_smfmac_f32_16x16x64_bf16 v[20:23], v[52:55], v[40:47], v2
    s_waitcnt lgkmcnt(1)
    ds_read_b128 v[60:63], v1 offset:27648
    v_smfmac_f32_16x16x64_bf16 v[24:27], v[16:19], v[32:39], v2
    ds_read_b128 v[40:43], v1 offset:28672
    v_smfmac_f32_16x16x64_bf16 v[24:27], v[52:55], a[224:231], v2
    ds_read_b128 v[44:47], v1 offset:29696
    v_add_f32 v20, v20, v22
    v_smfmac_f32_16x16x64_bf16 v[28:31], v[16:19], a[232:239], v2
    ds_read_b128 v[32:35], v1 offset:30720
    v_add_f32 v21, v21, v23
    v_smfmac_f32_16x16x64_bf16 v[28:31], v[52:55], a[240:247], v2
    ds_read_b128 v[36:39], v1 offset:31744
    v_add_f32 v24, v24, v26
    v_add_f32_e64 v25, v25, v27
    v_cvt_pk_bf16_f32 v20, v20, v24
    v_cvt_pk_bf16_f32 v21, v21, v25
    v_and_or_b32 v20, v20, -2, 1
    v_smfmac_f32_16x16x64_bf16 v[48:51], v[16:19], a[248:255], v2
    s_waitcnt lgkmcnt(4)
    buffer_store_dwordx2 v[20:21], v7, s[28:31], 0 offen
    v_smfmac_f32_16x16x64_bf16 v[48:51], v[52:55], v[56:63], v2
    s_waitcnt lgkmcnt(2)
    v_add_f32_e64 v28, v28, v30
    v_smfmac_f32_16x16x64_bf16 v[8:11], v[16:19], v[40:47], v2
    s_waitcnt lgkmcnt(0)
    v_add_f32 v29, v29, v31
    v_smfmac_f32_16x16x64_bf16 v[8:11], v[52:55], v[32:39], v2
    s_cmp_eq_u32 s21, 3
    v_add_f32 v48, v48, v50
    v_add_f32_e64 v49, v49, v51
    v_cvt_pk_bf16_f32 v28, v28, v48
    v_cvt_pk_bf16_f32 v29, v29, v49
    v_and_or_b32 v28, v28, -2, 1
    buffer_store_dwordx2 v[28:29], v7, s[28:31], s61 offen
    v_pk_add_f32 v[8:9], v[8:9], v[10:11]
    v_cvt_pk_bf16_f32 v8, v8, v9
    v_and_or_b32 v8, v8, -2, 1
    buffer_store_dword v8, v14, s[28:31], s62 offen
    s_cbranch_scc1 CH_h_181
    v_lshrrev_b32 v56, s91, v0
    v_and_b32_e64 v56, 16, v56
    v_lshlrev_b32_e64 v56, v56, s65
    v_cndmask_b32 v40, 0, v56, s[52:53]
    v_cndmask_b32 v41, 0, v56, s[54:55]
    v_cndmask_b32 v42, 0, v56, s[56:57]
    v_cndmask_b32 v43, 0, v56, s[58:59]
    v_mov_b64 v[58:59], -1
    s_mov_b32 s44, s43
    s_add_u32 s43, s43, 0x2000
    s_and_b32 s43, s43, 0x7fff
    s_add_u32 s43, s43, 163840
    s_mov_b32 s49, 0
    s_add_u32 s40, s40, 1
    s_add_u32 s90, s90, 32768
    s_mov_b32 s96, s97
    s_add_u32 s97, s97, 262144
    s_add_u32 s84, s40, s99
    s_sub_u32 s84, s84, 1
    s_cmp_eq_u32 s40, 63
    s_cselect_b32 s42, 1073741824, s42
    s_cmp_lg_u32 s95, 0
    s_cbranch_scc1 CH_nt_185
    s_nop 9
    s_cmp_le_u32 s21, 0
    s_cbranch_scc1 CH_d_187
    s_nop 7
CH_d_187:
    buffer_load_dwordx4 v[32:35], v0, s[28:31], s46 offen offset:0 sc1
    buffer_load_dwordx4 v[36:39], v0, s[28:31], s46 offen offset:1024 sc1
    v_mov_b64 v[8:9], 0
    v_mov_b64 v[10:11], 0
    v_mov_b64 v[12:13], 0
    v_mov_b64 v[14:15], 0
    v_mov_b64 v[48:49], 0
    v_mov_b64 v[50:51], 0
    v_mov_b64 v[52:53], 0
    v_mov_b64 v[54:55], 0
    s_cmp_eq_u32 s21, 2
    s_cselect_b32 s47, 0, 1
    s_nop 15
    s_nop 6
    buffer_load_dwordx4 v[24:27], v0, s[28:31], s46 offen offset:0 sc1
    buffer_load_dwordx4 v[28:31], v0, s[28:31], s46 offen offset:1024 sc1
CH_h_184:
    s_waitcnt vmcnt(3)
    v_mfma_f32_16x16x32_bf16 v[44:47], v[40:43], v[32:35], 0
    s_waitcnt vmcnt(2)
    v_mfma_f32_16x16x32_bf16 v[44:47], v[40:43], v[36:39], v[44:47]
    v_bitop3_b32 v56, v33, v35, v37 bitop3:0x80
    v_bitop3_b32 v57, v32, v34, v36 bitop3:0x80
    v_bitop3_b32 v56, v56, v39, s47 bitop3:0xea
    v_bitop3_b32 v56, v56, v57, v38 bitop3:0x80
    v_and_b32 v56, 1, v56
    v_cmp_ne_u32 vcc, 1, v56
    s_cbranch_vccnz CH_h_183
CH_ok_188:
    v_add_f32_dpp v44, v44, v44 row_ror:8 row_mask:0xf bank_mask:0xf
    v_add_f32_dpp v45, v45, v45 row_ror:8 row_mask:0xf bank_mask:0xf
    v_add_f32_dpp v46, v46, v46 row_ror:8 row_mask:0xf bank_mask:0xf
    v_add_f32_dpp v47, v47, v47 row_ror:8 row_mask:0xf bank_mask:0xf
    v_add_f32_dpp v44, v44, v44 row_ror:4 row_mask:0xf bank_mask:0xf
    v_add_f32_dpp v45, v45, v45 row_ror:4 row_mask:0xf bank_mask:0xf
    v_add_f32_dpp v46, v46, v46 row_ror:4 row_mask:0xf bank_mask:0xf
    v_add_f32_dpp v47, v47, v47 row_ror:4 row_mask:0xf bank_mask:0xf
    v_cvt_pk_bf16_f32 v56, v44, v45
    v_cvt_pk_bf16_f32 v57, v46, v47
    v_min_u32 v56, -2, v56
    buffer_store_dwordx2 v[56:57], v6, s[28:31], s43 offen
CH_x0_186:
    s_barrier
    buffer_store_dwordx2 v[56:57], v6, s[36:39], s50 offen sc1
    buffer_store_dwordx2 v[58:59], v6, s[28:31], s44 offen
    s_add_u32 s50, s50, 32768
    s_waitcnt vmcnt(3)
    v_mov_b64 v[16:17], 0
    v_mov_b64 v[18:19], 0
    v_mov_b64 v[20:21], 0
    v_mov_b64 v[22:23], 0
    ds_read_b128 v[32:35], v1 offset:4096
    ds_read_b128 v[36:39], v1 offset:5120
    v_add_u32 v40, s92, v0
    v_xor_b32 v42, 1024, v40
    s_nop 15
    s_nop 15
    s_nop 15
    s_nop 3
    s_branch CH_h_182
CH_h_181:
    v_mov_b64 v[48:49], 0
    v_mov_b64 v[50:51], 0
    v_mov_b64 v[52:53], 0
    v_mov_b64 v[54:55], 0
    ds_read_b128 v[32:35], v1 offset:4096
    ds_read_b128 v[36:39], v1 offset:5120
    v_add_u32 v40, s92, v0
    v_xor_b32 v42, 1024, v40
    s_mov_b32 s44, s43
    s_add_u32 s43, s43, 0x2000
    s_and_b32 s43, s43, 0x7fff
    s_add_u32 s43, s43, 163840
    s_mov_b32 s49, 0
    s_add_u32 s40, s40, 1
    s_add_u32 s90, s90, 32768
    s_mov_b32 s96, s97
    s_add_u32 s97, s97, 262144
    s_add_u32 s84, s40, s99
    s_sub_u32 s84, s84, 1
    s_cmp_eq_u32 s40, 63
    s_cselect_b32 s42, 1073741824, s42
    s_add_u32 s47, s98, 0
    s_load_dword s72, s[32:33], s47 glc
    s_add_u32 s47, s98, 128
    s_load_dword s73, s[32:33], s47 glc
    s_add_u32 s47, s98, 256
    s_load_dword s74, s[32:33], s47 glc
    s_add_u32 s47, s98, 384
    s_load_dword s75, s[32:33], s47 glc
    v_mfma_f32_32x32x2_f32 v[8:23], v48, v48, 0
    v_mfma_f32_32x32x2_f32 v[8:23], v48, v48, v[8:23]
    v_mfma_f32_32x32x2_f32 v[8:23], v48, v48, v[8:23]
    v_mfma_f32_32x32x2_f32 v[8:23], v48, v48, v[8:23]
    v_mfma_f32_32x32x2_f32 v[8:23], v48, v48, v[8:23]
    v_mfma_f32_32x32x2_f32 v[8:23], v48, v48, v[8:23]
    s_waitcnt vmcnt(0)
    s_barrier
    s_nop 15
    s_nop 15
    s_nop 15
    s_nop 15
    s_nop 9
    s_add_u32 s76, s40, 2
    s_min_u32 s76, s76, 64
    s_add_u32 s76, s76, s99
    s_waitcnt lgkmcnt(0)
    s_min_u32 s72, s72, s73
    s_min_u32 s72, s72, s74
    s_min_u32 s72, s72, s75
    s_cmp_lt_u32 s72, s76
    s_cselect_b32 s72, -1, 0
CH_h_182:
    s_waitcnt lgkmcnt(0)
    s_add_u32 s47, s43, s92
    buffer_load_dwordx4 v[24:27], v0, s[28:31], s47 offen sc1
    s_add_u32 s93, s90, s92
    s_add_u32 s89, s90, 4096
    s_nop 2
    s_add_u32 s47, s43, 4096
    buffer_load_dwordx4 v[28:31], v0, s[28:31], s47 offen sc1
CH_st_189:
    s_waitcnt vmcnt(1)
    v_smfmac_f32_16x16x64_bf16 v[8:11], v[24:27], v[64:71], v2
    ds_write_b128 v40, v[24:27] offset:0
    v_smfmac_f32_16x16x64_bf16 v[12:15], v[24:27], v[72:79], v2
    v_max_u32_e64 v41, v24, v26
    v_smfmac_f32_16x16x64_bf16 v[16:19], v[24:27], v[32:39], v2
    v_smfmac_f32_16x16x64_bf16 v[20:23], v[24:27], v[80:87], v2
    ds_read_b128 v[32:35], v1 offset:6144
    v_smfmac_f32_16x16x64_bf16 v[48:51], v[24:27], v[88:95], v2
    buffer_load_dwordx4 v[56:59], v0, s[36:39], s93 offen sc1
    ds_read_b128 v[36:39], v1 offset:7168
    s_waitcnt vmcnt(1)
    v_max3_u32 v41, v41, v28, v30
    v_smfmac_f32_16x16x64_bf16 v[52:55], v[24:27], v[96:103], v2
    buffer_load_dwordx4 v[60:63], v0, s[36:39], s89 offen sc1
    v_cmp_eq_u32 vcc, -1, v41
    v_smfmac_f32_16x16x64_bf16 v[8:11], v[28:31], v[104:111], v2
    v_smfmac_f32_16x16x64_bf16 v[12:15], v[28:31], v[112:119], v2
    s_cbranch_vccnz CH_re_190
    v_smfmac_f32_16x16x64_bf16 v[16:19], v[28:31], v[120:127], v2
    s_waitcnt lgkmcnt(2)
    s_barrier
    v_smfmac_f32_16x16x64_bf16 v[20:23], v[28:31], v[128:135], v2
    s_waitcnt lgkmcnt(0)
    ds_read_b128 v[24:27], v42 offset:0
    v_smfmac_f32_16x16x64_bf16 v[48:51], v[28:31], v[32:39], v2
    ds_read_b128 v[40:43], v1 offset:8192
    v_smfmac_f32_16x16x64_bf16 v[52:55], v[28:31], v[136:143], v2
    ds_read_b128 v[44:47], v1 offset:9216
    v_add_u32 v28, s14, v0
    s_waitcnt lgkmcnt(2)
    v_smfmac_f32_16x16x64_bf16 v[8:11], v[24:27], v[144:151], v2
    ds_read_b128 v[28:31], v28 offset:0
    v_smfmac_f32_16x16x64_bf16 v[12:15], v[24:27], v[152:159], v2
    ds_read_b128 v[32:35], v1 offset:10240
    v_smfmac_f32_16x16x64_bf16 v[16:19], v[24:27], v[160:167], v2
    s_waitcnt lgkmcnt(2)
    ds_read_b128 v[36:39], v1 offset:11264
    v_smfmac_f32_16x16x64_bf16 v[20:23], v[24:27], v[40:47], v2
    ds_read_b128 v[40:43], v1 offset:12288
    v_smfmac_f32_16x16x64_bf16 v[48:51], v[24:27], v[168:175], v2
    ds_read_b128 v[44:47], v1 offset:13312
    v_smfmac_f32_16x16x64_bf16 v[52:55], v[24:27], v[176:183], v2
    s_waitcnt lgkmcnt(4)
    v_add_u32_e64 v24, s15, v0
    v_smfmac_f32_16x16x64_bf16 v[8:11], v[28:31], v[184:191], v2
    s_waitcnt lgkmcnt(2)
    ds_read_b128 v[24:27], v24 offset:0
    v_smfmac_f32_16x16x64_bf16 v[12:15], v[28:31], v[32:39], v2
    ds_read_b128 v[32:35], v1 offset:14336
    v_smfmac_f32_16x16x64_bf16 v[16:19], v[28:31], v[192:199], v2
    s_waitcnt lgkmcnt(2)
    ds_read_b128 v[36:39], v1 offset:15360
    v_smfmac_f32_16x16x64_bf16 v[20:23], v[28:31], v[40:47], v2
    ds_read_b128 v[40:43], v1 offset:16384
    v_smfmac_f32_16x16x64_bf16 v[48:51], v[28:31], v[200:207], v2
    ds_read_b128 v[44:47], v1 offset:17408
    v_smfmac_f32_16x16x64_bf16 v[52:55], v[28:31], v[208:215], v2
    s_waitcnt lgkmcnt(4)
    v_smfmac_f32_16x16x64_bf16 v[8:11], v[24:27], v[216:223], v2
    v_add_u32_e64 v28, s92, v0
    v_smfmac_f32_16x16x64_bf16 v[12:15], v[24:27], v[224:231], v2
    s_waitcnt vmcnt(1)
    ds_write_b128 v28, v[56:59] offset:4096
    v_max3_u32 v29, v56, v58, s72
    v_smfmac_f32_16x16x64_bf16 v[16:19], v[24:27], v[232:239], v2
    s_waitcnt vmcnt(0)
    v_max3_u32 v29, v29, v60, v62
    v_smfmac_f32_16x16x64_bf16 v[20:23], v[24:27], v[240:247], v2
    s_add_u32 m0, s63, 0
    v_cmp_eq_u32_e64 vcc, -1, v29
    v_smfmac_f32_16x16x64_bf16 v[48:51], v[24:27], v[248:255], v2
    v_smfmac_f32_16x16x64_bf16 v[52:55], v[24:27], a[0:7], v2
    s_cbranch_vccnz CH_fp_193
CH_re_192:
    v_smfmac_f32_16x16x64_bf16 v[8:11], v[56:59], a[8:15], v2
    s_waitcnt lgkmcnt(0)
    s_barrier
    v_smfmac_f32_16x16x64_bf16 v[12:15], v[56:59], a[16:23], v2
    buffer_load_dwordx4 v0, s[32:35], s42 offen sc1 lds
    v_add_u32 v28, s13, v0
    v_smfmac_f32_16x16x64_bf16 v[16:19], v[56:59], a[24:31], v2
    ds_read_b128 v[28:31], v28 offset:4096
    v_add_u32_e64 v24, s14, v0
    v_smfmac_f32_16x16x64_bf16 v[20:23], v[56:59], a[32:39], v2
    ds_read_b128 v[24:27], v24 offset:4096
    v_smfmac_f32_16x16x64_bf16 v[8:11], v[60:63], a[40:47], v2
    s_xor_b32 m0, m0, 1024
    s_xor_b32 s60, s42, 1024
    v_smfmac_f32_16x16x64_bf16 v[12:15], v[60:63], v[32:39], v2
    buffer_load_dwordx4 v0, s[32:35], s60 offen sc1 lds
    v_cndmask_b32 v38, v3, v1, s[82:83]
    v_smfmac_f32_16x16x64_bf16 v[16:19], v[60:63], a[48:55], v2
    ds_read_b64 v[38:39], v38 offset:0
    v_add_u32_e64 v32, s15, v0
    v_smfmac_f32_16x16x64_bf16 v[20:23], v[60:63], a[56:63], v2
    s_waitcnt lgkmcnt(2)
    ds_read_b128 v[32:35], v32 offset:4096
    v_smfmac_f32_16x16x64_bf16 v[8:11], v[28:31], v[40:47], v2
    ds_read_b128 v[40:43], v1 offset:18432
    v_lshrrev_b32_e64 v37, 1, v0
    v_smfmac_f32_16x16x64_bf16 v[12:15], v[28:31], a[64:71], v2
    s_waitcnt lgkmcnt(3)
    ds_read_b128 v[44:47], v1 offset:19456
    v_smfmac_f32_16x16x64_bf16 v[8:11], v[24:27], a[72:79], v2
    s_add_u32 m0, s12, 0
    s_xor_b32 s60, s42, 16384
    v_mov_b32 v36, s84
    v_smfmac_f32_16x16x64_bf16 v[12:15], v[24:27], a[80:87], v2
    s_waitcnt lgkmcnt(2)
    buffer_load_dwordx4 v0, s[32:35], s60 offen sc1 lds
    v_smfmac_f32_16x16x64_bf16 v[8:11], v[32:35], a[88:95], v2
    s_add_u32 s42, s42, 1048576
    v_permlane16_swap_b32 v38, v39
    v_smfmac_f32_16x16x64_bf16 v[12:15], v[32:35], a[96:103], v2
    s_xor_b32 m0, m0, 1024
    s_xor_b32 s60, s60, 1024
    v_smfmac_f32_16x16x64_bf16 v[16:19], v[28:31], a[104:111], v2
    s_waitcnt lgkmcnt(0)
    buffer_load_dwordx4 v0, s[32:35], s60 offen sc1 lds
    v_add_f32 v8, v8, v10
    v_smfmac_f32_16x16x64_bf16 v[16:19], v[24:27], v[40:47], v2
    ds_read_b128 v[40:43], v0 offset:24576
    v_add_f32 v9, v9, v11
    v_smfmac_f32_16x16x64_bf16 v[16:19], v[32:35], a[112:119], v2
    ds_read_b128 v[44:47], v0 offset:25600
    v_add_f32 v12, v12, v14
    v_smfmac_f32_16x16x64_bf16 v[20:23], v[28:31], a[120:127], v2
    buffer_store_dwordx2 v[38:39], v37, s[32:35], s96 offen sc1
    v_add_f32_e64 v13, v13, v15
    v_smfmac_f32_16x16x64_bf16 v[20:23], v[24:27], a[128:135], v2
    buffer_store_dword v36, off, s[32:35], s18 sc1
    v_cvt_pk_bf16_f32 v8, v8, v9
    v_cvt_pk_bf16_f32 v9, v12, v13
    v_smfmac_f32_16x16x64_bf16 v[20:23], v[32:35], a[136:143], v2
    ds_write_b64 v3, v[8:9] offset:0
    v_add_f32 v16, v16, v18
    v_add_f32 v17, v17, v19
    v_smfmac_f32_16x16x64_bf16 v[48:51], v[56:59], a[144:151], v2
    v_cvt_pk_bf16_f32 v10, v16, v17
    v_add_f32 v20, v20, v22
    v_add_f32 v21, v21, v23
    v_cvt_pk_bf16_f32 v11, v20, v21
    v_smfmac_f32_16x16x64_bf16 v[52:55], v[56:59], a[152:159], v2
    ds_write_b64 v3, v[10:11] offset:2176
    v_smfmac_f32_16x16x64_bf16 v[48:51], v[60:63], a[160:167], v2
    ds_read_b128 v[56:59], v0 offset:26624
    v_smfmac_f32_16x16x64_bf16 v[52:55], v[60:63], a[168:175], v2
    ds_read_b128 v[60:63], v0 offset:27648
    v_smfmac_f32_16x16x64_bf16 v[48:51], v[28:31], a[176:183], v2
    s_waitcnt lgkmcnt(2)
    s_barrier
    v_smfmac_f32_16x16x64_bf16 v[52:55], v[28:31], a[184:191], v2
    ds_read_b64_tr_b16 v[12:13], v4 offset:0
    ds_read_b64_tr_b16 v[14:15], v4 offset:32
    v_smfmac_f32_16x16x64_bf16 v[48:51], v[24:27], a[192:199], v2
    ds_read_b64_tr_b16 v[16:17], v4 offset:1088
    ds_read_b64_tr_b16 v[18:19], v4 offset:1120
    v_smfmac_f32_16x16x64_bf16 v[52:55], v[24:27], a[200:207], v2
    ds_read_b64_tr_b16 v[20:21], v4 offset:2176
    ds_read_b64_tr_b16 v[22:23], v4 offset:2208
    v_smfmac_f32_16x16x64_bf16 v[48:51], v[32:35], a[208:215], v2
    ds_read_b64_tr_b16 v[36:37], v4 offset:3264
    ds_read_b64_tr_b16 v[38:39], v4 offset:3296
    v_smfmac_f32_16x16x64_bf16 v[52:55], v[32:35], a[216:223], v2
    ds_read_b128 v[28:31], v0 offset:29696
    ds_read_b128 v[24:27], v0 offset:28672
    s_waitcnt lgkmcnt(8)
    v_mfma_f32_16x16x32_bf16 v[8:11], v[40:43], v[12:15], 0
    ds_read_b128 v[32:35], v0 offset:30720
    s_waitcnt lgkmcnt(7)
    v_mfma_f32_16x16x32_bf16 v[8:11], v[44:47], v[16:19], v[8:11]
    ds_read_b128 v[44:47], v0 offset:31744
    v_add_f32 v48, v48, v50
    v_mfma_f32_16x16x32_bf16 v[40:43], v[56:59], v[12:15], 0
    v_add_f32 v49, v49, v51
    v_mfma_f32_16x16x32_bf16 v[40:43], v[60:63], v[16:19], v[40:43]
    s_waitcnt lgkmcnt(6)
    v_add_f32_e64 v52, v52, v54
    v_add_f32_dpp v8, v10, v8 quad_perm:[2,3,2,3] row_mask:0xf bank_mask:0xf
    v_mfma_f32_16x16x32_bf16 v[56:59], v[20:23], v[12:15], 0
    s_waitcnt lgkmcnt(4)
    v_add_f32_dpp v9, v11, v9 quad_perm:[2,3,2,3] row_mask:0xf bank_mask:0xf
    v_max_f32 v10, v8, v9
    v_mfma_f32_16x16x32_bf16 v[56:59], v[36:39], v[16:19], v[56:59]
    s_waitcnt lgkmcnt(2)
    v_add_f32_e64 v53, v53, v55
    v_add_f32_dpp v40, v42, v40 quad_perm:[2,3,2,3] row_mask:0xf bank_mask:0xf
    v_mfma_f32_16x16x32_bf16 v[20:23], v[24:27], v[12:15], 0
    v_add_f32_dpp v41, v43, v41 quad_perm:[2,3,2,3] row_mask:0xf bank_mask:0xf
    v_max3_f32 v10, v10, v40, v41
    v_mfma_f32_16x16x32_bf16 v[20:23], v[28:31], v[16:19], v[20:23]
    s_waitcnt lgkmcnt(1)
    v_cvt_pk_bf16_f32 v50, v48, v49
    v_add_f32_dpp v56, v58, v56 quad_perm:[2,3,2,3] row_mask:0xf bank_mask:0xf
    v_mfma_f32_16x16x32_bf16 v[24:27], v[32:35], v[12:15], 0
    s_waitcnt lgkmcnt(0)
    v_add_f32_dpp v57, v59, v57 quad_perm:[2,3,2,3] row_mask:0xf bank_mask:0xf
    v_max3_f32 v10, v10, v56, v57
    v_mfma_f32_16x16x32_bf16 v[24:27], v[44:47], v[16:19], v[24:27]
    ds_read_b128 v[32:35], v1 offset:2048
    v_add_f32_dpp v20, v22, v20 quad_perm:[2,3,2,3] row_mask:0xf bank_mask:0xf
    v_add_f32_dpp v21, v23, v21 quad_perm:[2,3,2,3] row_mask:0xf bank_mask:0xf
    v_max3_f32 v10, v10, v20, v21
    v_cvt_pk_bf16_f32 v51, v52, v53
    v_mov_b64 v[60:61], s[22:23]
    v_mov_b64_e64 v[62:63], s[22:23]
    s_nop 0
    v_add_f32_dpp v24, v26, v24 quad_perm:[2,3,2,3] row_mask:0xf bank_mask:0xf
    v_add_f32_dpp v25, v27, v25 quad_perm:[2,3,2,3] row_mask:0xf bank_mask:0xf
    v_max3_f32 v10, v10, v24, v25
    v_mov_b32 v11, v10
    v_mov_b32 v29, 0
    v_mov_b32 v30, 0
    v_permlane32_swap_b32 v10, v11
    v_max_f32 v10, v10, v11
    v_mov_b32 v11, v10
    s_cmp_eq_u32 s40, 63
    s_cbranch_scc1 CH_exit_175
    v_permlane16_swap_b32 v10, v11
    v_max_f32 v10, v10, v11
    v_mul_f32_e64 v10, s51, v10
    v_pk_fma_f32 v[56:57], v[56:57], s[16:17], v[10:11] op_sel_hi:[1,1,0] neg_lo:[0,0,1] neg_hi:[0,0,1]
    v_pk_fma_f32 v[8:9], v[8:9], s[16:17], v[10:11] op_sel_hi:[1,1,0] neg_lo:[0,0,1] neg_hi:[0,0,1]
    v_pk_fma_f32 v[40:41], v[40:41], s[16:17], v[10:11] op_sel_hi:[1,1,0] neg_lo:[0,0,1] neg_hi:[0,0,1]
    v_pk_fma_f32 v[20:21], v[20:21], s[16:17], v[10:11] op_sel_hi:[1,1,0] neg_lo:[0,0,1] neg_hi:[0,0,1]
    v_pk_fma_f32 v[24:25], v[24:25], s[16:17], v[10:11] op_sel_hi:[1,1,0] neg_lo:[0,0,1] neg_hi:[0,0,1]
    v_exp_f32_dpp v56, v56 quad_perm:[0,1,0,1] row_mask:0xf bank_mask:0xf
    v_exp_f32_dpp v57, v57 quad_perm:[0,1,0,1] row_mask:0xf bank_mask:0xf
    v_exp_f32_dpp v8, v8 quad_perm:[0,1,0,1] row_mask:0xf bank_mask:0xf
    v_cvt_pk_bf16_f32 v28, v56, v57
    v_cvt_pk_bf16_f32 v31, v56, v57
    v_exp_f32_dpp v9, v9 quad_perm:[0,1,0,1] row_mask:0xf bank_mask:0xf
    v_mfma_f32_16x16x16_bf16 v[36:39], v[60:61], v[28:29], 0
    ds_read_b128 v[44:47], v1 offset:3072
    v_exp_f32_dpp v40, v40 quad_perm:[0,1,0,1] row_mask:0xf bank_mask:0xf
    v_mfma_f32_16x16x16_bf16 v[16:19], v[50:51], v[28:29], 0
    v_exp_f32_dpp v41, v41 quad_perm:[0,1,0,1] row_mask:0xf bank_mask:0xf
    v_mfma_f32_16x16x16_bf16 v[52:55], v[50:51], v[30:31], 0
    v_exp_f32_dpp v20, v20 quad_perm:[0,1,0,1] row_mask:0xf bank_mask:0xf
    v_cvt_pk_bf16_f32 v12, v8, v9
    v_exp_f32_dpp v21, v21 quad_perm:[0,1,0,1] row_mask:0xf bank_mask:0xf
    v_cvt_pk_bf16_f32 v13, v40, v41
    v_exp_f32_dpp v24, v24 quad_perm:[0,1,0,1] row_mask:0xf bank_mask:0xf
    v_exp_f32_dpp v25, v25 quad_perm:[0,1,0,1] row_mask:0xf bank_mask:0xf
    v_cvt_pk_bf16_f32 v14, v20, v21
    v_cvt_pk_bf16_f32 v15, v24, v25
    s_waitcnt lgkmcnt(0)
    s_nop 0
    v_mfma_f32_16x16x32_bf16 v[36:39], v[60:63], v[12:15], v[36:39]
    ds_write_b64 v1, v[50:51] offset:2176
    v_mfma_f32_16x16x32_bf16 v[16:19], v[32:35], v[12:15], v[16:19]
    ds_read_b128 v[56:59], v1 offset:20480
    v_mfma_f32_16x16x32_bf16 v[52:55], v[44:47], v[12:15], v[52:55]
    ds_read_b128 v[60:63], v1 offset:21504
    v_rcp_f32 v10, v36
    v_mov_b64 v[12:13], 0
    s_nop 0
    v_pk_mul_f32 v[16:17], v[16:17], v[10:11] op_sel_hi:[1,0]
    v_pk_mul_f32 v[18:19], v[18:19], v[10:11] op_sel_hi:[1,0]
    s_mov_b64 exec, s[86:87]
    s_nop 0
    v_pk_mul_f32 v[16:17], v[52:53], v[10:11] op_sel_hi:[1,0]
    v_pk_mul_f32 v[18:19], v[54:55], v[10:11] op_sel_hi:[1,0]
    s_mov_b64 exec, -1
    v_cvt_pk_bf16_f32 v16, v16, v17
    v_cvt_pk_bf16_f32 v17, v18, v19
    v_mfma_f32_16x16x16_bf16 v[20:23], v[12:13], v[12:13], 0
    ds_write_b64 v5, v[16:17]
    v_mfma_f32_16x16x16_bf16 v[24:27], v[12:13], v[12:13], 0
    ds_read_b128 v[40:43], v1 offset:22528
    v_mfma_f32_16x16x16_bf16 v[28:31], v[12:13], v[12:13], 0
    ds_read_b128 v[44:47], v1 offset:23552
    v_mfma_f32_16x16x16_bf16 v[48:51], v[12:13], v[12:13], 0
    ds_read_b128 v[32:35], v1 offset:24576
    s_waitcnt lgkmcnt(3)
    s_barrier
    v_mfma_f32_16x16x16_bf16 v[8:11], v[12:13], v[12:13], 0
    ds_read_b128 v[16:19], v0 offset:8192
    ds_read_b128 v[52:55], v0 offset:9216
    ds_read_b128 v[36:39], v1 offset:25600
    v_mfma_f32_16x16x16_bf16 v[28:31], v[12:13], v[12:13], 0
    v_lshlrev_b32_e64 v15, 3, v0
    v_mfma_f32_16x16x16_bf16 v[48:51], v[12:13], v[12:13], 0
    v_bfe_u32 v14, v0, 2, 6
    v_and_or_b32 v14, v15, s94, v14
    s_waitcnt lgkmcnt(2)
    v_smfmac_f32_16x16x64_bf16 v[20:23], v[16:19], v[56:63], v2
    ds_read_b128 v[56:59], v1 offset:26624
    s_waitcnt lgkmcnt(2)
    v_smfmac_f32_16x16x64_bf16 v[20:23], v[52:55], v[40:47], v2
    s_waitcnt lgkmcnt(1)
    ds_read_b128 v[60:63], v1 offset:27648
    v_smfmac_f32_16x16x64_bf16 v[24:27], v[16:19], v[32:39], v2
    ds_read_b128 v[40:43], v1 offset:28672
    v_smfmac_f32_16x16x64_bf16 v[24:27], v[52:55], a[224:231], v2
    ds_read_b128 v[44:47], v1 offset:29696
    v_add_f32 v20, v20, v22
    v_smfmac_f32_16x16x64_bf16 v[28:31], v[16:19], a[232:239], v2
    ds_read_b128 v[32:35], v1 offset:30720
    v_add_f32_e64 v21, v21, v23
    v_smfmac_f32_16x16x64_bf16 v[28:31], v[52:55], a[240:247], v2
    ds_read_b128 v[36:39], v1 offset:31744
    v_add_f32 v24, v24, v26
    v_add_f32 v25, v25, v27
    v_cvt_pk_bf16_f32 v20, v20, v24
    v_cvt_pk_bf16_f32 v21, v21, v25
    v_and_or_b32 v20, v20, -2, 0
    v_smfmac_f32_16x16x64_bf16 v[48:51], v[16:19], a[248:255], v2
    s_waitcnt lgkmcnt(4)
    buffer_store_dwordx2 v[20:21], v7, s[28:31], 0 offen
    v_smfmac_f32_16x16x64_bf16 v[48:51], v[52:55], v[56:63], v2
    s_waitcnt lgkmcnt(2)
    v_add_f32 v28, v28, v30
    v_smfmac_f32_16x16x64_bf16 v[8:11], v[16:19], v[40:47], v2
    s_waitcnt lgkmcnt(0)
    v_add_f32 v29, v29, v31
    v_smfmac_f32_16x16x64_bf16 v[8:11], v[52:55], v[32:39], v2
    s_cmp_eq_u32 s21, 3
    v_add_f32 v48, v48, v50
    v_add_f32 v49, v49, v51
    v_cvt_pk_bf16_f32 v28, v28, v48
    v_cvt_pk_bf16_f32 v29, v29, v49
    v_and_or_b32 v28, v28, -2, 0
    buffer_store_dwordx2 v[28:29], v7, s[28:31], s61 offen
    v_pk_add_f32 v[8:9], v[8:9], v[10:11]
    v_cvt_pk_bf16_f32 v8, v8, v9
    v_and_or_b32 v8, v8, -2, 0
    buffer_store_dword v8, v14, s[28:31], s62 offen
    s_cbranch_scc1 CH_h_194
    v_lshrrev_b32 v56, s91, v0
    v_and_b32_e64 v56, 16, v56
    v_lshlrev_b32_e64 v56, v56, s65
    v_cndmask_b32 v40, 0, v56, s[52:53]
    v_cndmask_b32 v41, 0, v56, s[54:55]
    v_cndmask_b32 v42, 0, v56, s[56:57]
    v_cndmask_b32 v43, 0, v56, s[58:59]
    v_mov_b64 v[58:59], -1
    s_mov_b32 s44, s43
    s_add_u32 s43, s43, 0x2000
    s_and_b32 s43, s43, 0x7fff
    s_add_u32 s43, s43, 163840
    s_mov_b32 s49, 0
    s_add_u32 s40, s40, 1
    s_add_u32 s90, s90, 32768
    s_mov_b32 s96, s97
    s_add_u32 s97, s97, 262144
    s_and_b32 s48, s40, 7
    s_cselect_b32 s48, 0, 8192
    s_xor_b32 s97, s97, s48
    s_add_u32 s84, s40, s99
    s_sub_u32 s84, s84, 1
    s_cmp_lg_u32 s95, 0
    s_cbranch_scc1 CH_nt_198
    s_nop 9
    s_cmp_le_u32 s21, 0
    s_cbranch_scc1 CH_d_200
    s_nop 7
CH_d_200:
    buffer_load_dwordx4 v[32:35], v0, s[28:31], s46 offen offset:0 sc1
    buffer_load_dwordx4 v[36:39], v0, s[28:31], s46 offen offset:1024 sc1
    v_mov_b64 v[8:9], 0
    v_mov_b64 v[10:11], 0
    v_mov_b64 v[12:13], 0
    v_mov_b64 v[14:15], 0
    v_mov_b64 v[48:49], 0
    v_mov_b64 v[50:51], 0
    v_mov_b64 v[52:53], 0
    v_mov_b64_e64 v[54:55], 0
    s_cmp_eq_u32 s21, 2
    s_cselect_b32 s47, 1, 0
    s_nop 15
    s_nop 6
    buffer_load_dwordx4 v[24:27], v0, s[28:31], s46 offen offset:0 sc1
    buffer_load_dwordx4 v[28:31], v0, s[28:31], s46 offen offset:1024 sc1
CH_h_197:
    s_waitcnt vmcnt(3)
    v_mfma_f32_16x16x32_bf16 v[44:47], v[40:43], v[32:35], 0
    s_waitcnt vmcnt(2)
    v_mfma_f32_16x16x32_bf16 v[44:47], v[40:43], v[36:39], v[44:47]
    v_bitop3_b32 v56, v33, v35, v37 bitop3:0xfe
    v_bitop3_b32 v57, v32, v34, v36 bitop3:0xfe
    v_bitop3_b32 v56, v56, v39, s47 bitop3:0xa8
    v_bitop3_b32 v56, v56, v57, v38 bitop3:0xfe
    v_and_b32 v56, 1, v56
    v_cmp_ne_u32_e64 vcc, 0, v56
    s_cbranch_vccnz CH_h_196
CH_ok_201:
    v_add_f32_dpp v44, v44, v44 row_ror:8 row_mask:0xf bank_mask:0xf
    v_add_f32_dpp v45, v45, v45 row_ror:8 row_mask:0xf bank_mask:0xf
    v_add_f32_dpp v46, v46, v46 row_ror:8 row_mask:0xf bank_mask:0xf
    v_add_f32_dpp v47, v47, v47 row_ror:8 row_mask:0xf bank_mask:0xf
    v_add_f32_dpp v44, v44, v44 row_ror:4 row_mask:0xf bank_mask:0xf
    v_add_f32_dpp v45, v45, v45 row_ror:4 row_mask:0xf bank_mask:0xf
    v_add_f32_dpp v46, v46, v46 row_ror:4 row_mask:0xf bank_mask:0xf
    v_add_f32_dpp v47, v47, v47 row_ror:4 row_mask:0xf bank_mask:0xf
    v_cvt_pk_bf16_f32 v56, v44, v45
    v_cvt_pk_bf16_f32 v57, v46, v47
    v_min_u32 v56, -2, v56
    buffer_store_dwordx2 v[56:57], v6, s[28:31], s43 offen
CH_x0_199:
    s_barrier
    buffer_store_dwordx2 v[56:57], v6, s[36:39], s50 offen sc1
    buffer_store_dwordx2 v[58:59], v6, s[28:31], s44 offen
    s_add_u32 s50, s50, 32768
    s_waitcnt vmcnt(3)
    v_mov_b64 v[16:17], 0
    v_mov_b64 v[18:19], 0
    v_mov_b64 v[20:21], 0
    v_mov_b64 v[22:23], 0
    ds_read_b128 v[32:35], v1 offset:4096
    ds_read_b128 v[36:39], v1 offset:5120
    v_add_u32 v40, s92, v0
    v_xor_b32 v42, 1024, v40
    s_nop 15
    s_nop 15
    s_nop 15
    s_nop 3
    s_branch CH_h_195
CH_h_194:
    v_mov_b64 v[48:49], 0
    v_mov_b64 v[50:51], 0
    v_mov_b64 v[52:53], 0
    v_mov_b64 v[54:55], 0
    ds_read_b128 v[32:35], v1 offset:4096
    ds_read_b128 v[36:39], v1 offset:5120
    v_add_u32 v40, s92, v0
    v_xor_b32 v42, 1024, v40
    s_mov_b32 s44, s43
    s_add_u32 s43, s43, 0x2000
    s_and_b32 s43, s43, 0x7fff
    s_add_u32 s43, s43, 163840
    s_mov_b32 s49, 0
    s_add_u32 s40, s40, 1
    s_add_u32 s90, s90, 32768
    s_mov_b32 s96, s97
    s_add_u32 s97, s97, 262144
    s_and_b32 s48, s40, 7
    s_cselect_b32 s48, 0, 8192
    s_xor_b32 s97, s97, s48
    s_add_u32 s84, s40, s99
    s_sub_u32 s84, s84, 1
    s_add_u32 s47, s98, 0
    s_load_dword s72, s[32:33], s47 glc
    s_add_u32 s47, s98, 128
    s_load_dword s73, s[32:33], s47 glc
    s_add_u32 s47, s98, 256
    s_load_dword s74, s[32:33], s47 glc
    s_add_u32 s47, s98, 384
    s_load_dword s75, s[32:33], s47 glc
    v_mfma_f32_32x32x2_f32 v[8:23], v48, v48, 0
    v_mfma_f32_32x32x2_f32 v[8:23], v48, v48, v[8:23]
    v_mfma_f32_32x32x2_f32 v[8:23], v48, v48, v[8:23]
    v_mfma_f32_32x32x2_f32 v[8:23], v48, v48, v[8:23]
    v_mfma_f32_32x32x2_f32 v[8:23], v48, v48, v[8:23]
    v_mfma_f32_32x32x2_f32 v[8:23], v48, v48, v[8:23]
    s_waitcnt vmcnt(0)
    s_barrier
    s_nop 15
    s_nop 15
    s_nop 15
    s_nop 15
    s_nop 9
    s_add_u32 s76, s40, 2
    s_min_u32 s76, s76, 64
    s_add_u32 s76, s76, s99
    s_waitcnt lgkmcnt(0)
    s_min_u32 s72, s72, s73
    s_min_u32 s72, s72, s74
    s_min_u32 s72, s72, s75
    s_cmp_lt_u32 s72, s76
    s_cselect_b32 s72, -1, 0
CH_h_195:
    s_waitcnt lgkmcnt(0)
    s_add_u32 s47, s43, s92
    buffer_load_dwordx4 v[24:27], v0, s[28:31], s47 offen sc1
    s_add_u32 s93, s90, s92
    s_add_u32 s89, s90, 4096
    s_nop 2
    s_add_u32 s47, s43, 4096
    buffer_load_dwordx4 v[28:31], v0, s[28:31], s47 offen sc1
    s_branch CH_top_174
CH_re_177:
    s_add_u32 s47, s43, s92
    buffer_load_dwordx4 v[24:27], v0, s[28:31], s47 offen sc1
    s_add_u32 s47, s43, 4096
    buffer_load_dwordx4 v[28:31], v0, s[28:31], s47 offen sc1
    s_add_u32 s49, s49, 1
    s_cmp_gt_u32 s49, 400000
    s_cbranch_scc1 L_end
    s_waitcnt vmcnt(0) lgkmcnt(0)
    v_max_u32 v41, v24, v26
    v_max3_u32 v41, v41, v28, v30
    v_cmp_eq_u32 vcc, -1, v41
    s_cbranch_vccnz CH_re_177
    ds_read_b128 v[32:35], v1 offset:4096
    ds_read_b128 v[36:39], v1 offset:5120
    v_mov_b64 v[8:9], 0
    v_mov_b64 v[10:11], 0
    v_mov_b64 v[12:13], 0
    v_mov_b64 v[14:15], 0
    v_mov_b64 v[16:17], 0
    v_mov_b64 v[18:19], 0
    v_mov_b64 v[20:21], 0
    v_mov_b64 v[22:23], 0
    v_mov_b64 v[48:49], 0
    v_mov_b64 v[50:51], 0
    v_mov_b64 v[52:53], 0
    v_mov_b64 v[54:55], 0
    s_waitcnt lgkmcnt(0)
    s_branch CH_st_176
CH_fp_180:
    s_cmp_eq_u32 s72, 0
    s_cbranch_scc1 CH_re_178
    v_and_b32 v56, 0x180, v0
    buffer_load_dword v57, v56, s[32:35], s98 offen sc1
    s_add_u32 s49, s49, 1
    s_cmp_gt_u32 s49, 400000
    s_cbranch_scc1 L_end
    s_waitcnt vmcnt(0)
    v_cmp_gt_u32 vcc, s76, v57
    s_cbranch_vccnz CH_fp_180
CH_re_178:
    s_add_u32 s47, s90, s92
    buffer_load_dwordx4 v[56:59], v0, s[36:39], s47 offen sc1
    s_add_u32 s47, s90, 4096
    buffer_load_dwordx4 v[60:63], v0, s[36:39], s47 offen sc1
    s_add_u32 s49, s49, 1
    s_cmp_gt_u32 s49, 400000
    s_cbranch_scc1 L_end
    s_waitcnt vmcnt(0)
    v_max_u32 v29, v56, v58
    v_max3_u32 v29, v29, v60, v62
    v_cmp_eq_u32 vcc, -1, v29
    s_cbranch_vccnz CH_re_178
    ds_write_b128 v28, v[56:59] offset:4096
    s_waitcnt lgkmcnt(0)
    s_branch CH_re_179
CH_nt_185:
    v_mov_b64 v[8:9], 0
    v_mov_b64 v[10:11], 0
    v_mov_b64 v[12:13], 0
    v_mov_b64 v[14:15], 0
    v_mov_b64 v[16:17], 0
    v_mov_b64 v[18:19], 0
    v_mov_b64 v[20:21], 0
    v_mov_b64 v[22:23], 0
    v_mov_b64 v[48:49], 0
    v_mov_b64 v[50:51], 0
    v_mov_b64 v[52:53], 0
    v_mov_b64 v[54:55], 0
    s_waitcnt vmcnt(0)
    s_branch CH_x0_186
CH_h_183:
    buffer_load_dwordx4 v[32:35], v0, s[28:31], s46 offen offset:0 sc1
    buffer_load_dwordx4 v[36:39], v0, s[28:31], s46 offen offset:1024 sc1
    s_waitcnt vmcnt(3)
    v_mfma_f32_16x16x32_bf16 v[44:47], v[40:43], v[24:27], 0
    s_waitcnt vmcnt(2)
    v_mfma_f32_16x16x32_bf16 v[44:47], v[40:43], v[28:31], v[44:47]
    v_bitop3_b32 v56, v25, v27, v29 bitop3:0x80
    v_bitop3_b32 v57, v24, v26, v28 bitop3:0x80
    v_bitop3_b32 v56, v56, v31, s47 bitop3:0xea
    v_bitop3_b32 v56, v56, v57, v30 bitop3:0x80
    v_and_b32 v56, 1, v56
    v_cmp_ne_u32 vcc, 1, v56
    s_cbranch_vccz CH_ok_188
    buffer_load_dwordx4 v[24:27], v0, s[28:31], s46 offen offset:0 sc1
    buffer_load_dwordx4 v[28:31], v0, s[28:31], s46 offen offset:1024 sc1
    s_add_u32 s49, s49, 1
    s_cmp_gt_u32 s49, 400000
    s_cbranch_scc1 L_end
    s_branch CH_h_184
CH_re_190:
    s_add_u32 s47, s43, s92
    buffer_load_dwordx4 v[24:27], v0, s[28:31], s47 offen sc1
    s_add_u32 s47, s43, 4096
    buffer_load_dwordx4 v[28:31], v0, s[28:31], s47 offen sc1
    s_add_u32 s49, s49, 1
    s_cmp_gt_u32 s49, 400000
    s_cbranch_scc1 L_end
    s_waitcnt vmcnt(0) lgkmcnt(0)
    v_max_u32 v41, v24, v26
    v_max3_u32 v41, v41, v28, v30
    v_cmp_eq_u32 vcc, -1, v41
    s_cbranch_vccnz CH_re_190
    ds_read_b128 v[32:35], v1 offset:4096
    ds_read_b128 v[36:39], v1 offset:5120
    v_mov_b64 v[8:9], 0
    v_mov_b64 v[10:11], 0
    v_mov_b64 v[12:13], 0
    v_mov_b64 v[14:15], 0
    v_mov_b64 v[16:17], 0
    v_mov_b64 v[18:19], 0
    v_mov_b64 v[20:21], 0
    v_mov_b64 v[22:23], 0
    v_mov_b64 v[48:49], 0
    v_mov_b64 v[50:51], 0
    v_mov_b64 v[52:53], 0
    v_mov_b64 v[54:55], 0
    s_waitcnt lgkmcnt(0)
    s_branch CH_st_189
CH_fp_193:
    s_cmp_eq_u32 s72, 0
    s_cbranch_scc1 CH_re_191
    v_and_b32 v56, 0x180, v0
    buffer_load_dword v57, v56, s[32:35], s98 offen sc1
    s_add_u32 s49, s49, 1
    s_cmp_gt_u32 s49, 400000
    s_cbranch_scc1 L_end
    s_waitcnt vmcnt(0)
    v_cmp_gt_u32 vcc, s76, v57
    s_cbranch_vccnz CH_fp_193
CH_re_191:
    s_add_u32 s47, s90, s92
    buffer_load_dwordx4 v[56:59], v0, s[36:39], s47 offen sc1
    s_add_u32 s47, s90, 4096
    buffer_load_dwordx4 v[60:63], v0, s[36:39], s47 offen sc1
    s_add_u32 s49, s49, 1
    s_cmp_gt_u32 s49, 400000
    s_cbranch_scc1 L_end
    s_waitcnt vmcnt(0)
    v_max_u32 v29, v56, v58
    v_max3_u32 v29, v29, v60, v62
    v_cmp_eq_u32 vcc, -1, v29
    s_cbranch_vccnz CH_re_191
    ds_write_b128 v28, v[56:59] offset:4096
    s_waitcnt lgkmcnt(0)
    s_branch CH_re_192
CH_nt_198:
    v_mov_b64 v[8:9], 0
    v_mov_b64 v[10:11], 0
    v_mov_b64 v[12:13], 0
    v_mov_b64 v[14:15], 0
    v_mov_b64 v[16:17], 0
    v_mov_b64 v[18:19], 0
    v_mov_b64 v[20:21], 0
    v_mov_b64 v[22:23], 0
    v_mov_b64 v[48:49], 0
    v_mov_b64 v[50:51], 0
    v_mov_b64 v[52:53], 0
    v_mov_b64 v[54:55], 0
    s_waitcnt vmcnt(0)
    s_branch CH_x0_199
CH_h_196:
    buffer_load_dwordx4 v[32:35], v0, s[28:31], s46 offen offset:0 sc1
    buffer_load_dwordx4 v[36:39], v0, s[28:31], s46 offen offset:1024 sc1
    s_waitcnt vmcnt(3)
    v_mfma_f32_16x16x32_bf16 v[44:47], v[40:43], v[24:27], 0
    s_waitcnt vmcnt(2)
    v_mfma_f32_16x16x32_bf16 v[44:47], v[40:43], v[28:31], v[44:47]
    v_bitop3_b32 v56, v25, v27, v29 bitop3:0xfe
    v_bitop3_b32 v57, v24, v26, v28 bitop3:0xfe
    v_bitop3_b32 v56, v56, v31, s47 bitop3:0xa8
    v_bitop3_b32 v56, v56, v57, v30 bitop3:0xfe
    v_and_b32 v56, 1, v56
    v_cmp_ne_u32 vcc, 0, v56
    s_cbranch_vccz CH_ok_201
    buffer_load_dwordx4 v[24:27], v0, s[28:31], s46 offen offset:0 sc1
    buffer_load_dwordx4 v[28:31], v0, s[28:31], s46 offen offset:1024 sc1
    s_add_u32 s49, s49, 1
    s_cmp_gt_u32 s49, 400000
    s_cbranch_scc1 L_end
    s_branch CH_h_197
CH_exit_175:
    s_branch CH_fin_160
CH_slow_159:
.p2align 6
CH_top_215:
CH_st_217:
    s_waitcnt vmcnt(1)
    v_smfmac_f32_16x16x64_bf16 v[8:11], v[24:27], v[64:71], v2
    ds_write_b128 v40, v[24:27] offset:0
    v_smfmac_f32_16x16x64_bf16 v[12:15], v[24:27], v[72:79], v2
    v_max_u32 v41, v24, v26
    v_smfmac_f32_16x16x64_bf16 v[16:19], v[24:27], v[32:39], v2
    v_smfmac_f32_16x16x64_bf16 v[20:23], v[24:27], v[80:87], v2
    ds_read_b128 v[32:35], v1 offset:6144
    v_smfmac_f32_16x16x64_bf16 v[48:51], v[24:27], v[88:95], v2
    buffer_load_dwordx4 v[56:59], v0, s[36:39], s93 offen sc1
    ds_read_b128 v[36:39], v1 offset:7168
    s_waitcnt vmcnt(1)
    v_max3_u32 v41, v41, v28, v30
    v_smfmac_f32_16x16x64_bf16 v[52:55], v[24:27], v[96:103], v2
    buffer_load_dwordx4 v[60:63], v0, s[36:39], s89 offen sc1
    v_cmp_eq_u32 vcc, -1, v41
    v_smfmac_f32_16x16x64_bf16 v[8:11], v[28:31], v[104:111], v2
    v_smfmac_f32_16x16x64_bf16 v[12:15], v[28:31], v[112:119], v2
    s_cbranch_vccnz CH_re_218
    v_smfmac_f32_16x16x64_bf16 v[16:19], v[28:31], v[120:127], v2
    s_waitcnt lgkmcnt(2)
    s_barrier
    v_smfmac_f32_16x16x64_bf16 v[20:23], v[28:31], v[128:135], v2
    s_waitcnt lgkmcnt(0)
    ds_read_b128 v[24:27], v42 offset:0
    v_smfmac_f32_16x16x64_bf16 v[48:51], v[28:31], v[32:39], v2
    ds_read_b128 v[40:43], v1 offset:8192
    v_smfmac_f32_16x16x64_bf16 v[52:55], v[28:31], v[136:143], v2
    ds_read_b128 v[44:47], v1 offset:9216
    v_add_u32 v28, s14, v0
    s_waitcnt lgkmcnt(2)
    v_smfmac_f32_16x16x64_bf16 v[8:11], v[24:27], v[144:151], v2
    ds_read_b128 v[28:31], v28 offset:0
    v_smfmac_f32_16x16x64_bf16 v[12:15], v[24:27], v[152:159], v2
    ds_read_b128 v[32:35], v1 offset:10240
    v_smfmac_f32_16x16x64_bf16 v[16:19], v[24:27], v[160:167], v2
    s_waitcnt lgkmcnt(2)
    ds_read_b128 v[36:39], v1 offset:11264
    v_smfmac_f32_16x16x64_bf16 v[20:23], v[24:27], v[40:47], v2
    ds_read_b128 v[40:43], v1 offset:12288
    v_smfmac_f32_16x16x64_bf16 v[48:51], v[24:27], v[168:175], v2
    ds_read_b128 v[44:47], v1 offset:13312
    v_smfmac_f32_16x16x64_bf16 v[52:55], v[24:27], v[176:183], v2
    s_waitcnt lgkmcnt(4)
    v_add_u32 v24, s15, v0
    v_smfmac_f32_16x16x64_bf16 v[8:11], v[28:31], v[184:191], v2
    s_waitcnt lgkmcnt(2)
    ds_read_b128 v[24:27], v24 offset:0
    v_smfmac_f32_16x16x64_bf16 v[12:15], v[28:31], v[32:39], v2
    ds_read_b128 v[32:35], v1 offset:14336
    v_smfmac_f32_16x16x64_bf16 v[16:19], v[28:31], v[192:199], v2
    s_waitcnt lgkmcnt(2)
    ds_read_b128 v[36:39], v1 offset:15360
    v_smfmac_f32_16x16x64_bf16 v[20:23], v[28:31], v[40:47], v2
    ds_read_b128 v[40:43], v1 offset:16384
    v_smfmac_f32_16x16x64_bf16 v[48:51], v[28:31], v[200:207], v2
    ds_read_b128 v[44:47], v1 offset:17408
    v_smfmac_f32_16x16x64_bf16 v[52:55], v[28:31], v[208:215], v2
    s_waitcnt lgkmcnt(4)
    v_smfmac_f32_16x16x64_bf16 v[8:11], v[24:27], v[216:223], v2
    v_add_u32 v28, s92, v0
    v_smfmac_f32_16x16x64_bf16 v[12:15], v[24:27], v[224:231], v2
    s_waitcnt vmcnt(1)
    ds_write_b128 v28, v[56:59] offset:4096
    v_max3_u32 v29, v56, v58, s72
    v_smfmac_f32_16x16x64_bf16 v[16:19], v[24:27], v[232:239], v2
    s_waitcnt vmcnt(0)
    v_max3_u32 v29, v29, v60, v62
    v_smfmac_f32_16x16x64_bf16 v[20:23], v[24:27], v[240:247], v2
    s_add_u32 m0, s63, 8192
    v_cmp_eq_u32_e64 vcc, -1, v29
    v_smfmac_f32_16x16x64_bf16 v[48:51], v[24:27], v[248:255], v2
    v_smfmac_f32_16x16x64_bf16 v[52:55], v[24:27], a[0:7], v2
    s_cbranch_vccnz CH_fp_221
CH_re_220:
    v_smfmac_f32_16x16x64_bf16 v[8:11], v[56:59], a[8:15], v2
    s_waitcnt lgkmcnt(0)
    s_barrier
    v_smfmac_f32_16x16x64_bf16 v[12:15], v[56:59], a[16:23], v2
    buffer_load_dwordx4 v0, s[32:35], s42 offen sc1 lds
    v_add_u32 v28, s13, v0
    v_smfmac_f32_16x16x64_bf16 v[16:19], v[56:59], a[24:31], v2
    ds_read_b128 v[28:31], v28 offset:4096
    v_add_u32 v24, s14, v0
    v_smfmac_f32_16x16x64_bf16 v[20:23], v[56:59], a[32:39], v2
    ds_read_b128 v[24:27], v24 offset:4096
    v_smfmac_f32_16x16x64_bf16 v[8:11], v[60:63], a[40:47], v2
    s_xor_b32 m0, m0, 1024
    s_xor_b32 s60, s42, 1024
    v_smfmac_f32_16x16x64_bf16 v[12:15], v[60:63], v[32:39], v2
    buffer_load_dwordx4 v0, s[32:35], s60 offen sc1 lds
    v_cndmask_b32 v38, v3, v1, s[82:83]
    v_smfmac_f32_16x16x64_bf16 v[16:19], v[60:63], a[48:55], v2
    ds_read_b64 v[38:39], v38 offset:2176
    v_add_u32 v32, s15, v0
    v_smfmac_f32_16x16x64_bf16 v[20:23], v[60:63], a[56:63], v2
    s_waitcnt lgkmcnt(2)
    ds_read_b128 v[32:35], v32 offset:4096
    v_smfmac_f32_16x16x64_bf16 v[8:11], v[28:31], v[40:47], v2
    ds_read_b128 v[40:43], v1 offset:18432
    v_lshrrev_b32 v37, 1, v0
    v_smfmac_f32_16x16x64_bf16 v[12:15], v[28:31], a[64:71], v2
    s_waitcnt lgkmcnt(3)
    ds_read_b128 v[44:47], v1 offset:19456
    v_smfmac_f32_16x16x64_bf16 v[8:11], v[24:27], a[72:79], v2
    s_add_u32 m0, s12, 2048
    s_xor_b32 s60, s42, 16384
    v_mov_b32 v36, s84
    v_smfmac_f32_16x16x64_bf16 v[12:15], v[24:27], a[80:87], v2
    s_waitcnt lgkmcnt(2)
    buffer_load_dwordx4 v0, s[32:35], s60 offen sc1 lds
    v_smfmac_f32_16x16x64_bf16 v[8:11], v[32:35], a[88:95], v2
    s_add_u32 s42, s42, 1048576
    s_xor_b32 s42, s42, 8192
    v_permlane16_swap_b32 v38, v39
    v_smfmac_f32_16x16x64_bf16 v[12:15], v[32:35], a[96:103], v2
    s_xor_b32 m0, m0, 1024
    s_xor_b32 s60, s60, 1024
    v_smfmac_f32_16x16x64_bf16 v[16:19], v[28:31], a[104:111], v2
    s_waitcnt lgkmcnt(0)
    buffer_load_dwordx4 v0, s[32:35], s60 offen sc1 lds
    v_add_f32 v8, v8, v10
    v_smfmac_f32_16x16x64_bf16 v[16:19], v[24:27], v[40:47], v2
    ds_read_b128 v[40:43], v0 offset:16384
    v_add_f32 v9, v9, v11
    v_smfmac_f32_16x16x64_bf16 v[16:19], v[32:35], a[112:119], v2
    ds_read_b128 v[44:47], v0 offset:17408
    v_add_f32 v12, v12, v14
    v_smfmac_f32_16x16x64_bf16 v[20:23], v[28:31], a[120:127], v2
    buffer_store_dwordx2 v[38:39], v37, s[32:35], s96 offen sc1
    v_add_f32 v13, v13, v15
    v_smfmac_f32_16x16x64_bf16 v[20:23], v[24:27], a[128:135], v2
    buffer_store_dword v36, off, s[32:35], s18 sc1
    v_cvt_pk_bf16_f32 v8, v8, v9
    v_cvt_pk_bf16_f32 v9, v12, v13
    v_smfmac_f32_16x16x64_bf16 v[20:23], v[32:35], a[136:143], v2
    ds_write_b64 v3, v[8:9] offset:2176
    v_add_f32 v16, v16, v18
    v_add_f32 v17, v17, v19
    v_smfmac_f32_16x16x64_bf16 v[48:51], v[56:59], a[144:151], v2
    v_cvt_pk_bf16_f32 v10, v16, v17
    v_add_f32 v20, v20, v22
    v_add_f32 v21, v21, v23
    v_cvt_pk_bf16_f32 v11, v20, v21
    v_smfmac_f32_16x16x64_bf16 v[52:55], v[56:59], a[152:159], v2
    ds_write_b64 v3, v[10:11] offset:0
    v_smfmac_f32_16x16x64_bf16 v[48:51], v[60:63], a[160:167], v2
    ds_read_b128 v[56:59], v0 offset:18432
    v_smfmac_f32_16x16x64_bf16 v[52:55], v[60:63], a[168:175], v2
    ds_read_b128 v[60:63], v0 offset:19456
    v_smfmac_f32_16x16x64_bf16 v[48:51], v[28:31], a[176:183], v2
    s_waitcnt lgkmcnt(2)
    s_barrier
    v_smfmac_f32_16x16x64_bf16 v[52:55], v[28:31], a[184:191], v2
    ds_read_b64_tr_b16 v[12:13], v4 offset:2176
    ds_read_b64_tr_b16 v[14:15], v4 offset:2208
    v_smfmac_f32_16x16x64_bf16 v[48:51], v[24:27], a[192:199], v2
    ds_read_b64_tr_b16 v[16:17], v4 offset:3264
    ds_read_b64_tr_b16 v[18:19], v4 offset:3296
    v_smfmac_f32_16x16x64_bf16 v[52:55], v[24:27], a[200:207], v2
    ds_read_b64_tr_b16 v[20:21], v4 offset:0
    ds_read_b64_tr_b16 v[22:23], v4 offset:32
    v_smfmac_f32_16x16x64_bf16 v[48:51], v[32:35], a[208:215], v2
    ds_read_b64_tr_b16 v[36:37], v4 offset:1088
    ds_read_b64_tr_b16 v[38:39], v4 offset:1120
    v_smfmac_f32_16x16x64_bf16 v[52:55], v[32:35], a[216:223], v2
    ds_read_b128 v[28:31], v0 offset:21504
    ds_read_b128 v[24:27], v0 offset:20480
    s_waitcnt lgkmcnt(8)
    v_mfma_f32_16x16x32_bf16 v[8:11], v[40:43], v[12:15], 0
    ds_read_b128 v[32:35], v0 offset:22528
    s_waitcnt lgkmcnt(7)
    v_mfma_f32_16x16x32_bf16 v[8:11], v[44:47], v[16:19], v[8:11]
    ds_read_b128 v[44:47], v0 offset:23552
    v_add_f32_e64 v48, v48, v50
    v_mfma_f32_16x16x32_bf16 v[40:43], v[56:59], v[12:15], 0
    v_add_f32 v49, v49, v51
    v_mfma_f32_16x16x32_bf16 v[40:43], v[60:63], v[16:19], v[40:43]
    s_waitcnt lgkmcnt(6)
    v_add_f32_e64 v52, v52, v54
    v_add_f32_dpp v8, v10, v8 quad_perm:[2,3,2,3] row_mask:0xf bank_mask:0xf
    v_mfma_f32_16x16x32_bf16 v[56:59], v[20:23], v[12:15], 0
    s_waitcnt lgkmcnt(4)
    v_add_f32_dpp v9, v11, v9 quad_perm:[2,3,2,3] row_mask:0xf bank_mask:0xf
    v_max_f32 v10, v8, v9
    v_mfma_f32_16x16x32_bf16 v[56:59], v[36:39], v[16:19], v[56:59]
    s_waitcnt lgkmcnt(2)
    v_add_f32 v53, v53, v55
    v_add_f32_dpp v40, v42, v40 quad_perm:[2,3,2,3] row_mask:0xf bank_mask:0xf
    v_mfma_f32_16x16x32_bf16 v[20:23], v[24:27], v[12:15], 0
    v_add_f32_dpp v41, v43, v41 quad_perm:[2,3,2,3] row_mask:0xf bank_mask:0xf
    v_max3_f32 v10, v10, v40, v41
    v_mfma_f32_16x16x32_bf16 v[20:23], v[28:31], v[16:19], v[20:23]
    s_waitcnt lgkmcnt(1)
    v_cvt_pk_bf16_f32 v50, v48, v49
    v_add_f32_dpp v56, v58, v56 quad_perm:[2,3,2,3] row_mask:0xf bank_mask:0xf
    v_mfma_f32_16x16x32_bf16 v[24:27], v[32:35], v[12:15], 0
    s_waitcnt lgkmcnt(0)
    v_add_f32_dpp v57, v59, v57 quad_perm:[2,3,2,3] row_mask:0xf bank_mask:0xf
    v_max3_f32 v10, v10, v56, v57
    v_mfma_f32_16x16x32_bf16 v[24:27], v[44:47], v[16:19], v[24:27]
    ds_read_b128 v[32:35], v1 offset:0
    v_add_f32_dpp v20, v22, v20 quad_perm:[2,3,2,3] row_mask:0xf bank_mask:0xf
    v_add_f32_dpp v21, v23, v21 quad_perm:[2,3,2,3] row_mask:0xf bank_mask:0xf
    v_max3_f32 v10, v10, v20, v21
    v_cvt_pk_bf16_f32 v51, v52, v53
    v_mov_b64 v[60:61], s[22:23]
    v_mov_b64 v[62:63], s[22:23]
    s_nop 0
    v_add_f32_dpp v24, v26, v24 quad_perm:[2,3,2,3] row_mask:0xf bank_mask:0xf
    v_add_f32_dpp v25, v27, v25 quad_perm:[2,3,2,3] row_mask:0xf bank_mask:0xf
    v_max3_f32 v10, v10, v24, v25
    v_mov_b32 v11, v10
    v_mov_b32 v29, 0
    v_mov_b32 v30, 0
    v_permlane32_swap_b32 v10, v11
    v_max_f32 v10, v10, v11
    v_mov_b32 v11, v10
    s_nop 1
    v_permlane16_swap_b32 v10, v11
    v_max_f32 v10, v10, v11
    v_mul_f32_e64 v10, s51, v10
    v_pk_fma_f32 v[56:57], v[56:57], s[16:17], v[10:11] op_sel_hi:[1,1,0] neg_lo:[0,0,1] neg_hi:[0,0,1]
    v_pk_fma_f32 v[8:9], v[8:9], s[16:17], v[10:11] op_sel_hi:[1,1,0] neg_lo:[0,0,1] neg_hi:[0,0,1]
    v_pk_fma_f32 v[40:41], v[40:41], s[16:17], v[10:11] op_sel_hi:[1,1,0] neg_lo:[0,0,1] neg_hi:[0,0,1]
    v_pk_fma_f32 v[20:21], v[20:21], s[16:17], v[10:11] op_sel_hi:[1,1,0] neg_lo:[0,0,1] neg_hi:[0,0,1]
    v_pk_fma_f32 v[24:25], v[24:25], s[16:17], v[10:11] op_sel_hi:[1,1,0] neg_lo:[0,0,1] neg_hi:[0,0,1]
    v_exp_f32_dpp v56, v56 quad_perm:[0,1,0,1] row_mask:0xf bank_mask:0xf
    v_exp_f32_dpp v57, v57 quad_perm:[0,1,0,1] row_mask:0xf bank_mask:0xf
    v_exp_f32_dpp v8, v8 quad_perm:[0,1,0,1] row_mask:0xf bank_mask:0xf
    v_cvt_pk_bf16_f32 v28, v56, v57
    v_cvt_pk_bf16_f32 v31, v56, v57
    v_exp_f32_dpp v9, v9 quad_perm:[0,1,0,1] row_mask:0xf bank_mask:0xf
    v_mfma_f32_16x16x16_bf16 v[36:39], v[60:61], v[28:29], 0
    ds_read_b128 v[44:47], v1 offset:1024
    v_exp_f32_dpp v40, v40 quad_perm:[0,1,0,1] row_mask:0xf bank_mask:0xf
    v_mfma_f32_16x16x16_bf16 v[16:19], v[50:51], v[28:29], 0
    v_exp_f32_dpp v41, v41 quad_perm:[0,1,0,1] row_mask:0xf bank_mask:0xf
    v_mfma_f32_16x16x16_bf16 v[52:55], v[50:51], v[30:31], 0
    v_exp_f32_dpp v20, v20 quad_perm:[0,1,0,1] row_mask:0xf bank_mask:0xf
    v_cvt_pk_bf16_f32 v12, v8, v9
    v_exp_f32_dpp v21, v21 quad_perm:[0,1,0,1] row_mask:0xf bank_mask:0xf
    v_cvt_pk_bf16_f32 v13, v40, v41
    v_exp_f32_dpp v24, v24 quad_perm:[0,1,0,1] row_mask:0xf bank_mask:0xf
    v_exp_f32_dpp v25, v25 quad_perm:[0,1,0,1] row_mask:0xf bank_mask:0xf
    v_cvt_pk_bf16_f32 v14, v20, v21
    v_cvt_pk_bf16_f32 v15, v24, v25
    s_waitcnt lgkmcnt(0)
    s_nop 0
    v_mfma_f32_16x16x32_bf16 v[36:39], v[60:63], v[12:15], v[36:39]
    ds_write_b64 v1, v[50:51] offset:0
    v_mfma_f32_16x16x32_bf16 v[16:19], v[32:35], v[12:15], v[16:19]
    ds_read_b128 v[56:59], v1 offset:20480
    v_mfma_f32_16x16x32_bf16 v[52:55], v[44:47], v[12:15], v[52:55]
    ds_read_b128 v[60:63], v1 offset:21504
    v_rcp_f32 v10, v36
    v_mov_b64_e64 v[12:13], 0
    s_nop 0
    v_pk_mul_f32 v[16:17], v[16:17], v[10:11] op_sel_hi:[1,0]
    v_pk_mul_f32 v[18:19], v[18:19], v[10:11] op_sel_hi:[1,0]
    s_mov_b64 exec, s[86:87]
    s_nop 0
    v_pk_mul_f32 v[16:17], v[52:53], v[10:11] op_sel_hi:[1,0]
    v_pk_mul_f32 v[18:19], v[54:55], v[10:11] op_sel_hi:[1,0]
    s_mov_b64 exec, -1
    v_cvt_pk_bf16_f32 v16, v16, v17
    v_cvt_pk_bf16_f32 v17, v18, v19
    v_mfma_f32_16x16x16_bf16 v[20:23], v[12:13], v[12:13], 0
    ds_write_b64 v5, v[16:17]
    v_mfma_f32_16x16x16_bf16 v[24:27], v[12:13], v[12:13], 0
    ds_read_b128 v[40:43], v1 offset:22528
    v_mfma_f32_16x16x16_bf16 v[28:31], v[12:13], v[12:13], 0
    ds_read_b128 v[44:47], v1 offset:23552
    v_mfma_f32_16x16x16_bf16 v[48:51], v[12:13], v[12:13], 0
    ds_read_b128 v[32:35], v1 offset:24576
    s_waitcnt lgkmcnt(3)
    s_barrier
    v_mfma_f32_16x16x16_bf16 v[8:11], v[12:13], v[12:13], 0
    ds_read_b128 v[16:19], v0 offset:8192
    ds_read_b128 v[52:55], v0 offset:9216
    ds_read_b128 v[36:39], v1 offset:25600
    v_mfma_f32_16x16x16_bf16 v[28:31], v[12:13], v[12:13], 0
    v_lshlrev_b32 v15, 3, v0
    v_mfma_f32_16x16x16_bf16 v[48:51], v[12:13], v[12:13], 0
    v_bfe_u32 v14, v0, 2, 6
    v_and_or_b32 v14, v15, s94, v14
    s_waitcnt lgkmcnt(2)
    v_smfmac_f32_16x16x64_bf16 v[20:23], v[16:19], v[56:63], v2
    ds_read_b128 v[56:59], v1 offset:26624
    s_waitcnt lgkmcnt(2)
    v_smfmac_f32_16x16x64_bf16 v[20:23], v[52:55], v[40:47], v2
    s_waitcnt lgkmcnt(1)
    ds_read_b128 v[60:63], v1 offset:27648
    v_smfmac_f32_16x16x64_bf16 v[24:27], v[16:19], v[32:39], v2
    ds_read_b128 v[40:43], v1 offset:28672
    v_smfmac_f32_16x16x64_bf16 v[24:27], v[52:55], a[224:231], v2
    ds_read_b128 v[44:47], v1 offset:29696
    v_add_f32 v20, v20, v22
    v_smfmac_f32_16x16x64_bf16 v[28:31], v[16:19], a[232:239], v2
    ds_read_b128 v[32:35], v1 offset:30720
    v_add_f32 v21, v21, v23
    v_smfmac_f32_16x16x64_bf16 v[28:31], v[52:55], a[240:247], v2
    ds_read_b128 v[36:39], v1 offset:31744
    v_add_f32 v24, v24, v26
    v_add_f32_e64 v25, v25, v27
    v_cvt_pk_bf16_f32 v20, v20, v24
    v_cvt_pk_bf16_f32 v21, v21, v25
    v_and_or_b32 v20, v20, -2, 1
    v_smfmac_f32_16x16x64_bf16 v[48:51], v[16:19], a[248:255], v2
    s_waitcnt lgkmcnt(4)
    buffer_store_dwordx2 v[20:21], v7, s[28:31], 0 offen sc1
    v_smfmac_f32_16x16x64_bf16 v[48:51], v[52:55], v[56:63], v2
    s_waitcnt lgkmcnt(2)
    v_add_f32_e64 v28, v28, v30
    v_smfmac_f32_16x16x64_bf16 v[8:11], v[16:19], v[40:47], v2
    s_waitcnt lgkmcnt(0)
    v_add_f32 v29, v29, v31
    v_smfmac_f32_16x16x64_bf16 v[8:11], v[52:55], v[32:39], v2
    s_cmp_eq_u32 s21, 3
    v_add_f32 v48, v48, v50
    v_add_f32_e64 v49, v49, v51
    v_cvt_pk_bf16_f32 v28, v28, v48
    v_cvt_pk_bf16_f32 v29, v29, v49
    v_and_or_b32 v28, v28, -2, 1
    buffer_store_dwordx2 v[28:29], v7, s[28:31], s61 offen sc1
    v_pk_add_f32 v[8:9], v[8:9], v[10:11]
    v_cvt_pk_bf16_f32 v8, v8, v9
    v_and_or_b32 v8, v8, -2, 1
    buffer_store_dword v8, v14, s[28:31], s62 offen sc1
    s_cbranch_scc1 CH_h_222
    v_lshrrev_b32 v56, s91, v0
    v_and_b32_e64 v56, 16, v56
    v_lshlrev_b32_e64 v56, v56, s65
    v_cndmask_b32 v40, 0, v56, s[52:53]
    v_cndmask_b32 v41, 0, v56, s[54:55]
    v_cndmask_b32 v42, 0, v56, s[56:57]
    v_cndmask_b32 v43, 0, v56, s[58:59]
    v_mov_b64 v[58:59], -1
    s_mov_b32 s44, s43
    s_add_u32 s43, s43, 0x2000
    s_and_b32 s43, s43, 0x7fff
    s_add_u32 s43, s43, 163840
    s_mov_b32 s49, 0
    s_add_u32 s40, s40, 1
    s_add_u32 s90, s90, 32768
    s_mov_b32 s96, s97
    s_add_u32 s97, s97, 262144
    s_add_u32 s84, s40, s99
    s_sub_u32 s84, s84, 1
    s_cmp_eq_u32 s40, 63
    s_cselect_b32 s42, 1073741824, s42
    s_cmp_lg_u32 s95, 0
    s_cbranch_scc1 CH_nt_226
    s_nop 9
    s_cmp_le_u32 s21, 0
    s_cbranch_scc1 CH_d_228
    s_nop 7
CH_d_228:
    buffer_load_dwordx4 v[32:35], v0, s[28:31], s46 offen offset:0 sc1
    buffer_load_dwordx4 v[36:39], v0, s[28:31], s46 offen offset:1024 sc1
    v_mov_b64 v[8:9], 0
    v_mov_b64 v[10:11], 0
    v_mov_b64 v[12:13], 0
    v_mov_b64 v[14:15], 0
    v_mov_b64 v[48:49], 0
    v_mov_b64 v[50:51], 0
    v_mov_b64 v[52:53], 0
    v_mov_b64 v[54:55], 0
    s_cmp_eq_u32 s21, 2
    s_cselect_b32 s47, 0, 1
    s_nop 15
    s_nop 6
    buffer_load_dwordx4 v[24:27], v0, s[28:31], s46 offen offset:0 sc1
    buffer_load_dwordx4 v[28:31], v0, s[28:31], s46 offen offset:1024 sc1
CH_h_225:
    s_waitcnt vmcnt(3)
    v_mfma_f32_16x16x32_bf16 v[44:47], v[40:43], v[32:35], 0
    s_waitcnt vmcnt(2)
    v_mfma_f32_16x16x32_bf16 v[44:47], v[40:43], v[36:39], v[44:47]
    v_bitop3_b32 v56, v33, v35, v37 bitop3:0x80
    v_bitop3_b32 v57, v32, v34, v36 bitop3:0x80
    v_bitop3_b32 v56, v56, v39, s47 bitop3:0xea
    v_bitop3_b32 v56, v56, v57, v38 bitop3:0x80
    v_and_b32 v56, 1, v56
    v_cmp_ne_u32 vcc, 1, v56
    s_cbranch_vccnz CH_h_224
CH_ok_229:
    v_add_f32_dpp v44, v44, v44 row_ror:8 row_mask:0xf bank_mask:0xf
    v_add_f32_dpp v45, v45, v45 row_ror:8 row_mask:0xf bank_mask:0xf
    v_add_f32_dpp v46, v46, v46 row_ror:8 row_mask:0xf bank_mask:0xf
    v_add_f32_dpp v47, v47, v47 row_ror:8 row_mask:0xf bank_mask:0xf
    v_add_f32_dpp v44, v44, v44 row_ror:4 row_mask:0xf bank_mask:0xf
    v_add_f32_dpp v45, v45, v45 row_ror:4 row_mask:0xf bank_mask:0xf
    v_add_f32_dpp v46, v46, v46 row_ror:4 row_mask:0xf bank_mask:0xf
    v_add_f32_dpp v47, v47, v47 row_ror:4 row_mask:0xf bank_mask:0xf
    v_cvt_pk_bf16_f32 v56, v44, v45
    v_cvt_pk_bf16_f32 v57, v46, v47
    v_min_u32 v56, -2, v56
    buffer_store_dwordx2 v[56:57], v6, s[28:31], s43 offen sc1
CH_x0_227:
    s_barrier
    buffer_store_dwordx2 v[56:57], v6, s[36:39], s50 offen sc1
    buffer_store_dwordx2 v[58:59], v6, s[28:31], s44 offen sc1
    s_add_u32 s50, s50, 32768
    s_waitcnt vmcnt(3)
    v_mov_b64 v[16:17], 0
    v_mov_b64 v[18:19], 0
    v_mov_b64 v[20:21], 0
    v_mov_b64 v[22:23], 0
    ds_read_b128 v[32:35], v1 offset:4096
    ds_read_b128 v[36:39], v1 offset:5120
    v_add_u32 v40, s92, v0
    v_xor_b32 v42, 1024, v40
    s_nop 15
    s_nop 15
    s_nop 15
    s_nop 3
    s_branch CH_h_223
CH_h_222:
    v_mov_b64 v[48:49], 0
    v_mov_b64 v[50:51], 0
    v_mov_b64 v[52:53], 0
    v_mov_b64 v[54:55], 0
    ds_read_b128 v[32:35], v1 offset:4096
    ds_read_b128 v[36:39], v1 offset:5120
    v_add_u32 v40, s92, v0
    v_xor_b32 v42, 1024, v40
    s_mov_b32 s44, s43
    s_add_u32 s43, s43, 0x2000
    s_and_b32 s43, s43, 0x7fff
    s_add_u32 s43, s43, 163840
    s_mov_b32 s49, 0
    s_add_u32 s40, s40, 1
    s_add_u32 s90, s90, 32768
    s_mov_b32 s96, s97
    s_add_u32 s97, s97, 262144
    s_add_u32 s84, s40, s99
    s_sub_u32 s84, s84, 1
    s_cmp_eq_u32 s40, 63
    s_cselect_b32 s42, 1073741824, s42
    s_add_u32 s47, s98, 0
    s_load_dword s72, s[32:33], s47 glc
    s_add_u32 s47, s98, 128
    s_load_dword s73, s[32:33], s47 glc
    s_add_u32 s47, s98, 256
    s_load_dword s74, s[32:33], s47 glc
    s_add_u32 s47, s98, 384
    s_load_dword s75, s[32:33], s47 glc
    v_mfma_f32_32x32x2_f32 v[8:23], v48, v48, 0
    v_mfma_f32_32x32x2_f32 v[8:23], v48, v48, v[8:23]
    v_mfma_f32_32x32x2_f32 v[8:23], v48, v48, v[8:23]
    v_mfma_f32_32x32x2_f32 v[8:23], v48, v48, v[8:23]
    v_mfma_f32_32x32x2_f32 v[8:23], v48, v48, v[8:23]
    v_mfma_f32_32x32x2_f32 v[8:23], v48, v48, v[8:23]
    s_waitcnt vmcnt(0)
    s_barrier
    s_nop 15
    s_nop 15
    s_nop 15
    s_nop 15
    s_nop 9
    s_add_u32 s76, s40, 2
    s_min_u32 s76, s76, 64
    s_add_u32 s76, s76, s99
    s_waitcnt lgkmcnt(0)
    s_min_u32 s72, s72, s73
    s_min_u32 s72, s72, s74
    s_min_u32 s72, s72, s75
    s_cmp_lt_u32 s72, s76
    s_cselect_b32 s72, -1, 0
CH_h_223:
    s_waitcnt lgkmcnt(0)
    s_add_u32 s47, s43, s92
    buffer_load_dwordx4 v[24:27], v0, s[28:31], s47 offen sc1
    s_add_u32 s93, s90, s92
    s_add_u32 s89, s90, 4096
    s_nop 2
    s_add_u32 s47, s43, 4096
    buffer_load_dwordx4 v[28:31], v0, s[28:31], s47 offen sc1
CH_st_230:
    s_waitcnt vmcnt(1)
    v_smfmac_f32_16x16x64_bf16 v[8:11], v[24:27], v[64:71], v2
    ds_write_b128 v40, v[24:27] offset:0
    v_smfmac_f32_16x16x64_bf16 v[12:15], v[24:27], v[72:79], v2
    v_max_u32_e64 v41, v24, v26
    v_smfmac_f32_16x16x64_bf16 v[16:19], v[24:27], v[32:39], v2
    v_smfmac_f32_16x16x64_bf16 v[20:23], v[24:27], v[80:87], v2
    ds_read_b128 v[32:35], v1 offset:6144
    v_smfmac_f32_16x16x64_bf16 v[48:51], v[24:27], v[88:95], v2
    buffer_load_dwordx4 v[56:59], v0, s[36:39], s93 offen sc1
    ds_read_b128 v[36:39], v1 offset:7168
    s_waitcnt vmcnt(1)
    v_max3_u32 v41, v41, v28, v30
    v_smfmac_f32_16x16x64_bf16 v[52:55], v[24:27], v[96:103], v2
    buffer_load_dwordx4 v[60:63], v0, s[36:39], s89 offen sc1
    v_cmp_eq_u32 vcc, -1, v41
    v_smfmac_f32_16x16x64_bf16 v[8:11], v[28:31], v[104:111], v2
    v_smfmac_f32_16x16x64_bf16 v[12:15], v[28:31], v[112:119], v2
    s_cbranch_vccnz CH_re_231
    v_smfmac_f32_16x16x64_bf16 v[16:19], v[28:31], v[120:127], v2
    s_waitcnt lgkmcnt(2)
    s_barrier
    v_smfmac_f32_16x16x64_bf16 v[20:23], v[28:31], v[128:135], v2
    s_waitcnt lgkmcnt(0)
    ds_read_b128 v[24:27], v42 offset:0
    v_smfmac_f32_16x16x64_bf16 v[48:51], v[28:31], v[32:39], v2
    ds_read_b128 v[40:43], v1 offset:8192
    v_smfmac_f32_16x16x64_bf16 v[52:55], v[28:31], v[136:143], v2
    ds_read_b128 v[44:47], v1 offset:9216
    v_add_u32 v28, s14, v0
    s_waitcnt lgkmcnt(2)
    v_smfmac_f32_16x16x64_bf16 v[8:11], v[24:27], v[144:151], v2
    ds_read_b128 v[28:31], v28 offset:0
    v_smfmac_f32_16x16x64_bf16 v[12:15], v[24:27], v[152:159], v2
    ds_read_b128 v[32:35], v1 offset:10240
    v_smfmac_f32_16x16x64_bf16 v[16:19], v[24:27], v[160:167], v2
    s_waitcnt lgkmcnt(2)
    ds_read_b128 v[36:39], v1 offset:11264
    v_smfmac_f32_16x16x64_bf16 v[20:23], v[24:27], v[40:47], v2
    ds_read_b128 v[40:43], v1 offset:12288
    v_smfmac_f32_16x16x64_bf16 v[48:51], v[24:27], v[168:175], v2
    ds_read_b128 v[44:47], v1 offset:13312
    v_smfmac_f32_16x16x64_bf16 v[52:55], v[24:27], v[176:183], v2
    s_waitcnt lgkmcnt(4)
    v_add_u32_e64 v24, s15, v0
    v_smfmac_f32_16x16x64_bf16 v[8:11], v[28:31], v[184:191], v2
    s_waitcnt lgkmcnt(2)
    ds_read_b128 v[24:27], v24 offset:0
    v_smfmac_f32_16x16x64_bf16 v[12:15], v[28:31], v[32:39], v2
    ds_read_b128 v[32:35], v1 offset:14336
    v_smfmac_f32_16x16x64_bf16 v[16:19], v[28:31], v[192:199], v2
    s_waitcnt lgkmcnt(2)
    ds_read_b128 v[36:39], v1 offset:15360
    v_smfmac_f32_16x16x64_bf16 v[20:23], v[28:31], v[40:47], v2
    ds_read_b128 v[40:43], v1 offset:16384
    v_smfmac_f32_16x16x64_bf16 v[48:51], v[28:31], v[200:207], v2
    ds_read_b128 v[44:47], v1 offset:17408
    v_smfmac_f32_16x16x64_bf16 v[52:55], v[28:31], v[208:215], v2
    s_waitcnt lgkmcnt(4)
    v_smfmac_f32_16x16x64_bf16 v[8:11], v[24:27], v[216:223], v2
    v_add_u32_e64 v28, s92, v0
    v_smfmac_f32_16x16x64_bf16 v[12:15], v[24:27], v[224:231], v2
    s_waitcnt vmcnt(1)
    ds_write_b128 v28, v[56:59] offset:4096
    v_max3_u32 v29, v56, v58, s72
    v_smfmac_f32_16x16x64_bf16 v[16:19], v[24:27], v[232:239], v2
    s_waitcnt vmcnt(0)
    v_max3_u32 v29, v29, v60, v62
    v_smfmac_f32_16x16x64_bf16 v[20:23], v[24:27], v[240:247], v2
    s_add_u32 m0, s63, 0
    v_cmp_eq_u32_e64 vcc, -1, v29
    v_smfmac_f32_16x16x64_bf16 v[48:51], v[24:27], v[248:255], v2
    v_smfmac_f32_16x16x64_bf16 v[52:55], v[24:27], a[0:7], v2
    s_cbranch_vccnz CH_fp_234
CH_re_233:
    v_smfmac_f32_16x16x64_bf16 v[8:11], v[56:59], a[8:15], v2
    s_waitcnt lgkmcnt(0)
    s_barrier
    v_smfmac_f32_16x16x64_bf16 v[12:15], v[56:59], a[16:23], v2
    buffer_load_dwordx4 v0, s[32:35], s42 offen sc1 lds
    v_add_u32 v28, s13, v0
    v_smfmac_f32_16x16x64_bf16 v[16:19], v[56:59], a[24:31], v2
    ds_read_b128 v[28:31], v28 offset:4096
    v_add_u32_e64 v24, s14, v0
    v_smfmac_f32_16x16x64_bf16 v[20:23], v[56:59], a[32:39], v2
    ds_read_b128 v[24:27], v24 offset:4096
    v_smfmac_f32_16x16x64_bf16 v[8:11], v[60:63], a[40:47], v2
    s_xor_b32 m0, m0, 1024
    s_xor_b32 s60, s42, 1024
    v_smfmac_f32_16x16x64_bf16 v[12:15], v[60:63], v[32:39], v2
    buffer_load_dwordx4 v0, s[32:35], s60 offen sc1 lds
    v_cndmask_b32 v38, v3, v1, s[82:83]
    v_smfmac_f32_16x16x64_bf16 v[16:19], v[60:63], a[48:55], v2
    ds_read_b64 v[38:39], v38 offset:0
    v_add_u32_e64 v32, s15, v0
    v_smfmac_f32_16x16x64_bf16 v[20:23], v[60:63], a[56:63], v2
    s_waitcnt lgkmcnt(2)
    ds_read_b128 v[32:35], v32 offset:4096
    v_smfmac_f32_16x16x64_bf16 v[8:11], v[28:31], v[40:47], v2
    ds_read_b128 v[40:43], v1 offset:18432
    v_lshrrev_b32_e64 v37, 1, v0
    v_smfmac_f32_16x16x64_bf16 v[12:15], v[28:31], a[64:71], v2
    s_waitcnt lgkmcnt(3)
    ds_read_b128 v[44:47], v1 offset:19456
    v_smfmac_f32_16x16x64_bf16 v[8:11], v[24:27], a[72:79], v2
    s_add_u32 m0, s12, 0
    s_xor_b32 s60, s42, 16384
    v_mov_b32 v36, s84
    v_smfmac_f32_16x16x64_bf16 v[12:15], v[24:27], a[80:87], v2
    s_waitcnt lgkmcnt(2)
    buffer_load_dwordx4 v0, s[32:35], s60 offen sc1 lds
    v_smfmac_f32_16x16x64_bf16 v[8:11], v[32:35], a[88:95], v2
    s_add_u32 s42, s42, 1048576
    v_permlane16_swap_b32 v38, v39
    v_smfmac_f32_16x16x64_bf16 v[12:15], v[32:35], a[96:103], v2
    s_xor_b32 m0, m0, 1024
    s_xor_b32 s60, s60, 1024
    v_smfmac_f32_16x16x64_bf16 v[16:19], v[28:31], a[104:111], v2
    s_waitcnt lgkmcnt(0)
    buffer_load_dwordx4 v0, s[32:35], s60 offen sc1 lds
    v_add_f32 v8, v8, v10
    v_smfmac_f32_16x16x64_bf16 v[16:19], v[24:27], v[40:47], v2
    ds_read_b128 v[40:43], v0 offset:24576
    v_add_f32 v9, v9, v11
    v_smfmac_f32_16x16x64_bf16 v[16:19], v[32:35], a[112:119], v2
    ds_read_b128 v[44:47], v0 offset:25600
    v_add_f32 v12, v12, v14
    v_smfmac_f32_16x16x64_bf16 v[20:23], v[28:31], a[120:127], v2
    buffer_store_dwordx2 v[38:39], v37, s[32:35], s96 offen sc1
    v_add_f32_e64 v13, v13, v15
    v_smfmac_f32_16x16x64_bf16 v[20:23], v[24:27], a[128:135], v2
    buffer_store_dword v36, off, s[32:35], s18 sc1
    v_cvt_pk_bf16_f32 v8, v8, v9
    v_cvt_pk_bf16_f32 v9, v12, v13
    v_smfmac_f32_16x16x64_bf16 v[20:23], v[32:35], a[136:143], v2
    ds_write_b64 v3, v[8:9] offset:0
    v_add_f32 v16, v16, v18
    v_add_f32 v17, v17, v19
    v_smfmac_f32_16x16x64_bf16 v[48:51], v[56:59], a[144:151], v2
    v_cvt_pk_bf16_f32 v10, v16, v17
    v_add_f32 v20, v20, v22
    v_add_f32 v21, v21, v23
    v_cvt_pk_bf16_f32 v11, v20, v21
    v_smfmac_f32_16x16x64_bf16 v[52:55], v[56:59], a[152:159], v2
    ds_write_b64 v3, v[10:11] offset:2176
    v_smfmac_f32_16x16x64_bf16 v[48:51], v[60:63], a[160:167], v2
    ds_read_b128 v[56:59], v0 offset:26624
    v_smfmac_f32_16x16x64_bf16 v[52:55], v[60:63], a[168:175], v2
    ds_read_b128 v[60:63], v0 offset:27648
    v_smfmac_f32_16x16x64_bf16 v[48:51], v[28:31], a[176:183], v2
    s_waitcnt lgkmcnt(2)
    s_barrier
    v_smfmac_f32_16x16x64_bf16 v[52:55], v[28:31], a[184:191], v2
    ds_read_b64_tr_b16 v[12:13], v4 offset:0
    ds_read_b64_tr_b16 v[14:15], v4 offset:32
    v_smfmac_f32_16x16x64_bf16 v[48:51], v[24:27], a[192:199], v2
    ds_read_b64_tr_b16 v[16:17], v4 offset:1088
    ds_read_b64_tr_b16 v[18:19], v4 offset:1120
    v_smfmac_f32_16x16x64_bf16 v[52:55], v[24:27], a[200:207], v2
    ds_read_b64_tr_b16 v[20:21], v4 offset:2176
    ds_read_b64_tr_b16 v[22:23], v4 offset:2208
    v_smfmac_f32_16x16x64_bf16 v[48:51], v[32:35], a[208:215], v2
    ds_read_b64_tr_b16 v[36:37], v4 offset:3264
    ds_read_b64_tr_b16 v[38:39], v4 offset:3296
    v_smfmac_f32_16x16x64_bf16 v[52:55], v[32:35], a[216:223], v2
    ds_read_b128 v[28:31], v0 offset:29696
    ds_read_b128 v[24:27], v0 offset:28672
    s_waitcnt lgkmcnt(8)
    v_mfma_f32_16x16x32_bf16 v[8:11], v[40:43], v[12:15], 0
    ds_read_b128 v[32:35], v0 offset:30720
    s_waitcnt lgkmcnt(7)
    v_mfma_f32_16x16x32_bf16 v[8:11], v[44:47], v[16:19], v[8:11]
    ds_read_b128 v[44:47], v0 offset:31744
    v_add_f32 v48, v48, v50
    v_mfma_f32_16x16x32_bf16 v[40:43], v[56:59], v[12:15], 0
    v_add_f32 v49, v49, v51
    v_mfma_f32_16x16x32_bf16 v[40:43], v[60:63], v[16:19], v[40:43]
    s_waitcnt lgkmcnt(6)
    v_add_f32_e64 v52, v52, v54
    v_add_f32_dpp v8, v10, v8 quad_perm:[2,3,2,3] row_mask:0xf bank_mask:0xf
    v_mfma_f32_16x16x32_bf16 v[56:59], v[20:23], v[12:15], 0
    s_waitcnt lgkmcnt(4)
    v_add_f32_dpp v9, v11, v9 quad_perm:[2,3,2,3] row_mask:0xf bank_mask:0xf
    v_max_f32 v10, v8, v9
    v_mfma_f32_16x16x32_bf16 v[56:59], v[36:39], v[16:19], v[56:59]
    s_waitcnt lgkmcnt(2)
    v_add_f32_e64 v53, v53, v55
    v_add_f32_dpp v40, v42, v40 quad_perm:[2,3,2,3] row_mask:0xf bank_mask:0xf
    v_mfma_f32_16x16x32_bf16 v[20:23], v[24:27], v[12:15], 0
    v_add_f32_dpp v41, v43, v41 quad_perm:[2,3,2,3] row_mask:0xf bank_mask:0xf
    v_max3_f32 v10, v10, v40, v41
    v_mfma_f32_16x16x32_bf16 v[20:23], v[28:31], v[16:19], v[20:23]
    s_waitcnt lgkmcnt(1)
    v_cvt_pk_bf16_f32 v50, v48, v49
    v_add_f32_dpp v56, v58, v56 quad_perm:[2,3,2,3] row_mask:0xf bank_mask:0xf
    v_mfma_f32_16x16x32_bf16 v[24:27], v[32:35], v[12:15], 0
    s_waitcnt lgkmcnt(0)
    v_add_f32_dpp v57, v59, v57 quad_perm:[2,3,2,3] row_mask:0xf bank_mask:0xf
    v_max3_f32 v10, v10, v56, v57
    v_mfma_f32_16x16x32_bf16 v[24:27], v[44:47], v[16:19], v[24:27]
    ds_read_b128 v[32:35], v1 offset:2048
    v_add_f32_dpp v20, v22, v20 quad_perm:[2,3,2,3] row_mask:0xf bank_mask:0xf
    v_add_f32_dpp v21, v23, v21 quad_perm:[2,3,2,3] row_mask:0xf bank_mask:0xf
    v_max3_f32 v10, v10, v20, v21
    v_cvt_pk_bf16_f32 v51, v52, v53
    v_mov_b64 v[60:61], s[22:23]
    v_mov_b64_e64 v[62:63], s[22:23]
    s_nop 0
    v_add_f32_dpp v24, v26, v24 quad_perm:[2,3,2,3] row_mask:0xf bank_mask:0xf
    v_add_f32_dpp v25, v27, v25 quad_perm:[2,3,2,3] row_mask:0xf bank_mask:0xf
    v_max3_f32 v10, v10, v24, v25
    v_mov_b32 v11, v10
    v_mov_b32 v29, 0
    v_mov_b32 v30, 0
    v_permlane32_swap_b32 v10, v11
    v_max_f32 v10, v10, v11
    v_mov_b32 v11, v10
    s_cmp_eq_u32 s40, 63
    s_cbranch_scc1 CH_exit_216
    v_permlane16_swap_b32 v10, v11
    v_max_f32 v10, v10, v11
    v_mul_f32_e64 v10, s51, v10
    v_pk_fma_f32 v[56:57], v[56:57], s[16:17], v[10:11] op_sel_hi:[1,1,0] neg_lo:[0,0,1] neg_hi:[0,0,1]
    v_pk_fma_f32 v[8:9], v[8:9], s[16:17], v[10:11] op_sel_hi:[1,1,0] neg_lo:[0,0,1] neg_hi:[0,0,1]
    v_pk_fma_f32 v[40:41], v[40:41], s[16:17], v[10:11] op_sel_hi:[1,1,0] neg_lo:[0,0,1] neg_hi:[0,0,1]
    v_pk_fma_f32 v[20:21], v[20:21], s[16:17], v[10:11] op_sel_hi:[1,1,0] neg_lo:[0,0,1] neg_hi:[0,0,1]
    v_pk_fma_f32 v[24:25], v[24:25], s[16:17], v[10:11] op_sel_hi:[1,1,0] neg_lo:[0,0,1] neg_hi:[0,0,1]
    v_exp_f32_dpp v56, v56 quad_perm:[0,1,0,1] row_mask:0xf bank_mask:0xf
    v_exp_f32_dpp v57, v57 quad_perm:[0,1,0,1] row_mask:0xf bank_mask:0xf
    v_exp_f32_dpp v8, v8 quad_perm:[0,1,0,1] row_mask:0xf bank_mask:0xf
    v_cvt_pk_bf16_f32 v28, v56, v57
    v_cvt_pk_bf16_f32 v31, v56, v57
    v_exp_f32_dpp v9, v9 quad_perm:[0,1,0,1] row_mask:0xf bank_mask:0xf
    v_mfma_f32_16x16x16_bf16 v[36:39], v[60:61], v[28:29], 0
    ds_read_b128 v[44:47], v1 offset:3072
    v_exp_f32_dpp v40, v40 quad_perm:[0,1,0,1] row_mask:0xf bank_mask:0xf
    v_mfma_f32_16x16x16_bf16 v[16:19], v[50:51], v[28:29], 0
    v_exp_f32_dpp v41, v41 quad_perm:[0,1,0,1] row_mask:0xf bank_mask:0xf
    v_mfma_f32_16x16x16_bf16 v[52:55], v[50:51], v[30:31], 0
    v_exp_f32_dpp v20, v20 quad_perm:[0,1,0,1] row_mask:0xf bank_mask:0xf
    v_cvt_pk_bf16_f32 v12, v8, v9
    v_exp_f32_dpp v21, v21 quad_perm:[0,1,0,1] row_mask:0xf bank_mask:0xf
    v_cvt_pk_bf16_f32 v13, v40, v41
    v_exp_f32_dpp v24, v24 quad_perm:[0,1,0,1] row_mask:0xf bank_mask:0xf
    v_exp_f32_dpp v25, v25 quad_perm:[0,1,0,1] row_mask:0xf bank_mask:0xf
    v_cvt_pk_bf16_f32 v14, v20, v21
    v_cvt_pk_bf16_f32 v15, v24, v25
    s_waitcnt lgkmcnt(0)
    s_nop 0
    v_mfma_f32_16x16x32_bf16 v[36:39], v[60:63], v[12:15], v[36:39]
    ds_write_b64 v1, v[50:51] offset:2176
    v_mfma_f32_16x16x32_bf16 v[16:19], v[32:35], v[12:15], v[16:19]
    ds_read_b128 v[56:59], v1 offset:20480
    v_mfma_f32_16x16x32_bf16 v[52:55], v[44:47], v[12:15], v[52:55]
    ds_read_b128 v[60:63], v1 offset:21504
    v_rcp_f32 v10, v36
    v_mov_b64 v[12:13], 0
    s_nop 0
    v_pk_mul_f32 v[16:17], v[16:17], v[10:11] op_sel_hi:[1,0]
    v_pk_mul_f32 v[18:19], v[18:19], v[10:11] op_sel_hi:[1,0]
    s_mov_b64 exec, s[86:87]
    s_nop 0
    v_pk_mul_f32 v[16:17], v[52:53], v[10:11] op_sel_hi:[1,0]
    v_pk_mul_f32 v[18:19], v[54:55], v[10:11] op_sel_hi:[1,0]
    s_mov_b64 exec, -1
    v_cvt_pk_bf16_f32 v16, v16, v17
    v_cvt_pk_bf16_f32 v17, v18, v19
    v_mfma_f32_16x16x16_bf16 v[20:23], v[12:13], v[12:13], 0
    ds_write_b64 v5, v[16:17]
    v_mfma_f32_16x16x16_bf16 v[24:27], v[12:13], v[12:13], 0
    ds_read_b128 v[40:43], v1 offset:22528
    v_mfma_f32_16x16x16_bf16 v[28:31], v[12:13], v[12:13], 0
    ds_read_b128 v[44:47], v1 offset:23552
    v_mfma_f32_16x16x16_bf16 v[48:51], v[12:13], v[12:13], 0
    ds_read_b128 v[32:35], v1 offset:24576
    s_waitcnt lgkmcnt(3)
    s_barrier
    v_mfma_f32_16x16x16_bf16 v[8:11], v[12:13], v[12:13], 0
    ds_read_b128 v[16:19], v0 offset:8192
    ds_read_b128 v[52:55], v0 offset:9216
    ds_read_b128 v[36:39], v1 offset:25600
    v_mfma_f32_16x16x16_bf16 v[28:31], v[12:13], v[12:13], 0
    v_lshlrev_b32_e64 v15, 3, v0
    v_mfma_f32_16x16x16_bf16 v[48:51], v[12:13], v[12:13], 0
    v_bfe_u32 v14, v0, 2, 6
    v_and_or_b32 v14, v15, s94, v14
    s_waitcnt lgkmcnt(2)
    v_smfmac_f32_16x16x64_bf16 v[20:23], v[16:19], v[56:63], v2
    ds_read_b128 v[56:59], v1 offset:26624
    s_waitcnt lgkmcnt(2)
    v_smfmac_f32_16x16x64_bf16 v[20:23], v[52:55], v[40:47], v2
    s_waitcnt lgkmcnt(1)
    ds_read_b128 v[60:63], v1 offset:27648
    v_smfmac_f32_16x16x64_bf16 v[24:27], v[16:19], v[32:39], v2
    ds_read_b128 v[40:43], v1 offset:28672
    v_smfmac_f32_16x16x64_bf16 v[24:27], v[52:55], a[224:231], v2
    ds_read_b128 v[44:47], v1 offset:29696
    v_add_f32 v20, v20, v22
    v_smfmac_f32_16x16x64_bf16 v[28:31], v[16:19], a[232:239], v2
    ds_read_b128 v[32:35], v1 offset:30720
    v_add_f32_e64 v21, v21, v23
    v_smfmac_f32_16x16x64_bf16 v[28:31], v[52:55], a[240:247], v2
    ds_read_b128 v[36:39], v1 offset:31744
    v_add_f32 v24, v24, v26
    v_add_f32 v25, v25, v27
    v_cvt_pk_bf16_f32 v20, v20, v24
    v_cvt_pk_bf16_f32 v21, v21, v25
    v_and_or_b32 v20, v20, -2, 0
    v_smfmac_f32_16x16x64_bf16 v[48:51], v[16:19], a[248:255], v2
    s_waitcnt lgkmcnt(4)
    buffer_store_dwordx2 v[20:21], v7, s[28:31], 0 offen sc1
    v_smfmac_f32_16x16x64_bf16 v[48:51], v[52:55], v[56:63], v2
    s_waitcnt lgkmcnt(2)
    v_add_f32 v28, v28, v30
    v_smfmac_f32_16x16x64_bf16 v[8:11], v[16:19], v[40:47], v2
    s_waitcnt lgkmcnt(0)
    v_add_f32 v29, v29, v31
    v_smfmac_f32_16x16x64_bf16 v[8:11], v[52:55], v[32:39], v2
    s_cmp_eq_u32 s21, 3
    v_add_f32 v48, v48, v50
    v_add_f32 v49, v49, v51
    v_cvt_pk_bf16_f32 v28, v28, v48
    v_cvt_pk_bf16_f32 v29, v29, v49
    v_and_or_b32 v28, v28, -2, 0
    buffer_store_dwordx2 v[28:29], v7, s[28:31], s61 offen sc1
    v_pk_add_f32 v[8:9], v[8:9], v[10:11]
    v_cvt_pk_bf16_f32 v8, v8, v9
    v_and_or_b32 v8, v8, -2, 0
    buffer_store_dword v8, v14, s[28:31], s62 offen sc1
    s_cbranch_scc1 CH_h_235
    v_lshrrev_b32 v56, s91, v0
    v_and_b32_e64 v56, 16, v56
    v_lshlrev_b32_e64 v56, v56, s65
    v_cndmask_b32 v40, 0, v56, s[52:53]
    v_cndmask_b32 v41, 0, v56, s[54:55]
    v_cndmask_b32 v42, 0, v56, s[56:57]
    v_cndmask_b32 v43, 0, v56, s[58:59]
    v_mov_b64 v[58:59], -1
    s_mov_b32 s44, s43
    s_add_u32 s43, s43, 0x2000
    s_and_b32 s43, s43, 0x7fff
    s_add_u32 s43, s43, 163840
    s_mov_b32 s49, 0
    s_add_u32 s40, s40, 1
    s_add_u32 s90, s90, 32768
    s_mov_b32 s96, s97
    s_add_u32 s97, s97, 262144
    s_and_b32 s48, s40, 7
    s_cselect_b32 s48, 0, 8192
    s_xor_b32 s97, s97, s48
    s_add_u32 s84, s40, s99
    s_sub_u32 s84, s84, 1
    s_cmp_lg_u32 s95, 0
    s_cbranch_scc1 CH_nt_239
    s_nop 9
    s_cmp_le_u32 s21, 0
    s_cbranch_scc1 CH_d_241
    s_nop 7
CH_d_241:
    buffer_load_dwordx4 v[32:35], v0, s[28:31], s46 offen offset:0 sc1
    buffer_load_dwordx4 v[36:39], v0, s[28:31], s46 offen offset:1024 sc1
    v_mov_b64 v[8:9], 0
    v_mov_b64 v[10:11], 0
    v_mov_b64 v[12:13], 0
    v_mov_b64 v[14:15], 0
    v_mov_b64 v[48:49], 0
    v_mov_b64 v[50:51], 0
    v_mov_b64 v[52:53], 0
    v_mov_b64_e64 v[54:55], 0
    s_cmp_eq_u32 s21, 2
    s_cselect_b32 s47, 1, 0
    s_nop 15
    s_nop 6
    buffer_load_dwordx4 v[24:27], v0, s[28:31], s46 offen offset:0 sc1
    buffer_load_dwordx4 v[28:31], v0, s[28:31], s46 offen offset:1024 sc1
CH_h_238:
    s_waitcnt vmcnt(3)
    v_mfma_f32_16x16x32_bf16 v[44:47], v[40:43], v[32:35], 0
    s_waitcnt vmcnt(2)
    v_mfma_f32_16x16x32_bf16 v[44:47], v[40:43], v[36:39], v[44:47]
    v_bitop3_b32 v56, v33, v35, v37 bitop3:0xfe
    v_bitop3_b32 v57, v32, v34, v36 bitop3:0xfe
    v_bitop3_b32 v56, v56, v39, s47 bitop3:0xa8
    v_bitop3_b32 v56, v56, v57, v38 bitop3:0xfe
    v_and_b32 v56, 1, v56
    v_cmp_ne_u32_e64 vcc, 0, v56
    s_cbranch_vccnz CH_h_237
CH_ok_242:
    v_add_f32_dpp v44, v44, v44 row_ror:8 row_mask:0xf bank_mask:0xf
    v_add_f32_dpp v45, v45, v45 row_ror:8 row_mask:0xf bank_mask:0xf
    v_add_f32_dpp v46, v46, v46 row_ror:8 row_mask:0xf bank_mask:0xf
    v_add_f32_dpp v47, v47, v47 row_ror:8 row_mask:0xf bank_mask:0xf
    v_add_f32_dpp v44, v44, v44 row_ror:4 row_mask:0xf bank_mask:0xf
    v_add_f32_dpp v45, v45, v45 row_ror:4 row_mask:0xf bank_mask:0xf
    v_add_f32_dpp v46, v46, v46 row_ror:4 row_mask:0xf bank_mask:0xf
    v_add_f32_dpp v47, v47, v47 row_ror:4 row_mask:0xf bank_mask:0xf
    v_cvt_pk_bf16_f32 v56, v44, v45
    v_cvt_pk_bf16_f32 v57, v46, v47
    v_min_u32 v56, -2, v56
    buffer_store_dwordx2 v[56:57], v6, s[28:31], s43 offen sc1
CH_x0_240:
    s_barrier
    buffer_store_dwordx2 v[56:57], v6, s[36:39], s50 offen sc1
    buffer_store_dwordx2 v[58:59], v6, s[28:31], s44 offen sc1
    s_add_u32 s50, s50, 32768
    s_waitcnt vmcnt(3)
    v_mov_b64 v[16:17], 0
    v_mov_b64 v[18:19], 0
    v_mov_b64 v[20:21], 0
    v_mov_b64 v[22:23], 0
    ds_read_b128 v[32:35], v1 offset:4096
    ds_read_b128 v[36:39], v1 offset:5120
    v_add_u32 v40, s92, v0
    v_xor_b32 v42, 1024, v40
    s_nop 15
    s_nop 15
    s_nop 15
    s_nop 3
    s_branch CH_h_236
CH_h_235:
    v_mov_b64 v[48:49], 0
    v_mov_b64 v[50:51], 0
    v_mov_b64 v[52:53], 0
    v_mov_b64 v[54:55], 0
    ds_read_b128 v[32:35], v1 offset:4096
    ds_read_b128 v[36:39], v1 offset:5120
    v_add_u32 v40, s92, v0
    v_xor_b32 v42, 1024, v40
    s_mov_b32 s44, s43
    s_add_u32 s43, s43, 0x2000
    s_and_b32 s43, s43, 0x7fff
    s_add_u32 s43, s43, 163840
    s_mov_b32 s49, 0
    s_add_u32 s40, s40, 1
    s_add_u32 s90, s90, 32768
    s_mov_b32 s96, s97
    s_add_u32 s97, s97, 262144
    s_and_b32 s48, s40, 7
    s_cselect_b32 s48, 0, 8192
    s_xor_b32 s97, s97, s48
    s_add_u32 s84, s40, s99
    s_sub_u32 s84, s84, 1
    s_add_u32 s47, s98, 0
    s_load_dword s72, s[32:33], s47 glc
    s_add_u32 s47, s98, 128
    s_load_dword s73, s[32:33], s47 glc
    s_add_u32 s47, s98, 256
    s_load_dword s74, s[32:33], s47 glc
    s_add_u32 s47, s98, 384
    s_load_dword s75, s[32:33], s47 glc
    v_mfma_f32_32x32x2_f32 v[8:23], v48, v48, 0
    v_mfma_f32_32x32x2_f32 v[8:23], v48, v48, v[8:23]
    v_mfma_f32_32x32x2_f32 v[8:23], v48, v48, v[8:23]
    v_mfma_f32_32x32x2_f32 v[8:23], v48, v48, v[8:23]
    v_mfma_f32_32x32x2_f32 v[8:23], v48, v48, v[8:23]
    v_mfma_f32_32x32x2_f32 v[8:23], v48, v48, v[8:23]
    s_waitcnt vmcnt(0)
    s_barrier
    s_nop 15
    s_nop 15
    s_nop 15
    s_nop 15
    s_nop 9
    s_add_u32 s76, s40, 2
    s_min_u32 s76, s76, 64
    s_add_u32 s76, s76, s99
    s_waitcnt lgkmcnt(0)
    s_min_u32 s72, s72, s73
    s_min_u32 s72, s72, s74
    s_min_u32 s72, s72, s75
    s_cmp_lt_u32 s72, s76
    s_cselect_b32 s72, -1, 0
CH_h_236:
    s_waitcnt lgkmcnt(0)
    s_add_u32 s47, s43, s92
    buffer_load_dwordx4 v[24:27], v0, s[28:31], s47 offen sc1
    s_add_u32 s93, s90, s92
    s_add_u32 s89, s90, 4096
    s_nop 2
    s_add_u32 s47, s43, 4096
    buffer_load_dwordx4 v[28:31], v0, s[28:31], s47 offen sc1
    s_branch CH_top_215
CH_re_218:
    s_add_u32 s47, s43, s92
    buffer_load_dwordx4 v[24:27], v0, s[28:31], s47 offen sc1
    s_add_u32 s47, s43, 4096
    buffer_load_dwordx4 v[28:31], v0, s[28:31], s47 offen sc1
    s_add_u32 s49, s49, 1
    s_cmp_gt_u32 s49, 400000
    s_cbranch_scc1 L_end
    s_waitcnt vmcnt(0) lgkmcnt(0)
    v_max_u32 v41, v24, v26
    v_max3_u32 v41, v41, v28, v30
    v_cmp_eq_u32 vcc, -1, v41
    s_cbranch_vccnz CH_re_218
    ds_read_b128 v[32:35], v1 offset:4096
    ds_read_b128 v[36:39], v1 offset:5120
    v_mov_b64 v[8:9], 0
    v_mov_b64 v[10:11], 0
    v_mov_b64 v[12:13], 0
    v_mov_b64 v[14:15], 0
    v_mov_b64 v[16:17], 0
    v_mov_b64 v[18:19], 0
    v_mov_b64 v[20:21], 0
    v_mov_b64 v[22:23], 0
    v_mov_b64 v[48:49], 0
    v_mov_b64 v[50:51], 0
    v_mov_b64 v[52:53], 0
    v_mov_b64 v[54:55], 0
    s_waitcnt lgkmcnt(0)
    s_branch CH_st_217
CH_fp_221:
    s_cmp_eq_u32 s72, 0
    s_cbranch_scc1 CH_re_219
    v_and_b32 v56, 0x180, v0
    buffer_load_dword v57, v56, s[32:35], s98 offen sc1
    s_add_u32 s49, s49, 1
    s_cmp_gt_u32 s49, 400000
    s_cbranch_scc1 L_end
    s_waitcnt vmcnt(0)
    v_cmp_gt_u32 vcc, s76, v57
    s_cbranch_vccnz CH_fp_221
CH_re_219:
    s_add_u32 s47, s90, s92
    buffer_load_dwordx4 v[56:59], v0, s[36:39], s47 offen sc1
    s_add_u32 s47, s90, 4096
    buffer_load_dwordx4 v[60:63], v0, s[36:39], s47 offen sc1
    s_add_u32 s49, s49, 1
    s_cmp_gt_u32 s49, 400000
    s_cbranch_scc1 L_end
    s_waitcnt vmcnt(0)
    v_max_u32 v29, v56, v58
    v_max3_u32 v29, v29, v60, v62
    v_cmp_eq_u32 vcc, -1, v29
    s_cbranch_vccnz CH_re_219
    ds_write_b128 v28, v[56:59] offset:4096
    s_waitcnt lgkmcnt(0)
    s_branch CH_re_220
CH_nt_226:
    v_mov_b64 v[8:9], 0
    v_mov_b64 v[10:11], 0
    v_mov_b64 v[12:13], 0
    v_mov_b64 v[14:15], 0
    v_mov_b64 v[16:17], 0
    v_mov_b64 v[18:19], 0
    v_mov_b64 v[20:21], 0
    v_mov_b64 v[22:23], 0
    v_mov_b64 v[48:49], 0
    v_mov_b64 v[50:51], 0
    v_mov_b64 v[52:53], 0
    v_mov_b64 v[54:55], 0
    s_waitcnt vmcnt(0)
    s_branch CH_x0_227
CH_h_224:
    buffer_load_dwordx4 v[32:35], v0, s[28:31], s46 offen offset:0 sc1
    buffer_load_dwordx4 v[36:39], v0, s[28:31], s46 offen offset:1024 sc1
    s_waitcnt vmcnt(3)
    v_mfma_f32_16x16x32_bf16 v[44:47], v[40:43], v[24:27], 0
    s_waitcnt vmcnt(2)
    v_mfma_f32_16x16x32_bf16 v[44:47], v[40:43], v[28:31], v[44:47]
    v_bitop3_b32 v56, v25, v27, v29 bitop3:0x80
    v_bitop3_b32 v57, v24, v26, v28 bitop3:0x80
    v_bitop3_b32 v56, v56, v31, s47 bitop3:0xea
    v_bitop3_b32 v56, v56, v57, v30 bitop3:0x80
    v_and_b32 v56, 1, v56
    v_cmp_ne_u32 vcc, 1, v56
    s_cbranch_vccz CH_ok_229
    buffer_load_dwordx4 v[24:27], v0, s[28:31], s46 offen offset:0 sc1
    buffer_load_dwordx4 v[28:31], v0, s[28:31], s46 offen offset:1024 sc1
    s_add_u32 s49, s49, 1
    s_cmp_gt_u32 s49, 400000
    s_cbranch_scc1 L_end
    s_branch CH_h_225
CH_re_231:
    s_add_u32 s47, s43, s92
    buffer_load_dwordx4 v[24:27], v0, s[28:31], s47 offen sc1
    s_add_u32 s47, s43, 4096
    buffer_load_dwordx4 v[28:31], v0, s[28:31], s47 offen sc1
    s_add_u32 s49, s49, 1
    s_cmp_gt_u32 s49, 400000
    s_cbranch_scc1 L_end
    s_waitcnt vmcnt(0) lgkmcnt(0)
    v_max_u32 v41, v24, v26
    v_max3_u32 v41, v41, v28, v30
    v_cmp_eq_u32 vcc, -1, v41
    s_cbranch_vccnz CH_re_231
    ds_read_b128 v[32:35], v1 offset:4096
    ds_read_b128 v[36:39], v1 offset:5120
    v_mov_b64 v[8:9], 0
    v_mov_b64 v[10:11], 0
    v_mov_b64 v[12:13], 0
    v_mov_b64 v[14:15], 0
    v_mov_b64 v[16:17], 0
    v_mov_b64 v[18:19], 0
    v_mov_b64 v[20:21], 0
    v_mov_b64 v[22:23], 0
    v_mov_b64 v[48:49], 0
    v_mov_b64 v[50:51], 0
    v_mov_b64 v[52:53], 0
    v_mov_b64 v[54:55], 0
    s_waitcnt lgkmcnt(0)
    s_branch CH_st_230
CH_fp_234:
    s_cmp_eq_u32 s72, 0
    s_cbranch_scc1 CH_re_232
    v_and_b32 v56, 0x180, v0
    buffer_load_dword v57, v56, s[32:35], s98 offen sc1
    s_add_u32 s49, s49, 1
    s_cmp_gt_u32 s49, 400000
    s_cbranch_scc1 L_end
    s_waitcnt vmcnt(0)
    v_cmp_gt_u32 vcc, s76, v57
    s_cbranch_vccnz CH_fp_234
CH_re_232:
    s_add_u32 s47, s90, s92
    buffer_load_dwordx4 v[56:59], v0, s[36:39], s47 offen sc1
    s_add_u32 s47, s90, 4096
    buffer_load_dwordx4 v[60:63], v0, s[36:39], s47 offen sc1
    s_add_u32 s49, s49, 1
    s_cmp_gt_u32 s49, 400000
    s_cbranch_scc1 L_end
    s_waitcnt vmcnt(0)
    v_max_u32 v29, v56, v58
    v_max3_u32 v29, v29, v60, v62
    v_cmp_eq_u32 vcc, -1, v29
    s_cbranch_vccnz CH_re_232
    ds_write_b128 v28, v[56:59] offset:4096
    s_waitcnt lgkmcnt(0)
    s_branch CH_re_233
CH_nt_239:
    v_mov_b64 v[8:9], 0
    v_mov_b64 v[10:11], 0
    v_mov_b64 v[12:13], 0
    v_mov_b64 v[14:15], 0
    v_mov_b64 v[16:17], 0
    v_mov_b64 v[18:19], 0
    v_mov_b64 v[20:21], 0
    v_mov_b64 v[22:23], 0
    v_mov_b64 v[48:49], 0
    v_mov_b64 v[50:51], 0
    v_mov_b64 v[52:53], 0
    v_mov_b64 v[54:55], 0
    s_waitcnt vmcnt(0)
    s_branch CH_x0_240
CH_h_237:
    buffer_load_dwordx4 v[32:35], v0, s[28:31], s46 offen offset:0 sc1
    buffer_load_dwordx4 v[36:39], v0, s[28:31], s46 offen offset:1024 sc1
    s_waitcnt vmcnt(3)
    v_mfma_f32_16x16x32_bf16 v[44:47], v[40:43], v[24:27], 0
    s_waitcnt vmcnt(2)
    v_mfma_f32_16x16x32_bf16 v[44:47], v[40:43], v[28:31], v[44:47]
    v_bitop3_b32 v56, v25, v27, v29 bitop3:0xfe
    v_bitop3_b32 v57, v24, v26, v28 bitop3:0xfe
    v_bitop3_b32 v56, v56, v31, s47 bitop3:0xa8
    v_bitop3_b32 v56, v56, v57, v30 bitop3:0xfe
    v_and_b32 v56, 1, v56
    v_cmp_ne_u32 vcc, 0, v56
    s_cbranch_vccz CH_ok_242
    buffer_load_dwordx4 v[24:27], v0, s[28:31], s46 offen offset:0 sc1
    buffer_load_dwordx4 v[28:31], v0, s[28:31], s46 offen offset:1024 sc1
    s_add_u32 s49, s49, 1
    s_cmp_gt_u32 s49, 400000
    s_cbranch_scc1 L_end
    s_branch CH_h_238
CH_exit_216:
CH_fin_160:
    ds_read_b64 v[14:15], v3 offset:2176
    s_waitcnt lgkmcnt(0)
    v_cndmask_b32 v14, v14, v50, s[82:83]
    v_cndmask_b32 v15, v15, v51, s[82:83]
    v_lshrrev_b32 v13, 1, v0
    s_nop 0
    v_permlane16_swap_b32 v14, v15
    buffer_store_dwordx2 v[14:15], v13, s[32:35], s97 offen sc1
    s_add_u32 s47, s99, 64
    v_mov_b32 v8, s47
    s_waitcnt vmcnt(0) lgkmcnt(0)
    s_barrier
    buffer_store_dword v8, off, s[32:35], s18 sc1
    s_add_u32 s100, s100, 1
    s_cmp_ge_u32 s100, 2
    s_cbranch_scc1 L_end
    s_add_u32 s28, s28, 393216
    s_addc_u32 s29, s29, 0
    s_waitcnt vmcnt(0)
    s_branch CH_layer_156
L_end:
    s_endpgm
L_worker:
    s_sub_u32 s3, s3, 2
    s_lshl_b32 s3, s3, 5
    s_add_u32 s28, s3, s2
    s_lshr_b32 s8, s3, 5
    s_lshl_b32 s9, s2, 1
    s_add_u32 s8, s8, s9
    s_add_u32 s8, s8, 124
    s_cmp_ge_u32 s3, 128
    s_cselect_b32 s28, s8, s28
    v_readfirstlane_b32 s29, v1
    s_load_dwordx16 s[76:91], s[0:1], 0
    s_load_dwordx8 s[92:99], s[0:1], 64
    s_load_dwordx2 s[100:101], s[0:1], 96
    s_getpc_b64 s[4:5]
L_w0:
    s_mov_b32 s6, L_last - L_w0
    s_mov_b32 s7, 0x20000
    v_and_b32 v2, 63, v0
    v_lshlrev_b32 v2, 6, v2
    s_lshl_b32 s3, s2, 12
    buffer_load_dword v11, v2, s[4:7], s3 offen
    v_and_b32 v1, 63, v0
    v_lshlrev_b32 v0, 4, v1
    s_waitcnt lgkmcnt(0)
    s_mov_b64 s[4:5], s[100:101]
    s_mov_b32 s6, 268435456
    s_mov_b32 s7, 0x20000
    s_mov_b64 s[8:9], s[76:77]
    s_mov_b32 s10, 2621440
    s_mov_b32 s11, 0x20000
    s_mov_b64 s[12:13], s[96:97]
    s_mov_b32 s14, 2621440
    s_mov_b32 s15, 0x20000
    s_mov_b64 s[24:25], s[98:99]
    s_mov_b32 s26, 256
    s_mov_b32 s27, 0x20000
    s_mul_i32 s60, s29, 20480
    s_add_u32 s60, s60, 69632
    s_mov_b32 s30, 0
    s_mov_b32 s61, 0
    s_cmp_lt_u32 s28, 190
    s_cbranch_scc1 I_243
    v_mov_b64 v[4:5], 0
    v_mov_b64 v[6:7], 0
    v_bfe_u32 v9, v1, 2, 4
    v_mul_u32_u24 v9, 128, v9
    v_bfe_u32 v8, v1, 0, 2
    v_lshl_add_u32 v9, v8, 4, v9
    s_and_b32 s34, s28, 1
    s_lshl_b32 s34, s34, 2
    s_add_u32 s32, s34, s29
    s_mul_i32 s32, s32, 24576
    s_add_u32 s33, s32, 1048576
    buffer_store_dwordx4 v[4:7], v9, s[4:7], s33 offen sc1
    s_add_u32 s33, s32, 1050624
    buffer_store_dwordx4 v[4:7], v9, s[4:7], s33 offen sc1
    s_add_u32 s33, s32, 1052672
    buffer_store_dwordx4 v[4:7], v9, s[4:7], s33 offen sc1
    s_add_u32 s33, s32, 1054720
    buffer_store_dwordx4 v[4:7], v9, s[4:7], s33 offen sc1
    s_add_u32 s33, s32, 1056768
    buffer_store_dwordx4 v[4:7], v9, s[4:7], s33 offen sc1
    s_add_u32 s33, s32, 1058816
    buffer_store_dwordx4 v[4:7], v9, s[4:7], s33 offen sc1
    s_add_u32 s33, s32, 1060864
    buffer_store_dwordx4 v[4:7], v9, s[4:7], s33 offen sc1
    s_add_u32 s33, s32, 1062912
    buffer_store_dwordx4 v[4:7], v9, s[4:7], s33 offen sc1
    s_add_u32 s33, s32, 1064960
    buffer_store_dwordx4 v[4:7], v9, s[4:7], s33 offen sc1
    s_add_u32 s33, s32, 1067008
    buffer_store_dwordx4 v[4:7], v9, s[4:7], s33 offen sc1
    s_add_u32 s33, s32, 1069056
    buffer_store_dwordx4 v[4:7], v9, s[4:7], s33 offen sc1
    s_add_u32 s33, s32, 1071104
    buffer_store_dwordx4 v[4:7], v9, s[4:7], s33 offen sc1
    s_waitcnt vmcnt(0)
    s_barrier
    v_mov_b32 v8, 1
    buffer_store_dword v8, off, s[24:27], s34 offset:8 sc1
I_243:
    s_cmp_lt_u32 s28, 191
    s_cbranch_scc1 R_244
    s_lshl_b32 s32, s29, 8
    s_add_u32 s32, s32, s28
    s_cmp_lg_u32 s32, 191
    s_cbranch_scc1 NP_245
    v_bfe_u32 v8, v0, 2, 6
    v_mov_b32 v9, -1
    s_mov_b32 s38, -1
    s_mov_b32 s39, -1
    s_waitcnt vmcnt(0)
    s_mov_b32 s32, 2103296
    s_memtime s[34:35]
    s_waitcnt lgkmcnt(0)
    buffer_store_dword v9, v8, s[4:7], s32 offen sc1
    s_waitcnt vmcnt(0)
    s_memtime s[36:37]
    s_waitcnt lgkmcnt(0)
    s_sub_u32 s33, s36, s34
    s_min_u32 s38, s38, s33
    s_mov_b32 s32, 2111488
    s_memtime s[34:35]
    s_waitcnt lgkmcnt(0)
    buffer_store_dword v9, v8, s[4:7], s32 offen sc1
    s_waitcnt vmcnt(0)
    s_memtime s[36:37]
    s_waitcnt lgkmcnt(0)
    s_sub_u32 s33, s36, s34
    s_min_u32 s39, s39, s33
    s_mov_b32 s32, 2103296
    s_memtime s[34:35]
    s_waitcnt lgkmcnt(0)
    buffer_store_dword v9, v8, s[4:7], s32 offen sc1
    s_waitcnt vmcnt(0)
    s_memtime s[36:37]
    s_waitcnt lgkmcnt(0)
    s_sub_u32 s33, s36, s34
    s_min_u32 s38, s38, s33
    s_mov_b32 s32, 2111488
    s_memtime s[34:35]
    s_waitcnt lgkmcnt(0)
    buffer_store_dword v9, v8, s[4:7], s32 offen sc1
    s_waitcnt vmcnt(0)
    s_memtime s[36:37]
    s_waitcnt lgkmcnt(0)
    s_sub_u32 s33, s36, s34
    s_min_u32 s39, s39, s33
    s_mov_b32 s32, 2103296
    s_memtime s[34:35]
    s_waitcnt lgkmcnt(0)
    buffer_store_dword v9, v8, s[4:7], s32 offen sc1
    s_waitcnt vmcnt(0)
    s_memtime s[36:37]
    s_waitcnt lgkmcnt(0)
    s_sub_u32 s33, s36, s34
    s_min_u32 s38, s38, s33
    s_mov_b32 s32, 2111488
    s_memtime s[34:35]
    s_waitcnt lgkmcnt(0)
    buffer_store_dword v9, v8, s[4:7], s32 offen sc1
    s_waitcnt vmcnt(0)
    s_memtime s[36:37]
    s_waitcnt lgkmcnt(0)
    s_sub_u32 s33, s36, s34
    s_min_u32 s39, s39, s33
    s_mov_b32 s32, 2103296
    s_memtime s[34:35]
    s_waitcnt lgkmcnt(0)
    buffer_store_dword v9, v8, s[4:7], s32 offen sc1
    s_waitcnt vmcnt(0)
    s_memtime s[36:37]
    s_waitcnt lgkmcnt(0)
    s_sub_u32 s33, s36, s34
    s_min_u32 s38, s38, s33
    s_mov_b32 s32, 2111488
    s_memtime s[34:35]
    s_waitcnt lgkmcnt(0)
    buffer_store_dword v9, v8, s[4:7], s32 offen sc1
    s_waitcnt vmcnt(0)
    s_memtime s[36:37]
    s_waitcnt lgkmcnt(0)
    s_sub_u32 s33, s36, s34
    s_min_u32 s39, s39, s33
    s_mov_b32 s32, 2103296
    s_memtime s[34:35]
    s_waitcnt lgkmcnt(0)
    buffer_store_dword v9, v8, s[4:7], s32 offen sc1
    s_waitcnt vmcnt(0)
    s_memtime s[36:37]
    s_waitcnt lgkmcnt(0)
    s_sub_u32 s33, s36, s34
    s_min_u32 s38, s38, s33
    s_mov_b32 s32, 2111488
    s_memtime s[34:35]
    s_waitcnt lgkmcnt(0)
    buffer_store_dword v9, v8, s[4:7], s32 offen sc1
    s_waitcnt vmcnt(0)
    s_memtime s[36:37]
    s_waitcnt lgkmcnt(0)
    s_sub_u32 s33, s36, s34
    s_min_u32 s39, s39, s33
    s_mov_b32 s32, 2103296
    s_memtime s[34:35]
    s_waitcnt lgkmcnt(0)
    buffer_store_dword v9, v8, s[4:7], s32 offen sc1
    s_waitcnt vmcnt(0)
    s_memtime s[36:37]
    s_waitcnt lgkmcnt(0)
    s_sub_u32 s33, s36, s34
    s_min_u32 s38, s38, s33
    s_mov_b32 s32, 2111488
    s_memtime s[34:35]
    s_waitcnt lgkmcnt(0)
    buffer_store_dword v9, v8, s[4:7], s32 offen sc1
    s_waitcnt vmcnt(0)
    s_memtime s[36:37]
    s_waitcnt lgkmcnt(0)
    s_sub_u32 s33, s36, s34
    s_min_u32 s39, s39, s33
    s_cmp_lt_u32 s39, s38
    s_cselect_b32 s32, 3, 1
    v_mov_b32 v9, s32
    buffer_store_dword v9, off, s[24:27], 0 offset:4 sc1
NP_245:
    s_barrier
R_244:
    s_mul_i32 s66, s28, 6554
    s_lshr_b32 s66, s66, 16
    s_mul_i32 s67, s66, 10
    s_sub_u32 s67, s28, s67
    s_bfe_u32 s63, s28, 0x50001
    s_and_b32 s34, s28, 1
    s_lshr_b32 s35, s28, 7
    s_cmp_lt_u32 s28, 64
    s_cselect_b32 s64, 2, s34
    s_cselect_b32 s65, s34, s35
    s_lshl_b32 s34, s29, 3
    v_add_u32 v172, 0, v1
    v_mul_u32_u24 v173, 820, v172
    v_lshrrev_b32 v173, 16, v173
    v_add_u32 v173, s34, v173
    v_and_b32 v173, 15, v173
    v_xor_b32 v172, v172, v173
    v_lshlrev_b32 v220, 4, v172
    v_add_u32 v172, 64, v1
    v_mul_u32_u24 v173, 820, v172
    v_lshrrev_b32 v173, 16, v173
    v_add_u32 v173, s34, v173
    v_and_b32 v173, 15, v173
    v_xor_b32 v172, v172, v173
    v_lshlrev_b32 v221, 4, v172
    v_add_u32 v172, 128, v1
    v_mul_u32_u24 v173, 820, v172
    v_lshrrev_b32 v173, 16, v173
    v_add_u32 v173, s34, v173
    v_and_b32 v173, 15, v173
    v_xor_b32 v172, v172, v173
    v_lshlrev_b32 v222, 4, v172
    v_add_u32 v172, 192, v1
    v_mul_u32_u24 v173, 820, v172
    v_lshrrev_b32 v173, 16, v173
    v_add_u32 v173, s34, v173
    v_and_b32 v173, 15, v173
    v_xor_b32 v172, v172, v173
    v_lshlrev_b32 v223, 4, v172
    v_add_u32 v172, 256, v1
    v_mul_u32_u24 v173, 820, v172
    v_lshrrev_b32 v173, 16, v173
    v_add_u32 v173, s34, v173
    v_and_b32 v173, 15, v173
    v_xor_b32 v172, v172, v173
    v_lshlrev_b32 v224, 4, v172
    v_add_u32 v172, 320, v1
    v_mul_u32_u24 v173, 820, v172
    v_lshrrev_b32 v173, 16, v173
    v_add_u32 v173, s34, v173
    v_and_b32 v173, 15, v173
    v_xor_b32 v172, v172, v173
    v_lshlrev_b32 v225, 4, v172
    v_add_u32 v172, 384, v1
    v_mul_u32_u24 v173, 820, v172
    v_lshrrev_b32 v173, 16, v173
    v_add_u32 v173, s34, v173
    v_and_b32 v173, 15, v173
    v_xor_b32 v172, v172, v173
    v_lshlrev_b32 v226, 4, v172
    v_add_u32 v172, 448, v1
    v_mul_u32_u24 v173, 820, v172
    v_lshrrev_b32 v173, 16, v173
    v_add_u32 v173, s34, v173
    v_and_b32 v173, 15, v173
    v_xor_b32 v172, v172, v173
    v_lshlrev_b32 v227, 4, v172
    v_add_u32 v172, 512, v1
    v_mul_u32_u24 v173, 820, v172
    v_lshrrev_b32 v173, 16, v173
    v_add_u32 v173, s34, v173
    v_and_b32 v173, 15, v173
    v_xor_b32 v172, v172, v173
    v_lshlrev_b32 v228, 4, v172
    v_add_u32 v172, 576, v1
    v_mul_u32_u24 v173, 820, v172
    v_lshrrev_b32 v173, 16, v173
    v_add_u32 v173, s34, v173
    v_and_b32 v173, 15, v173
    v_xor_b32 v172, v172, v173
    v_lshlrev_b32 v229, 4, v172
    v_bfe_u32 v174, v1, 0, 2
    v_mul_u32_u24 v174, 80, v174
    v_bfe_u32 v172, v1, 2, 1
    v_mul_u32_u24 v172, 640, v172
    v_add_u32 v174, v174, v172
    v_bfe_u32 v172, v1, 3, 1
    v_mul_u32_u24 v172, 320, v172
    v_add_u32 v174, v174, v172
    v_bfe_u32 v172, v1, 4, 1
    v_mul_u32_u24 v172, 1280, v172
    v_add_u32 v174, v174, v172
    v_bfe_u32 v175, v1, 0, 2
    v_bfe_u32 v172, v1, 2, 1
    v_lshl_add_u32 v175, v172, 3, v175
    v_bfe_u32 v172, v1, 3, 1
    v_lshl_add_u32 v175, v172, 2, v175
    s_mul_i32 s34, s29, 20
    v_bfe_u32 v176, v1, 5, 1
    v_add_u32 v176, s34, v176
    v_add_u32 v172, 0, v176
    v_xor_b32 v172, v172, v175
    v_add_lshl_u32 v172, v172, v174, 4
    v_add_u32 v230, 69632, v172
    v_add_u32 v172, 2, v176
    v_xor_b32 v172, v172, v175
    v_add_lshl_u32 v172, v172, v174, 4
    v_add_u32 v231, 69632, v172
    v_add_u32 v172, 4, v176
    v_xor_b32 v172, v172, v175
    v_add_lshl_u32 v172, v172, v174, 4
    v_add_u32 v232, 69632, v172
    v_add_u32 v172, 6, v176
    v_xor_b32 v172, v172, v175
    v_add_lshl_u32 v172, v172, v174, 4
    v_add_u32 v233, 69632, v172
    v_add_u32 v172, 8, v176
    v_xor_b32 v172, v172, v175
    v_add_lshl_u32 v172, v172, v174, 4
    v_add_u32 v234, 69632, v172
    v_add_u32 v172, 10, v176
    v_xor_b32 v172, v172, v175
    v_add_lshl_u32 v172, v172, v174, 4
    v_add_u32 v235, 69632, v172
    v_add_u32 v172, 12, v176
    v_xor_b32 v172, v172, v175
    v_add_lshl_u32 v172, v172, v174, 4
    v_add_u32 v236, 69632, v172
    v_add_u32 v172, 14, v176
    v_xor_b32 v172, v172, v175
    v_add_lshl_u32 v172, v172, v174, 4
    v_add_u32 v237, 69632, v172
    v_add_u32 v172, 16, v176
    v_xor_b32 v172, v172, v175
    v_add_lshl_u32 v172, v172, v174, 4
    v_add_u32 v238, 69632, v172
    v_add_u32 v172, 18, v176
    v_xor_b32 v172, v172, v175
    v_add_lshl_u32 v172, v172, v174, 4
    v_add_u32 v239, 69632, v172
    s_lshl_b32 s34, s29, 13
    v_add_u32 v4, s34, v0
    s_lshl_b32 s34, s29, 3
    s_add_u32 s34, s34, 65536
    v_bfe_u32 v5, v1, 0, 5
    v_mul_u32_u24 v5, 32, v5
    v_add_u32 v5, s34, v5
    s_lshl_b32 s35, s29, 11
    s_lshl_b32 s36, s29, 8
    s_add_u32 s36, s36, 67584
    s_lshr_b32 s34, s29, 1
    s_lshl_b32 s34, s34, 12
    s_and_b32 s37, s29, 1
    s_lshl_b32 s37, s37, 8
    s_add_u32 s34, s34, s37
    v_bfe_u32 v3, v1, 1, 1
    v_mul_u32_u24 v3, 2048, v3
    v_bfe_u32 v172, v1, 0, 1
    v_lshl_add_u32 v3, v172, 9, v3
    v_bfe_u32 v172, v1, 2, 4
    v_lshl_add_u32 v3, v172, 4, v3
    v_add_u32 v3, s34, v3
    v_bfe_u32 v10, v1, 0, 2
    v_mul_u32_u24 v10, 32, v10
    v_add_u32 v10, s36, v10
    s_lshl_b32 s34, s29, 10
    v_add_u32 v7, s34, v0
    v_bfe_u32 v6, v1, 0, 5
    v_mul_u32_u24 v6, 32, v6
    v_add_u32 v6, 65536, v6
    v_bfe_u32 v9, v1, 0, 2
    v_mul_u32_u24 v9, 4, v9
    v_bfe_u32 v172, v1, 2, 1
    v_lshl_add_u32 v9, v172, 5, v9
    v_bfe_u32 v172, v1, 3, 1
    v_lshl_add_u32 v9, v172, 4, v9
    v_bfe_u32 v172, v1, 4, 1
    v_lshl_add_u32 v9, v172, 6, v9
    v_add_u32 v9, s36, v9
    s_mov_b32 s44, s66
    s_mov_b32 s47, 19
    s_mov_b32 s46, 64
    s_mul_i32 s50, s29, 10240
    s_mov_b32 s52, 0
    s_lshl_b32 s51, s67, 12
    s_add_u32 s51, s51, 20971520
    s_mov_b32 s58, 40960
    s_mul_i32 s54, s44, 40960
    s_add_u32 s56, s54, s52
    s_add_u32 s54, s54, s50
    s_add_u32 m0, s50, 69632
    s_nop 0
    buffer_load_dwordx4 v220, s[8:11], s54 offen lds
    s_add_u32 m0, s50, 70656
    s_nop 0
    buffer_load_dwordx4 v221, s[8:11], s54 offen lds
    s_add_u32 m0, s50, 71680
    s_nop 0
    buffer_load_dwordx4 v222, s[8:11], s54 offen lds
    s_add_u32 m0, s50, 72704
    s_nop 0
    buffer_load_dwordx4 v223, s[8:11], s54 offen lds
    s_add_u32 m0, s50, 73728
    s_nop 0
    buffer_load_dwordx4 v224, s[8:11], s54 offen lds
    s_add_u32 m0, s50, 74752
    s_nop 0
    buffer_load_dwordx4 v225, s[8:11], s54 offen lds
    s_add_u32 m0, s50, 75776
    s_nop 0
    buffer_load_dwordx4 v226, s[8:11], s54 offen lds
    s_add_u32 m0, s50, 76800
    s_nop 0
    buffer_load_dwordx4 v227, s[8:11], s54 offen lds
    s_add_u32 m0, s50, 77824
    s_nop 0
    buffer_load_dwordx4 v228, s[8:11], s54 offen lds
    s_add_u32 m0, s50, 78848
    s_nop 0
    buffer_load_dwordx4 v229, s[8:11], s54 offen lds
    s_cmp_ge_u32 s28, 160
    s_cbranch_scc1 R_246
    s_mov_b64 s[16:17], s[78:79]
    s_mov_b32 s18, 1314816
    s_mov_b32 s19, 0x20000
    s_mov_b64 s[20:21], s[80:81]
    s_mov_b32 s22, 1314816
    s_mov_b32 s23, 0x20000
    s_lshl_b32 s34, s28, 2
    s_add_u32 s34, s34, s29
    s_mul_i32 s35, s34, 13108
    s_lshr_b32 s35, s35, 16
    s_mul_i32 s36, s35, 5
    s_sub_u32 s36, s34, s36
    s_lshr_b32 s37, s35, 1
    s_and_b32 s38, s35, 1
    s_lshl_b32 s38, s38, 8
    s_add_u32 s37, s37, s38
    s_mul_i32 s37, s37, 642
    s_lshl_b32 s38, s36, 7
    s_add_u32 s37, s37, s38
    v_lshlrev_b32 v216, 1, v1
    s_add_u32 s38, s37, 2
    buffer_load_ushort v184, v216, s[16:19], s38 offen
    buffer_load_ushort v200, v216, s[20:23], s38 offen
    s_add_u32 s38, s37, 41090
    buffer_load_ushort v185, v216, s[16:19], s38 offen
    buffer_load_ushort v201, v216, s[20:23], s38 offen
    s_add_u32 s38, s37, 82178
    buffer_load_ushort v186, v216, s[16:19], s38 offen
    buffer_load_ushort v202, v216, s[20:23], s38 offen
    s_add_u32 s38, s37, 123266
    buffer_load_ushort v187, v216, s[16:19], s38 offen
    buffer_load_ushort v203, v216, s[20:23], s38 offen
    s_add_u32 s38, s37, 328706
    buffer_load_ushort v188, v216, s[16:19], s38 offen
    buffer_load_ushort v204, v216, s[20:23], s38 offen
    s_add_u32 s38, s37, 369794
    buffer_load_ushort v189, v216, s[16:19], s38 offen
    buffer_load_ushort v205, v216, s[20:23], s38 offen
    s_add_u32 s38, s37, 410882
    buffer_load_ushort v190, v216, s[16:19], s38 offen
    buffer_load_ushort v206, v216, s[20:23], s38 offen
    s_add_u32 s38, s37, 451970
    buffer_load_ushort v191, v216, s[16:19], s38 offen
    buffer_load_ushort v207, v216, s[20:23], s38 offen
    s_add_u32 s38, s37, 657410
    buffer_load_ushort v192, v216, s[16:19], s38 offen
    buffer_load_ushort v208, v216, s[20:23], s38 offen
    s_add_u32 s38, s37, 698498
    buffer_load_ushort v193, v216, s[16:19], s38 offen
    buffer_load_ushort v209, v216, s[20:23], s38 offen
    s_add_u32 s38, s37, 739586
    buffer_load_ushort v194, v216, s[16:19], s38 offen
    buffer_load_ushort v210, v216, s[20:23], s38 offen
    s_add_u32 s38, s37, 780674
    buffer_load_ushort v195, v216, s[16:19], s38 offen
    buffer_load_ushort v211, v216, s[20:23], s38 offen
    s_add_u32 s38, s37, 986114
    buffer_load_ushort v196, v216, s[16:19], s38 offen
    buffer_load_ushort v212, v216, s[20:23], s38 offen
    s_add_u32 s38, s37, 1027202
    buffer_load_ushort v197, v216, s[16:19], s38 offen
    buffer_load_ushort v213, v216, s[20:23], s38 offen
    s_add_u32 s38, s37, 1068290
    buffer_load_ushort v198, v216, s[16:19], s38 offen
    buffer_load_ushort v214, v216, s[20:23], s38 offen
    s_add_u32 s38, s37, 1109378
    buffer_load_ushort v199, v216, s[16:19], s38 offen
    buffer_load_ushort v215, v216, s[20:23], s38 offen
    s_mul_i32 s62, s35, 20480
    s_lshl_b32 s38, s36, 10
    s_add_u32 s62, s62, s38
    s_add_u32 s62, s62, 8388608
R_246:
    s_mul_i32 s34, s29, 19
    s_add_u32 s34, s34, s66
    s_mul_i32 s34, s34, 40960
    s_lshl_b32 s35, s67, 12
    s_add_u32 s34, s34, s35
    v_lshlrev_b32 v12, 6, v1
    buffer_load_dword v13, v12, s[8:11], s34 offen
    s_mov_b32 s35, 0x3acccccd
    s_lshl_b32 s34, s67, 6
    s_add_u32 s34, s34, 0
    s_lshr_b32 s34, s34, 1
    s_add_u32 s34, s34, 1
    v_bfe_u32 v173, v1, 1, 4
    v_add_u32 v173, s34, v173
    s_mul_i32 s36, s29, 160
    v_bfe_u32 v172, v1, 5, 1
    v_mul_u32_u24 v172, 8, v172
    v_add_u32 v172, s36, v172
    v_mul_u32_u24 v172, v172, v173
    v_and_b32 v174, 1, v1
    v_mul_u32_u24 v174, 160, v174
    v_add_u32 v172, v172, v174
    v_cvt_f32_u32 v172, v172
    v_cvt_f32_u32 v173, v173
    v_mul_f32 v172, s35, v172
    v_mul_f32 v173, s35, v173
    v_fract_f32 v172, v172
    v_fmamk_f32 v174, v173, 0x0, v172
    v_fmamk_f32 v175, v173, 0x3f800000, v172
    v_cos_f32 v175, v175
    v_cos_f32 v174, v174
    s_nop 0
    v_cvt_pk_bf16_f32 v178, v174, v175
    v_fmamk_f32 v176, v173, 0x40000000, v172
    v_fmamk_f32 v177, v173, 0x40400000, v172
    v_cos_f32 v177, v177
    v_cos_f32 v176, v176
    v_accvgpr_write_b32 a160, v178
    v_cvt_pk_bf16_f32 v178, v176, v177
    v_fmamk_f32 v174, v173, 0x40800000, v172
    v_fmamk_f32 v175, v173, 0x40a00000, v172
    v_cos_f32 v175, v175
    v_cos_f32 v174, v174
    v_accvgpr_write_b32 a161, v178
    v_cvt_pk_bf16_f32 v178, v174, v175
    v_fmamk_f32 v176, v173, 0x40c00000, v172
    v_fmamk_f32 v177, v173, 0x40e00000, v172
    v_cos_f32 v177, v177
    v_cos_f32 v176, v176
    v_accvgpr_write_b32 a162, v178
    v_cvt_pk_bf16_f32 v178, v176, v177
    v_fmamk_f32 v174, v173, 0x41800000, v172
    v_fmamk_f32 v175, v173, 0x41880000, v172
    v_cos_f32 v175, v175
    v_cos_f32 v174, v174
    v_accvgpr_write_b32 a163, v178
    v_cvt_pk_bf16_f32 v178, v174, v175
    v_fmamk_f32 v176, v173, 0x41900000, v172
    v_fmamk_f32 v177, v173, 0x41980000, v172
    v_cos_f32 v177, v177
    v_cos_f32 v176, v176
    v_accvgpr_write_b32 a164, v178
    v_cvt_pk_bf16_f32 v178, v176, v177
    v_fmamk_f32 v174, v173, 0x41a00000, v172
    v_fmamk_f32 v175, v173, 0x41a80000, v172
    v_cos_f32 v175, v175
    v_cos_f32 v174, v174
    v_accvgpr_write_b32 a165, v178
    v_cvt_pk_bf16_f32 v178, v174, v175
    v_fmamk_f32 v176, v173, 0x41b00000, v172
    v_fmamk_f32 v177, v173, 0x41b80000, v172
    v_cos_f32 v177, v177
    v_cos_f32 v176, v176
    v_accvgpr_write_b32 a166, v178
    v_cvt_pk_bf16_f32 v178, v176, v177
    v_fmamk_f32 v174, v173, 0x42000000, v172
    v_fmamk_f32 v175, v173, 0x42040000, v172
    v_cos_f32 v175, v175
    v_cos_f32 v174, v174
    v_accvgpr_write_b32 a167, v178
    v_cvt_pk_bf16_f32 v178, v174, v175
    v_fmamk_f32 v176, v173, 0x42080000, v172
    v_fmamk_f32 v177, v173, 0x420c0000, v172
    v_cos_f32 v177, v177
    v_cos_f32 v176, v176
    v_accvgpr_write_b32 a168, v178
    v_cvt_pk_bf16_f32 v178, v176, v177
    v_fmamk_f32 v174, v173, 0x42100000, v172
    v_fmamk_f32 v175, v173, 0x42140000, v172
    v_cos_f32 v175, v175
    v_cos_f32 v174, v174
    v_accvgpr_write_b32 a169, v178
    v_cvt_pk_bf16_f32 v178, v174, v175
    v_fmamk_f32 v176, v173, 0x42180000, v172
    v_fmamk_f32 v177, v173, 0x421c0000, v172
    v_cos_f32 v177, v177
    v_cos_f32 v176, v176
    v_accvgpr_write_b32 a170, v178
    v_cvt_pk_bf16_f32 v178, v176, v177
    v_fmamk_f32 v174, v173, 0x42400000, v172
    v_fmamk_f32 v175, v173, 0x42440000, v172
    v_cos_f32 v175, v175
    v_cos_f32 v174, v174
    v_accvgpr_write_b32 a171, v178
    v_cvt_pk_bf16_f32 v178, v174, v175
    v_fmamk_f32 v176, v173, 0x42480000, v172
    v_fmamk_f32 v177, v173, 0x424c0000, v172
    v_cos_f32 v177, v177
    v_cos_f32 v176, v176
    v_accvgpr_write_b32 a172, v178
    v_cvt_pk_bf16_f32 v178, v176, v177
    v_fmamk_f32 v174, v173, 0x42500000, v172
    v_fmamk_f32 v175, v173, 0x42540000, v172
    v_cos_f32 v175, v175
    v_cos_f32 v174, v174
    v_accvgpr_write_b32 a173, v178
    v_cvt_pk_bf16_f32 v178, v174, v175
    v_fmamk_f32 v176, v173, 0x42580000, v172
    v_fmamk_f32 v177, v173, 0x425c0000, v172
    v_cos_f32 v177, v177
    v_cos_f32 v176, v176
    v_accvgpr_write_b32 a174, v178
    v_cvt_pk_bf16_f32 v178, v176, v177
    v_fmamk_f32 v174, v173, 0x42800000, v172
    v_fmamk_f32 v175, v173, 0x42820000, v172
    v_cos_f32 v175, v175
    v_cos_f32 v174, v174
    v_accvgpr_write_b32 a175, v178
    v_cvt_pk_bf16_f32 v178, v174, v175
    v_fmamk_f32 v176, v173, 0x42840000, v172
    v_fmamk_f32 v177, v173, 0x42860000, v172
    v_cos_f32 v177, v177
    v_cos_f32 v176, v176
    v_accvgpr_write_b32 a176, v178
    v_cvt_pk_bf16_f32 v178, v176, v177
    v_fmamk_f32 v174, v173, 0x42880000, v172
    v_fmamk_f32 v175, v173, 0x428a0000, v172
    v_cos_f32 v175, v175
    v_cos_f32 v174, v174
    v_accvgpr_write_b32 a177, v178
    v_cvt_pk_bf16_f32 v178, v174, v175
    v_fmamk_f32 v176, v173, 0x428c0000, v172
    v_fmamk_f32 v177, v173, 0x428e0000, v172
    v_cos_f32 v177, v177
    v_cos_f32 v176, v176
    v_accvgpr_write_b32 a178, v178
    v_cvt_pk_bf16_f32 v178, v176, v177
    v_fmamk_f32 v174, v173, 0x42a00000, v172
    v_fmamk_f32 v175, v173, 0x42a20000, v172
    v_cos_f32 v175, v175
    v_cos_f32 v174, v174
    v_accvgpr_write_b32 a179, v178
    v_cvt_pk_bf16_f32 v178, v174, v175
    v_fmamk_f32 v176, v173, 0x42a40000, v172
    v_fmamk_f32 v177, v173, 0x42a60000, v172
    v_cos_f32 v177, v177
    v_cos_f32 v176, v176
    v_accvgpr_write_b32 a180, v178
    v_cvt_pk_bf16_f32 v178, v176, v177
    v_fmamk_f32 v174, v173, 0x42a80000, v172
    v_fmamk_f32 v175, v173, 0x42aa0000, v172
    v_cos_f32 v175, v175
    v_cos_f32 v174, v174
    v_accvgpr_write_b32 a181, v178
    v_cvt_pk_bf16_f32 v178, v174, v175
    v_fmamk_f32 v176, v173, 0x42ac0000, v172
    v_fmamk_f32 v177, v173, 0x42ae0000, v172
    v_cos_f32 v177, v177
    v_cos_f32 v176, v176
    v_accvgpr_write_b32 a182, v178
    v_cvt_pk_bf16_f32 v178, v176, v177
    v_fmamk_f32 v174, v173, 0x42c00000, v172
    v_fmamk_f32 v175, v173, 0x42c20000, v172
    v_cos_f32 v175, v175
    v_cos_f32 v174, v174
    v_accvgpr_write_b32 a183, v178
    v_cvt_pk_bf16_f32 v178, v174, v175
    v_fmamk_f32 v176, v173, 0x42c40000, v172
    v_fmamk_f32 v177, v173, 0x42c60000, v172
    v_cos_f32 v177, v177
    v_cos_f32 v176, v176
    v_accvgpr_write_b32 a184, v178
    v_cvt_pk_bf16_f32 v178, v176, v177
    v_fmamk_f32 v174, v173, 0x42c80000, v172
    v_fmamk_f32 v175, v173, 0x42ca0000, v172
    v_cos_f32 v175, v175
    v_cos_f32 v174, v174
    v_accvgpr_write_b32 a185, v178
    v_cvt_pk_bf16_f32 v178, v174, v175
    v_fmamk_f32 v176, v173, 0x42cc0000, v172
    v_fmamk_f32 v177, v173, 0x42ce0000, v172
    v_cos_f32 v177, v177
    v_cos_f32 v176, v176
    v_accvgpr_write_b32 a186, v178
    v_cvt_pk_bf16_f32 v178, v176, v177
    v_fmamk_f32 v174, v173, 0x42e00000, v172
    v_fmamk_f32 v175, v173, 0x42e20000, v172
    v_cos_f32 v175, v175
    v_cos_f32 v174, v174
    v_accvgpr_write_b32 a187, v178
    v_cvt_pk_bf16_f32 v178, v174, v175
    v_fmamk_f32 v176, v173, 0x42e40000, v172
    v_fmamk_f32 v177, v173, 0x42e60000, v172
    v_cos_f32 v177, v177
    v_cos_f32 v176, v176
    v_accvgpr_write_b32 a188, v178
    v_cvt_pk_bf16_f32 v178, v176, v177
    v_fmamk_f32 v174, v173, 0x42e80000, v172
    v_fmamk_f32 v175, v173, 0x42ea0000, v172
    v_cos_f32 v175, v175
    v_cos_f32 v174, v174
    v_accvgpr_write_b32 a189, v178
    v_cvt_pk_bf16_f32 v178, v174, v175
    v_fmamk_f32 v176, v173, 0x42ec0000, v172
    v_fmamk_f32 v177, v173, 0x42ee0000, v172
    v_cos_f32 v177, v177
    v_cos_f32 v176, v176
    v_accvgpr_write_b32 a190, v178
    v_cvt_pk_bf16_f32 v178, v176, v177
    v_fmamk_f32 v174, v173, 0x43000000, v172
    v_fmamk_f32 v175, v173, 0x43010000, v172
    v_cos_f32 v175, v175
    v_cos_f32 v174, v174
    v_accvgpr_write_b32 a191, v178
    v_cvt_pk_bf16_f32 v178, v174, v175
    v_fmamk_f32 v176, v173, 0x43020000, v172
    v_fmamk_f32 v177, v173, 0x43030000, v172
    v_cos_f32 v177, v177
    v_cos_f32 v176, v176
    v_accvgpr_write_b32 a192, v178
    v_cvt_pk_bf16_f32 v178, v176, v177
    v_fmamk_f32 v174, v173, 0x43040000, v172
    v_fmamk_f32 v175, v173, 0x43050000, v172
    v_cos_f32 v175, v175
    v_cos_f32 v174, v174
    v_accvgpr_write_b32 a193, v178
    v_cvt_pk_bf16_f32 v178, v174, v175
    v_fmamk_f32 v176, v173, 0x43060000, v172
    v_fmamk_f32 v177, v173, 0x43070000, v172
    v_cos_f32 v177, v177
    v_cos_f32 v176, v176
    v_accvgpr_write_b32 a194, v178
    v_cvt_pk_bf16_f32 v178, v176, v177
    v_fmamk_f32 v174, v173, 0x43100000, v172
    v_fmamk_f32 v175, v173, 0x43110000, v172
    v_cos_f32 v175, v175
    v_cos_f32 v174, v174
    v_accvgpr_write_b32 a195, v178
    v_cvt_pk_bf16_f32 v178, v174, v175
    v_fmamk_f32 v176, v173, 0x43120000, v172
    v_fmamk_f32 v177, v173, 0x43130000, v172
    v_cos_f32 v177, v177
    v_cos_f32 v176, v176
    v_accvgpr_write_b32 a196, v178
    v_cvt_pk_bf16_f32 v178, v176, v177
    v_fmamk_f32 v174, v173, 0x43140000, v172
    v_fmamk_f32 v175, v173, 0x43150000, v172
    v_cos_f32 v175, v175
    v_cos_f32 v174, v174
    v_accvgpr_write_b32 a197, v178
    v_cvt_pk_bf16_f32 v178, v174, v175
    v_fmamk_f32 v176, v173, 0x43160000, v172
    v_fmamk_f32 v177, v173, 0x43170000, v172
    v_cos_f32 v177, v177
    v_cos_f32 v176, v176
    v_accvgpr_write_b32 a198, v178
    v_cvt_pk_bf16_f32 v178, v176, v177
    v_accvgpr_write_b32 a199, v178
    s_lshl_b32 s34, s67, 6
    s_add_u32 s34, s34, 32
    s_lshr_b32 s34, s34, 1
    s_add_u32 s34, s34, 1
    v_bfe_u32 v173, v1, 1, 4
    v_add_u32 v173, s34, v173
    s_mul_i32 s36, s29, 160
    v_bfe_u32 v172, v1, 5, 1
    v_mul_u32_u24 v172, 8, v172
    v_add_u32 v172, s36, v172
    v_mul_u32_u24 v172, v172, v173
    v_and_b32 v174, 1, v1
    v_mul_u32_u24 v174, 160, v174
    v_add_u32 v172, v172, v174
    v_cvt_f32_u32 v172, v172
    v_cvt_f32_u32 v173, v173
    v_mul_f32 v172, s35, v172
    v_mul_f32 v173, s35, v173
    v_fract_f32 v172, v172
    v_fmamk_f32 v174, v173, 0x0, v172
    v_fmamk_f32 v175, v173, 0x3f800000, v172
    v_cos_f32 v175, v175
    v_cos_f32 v174, v174
    s_nop 0
    v_cvt_pk_bf16_f32 v178, v174, v175
    v_fmamk_f32 v176, v173, 0x40000000, v172
    v_fmamk_f32 v177, v173, 0x40400000, v172
    v_cos_f32 v177, v177
    v_cos_f32 v176, v176
    v_accvgpr_write_b32 a200, v178
    v_cvt_pk_bf16_f32 v178, v176, v177
    v_fmamk_f32 v174, v173, 0x40800000, v172
    v_fmamk_f32 v175, v173, 0x40a00000, v172
    v_cos_f32 v175, v175
    v_cos_f32 v174, v174
    v_accvgpr_write_b32 a201, v178
    v_cvt_pk_bf16_f32 v178, v174, v175
    v_fmamk_f32 v176, v173, 0x40c00000, v172
    v_fmamk_f32 v177, v173, 0x40e00000, v172
    v_cos_f32 v177, v177
    v_cos_f32 v176, v176
    v_accvgpr_write_b32 a202, v178
    v_cvt_pk_bf16_f32 v178, v176, v177
    v_fmamk_f32 v174, v173, 0x41800000, v172
    v_fmamk_f32 v175, v173, 0x41880000, v172
    v_cos_f32 v175, v175
    v_cos_f32 v174, v174
    v_accvgpr_write_b32 a203, v178
    v_cvt_pk_bf16_f32 v178, v174, v175
    v_fmamk_f32 v176, v173, 0x41900000, v172
    v_fmamk_f32 v177, v173, 0x41980000, v172
    v_cos_f32 v177, v177
    v_cos_f32 v176, v176
    v_accvgpr_write_b32 a204, v178
    v_cvt_pk_bf16_f32 v178, v176, v177
    v_fmamk_f32 v174, v173, 0x41a00000, v172
    v_fmamk_f32 v175, v173, 0x41a80000, v172
    v_cos_f32 v175, v175
    v_cos_f32 v174, v174
    v_accvgpr_write_b32 a205, v178
    v_cvt_pk_bf16_f32 v178, v174, v175
    v_fmamk_f32 v176, v173, 0x41b00000, v172
    v_fmamk_f32 v177, v173, 0x41b80000, v172
    v_cos_f32 v177, v177
    v_cos_f32 v176, v176
    v_accvgpr_write_b32 a206, v178
    v_cvt_pk_bf16_f32 v178, v176, v177
    v_fmamk_f32 v174, v173, 0x42000000, v172
    v_fmamk_f32 v175, v173, 0x42040000, v172
    v_cos_f32 v175, v175
    v_cos_f32 v174, v174
    v_accvgpr_write_b32 a207, v178
    v_cvt_pk_bf16_f32 v178, v174, v175
    v_fmamk_f32 v176, v173, 0x42080000, v172
    v_fmamk_f32 v177, v173, 0x420c0000, v172
    v_cos_f32 v177, v177
    v_cos_f32 v176, v176
    v_accvgpr_write_b32 a208, v178
    v_cvt_pk_bf16_f32 v178, v176, v177
    v_fmamk_f32 v174, v173, 0x42100000, v172
    v_fmamk_f32 v175, v173, 0x42140000, v172
    v_cos_f32 v175, v175
    v_cos_f32 v174, v174
    v_accvgpr_write_b32 a209, v178
    v_cvt_pk_bf16_f32 v178, v174, v175
    v_fmamk_f32 v176, v173, 0x42180000, v172
    v_fmamk_f32 v177, v173, 0x421c0000, v172
    v_cos_f32 v177, v177
    v_cos_f32 v176, v176
    v_accvgpr_write_b32 a210, v178
    v_cvt_pk_bf16_f32 v178, v176, v177
    v_fmamk_f32 v174, v173, 0x42400000, v172
    v_fmamk_f32 v175, v173, 0x42440000, v172
    v_cos_f32 v175, v175
    v_cos_f32 v174, v174
    v_accvgpr_write_b32 a211, v178
    v_cvt_pk_bf16_f32 v178, v174, v175
    v_fmamk_f32 v176, v173, 0x42480000, v172
    v_fmamk_f32 v177, v173, 0x424c0000, v172
    v_cos_f32 v177, v177
    v_cos_f32 v176, v176
    v_accvgpr_write_b32 a212, v178
    v_cvt_pk_bf16_f32 v178, v176, v177
    v_fmamk_f32 v174, v173, 0x42500000, v172
    v_fmamk_f32 v175, v173, 0x42540000, v172
    v_cos_f32 v175, v175
    v_cos_f32 v174, v174
    v_accvgpr_write_b32 a213, v178
    v_cvt_pk_bf16_f32 v178, v174, v175
    v_fmamk_f32 v176, v173, 0x42580000, v172
    v_fmamk_f32 v177, v173, 0x425c0000, v172
    v_cos_f32 v177, v177
    v_cos_f32 v176, v176
    v_accvgpr_write_b32 a214, v178
    v_cvt_pk_bf16_f32 v178, v176, v177
    v_fmamk_f32 v174, v173, 0x42800000, v172
    v_fmamk_f32 v175, v173, 0x42820000, v172
    v_cos_f32 v175, v175
    v_cos_f32 v174, v174
    v_accvgpr_write_b32 a215, v178
    v_cvt_pk_bf16_f32 v178, v174, v175
    v_fmamk_f32 v176, v173, 0x42840000, v172
    v_fmamk_f32 v177, v173, 0x42860000, v172
    v_cos_f32 v177, v177
    v_cos_f32 v176, v176
    v_accvgpr_write_b32 a216, v178
    v_cvt_pk_bf16_f32 v178, v176, v177
    v_fmamk_f32 v174, v173, 0x42880000, v172
    v_fmamk_f32 v175, v173, 0x428a0000, v172
    v_cos_f32 v175, v175
    v_cos_f32 v174, v174
    v_accvgpr_write_b32 a217, v178
    v_cvt_pk_bf16_f32 v178, v174, v175
    v_fmamk_f32 v176, v173, 0x428c0000, v172
    v_fmamk_f32 v177, v173, 0x428e0000, v172
    v_cos_f32 v177, v177
    v_cos_f32 v176, v176
    v_accvgpr_write_b32 a218, v178
    v_cvt_pk_bf16_f32 v178, v176, v177
    v_fmamk_f32 v174, v173, 0x42a00000, v172
    v_fmamk_f32 v175, v173, 0x42a20000, v172
    v_cos_f32 v175, v175
    v_cos_f32 v174, v174
    v_accvgpr_write_b32 a219, v178
    v_cvt_pk_bf16_f32 v178, v174, v175
    v_fmamk_f32 v176, v173, 0x42a40000, v172
    v_fmamk_f32 v177, v173, 0x42a60000, v172
    v_cos_f32 v177, v177
    v_cos_f32 v176, v176
    v_accvgpr_write_b32 a220, v178
    v_cvt_pk_bf16_f32 v178, v176, v177
    v_fmamk_f32 v174, v173, 0x42a80000, v172
    v_fmamk_f32 v175, v173, 0x42aa0000, v172
    v_cos_f32 v175, v175
    v_cos_f32 v174, v174
    v_accvgpr_write_b32 a221, v178
    v_cvt_pk_bf16_f32 v178, v174, v175
    v_fmamk_f32 v176, v173, 0x42ac0000, v172
    v_fmamk_f32 v177, v173, 0x42ae0000, v172
    v_cos_f32 v177, v177
    v_cos_f32 v176, v176
    v_accvgpr_write_b32 a222, v178
    v_cvt_pk_bf16_f32 v178, v176, v177
    v_fmamk_f32 v174, v173, 0x42c00000, v172
    v_fmamk_f32 v175, v173, 0x42c20000, v172
    v_cos_f32 v175, v175
    v_cos_f32 v174, v174
    v_accvgpr_write_b32 a223, v178
    v_cvt_pk_bf16_f32 v178, v174, v175
    v_fmamk_f32 v176, v173, 0x42c40000, v172
    v_fmamk_f32 v177, v173, 0x42c60000, v172
    v_cos_f32 v177, v177
    v_cos_f32 v176, v176
    v_accvgpr_write_b32 a224, v178
    v_cvt_pk_bf16_f32 v178, v176, v177
    v_fmamk_f32 v174, v173, 0x42c80000, v172
    v_fmamk_f32 v175, v173, 0x42ca0000, v172
    v_cos_f32 v175, v175
    v_cos_f32 v174, v174
    v_accvgpr_write_b32 a225, v178
    v_cvt_pk_bf16_f32 v178, v174, v175
    v_fmamk_f32 v176, v173, 0x42cc0000, v172
    v_fmamk_f32 v177, v173, 0x42ce0000, v172
    v_cos_f32 v177, v177
    v_cos_f32 v176, v176
    v_accvgpr_write_b32 a226, v178
    v_cvt_pk_bf16_f32 v178, v176, v177
    v_fmamk_f32 v174, v173, 0x42e00000, v172
    v_fmamk_f32 v175, v173, 0x42e20000, v172
    v_cos_f32 v175, v175
    v_cos_f32 v174, v174
    v_accvgpr_write_b32 a227, v178
    v_cvt_pk_bf16_f32 v178, v174, v175
    v_fmamk_f32 v176, v173, 0x42e40000, v172
    v_fmamk_f32 v177, v173, 0x42e60000, v172
    v_cos_f32 v177, v177
    v_cos_f32 v176, v176
    v_accvgpr_write_b32 a228, v178
    v_cvt_pk_bf16_f32 v178, v176, v177
    v_fmamk_f32 v174, v173, 0x42e80000, v172
    v_fmamk_f32 v175, v173, 0x42ea0000, v172
    v_cos_f32 v175, v175
    v_cos_f32 v174, v174
    v_accvgpr_write_b32 a229, v178
    v_cvt_pk_bf16_f32 v178, v174, v175
    v_fmamk_f32 v176, v173, 0x42ec0000, v172
    v_fmamk_f32 v177, v173, 0x42ee0000, v172
    v_cos_f32 v177, v177
    v_cos_f32 v176, v176
    v_accvgpr_write_b32 a230, v178
    v_cvt_pk_bf16_f32 v178, v176, v177
    v_fmamk_f32 v174, v173, 0x43000000, v172
    v_fmamk_f32 v175, v173, 0x43010000, v172
    v_cos_f32 v175, v175
    v_cos_f32 v174, v174
    v_accvgpr_write_b32 a231, v178
    v_cvt_pk_bf16_f32 v178, v174, v175
    v_fmamk_f32 v176, v173, 0x43020000, v172
    v_fmamk_f32 v177, v173, 0x43030000, v172
    v_cos_f32 v177, v177
    v_cos_f32 v176, v176
    v_accvgpr_write_b32 a232, v178
    v_cvt_pk_bf16_f32 v178, v176, v177
    v_fmamk_f32 v174, v173, 0x43040000, v172
    v_fmamk_f32 v175, v173, 0x43050000, v172
    v_cos_f32 v175, v175
    v_cos_f32 v174, v174
    v_accvgpr_write_b32 a233, v178
    v_cvt_pk_bf16_f32 v178, v174, v175
    v_fmamk_f32 v176, v173, 0x43060000, v172
    v_fmamk_f32 v177, v173, 0x43070000, v172
    v_cos_f32 v177, v177
    v_cos_f32 v176, v176
    v_accvgpr_write_b32 a234, v178
    v_cvt_pk_bf16_f32 v178, v176, v177
    v_fmamk_f32 v174, v173, 0x43100000, v172
    v_fmamk_f32 v175, v173, 0x43110000, v172
    v_cos_f32 v175, v175
    v_cos_f32 v174, v174
    v_accvgpr_write_b32 a235, v178
    v_cvt_pk_bf16_f32 v178, v174, v175
    v_fmamk_f32 v176, v173, 0x43120000, v172
    v_fmamk_f32 v177, v173, 0x43130000, v172
    v_cos_f32 v177, v177
    v_cos_f32 v176, v176
    v_accvgpr_write_b32 a236, v178
    v_cvt_pk_bf16_f32 v178, v176, v177
    v_fmamk_f32 v174, v173, 0x43140000, v172
    v_fmamk_f32 v175, v173, 0x43150000, v172
    v_cos_f32 v175, v175
    v_cos_f32 v174, v174
    v_accvgpr_write_b32 a237, v178
    v_cvt_pk_bf16_f32 v178, v174, v175
    v_fmamk_f32 v176, v173, 0x43160000, v172
    v_fmamk_f32 v177, v173, 0x43170000, v172
    v_cos_f32 v177, v177
    v_cos_f32 v176, v176
    v_accvgpr_write_b32 a238, v178
    v_cvt_pk_bf16_f32 v178, v176, v177
    v_accvgpr_write_b32 a239, v178
    v_bfe_u32 v173, v1, 0, 1
    v_mul_u32_u24 v173, 4, v173
    v_add_u32 v173, 8, v173
    s_mov_b32 s48, 0
P_247:
    buffer_load_dword v172, v173, s[24:27], 0 offen sc1
    s_waitcnt vmcnt(0)
    v_cmp_gt_u32 vcc, 1, v172
    s_cbranch_vccz P_248
    s_add_u32 s48, s48, 1
    s_cmp_gt_u32 s48, 200000
    s_cbranch_scc1 L_end
    s_sleep 1
    s_branch P_247
P_248:
    s_cmp_ge_u32 s28, 160
    s_cbranch_scc1 R_249
    v_lshl_or_b32 v184, v200, 16, v184
    v_lshl_or_b32 v185, v201, 16, v185
    v_lshl_or_b32 v186, v202, 16, v186
    v_lshl_or_b32 v187, v203, 16, v187
    v_lshl_or_b32 v188, v204, 16, v188
    v_lshl_or_b32 v189, v205, 16, v189
    v_lshl_or_b32 v190, v206, 16, v190
    v_lshl_or_b32 v191, v207, 16, v191
    v_lshl_or_b32 v192, v208, 16, v192
    v_lshl_or_b32 v193, v209, 16, v193
    v_lshl_or_b32 v194, v210, 16, v194
    v_lshl_or_b32 v195, v211, 16, v195
    v_lshl_or_b32 v196, v212, 16, v196
    v_lshl_or_b32 v197, v213, 16, v197
    v_lshl_or_b32 v198, v214, 16, v198
    v_lshl_or_b32 v199, v215, 16, v199
    s_add_u32 s33, s62, 0
    buffer_store_dwordx4 v[184:187], v0, s[4:7], s33 offen sc1
    s_add_u32 s33, s62, 5120
    buffer_store_dwordx4 v[188:191], v0, s[4:7], s33 offen sc1
    s_add_u32 s33, s62, 10240
    buffer_store_dwordx4 v[192:195], v0, s[4:7], s33 offen sc1
    s_add_u32 s33, s62, 15360
    buffer_store_dwordx4 v[196:199], v0, s[4:7], s33 offen sc1
R_249:
    s_cmp_ge_u32 s28, 190
    s_cbranch_scc1 R_250
    s_add_u32 s45, s44, s47
    s_mul_i32 s54, s45, 40960
    s_add_u32 s56, s54, s52
    s_add_u32 s54, s54, s50
    s_barrier
    ds_read_b128 v[16:19], v230 offset:0
    ds_read_b128 v[20:23], v231 offset:0
    ds_read_b128 v[24:27], v232 offset:0
    ds_read_b128 v[28:31], v233 offset:0
    ds_read_b128 v[32:35], v234 offset:0
    ds_read_b128 v[36:39], v235 offset:0
    ds_read_b128 v[40:43], v236 offset:0
    ds_read_b128 v[44:47], v237 offset:0
    ds_read_b128 v[48:51], v238 offset:0
    ds_read_b128 v[52:55], v239 offset:0
    s_waitcnt lgkmcnt(9)
    v_mfma_f32_32x32x16_bf16 v[96:111], v[16:19], a[160:163], 0
    s_waitcnt lgkmcnt(8)
    v_mfma_f32_32x32x16_bf16 v[96:111], v[20:23], a[164:167], v[96:111]
    s_waitcnt lgkmcnt(7)
    v_mfma_f32_32x32x16_bf16 v[96:111], v[24:27], a[168:171], v[96:111]
    s_waitcnt lgkmcnt(6)
    v_mfma_f32_32x32x16_bf16 v[96:111], v[28:31], a[172:175], v[96:111]
    s_waitcnt lgkmcnt(5)
    v_mfma_f32_32x32x16_bf16 v[96:111], v[32:35], a[176:179], v[96:111]
    s_waitcnt lgkmcnt(4)
    v_mfma_f32_32x32x16_bf16 v[96:111], v[36:39], a[180:183], v[96:111]
    s_waitcnt lgkmcnt(3)
    v_mfma_f32_32x32x16_bf16 v[96:111], v[40:43], a[184:187], v[96:111]
    s_waitcnt lgkmcnt(2)
    v_mfma_f32_32x32x16_bf16 v[96:111], v[44:47], a[188:191], v[96:111]
    s_waitcnt lgkmcnt(1)
    v_mfma_f32_32x32x16_bf16 v[96:111], v[48:51], a[192:195], v[96:111]
    s_add_u32 m0, s50, 110592
    s_nop 0
    buffer_load_dwordx4 v220, s[8:11], s54 offen lds
    s_waitcnt lgkmcnt(0)
    v_mfma_f32_32x32x16_bf16 v[96:111], v[52:55], a[196:199], v[96:111]
    s_add_u32 m0, s50, 111616
    s_nop 0
    buffer_load_dwordx4 v221, s[8:11], s54 offen lds
    v_mfma_f32_32x32x16_bf16 v[112:127], v[16:19], a[200:203], 0
    s_add_u32 m0, s50, 112640
    s_nop 0
    buffer_load_dwordx4 v222, s[8:11], s54 offen lds
    v_mfma_f32_32x32x16_bf16 v[112:127], v[20:23], a[204:207], v[112:127]
    v_mfma_f32_32x32x16_bf16 v[112:127], v[24:27], a[208:211], v[112:127]
    s_add_u32 m0, s50, 113664
    s_nop 0
    buffer_load_dwordx4 v223, s[8:11], s54 offen lds
    v_mfma_f32_32x32x16_bf16 v[112:127], v[28:31], a[212:215], v[112:127]
    v_mfma_f32_32x32x16_bf16 v[112:127], v[32:35], a[216:219], v[112:127]
    s_add_u32 m0, s50, 114688
    s_nop 0
    buffer_load_dwordx4 v224, s[8:11], s54 offen lds
    v_mfma_f32_32x32x16_bf16 v[112:127], v[36:39], a[220:223], v[112:127]
    v_mfma_f32_32x32x16_bf16 v[112:127], v[40:43], a[224:227], v[112:127]
    s_add_u32 m0, s50, 115712
    s_nop 0
    buffer_load_dwordx4 v225, s[8:11], s54 offen lds
    ds_write_b128 v4, v[96:99] offset:0
    v_mfma_f32_32x32x16_bf16 v[112:127], v[44:47], a[228:231], v[112:127]
    ds_write_b128 v4, v[100:103] offset:1024
    v_mfma_f32_32x32x16_bf16 v[112:127], v[48:51], a[232:235], v[112:127]
    s_add_u32 m0, s50, 116736
    s_nop 0
    buffer_load_dwordx4 v226, s[8:11], s54 offen lds
    ds_write_b128 v4, v[104:107] offset:2048
    v_mfma_f32_32x32x16_bf16 v[112:127], v[52:55], a[236:239], v[112:127]
    ds_write_b128 v4, v[108:111] offset:3072
    s_mov_b32 s59, 1073741824
    s_mul_i32 s55, s44, s58
    s_add_u32 s55, s55, s51
    v_mov_b64 v[128:129], 0
    s_mov_b32 s34, 0x3f803f80
    v_dot2c_f32_bf16 v128, s34, v16
    v_dot2c_f32_bf16 v129, v16, v16
    s_add_u32 m0, s50, 117760
    s_nop 0
    buffer_load_dwordx4 v227, s[8:11], s54 offen lds
    v_dot2c_f32_bf16 v128, s34, v17
    v_dot2c_f32_bf16 v129, v17, v17
    v_dot2c_f32_bf16 v128, s34, v18
    v_dot2c_f32_bf16 v129, v18, v18
    v_dot2c_f32_bf16 v128, s34, v19
    v_dot2c_f32_bf16 v129, v19, v19
    v_dot2c_f32_bf16 v128, s34, v20
    v_dot2c_f32_bf16 v129, v20, v20
    v_dot2c_f32_bf16 v128, s34, v21
    v_dot2c_f32_bf16 v129, v21, v21
    v_dot2c_f32_bf16 v128, s34, v22
    v_dot2c_f32_bf16 v129, v22, v22
    v_dot2c_f32_bf16 v128, s34, v23
    v_dot2c_f32_bf16 v129, v23, v23
    v_dot2c_f32_bf16 v128, s34, v24
    v_dot2c_f32_bf16 v129, v24, v24
    s_add_u32 m0, s50, 118784
    s_nop 0
    buffer_load_dwordx4 v228, s[8:11], s54 offen lds
    v_dot2c_f32_bf16 v128, s34, v25
    v_dot2c_f32_bf16 v129, v25, v25
    v_dot2c_f32_bf16 v128, s34, v26
    v_dot2c_f32_bf16 v129, v26, v26
    v_dot2c_f32_bf16 v128, s34, v27
    v_dot2c_f32_bf16 v129, v27, v27
    v_dot2c_f32_bf16 v128, s34, v28
    v_dot2c_f32_bf16 v129, v28, v28
    v_dot2c_f32_bf16 v128, s34, v29
    v_dot2c_f32_bf16 v129, v29, v29
    v_dot2c_f32_bf16 v128, s34, v30
    v_dot2c_f32_bf16 v129, v30, v30
    v_dot2c_f32_bf16 v128, s34, v31
    v_dot2c_f32_bf16 v129, v31, v31
    v_dot2c_f32_bf16 v128, s34, v32
    v_dot2c_f32_bf16 v129, v32, v32
    s_add_u32 m0, s50, 119808
    s_nop 0
    buffer_load_dwordx4 v229, s[8:11], s54 offen lds
    v_dot2c_f32_bf16 v128, s34, v33
    v_dot2c_f32_bf16 v129, v33, v33
    v_dot2c_f32_bf16 v128, s34, v34
    v_dot2c_f32_bf16 v129, v34, v34
    v_dot2c_f32_bf16 v128, s34, v35
    v_dot2c_f32_bf16 v129, v35, v35
    v_dot2c_f32_bf16 v128, s34, v36
    v_dot2c_f32_bf16 v129, v36, v36
    v_dot2c_f32_bf16 v128, s34, v37
    v_dot2c_f32_bf16 v129, v37, v37
    v_dot2c_f32_bf16 v128, s34, v38
    v_dot2c_f32_bf16 v129, v38, v38
    v_dot2c_f32_bf16 v128, s34, v39
    v_dot2c_f32_bf16 v129, v39, v39
    v_dot2c_f32_bf16 v128, s34, v40
    v_dot2c_f32_bf16 v129, v40, v40
    v_dot2c_f32_bf16 v128, s34, v41
    v_dot2c_f32_bf16 v129, v41, v41
    v_dot2c_f32_bf16 v128, s34, v42
    v_dot2c_f32_bf16 v129, v42, v42
    v_dot2c_f32_bf16 v128, s34, v43
    v_dot2c_f32_bf16 v129, v43, v43
    v_dot2c_f32_bf16 v128, s34, v44
    v_dot2c_f32_bf16 v129, v44, v44
    v_dot2c_f32_bf16 v128, s34, v45
    v_dot2c_f32_bf16 v129, v45, v45
    v_dot2c_f32_bf16 v128, s34, v46
    v_dot2c_f32_bf16 v129, v46, v46
    v_dot2c_f32_bf16 v128, s34, v47
    v_dot2c_f32_bf16 v129, v47, v47
    v_dot2c_f32_bf16 v128, s34, v48
    v_dot2c_f32_bf16 v129, v48, v48
    v_dot2c_f32_bf16 v128, s34, v49
    v_dot2c_f32_bf16 v129, v49, v49
    v_dot2c_f32_bf16 v128, s34, v50
    v_dot2c_f32_bf16 v129, v50, v50
    v_dot2c_f32_bf16 v128, s34, v51
    v_dot2c_f32_bf16 v129, v51, v51
    v_dot2c_f32_bf16 v128, s34, v52
    v_dot2c_f32_bf16 v129, v52, v52
    v_dot2c_f32_bf16 v128, s34, v53
    v_dot2c_f32_bf16 v129, v53, v53
    v_dot2c_f32_bf16 v128, s34, v54
    v_dot2c_f32_bf16 v129, v54, v54
    v_dot2c_f32_bf16 v128, s34, v55
    v_dot2c_f32_bf16 v129, v55, v55
    s_nop 2
    v_mov_b64 v[176:177], v[128:129]
    s_nop 1
    v_permlane32_swap_b32 v128, v176
    v_permlane32_swap_b32 v129, v177
    v_pk_add_f32 v[128:129], v[128:129], v[176:177]
    ds_write_b64 v5, v[128:129] offset:0
G_251:
    s_mov_b32 s44, s45
    s_add_u32 s45, s44, s47
    s_cmp_lt_u32 s45, s46
    s_cbranch_scc0 G_254
    s_mul_i32 s54, s45, 40960
    s_add_u32 s56, s54, s52
    s_add_u32 s54, s54, s50
    s_waitcnt vmcnt(0)
    s_barrier
    s_cmp_lg_u32 s29, 0
    s_cbranch_scc1 F_255
    s_lshl_b32 s32, s28, 5
    s_add_u32 s32, s32, s29
    s_lshl_b32 s32, s32, 2
    s_add_u32 s32, s32, 1048576
    v_mov_b32 v178, 1
    s_mov_b64 exec, 1
    buffer_store_dword v178, off, s[4:7], s32 sc1
    s_mov_b64 exec, -1
F_255:
    ds_read_b128 v[56:59], v230 offset:40960
    ds_read_b128 v[60:63], v231 offset:40960
    ds_read_b128 v[64:67], v232 offset:40960
    ds_read_b128 v[68:71], v233 offset:40960
    ds_read_b128 v[72:75], v234 offset:40960
    ds_read_b128 v[76:79], v235 offset:40960
    ds_read_b128 v[80:83], v236 offset:40960
    ds_read_b128 v[84:87], v237 offset:40960
    ds_read_b128 v[88:91], v238 offset:40960
    ds_read_b128 v[92:95], v239 offset:40960
    s_waitcnt lgkmcnt(9)
    v_mfma_f32_32x32x16_bf16 v[96:111], v[56:59], a[160:163], 0
    ds_write_b128 v4, v[112:115] offset:4096
    s_waitcnt lgkmcnt(9)
    v_mfma_f32_32x32x16_bf16 v[96:111], v[60:63], a[164:167], v[96:111]
    ds_write_b128 v4, v[116:119] offset:5120
    s_waitcnt lgkmcnt(9)
    v_mfma_f32_32x32x16_bf16 v[96:111], v[64:67], a[168:171], v[96:111]
    ds_write_b128 v4, v[120:123] offset:6144
    s_waitcnt lgkmcnt(9)
    v_mfma_f32_32x32x16_bf16 v[96:111], v[68:71], a[172:175], v[96:111]
    ds_write_b128 v4, v[124:127] offset:7168
    s_waitcnt lgkmcnt(9)
    v_mfma_f32_32x32x16_bf16 v[96:111], v[72:75], a[176:179], v[96:111]
    s_waitcnt lgkmcnt(8)
    v_mfma_f32_32x32x16_bf16 v[96:111], v[76:79], a[180:183], v[96:111]
    s_waitcnt lgkmcnt(0)
    s_barrier
    buffer_store_dwordx4 v[172:175], v7, s[4:7], s59 offen sc1
    v_mfma_f32_32x32x16_bf16 v[96:111], v[80:83], a[184:187], v[96:111]
    ds_read_b128 v[130:133], v6 offset:0
    ds_read_b128 v[134:137], v6 offset:16
    ds_read_b128 v[184:187], v3 offset:0
    ds_read_b128 v[188:191], v3 offset:1024
    ds_read_b128 v[192:195], v3 offset:8192
    ds_read_b128 v[196:199], v3 offset:9216
    v_mfma_f32_32x32x16_bf16 v[96:111], v[84:87], a[188:191], v[96:111]
    ds_read_b128 v[200:203], v3 offset:16384
    ds_read_b128 v[204:207], v3 offset:17408
    ds_read_b128 v[208:211], v3 offset:24576
    ds_read_b128 v[212:215], v3 offset:25600
    v_mfma_f32_32x32x16_bf16 v[96:111], v[88:91], a[192:195], v[96:111]
    s_add_u32 m0, s50, 69632
    s_nop 0
    buffer_load_dwordx4 v220, s[8:11], s54 offen lds
    v_mfma_f32_32x32x16_bf16 v[96:111], v[92:95], a[196:199], v[96:111]
    s_add_u32 m0, s50, 70656
    s_nop 0
    buffer_load_dwordx4 v221, s[8:11], s54 offen lds
    v_mfma_f32_32x32x16_bf16 v[112:127], v[56:59], a[200:203], 0
    s_add_u32 m0, s50, 71680
    s_nop 0
    buffer_load_dwordx4 v222, s[8:11], s54 offen lds
    s_waitcnt lgkmcnt(9)
    v_add_f32 v130, v130, v132
    v_add_f32 v131, v131, v133
    s_waitcnt lgkmcnt(8)
    v_add_f32 v130, v130, v134
    v_add_f32 v131, v131, v135
    v_add_f32 v130, v130, v136
    v_add_f32 v131, v131, v137
    v_mfma_f32_32x32x16_bf16 v[112:127], v[60:63], a[204:207], v[112:127]
    v_mul_f32 v130, 0x3acccccd, v130
    v_mul_f32 v131, 0x3acccccd, v131
    v_fma_f32 v131, -v130, v130, v131
    v_max_f32 v131, 0, v131
    v_add_f32 v131, 0x3727c5ac, v131
    v_rsq_f32 v131, v131
    v_mfma_f32_32x32x16_bf16 v[112:127], v[64:67], a[208:211], v[112:127]
    s_add_u32 m0, s50, 72704
    s_nop 0
    buffer_load_dwordx4 v223, s[8:11], s54 offen lds
    ds_write2_b32 v9, v130, v131 offset0:0 offset1:32
    ds_read_b128 v[146:149], v10 offset:128
    ds_read_b128 v[150:153], v10 offset:144
    s_waitcnt lgkmcnt(8)
    v_add_f32 v184, v184, v192
    v_add_f32 v185, v185, v193
    v_add_f32 v186, v186, v194
    v_mfma_f32_32x32x16_bf16 v[112:127], v[68:71], a[212:215], v[112:127]
    v_add_f32 v187, v187, v195
    s_waitcnt lgkmcnt(7)
    v_add_f32 v188, v188, v196
    v_add_f32 v189, v189, v197
    v_add_f32 v190, v190, v198
    v_add_f32 v191, v191, v199
    s_waitcnt lgkmcnt(6)
    v_add_f32 v184, v184, v200
    v_mfma_f32_32x32x16_bf16 v[112:127], v[72:75], a[216:219], v[112:127]
    s_add_u32 m0, s50, 73728
    s_nop 0
    buffer_load_dwordx4 v224, s[8:11], s54 offen lds
    v_add_f32 v185, v185, v201
    v_add_f32 v186, v186, v202
    v_add_f32 v187, v187, v203
    s_waitcnt lgkmcnt(5)
    v_add_f32 v188, v188, v204
    v_add_f32 v189, v189, v205
    v_add_f32 v190, v190, v206
    v_mfma_f32_32x32x16_bf16 v[112:127], v[76:79], a[220:223], v[112:127]
    v_add_f32 v191, v191, v207
    s_waitcnt lgkmcnt(4)
    v_add_f32 v184, v184, v208
    v_add_f32 v185, v185, v209
    v_add_f32 v186, v186, v210
    v_add_f32 v187, v187, v211
    s_waitcnt lgkmcnt(3)
    v_add_f32 v188, v188, v212
    v_mfma_f32_32x32x16_bf16 v[112:127], v[80:83], a[224:227], v[112:127]
    s_add_u32 m0, s50, 74752
    s_nop 0
    buffer_load_dwordx4 v225, s[8:11], s54 offen lds
    ds_write_b128 v4, v[96:99] offset:32768
    v_add_f32 v189, v189, v213
    v_add_f32 v190, v190, v214
    v_add_f32 v191, v191, v215
    s_waitcnt lgkmcnt(2)
    v_mul_f32 v184, v184, v146
    v_mul_f32 v185, v185, v147
    v_mul_f32 v186, v186, v148
    v_mfma_f32_32x32x16_bf16 v[112:127], v[84:87], a[228:231], v[112:127]
    ds_write_b128 v4, v[100:103] offset:33792
    v_mul_f32 v187, v187, v149
    s_waitcnt lgkmcnt(2)
    v_mul_f32 v188, v188, v150
    v_mul_f32 v189, v189, v151
    v_mul_f32 v190, v190, v152
    v_mul_f32 v191, v191, v153
    v_cvt_pk_bf16_f32 v172, v184, v185
    v_mfma_f32_32x32x16_bf16 v[112:127], v[88:91], a[232:235], v[112:127]
    s_add_u32 m0, s50, 75776
    s_nop 0
    buffer_load_dwordx4 v226, s[8:11], s54 offen lds
    ds_write_b128 v4, v[104:107] offset:34816
    v_cvt_pk_bf16_f32 v173, v186, v187
    v_cvt_pk_bf16_f32 v174, v188, v189
    v_cvt_pk_bf16_f32 v175, v190, v191
    v_mfma_f32_32x32x16_bf16 v[112:127], v[92:95], a[236:239], v[112:127]
    ds_write_b128 v4, v[108:111] offset:35840
    s_mov_b32 s59, s55
    s_mul_i32 s55, s44, s58
    s_add_u32 s55, s55, s51
    v_mov_b64 v[128:129], 0
    s_mov_b32 s34, 0x3f803f80
    v_dot2c_f32_bf16 v128, s34, v56
    v_dot2c_f32_bf16 v129, v56, v56
    s_add_u32 m0, s50, 76800
    s_nop 0
    buffer_load_dwordx4 v227, s[8:11], s54 offen lds
    v_dot2c_f32_bf16 v128, s34, v57
    v_dot2c_f32_bf16 v129, v57, v57
    v_dot2c_f32_bf16 v128, s34, v58
    v_dot2c_f32_bf16 v129, v58, v58
    v_dot2c_f32_bf16 v128, s34, v59
    v_dot2c_f32_bf16 v129, v59, v59
    v_dot2c_f32_bf16 v128, s34, v60
    v_dot2c_f32_bf16 v129, v60, v60
    v_dot2c_f32_bf16 v128, s34, v61
    v_dot2c_f32_bf16 v129, v61, v61
    v_dot2c_f32_bf16 v128, s34, v62
    v_dot2c_f32_bf16 v129, v62, v62
    v_dot2c_f32_bf16 v128, s34, v63
    v_dot2c_f32_bf16 v129, v63, v63
    v_dot2c_f32_bf16 v128, s34, v64
    v_dot2c_f32_bf16 v129, v64, v64
    s_add_u32 m0, s50, 77824
    s_nop 0
    buffer_load_dwordx4 v228, s[8:11], s54 offen lds
    v_dot2c_f32_bf16 v128, s34, v65
    v_dot2c_f32_bf16 v129, v65, v65
    v_dot2c_f32_bf16 v128, s34, v66
    v_dot2c_f32_bf16 v129, v66, v66
    v_dot2c_f32_bf16 v128, s34, v67
    v_dot2c_f32_bf16 v129, v67, v67
    v_dot2c_f32_bf16 v128, s34, v68
    v_dot2c_f32_bf16 v129, v68, v68
    v_dot2c_f32_bf16 v128, s34, v69
    v_dot2c_f32_bf16 v129, v69, v69
    v_dot2c_f32_bf16 v128, s34, v70
    v_dot2c_f32_bf16 v129, v70, v70
    v_dot2c_f32_bf16 v128, s34, v71
    v_dot2c_f32_bf16 v129, v71, v71
    v_dot2c_f32_bf16 v128, s34, v72
    v_dot2c_f32_bf16 v129, v72, v72
    s_add_u32 m0, s50, 78848
    s_nop 0
    buffer_load_dwordx4 v229, s[8:11], s54 offen lds
    v_dot2c_f32_bf16 v128, s34, v73
    v_dot2c_f32_bf16 v129, v73, v73
    v_dot2c_f32_bf16 v128, s34, v74
    v_dot2c_f32_bf16 v129, v74, v74
    v_dot2c_f32_bf16 v128, s34, v75
    v_dot2c_f32_bf16 v129, v75, v75
    v_dot2c_f32_bf16 v128, s34, v76
    v_dot2c_f32_bf16 v129, v76, v76
    v_dot2c_f32_bf16 v128, s34, v77
    v_dot2c_f32_bf16 v129, v77, v77
    v_dot2c_f32_bf16 v128, s34, v78
    v_dot2c_f32_bf16 v129, v78, v78
    v_dot2c_f32_bf16 v128, s34, v79
    v_dot2c_f32_bf16 v129, v79, v79
    v_dot2c_f32_bf16 v128, s34, v80
    v_dot2c_f32_bf16 v129, v80, v80
    v_dot2c_f32_bf16 v128, s34, v81
    v_dot2c_f32_bf16 v129, v81, v81
    v_dot2c_f32_bf16 v128, s34, v82
    v_dot2c_f32_bf16 v129, v82, v82
    v_dot2c_f32_bf16 v128, s34, v83
    v_dot2c_f32_bf16 v129, v83, v83
    v_dot2c_f32_bf16 v128, s34, v84
    v_dot2c_f32_bf16 v129, v84, v84
    v_dot2c_f32_bf16 v128, s34, v85
    v_dot2c_f32_bf16 v129, v85, v85
    v_dot2c_f32_bf16 v128, s34, v86
    v_dot2c_f32_bf16 v129, v86, v86
    v_dot2c_f32_bf16 v128, s34, v87
    v_dot2c_f32_bf16 v129, v87, v87
    v_dot2c_f32_bf16 v128, s34, v88
    v_dot2c_f32_bf16 v129, v88, v88
    v_dot2c_f32_bf16 v128, s34, v89
    v_dot2c_f32_bf16 v129, v89, v89
    v_dot2c_f32_bf16 v128, s34, v90
    v_dot2c_f32_bf16 v129, v90, v90
    v_dot2c_f32_bf16 v128, s34, v91
    v_dot2c_f32_bf16 v129, v91, v91
    v_dot2c_f32_bf16 v128, s34, v92
    v_dot2c_f32_bf16 v129, v92, v92
    v_dot2c_f32_bf16 v128, s34, v93
    v_dot2c_f32_bf16 v129, v93, v93
    v_dot2c_f32_bf16 v128, s34, v94
    v_dot2c_f32_bf16 v129, v94, v94
    v_dot2c_f32_bf16 v128, s34, v95
    v_dot2c_f32_bf16 v129, v95, v95
    s_nop 2
    v_mov_b64 v[176:177], v[128:129]
    s_nop 1
    v_permlane32_swap_b32 v128, v176
    v_permlane32_swap_b32 v129, v177
    v_pk_add_f32 v[128:129], v[128:129], v[176:177]
    ds_write_b64 v5, v[128:129] offset:1024
    s_mov_b32 s44, s45
    s_add_u32 s45, s44, s47
    s_cmp_lt_u32 s45, s46
    s_cbranch_scc0 G_253
    s_mul_i32 s54, s45, 40960
    s_add_u32 s56, s54, s52
    s_add_u32 s54, s54, s50
    s_waitcnt vmcnt(0)
    s_barrier
    ds_read_b128 v[16:19], v230 offset:0
    ds_read_b128 v[20:23], v231 offset:0
    ds_read_b128 v[24:27], v232 offset:0
    ds_read_b128 v[28:31], v233 offset:0
    ds_read_b128 v[32:35], v234 offset:0
    ds_read_b128 v[36:39], v235 offset:0
    ds_read_b128 v[40:43], v236 offset:0
    ds_read_b128 v[44:47], v237 offset:0
    ds_read_b128 v[48:51], v238 offset:0
    ds_read_b128 v[52:55], v239 offset:0
    s_waitcnt lgkmcnt(9)
    v_mfma_f32_32x32x16_bf16 v[96:111], v[16:19], a[160:163], 0
    ds_write_b128 v4, v[112:115] offset:36864
    s_waitcnt lgkmcnt(9)
    v_mfma_f32_32x32x16_bf16 v[96:111], v[20:23], a[164:167], v[96:111]
    ds_write_b128 v4, v[116:119] offset:37888
    s_waitcnt lgkmcnt(9)
    v_mfma_f32_32x32x16_bf16 v[96:111], v[24:27], a[168:171], v[96:111]
    ds_write_b128 v4, v[120:123] offset:38912
    s_waitcnt lgkmcnt(9)
    v_mfma_f32_32x32x16_bf16 v[96:111], v[28:31], a[172:175], v[96:111]
    ds_write_b128 v4, v[124:127] offset:39936
    s_waitcnt lgkmcnt(9)
    v_mfma_f32_32x32x16_bf16 v[96:111], v[32:35], a[176:179], v[96:111]
    s_waitcnt lgkmcnt(8)
    v_mfma_f32_32x32x16_bf16 v[96:111], v[36:39], a[180:183], v[96:111]
    s_waitcnt lgkmcnt(0)
    s_barrier
    buffer_store_dwordx4 v[172:175], v7, s[4:7], s59 offen sc1
    v_mfma_f32_32x32x16_bf16 v[96:111], v[40:43], a[184:187], v[96:111]
    ds_read_b128 v[130:133], v6 offset:1024
    ds_read_b128 v[134:137], v6 offset:1040
    ds_read_b128 v[184:187], v3 offset:32768
    ds_read_b128 v[188:191], v3 offset:33792
    ds_read_b128 v[192:195], v3 offset:40960
    ds_read_b128 v[196:199], v3 offset:41984
    v_mfma_f32_32x32x16_bf16 v[96:111], v[44:47], a[188:191], v[96:111]
    ds_read_b128 v[200:203], v3 offset:49152
    ds_read_b128 v[204:207], v3 offset:50176
    ds_read_b128 v[208:211], v3 offset:57344
    ds_read_b128 v[212:215], v3 offset:58368
    v_mfma_f32_32x32x16_bf16 v[96:111], v[48:51], a[192:195], v[96:111]
    s_add_u32 m0, s50, 110592
    s_nop 0
    buffer_load_dwordx4 v220, s[8:11], s54 offen lds
    v_mfma_f32_32x32x16_bf16 v[96:111], v[52:55], a[196:199], v[96:111]
    s_add_u32 m0, s50, 111616
    s_nop 0
    buffer_load_dwordx4 v221, s[8:11], s54 offen lds
    v_mfma_f32_32x32x16_bf16 v[112:127], v[16:19], a[200:203], 0
    s_add_u32 m0, s50, 112640
    s_nop 0
    buffer_load_dwordx4 v222, s[8:11], s54 offen lds
    s_waitcnt lgkmcnt(9)
    v_add_f32 v130, v130, v132
    v_add_f32 v131, v131, v133
    s_waitcnt lgkmcnt(8)
    v_add_f32 v130, v130, v134
    v_add_f32 v131, v131, v135
    v_add_f32 v130, v130, v136
    v_add_f32 v131, v131, v137
    v_mfma_f32_32x32x16_bf16 v[112:127], v[20:23], a[204:207], v[112:127]
    v_mul_f32 v130, 0x3acccccd, v130
    v_mul_f32 v131, 0x3acccccd, v131
    v_fma_f32 v131, -v130, v130, v131
    v_max_f32 v131, 0, v131
    v_add_f32 v131, 0x3727c5ac, v131
    v_rsq_f32 v131, v131
    v_mfma_f32_32x32x16_bf16 v[112:127], v[24:27], a[208:211], v[112:127]
    s_add_u32 m0, s50, 113664
    s_nop 0
    buffer_load_dwordx4 v223, s[8:11], s54 offen lds
    ds_write2_b32 v9, v130, v131 offset0:0 offset1:32
    ds_read_b128 v[146:149], v10 offset:128
    ds_read_b128 v[150:153], v10 offset:144
    s_waitcnt lgkmcnt(8)
    v_add_f32 v184, v184, v192
    v_add_f32 v185, v185, v193
    v_add_f32 v186, v186, v194
    v_mfma_f32_32x32x16_bf16 v[112:127], v[28:31], a[212:215], v[112:127]
    v_add_f32 v187, v187, v195
    s_waitcnt lgkmcnt(7)
    v_add_f32 v188, v188, v196
    v_add_f32 v189, v189, v197
    v_add_f32 v190, v190, v198
    v_add_f32 v191, v191, v199
    s_waitcnt lgkmcnt(6)
    v_add_f32 v184, v184, v200
    v_mfma_f32_32x32x16_bf16 v[112:127], v[32:35], a[216:219], v[112:127]
    s_add_u32 m0, s50, 114688
    s_nop 0
    buffer_load_dwordx4 v224, s[8:11], s54 offen lds
    v_add_f32 v185, v185, v201
    v_add_f32 v186, v186, v202
    v_add_f32 v187, v187, v203
    s_waitcnt lgkmcnt(5)
    v_add_f32 v188, v188, v204
    v_add_f32 v189, v189, v205
    v_add_f32 v190, v190, v206
    v_mfma_f32_32x32x16_bf16 v[112:127], v[36:39], a[220:223], v[112:127]
    v_add_f32 v191, v191, v207
    s_waitcnt lgkmcnt(4)
    v_add_f32 v184, v184, v208
    v_add_f32 v185, v185, v209
    v_add_f32 v186, v186, v210
    v_add_f32 v187, v187, v211
    s_waitcnt lgkmcnt(3)
    v_add_f32 v188, v188, v212
    v_mfma_f32_32x32x16_bf16 v[112:127], v[40:43], a[224:227], v[112:127]
    s_add_u32 m0, s50, 115712
    s_nop 0
    buffer_load_dwordx4 v225, s[8:11], s54 offen lds
    ds_write_b128 v4, v[96:99] offset:0
    v_add_f32 v189, v189, v213
    v_add_f32 v190, v190, v214
    v_add_f32 v191, v191, v215
    s_waitcnt lgkmcnt(2)
    v_mul_f32 v184, v184, v146
    v_mul_f32 v185, v185, v147
    v_mul_f32 v186, v186, v148
    v_mfma_f32_32x32x16_bf16 v[112:127], v[44:47], a[228:231], v[112:127]
    ds_write_b128 v4, v[100:103] offset:1024
    v_mul_f32 v187, v187, v149
    s_waitcnt lgkmcnt(2)
    v_mul_f32 v188, v188, v150
    v_mul_f32 v189, v189, v151
    v_mul_f32 v190, v190, v152
    v_mul_f32 v191, v191, v153
    v_cvt_pk_bf16_f32 v172, v184, v185
    v_mfma_f32_32x32x16_bf16 v[112:127], v[48:51], a[232:235], v[112:127]
    s_add_u32 m0, s50, 116736
    s_nop 0
    buffer_load_dwordx4 v226, s[8:11], s54 offen lds
    ds_write_b128 v4, v[104:107] offset:2048
    v_cvt_pk_bf16_f32 v173, v186, v187
    v_cvt_pk_bf16_f32 v174, v188, v189
    v_cvt_pk_bf16_f32 v175, v190, v191
    v_mfma_f32_32x32x16_bf16 v[112:127], v[52:55], a[236:239], v[112:127]
    ds_write_b128 v4, v[108:111] offset:3072
    s_mov_b32 s59, s55
    s_mul_i32 s55, s44, s58
    s_add_u32 s55, s55, s51
    v_mov_b64 v[128:129], 0
    s_mov_b32 s34, 0x3f803f80
    v_dot2c_f32_bf16 v128, s34, v16
    v_dot2c_f32_bf16 v129, v16, v16
    s_add_u32 m0, s50, 117760
    s_nop 0
    buffer_load_dwordx4 v227, s[8:11], s54 offen lds
    v_dot2c_f32_bf16 v128, s34, v17
    v_dot2c_f32_bf16 v129, v17, v17
    v_dot2c_f32_bf16 v128, s34, v18
    v_dot2c_f32_bf16 v129, v18, v18
    v_dot2c_f32_bf16 v128, s34, v19
    v_dot2c_f32_bf16 v129, v19, v19
    v_dot2c_f32_bf16 v128, s34, v20
    v_dot2c_f32_bf16 v129, v20, v20
    v_dot2c_f32_bf16 v128, s34, v21
    v_dot2c_f32_bf16 v129, v21, v21
    v_dot2c_f32_bf16 v128, s34, v22
    v_dot2c_f32_bf16 v129, v22, v22
    v_dot2c_f32_bf16 v128, s34, v23
    v_dot2c_f32_bf16 v129, v23, v23
    v_dot2c_f32_bf16 v128, s34, v24
    v_dot2c_f32_bf16 v129, v24, v24
    s_add_u32 m0, s50, 118784
    s_nop 0
    buffer_load_dwordx4 v228, s[8:11], s54 offen lds
    v_dot2c_f32_bf16 v128, s34, v25
    v_dot2c_f32_bf16 v129, v25, v25
    v_dot2c_f32_bf16 v128, s34, v26
    v_dot2c_f32_bf16 v129, v26, v26
    v_dot2c_f32_bf16 v128, s34, v27
    v_dot2c_f32_bf16 v129, v27, v27
    v_dot2c_f32_bf16 v128, s34, v28
    v_dot2c_f32_bf16 v129, v28, v28
    v_dot2c_f32_bf16 v128, s34, v29
    v_dot2c_f32_bf16 v129, v29, v29
    v_dot2c_f32_bf16 v128, s34, v30
    v_dot2c_f32_bf16 v129, v30, v30
    v_dot2c_f32_bf16 v128, s34, v31
    v_dot2c_f32_bf16 v129, v31, v31
    v_dot2c_f32_bf16 v128, s34, v32
    v_dot2c_f32_bf16 v129, v32, v32
    s_add_u32 m0, s50, 119808
    s_nop 0
    buffer_load_dwordx4 v229, s[8:11], s54 offen lds
    v_dot2c_f32_bf16 v128, s34, v33
    v_dot2c_f32_bf16 v129, v33, v33
    v_dot2c_f32_bf16 v128, s34, v34
    v_dot2c_f32_bf16 v129, v34, v34
    v_dot2c_f32_bf16 v128, s34, v35
    v_dot2c_f32_bf16 v129, v35, v35
    v_dot2c_f32_bf16 v128, s34, v36
    v_dot2c_f32_bf16 v129, v36, v36
    v_dot2c_f32_bf16 v128, s34, v37
    v_dot2c_f32_bf16 v129, v37, v37
    v_dot2c_f32_bf16 v128, s34, v38
    v_dot2c_f32_bf16 v129, v38, v38
    v_dot2c_f32_bf16 v128, s34, v39
    v_dot2c_f32_bf16 v129, v39, v39
    v_dot2c_f32_bf16 v128, s34, v40
    v_dot2c_f32_bf16 v129, v40, v40
    v_dot2c_f32_bf16 v128, s34, v41
    v_dot2c_f32_bf16 v129, v41, v41
    v_dot2c_f32_bf16 v128, s34, v42
    v_dot2c_f32_bf16 v129, v42, v42
    v_dot2c_f32_bf16 v128, s34, v43
    v_dot2c_f32_bf16 v129, v43, v43
    v_dot2c_f32_bf16 v128, s34, v44
    v_dot2c_f32_bf16 v129, v44, v44
    v_dot2c_f32_bf16 v128, s34, v45
    v_dot2c_f32_bf16 v129, v45, v45
    v_dot2c_f32_bf16 v128, s34, v46
    v_dot2c_f32_bf16 v129, v46, v46
    v_dot2c_f32_bf16 v128, s34, v47
    v_dot2c_f32_bf16 v129, v47, v47
    v_dot2c_f32_bf16 v128, s34, v48
    v_dot2c_f32_bf16 v129, v48, v48
    v_dot2c_f32_bf16 v128, s34, v49
    v_dot2c_f32_bf16 v129, v49, v49
    v_dot2c_f32_bf16 v128, s34, v50
    v_dot2c_f32_bf16 v129, v50, v50
    v_dot2c_f32_bf16 v128, s34, v51
    v_dot2c_f32_bf16 v129, v51, v51
    v_dot2c_f32_bf16 v128, s34, v52
    v_dot2c_f32_bf16 v129, v52, v52
    v_dot2c_f32_bf16 v128, s34, v53
    v_dot2c_f32_bf16 v129, v53, v53
    v_dot2c_f32_bf16 v128, s34, v54
    v_dot2c_f32_bf16 v129, v54, v54
    v_dot2c_f32_bf16 v128, s34, v55
    v_dot2c_f32_bf16 v129, v55, v55
    s_nop 2
    v_mov_b64 v[176:177], v[128:129]
    s_nop 1
    v_permlane32_swap_b32 v128, v176
    v_permlane32_swap_b32 v129, v177
    v_pk_add_f32 v[128:129], v[128:129], v[176:177]
    ds_write_b64 v5, v[128:129] offset:0
    s_branch G_251
G_254:
    s_waitcnt vmcnt(0)
    s_barrier
    ds_read_b128 v[56:59], v230 offset:40960
    ds_read_b128 v[60:63], v231 offset:40960
    ds_read_b128 v[64:67], v232 offset:40960
    ds_read_b128 v[68:71], v233 offset:40960
    ds_read_b128 v[72:75], v234 offset:40960
    ds_read_b128 v[76:79], v235 offset:40960
    ds_read_b128 v[80:83], v236 offset:40960
    ds_read_b128 v[84:87], v237 offset:40960
    ds_read_b128 v[88:91], v238 offset:40960
    ds_read_b128 v[92:95], v239 offset:40960
    s_waitcnt lgkmcnt(9)
    v_mfma_f32_32x32x16_bf16 v[96:111], v[56:59], a[160:163], 0
    ds_write_b128 v4, v[112:115] offset:4096
    s_waitcnt lgkmcnt(9)
    v_mfma_f32_32x32x16_bf16 v[96:111], v[60:63], a[164:167], v[96:111]
    ds_write_b128 v4, v[116:119] offset:5120
    s_waitcnt lgkmcnt(9)
    v_mfma_f32_32x32x16_bf16 v[96:111], v[64:67], a[168:171], v[96:111]
    ds_write_b128 v4, v[120:123] offset:6144
    s_waitcnt lgkmcnt(9)
    v_mfma_f32_32x32x16_bf16 v[96:111], v[68:71], a[172:175], v[96:111]
    ds_write_b128 v4, v[124:127] offset:7168
    s_waitcnt lgkmcnt(9)
    v_mfma_f32_32x32x16_bf16 v[96:111], v[72:75], a[176:179], v[96:111]
    s_waitcnt lgkmcnt(8)
    v_mfma_f32_32x32x16_bf16 v[96:111], v[76:79], a[180:183], v[96:111]
    s_waitcnt lgkmcnt(0)
    s_barrier
    buffer_store_dwordx4 v[172:175], v7, s[4:7], s59 offen sc1
    v_mfma_f32_32x32x16_bf16 v[96:111], v[80:83], a[184:187], v[96:111]
    ds_read_b128 v[130:133], v6 offset:0
    ds_read_b128 v[134:137], v6 offset:16
    ds_read_b128 v[184:187], v3 offset:0
    ds_read_b128 v[188:191], v3 offset:1024
    ds_read_b128 v[192:195], v3 offset:8192
    ds_read_b128 v[196:199], v3 offset:9216
    v_mfma_f32_32x32x16_bf16 v[96:111], v[84:87], a[188:191], v[96:111]
    ds_read_b128 v[200:203], v3 offset:16384
    ds_read_b128 v[204:207], v3 offset:17408
    ds_read_b128 v[208:211], v3 offset:24576
    ds_read_b128 v[212:215], v3 offset:25600
    v_mfma_f32_32x32x16_bf16 v[96:111], v[88:91], a[192:195], v[96:111]
    v_mfma_f32_32x32x16_bf16 v[96:111], v[92:95], a[196:199], v[96:111]
    v_mfma_f32_32x32x16_bf16 v[112:127], v[56:59], a[200:203], 0
    s_waitcnt lgkmcnt(9)
    v_add_f32 v130, v130, v132
    v_add_f32 v131, v131, v133
    s_waitcnt lgkmcnt(8)
    v_add_f32 v130, v130, v134
    v_add_f32 v131, v131, v135
    v_add_f32 v130, v130, v136
    v_add_f32 v131, v131, v137
    v_mfma_f32_32x32x16_bf16 v[112:127], v[60:63], a[204:207], v[112:127]
    v_mul_f32 v130, 0x3acccccd, v130
    v_mul_f32 v131, 0x3acccccd, v131
    v_fma_f32 v131, -v130, v130, v131
    v_max_f32 v131, 0, v131
    v_add_f32 v131, 0x3727c5ac, v131
    v_rsq_f32 v131, v131
    v_mfma_f32_32x32x16_bf16 v[112:127], v[64:67], a[208:211], v[112:127]
    ds_write2_b32 v9, v130, v131 offset0:0 offset1:32
    ds_read_b128 v[146:149], v10 offset:128
    ds_read_b128 v[150:153], v10 offset:144
    s_waitcnt lgkmcnt(8)
    v_add_f32 v184, v184, v192
    v_add_f32 v185, v185, v193
    v_add_f32 v186, v186, v194
    v_mfma_f32_32x32x16_bf16 v[112:127], v[68:71], a[212:215], v[112:127]
    v_add_f32 v187, v187, v195
    s_waitcnt lgkmcnt(7)
    v_add_f32 v188, v188, v196
    v_add_f32 v189, v189, v197
    v_add_f32 v190, v190, v198
    v_add_f32 v191, v191, v199
    s_waitcnt lgkmcnt(6)
    v_add_f32 v184, v184, v200
    v_mfma_f32_32x32x16_bf16 v[112:127], v[72:75], a[216:219], v[112:127]
    v_add_f32 v185, v185, v201
    v_add_f32 v186, v186, v202
    v_add_f32 v187, v187, v203
    s_waitcnt lgkmcnt(5)
    v_add_f32 v188, v188, v204
    v_add_f32 v189, v189, v205
    v_add_f32 v190, v190, v206
    v_mfma_f32_32x32x16_bf16 v[112:127], v[76:79], a[220:223], v[112:127]
    v_add_f32 v191, v191, v207
    s_waitcnt lgkmcnt(4)
    v_add_f32 v184, v184, v208
    v_add_f32 v185, v185, v209
    v_add_f32 v186, v186, v210
    v_add_f32 v187, v187, v211
    s_waitcnt lgkmcnt(3)
    v_add_f32 v188, v188, v212
    v_mfma_f32_32x32x16_bf16 v[112:127], v[80:83], a[224:227], v[112:127]
    ds_write_b128 v4, v[96:99] offset:32768
    v_add_f32 v189, v189, v213
    v_add_f32 v190, v190, v214
    v_add_f32 v191, v191, v215
    s_waitcnt lgkmcnt(2)
    v_mul_f32 v184, v184, v146
    v_mul_f32 v185, v185, v147
    v_mul_f32 v186, v186, v148
    v_mfma_f32_32x32x16_bf16 v[112:127], v[84:87], a[228:231], v[112:127]
    ds_write_b128 v4, v[100:103] offset:33792
    v_mul_f32 v187, v187, v149
    s_waitcnt lgkmcnt(2)
    v_mul_f32 v188, v188, v150
    v_mul_f32 v189, v189, v151
    v_mul_f32 v190, v190, v152
    v_mul_f32 v191, v191, v153
    v_cvt_pk_bf16_f32 v172, v184, v185
    v_mfma_f32_32x32x16_bf16 v[112:127], v[88:91], a[232:235], v[112:127]
    ds_write_b128 v4, v[104:107] offset:34816
    v_cvt_pk_bf16_f32 v173, v186, v187
    v_cvt_pk_bf16_f32 v174, v188, v189
    v_cvt_pk_bf16_f32 v175, v190, v191
    v_mfma_f32_32x32x16_bf16 v[112:127], v[92:95], a[236:239], v[112:127]
    ds_write_b128 v4, v[108:111] offset:35840
    s_mov_b32 s59, s55
    s_mul_i32 s55, s44, s58
    s_add_u32 s55, s55, s51
    v_mov_b64 v[128:129], 0
    s_mov_b32 s34, 0x3f803f80
    v_dot2c_f32_bf16 v128, s34, v56
    v_dot2c_f32_bf16 v129, v56, v56
    v_dot2c_f32_bf16 v128, s34, v57
    v_dot2c_f32_bf16 v129, v57, v57
    v_dot2c_f32_bf16 v128, s34, v58
    v_dot2c_f32_bf16 v129, v58, v58
    v_dot2c_f32_bf16 v128, s34, v59
    v_dot2c_f32_bf16 v129, v59, v59
    v_dot2c_f32_bf16 v128, s34, v60
    v_dot2c_f32_bf16 v129, v60, v60
    v_dot2c_f32_bf16 v128, s34, v61
    v_dot2c_f32_bf16 v129, v61, v61
    v_dot2c_f32_bf16 v128, s34, v62
    v_dot2c_f32_bf16 v129, v62, v62
    v_dot2c_f32_bf16 v128, s34, v63
    v_dot2c_f32_bf16 v129, v63, v63
    v_dot2c_f32_bf16 v128, s34, v64
    v_dot2c_f32_bf16 v129, v64, v64
    v_dot2c_f32_bf16 v128, s34, v65
    v_dot2c_f32_bf16 v129, v65, v65
    v_dot2c_f32_bf16 v128, s34, v66
    v_dot2c_f32_bf16 v129, v66, v66
    v_dot2c_f32_bf16 v128, s34, v67
    v_dot2c_f32_bf16 v129, v67, v67
    v_dot2c_f32_bf16 v128, s34, v68
    v_dot2c_f32_bf16 v129, v68, v68
    v_dot2c_f32_bf16 v128, s34, v69
    v_dot2c_f32_bf16 v129, v69, v69
    v_dot2c_f32_bf16 v128, s34, v70
    v_dot2c_f32_bf16 v129, v70, v70
    v_dot2c_f32_bf16 v128, s34, v71
    v_dot2c_f32_bf16 v129, v71, v71
    v_dot2c_f32_bf16 v128, s34, v72
    v_dot2c_f32_bf16 v129, v72, v72
    v_dot2c_f32_bf16 v128, s34, v73
    v_dot2c_f32_bf16 v129, v73, v73
    v_dot2c_f32_bf16 v128, s34, v74
    v_dot2c_f32_bf16 v129, v74, v74
    v_dot2c_f32_bf16 v128, s34, v75
    v_dot2c_f32_bf16 v129, v75, v75
    v_dot2c_f32_bf16 v128, s34, v76
    v_dot2c_f32_bf16 v129, v76, v76
    v_dot2c_f32_bf16 v128, s34, v77
    v_dot2c_f32_bf16 v129, v77, v77
    v_dot2c_f32_bf16 v128, s34, v78
    v_dot2c_f32_bf16 v129, v78, v78
    v_dot2c_f32_bf16 v128, s34, v79
    v_dot2c_f32_bf16 v129, v79, v79
    v_dot2c_f32_bf16 v128, s34, v80
    v_dot2c_f32_bf16 v129, v80, v80
    v_dot2c_f32_bf16 v128, s34, v81
    v_dot2c_f32_bf16 v129, v81, v81
    v_dot2c_f32_bf16 v128, s34, v82
    v_dot2c_f32_bf16 v129, v82, v82
    v_dot2c_f32_bf16 v128, s34, v83
    v_dot2c_f32_bf16 v129, v83, v83
    v_dot2c_f32_bf16 v128, s34, v84
    v_dot2c_f32_bf16 v129, v84, v84
    v_dot2c_f32_bf16 v128, s34, v85
    v_dot2c_f32_bf16 v129, v85, v85
    v_dot2c_f32_bf16 v128, s34, v86
    v_dot2c_f32_bf16 v129, v86, v86
    v_dot2c_f32_bf16 v128, s34, v87
    v_dot2c_f32_bf16 v129, v87, v87
    v_dot2c_f32_bf16 v128, s34, v88
    v_dot2c_f32_bf16 v129, v88, v88
    v_dot2c_f32_bf16 v128, s34, v89
    v_dot2c_f32_bf16 v129, v89, v89
    v_dot2c_f32_bf16 v128, s34, v90
    v_dot2c_f32_bf16 v129, v90, v90
    v_dot2c_f32_bf16 v128, s34, v91
    v_dot2c_f32_bf16 v129, v91, v91
    v_dot2c_f32_bf16 v128, s34, v92
    v_dot2c_f32_bf16 v129, v92, v92
    v_dot2c_f32_bf16 v128, s34, v93
    v_dot2c_f32_bf16 v129, v93, v93
    v_dot2c_f32_bf16 v128, s34, v94
    v_dot2c_f32_bf16 v129, v94, v94
    v_dot2c_f32_bf16 v128, s34, v95
    v_dot2c_f32_bf16 v129, v95, v95
    s_nop 2
    v_mov_b64 v[176:177], v[128:129]
    s_nop 1
    v_permlane32_swap_b32 v128, v176
    v_permlane32_swap_b32 v129, v177
    v_pk_add_f32 v[128:129], v[128:129], v[176:177]
    ds_write_b64 v5, v[128:129] offset:1024
    ds_write_b128 v4, v[112:115] offset:36864
    ds_write_b128 v4, v[116:119] offset:37888
    ds_write_b128 v4, v[120:123] offset:38912
    ds_write_b128 v4, v[124:127] offset:39936
    s_waitcnt vmcnt(0)
    s_waitcnt lgkmcnt(0)
    s_barrier
    buffer_store_dwordx4 v[172:175], v7, s[4:7], s59 offen sc1
    ds_read_b128 v[130:133], v6 offset:1024
    ds_read_b128 v[134:137], v6 offset:1040
    ds_read_b128 v[184:187], v3 offset:32768
    ds_read_b128 v[188:191], v3 offset:33792
    ds_read_b128 v[192:195], v3 offset:40960
    ds_read_b128 v[196:199], v3 offset:41984
    ds_read_b128 v[200:203], v3 offset:49152
    ds_read_b128 v[204:207], v3 offset:50176
    ds_read_b128 v[208:211], v3 offset:57344
    ds_read_b128 v[212:215], v3 offset:58368
    s_waitcnt lgkmcnt(9)
    v_add_f32 v130, v130, v132
    v_add_f32 v131, v131, v133
    s_waitcnt lgkmcnt(8)
    v_add_f32 v130, v130, v134
    v_add_f32 v131, v131, v135
    v_add_f32 v130, v130, v136
    v_add_f32 v131, v131, v137
    v_mul_f32 v130, 0x3acccccd, v130
    v_mul_f32 v131, 0x3acccccd, v131
    v_fma_f32 v131, -v130, v130, v131
    v_max_f32 v131, 0, v131
    v_add_f32 v131, 0x3727c5ac, v131
    v_rsq_f32 v131, v131
    s_nop 0
    ds_write2_b32 v9, v130, v131 offset0:0 offset1:32
    ds_read_b128 v[146:149], v10 offset:128
    ds_read_b128 v[150:153], v10 offset:144
    s_waitcnt lgkmcnt(8)
    v_add_f32 v184, v184, v192
    v_add_f32 v185, v185, v193
    v_add_f32 v186, v186, v194
    v_add_f32 v187, v187, v195
    s_waitcnt lgkmcnt(7)
    v_add_f32 v188, v188, v196
    v_add_f32 v189, v189, v197
    v_add_f32 v190, v190, v198
    v_add_f32 v191, v191, v199
    s_waitcnt lgkmcnt(6)
    v_add_f32 v184, v184, v200
    v_add_f32 v185, v185, v201
    v_add_f32 v186, v186, v202
    v_add_f32 v187, v187, v203
    s_waitcnt lgkmcnt(5)
    v_add_f32 v188, v188, v204
    v_add_f32 v189, v189, v205
    v_add_f32 v190, v190, v206
    v_add_f32 v191, v191, v207
    s_waitcnt lgkmcnt(4)
    v_add_f32 v184, v184, v208
    v_add_f32 v185, v185, v209
    v_add_f32 v186, v186, v210
    v_add_f32 v187, v187, v211
    s_waitcnt lgkmcnt(3)
    v_add_f32 v188, v188, v212
    v_add_f32 v189, v189, v213
    v_add_f32 v190, v190, v214
    v_add_f32 v191, v191, v215
    s_waitcnt lgkmcnt(1)
    v_mul_f32 v184, v184, v146
    v_mul_f32 v185, v185, v147
    v_mul_f32 v186, v186, v148
    v_mul_f32 v187, v187, v149
    s_waitcnt lgkmcnt(0)
    v_mul_f32 v188, v188, v150
    v_mul_f32 v189, v189, v151
    v_mul_f32 v190, v190, v152
    v_mul_f32 v191, v191, v153
    v_cvt_pk_bf16_f32 v172, v184, v185
    v_cvt_pk_bf16_f32 v173, v186, v187
    v_cvt_pk_bf16_f32 v174, v188, v189
    v_cvt_pk_bf16_f32 v175, v190, v191
    s_mov_b32 s59, s55
    buffer_store_dwordx4 v[172:175], v7, s[4:7], s59 offen sc1
    s_branch G_252
G_253:
    s_waitcnt vmcnt(0)
    s_barrier
    ds_read_b128 v[16:19], v230 offset:0
    ds_read_b128 v[20:23], v231 offset:0
    ds_read_b128 v[24:27], v232 offset:0
    ds_read_b128 v[28:31], v233 offset:0
    ds_read_b128 v[32:35], v234 offset:0
    ds_read_b128 v[36:39], v235 offset:0
    ds_read_b128 v[40:43], v236 offset:0
    ds_read_b128 v[44:47], v237 offset:0
    ds_read_b128 v[48:51], v238 offset:0
    ds_read_b128 v[52:55], v239 offset:0
    s_waitcnt lgkmcnt(9)
    v_mfma_f32_32x32x16_bf16 v[96:111], v[16:19], a[160:163], 0
    ds_write_b128 v4, v[112:115] offset:36864
    s_waitcnt lgkmcnt(9)
    v_mfma_f32_32x32x16_bf16 v[96:111], v[20:23], a[164:167], v[96:111]
    ds_write_b128 v4, v[116:119] offset:37888
    s_waitcnt lgkmcnt(9)
    v_mfma_f32_32x32x16_bf16 v[96:111], v[24:27], a[168:171], v[96:111]
    ds_write_b128 v4, v[120:123] offset:38912
    s_waitcnt lgkmcnt(9)
    v_mfma_f32_32x32x16_bf16 v[96:111], v[28:31], a[172:175], v[96:111]
    ds_write_b128 v4, v[124:127] offset:39936
    s_waitcnt lgkmcnt(9)
    v_mfma_f32_32x32x16_bf16 v[96:111], v[32:35], a[176:179], v[96:111]
    s_waitcnt lgkmcnt(8)
    v_mfma_f32_32x32x16_bf16 v[96:111], v[36:39], a[180:183], v[96:111]
    s_waitcnt lgkmcnt(0)
    s_barrier
    buffer_store_dwordx4 v[172:175], v7, s[4:7], s59 offen sc1
    v_mfma_f32_32x32x16_bf16 v[96:111], v[40:43], a[184:187], v[96:111]
    ds_read_b128 v[130:133], v6 offset:1024
    ds_read_b128 v[134:137], v6 offset:1040
    ds_read_b128 v[184:187], v3 offset:32768
    ds_read_b128 v[188:191], v3 offset:33792
    ds_read_b128 v[192:195], v3 offset:40960
    ds_read_b128 v[196:199], v3 offset:41984
    v_mfma_f32_32x32x16_bf16 v[96:111], v[44:47], a[188:191], v[96:111]
    ds_read_b128 v[200:203], v3 offset:49152
    ds_read_b128 v[204:207], v3 offset:50176
    ds_read_b128 v[208:211], v3 offset:57344
    ds_read_b128 v[212:215], v3 offset:58368
    v_mfma_f32_32x32x16_bf16 v[96:111], v[48:51], a[192:195], v[96:111]
    v_mfma_f32_32x32x16_bf16 v[96:111], v[52:55], a[196:199], v[96:111]
    v_mfma_f32_32x32x16_bf16 v[112:127], v[16:19], a[200:203], 0
    s_waitcnt lgkmcnt(9)
    v_add_f32 v130, v130, v132
    v_add_f32 v131, v131, v133
    s_waitcnt lgkmcnt(8)
    v_add_f32 v130, v130, v134
    v_add_f32 v131, v131, v135
    v_add_f32 v130, v130, v136
    v_add_f32 v131, v131, v137
    v_mfma_f32_32x32x16_bf16 v[112:127], v[20:23], a[204:207], v[112:127]
    v_mul_f32 v130, 0x3acccccd, v130
    v_mul_f32 v131, 0x3acccccd, v131
    v_fma_f32 v131, -v130, v130, v131
    v_max_f32 v131, 0, v131
    v_add_f32 v131, 0x3727c5ac, v131
    v_rsq_f32 v131, v131
    v_mfma_f32_32x32x16_bf16 v[112:127], v[24:27], a[208:211], v[112:127]
    ds_write2_b32 v9, v130, v131 offset0:0 offset1:32
    ds_read_b128 v[146:149], v10 offset:128
    ds_read_b128 v[150:153], v10 offset:144
    s_waitcnt lgkmcnt(8)
    v_add_f32 v184, v184, v192
    v_add_f32 v185, v185, v193
    v_add_f32 v186, v186, v194
    v_mfma_f32_32x32x16_bf16 v[112:127], v[28:31], a[212:215], v[112:127]
    v_add_f32 v187, v187, v195
    s_waitcnt lgkmcnt(7)
    v_add_f32 v188, v188, v196
    v_add_f32 v189, v189, v197
    v_add_f32 v190, v190, v198
    v_add_f32 v191, v191, v199
    s_waitcnt lgkmcnt(6)
    v_add_f32 v184, v184, v200
    v_mfma_f32_32x32x16_bf16 v[112:127], v[32:35], a[216:219], v[112:127]
    v_add_f32 v185, v185, v201
    v_add_f32 v186, v186, v202
    v_add_f32 v187, v187, v203
    s_waitcnt lgkmcnt(5)
    v_add_f32 v188, v188, v204
    v_add_f32 v189, v189, v205
    v_add_f32 v190, v190, v206
    v_mfma_f32_32x32x16_bf16 v[112:127], v[36:39], a[220:223], v[112:127]
    v_add_f32 v191, v191, v207
    s_waitcnt lgkmcnt(4)
    v_add_f32 v184, v184, v208
    v_add_f32 v185, v185, v209
    v_add_f32 v186, v186, v210
    v_add_f32 v187, v187, v211
    s_waitcnt lgkmcnt(3)
    v_add_f32 v188, v188, v212
    v_mfma_f32_32x32x16_bf16 v[112:127], v[40:43], a[224:227], v[112:127]
    ds_write_b128 v4, v[96:99] offset:0
    v_add_f32 v189, v189, v213
    v_add_f32 v190, v190, v214
    v_add_f32 v191, v191, v215
    s_waitcnt lgkmcnt(2)
    v_mul_f32 v184, v184, v146
    v_mul_f32 v185, v185, v147
    v_mul_f32 v186, v186, v148
    v_mfma_f32_32x32x16_bf16 v[112:127], v[44:47], a[228:231], v[112:127]
    ds_write_b128 v4, v[100:103] offset:1024
    v_mul_f32 v187, v187, v149
    s_waitcnt lgkmcnt(2)
    v_mul_f32 v188, v188, v150
    v_mul_f32 v189, v189, v151
    v_mul_f32 v190, v190, v152
    v_mul_f32 v191, v191, v153
    v_cvt_pk_bf16_f32 v172, v184, v185
    v_mfma_f32_32x32x16_bf16 v[112:127], v[48:51], a[232:235], v[112:127]
    ds_write_b128 v4, v[104:107] offset:2048
    v_cvt_pk_bf16_f32 v173, v186, v187
    v_cvt_pk_bf16_f32 v174, v188, v189
    v_cvt_pk_bf16_f32 v175, v190, v191
    v_mfma_f32_32x32x16_bf16 v[112:127], v[52:55], a[236:239], v[112:127]
    ds_write_b128 v4, v[108:111] offset:3072
    s_mov_b32 s59, s55
    s_mul_i32 s55, s44, s58
    s_add_u32 s55, s55, s51
    v_mov_b64 v[128:129], 0
    s_mov_b32 s34, 0x3f803f80
    v_dot2c_f32_bf16 v128, s34, v16
    v_dot2c_f32_bf16 v129, v16, v16
    v_dot2c_f32_bf16 v128, s34, v17
    v_dot2c_f32_bf16 v129, v17, v17
    v_dot2c_f32_bf16 v128, s34, v18
    v_dot2c_f32_bf16 v129, v18, v18
    v_dot2c_f32_bf16 v128, s34, v19
    v_dot2c_f32_bf16 v129, v19, v19
    v_dot2c_f32_bf16 v128, s34, v20
    v_dot2c_f32_bf16 v129, v20, v20
    v_dot2c_f32_bf16 v128, s34, v21
    v_dot2c_f32_bf16 v129, v21, v21
    v_dot2c_f32_bf16 v128, s34, v22
    v_dot2c_f32_bf16 v129, v22, v22
    v_dot2c_f32_bf16 v128, s34, v23
    v_dot2c_f32_bf16 v129, v23, v23
    v_dot2c_f32_bf16 v128, s34, v24
    v_dot2c_f32_bf16 v129, v24, v24
    v_dot2c_f32_bf16 v128, s34, v25
    v_dot2c_f32_bf16 v129, v25, v25
    v_dot2c_f32_bf16 v128, s34, v26
    v_dot2c_f32_bf16 v129, v26, v26
    v_dot2c_f32_bf16 v128, s34, v27
    v_dot2c_f32_bf16 v129, v27, v27
    v_dot2c_f32_bf16 v128, s34, v28
    v_dot2c_f32_bf16 v129, v28, v28
    v_dot2c_f32_bf16 v128, s34, v29
    v_dot2c_f32_bf16 v129, v29, v29
    v_dot2c_f32_bf16 v128, s34, v30
    v_dot2c_f32_bf16 v129, v30, v30
    v_dot2c_f32_bf16 v128, s34, v31
    v_dot2c_f32_bf16 v129, v31, v31
    v_dot2c_f32_bf16 v128, s34, v32
    v_dot2c_f32_bf16 v129, v32, v32
    v_dot2c_f32_bf16 v128, s34, v33
    v_dot2c_f32_bf16 v129, v33, v33
    v_dot2c_f32_bf16 v128, s34, v34
    v_dot2c_f32_bf16 v129, v34, v34
    v_dot2c_f32_bf16 v128, s34, v35
    v_dot2c_f32_bf16 v129, v35, v35
    v_dot2c_f32_bf16 v128, s34, v36
    v_dot2c_f32_bf16 v129, v36, v36
    v_dot2c_f32_bf16 v128, s34, v37
    v_dot2c_f32_bf16 v129, v37, v37
    v_dot2c_f32_bf16 v128, s34, v38
    v_dot2c_f32_bf16 v129, v38, v38
    v_dot2c_f32_bf16 v128, s34, v39
    v_dot2c_f32_bf16 v129, v39, v39
    v_dot2c_f32_bf16 v128, s34, v40
    v_dot2c_f32_bf16 v129, v40, v40
    v_dot2c_f32_bf16 v128, s34, v41
    v_dot2c_f32_bf16 v129, v41, v41
    v_dot2c_f32_bf16 v128, s34, v42
    v_dot2c_f32_bf16 v129, v42, v42
    v_dot2c_f32_bf16 v128, s34, v43
    v_dot2c_f32_bf16 v129, v43, v43
    v_dot2c_f32_bf16 v128, s34, v44
    v_dot2c_f32_bf16 v129, v44, v44
    v_dot2c_f32_bf16 v128, s34, v45
    v_dot2c_f32_bf16 v129, v45, v45
    v_dot2c_f32_bf16 v128, s34, v46
    v_dot2c_f32_bf16 v129, v46, v46
    v_dot2c_f32_bf16 v128, s34, v47
    v_dot2c_f32_bf16 v129, v47, v47
    v_dot2c_f32_bf16 v128, s34, v48
    v_dot2c_f32_bf16 v129, v48, v48
    v_dot2c_f32_bf16 v128, s34, v49
    v_dot2c_f32_bf16 v129, v49, v49
    v_dot2c_f32_bf16 v128, s34, v50
    v_dot2c_f32_bf16 v129, v50, v50
    v_dot2c_f32_bf16 v128, s34, v51
    v_dot2c_f32_bf16 v129, v51, v51
    v_dot2c_f32_bf16 v128, s34, v52
    v_dot2c_f32_bf16 v129, v52, v52
    v_dot2c_f32_bf16 v128, s34, v53
    v_dot2c_f32_bf16 v129, v53, v53
    v_dot2c_f32_bf16 v128, s34, v54
    v_dot2c_f32_bf16 v129, v54, v54
    v_dot2c_f32_bf16 v128, s34, v55
    v_dot2c_f32_bf16 v129, v55, v55
    s_nop 2
    v_mov_b64 v[176:177], v[128:129]
    s_nop 1
    v_permlane32_swap_b32 v128, v176
    v_permlane32_swap_b32 v129, v177
    v_pk_add_f32 v[128:129], v[128:129], v[176:177]
    ds_write_b64 v5, v[128:129] offset:0
    ds_write_b128 v4, v[112:115] offset:4096
    ds_write_b128 v4, v[116:119] offset:5120
    ds_write_b128 v4, v[120:123] offset:6144
    ds_write_b128 v4, v[124:127] offset:7168
    s_waitcnt vmcnt(0)
    s_waitcnt lgkmcnt(0)
    s_barrier
    buffer_store_dwordx4 v[172:175], v7, s[4:7], s59 offen sc1
    ds_read_b128 v[130:133], v6 offset:0
    ds_read_b128 v[134:137], v6 offset:16
    ds_read_b128 v[184:187], v3 offset:0
    ds_read_b128 v[188:191], v3 offset:1024
    ds_read_b128 v[192:195], v3 offset:8192
    ds_read_b128 v[196:199], v3 offset:9216
    ds_read_b128 v[200:203], v3 offset:16384
    ds_read_b128 v[204:207], v3 offset:17408
    ds_read_b128 v[208:211], v3 offset:24576
    ds_read_b128 v[212:215], v3 offset:25600
    s_waitcnt lgkmcnt(9)
    v_add_f32 v130, v130, v132
    v_add_f32 v131, v131, v133
    s_waitcnt lgkmcnt(8)
    v_add_f32 v130, v130, v134
    v_add_f32 v131, v131, v135
    v_add_f32 v130, v130, v136
    v_add_f32 v131, v131, v137
    v_mul_f32 v130, 0x3acccccd, v130
    v_mul_f32 v131, 0x3acccccd, v131
    v_fma_f32 v131, -v130, v130, v131
    v_max_f32 v131, 0, v131
    v_add_f32 v131, 0x3727c5ac, v131
    v_rsq_f32 v131, v131
    s_nop 0
    ds_write2_b32 v9, v130, v131 offset0:0 offset1:32
    ds_read_b128 v[146:149], v10 offset:128
    ds_read_b128 v[150:153], v10 offset:144
    s_waitcnt lgkmcnt(8)
    v_add_f32 v184, v184, v192
    v_add_f32 v185, v185, v193
    v_add_f32 v186, v186, v194
    v_add_f32 v187, v187, v195
    s_waitcnt lgkmcnt(7)
    v_add_f32 v188, v188, v196
    v_add_f32 v189, v189, v197
    v_add_f32 v190, v190, v198
    v_add_f32 v191, v191, v199
    s_waitcnt lgkmcnt(6)
    v_add_f32 v184, v184, v200
    v_add_f32 v185, v185, v201
    v_add_f32 v186, v186, v202
    v_add_f32 v187, v187, v203
    s_waitcnt lgkmcnt(5)
    v_add_f32 v188, v188, v204
    v_add_f32 v189, v189, v205
    v_add_f32 v190, v190, v206
    v_add_f32 v191, v191, v207
    s_waitcnt lgkmcnt(4)
    v_add_f32 v184, v184, v208
    v_add_f32 v185, v185, v209
    v_add_f32 v186, v186, v210
    v_add_f32 v187, v187, v211
    s_waitcnt lgkmcnt(3)
    v_add_f32 v188, v188, v212
    v_add_f32 v189, v189, v213
    v_add_f32 v190, v190, v214
    v_add_f32 v191, v191, v215
    s_waitcnt lgkmcnt(1)
    v_mul_f32 v184, v184, v146
    v_mul_f32 v185, v185, v147
    v_mul_f32 v186, v186, v148
    v_mul_f32 v187, v187, v149
    s_waitcnt lgkmcnt(0)
    v_mul_f32 v188, v188, v150
    v_mul_f32 v189, v189, v151
    v_mul_f32 v190, v190, v152
    v_mul_f32 v191, v191, v153
    v_cvt_pk_bf16_f32 v172, v184, v185
    v_cvt_pk_bf16_f32 v173, v186, v187
    v_cvt_pk_bf16_f32 v174, v188, v189
    v_cvt_pk_bf16_f32 v175, v190, v191
    s_mov_b32 s59, s55
    buffer_store_dwordx4 v[172:175], v7, s[4:7], s59 offen sc1
G_252:
    s_waitcnt vmcnt(0)
    s_barrier
    s_cmp_lg_u32 s29, 0
    s_cbranch_scc1 F_256
    s_lshl_b32 s32, s28, 5
    s_add_u32 s32, s32, s29
    s_lshl_b32 s32, s32, 2
    s_add_u32 s32, s32, 1073152
    v_mov_b32 v172, 1
    s_mov_b64 exec, 1
    buffer_store_dword v172, off, s[4:7], s32 sc1
    s_mov_b64 exec, -1
F_256:
R_250:
    s_cmp_lt_u32 s28, 160
    s_cbranch_scc1 R_257
    s_cmp_eq_u32 s64, 1
    s_cselect_b64 s[20:21], s[90:91], s[88:89]
    s_cmp_eq_u32 s64, 2
    s_cselect_b64 s[20:21], s[86:87], s[20:21]
    s_mov_b32 s22, 5242880
    s_mov_b32 s23, 0x20000
    v_bfe_u32 v14, v1, 2, 4
    v_mul_u32_u24 v14, 8192, v14
    v_bfe_u32 v15, v1, 0, 2
    v_lshl_add_u32 v14, v15, 4, v14
    s_lshl_b32 s38, s29, 6
    s_lshl_b32 s35, s63, 8
    s_add_u32 s38, s38, s35
    s_add_u32 m0, s60, 0
    s_add_u32 s39, s38, 2621440
    buffer_load_dwordx4 v14, s[20:23], s39 offen lds
    s_add_u32 m0, s60, 1024
    s_add_u32 s39, s38, 2752512
    buffer_load_dwordx4 v14, s[20:23], s39 offen lds
    s_add_u32 m0, s60, 2048
    s_add_u32 s39, s38, 2883584
    buffer_load_dwordx4 v14, s[20:23], s39 offen lds
    s_add_u32 m0, s60, 3072
    s_add_u32 s39, s38, 3014656
    buffer_load_dwordx4 v14, s[20:23], s39 offen lds
    s_add_u32 m0, s60, 4096
    s_add_u32 s39, s38, 3145728
    buffer_load_dwordx4 v14, s[20:23], s39 offen lds
    s_add_u32 m0, s60, 5120
    s_add_u32 s39, s38, 3276800
    buffer_load_dwordx4 v14, s[20:23], s39 offen lds
    s_add_u32 m0, s60, 6144
    s_add_u32 s39, s38, 3407872
    buffer_load_dwordx4 v14, s[20:23], s39 offen lds
    s_add_u32 m0, s60, 7168
    s_add_u32 s39, s38, 3538944
    buffer_load_dwordx4 v14, s[20:23], s39 offen lds
    s_add_u32 m0, s60, 8192
    s_add_u32 s39, s38, 3670016
    buffer_load_dwordx4 v14, s[20:23], s39 offen lds
    s_add_u32 m0, s60, 9216
    s_add_u32 s39, s38, 3801088
    buffer_load_dwordx4 v14, s[20:23], s39 offen lds
    s_add_u32 m0, s60, 10240
    s_add_u32 s39, s38, 3932160
    buffer_load_dwordx4 v14, s[20:23], s39 offen lds
    s_add_u32 m0, s60, 11264
    s_add_u32 s39, s38, 4063232
    buffer_load_dwordx4 v14, s[20:23], s39 offen lds
    s_add_u32 m0, s60, 12288
    s_add_u32 s39, s38, 4194304
    buffer_load_dwordx4 v14, s[20:23], s39 offen lds
    s_add_u32 m0, s60, 13312
    s_add_u32 s39, s38, 4325376
    buffer_load_dwordx4 v14, s[20:23], s39 offen lds
    s_add_u32 m0, s60, 14336
    s_add_u32 s39, s38, 4456448
    buffer_load_dwordx4 v14, s[20:23], s39 offen lds
    s_add_u32 m0, s60, 15360
    s_add_u32 s39, s38, 4587520
    buffer_load_dwordx4 v14, s[20:23], s39 offen lds
    s_add_u32 m0, s60, 16384
    s_add_u32 s39, s38, 4718592
    buffer_load_dwordx4 v14, s[20:23], s39 offen lds
    s_add_u32 m0, s60, 17408
    s_add_u32 s39, s38, 4849664
    buffer_load_dwordx4 v14, s[20:23], s39 offen lds
    s_add_u32 m0, s60, 18432
    s_add_u32 s39, s38, 4980736
    buffer_load_dwordx4 v14, s[20:23], s39 offen lds
    s_add_u32 m0, s60, 19456
    s_add_u32 s39, s38, 5111808
    buffer_load_dwordx4 v14, s[20:23], s39 offen lds
    s_cmp_eq_u32 s64, 1
    s_cbranch_scc1 Q_258
    v_bfe_u32 v14, v1, 5, 1
    v_mul_u32_u24 v14, 512, v14
    v_bfe_u32 v15, v1, 2, 2
    v_lshl_add_u32 v14, v15, 6, v14
    v_bfe_u32 v15, v1, 4, 1
    v_lshl_add_u32 v14, v15, 4, v14
    v_bfe_u32 v15, v1, 1, 1
    v_lshl_add_u32 v14, v15, 3, v14
    v_bfe_u32 v15, v1, 0, 1
    v_lshl_add_u32 v14, v15, 5, v14
    v_add_u32 v14, s60, v14
    s_branch Q_259
Q_258:
    v_bfe_u32 v14, v1, 5, 1
    v_mul_u32_u24 v14, 512, v14
    v_bfe_u32 v15, v1, 2, 2
    v_lshl_add_u32 v14, v15, 6, v14
    v_bfe_u32 v15, v1, 4, 1
    v_lshl_add_u32 v14, v15, 5, v14
    v_bfe_u32 v15, v1, 0, 2
    v_lshl_add_u32 v14, v15, 3, v14
    v_add_u32 v14, s60, v14
Q_259:
    s_waitcnt vmcnt(0)
    ds_read_b64_tr_b16 a[80:81], v14 offset:0
    ds_read_b64_tr_b16 a[82:83], v14 offset:256
    ds_read_b64_tr_b16 a[84:85], v14 offset:1024
    ds_read_b64_tr_b16 a[86:87], v14 offset:1280
    ds_read_b64_tr_b16 a[88:89], v14 offset:2048
    ds_read_b64_tr_b16 a[90:91], v14 offset:2304
    ds_read_b64_tr_b16 a[92:93], v14 offset:3072
    ds_read_b64_tr_b16 a[94:95], v14 offset:3328
    ds_read_b64_tr_b16 a[96:97], v14 offset:4096
    ds_read_b64_tr_b16 a[98:99], v14 offset:4352
    ds_read_b64_tr_b16 a[100:101], v14 offset:5120
    ds_read_b64_tr_b16 a[102:103], v14 offset:5376
    ds_read_b64_tr_b16 a[104:105], v14 offset:6144
    ds_read_b64_tr_b16 a[106:107], v14 offset:6400
    ds_read_b64_tr_b16 a[108:109], v14 offset:7168
    ds_read_b64_tr_b16 a[110:111], v14 offset:7424
    ds_read_b64_tr_b16 a[112:113], v14 offset:8192
    ds_read_b64_tr_b16 a[114:115], v14 offset:8448
    ds_read_b64_tr_b16 a[116:117], v14 offset:9216
    ds_read_b64_tr_b16 a[118:119], v14 offset:9472
    ds_read_b64_tr_b16 a[120:121], v14 offset:10240
    ds_read_b64_tr_b16 a[122:123], v14 offset:10496
    ds_read_b64_tr_b16 a[124:125], v14 offset:11264
    ds_read_b64_tr_b16 a[126:127], v14 offset:11520
    ds_read_b64_tr_b16 a[128:129], v14 offset:12288
    ds_read_b64_tr_b16 a[130:131], v14 offset:12544
    ds_read_b64_tr_b16 a[132:133], v14 offset:13312
    ds_read_b64_tr_b16 a[134:135], v14 offset:13568
    ds_read_b64_tr_b16 a[136:137], v14 offset:14336
    ds_read_b64_tr_b16 a[138:139], v14 offset:14592
    ds_read_b64_tr_b16 a[140:141], v14 offset:15360
    ds_read_b64_tr_b16 a[142:143], v14 offset:15616
    ds_read_b64_tr_b16 a[144:145], v14 offset:16384
    ds_read_b64_tr_b16 a[146:147], v14 offset:16640
    ds_read_b64_tr_b16 a[148:149], v14 offset:17408
    ds_read_b64_tr_b16 a[150:151], v14 offset:17664
    ds_read_b64_tr_b16 a[152:153], v14 offset:18432
    ds_read_b64_tr_b16 a[154:155], v14 offset:18688
    ds_read_b64_tr_b16 a[156:157], v14 offset:19456
    ds_read_b64_tr_b16 a[158:159], v14 offset:19712
    s_waitcnt lgkmcnt(0)
    s_cmp_eq_u32 s64, 1
    s_cselect_b64 s[20:21], s[90:91], s[88:89]
    s_cmp_eq_u32 s64, 2
    s_cselect_b64 s[20:21], s[86:87], s[20:21]
    s_mov_b32 s22, 5242880
    s_mov_b32 s23, 0x20000
    v_bfe_u32 v14, v1, 2, 4
    v_mul_u32_u24 v14, 8192, v14
    v_bfe_u32 v15, v1, 0, 2
    v_lshl_add_u32 v14, v15, 4, v14
    s_lshl_b32 s38, s29, 6
    s_lshl_b32 s35, s63, 8
    s_add_u32 s38, s38, s35
    s_add_u32 m0, s60, 0
    s_add_u32 s39, s38, 0
    buffer_load_dwordx4 v14, s[20:23], s39 offen lds
    s_add_u32 m0, s60, 1024
    s_add_u32 s39, s38, 131072
    buffer_load_dwordx4 v14, s[20:23], s39 offen lds
    s_add_u32 m0, s60, 2048
    s_add_u32 s39, s38, 262144
    buffer_load_dwordx4 v14, s[20:23], s39 offen lds
    s_add_u32 m0, s60, 3072
    s_add_u32 s39, s38, 393216
    buffer_load_dwordx4 v14, s[20:23], s39 offen lds
    s_add_u32 m0, s60, 4096
    s_add_u32 s39, s38, 524288
    buffer_load_dwordx4 v14, s[20:23], s39 offen lds
    s_add_u32 m0, s60, 5120
    s_add_u32 s39, s38, 655360
    buffer_load_dwordx4 v14, s[20:23], s39 offen lds
    s_add_u32 m0, s60, 6144
    s_add_u32 s39, s38, 786432
    buffer_load_dwordx4 v14, s[20:23], s39 offen lds
    s_add_u32 m0, s60, 7168
    s_add_u32 s39, s38, 917504
    buffer_load_dwordx4 v14, s[20:23], s39 offen lds
    s_add_u32 m0, s60, 8192
    s_add_u32 s39, s38, 1048576
    buffer_load_dwordx4 v14, s[20:23], s39 offen lds
    s_add_u32 m0, s60, 9216
    s_add_u32 s39, s38, 1179648
    buffer_load_dwordx4 v14, s[20:23], s39 offen lds
    s_add_u32 m0, s60, 10240
    s_add_u32 s39, s38, 1310720
    buffer_load_dwordx4 v14, s[20:23], s39 offen lds
    s_add_u32 m0, s60, 11264
    s_add_u32 s39, s38, 1441792
    buffer_load_dwordx4 v14, s[20:23], s39 offen lds
    s_add_u32 m0, s60, 12288
    s_add_u32 s39, s38, 1572864
    buffer_load_dwordx4 v14, s[20:23], s39 offen lds
    s_add_u32 m0, s60, 13312
    s_add_u32 s39, s38, 1703936
    buffer_load_dwordx4 v14, s[20:23], s39 offen lds
    s_add_u32 m0, s60, 14336
    s_add_u32 s39, s38, 1835008
    buffer_load_dwordx4 v14, s[20:23], s39 offen lds
    s_add_u32 m0, s60, 15360
    s_add_u32 s39, s38, 1966080
    buffer_load_dwordx4 v14, s[20:23], s39 offen lds
    s_add_u32 m0, s60, 16384
    s_add_u32 s39, s38, 2097152
    buffer_load_dwordx4 v14, s[20:23], s39 offen lds
    s_add_u32 m0, s60, 17408
    s_add_u32 s39, s38, 2228224
    buffer_load_dwordx4 v14, s[20:23], s39 offen lds
    s_add_u32 m0, s60, 18432
    s_add_u32 s39, s38, 2359296
    buffer_load_dwordx4 v14, s[20:23], s39 offen lds
    s_add_u32 m0, s60, 19456
    s_add_u32 s39, s38, 2490368
    buffer_load_dwordx4 v14, s[20:23], s39 offen lds
R_257:
    s_waitcnt lgkmcnt(0)
LAYER_260:
    s_cmp_ge_u32 s28, 160
    s_cbranch_scc1 R_267
    s_and_b32 s40, s29, 1
    s_lshr_b32 s41, s29, 1
    s_mul_i32 s32, s29, 40
    v_min_u32 v6, 39, v1
    v_add_u32 v6, s32, v6
    v_min_u32 v6, 159, v6
    v_lshlrev_b32 v6, 7, v6
    s_mov_b32 s32, 1048576
    s_mov_b32 s48, 0
P_268:
    buffer_load_dword v2, v6, s[4:7], s32 offen sc1
    s_waitcnt vmcnt(0)
    v_cmp_gt_u32 vcc, 1, v2
    s_cbranch_vccz P_269
    s_add_u32 s48, s48, 1
    s_cmp_gt_u32 s48, 200000
    s_cbranch_scc1 L_end
    s_sleep 1
    s_branch P_268
P_269:
    s_barrier
    s_lshl_b32 s34, s28, 1
    s_add_u32 s42, s34, s41
    s_lshl_b32 s34, s42, 4
    s_mul_i32 s35, s40, 1310720
    s_add_u32 s34, s34, s35
    s_add_u32 s34, s34, 8388608
    v_bfe_u32 v2, v1, 0, 5
    v_mul_u32_u24 v2, 40960, v2
    v_bfe_u32 v3, v1, 5, 1
    v_mul_u32_u24 v3, 20480, v3
    v_add_u32 v2, v2, v3
    s_add_u32 s35, s34, 0
    buffer_load_dwordx4 v[216:219], v2, s[4:7], s35 offen sc1
    s_add_u32 s35, s34, 5120
    buffer_load_dwordx4 v[220:223], v2, s[4:7], s35 offen sc1
    s_add_u32 s35, s34, 10240
    buffer_load_dwordx4 v[224:227], v2, s[4:7], s35 offen sc1
    s_add_u32 s35, s34, 15360
    buffer_load_dwordx4 v[228:231], v2, s[4:7], s35 offen sc1
    s_lshl_b32 s34, s40, 5
    v_bfe_u32 v3, v1, 0, 5
    v_add_u32 v3, s34, v3
    v_bfe_u32 v4, v1, 5, 1
    v_mul_u32_u24 v4, 4, v4
    v_bfe_u32 v5, v1, 0, 5
    v_add_u32 v7, 0, v4
    v_mul_u32_u24 v7, v7, v3
    v_cvt_f32_u32 v7, v7
    v_cvt_f32_u32 v8, v3
    v_mul_f32 v7, 0x3c800000, v7
    v_mul_f32 v8, 0x3c800000, v8
    v_fmamk_f32 v10, v8, 0x0, v7
    v_sin_f32 v12, v10
    v_cos_f32 v10, v10
    v_fmamk_f32 v11, v8, 0x3f800000, v7
    v_sin_f32 v13, v11
    v_cos_f32 v11, v11
    v_cvt_pk_bf16_f32 v32, v12, v13
    v_cvt_pk_bf16_f32 v16, v10, v11
    v_xor_b32 v48, 0x80008000, v32
    v_fmamk_f32 v10, v8, 0x40000000, v7
    v_sin_f32 v12, v10
    v_cos_f32 v10, v10
    v_fmamk_f32 v11, v8, 0x40400000, v7
    v_sin_f32 v13, v11
    v_cos_f32 v11, v11
    v_cvt_pk_bf16_f32 v33, v12, v13
    v_cvt_pk_bf16_f32 v17, v10, v11
    v_xor_b32 v49, 0x80008000, v33
    v_fmamk_f32 v10, v8, 0x41000000, v7
    v_sin_f32 v12, v10
    v_cos_f32 v10, v10
    v_fmamk_f32 v11, v8, 0x41100000, v7
    v_sin_f32 v13, v11
    v_cos_f32 v11, v11
    v_cvt_pk_bf16_f32 v34, v12, v13
    v_cvt_pk_bf16_f32 v18, v10, v11
    v_xor_b32 v50, 0x80008000, v34
    v_fmamk_f32 v10, v8, 0x41200000, v7
    v_sin_f32 v12, v10
    v_cos_f32 v10, v10
    v_fmamk_f32 v11, v8, 0x41300000, v7
    v_sin_f32 v13, v11
    v_cos_f32 v11, v11
    v_cvt_pk_bf16_f32 v35, v12, v13
    v_cvt_pk_bf16_f32 v19, v10, v11
    v_xor_b32 v51, 0x80008000, v35
    v_fmamk_f32 v10, v8, 0x41800000, v7
    v_sin_f32 v12, v10
    v_cos_f32 v10, v10
    v_fmamk_f32 v11, v8, 0x41880000, v7
    v_sin_f32 v13, v11
    v_cos_f32 v11, v11
    v_cvt_pk_bf16_f32 v36, v12, v13
    v_cvt_pk_bf16_f32 v20, v10, v11
    v_xor_b32 v52, 0x80008000, v36
    v_fmamk_f32 v10, v8, 0x41900000, v7
    v_sin_f32 v12, v10
    v_cos_f32 v10, v10
    v_fmamk_f32 v11, v8, 0x41980000, v7
    v_sin_f32 v13, v11
    v_cos_f32 v11, v11
    v_cvt_pk_bf16_f32 v37, v12, v13
    v_cvt_pk_bf16_f32 v21, v10, v11
    v_xor_b32 v53, 0x80008000, v37
    v_fmamk_f32 v10, v8, 0x41c00000, v7
    v_sin_f32 v12, v10
    v_cos_f32 v10, v10
    v_fmamk_f32 v11, v8, 0x41c80000, v7
    v_sin_f32 v13, v11
    v_cos_f32 v11, v11
    v_cvt_pk_bf16_f32 v38, v12, v13
    v_cvt_pk_bf16_f32 v22, v10, v11
    v_xor_b32 v54, 0x80008000, v38
    v_fmamk_f32 v10, v8, 0x41d00000, v7
    v_sin_f32 v12, v10
    v_cos_f32 v10, v10
    v_fmamk_f32 v11, v8, 0x41d80000, v7
    v_sin_f32 v13, v11
    v_cos_f32 v11, v11
    v_cvt_pk_bf16_f32 v39, v12, v13
    v_cvt_pk_bf16_f32 v23, v10, v11
    v_xor_b32 v55, 0x80008000, v39
    v_fmamk_f32 v10, v8, 0x42000000, v7
    v_sin_f32 v12, v10
    v_cos_f32 v10, v10
    v_fmamk_f32 v11, v8, 0x42040000, v7
    v_sin_f32 v13, v11
    v_cos_f32 v11, v11
    v_cvt_pk_bf16_f32 v40, v12, v13
    v_cvt_pk_bf16_f32 v24, v10, v11
    v_xor_b32 v56, 0x80008000, v40
    v_fmamk_f32 v10, v8, 0x42080000, v7
    v_sin_f32 v12, v10
    v_cos_f32 v10, v10
    v_fmamk_f32 v11, v8, 0x420c0000, v7
    v_sin_f32 v13, v11
    v_cos_f32 v11, v11
    v_cvt_pk_bf16_f32 v41, v12, v13
    v_cvt_pk_bf16_f32 v25, v10, v11
    v_xor_b32 v57, 0x80008000, v41
    v_fmamk_f32 v10, v8, 0x42200000, v7
    v_sin_f32 v12, v10
    v_cos_f32 v10, v10
    v_fmamk_f32 v11, v8, 0x42240000, v7
    v_sin_f32 v13, v11
    v_cos_f32 v11, v11
    v_cvt_pk_bf16_f32 v42, v12, v13
    v_cvt_pk_bf16_f32 v26, v10, v11
    v_xor_b32 v58, 0x80008000, v42
    v_fmamk_f32 v10, v8, 0x42280000, v7
    v_sin_f32 v12, v10
    v_cos_f32 v10, v10
    v_fmamk_f32 v11, v8, 0x422c0000, v7
    v_sin_f32 v13, v11
    v_cos_f32 v11, v11
    v_cvt_pk_bf16_f32 v43, v12, v13
    v_cvt_pk_bf16_f32 v27, v10, v11
    v_xor_b32 v59, 0x80008000, v43
    v_fmamk_f32 v10, v8, 0x42400000, v7
    v_sin_f32 v12, v10
    v_cos_f32 v10, v10
    v_fmamk_f32 v11, v8, 0x42440000, v7
    v_sin_f32 v13, v11
    v_cos_f32 v11, v11
    v_cvt_pk_bf16_f32 v44, v12, v13
    v_cvt_pk_bf16_f32 v28, v10, v11
    v_xor_b32 v60, 0x80008000, v44
    v_fmamk_f32 v10, v8, 0x42480000, v7
    v_sin_f32 v12, v10
    v_cos_f32 v10, v10
    v_fmamk_f32 v11, v8, 0x424c0000, v7
    v_sin_f32 v13, v11
    v_cos_f32 v11, v11
    v_cvt_pk_bf16_f32 v45, v12, v13
    v_cvt_pk_bf16_f32 v29, v10, v11
    v_xor_b32 v61, 0x80008000, v45
    v_fmamk_f32 v10, v8, 0x42600000, v7
    v_sin_f32 v12, v10
    v_cos_f32 v10, v10
    v_fmamk_f32 v11, v8, 0x42640000, v7
    v_sin_f32 v13, v11
    v_cos_f32 v11, v11
    v_cvt_pk_bf16_f32 v46, v12, v13
    v_cvt_pk_bf16_f32 v30, v10, v11
    v_xor_b32 v62, 0x80008000, v46
    v_fmamk_f32 v10, v8, 0x42680000, v7
    v_sin_f32 v12, v10
    v_cos_f32 v10, v10
    v_fmamk_f32 v11, v8, 0x426c0000, v7
    v_sin_f32 v13, v11
    v_cos_f32 v11, v11
    v_cvt_pk_bf16_f32 v47, v12, v13
    v_cvt_pk_bf16_f32 v31, v10, v11
    v_xor_b32 v63, 0x80008000, v47
    v_add_u32 v7, 0, v4
    v_mul_u32_u24 v7, v7, v5
    v_cvt_f32_u32 v7, v7
    v_cvt_f32_u32 v8, v5
    v_mul_f32 v7, 0x3d000000, v7
    v_mul_f32 v8, 0x3d000000, v8
    v_fmamk_f32 v10, v8, 0x0, v7
    v_sin_f32 v12, v10
    v_cos_f32 v10, v10
    v_fmamk_f32 v11, v8, 0x3f800000, v7
    v_sin_f32 v13, v11
    v_cos_f32 v11, v11
    v_cvt_pk_bf16_f32 v72, v12, v13
    v_cvt_pk_bf16_f32 v64, v10, v11
    v_xor_b32 v80, 0x80008000, v72
    v_fmamk_f32 v10, v8, 0x40000000, v7
    v_sin_f32 v12, v10
    v_cos_f32 v10, v10
    v_fmamk_f32 v11, v8, 0x40400000, v7
    v_sin_f32 v13, v11
    v_cos_f32 v11, v11
    v_cvt_pk_bf16_f32 v73, v12, v13
    v_cvt_pk_bf16_f32 v65, v10, v11
    v_xor_b32 v81, 0x80008000, v73
    v_fmamk_f32 v10, v8, 0x41000000, v7
    v_sin_f32 v12, v10
    v_cos_f32 v10, v10
    v_fmamk_f32 v11, v8, 0x41100000, v7
    v_sin_f32 v13, v11
    v_cos_f32 v11, v11
    v_cvt_pk_bf16_f32 v74, v12, v13
    v_cvt_pk_bf16_f32 v66, v10, v11
    v_xor_b32 v82, 0x80008000, v74
    v_fmamk_f32 v10, v8, 0x41200000, v7
    v_sin_f32 v12, v10
    v_cos_f32 v10, v10
    v_fmamk_f32 v11, v8, 0x41300000, v7
    v_sin_f32 v13, v11
    v_cos_f32 v11, v11
    v_cvt_pk_bf16_f32 v75, v12, v13
    v_cvt_pk_bf16_f32 v67, v10, v11
    v_xor_b32 v83, 0x80008000, v75
    v_fmamk_f32 v10, v8, 0x41800000, v7
    v_sin_f32 v12, v10
    v_cos_f32 v10, v10
    v_fmamk_f32 v11, v8, 0x41880000, v7
    v_sin_f32 v13, v11
    v_cos_f32 v11, v11
    v_cvt_pk_bf16_f32 v76, v12, v13
    v_cvt_pk_bf16_f32 v68, v10, v11
    v_xor_b32 v84, 0x80008000, v76
    v_fmamk_f32 v10, v8, 0x41900000, v7
    v_sin_f32 v12, v10
    v_cos_f32 v10, v10
    v_fmamk_f32 v11, v8, 0x41980000, v7
    v_sin_f32 v13, v11
    v_cos_f32 v11, v11
    v_cvt_pk_bf16_f32 v77, v12, v13
    v_cvt_pk_bf16_f32 v69, v10, v11
    v_xor_b32 v85, 0x80008000, v77
    v_fmamk_f32 v10, v8, 0x41c00000, v7
    v_sin_f32 v12, v10
    v_cos_f32 v10, v10
    v_fmamk_f32 v11, v8, 0x41c80000, v7
    v_sin_f32 v13, v11
    v_cos_f32 v11, v11
    v_cvt_pk_bf16_f32 v78, v12, v13
    v_cvt_pk_bf16_f32 v70, v10, v11
    v_xor_b32 v86, 0x80008000, v78
    v_fmamk_f32 v10, v8, 0x41d00000, v7
    v_sin_f32 v12, v10
    v_cos_f32 v10, v10
    v_fmamk_f32 v11, v8, 0x41d80000, v7
    v_sin_f32 v13, v11
    v_cos_f32 v11, v11
    v_cvt_pk_bf16_f32 v79, v12, v13
    v_cvt_pk_bf16_f32 v71, v10, v11
    v_xor_b32 v87, 0x80008000, v79
    v_add_u32 v7, 0, v4
    v_mul_u32_u24 v7, v7, v3
    v_cvt_f32_u32 v7, v7
    v_cvt_f32_u32 v8, v3
    v_mul_f32 v7, 0x3a000000, v7
    v_mul_f32 v8, 0x3a000000, v8
    v_fmamk_f32 v88, v8, 0x0, v7
    v_sin_f32 v104, v88
    v_cos_f32 v88, v88
    v_fmamk_f32 v89, v8, 0x3f800000, v7
    v_sin_f32 v105, v89
    v_cos_f32 v89, v89
    v_fmamk_f32 v90, v8, 0x40000000, v7
    v_sin_f32 v106, v90
    v_cos_f32 v90, v90
    v_fmamk_f32 v91, v8, 0x40400000, v7
    v_sin_f32 v107, v91
    v_cos_f32 v91, v91
    v_fmamk_f32 v92, v8, 0x41000000, v7
    v_sin_f32 v108, v92
    v_cos_f32 v92, v92
    v_fmamk_f32 v93, v8, 0x41100000, v7
    v_sin_f32 v109, v93
    v_cos_f32 v93, v93
    v_fmamk_f32 v94, v8, 0x41200000, v7
    v_sin_f32 v110, v94
    v_cos_f32 v94, v94
    v_fmamk_f32 v95, v8, 0x41300000, v7
    v_sin_f32 v111, v95
    v_cos_f32 v95, v95
    v_fmamk_f32 v96, v8, 0x41800000, v7
    v_sin_f32 v112, v96
    v_cos_f32 v96, v96
    v_fmamk_f32 v97, v8, 0x41880000, v7
    v_sin_f32 v113, v97
    v_cos_f32 v97, v97
    v_fmamk_f32 v98, v8, 0x41900000, v7
    v_sin_f32 v114, v98
    v_cos_f32 v98, v98
    v_fmamk_f32 v99, v8, 0x41980000, v7
    v_sin_f32 v115, v99
    v_cos_f32 v99, v99
    v_fmamk_f32 v100, v8, 0x41c00000, v7
    v_sin_f32 v116, v100
    v_cos_f32 v100, v100
    v_fmamk_f32 v101, v8, 0x41c80000, v7
    v_sin_f32 v117, v101
    v_cos_f32 v101, v101
    v_fmamk_f32 v102, v8, 0x41d00000, v7
    v_sin_f32 v118, v102
    v_cos_f32 v102, v102
    v_fmamk_f32 v103, v8, 0x41d80000, v7
    v_sin_f32 v119, v103
    v_cos_f32 v103, v103
    v_add_u32 v7, s34, v4
    v_mul_u32_u24 v7, v7, v5
    v_cvt_f32_u32 v7, v7
    v_cvt_f32_u32 v8, v5
    v_mul_f32 v7, 0x3a000000, v7
    v_mul_f32 v8, 0x3a000000, v8
    v_fmamk_f32 v120, v8, 0x0, v7
    v_sin_f32 v136, v120
    v_cos_f32 v120, v120
    v_fmamk_f32 v121, v8, 0x3f800000, v7
    v_sin_f32 v137, v121
    v_cos_f32 v121, v121
    v_fmamk_f32 v122, v8, 0x40000000, v7
    v_sin_f32 v138, v122
    v_cos_f32 v122, v122
    v_fmamk_f32 v123, v8, 0x40400000, v7
    v_sin_f32 v139, v123
    v_cos_f32 v123, v123
    v_fmamk_f32 v124, v8, 0x41000000, v7
    v_sin_f32 v140, v124
    v_cos_f32 v124, v124
    v_fmamk_f32 v125, v8, 0x41100000, v7
    v_sin_f32 v141, v125
    v_cos_f32 v125, v125
    v_fmamk_f32 v126, v8, 0x41200000, v7
    v_sin_f32 v142, v126
    v_cos_f32 v126, v126
    v_fmamk_f32 v127, v8, 0x41300000, v7
    v_sin_f32 v143, v127
    v_cos_f32 v127, v127
    v_fmamk_f32 v128, v8, 0x41800000, v7
    v_sin_f32 v144, v128
    v_cos_f32 v128, v128
    v_fmamk_f32 v129, v8, 0x41880000, v7
    v_sin_f32 v145, v129
    v_cos_f32 v129, v129
    v_fmamk_f32 v130, v8, 0x41900000, v7
    v_sin_f32 v146, v130
    v_cos_f32 v130, v130
    v_fmamk_f32 v131, v8, 0x41980000, v7
    v_sin_f32 v147, v131
    v_cos_f32 v131, v131
    v_fmamk_f32 v132, v8, 0x41c00000, v7
    v_sin_f32 v148, v132
    v_cos_f32 v132, v132
    v_fmamk_f32 v133, v8, 0x41c80000, v7
    v_sin_f32 v149, v133
    v_cos_f32 v133, v133
    v_fmamk_f32 v134, v8, 0x41d00000, v7
    v_sin_f32 v150, v134
    v_cos_f32 v134, v134
    v_fmamk_f32 v135, v8, 0x41d80000, v7
    v_sin_f32 v151, v135
    v_cos_f32 v135, v135
    s_mov_b32 s36, 0x35cccccd
    s_cmp_eq_u32 s42, 319
    s_cselect_b32 s35, 0x354ccccd, s36
    s_waitcnt vmcnt(3)
    v_lshlrev_b32 v152, 16, v216
    v_and_b32 v168, 0xffff0000, v216
    v_mul_f32 v152, s35, v152
    v_mul_f32 v168, s35, v168
    v_lshlrev_b32 v153, 16, v217
    v_and_b32 v169, 0xffff0000, v217
    v_mul_f32 v153, s35, v153
    v_mul_f32 v169, s35, v169
    v_lshlrev_b32 v154, 16, v218
    v_and_b32 v170, 0xffff0000, v218
    v_mul_f32 v154, s35, v154
    v_mul_f32 v170, s35, v170
    v_lshlrev_b32 v155, 16, v219
    v_and_b32 v171, 0xffff0000, v219
    v_mul_f32 v155, s35, v155
    v_mul_f32 v171, s35, v171
    s_waitcnt vmcnt(2)
    v_lshlrev_b32 v156, 16, v220
    v_and_b32 v172, 0xffff0000, v220
    v_mul_f32 v156, s35, v156
    v_mul_f32 v172, s35, v172
    v_lshlrev_b32 v157, 16, v221
    v_and_b32 v173, 0xffff0000, v221
    v_mul_f32 v157, s35, v157
    v_mul_f32 v173, s35, v173
    v_lshlrev_b32 v158, 16, v222
    v_and_b32 v174, 0xffff0000, v222
    v_mul_f32 v158, s35, v158
    v_mul_f32 v174, s35, v174
    v_lshlrev_b32 v159, 16, v223
    v_and_b32 v175, 0xffff0000, v223
    v_mul_f32 v159, s35, v159
    v_mul_f32 v175, s35, v175
    s_waitcnt vmcnt(1)
    v_lshlrev_b32 v160, 16, v224
    v_and_b32 v176, 0xffff0000, v224
    v_mul_f32 v160, s35, v160
    v_mul_f32 v176, s35, v176
    v_lshlrev_b32 v161, 16, v225
    v_and_b32 v177, 0xffff0000, v225
    v_mul_f32 v161, s35, v161
    v_mul_f32 v177, s35, v177
    v_lshlrev_b32 v162, 16, v226
    v_and_b32 v178, 0xffff0000, v226
    v_mul_f32 v162, s35, v162
    v_mul_f32 v178, s35, v178
    v_lshlrev_b32 v163, 16, v227
    v_and_b32 v179, 0xffff0000, v227
    v_mul_f32 v163, s35, v163
    v_mul_f32 v179, s35, v179
    s_waitcnt vmcnt(0)
    v_lshlrev_b32 v164, 16, v228
    v_and_b32 v180, 0xffff0000, v228
    v_mul_f32 v164, s35, v164
    v_mul_f32 v180, s35, v180
    v_lshlrev_b32 v165, 16, v229
    v_and_b32 v181, 0xffff0000, v229
    v_mul_f32 v165, s35, v165
    v_mul_f32 v181, s35, v181
    v_lshlrev_b32 v166, 16, v230
    v_and_b32 v182, 0xffff0000, v230
    v_mul_f32 v166, s35, v166
    v_mul_f32 v182, s35, v182
    v_lshlrev_b32 v167, 16, v231
    v_and_b32 v183, 0xffff0000, v231
    v_mul_f32 v167, s35, v167
    v_mul_f32 v183, s35, v183
    v_bfe_u32 v2, v1, 4, 2
    v_mul_u32_u24 v2, 64, v2
    v_xor_b32 v2, v2, v0
    v_and_b32 v2, 255, v2
    v_bfe_u32 v8, v1, 4, 2
    v_mul_u32_u24 v8, 40960, v8
    v_add_u32 v2, v2, v8
    s_lshl_b32 s34, s41, 7
    v_bfe_u32 v3, v1, 4, 1
    v_mul_u32_u24 v3, 32, v3
    v_bfe_u32 v7, v1, 0, 2
    v_lshl_add_u32 v3, v7, 3, v3
    v_add_u32 v3, s34, v3
    v_bfe_u32 v8, v1, 2, 2
    v_mul_u32_u24 v8, 64, v8
    v_xor_b32 v3, v3, v8
    v_bfe_u32 v8, v1, 5, 1
    v_mul_u32_u24 v8, 1024, v8
    v_bfe_u32 v7, v1, 2, 2
    v_lshl_add_u32 v8, v7, 8, v8
    v_add_u32 v3, v3, v8
    v_xor_b32 v6, 64, v3
    s_cmp_eq_u32 s64, 1
    s_cselect_b64 s[20:21], s[90:91], s[88:89]
    s_cmp_eq_u32 s64, 2
    s_cselect_b64 s[20:21], s[86:87], s[20:21]
    s_mov_b32 s22, 5242880
    s_mov_b32 s23, 0x20000
    v_bfe_u32 v250, v1, 2, 4
    v_mul_u32_u24 v250, 8192, v250
    v_bfe_u32 v251, v1, 0, 2
    v_lshl_add_u32 v250, v251, 4, v250
    s_lshl_b32 s38, s29, 6
    s_lshl_b32 s35, s63, 8
    s_add_u32 s38, s38, s35
    s_cmp_eq_u32 s30, 0
    s_cselect_b32 s38, s38, 0x40000000
    s_cmp_eq_u32 s30, 0
    s_cselect_b32 s34, 18, 2
    s_cselect_b32 s35, 0, 20480
    v_min_u32 v12, s34, v1
    v_mul_u32_u24 v12, 1280, v12
    s_lshr_b32 s34, s28, 4
    s_lshl_b32 s34, s34, 7
    s_add_u32 s35, s35, s34
    s_add_u32 s35, s35, 1073152
    s_add_u32 s57, s30, 1
    s_mov_b32 s48, 0
P_270:
    buffer_load_dword v8, v12, s[4:7], s35 offen sc1
    s_waitcnt vmcnt(0)
    v_cmp_gt_u32 vcc, s57, v8
    s_cbranch_vccz P_271
    s_add_u32 s48, s48, 1
    s_cmp_gt_u32 s48, 200000
    s_cbranch_scc1 L_end
    s_sleep 1
    s_branch P_270
P_271:
    s_mul_i32 s34, s30, 3145728
    s_add_u32 s34, s34, 20971520
    s_lshl_b32 s35, s28, 8
    s_mul_i32 s36, s29, 655360
    s_add_u32 s43, s35, s36
    s_add_u32 s34, s34, s43
    s_lshl_b32 s35, s29, 12
    s_add_u32 m0, s35, 0
    s_add_u32 s36, s34, 0
    buffer_load_dwordx4 v2, s[4:7], s36 offen sc1 lds
    s_add_u32 m0, s35, 1024
    s_add_u32 s36, s34, 163840
    buffer_load_dwordx4 v2, s[4:7], s36 offen sc1 lds
    s_add_u32 m0, s35, 2048
    s_add_u32 s36, s34, 327680
    buffer_load_dwordx4 v2, s[4:7], s36 offen sc1 lds
    s_add_u32 m0, s35, 3072
    s_add_u32 s36, s34, 491520
    buffer_load_dwordx4 v2, s[4:7], s36 offen sc1 lds
    s_lshl_b32 s34, s29, 12
    s_add_u32 s34, s34, 16384
    v_add_u32 v4, s34, v0
    s_lshl_b32 s34, s41, 13
    s_add_u32 s34, s34, 16384
    v_bfe_u32 v7, v1, 0, 2
    v_mul_u32_u24 v7, 16, v7
    v_bfe_u32 v8, v1, 2, 1
    v_lshl_add_u32 v7, v8, 7, v7
    v_bfe_u32 v8, v1, 3, 1
    v_lshl_add_u32 v7, v8, 6, v7
    v_bfe_u32 v8, v1, 4, 2
    v_lshl_add_u32 v7, v8, 8, v7
    v_add_u32 v7, s34, v7
    s_lshl_b32 s34, s41, 7
    v_bfe_u32 v5, v1, 5, 1
    v_mul_u32_u24 v5, 16, v5
    v_add_u32 v5, s34, v5
    v_bfe_u32 v9, v1, 0, 3
    v_mul_u32_u24 v9, 16, v9
    v_xor_b32 v5, v5, v9
    s_lshl_b32 s34, s40, 13
    s_add_u32 s34, s34, 32768
    v_bfe_u32 v9, v1, 0, 5
    v_mul_u32_u24 v9, 256, v9
    v_add_u32 v9, s34, v9
    v_add_u32 v5, v5, v9
    s_waitcnt vmcnt(0)
    s_barrier
    ds_read_b64_tr_b16 v[216:217], v3 offset:0
    ds_read_b64_tr_b16 v[232:233], v6 offset:0
    ds_read_b64_tr_b16 v[218:219], v3 offset:2048
    ds_read_b64_tr_b16 v[234:235], v6 offset:2048
    ds_read_b64_tr_b16 v[220:221], v3 offset:4096
    ds_read_b64_tr_b16 v[236:237], v6 offset:4096
    ds_read_b64_tr_b16 v[222:223], v3 offset:6144
    ds_read_b64_tr_b16 v[238:239], v6 offset:6144
    ds_read_b64_tr_b16 v[224:225], v3 offset:8192
    ds_read_b64_tr_b16 v[240:241], v6 offset:8192
    ds_read_b64_tr_b16 v[226:227], v3 offset:10240
    ds_read_b64_tr_b16 v[242:243], v6 offset:10240
    ds_read_b64_tr_b16 v[228:229], v3 offset:12288
    ds_read_b64_tr_b16 v[244:245], v6 offset:12288
    ds_read_b64_tr_b16 v[230:231], v3 offset:14336
    ds_read_b64_tr_b16 v[246:247], v6 offset:14336
    s_waitcnt lgkmcnt(13)
    v_mfma_f32_32x32x16_bf16 v[184:199], v[216:219], v[16:19], 0
    s_waitcnt lgkmcnt(12)
    v_mfma_f32_32x32x16_bf16 v[200:215], v[232:235], v[16:19], 0
    s_add_u32 m0, s60, 0
    s_add_u32 s39, s38, 0
    buffer_load_dwordx4 v250, s[20:23], s39 offen lds
    v_mfma_f32_32x32x16_bf16 v[184:199], v[232:235], v[32:35], v[184:199]
    v_mfma_f32_32x32x16_bf16 v[200:215], v[216:219], v[48:51], v[200:215]
    s_add_u32 m0, s60, 1024
    s_add_u32 s39, s38, 131072
    buffer_load_dwordx4 v250, s[20:23], s39 offen lds
    s_waitcnt lgkmcnt(9)
    v_mfma_f32_32x32x16_bf16 v[184:199], v[220:223], v[20:23], v[184:199]
    s_waitcnt lgkmcnt(8)
    v_mfma_f32_32x32x16_bf16 v[200:215], v[236:239], v[20:23], v[200:215]
    s_add_u32 m0, s60, 2048
    s_add_u32 s39, s38, 262144
    buffer_load_dwordx4 v250, s[20:23], s39 offen lds
    v_mfma_f32_32x32x16_bf16 v[184:199], v[236:239], v[36:39], v[184:199]
    v_mfma_f32_32x32x16_bf16 v[200:215], v[220:223], v[52:55], v[200:215]
    s_add_u32 m0, s60, 3072
    s_add_u32 s39, s38, 393216
    buffer_load_dwordx4 v250, s[20:23], s39 offen lds
    s_waitcnt lgkmcnt(5)
    v_mfma_f32_32x32x16_bf16 v[184:199], v[224:227], v[24:27], v[184:199]
    s_waitcnt lgkmcnt(4)
    v_mfma_f32_32x32x16_bf16 v[200:215], v[240:243], v[24:27], v[200:215]
    s_add_u32 m0, s60, 4096
    s_add_u32 s39, s38, 524288
    buffer_load_dwordx4 v250, s[20:23], s39 offen lds
    v_mfma_f32_32x32x16_bf16 v[184:199], v[240:243], v[40:43], v[184:199]
    v_mfma_f32_32x32x16_bf16 v[200:215], v[224:227], v[56:59], v[200:215]
    s_add_u32 m0, s60, 5120
    s_add_u32 s39, s38, 655360
    buffer_load_dwordx4 v250, s[20:23], s39 offen lds
    s_waitcnt lgkmcnt(1)
    v_mfma_f32_32x32x16_bf16 v[184:199], v[228:231], v[28:31], v[184:199]
    s_waitcnt lgkmcnt(0)
    v_mfma_f32_32x32x16_bf16 v[200:215], v[244:247], v[28:31], v[200:215]
    s_add_u32 m0, s60, 6144
    s_add_u32 s39, s38, 786432
    buffer_load_dwordx4 v250, s[20:23], s39 offen lds
    v_mfma_f32_32x32x16_bf16 v[184:199], v[244:247], v[44:47], v[184:199]
    v_mfma_f32_32x32x16_bf16 v[200:215], v[228:231], v[60:63], v[200:215]
    s_add_u32 m0, s60, 7168
    s_add_u32 s39, s38, 917504
    buffer_load_dwordx4 v250, s[20:23], s39 offen lds
    s_nop 0
    v_pk_mul_f32 v[10:11], v[184:185], v[88:89]
    s_nop 6
    v_pk_mul_f32 v[12:13], v[200:201], v[88:89]
    v_pk_fma_f32 v[10:11], v[200:201], v[104:105], v[10:11]
    v_pk_fma_f32 v[12:13], v[184:185], v[104:105], v[12:13] neg_lo:[1,0,0] neg_hi:[1,0,0]
    v_cvt_pk_bf16_f32 v216, v10, v11
    v_cvt_pk_bf16_f32 v232, v12, v13
    v_pk_mul_f32 v[10:11], v[186:187], v[90:91]
    v_pk_mul_f32 v[12:13], v[202:203], v[90:91]
    v_pk_fma_f32 v[10:11], v[202:203], v[106:107], v[10:11]
    v_pk_fma_f32 v[12:13], v[186:187], v[106:107], v[12:13] neg_lo:[1,0,0] neg_hi:[1,0,0]
    v_cvt_pk_bf16_f32 v217, v10, v11
    v_cvt_pk_bf16_f32 v233, v12, v13
    v_pk_mul_f32 v[10:11], v[188:189], v[92:93]
    v_pk_mul_f32 v[12:13], v[204:205], v[92:93]
    v_pk_fma_f32 v[10:11], v[204:205], v[108:109], v[10:11]
    v_pk_fma_f32 v[12:13], v[188:189], v[108:109], v[12:13] neg_lo:[1,0,0] neg_hi:[1,0,0]
    v_cvt_pk_bf16_f32 v218, v10, v11
    v_cvt_pk_bf16_f32 v234, v12, v13
    v_pk_mul_f32 v[10:11], v[190:191], v[94:95]
    v_pk_mul_f32 v[12:13], v[206:207], v[94:95]
    v_pk_fma_f32 v[10:11], v[206:207], v[110:111], v[10:11]
    v_pk_fma_f32 v[12:13], v[190:191], v[110:111], v[12:13] neg_lo:[1,0,0] neg_hi:[1,0,0]
    v_cvt_pk_bf16_f32 v219, v10, v11
    v_cvt_pk_bf16_f32 v235, v12, v13
    v_pk_mul_f32 v[10:11], v[192:193], v[96:97]
    v_pk_mul_f32 v[12:13], v[208:209], v[96:97]
    v_pk_fma_f32 v[10:11], v[208:209], v[112:113], v[10:11]
    v_pk_fma_f32 v[12:13], v[192:193], v[112:113], v[12:13] neg_lo:[1,0,0] neg_hi:[1,0,0]
    v_cvt_pk_bf16_f32 v220, v10, v11
    v_cvt_pk_bf16_f32 v236, v12, v13
    v_pk_mul_f32 v[10:11], v[194:195], v[98:99]
    v_pk_mul_f32 v[12:13], v[210:211], v[98:99]
    v_pk_fma_f32 v[10:11], v[210:211], v[114:115], v[10:11]
    v_pk_fma_f32 v[12:13], v[194:195], v[114:115], v[12:13] neg_lo:[1,0,0] neg_hi:[1,0,0]
    v_cvt_pk_bf16_f32 v221, v10, v11
    v_cvt_pk_bf16_f32 v237, v12, v13
    v_pk_mul_f32 v[10:11], v[196:197], v[100:101]
    v_pk_mul_f32 v[12:13], v[212:213], v[100:101]
    v_pk_fma_f32 v[10:11], v[212:213], v[116:117], v[10:11]
    v_pk_fma_f32 v[12:13], v[196:197], v[116:117], v[12:13] neg_lo:[1,0,0] neg_hi:[1,0,0]
    v_cvt_pk_bf16_f32 v222, v10, v11
    v_cvt_pk_bf16_f32 v238, v12, v13
    v_pk_mul_f32 v[10:11], v[198:199], v[102:103]
    v_pk_mul_f32 v[12:13], v[214:215], v[102:103]
    v_pk_fma_f32 v[10:11], v[214:215], v[118:119], v[10:11]
    v_pk_fma_f32 v[12:13], v[198:199], v[118:119], v[12:13] neg_lo:[1,0,0] neg_hi:[1,0,0]
    v_cvt_pk_bf16_f32 v223, v10, v11
    v_cvt_pk_bf16_f32 v239, v12, v13
    v_mfma_f32_32x32x16_bf16 v[184:199], v[64:67], v[216:219], 0
    v_mfma_f32_32x32x16_bf16 v[200:215], v[64:67], v[232:235], 0
    s_add_u32 m0, s60, 8192
    s_add_u32 s39, s38, 1048576
    buffer_load_dwordx4 v250, s[20:23], s39 offen lds
    v_mfma_f32_32x32x16_bf16 v[184:199], v[72:75], v[232:235], v[184:199]
    v_mfma_f32_32x32x16_bf16 v[200:215], v[80:83], v[216:219], v[200:215]
    s_add_u32 m0, s60, 9216
    s_add_u32 s39, s38, 1179648
    buffer_load_dwordx4 v250, s[20:23], s39 offen lds
    v_mfma_f32_32x32x16_bf16 v[184:199], v[68:71], v[220:223], v[184:199]
    v_mfma_f32_32x32x16_bf16 v[200:215], v[68:71], v[236:239], v[200:215]
    s_add_u32 m0, s60, 10240
    s_add_u32 s39, s38, 1310720
    buffer_load_dwordx4 v250, s[20:23], s39 offen lds
    v_mfma_f32_32x32x16_bf16 v[184:199], v[76:79], v[236:239], v[184:199]
    v_mfma_f32_32x32x16_bf16 v[200:215], v[84:87], v[220:223], v[200:215]
    s_add_u32 m0, s60, 11264
    s_add_u32 s39, s38, 1441792
    buffer_load_dwordx4 v250, s[20:23], s39 offen lds
    s_nop 0
    v_pk_mul_f32 v[10:11], v[184:185], v[152:153]
    s_nop 6
    v_pk_mul_f32 v[12:13], v[200:201], v[152:153]
    v_pk_fma_f32 v[10:11], v[200:201], v[168:169], v[10:11] neg_lo:[1,0,0] neg_hi:[1,0,0]
    v_pk_fma_f32 v[12:13], v[184:185], v[168:169], v[12:13]
    v_cvt_pk_bf16_f32 v216, v10, v11
    v_cvt_pk_bf16_f32 v232, v12, v13
    v_pk_mul_f32 v[10:11], v[186:187], v[154:155]
    v_pk_mul_f32 v[12:13], v[202:203], v[154:155]
    v_pk_fma_f32 v[10:11], v[202:203], v[170:171], v[10:11] neg_lo:[1,0,0] neg_hi:[1,0,0]
    v_pk_fma_f32 v[12:13], v[186:187], v[170:171], v[12:13]
    v_cvt_pk_bf16_f32 v217, v10, v11
    v_cvt_pk_bf16_f32 v233, v12, v13
    v_pk_mul_f32 v[10:11], v[188:189], v[156:157]
    v_pk_mul_f32 v[12:13], v[204:205], v[156:157]
    v_pk_fma_f32 v[10:11], v[204:205], v[172:173], v[10:11] neg_lo:[1,0,0] neg_hi:[1,0,0]
    v_pk_fma_f32 v[12:13], v[188:189], v[172:173], v[12:13]
    v_cvt_pk_bf16_f32 v218, v10, v11
    v_cvt_pk_bf16_f32 v234, v12, v13
    v_pk_mul_f32 v[10:11], v[190:191], v[158:159]
    v_pk_mul_f32 v[12:13], v[206:207], v[158:159]
    v_pk_fma_f32 v[10:11], v[206:207], v[174:175], v[10:11] neg_lo:[1,0,0] neg_hi:[1,0,0]
    v_pk_fma_f32 v[12:13], v[190:191], v[174:175], v[12:13]
    v_cvt_pk_bf16_f32 v219, v10, v11
    v_cvt_pk_bf16_f32 v235, v12, v13
    v_pk_mul_f32 v[10:11], v[192:193], v[160:161]
    v_pk_mul_f32 v[12:13], v[208:209], v[160:161]
    v_pk_fma_f32 v[10:11], v[208:209], v[176:177], v[10:11] neg_lo:[1,0,0] neg_hi:[1,0,0]
    v_pk_fma_f32 v[12:13], v[192:193], v[176:177], v[12:13]
    v_cvt_pk_bf16_f32 v220, v10, v11
    v_cvt_pk_bf16_f32 v236, v12, v13
    v_pk_mul_f32 v[10:11], v[194:195], v[162:163]
    v_pk_mul_f32 v[12:13], v[210:211], v[162:163]
    v_pk_fma_f32 v[10:11], v[210:211], v[178:179], v[10:11] neg_lo:[1,0,0] neg_hi:[1,0,0]
    v_pk_fma_f32 v[12:13], v[194:195], v[178:179], v[12:13]
    v_cvt_pk_bf16_f32 v221, v10, v11
    v_cvt_pk_bf16_f32 v237, v12, v13
    v_pk_mul_f32 v[10:11], v[196:197], v[164:165]
    v_pk_mul_f32 v[12:13], v[212:213], v[164:165]
    v_pk_fma_f32 v[10:11], v[212:213], v[180:181], v[10:11] neg_lo:[1,0,0] neg_hi:[1,0,0]
    v_pk_fma_f32 v[12:13], v[196:197], v[180:181], v[12:13]
    v_cvt_pk_bf16_f32 v222, v10, v11
    v_cvt_pk_bf16_f32 v238, v12, v13
    v_pk_mul_f32 v[10:11], v[198:199], v[166:167]
    v_pk_mul_f32 v[12:13], v[214:215], v[166:167]
    v_pk_fma_f32 v[10:11], v[214:215], v[182:183], v[10:11] neg_lo:[1,0,0] neg_hi:[1,0,0]
    v_pk_fma_f32 v[12:13], v[198:199], v[182:183], v[12:13]
    v_cvt_pk_bf16_f32 v223, v10, v11
    v_cvt_pk_bf16_f32 v239, v12, v13
    v_mfma_f32_32x32x16_bf16 v[184:199], v[216:219], v[64:67], 0
    s_add_u32 m0, s60, 12288
    s_add_u32 s39, s38, 1572864
    buffer_load_dwordx4 v250, s[20:23], s39 offen lds
    v_mfma_f32_32x32x16_bf16 v[200:215], v[232:235], v[64:67], 0
    s_add_u32 m0, s60, 13312
    s_add_u32 s39, s38, 1703936
    buffer_load_dwordx4 v250, s[20:23], s39 offen lds
    v_mfma_f32_32x32x16_bf16 v[184:199], v[232:235], v[80:83], v[184:199]
    s_add_u32 m0, s60, 14336
    s_add_u32 s39, s38, 1835008
    buffer_load_dwordx4 v250, s[20:23], s39 offen lds
    v_mfma_f32_32x32x16_bf16 v[200:215], v[216:219], v[72:75], v[200:215]
    s_add_u32 m0, s60, 15360
    s_add_u32 s39, s38, 1966080
    buffer_load_dwordx4 v250, s[20:23], s39 offen lds
    v_mfma_f32_32x32x16_bf16 v[184:199], v[220:223], v[68:71], v[184:199]
    s_add_u32 m0, s60, 16384
    s_add_u32 s39, s38, 2097152
    buffer_load_dwordx4 v250, s[20:23], s39 offen lds
    v_mfma_f32_32x32x16_bf16 v[200:215], v[236:239], v[68:71], v[200:215]
    s_add_u32 m0, s60, 17408
    s_add_u32 s39, s38, 2228224
    buffer_load_dwordx4 v250, s[20:23], s39 offen lds
    v_mfma_f32_32x32x16_bf16 v[184:199], v[236:239], v[84:87], v[184:199]
    s_add_u32 m0, s60, 18432
    s_add_u32 s39, s38, 2359296
    buffer_load_dwordx4 v250, s[20:23], s39 offen lds
    v_mfma_f32_32x32x16_bf16 v[200:215], v[220:223], v[76:79], v[200:215]
    s_add_u32 m0, s60, 19456
    s_add_u32 s39, s38, 2490368
    buffer_load_dwordx4 v250, s[20:23], s39 offen lds
    s_nop 0
    v_pk_mul_f32 v[10:11], v[184:185], v[120:121]
    s_nop 6
    v_pk_mul_f32 v[12:13], v[200:201], v[120:121]
    v_pk_fma_f32 v[10:11], v[200:201], v[136:137], v[10:11] neg_lo:[1,0,0] neg_hi:[1,0,0]
    v_pk_fma_f32 v[12:13], v[184:185], v[136:137], v[12:13]
    v_cvt_pk_bf16_f32 v216, v10, v11
    v_cvt_pk_bf16_f32 v232, v12, v13
    v_pk_mul_f32 v[10:11], v[186:187], v[122:123]
    v_pk_mul_f32 v[12:13], v[202:203], v[122:123]
    v_pk_fma_f32 v[10:11], v[202:203], v[138:139], v[10:11] neg_lo:[1,0,0] neg_hi:[1,0,0]
    v_pk_fma_f32 v[12:13], v[186:187], v[138:139], v[12:13]
    v_cvt_pk_bf16_f32 v217, v10, v11
    v_cvt_pk_bf16_f32 v233, v12, v13
    v_pk_mul_f32 v[10:11], v[188:189], v[124:125]
    v_pk_mul_f32 v[12:13], v[204:205], v[124:125]
    v_pk_fma_f32 v[10:11], v[204:205], v[140:141], v[10:11] neg_lo:[1,0,0] neg_hi:[1,0,0]
    v_pk_fma_f32 v[12:13], v[188:189], v[140:141], v[12:13]
    v_cvt_pk_bf16_f32 v218, v10, v11
    v_cvt_pk_bf16_f32 v234, v12, v13
    v_pk_mul_f32 v[10:11], v[190:191], v[126:127]
    v_pk_mul_f32 v[12:13], v[206:207], v[126:127]
    v_pk_fma_f32 v[10:11], v[206:207], v[142:143], v[10:11] neg_lo:[1,0,0] neg_hi:[1,0,0]
    v_pk_fma_f32 v[12:13], v[190:191], v[142:143], v[12:13]
    v_cvt_pk_bf16_f32 v219, v10, v11
    v_cvt_pk_bf16_f32 v235, v12, v13
    v_pk_mul_f32 v[10:11], v[192:193], v[128:129]
    v_pk_mul_f32 v[12:13], v[208:209], v[128:129]
    v_pk_fma_f32 v[10:11], v[208:209], v[144:145], v[10:11] neg_lo:[1,0,0] neg_hi:[1,0,0]
    v_pk_fma_f32 v[12:13], v[192:193], v[144:145], v[12:13]
    v_cvt_pk_bf16_f32 v220, v10, v11
    v_cvt_pk_bf16_f32 v236, v12, v13
    v_pk_mul_f32 v[10:11], v[194:195], v[130:131]
    v_pk_mul_f32 v[12:13], v[210:211], v[130:131]
    v_pk_fma_f32 v[10:11], v[210:211], v[146:147], v[10:11] neg_lo:[1,0,0] neg_hi:[1,0,0]
    v_pk_fma_f32 v[12:13], v[194:195], v[146:147], v[12:13]
    v_cvt_pk_bf16_f32 v221, v10, v11
    v_cvt_pk_bf16_f32 v237, v12, v13
    v_pk_mul_f32 v[10:11], v[196:197], v[132:133]
    v_pk_mul_f32 v[12:13], v[212:213], v[132:133]
    v_pk_fma_f32 v[10:11], v[212:213], v[148:149], v[10:11] neg_lo:[1,0,0] neg_hi:[1,0,0]
    v_pk_fma_f32 v[12:13], v[196:197], v[148:149], v[12:13]
    v_cvt_pk_bf16_f32 v222, v10, v11
    v_cvt_pk_bf16_f32 v238, v12, v13
    v_pk_mul_f32 v[10:11], v[198:199], v[134:135]
    v_pk_mul_f32 v[12:13], v[214:215], v[134:135]
    v_pk_fma_f32 v[10:11], v[214:215], v[150:151], v[10:11] neg_lo:[1,0,0] neg_hi:[1,0,0]
    v_pk_fma_f32 v[12:13], v[198:199], v[150:151], v[12:13]
    v_cvt_pk_bf16_f32 v223, v10, v11
    v_cvt_pk_bf16_f32 v239, v12, v13
    ds_write_b128 v4, v[216:219] offset:0
    ds_write_b128 v4, v[220:223] offset:1024
    ds_write_b128 v4, v[232:235] offset:2048
    ds_write_b128 v4, v[236:239] offset:3072
    s_waitcnt lgkmcnt(0)
    s_barrier
    ds_read_b128 v[216:219], v7 offset:0
    ds_read_b128 v[232:235], v7 offset:2048
    ds_read_b128 v[220:223], v7 offset:1024
    ds_read_b128 v[236:239], v7 offset:3072
    ds_read_b128 v[224:227], v7 offset:4096
    ds_read_b128 v[240:243], v7 offset:6144
    ds_read_b128 v[228:231], v7 offset:5120
    ds_read_b128 v[244:247], v7 offset:7168
    s_waitcnt lgkmcnt(7)
    v_mfma_f32_32x32x16_bf16 v[184:199], v[216:219], v[16:19], 0
    s_waitcnt lgkmcnt(6)
    v_mfma_f32_32x32x16_bf16 v[200:215], v[232:235], v[16:19], 0
    v_mfma_f32_32x32x16_bf16 v[184:199], v[232:235], v[48:51], v[184:199]
    v_mfma_f32_32x32x16_bf16 v[200:215], v[216:219], v[32:35], v[200:215]
    s_waitcnt lgkmcnt(5)
    v_mfma_f32_32x32x16_bf16 v[184:199], v[220:223], v[20:23], v[184:199]
    s_waitcnt lgkmcnt(4)
    v_mfma_f32_32x32x16_bf16 v[200:215], v[236:239], v[20:23], v[200:215]
    v_mfma_f32_32x32x16_bf16 v[184:199], v[236:239], v[52:55], v[184:199]
    v_mfma_f32_32x32x16_bf16 v[200:215], v[220:223], v[36:39], v[200:215]
    s_waitcnt lgkmcnt(3)
    v_mfma_f32_32x32x16_bf16 v[184:199], v[224:227], v[24:27], v[184:199]
    s_waitcnt lgkmcnt(2)
    v_mfma_f32_32x32x16_bf16 v[200:215], v[240:243], v[24:27], v[200:215]
    v_mfma_f32_32x32x16_bf16 v[184:199], v[240:243], v[56:59], v[184:199]
    v_mfma_f32_32x32x16_bf16 v[200:215], v[224:227], v[40:43], v[200:215]
    s_waitcnt lgkmcnt(1)
    v_mfma_f32_32x32x16_bf16 v[184:199], v[228:231], v[28:31], v[184:199]
    s_waitcnt lgkmcnt(0)
    v_mfma_f32_32x32x16_bf16 v[200:215], v[244:247], v[28:31], v[200:215]
    v_mfma_f32_32x32x16_bf16 v[184:199], v[244:247], v[60:63], v[184:199]
    v_mfma_f32_32x32x16_bf16 v[200:215], v[228:231], v[44:47], v[200:215]
    v_bfe_u32 v2, v1, 4, 2
    v_mul_u32_u24 v2, 16, v2
    v_xor_b32 v2, v2, v0
    s_lshl_b32 s34, s29, 12
    s_add_u32 s34, s34, 32768
    v_add_u32 v2, s34, v2
    v_xor_b32 v6, 64, v2
    v_bfe_u32 v3, v1, 4, 2
    v_mul_u32_u24 v3, 40960, v3
    v_bfe_u32 v8, v1, 0, 4
    v_lshl_add_u32 v3, v8, 4, v3
    v_cvt_pk_bf16_f32 v216, v184, v185
    v_cvt_pk_bf16_f32 v217, v186, v187
    v_cvt_pk_bf16_f32 v218, v188, v189
    v_cvt_pk_bf16_f32 v219, v190, v191
    v_xor_b32 v10, 0, v5
    ds_write_b128 v10, v[216:219]
    v_cvt_pk_bf16_f32 v220, v192, v193
    v_cvt_pk_bf16_f32 v221, v194, v195
    v_cvt_pk_bf16_f32 v222, v196, v197
    v_cvt_pk_bf16_f32 v223, v198, v199
    v_xor_b32 v11, 32, v5
    ds_write_b128 v11, v[220:223]
    v_cvt_pk_bf16_f32 v224, v200, v201
    v_cvt_pk_bf16_f32 v225, v202, v203
    v_cvt_pk_bf16_f32 v226, v204, v205
    v_cvt_pk_bf16_f32 v227, v206, v207
    v_xor_b32 v12, 64, v5
    ds_write_b128 v12, v[224:227]
    v_cvt_pk_bf16_f32 v228, v208, v209
    v_cvt_pk_bf16_f32 v229, v210, v211
    v_cvt_pk_bf16_f32 v230, v212, v213
    v_cvt_pk_bf16_f32 v231, v214, v215
    v_xor_b32 v13, 96, v5
    ds_write_b128 v13, v[228:231]
    s_mul_i32 s34, s30, 3145728
    s_add_u32 s34, s34, 27262976
    s_add_u32 s34, s34, s43
    s_waitcnt lgkmcnt(0)
    s_barrier
    ds_read_b128 v[232:235], v2 offset:0
    ds_read_b128 v[236:239], v6 offset:1024
    ds_read_b128 v[240:243], v2 offset:2048
    ds_read_b128 v[244:247], v6 offset:3072
    s_add_u32 s36, s34, 0
    s_waitcnt lgkmcnt(3)
    buffer_store_dwordx4 v[232:235], v3, s[4:7], s36 offen sc1
    s_add_u32 s36, s34, 163840
    s_waitcnt lgkmcnt(2)
    buffer_store_dwordx4 v[236:239], v3, s[4:7], s36 offen sc1
    s_add_u32 s36, s34, 327680
    s_waitcnt lgkmcnt(1)
    buffer_store_dwordx4 v[240:243], v3, s[4:7], s36 offen sc1
    s_add_u32 s36, s34, 491520
    s_waitcnt lgkmcnt(0)
    buffer_store_dwordx4 v[244:247], v3, s[4:7], s36 offen sc1
    s_add_u32 s57, s30, 1
    s_waitcnt vmcnt(0)
    s_barrier
    s_cmp_lg_u32 s29, 0
    s_cbranch_scc1 F_272
    s_lshl_b32 s32, s28, 5
    s_add_u32 s32, s32, s29
    s_lshl_b32 s32, s32, 2
    s_add_u32 s32, s32, 1097728
    v_mov_b32 v8, s57
    s_mov_b64 exec, 1
    buffer_store_dword v8, off, s[4:7], s32 sc1
    s_mov_b64 exec, -1
F_272:
R_267:
    s_cmp_lg_u32 s30, 0
    s_cbranch_scc1 LAYER_264
    s_cmp_eq_u32 s64, 1
    s_cbranch_scc1 Q_273
    v_bfe_u32 v2, v1, 5, 1
    v_mul_u32_u24 v2, 512, v2
    v_bfe_u32 v3, v1, 2, 2
    v_lshl_add_u32 v2, v3, 6, v2
    v_bfe_u32 v3, v1, 4, 1
    v_lshl_add_u32 v2, v3, 4, v2
    v_bfe_u32 v3, v1, 1, 1
    v_lshl_add_u32 v2, v3, 3, v2
    v_bfe_u32 v3, v1, 0, 1
    v_lshl_add_u32 v2, v3, 5, v2
    v_add_u32 v2, s60, v2
    s_branch Q_274
Q_273:
    v_bfe_u32 v2, v1, 5, 1
    v_mul_u32_u24 v2, 512, v2
    v_bfe_u32 v3, v1, 2, 2
    v_lshl_add_u32 v2, v3, 6, v2
    v_bfe_u32 v3, v1, 4, 1
    v_lshl_add_u32 v2, v3, 5, v2
    v_bfe_u32 v3, v1, 0, 2
    v_lshl_add_u32 v2, v3, 3, v2
    v_add_u32 v2, s60, v2
Q_274:
    s_waitcnt vmcnt(0)
    ds_read_b64_tr_b16 a[0:1], v2 offset:0
    ds_read_b64_tr_b16 a[2:3], v2 offset:256
    ds_read_b64_tr_b16 a[4:5], v2 offset:1024
    ds_read_b64_tr_b16 a[6:7], v2 offset:1280
    ds_read_b64_tr_b16 a[8:9], v2 offset:2048
    ds_read_b64_tr_b16 a[10:11], v2 offset:2304
    ds_read_b64_tr_b16 a[12:13], v2 offset:3072
    ds_read_b64_tr_b16 a[14:15], v2 offset:3328
    ds_read_b64_tr_b16 a[16:17], v2 offset:4096
    ds_read_b64_tr_b16 a[18:19], v2 offset:4352
    ds_read_b64_tr_b16 a[20:21], v2 offset:5120
    ds_read_b64_tr_b16 a[22:23], v2 offset:5376
    ds_read_b64_tr_b16 a[24:25], v2 offset:6144
    ds_read_b64_tr_b16 a[26:27], v2 offset:6400
    ds_read_b64_tr_b16 a[28:29], v2 offset:7168
    ds_read_b64_tr_b16 a[30:31], v2 offset:7424
    ds_read_b64_tr_b16 a[32:33], v2 offset:8192
    ds_read_b64_tr_b16 a[34:35], v2 offset:8448
    ds_read_b64_tr_b16 a[36:37], v2 offset:9216
    ds_read_b64_tr_b16 a[38:39], v2 offset:9472
    ds_read_b64_tr_b16 a[40:41], v2 offset:10240
    ds_read_b64_tr_b16 a[42:43], v2 offset:10496
    ds_read_b64_tr_b16 a[44:45], v2 offset:11264
    ds_read_b64_tr_b16 a[46:47], v2 offset:11520
    ds_read_b64_tr_b16 a[48:49], v2 offset:12288
    ds_read_b64_tr_b16 a[50:51], v2 offset:12544
    ds_read_b64_tr_b16 a[52:53], v2 offset:13312
    ds_read_b64_tr_b16 a[54:55], v2 offset:13568
    ds_read_b64_tr_b16 a[56:57], v2 offset:14336
    ds_read_b64_tr_b16 a[58:59], v2 offset:14592
    ds_read_b64_tr_b16 a[60:61], v2 offset:15360
    ds_read_b64_tr_b16 a[62:63], v2 offset:15616
    ds_read_b64_tr_b16 a[64:65], v2 offset:16384
    ds_read_b64_tr_b16 a[66:67], v2 offset:16640
    ds_read_b64_tr_b16 a[68:69], v2 offset:17408
    ds_read_b64_tr_b16 a[70:71], v2 offset:17664
    ds_read_b64_tr_b16 a[72:73], v2 offset:18432
    ds_read_b64_tr_b16 a[74:75], v2 offset:18688
    ds_read_b64_tr_b16 a[76:77], v2 offset:19456
    ds_read_b64_tr_b16 a[78:79], v2 offset:19712
    s_waitcnt lgkmcnt(0)
    s_cmp_lt_u32 s28, 64
    s_cbranch_scc1 R_275
    s_cmp_ge_u32 s28, 160
    s_cbranch_scc1 R_275
    s_cmp_eq_u32 s64, 1
    s_cselect_b64 s[20:21], s[90:91], s[88:89]
    s_cmp_eq_u32 s64, 2
    s_cselect_b64 s[20:21], s[86:87], s[20:21]
    s_mov_b32 s22, 5242880
    s_mov_b32 s23, 0x20000
    v_bfe_u32 v14, v1, 2, 4
    v_mul_u32_u24 v14, 8192, v14
    v_bfe_u32 v15, v1, 0, 2
    v_lshl_add_u32 v14, v15, 4, v14
    s_lshl_b32 s38, s29, 6
    s_lshl_b32 s35, s63, 8
    s_add_u32 s38, s38, s35
    s_add_u32 m0, s60, 0
    s_add_u32 s39, s38, 2621440
    buffer_load_dwordx4 v14, s[20:23], s39 offen lds
    s_add_u32 m0, s60, 1024
    s_add_u32 s39, s38, 2752512
    buffer_load_dwordx4 v14, s[20:23], s39 offen lds
    s_add_u32 m0, s60, 2048
    s_add_u32 s39, s38, 2883584
    buffer_load_dwordx4 v14, s[20:23], s39 offen lds
    s_add_u32 m0, s60, 3072
    s_add_u32 s39, s38, 3014656
    buffer_load_dwordx4 v14, s[20:23], s39 offen lds
    s_add_u32 m0, s60, 4096
    s_add_u32 s39, s38, 3145728
    buffer_load_dwordx4 v14, s[20:23], s39 offen lds
    s_add_u32 m0, s60, 5120
    s_add_u32 s39, s38, 3276800
    buffer_load_dwordx4 v14, s[20:23], s39 offen lds
    s_add_u32 m0, s60, 6144
    s_add_u32 s39, s38, 3407872
    buffer_load_dwordx4 v14, s[20:23], s39 offen lds
    s_add_u32 m0, s60, 7168
    s_add_u32 s39, s38, 3538944
    buffer_load_dwordx4 v14, s[20:23], s39 offen lds
    s_add_u32 m0, s60, 8192
    s_add_u32 s39, s38, 3670016
    buffer_load_dwordx4 v14, s[20:23], s39 offen lds
    s_add_u32 m0, s60, 9216
    s_add_u32 s39, s38, 3801088
    buffer_load_dwordx4 v14, s[20:23], s39 offen lds
    s_add_u32 m0, s60, 10240
    s_add_u32 s39, s38, 3932160
    buffer_load_dwordx4 v14, s[20:23], s39 offen lds
    s_add_u32 m0, s60, 11264
    s_add_u32 s39, s38, 4063232
    buffer_load_dwordx4 v14, s[20:23], s39 offen lds
    s_add_u32 m0, s60, 12288
    s_add_u32 s39, s38, 4194304
    buffer_load_dwordx4 v14, s[20:23], s39 offen lds
    s_add_u32 m0, s60, 13312
    s_add_u32 s39, s38, 4325376
    buffer_load_dwordx4 v14, s[20:23], s39 offen lds
    s_add_u32 m0, s60, 14336
    s_add_u32 s39, s38, 4456448
    buffer_load_dwordx4 v14, s[20:23], s39 offen lds
    s_add_u32 m0, s60, 15360
    s_add_u32 s39, s38, 4587520
    buffer_load_dwordx4 v14, s[20:23], s39 offen lds
    s_add_u32 m0, s60, 16384
    s_add_u32 s39, s38, 4718592
    buffer_load_dwordx4 v14, s[20:23], s39 offen lds
    s_add_u32 m0, s60, 17408
    s_add_u32 s39, s38, 4849664
    buffer_load_dwordx4 v14, s[20:23], s39 offen lds
    s_add_u32 m0, s60, 18432
    s_add_u32 s39, s38, 4980736
    buffer_load_dwordx4 v14, s[20:23], s39 offen lds
    s_add_u32 m0, s60, 19456
    s_add_u32 s39, s38, 5111808
    buffer_load_dwordx4 v14, s[20:23], s39 offen lds
R_275:
    s_sub_u32 s32, s28, 60
    s_cmp_lt_u32 s32, 70
    s_cbranch_scc1 R_276
    s_mov_b32 s35, 0x3acccccd
    s_lshl_b32 s34, s67, 6
    s_add_u32 s34, s34, 0
    v_bfe_u32 v5, v1, 0, 2
    v_bfe_u32 v6, v1, 2, 1
    v_lshl_add_u32 v5, v6, 3, v5
    v_bfe_u32 v6, v1, 3, 1
    v_lshl_add_u32 v5, v6, 2, v5
    v_bfe_u32 v6, v1, 4, 1
    v_lshl_add_u32 v5, v6, 4, v5
    v_add_u32 v5, s34, v5
    s_mul_i32 s36, s29, 80
    s_add_u32 s36, s36, 1
    v_bfe_u32 v4, v1, 5, 1
    v_mul_u32_u24 v4, 4, v4
    v_add_u32 v4, s36, v4
    v_mul_u32_u24 v4, v4, v5
    v_cvt_f32_u32 v4, v4
    v_cvt_f32_u32 v5, v5
    v_mul_f32 v4, s35, v4
    v_mul_f32 v5, s35, v5
    v_fract_f32 v4, v4
    v_fmamk_f32 v6, v5, 0x0, v4
    v_sin_f32 v7, -v6
    v_cos_f32 v6, v6
    s_nop 0
    v_cvt_pk_bf16_f32 v10, v6, v7
    v_fmamk_f32 v8, v5, 0x3f800000, v4
    v_sin_f32 v9, -v8
    v_cos_f32 v8, v8
    v_accvgpr_write_b32 a160, v10
    v_cvt_pk_bf16_f32 v10, v8, v9
    v_fmamk_f32 v6, v5, 0x40000000, v4
    v_sin_f32 v7, -v6
    v_cos_f32 v6, v6
    v_accvgpr_write_b32 a161, v10
    v_cvt_pk_bf16_f32 v10, v6, v7
    v_fmamk_f32 v8, v5, 0x40400000, v4
    v_sin_f32 v9, -v8
    v_cos_f32 v8, v8
    v_accvgpr_write_b32 a162, v10
    v_cvt_pk_bf16_f32 v10, v8, v9
    v_fmamk_f32 v6, v5, 0x41000000, v4
    v_sin_f32 v7, -v6
    v_cos_f32 v6, v6
    v_accvgpr_write_b32 a163, v10
    v_cvt_pk_bf16_f32 v10, v6, v7
    v_fmamk_f32 v8, v5, 0x41100000, v4
    v_sin_f32 v9, -v8
    v_cos_f32 v8, v8
    v_accvgpr_write_b32 a164, v10
    v_cvt_pk_bf16_f32 v10, v8, v9
    v_fmamk_f32 v6, v5, 0x41200000, v4
    v_sin_f32 v7, -v6
    v_cos_f32 v6, v6
    v_accvgpr_write_b32 a165, v10
    v_cvt_pk_bf16_f32 v10, v6, v7
    v_fmamk_f32 v8, v5, 0x41300000, v4
    v_sin_f32 v9, -v8
    v_cos_f32 v8, v8
    v_accvgpr_write_b32 a166, v10
    v_cvt_pk_bf16_f32 v10, v8, v9
    v_fmamk_f32 v6, v5, 0x41800000, v4
    v_sin_f32 v7, -v6
    v_cos_f32 v6, v6
    v_accvgpr_write_b32 a167, v10
    v_cvt_pk_bf16_f32 v10, v6, v7
    v_fmamk_f32 v8, v5, 0x41880000, v4
    v_sin_f32 v9, -v8
    v_cos_f32 v8, v8
    v_accvgpr_write_b32 a168, v10
    v_cvt_pk_bf16_f32 v10, v8, v9
    v_fmamk_f32 v6, v5, 0x41900000, v4
    v_sin_f32 v7, -v6
    v_cos_f32 v6, v6
    v_accvgpr_write_b32 a169, v10
    v_cvt_pk_bf16_f32 v10, v6, v7
    v_fmamk_f32 v8, v5, 0x41980000, v4
    v_sin_f32 v9, -v8
    v_cos_f32 v8, v8
    v_accvgpr_write_b32 a170, v10
    v_cvt_pk_bf16_f32 v10, v8, v9
    v_fmamk_f32 v6, v5, 0x41c00000, v4
    v_sin_f32 v7, -v6
    v_cos_f32 v6, v6
    v_accvgpr_write_b32 a171, v10
    v_cvt_pk_bf16_f32 v10, v6, v7
    v_fmamk_f32 v8, v5, 0x41c80000, v4
    v_sin_f32 v9, -v8
    v_cos_f32 v8, v8
    v_accvgpr_write_b32 a172, v10
    v_cvt_pk_bf16_f32 v10, v8, v9
    v_fmamk_f32 v6, v5, 0x41d00000, v4
    v_sin_f32 v7, -v6
    v_cos_f32 v6, v6
    v_accvgpr_write_b32 a173, v10
    v_cvt_pk_bf16_f32 v10, v6, v7
    v_fmamk_f32 v8, v5, 0x41d80000, v4
    v_sin_f32 v9, -v8
    v_cos_f32 v8, v8
    v_accvgpr_write_b32 a174, v10
    v_cvt_pk_bf16_f32 v10, v8, v9
    v_fmamk_f32 v6, v5, 0x42000000, v4
    v_sin_f32 v7, -v6
    v_cos_f32 v6, v6
    v_accvgpr_write_b32 a175, v10
    v_cvt_pk_bf16_f32 v10, v6, v7
    v_fmamk_f32 v8, v5, 0x42040000, v4
    v_sin_f32 v9, -v8
    v_cos_f32 v8, v8
    v_accvgpr_write_b32 a176, v10
    v_cvt_pk_bf16_f32 v10, v8, v9
    v_fmamk_f32 v6, v5, 0x42080000, v4
    v_sin_f32 v7, -v6
    v_cos_f32 v6, v6
    v_accvgpr_write_b32 a177, v10
    v_cvt_pk_bf16_f32 v10, v6, v7
    v_fmamk_f32 v8, v5, 0x420c0000, v4
    v_sin_f32 v9, -v8
    v_cos_f32 v8, v8
    v_accvgpr_write_b32 a178, v10
    v_cvt_pk_bf16_f32 v10, v8, v9
    v_fmamk_f32 v6, v5, 0x42200000, v4
    v_sin_f32 v7, -v6
    v_cos_f32 v6, v6
    v_accvgpr_write_b32 a179, v10
    v_cvt_pk_bf16_f32 v10, v6, v7
    v_fmamk_f32 v8, v5, 0x42240000, v4
    v_sin_f32 v9, -v8
    v_cos_f32 v8, v8
    v_accvgpr_write_b32 a180, v10
    v_cvt_pk_bf16_f32 v10, v8, v9
    v_fmamk_f32 v6, v5, 0x42280000, v4
    v_sin_f32 v7, -v6
    v_cos_f32 v6, v6
    v_accvgpr_write_b32 a181, v10
    v_cvt_pk_bf16_f32 v10, v6, v7
    v_fmamk_f32 v8, v5, 0x422c0000, v4
    v_sin_f32 v9, -v8
    v_cos_f32 v8, v8
    v_accvgpr_write_b32 a182, v10
    v_cvt_pk_bf16_f32 v10, v8, v9
    v_fmamk_f32 v6, v5, 0x42400000, v4
    v_sin_f32 v7, -v6
    v_cos_f32 v6, v6
    v_accvgpr_write_b32 a183, v10
    v_cvt_pk_bf16_f32 v10, v6, v7
    v_fmamk_f32 v8, v5, 0x42440000, v4
    v_sin_f32 v9, -v8
    v_cos_f32 v8, v8
    v_accvgpr_write_b32 a184, v10
    v_cvt_pk_bf16_f32 v10, v8, v9
    v_fmamk_f32 v6, v5, 0x42480000, v4
    v_sin_f32 v7, -v6
    v_cos_f32 v6, v6
    v_accvgpr_write_b32 a185, v10
    v_cvt_pk_bf16_f32 v10, v6, v7
    v_fmamk_f32 v8, v5, 0x424c0000, v4
    v_sin_f32 v9, -v8
    v_cos_f32 v8, v8
    v_accvgpr_write_b32 a186, v10
    v_cvt_pk_bf16_f32 v10, v8, v9
    v_fmamk_f32 v6, v5, 0x42600000, v4
    v_sin_f32 v7, -v6
    v_cos_f32 v6, v6
    v_accvgpr_write_b32 a187, v10
    v_cvt_pk_bf16_f32 v10, v6, v7
    v_fmamk_f32 v8, v5, 0x42640000, v4
    v_sin_f32 v9, -v8
    v_cos_f32 v8, v8
    v_accvgpr_write_b32 a188, v10
    v_cvt_pk_bf16_f32 v10, v8, v9
    v_fmamk_f32 v6, v5, 0x42680000, v4
    v_sin_f32 v7, -v6
    v_cos_f32 v6, v6
    v_accvgpr_write_b32 a189, v10
    v_cvt_pk_bf16_f32 v10, v6, v7
    v_fmamk_f32 v8, v5, 0x426c0000, v4
    v_sin_f32 v9, -v8
    v_cos_f32 v8, v8
    v_accvgpr_write_b32 a190, v10
    v_cvt_pk_bf16_f32 v10, v8, v9
    v_fmamk_f32 v6, v5, 0x42800000, v4
    v_sin_f32 v7, -v6
    v_cos_f32 v6, v6
    v_accvgpr_write_b32 a191, v10
    v_cvt_pk_bf16_f32 v10, v6, v7
    v_fmamk_f32 v8, v5, 0x42820000, v4
    v_sin_f32 v9, -v8
    v_cos_f32 v8, v8
    v_accvgpr_write_b32 a192, v10
    v_cvt_pk_bf16_f32 v10, v8, v9
    v_fmamk_f32 v6, v5, 0x42840000, v4
    v_sin_f32 v7, -v6
    v_cos_f32 v6, v6
    v_accvgpr_write_b32 a193, v10
    v_cvt_pk_bf16_f32 v10, v6, v7
    v_fmamk_f32 v8, v5, 0x42860000, v4
    v_sin_f32 v9, -v8
    v_cos_f32 v8, v8
    v_accvgpr_write_b32 a194, v10
    v_cvt_pk_bf16_f32 v10, v8, v9
    v_fmamk_f32 v6, v5, 0x42900000, v4
    v_sin_f32 v7, -v6
    v_cos_f32 v6, v6
    v_accvgpr_write_b32 a195, v10
    v_cvt_pk_bf16_f32 v10, v6, v7
    v_fmamk_f32 v8, v5, 0x42920000, v4
    v_sin_f32 v9, -v8
    v_cos_f32 v8, v8
    v_accvgpr_write_b32 a196, v10
    v_cvt_pk_bf16_f32 v10, v8, v9
    v_fmamk_f32 v6, v5, 0x42940000, v4
    v_sin_f32 v7, -v6
    v_cos_f32 v6, v6
    v_accvgpr_write_b32 a197, v10
    v_cvt_pk_bf16_f32 v10, v6, v7
    v_fmamk_f32 v8, v5, 0x42960000, v4
    v_sin_f32 v9, -v8
    v_cos_f32 v8, v8
    v_accvgpr_write_b32 a198, v10
    v_cvt_pk_bf16_f32 v10, v8, v9
    v_accvgpr_write_b32 a199, v10
    s_lshl_b32 s34, s67, 6
    s_add_u32 s34, s34, 32
    v_bfe_u32 v5, v1, 0, 2
    v_bfe_u32 v6, v1, 2, 1
    v_lshl_add_u32 v5, v6, 3, v5
    v_bfe_u32 v6, v1, 3, 1
    v_lshl_add_u32 v5, v6, 2, v5
    v_bfe_u32 v6, v1, 4, 1
    v_lshl_add_u32 v5, v6, 4, v5
    v_add_u32 v5, s34, v5
    s_mul_i32 s36, s29, 80
    s_add_u32 s36, s36, 1
    v_bfe_u32 v4, v1, 5, 1
    v_mul_u32_u24 v4, 4, v4
    v_add_u32 v4, s36, v4
    v_mul_u32_u24 v4, v4, v5
    v_cvt_f32_u32 v4, v4
    v_cvt_f32_u32 v5, v5
    v_mul_f32 v4, s35, v4
    v_mul_f32 v5, s35, v5
    v_fract_f32 v4, v4
    v_fmamk_f32 v6, v5, 0x0, v4
    v_sin_f32 v7, -v6
    v_cos_f32 v6, v6
    s_nop 0
    v_cvt_pk_bf16_f32 v10, v6, v7
    v_fmamk_f32 v8, v5, 0x3f800000, v4
    v_sin_f32 v9, -v8
    v_cos_f32 v8, v8
    v_accvgpr_write_b32 a200, v10
    v_cvt_pk_bf16_f32 v10, v8, v9
    v_fmamk_f32 v6, v5, 0x40000000, v4
    v_sin_f32 v7, -v6
    v_cos_f32 v6, v6
    v_accvgpr_write_b32 a201, v10
    v_cvt_pk_bf16_f32 v10, v6, v7
    v_fmamk_f32 v8, v5, 0x40400000, v4
    v_sin_f32 v9, -v8
    v_cos_f32 v8, v8
    v_accvgpr_write_b32 a202, v10
    v_cvt_pk_bf16_f32 v10, v8, v9
    v_fmamk_f32 v6, v5, 0x41000000, v4
    v_sin_f32 v7, -v6
    v_cos_f32 v6, v6
    v_accvgpr_write_b32 a203, v10
    v_cvt_pk_bf16_f32 v10, v6, v7
    v_fmamk_f32 v8, v5, 0x41100000, v4
    v_sin_f32 v9, -v8
    v_cos_f32 v8, v8
    v_accvgpr_write_b32 a204, v10
    v_cvt_pk_bf16_f32 v10, v8, v9
    v_fmamk_f32 v6, v5, 0x41200000, v4
    v_sin_f32 v7, -v6
    v_cos_f32 v6, v6
    v_accvgpr_write_b32 a205, v10
    v_cvt_pk_bf16_f32 v10, v6, v7
    v_fmamk_f32 v8, v5, 0x41300000, v4
    v_sin_f32 v9, -v8
    v_cos_f32 v8, v8
    v_accvgpr_write_b32 a206, v10
    v_cvt_pk_bf16_f32 v10, v8, v9
    v_fmamk_f32 v6, v5, 0x41800000, v4
    v_sin_f32 v7, -v6
    v_cos_f32 v6, v6
    v_accvgpr_write_b32 a207, v10
    v_cvt_pk_bf16_f32 v10, v6, v7
    v_fmamk_f32 v8, v5, 0x41880000, v4
    v_sin_f32 v9, -v8
    v_cos_f32 v8, v8
    v_accvgpr_write_b32 a208, v10
    v_cvt_pk_bf16_f32 v10, v8, v9
    v_fmamk_f32 v6, v5, 0x41900000, v4
    v_sin_f32 v7, -v6
    v_cos_f32 v6, v6
    v_accvgpr_write_b32 a209, v10
    v_cvt_pk_bf16_f32 v10, v6, v7
    v_fmamk_f32 v8, v5, 0x41980000, v4
    v_sin_f32 v9, -v8
    v_cos_f32 v8, v8
    v_accvgpr_write_b32 a210, v10
    v_cvt_pk_bf16_f32 v10, v8, v9
    v_fmamk_f32 v6, v5, 0x41c00000, v4
    v_sin_f32 v7, -v6
    v_cos_f32 v6, v6
    v_accvgpr_write_b32 a211, v10
    v_cvt_pk_bf16_f32 v10, v6, v7
    v_fmamk_f32 v8, v5, 0x41c80000, v4
    v_sin_f32 v9, -v8
    v_cos_f32 v8, v8
    v_accvgpr_write_b32 a212, v10
    v_cvt_pk_bf16_f32 v10, v8, v9
    v_fmamk_f32 v6, v5, 0x41d00000, v4
    v_sin_f32 v7, -v6
    v_cos_f32 v6, v6
    v_accvgpr_write_b32 a213, v10
    v_cvt_pk_bf16_f32 v10, v6, v7
    v_fmamk_f32 v8, v5, 0x41d80000, v4
    v_sin_f32 v9, -v8
    v_cos_f32 v8, v8
    v_accvgpr_write_b32 a214, v10
    v_cvt_pk_bf16_f32 v10, v8, v9
    v_fmamk_f32 v6, v5, 0x42000000, v4
    v_sin_f32 v7, -v6
    v_cos_f32 v6, v6
    v_accvgpr_write_b32 a215, v10
    v_cvt_pk_bf16_f32 v10, v6, v7
    v_fmamk_f32 v8, v5, 0x42040000, v4
    v_sin_f32 v9, -v8
    v_cos_f32 v8, v8
    v_accvgpr_write_b32 a216, v10
    v_cvt_pk_bf16_f32 v10, v8, v9
    v_fmamk_f32 v6, v5, 0x42080000, v4
    v_sin_f32 v7, -v6
    v_cos_f32 v6, v6
    v_accvgpr_write_b32 a217, v10
    v_cvt_pk_bf16_f32 v10, v6, v7
    v_fmamk_f32 v8, v5, 0x420c0000, v4
    v_sin_f32 v9, -v8
    v_cos_f32 v8, v8
    v_accvgpr_write_b32 a218, v10
    v_cvt_pk_bf16_f32 v10, v8, v9
    v_fmamk_f32 v6, v5, 0x42200000, v4
    v_sin_f32 v7, -v6
    v_cos_f32 v6, v6
    v_accvgpr_write_b32 a219, v10
    v_cvt_pk_bf16_f32 v10, v6, v7
    v_fmamk_f32 v8, v5, 0x42240000, v4
    v_sin_f32 v9, -v8
    v_cos_f32 v8, v8
    v_accvgpr_write_b32 a220, v10
    v_cvt_pk_bf16_f32 v10, v8, v9
    v_fmamk_f32 v6, v5, 0x42280000, v4
    v_sin_f32 v7, -v6
    v_cos_f32 v6, v6
    v_accvgpr_write_b32 a221, v10
    v_cvt_pk_bf16_f32 v10, v6, v7
    v_fmamk_f32 v8, v5, 0x422c0000, v4
    v_sin_f32 v9, -v8
    v_cos_f32 v8, v8
    v_accvgpr_write_b32 a222, v10
    v_cvt_pk_bf16_f32 v10, v8, v9
    v_fmamk_f32 v6, v5, 0x42400000, v4
    v_sin_f32 v7, -v6
    v_cos_f32 v6, v6
    v_accvgpr_write_b32 a223, v10
    v_cvt_pk_bf16_f32 v10, v6, v7
    v_fmamk_f32 v8, v5, 0x42440000, v4
    v_sin_f32 v9, -v8
    v_cos_f32 v8, v8
    v_accvgpr_write_b32 a224, v10
    v_cvt_pk_bf16_f32 v10, v8, v9
    v_fmamk_f32 v6, v5, 0x42480000, v4
    v_sin_f32 v7, -v6
    v_cos_f32 v6, v6
    v_accvgpr_write_b32 a225, v10
    v_cvt_pk_bf16_f32 v10, v6, v7
    v_fmamk_f32 v8, v5, 0x424c0000, v4
    v_sin_f32 v9, -v8
    v_cos_f32 v8, v8
    v_accvgpr_write_b32 a226, v10
    v_cvt_pk_bf16_f32 v10, v8, v9
    v_fmamk_f32 v6, v5, 0x42600000, v4
    v_sin_f32 v7, -v6
    v_cos_f32 v6, v6
    v_accvgpr_write_b32 a227, v10
    v_cvt_pk_bf16_f32 v10, v6, v7
    v_fmamk_f32 v8, v5, 0x42640000, v4
    v_sin_f32 v9, -v8
    v_cos_f32 v8, v8
    v_accvgpr_write_b32 a228, v10
    v_cvt_pk_bf16_f32 v10, v8, v9
    v_fmamk_f32 v6, v5, 0x42680000, v4
    v_sin_f32 v7, -v6
    v_cos_f32 v6, v6
    v_accvgpr_write_b32 a229, v10
    v_cvt_pk_bf16_f32 v10, v6, v7
    v_fmamk_f32 v8, v5, 0x426c0000, v4
    v_sin_f32 v9, -v8
    v_cos_f32 v8, v8
    v_accvgpr_write_b32 a230, v10
    v_cvt_pk_bf16_f32 v10, v8, v9
    v_fmamk_f32 v6, v5, 0x42800000, v4
    v_sin_f32 v7, -v6
    v_cos_f32 v6, v6
    v_accvgpr_write_b32 a231, v10
    v_cvt_pk_bf16_f32 v10, v6, v7
    v_fmamk_f32 v8, v5, 0x42820000, v4
    v_sin_f32 v9, -v8
    v_cos_f32 v8, v8
    v_accvgpr_write_b32 a232, v10
    v_cvt_pk_bf16_f32 v10, v8, v9
    v_fmamk_f32 v6, v5, 0x42840000, v4
    v_sin_f32 v7, -v6
    v_cos_f32 v6, v6
    v_accvgpr_write_b32 a233, v10
    v_cvt_pk_bf16_f32 v10, v6, v7
    v_fmamk_f32 v8, v5, 0x42860000, v4
    v_sin_f32 v9, -v8
    v_cos_f32 v8, v8
    v_accvgpr_write_b32 a234, v10
    v_cvt_pk_bf16_f32 v10, v8, v9
    v_fmamk_f32 v6, v5, 0x42900000, v4
    v_sin_f32 v7, -v6
    v_cos_f32 v6, v6
    v_accvgpr_write_b32 a235, v10
    v_cvt_pk_bf16_f32 v10, v6, v7
    v_fmamk_f32 v8, v5, 0x42920000, v4
    v_sin_f32 v9, -v8
    v_cos_f32 v8, v8
    v_accvgpr_write_b32 a236, v10
    v_cvt_pk_bf16_f32 v10, v8, v9
    v_fmamk_f32 v6, v5, 0x42940000, v4
    v_sin_f32 v7, -v6
    v_cos_f32 v6, v6
    v_accvgpr_write_b32 a237, v10
    v_cvt_pk_bf16_f32 v10, v6, v7
    v_fmamk_f32 v8, v5, 0x42960000, v4
    v_sin_f32 v9, -v8
    v_cos_f32 v8, v8
    v_accvgpr_write_b32 a238, v10
    v_cvt_pk_bf16_f32 v10, v8, v9
    v_accvgpr_write_b32 a239, v10
R_276:
    s_cmp_lt_u32 s28, 64
    s_cbranch_scc1 R_277
    s_cmp_ge_u32 s28, 160
    s_cbranch_scc1 R_277
    s_cmp_eq_u32 s64, 1
    s_cbranch_scc1 Q_278
    v_bfe_u32 v2, v1, 5, 1
    v_mul_u32_u24 v2, 512, v2
    v_bfe_u32 v3, v1, 2, 2
    v_lshl_add_u32 v2, v3, 6, v2
    v_bfe_u32 v3, v1, 4, 1
    v_lshl_add_u32 v2, v3, 4, v2
    v_bfe_u32 v3, v1, 1, 1
    v_lshl_add_u32 v2, v3, 3, v2
    v_bfe_u32 v3, v1, 0, 1
    v_lshl_add_u32 v2, v3, 5, v2
    v_add_u32 v2, s60, v2
    s_branch Q_279
Q_278:
    v_bfe_u32 v2, v1, 5, 1
    v_mul_u32_u24 v2, 512, v2
    v_bfe_u32 v3, v1, 2, 2
    v_lshl_add_u32 v2, v3, 6, v2
    v_bfe_u32 v3, v1, 4, 1
    v_lshl_add_u32 v2, v3, 5, v2
    v_bfe_u32 v3, v1, 0, 2
    v_lshl_add_u32 v2, v3, 3, v2
    v_add_u32 v2, s60, v2
Q_279:
    s_waitcnt vmcnt(0)
    ds_read_b64_tr_b16 a[80:81], v2 offset:0
    ds_read_b64_tr_b16 a[82:83], v2 offset:256
    ds_read_b64_tr_b16 a[84:85], v2 offset:1024
    ds_read_b64_tr_b16 a[86:87], v2 offset:1280
    ds_read_b64_tr_b16 a[88:89], v2 offset:2048
    ds_read_b64_tr_b16 a[90:91], v2 offset:2304
    ds_read_b64_tr_b16 a[92:93], v2 offset:3072
    ds_read_b64_tr_b16 a[94:95], v2 offset:3328
    ds_read_b64_tr_b16 a[96:97], v2 offset:4096
    ds_read_b64_tr_b16 a[98:99], v2 offset:4352
    ds_read_b64_tr_b16 a[100:101], v2 offset:5120
    ds_read_b64_tr_b16 a[102:103], v2 offset:5376
    ds_read_b64_tr_b16 a[104:105], v2 offset:6144
    ds_read_b64_tr_b16 a[106:107], v2 offset:6400
    ds_read_b64_tr_b16 a[108:109], v2 offset:7168
    ds_read_b64_tr_b16 a[110:111], v2 offset:7424
    ds_read_b64_tr_b16 a[112:113], v2 offset:8192
    ds_read_b64_tr_b16 a[114:115], v2 offset:8448
    ds_read_b64_tr_b16 a[116:117], v2 offset:9216
    ds_read_b64_tr_b16 a[118:119], v2 offset:9472
    ds_read_b64_tr_b16 a[120:121], v2 offset:10240
    ds_read_b64_tr_b16 a[122:123], v2 offset:10496
    ds_read_b64_tr_b16 a[124:125], v2 offset:11264
    ds_read_b64_tr_b16 a[126:127], v2 offset:11520
    ds_read_b64_tr_b16 a[128:129], v2 offset:12288
    ds_read_b64_tr_b16 a[130:131], v2 offset:12544
    ds_read_b64_tr_b16 a[132:133], v2 offset:13312
    ds_read_b64_tr_b16 a[134:135], v2 offset:13568
    ds_read_b64_tr_b16 a[136:137], v2 offset:14336
    ds_read_b64_tr_b16 a[138:139], v2 offset:14592
    ds_read_b64_tr_b16 a[140:141], v2 offset:15360
    ds_read_b64_tr_b16 a[142:143], v2 offset:15616
    ds_read_b64_tr_b16 a[144:145], v2 offset:16384
    ds_read_b64_tr_b16 a[146:147], v2 offset:16640
    ds_read_b64_tr_b16 a[148:149], v2 offset:17408
    ds_read_b64_tr_b16 a[150:151], v2 offset:17664
    ds_read_b64_tr_b16 a[152:153], v2 offset:18432
    ds_read_b64_tr_b16 a[154:155], v2 offset:18688
    ds_read_b64_tr_b16 a[156:157], v2 offset:19456
    ds_read_b64_tr_b16 a[158:159], v2 offset:19712
    s_waitcnt lgkmcnt(0)
    s_barrier
R_277:
    v_mov_b32 v5, 4
    s_mov_b32 s48, 0
P_280:
    buffer_load_dword v4, v5, s[24:27], 0 offen sc1
    s_waitcnt vmcnt(0)
    v_cmp_gt_u32 vcc, 1, v4
    s_cbranch_vccz P_281
    s_add_u32 s48, s48, 1
    s_cmp_gt_u32 s48, 200000
    s_cbranch_scc1 L_end
    s_sleep 1
    s_branch P_280
P_281:
    v_readfirstlane_b32 s31, v4
    s_nop 0
    s_and_b32 s31, s31, 2
    s_cmp_lt_u32 s28, 160
    s_cbranch_scc1 R_282
    v_mov_b64 v[4:5], -1
    v_mov_b64 v[6:7], -1
    s_sub_u32 s34, s28, 160
    s_lshl_b32 s34, s34, 2
    s_add_u32 s34, s34, s29
    s_lshl_b32 s34, s34, 2
    s_add_u32 s34, s34, s31
    s_lshl_b32 s34, s34, 12
    s_add_u32 s35, s34, 2097152
    buffer_store_dwordx4 v[4:7], v0, s[4:7], s35 offen sc1
    s_add_u32 s35, s34, 2098176
    buffer_store_dwordx4 v[4:7], v0, s[4:7], s35 offen sc1
    s_add_u32 s35, s34, 2099200
    buffer_store_dwordx4 v[4:7], v0, s[4:7], s35 offen sc1
    s_add_u32 s35, s34, 2100224
    buffer_store_dwordx4 v[4:7], v0, s[4:7], s35 offen sc1
    s_add_u32 s35, s34, 2101248
    buffer_store_dwordx4 v[4:7], v0, s[4:7], s35 offen sc1
    s_add_u32 s35, s34, 6291456
    buffer_store_dwordx4 v[4:7], v0, s[4:7], s35 offen sc1
    s_add_u32 s35, s34, 6292480
    buffer_store_dwordx4 v[4:7], v0, s[4:7], s35 offen sc1
    s_add_u32 s35, s34, 6293504
    buffer_store_dwordx4 v[4:7], v0, s[4:7], s35 offen sc1
    s_add_u32 s35, s34, 6294528
    buffer_store_dwordx4 v[4:7], v0, s[4:7], s35 offen sc1
    s_add_u32 s35, s34, 6295552
    buffer_store_dwordx4 v[4:7], v0, s[4:7], s35 offen sc1
    s_waitcnt vmcnt(0)
    s_barrier
    s_cmp_lg_u32 s29, 0
    s_cbranch_scc1 F_283
    s_lshl_b32 s32, s28, 5
    s_add_u32 s32, s32, s29
    s_lshl_b32 s32, s32, 2
    s_add_u32 s32, s32, 1220608
    v_mov_b32 v8, 1
    s_mov_b64 exec, 1
    buffer_store_dword v8, off, s[4:7], s32 sc1
    s_mov_b64 exec, -1
F_283:
R_282:
LAYER_264:
    s_cmp_lt_u32 s28, 160
    s_cbranch_scc1 R_284
    s_cmp_ge_u32 s28, 190
    s_cbranch_scc1 R_284
    s_sub_u32 s44, s66, 16
    s_mul_i32 s50, s30, 3145728
    s_add_u32 s50, s50, 27262976
    s_mul_i32 s34, s29, 10240
    s_add_u32 s50, s50, s34
    s_mul_i32 s51, s30, 6291456
    s_add_u32 s51, s51, 11534336
    s_lshl_b32 s34, s67, 12
    s_add_u32 s51, s51, s34
    s_add_u32 s52, s34, 14680064
    s_mov_b32 s58, 40960
    v_bfe_u32 v2, v1, 5, 1
    v_mul_u32_u24 v2, 512, v2
    v_bfe_u32 v172, v1, 2, 2
    v_lshl_add_u32 v2, v172, 6, v2
    v_bfe_u32 v172, v1, 4, 1
    v_lshl_add_u32 v2, v172, 5, v2
    v_bfe_u32 v172, v1, 0, 1
    v_lshl_add_u32 v2, v172, 4, v2
    v_bfe_u32 v172, v1, 1, 1
    v_lshl_add_u32 v2, v172, 3, v2
    v_add_u32 v2, s60, v2
    s_lshl_b32 s34, s29, 13
    v_add_u32 v4, s34, v0
    s_lshl_b32 s34, s29, 3
    s_add_u32 s34, s34, 65536
    v_bfe_u32 v5, v1, 0, 5
    v_mul_u32_u24 v5, 32, v5
    v_add_u32 v5, s34, v5
    s_lshl_b32 s35, s29, 11
    s_lshl_b32 s36, s29, 8
    s_add_u32 s36, s36, 67584
    v_add_u32 v3, s35, v0
    s_lshl_b32 s34, s29, 10
    v_add_u32 v7, s34, v0
    v_bfe_u32 v6, v1, 0, 5
    v_mul_u32_u24 v6, 32, v6
    v_add_u32 v6, 65536, v6
    s_lshl_b32 s34, s29, 5
    v_bfe_u32 v8, v1, 0, 2
    v_mul_u32_u24 v8, 1280, v8
    v_bfe_u32 v172, v1, 2, 1
    v_mul_u32_u24 v172, 10240, v172
    v_add_u32 v8, v8, v172
    v_bfe_u32 v172, v1, 3, 1
    v_mul_u32_u24 v172, 5120, v172
    v_add_u32 v8, v8, v172
    v_bfe_u32 v172, v1, 4, 1
    v_mul_u32_u24 v172, 20480, v172
    v_add_u32 v8, v8, v172
    v_bfe_u32 v172, v1, 5, 1
    v_lshl_add_u32 v8, v172, 4, v8
    v_add_u32 v8, s34, v8
    s_cmp_lg_u32 s30, 0
    s_cbranch_scc1 F3_285
    s_lshl_b32 s52, s67, 7
    s_mov_b64 s[16:17], s[76:77]
    s_mov_b32 s18, 2621440
    s_mov_b32 s19, 0x20000
    s_branch F3_286
F3_285:
    v_mov_b32 v8, v7
    s_mov_b64 s[16:17], s[100:101]
    s_mov_b32 s18, 268435456
    s_mov_b32 s19, 0x20000
F3_286:
    s_add_u32 s57, s30, 1
    s_mul_i32 s37, s29, 40
    v_min_u32 v176, 39, v1
    v_lshlrev_b32 v176, 7, v176
    s_lshl_b32 s32, s37, 7
    s_add_u32 s32, s32, 1097728
    s_mov_b32 s48, 0
P_287:
    buffer_load_dword v172, v176, s[4:7], s32 offen sc1
    s_waitcnt vmcnt(0)
    v_cmp_gt_u32 vcc, s57, v172
    s_cbranch_vccz P_288
    s_add_u32 s48, s48, 1
    s_cmp_gt_u32 s48, 200000
    s_cbranch_scc1 L_end
    s_sleep 1
    s_branch P_287
P_288:
    s_mul_i32 s54, s44, 40960
    s_add_u32 s56, s54, s52
    s_add_u32 s54, s54, s50
    s_add_u32 m0, s60, 0
    s_nop 0
    buffer_load_dwordx4 v0, s[4:7], s54 offen offset:0 sc1 lds
    buffer_load_dwordx4 v0, s[4:7], s54 offen offset:1024 sc1 lds
    buffer_load_dwordx4 v0, s[4:7], s54 offen offset:2048 sc1 lds
    buffer_load_dwordx4 v0, s[4:7], s54 offen offset:3072 sc1 lds
    s_add_u32 s54, s54, 4096
    s_add_u32 m0, s60, 4096
    s_nop 0
    buffer_load_dwordx4 v0, s[4:7], s54 offen offset:0 sc1 lds
    buffer_load_dwordx4 v0, s[4:7], s54 offen offset:1024 sc1 lds
    buffer_load_dwordx4 v0, s[4:7], s54 offen offset:2048 sc1 lds
    buffer_load_dwordx4 v0, s[4:7], s54 offen offset:3072 sc1 lds
    s_add_u32 s54, s54, 4096
    s_add_u32 m0, s60, 8192
    s_nop 0
    buffer_load_dwordx4 v0, s[4:7], s54 offen offset:0 sc1 lds
    buffer_load_dwordx4 v0, s[4:7], s54 offen offset:1024 sc1 lds
    buffer_load_dwordx4 v[164:167], v8, s[16:19], s56 offen sc1
    s_waitcnt vmcnt(0)
    ds_read_b64_tr_b16 v[16:17], v2 offset:0
    ds_read_b64_tr_b16 v[18:19], v2 offset:256
    ds_read_b64_tr_b16 v[20:21], v2 offset:1024
    ds_read_b64_tr_b16 v[22:23], v2 offset:1280
    ds_read_b64_tr_b16 v[24:25], v2 offset:2048
    ds_read_b64_tr_b16 v[26:27], v2 offset:2304
    ds_read_b64_tr_b16 v[28:29], v2 offset:3072
    ds_read_b64_tr_b16 v[30:31], v2 offset:3328
    ds_read_b64_tr_b16 v[32:33], v2 offset:4096
    ds_read_b64_tr_b16 v[34:35], v2 offset:4352
    ds_read_b64_tr_b16 v[36:37], v2 offset:5120
    ds_read_b64_tr_b16 v[38:39], v2 offset:5376
    ds_read_b64_tr_b16 v[40:41], v2 offset:6144
    ds_read_b64_tr_b16 v[42:43], v2 offset:6400
    ds_read_b64_tr_b16 v[44:45], v2 offset:7168
    ds_read_b64_tr_b16 v[46:47], v2 offset:7424
    ds_read_b64_tr_b16 v[48:49], v2 offset:8192
    ds_read_b64_tr_b16 v[50:51], v2 offset:8448
    ds_read_b64_tr_b16 v[52:53], v2 offset:9216
    ds_read_b64_tr_b16 v[54:55], v2 offset:9472
    s_waitcnt lgkmcnt(15)
    v_mfma_f32_32x32x16_bf16 v[96:111], a[160:163], v[16:19], 0
    v_mfma_f32_32x32x16_bf16 v[112:127], a[200:203], v[16:19], 0
    v_mfma_f32_32x32x16_bf16 v[96:111], a[164:167], v[20:23], v[96:111]
    v_mfma_f32_32x32x16_bf16 v[112:127], a[204:207], v[20:23], v[112:127]
    s_waitcnt lgkmcnt(14)
    v_mfma_f32_32x32x16_bf16 v[96:111], a[168:171], v[24:27], v[96:111]
    v_mfma_f32_32x32x16_bf16 v[112:127], a[208:211], v[24:27], v[112:127]
    s_waitcnt lgkmcnt(12)
    v_mfma_f32_32x32x16_bf16 v[96:111], a[172:175], v[28:31], v[96:111]
    v_mfma_f32_32x32x16_bf16 v[112:127], a[212:215], v[28:31], v[112:127]
    s_waitcnt lgkmcnt(10)
    v_mfma_f32_32x32x16_bf16 v[96:111], a[176:179], v[32:35], v[96:111]
    v_mfma_f32_32x32x16_bf16 v[112:127], a[216:219], v[32:35], v[112:127]
    s_waitcnt lgkmcnt(8)
    v_mfma_f32_32x32x16_bf16 v[96:111], a[180:183], v[36:39], v[96:111]
    v_mfma_f32_32x32x16_bf16 v[112:127], a[220:223], v[36:39], v[112:127]
    s_waitcnt lgkmcnt(6)
    v_mfma_f32_32x32x16_bf16 v[96:111], a[184:187], v[40:43], v[96:111]
    v_mfma_f32_32x32x16_bf16 v[112:127], a[224:227], v[40:43], v[112:127]
    s_waitcnt lgkmcnt(4)
    v_mfma_f32_32x32x16_bf16 v[96:111], a[188:191], v[44:47], v[96:111]
    v_mfma_f32_32x32x16_bf16 v[112:127], a[228:231], v[44:47], v[112:127]
    s_waitcnt lgkmcnt(2)
    v_mfma_f32_32x32x16_bf16 v[96:111], a[192:195], v[48:51], v[96:111]
    v_mfma_f32_32x32x16_bf16 v[112:127], a[232:235], v[48:51], v[112:127]
    s_waitcnt lgkmcnt(0)
    v_mfma_f32_32x32x16_bf16 v[96:111], a[196:199], v[52:55], v[96:111]
    v_mfma_f32_32x32x16_bf16 v[112:127], a[236:239], v[52:55], v[112:127]
    s_mul_i32 s55, s44, s58
    s_add_u32 s55, s55, s51
    s_nop 1
    ds_write_b128 v4, v[96:99] offset:0
    ds_write_b128 v4, v[100:103] offset:1024
    ds_write_b128 v4, v[104:107] offset:2048
    ds_write_b128 v4, v[108:111] offset:3072
    ds_write_b128 v4, v[112:115] offset:4096
    ds_write_b128 v4, v[116:119] offset:5120
    ds_write_b128 v4, v[120:123] offset:6144
    ds_write_b128 v4, v[124:127] offset:7168
    s_waitcnt lgkmcnt(0)
    s_barrier
    ds_read_b128 v[96:99], v3 offset:0
    ds_read_b128 v[100:103], v3 offset:1024
    ds_read_b128 v[104:107], v3 offset:8192
    ds_read_b128 v[108:111], v3 offset:9216
    ds_read_b128 v[112:115], v3 offset:16384
    ds_read_b128 v[116:119], v3 offset:17408
    ds_read_b128 v[120:123], v3 offset:24576
    ds_read_b128 v[124:127], v3 offset:25600
    s_waitcnt lgkmcnt(5)
    v_pk_add_f32 v[96:97], v[96:97], v[104:105]
    v_pk_add_f32 v[98:99], v[98:99], v[106:107]
    s_waitcnt lgkmcnt(4)
    v_pk_add_f32 v[100:101], v[100:101], v[108:109]
    v_pk_add_f32 v[102:103], v[102:103], v[110:111]
    s_waitcnt lgkmcnt(3)
    v_pk_add_f32 v[96:97], v[96:97], v[112:113]
    v_pk_add_f32 v[98:99], v[98:99], v[114:115]
    s_waitcnt lgkmcnt(2)
    v_pk_add_f32 v[100:101], v[100:101], v[116:117]
    v_pk_add_f32 v[102:103], v[102:103], v[118:119]
    s_waitcnt lgkmcnt(1)
    v_pk_add_f32 v[96:97], v[96:97], v[120:121]
    v_pk_add_f32 v[98:99], v[98:99], v[122:123]
    s_waitcnt lgkmcnt(0)
    v_pk_add_f32 v[100:101], v[100:101], v[124:125]
    v_pk_add_f32 v[102:103], v[102:103], v[126:127]
    v_cvt_pk_bf16_f32 v172, v96, v97
    v_cvt_pk_bf16_f32 v173, v98, v99
    v_cvt_pk_bf16_f32 v174, v100, v101
    v_cvt_pk_bf16_f32 v175, v102, v103
    v_lshlrev_b32 v96, 16, v172
    v_lshlrev_b32 v97, 16, v164
    v_and_b32 v98, 0xffff0000, v172
    v_and_b32 v99, 0xffff0000, v164
    v_add_f32 v96, v96, v97
    v_add_f32 v98, v98, v99
    v_cvt_pk_bf16_f32 v172, v96, v98
    v_lshlrev_b32 v96, 16, v173
    v_lshlrev_b32 v97, 16, v165
    v_and_b32 v98, 0xffff0000, v173
    v_and_b32 v99, 0xffff0000, v165
    v_add_f32 v96, v96, v97
    v_add_f32 v98, v98, v99
    v_cvt_pk_bf16_f32 v173, v96, v98
    v_lshlrev_b32 v96, 16, v174
    v_lshlrev_b32 v97, 16, v166
    v_and_b32 v98, 0xffff0000, v174
    v_and_b32 v99, 0xffff0000, v166
    v_add_f32 v96, v96, v97
    v_add_f32 v98, v98, v99
    v_cvt_pk_bf16_f32 v174, v96, v98
    v_lshlrev_b32 v96, 16, v175
    v_lshlrev_b32 v97, 16, v167
    v_and_b32 v98, 0xffff0000, v175
    v_and_b32 v99, 0xffff0000, v167
    v_add_f32 v96, v96, v97
    v_add_f32 v98, v98, v99
    v_cvt_pk_bf16_f32 v175, v96, v98
    buffer_store_dwordx4 v[172:175], v7, s[4:7], s55 offen sc1
    s_lshl_b32 s57, s30, 1
    s_add_u32 s57, s57, 1
    s_waitcnt vmcnt(0)
    s_barrier
    s_cmp_lg_u32 s29, 0
    s_cbranch_scc1 F_289
    s_lshl_b32 s32, s28, 5
    s_add_u32 s32, s32, s29
    s_lshl_b32 s32, s32, 2
    s_add_u32 s32, s32, 1122304
    v_mov_b32 v172, s57
    s_mov_b64 exec, 1
    buffer_store_dword v172, off, s[4:7], s32 sc1
    s_mov_b64 exec, -1
F_289:
R_284:
    s_cmp_lt_u32 s28, 60
    s_cbranch_scc1 LAYER_266
LAYER_265:
    s_add_u32 s32, s28, s61
    s_cmp_ge_u32 s32, 64
    s_cbranch_scc1 R_290
    s_cmp_eq_u32 s64, 1
    s_cselect_b64 s[20:21], s[90:91], s[88:89]
    s_cmp_eq_u32 s64, 2
    s_cselect_b64 s[20:21], s[86:87], s[20:21]
    s_mov_b32 s22, 5242880
    s_mov_b32 s23, 0x20000
    v_bfe_u32 v14, v1, 2, 4
    v_mul_u32_u24 v14, 8192, v14
    v_bfe_u32 v15, v1, 0, 2
    v_lshl_add_u32 v14, v15, 4, v14
    s_lshl_b32 s38, s29, 6
    s_lshl_b32 s35, s63, 8
    s_add_u32 s38, s38, s35
    s_add_u32 m0, s60, 0
    s_add_u32 s39, s38, 2621440
    buffer_load_dwordx4 v14, s[20:23], s39 offen lds
    s_add_u32 m0, s60, 1024
    s_add_u32 s39, s38, 2752512
    buffer_load_dwordx4 v14, s[20:23], s39 offen lds
    s_add_u32 m0, s60, 2048
    s_add_u32 s39, s38, 2883584
    buffer_load_dwordx4 v14, s[20:23], s39 offen lds
    s_add_u32 m0, s60, 3072
    s_add_u32 s39, s38, 3014656
    buffer_load_dwordx4 v14, s[20:23], s39 offen lds
    s_add_u32 m0, s60, 4096
    s_add_u32 s39, s38, 3145728
    buffer_load_dwordx4 v14, s[20:23], s39 offen lds
    s_add_u32 m0, s60, 5120
    s_add_u32 s39, s38, 3276800
    buffer_load_dwordx4 v14, s[20:23], s39 offen lds
    s_add_u32 m0, s60, 6144
    s_add_u32 s39, s38, 3407872
    buffer_load_dwordx4 v14, s[20:23], s39 offen lds
    s_add_u32 m0, s60, 7168
    s_add_u32 s39, s38, 3538944
    buffer_load_dwordx4 v14, s[20:23], s39 offen lds
    s_add_u32 m0, s60, 8192
    s_add_u32 s39, s38, 3670016
    buffer_load_dwordx4 v14, s[20:23], s39 offen lds
    s_add_u32 m0, s60, 9216
    s_add_u32 s39, s38, 3801088
    buffer_load_dwordx4 v14, s[20:23], s39 offen lds
    s_add_u32 m0, s60, 10240
    s_add_u32 s39, s38, 3932160
    buffer_load_dwordx4 v14, s[20:23], s39 offen lds
    s_add_u32 m0, s60, 11264
    s_add_u32 s39, s38, 4063232
    buffer_load_dwordx4 v14, s[20:23], s39 offen lds
    s_add_u32 m0, s60, 12288
    s_add_u32 s39, s38, 4194304
    buffer_load_dwordx4 v14, s[20:23], s39 offen lds
    s_add_u32 m0, s60, 13312
    s_add_u32 s39, s38, 4325376
    buffer_load_dwordx4 v14, s[20:23], s39 offen lds
    s_add_u32 m0, s60, 14336
    s_add_u32 s39, s38, 4456448
    buffer_load_dwordx4 v14, s[20:23], s39 offen lds
    s_add_u32 m0, s60, 15360
    s_add_u32 s39, s38, 4587520
    buffer_load_dwordx4 v14, s[20:23], s39 offen lds
    s_add_u32 m0, s60, 16384
    s_add_u32 s39, s38, 4718592
    buffer_load_dwordx4 v14, s[20:23], s39 offen lds
    s_add_u32 m0, s60, 17408
    s_add_u32 s39, s38, 4849664
    buffer_load_dwordx4 v14, s[20:23], s39 offen lds
    s_add_u32 m0, s60, 18432
    s_add_u32 s39, s38, 4980736
    buffer_load_dwordx4 v14, s[20:23], s39 offen lds
    s_add_u32 m0, s60, 19456
    s_add_u32 s39, s38, 5111808
    buffer_load_dwordx4 v14, s[20:23], s39 offen lds
    s_cmp_eq_u32 s64, 1
    s_cbranch_scc1 Q_291
    v_bfe_u32 v14, v1, 5, 1
    v_mul_u32_u24 v14, 512, v14
    v_bfe_u32 v15, v1, 2, 2
    v_lshl_add_u32 v14, v15, 6, v14
    v_bfe_u32 v15, v1, 4, 1
    v_lshl_add_u32 v14, v15, 4, v14
    v_bfe_u32 v15, v1, 1, 1
    v_lshl_add_u32 v14, v15, 3, v14
    v_bfe_u32 v15, v1, 0, 1
    v_lshl_add_u32 v14, v15, 5, v14
    v_add_u32 v14, s60, v14
    s_branch Q_292
Q_291:
    v_bfe_u32 v14, v1, 5, 1
    v_mul_u32_u24 v14, 512, v14
    v_bfe_u32 v15, v1, 2, 2
    v_lshl_add_u32 v14, v15, 6, v14
    v_bfe_u32 v15, v1, 4, 1
    v_lshl_add_u32 v14, v15, 5, v14
    v_bfe_u32 v15, v1, 0, 2
    v_lshl_add_u32 v14, v15, 3, v14
    v_add_u32 v14, s60, v14
Q_292:
    s_waitcnt vmcnt(0)
    ds_read_b64_tr_b16 a[80:81], v14 offset:0
    ds_read_b64_tr_b16 a[82:83], v14 offset:256
    ds_read_b64_tr_b16 a[84:85], v14 offset:1024
    ds_read_b64_tr_b16 a[86:87], v14 offset:1280
    ds_read_b64_tr_b16 a[88:89], v14 offset:2048
    ds_read_b64_tr_b16 a[90:91], v14 offset:2304
    ds_read_b64_tr_b16 a[92:93], v14 offset:3072
    ds_read_b64_tr_b16 a[94:95], v14 offset:3328
    ds_read_b64_tr_b16 a[96:97], v14 offset:4096
    ds_read_b64_tr_b16 a[98:99], v14 offset:4352
    ds_read_b64_tr_b16 a[100:101], v14 offset:5120
    ds_read_b64_tr_b16 a[102:103], v14 offset:5376
    ds_read_b64_tr_b16 a[104:105], v14 offset:6144
    ds_read_b64_tr_b16 a[106:107], v14 offset:6400
    ds_read_b64_tr_b16 a[108:109], v14 offset:7168
    ds_read_b64_tr_b16 a[110:111], v14 offset:7424
    ds_read_b64_tr_b16 a[112:113], v14 offset:8192
    ds_read_b64_tr_b16 a[114:115], v14 offset:8448
    ds_read_b64_tr_b16 a[116:117], v14 offset:9216
    ds_read_b64_tr_b16 a[118:119], v14 offset:9472
    ds_read_b64_tr_b16 a[120:121], v14 offset:10240
    ds_read_b64_tr_b16 a[122:123], v14 offset:10496
    ds_read_b64_tr_b16 a[124:125], v14 offset:11264
    ds_read_b64_tr_b16 a[126:127], v14 offset:11520
    ds_read_b64_tr_b16 a[128:129], v14 offset:12288
    ds_read_b64_tr_b16 a[130:131], v14 offset:12544
    ds_read_b64_tr_b16 a[132:133], v14 offset:13312
    ds_read_b64_tr_b16 a[134:135], v14 offset:13568
    ds_read_b64_tr_b16 a[136:137], v14 offset:14336
    ds_read_b64_tr_b16 a[138:139], v14 offset:14592
    ds_read_b64_tr_b16 a[140:141], v14 offset:15360
    ds_read_b64_tr_b16 a[142:143], v14 offset:15616
    ds_read_b64_tr_b16 a[144:145], v14 offset:16384
    ds_read_b64_tr_b16 a[146:147], v14 offset:16640
    ds_read_b64_tr_b16 a[148:149], v14 offset:17408
    ds_read_b64_tr_b16 a[150:151], v14 offset:17664
    ds_read_b64_tr_b16 a[152:153], v14 offset:18432
    ds_read_b64_tr_b16 a[154:155], v14 offset:18688
    ds_read_b64_tr_b16 a[156:157], v14 offset:19456
    ds_read_b64_tr_b16 a[158:159], v14 offset:19712
    s_waitcnt lgkmcnt(0)
    s_barrier
R_290:
    s_mov_b32 s68, 0
    s_cmp_lt_u32 s28, 128
    s_cselect_b32 s46, 20, 2
    s_lshl_b32 s57, s30, 1
    s_add_u32 s57, s57, 1
LAYER_263:
    s_waitcnt vmcnt(0) lgkmcnt(0)
    s_add_u32 s44, s68, s65
    s_cmp_eq_u32 s64, 2
    s_cselect_b32 s47, 64, 2
    s_cselect_b32 s74, 2, 0
    s_xor_b32 s74, s74, s31
    s_mul_i32 s52, s29, 10240
    s_mul_i32 s50, s30, 6291456
    s_add_u32 s50, s50, 11534336
    s_add_u32 s50, s50, s52
    s_add_u32 s49, s61, s44
    s_mul_i32 s53, s63, 3
    s_add_u32 s53, s53, s64
    s_lshl_b32 s53, s53, 1
    s_add_u32 s53, s53, s65
    s_lshl_b32 s53, s53, 7
    s_add_u32 s53, s53, 1146880
    s_cmp_eq_u32 s29, 0
    s_cselect_b32 s53, s53, 0x40000000
    v_add_u32 v2, s52, v0
    v_add_u32 v8, 0x10000, v0
    s_lshl_b32 s34, s29, 3
    s_add_u32 s34, s34, 81920
    v_bfe_u32 v3, v1, 0, 5
    v_mul_u32_u24 v3, 32, v3
    v_add_u32 v3, s34, v3
    v_bfe_u32 v4, v1, 0, 5
    v_mul_u32_u24 v4, 32, v4
    v_add_u32 v4, 81920, v4
    s_lshl_b32 s36, s29, 8
    s_add_u32 s37, s36, 151552
    s_cmp_eq_u32 s64, 1
    s_cbranch_scc1 G1_293
    s_cmp_eq_u32 s64, 2
    s_cbranch_scc1 G1_294
    s_mul_i32 s51, s30, 67108864
    s_add_u32 s51, s51, 119537664
    s_lshl_b32 s34, s63, 15
    s_lshl_b32 s35, s29, 9
    s_add_u32 s51, s51, s34
    s_add_u32 s51, s51, s35
    s_and_b32 s34, s63, 1
    s_lshl_b32 s34, s34, 14
    s_xor_b32 s51, s51, s34
    s_mov_b32 s58, 1048576
    s_mov_b32 s59, 256
    v_bfe_u32 v5, v1, 1, 1
    v_mul_u32_u24 v5, 2048, v5
    v_bfe_u32 v176, v1, 3, 1
    v_lshl_add_u32 v5, v176, 12, v5
    v_bfe_u32 v176, v1, 2, 1
    v_lshl_add_u32 v5, v176, 6, v5
    v_bfe_u32 v176, v1, 4, 1
    v_lshl_add_u32 v5, v176, 7, v5
    v_bfe_u32 v176, v1, 5, 1
    v_lshl_add_u32 v5, v176, 5, v5
    v_bfe_u32 v176, v1, 0, 1
    v_lshl_add_u32 v5, v176, 4, v5
    s_branch G1_295
G1_293:
    s_mul_i32 s51, s30, 67108864
    s_add_u32 s51, s51, 119554048
    s_lshl_b32 s34, s63, 15
    s_lshl_b32 s35, s29, 11
    s_add_u32 s51, s51, s34
    s_add_u32 s51, s51, s35
    s_and_b32 s34, s63, 1
    s_lshl_b32 s34, s34, 14
    s_xor_b32 s51, s51, s34
    s_mov_b32 s58, 1048576
    s_mov_b32 s59, 512
    v_bfe_u32 v5, v1, 4, 1
    v_mul_u32_u24 v5, 1024, v5
    v_bfe_u32 v176, v1, 5, 1
    v_lshl_add_u32 v5, v176, 8, v5
    v_bfe_u32 v176, v1, 0, 4
    v_lshl_add_u32 v5, v176, 4, v5
    s_add_u32 s36, s36, 83968
    v_bfe_u32 v6, v1, 0, 2
    v_mul_u32_u24 v6, 4, v6
    v_bfe_u32 v176, v1, 2, 1
    v_lshl_add_u32 v6, v176, 5, v6
    v_bfe_u32 v176, v1, 3, 1
    v_lshl_add_u32 v6, v176, 4, v6
    v_bfe_u32 v176, v1, 4, 1
    v_lshl_add_u32 v6, v176, 6, v6
    v_add_u32 v6, s36, v6
    v_bfe_u32 v7, v1, 5, 1
    v_mul_u32_u24 v7, 32, v7
    v_add_u32 v7, s36, v7
    v_bfe_u32 v184, v1, 0, 6
    v_mul_u32_u24 v184, 4, v184
    v_add_u32 v184, s37, v184
    s_cmp_gt_u32 s49, 1
    s_cbranch_scc1 G1_297
    s_mov_b32 s34, 0x3f803f80
    v_mov_b32 v16, s34
    v_mov_b32 v17, s34
    v_mov_b32 v18, s34
    v_mov_b32 v19, s34
    s_nop 1
    v_mfma_f32_32x32x16_bf16 v[88:103], v[16:19], a[0:3], 0
    v_mfma_f32_32x32x16_bf16 v[88:103], v[16:19], a[4:7], v[88:103]
    v_mfma_f32_32x32x16_bf16 v[88:103], v[16:19], a[8:11], v[88:103]
    v_mfma_f32_32x32x16_bf16 v[88:103], v[16:19], a[12:15], v[88:103]
    v_mfma_f32_32x32x16_bf16 v[88:103], v[16:19], a[16:19], v[88:103]
    v_mfma_f32_32x32x16_bf16 v[88:103], v[16:19], a[20:23], v[88:103]
    v_mfma_f32_32x32x16_bf16 v[88:103], v[16:19], a[24:27], v[88:103]
    v_mfma_f32_32x32x16_bf16 v[88:103], v[16:19], a[28:31], v[88:103]
    v_mfma_f32_32x32x16_bf16 v[88:103], v[16:19], a[32:35], v[88:103]
    v_mfma_f32_32x32x16_bf16 v[88:103], v[16:19], a[36:39], v[88:103]
    v_mfma_f32_32x32x16_bf16 v[88:103], v[16:19], a[40:43], v[88:103]
    v_mfma_f32_32x32x16_bf16 v[88:103], v[16:19], a[44:47], v[88:103]
    v_mfma_f32_32x32x16_bf16 v[88:103], v[16:19], a[48:51], v[88:103]
    v_mfma_f32_32x32x16_bf16 v[88:103], v[16:19], a[52:55], v[88:103]
    v_mfma_f32_32x32x16_bf16 v[88:103], v[16:19], a[56:59], v[88:103]
    v_mfma_f32_32x32x16_bf16 v[88:103], v[16:19], a[60:63], v[88:103]
    v_mfma_f32_32x32x16_bf16 v[88:103], v[16:19], a[64:67], v[88:103]
    v_mfma_f32_32x32x16_bf16 v[88:103], v[16:19], a[68:71], v[88:103]
    v_mfma_f32_32x32x16_bf16 v[88:103], v[16:19], a[72:75], v[88:103]
    v_mfma_f32_32x32x16_bf16 v[88:103], v[16:19], a[76:79], v[88:103]
    v_mfma_f32_32x32x16_bf16 v[88:103], v[16:19], a[80:83], v[88:103]
    v_mfma_f32_32x32x16_bf16 v[88:103], v[16:19], a[84:87], v[88:103]
    v_mfma_f32_32x32x16_bf16 v[88:103], v[16:19], a[88:91], v[88:103]
    v_mfma_f32_32x32x16_bf16 v[88:103], v[16:19], a[92:95], v[88:103]
    v_mfma_f32_32x32x16_bf16 v[88:103], v[16:19], a[96:99], v[88:103]
    v_mfma_f32_32x32x16_bf16 v[88:103], v[16:19], a[100:103], v[88:103]
    v_mfma_f32_32x32x16_bf16 v[88:103], v[16:19], a[104:107], v[88:103]
    v_mfma_f32_32x32x16_bf16 v[88:103], v[16:19], a[108:111], v[88:103]
    v_mfma_f32_32x32x16_bf16 v[88:103], v[16:19], a[112:115], v[88:103]
    v_mfma_f32_32x32x16_bf16 v[88:103], v[16:19], a[116:119], v[88:103]
    v_mfma_f32_32x32x16_bf16 v[88:103], v[16:19], a[120:123], v[88:103]
    v_mfma_f32_32x32x16_bf16 v[88:103], v[16:19], a[124:127], v[88:103]
    v_mfma_f32_32x32x16_bf16 v[88:103], v[16:19], a[128:131], v[88:103]
    v_mfma_f32_32x32x16_bf16 v[88:103], v[16:19], a[132:135], v[88:103]
    v_mfma_f32_32x32x16_bf16 v[88:103], v[16:19], a[136:139], v[88:103]
    v_mfma_f32_32x32x16_bf16 v[88:103], v[16:19], a[140:143], v[88:103]
    v_mfma_f32_32x32x16_bf16 v[88:103], v[16:19], a[144:147], v[88:103]
    v_mfma_f32_32x32x16_bf16 v[88:103], v[16:19], a[148:151], v[88:103]
    v_mfma_f32_32x32x16_bf16 v[88:103], v[16:19], a[152:155], v[88:103]
    v_mfma_f32_32x32x16_bf16 v[88:103], v[16:19], a[156:159], v[88:103]
    s_nop 11
    ds_write_b32 v184, v88
G1_297:
    ds_read_b32 v116, v184
    s_cmp_lg_u32 s68, 0
    s_cbranch_scc1 G1_298
    v_min_u32 v180, 29, v1
    v_lshlrev_b32 v180, 7, v180
    s_mov_b32 s32, 1142784
    s_mov_b32 s48, 0
P_299:
    buffer_load_dword v176, v180, s[4:7], s32 offen sc1
    s_waitcnt vmcnt(0)
    v_cmp_gt_u32 vcc, s57, v176
    s_cbranch_vccz P_300
    s_add_u32 s48, s48, 1
    s_cmp_gt_u32 s48, 200000
    s_cbranch_scc1 L_end
    s_sleep 1
    s_branch P_299
P_300:
    s_mul_i32 s54, s44, 40960
    s_add_u32 s56, s54, s52
    s_add_u32 s54, s54, s50
    s_waitcnt lgkmcnt(0)
    s_add_u32 m0, s52, 0
    s_add_u32 s35, s54, 0
    buffer_load_dwordx4 v0, s[4:7], s35 offen offset:0 sc1 lds
    buffer_load_dwordx4 v0, s[4:7], s35 offen offset:1024 sc1 lds
    buffer_load_dwordx4 v0, s[4:7], s35 offen offset:2048 sc1 lds
    buffer_load_dwordx4 v0, s[4:7], s35 offen offset:3072 sc1 lds
    s_add_u32 m0, s52, 4096
    s_add_u32 s35, s54, 4096
    buffer_load_dwordx4 v0, s[4:7], s35 offen offset:0 sc1 lds
    buffer_load_dwordx4 v0, s[4:7], s35 offen offset:1024 sc1 lds
    buffer_load_dwordx4 v0, s[4:7], s35 offen offset:2048 sc1 lds
    buffer_load_dwordx4 v0, s[4:7], s35 offen offset:3072 sc1 lds
    s_add_u32 m0, s52, 8192
    s_add_u32 s35, s54, 8192
    buffer_load_dwordx4 v0, s[4:7], s35 offen offset:0 sc1 lds
    buffer_load_dwordx4 v0, s[4:7], s35 offen offset:1024 sc1 lds
    buffer_load_dword v185, off, s[8:11], 0
    buffer_load_dword v185, off, s[8:11], 0
    buffer_load_dword v185, off, s[8:11], 0
G1_301:
    v_mov_b64 v[104:105], 0
    s_mov_b32 s34, 0x3f803f80
    s_waitcnt vmcnt(11)
    ds_read_b128 v[16:19], v2 offset:0
    ds_read_b128 v[20:23], v2 offset:1024
    s_waitcnt vmcnt(9)
    ds_read_b128 v[24:27], v2 offset:2048
    ds_read_b128 v[28:31], v2 offset:3072
    s_waitcnt vmcnt(7)
    ds_read_b128 v[32:35], v2 offset:4096
    ds_read_b128 v[36:39], v2 offset:5120
    s_waitcnt lgkmcnt(5)
    v_dot2c_f32_bf16 v104, s34, v16
    v_dot2c_f32_bf16 v105, v16, v16
    v_dot2c_f32_bf16 v104, s34, v17
    v_dot2c_f32_bf16 v105, v17, v17
    v_dot2c_f32_bf16 v104, s34, v18
    v_dot2c_f32_bf16 v105, v18, v18
    v_dot2c_f32_bf16 v104, s34, v19
    v_dot2c_f32_bf16 v105, v19, v19
    s_waitcnt lgkmcnt(4)
    v_dot2c_f32_bf16 v104, s34, v20
    v_dot2c_f32_bf16 v105, v20, v20
    v_dot2c_f32_bf16 v104, s34, v21
    v_dot2c_f32_bf16 v105, v21, v21
    v_dot2c_f32_bf16 v104, s34, v22
    v_dot2c_f32_bf16 v105, v22, v22
    v_dot2c_f32_bf16 v104, s34, v23
    v_dot2c_f32_bf16 v105, v23, v23
    s_waitcnt vmcnt(5)
    ds_read_b128 v[40:43], v2 offset:6144
    ds_read_b128 v[44:47], v2 offset:7168
    s_waitcnt lgkmcnt(5)
    v_dot2c_f32_bf16 v104, s34, v24
    v_dot2c_f32_bf16 v105, v24, v24
    v_dot2c_f32_bf16 v104, s34, v25
    v_dot2c_f32_bf16 v105, v25, v25
    v_dot2c_f32_bf16 v104, s34, v26
    v_dot2c_f32_bf16 v105, v26, v26
    v_dot2c_f32_bf16 v104, s34, v27
    v_dot2c_f32_bf16 v105, v27, v27
    s_waitcnt lgkmcnt(4)
    v_dot2c_f32_bf16 v104, s34, v28
    v_dot2c_f32_bf16 v105, v28, v28
    v_dot2c_f32_bf16 v104, s34, v29
    v_dot2c_f32_bf16 v105, v29, v29
    v_dot2c_f32_bf16 v104, s34, v30
    v_dot2c_f32_bf16 v105, v30, v30
    v_dot2c_f32_bf16 v104, s34, v31
    v_dot2c_f32_bf16 v105, v31, v31
    s_waitcnt vmcnt(3)
    ds_read_b128 v[48:51], v2 offset:8192
    ds_read_b128 v[52:55], v2 offset:9216
    s_waitcnt lgkmcnt(5)
    v_dot2c_f32_bf16 v104, s34, v32
    v_dot2c_f32_bf16 v105, v32, v32
    v_dot2c_f32_bf16 v104, s34, v33
    v_dot2c_f32_bf16 v105, v33, v33
    v_dot2c_f32_bf16 v104, s34, v34
    v_dot2c_f32_bf16 v105, v34, v34
    v_dot2c_f32_bf16 v104, s34, v35
    v_dot2c_f32_bf16 v105, v35, v35
    s_waitcnt lgkmcnt(4)
    v_dot2c_f32_bf16 v104, s34, v36
    v_dot2c_f32_bf16 v105, v36, v36
    v_dot2c_f32_bf16 v104, s34, v37
    v_dot2c_f32_bf16 v105, v37, v37
    v_dot2c_f32_bf16 v104, s34, v38
    v_dot2c_f32_bf16 v105, v38, v38
    v_dot2c_f32_bf16 v104, s34, v39
    v_dot2c_f32_bf16 v105, v39, v39
    s_waitcnt lgkmcnt(3)
    v_dot2c_f32_bf16 v104, s34, v40
    v_dot2c_f32_bf16 v105, v40, v40
    v_dot2c_f32_bf16 v104, s34, v41
    v_dot2c_f32_bf16 v105, v41, v41
    v_dot2c_f32_bf16 v104, s34, v42
    v_dot2c_f32_bf16 v105, v42, v42
    v_dot2c_f32_bf16 v104, s34, v43
    v_dot2c_f32_bf16 v105, v43, v43
    s_waitcnt lgkmcnt(2)
    v_dot2c_f32_bf16 v104, s34, v44
    v_dot2c_f32_bf16 v105, v44, v44
    v_dot2c_f32_bf16 v104, s34, v45
    v_dot2c_f32_bf16 v105, v45, v45
    v_dot2c_f32_bf16 v104, s34, v46
    v_dot2c_f32_bf16 v105, v46, v46
    v_dot2c_f32_bf16 v104, s34, v47
    v_dot2c_f32_bf16 v105, v47, v47
    s_waitcnt lgkmcnt(1)
    v_dot2c_f32_bf16 v104, s34, v48
    v_dot2c_f32_bf16 v105, v48, v48
    v_dot2c_f32_bf16 v104, s34, v49
    v_dot2c_f32_bf16 v105, v49, v49
    v_dot2c_f32_bf16 v104, s34, v50
    v_dot2c_f32_bf16 v105, v50, v50
    v_dot2c_f32_bf16 v104, s34, v51
    v_dot2c_f32_bf16 v105, v51, v51
    s_waitcnt lgkmcnt(0)
    v_dot2c_f32_bf16 v104, s34, v52
    v_dot2c_f32_bf16 v105, v52, v52
    v_dot2c_f32_bf16 v104, s34, v53
    v_dot2c_f32_bf16 v105, v53, v53
    v_dot2c_f32_bf16 v104, s34, v54
    v_dot2c_f32_bf16 v105, v54, v54
    v_dot2c_f32_bf16 v104, s34, v55
    v_dot2c_f32_bf16 v105, v55, v55
    s_nop 2
    v_mov_b64 v[106:107], v[104:105]
    s_nop 1
    v_permlane32_swap_b32 v104, v106
    v_permlane32_swap_b32 v105, v107
    v_pk_add_f32 v[104:105], v[104:105], v[106:107]
    ds_write_b64 v3, v[104:105] offset:0
    v_mov_b32 v172, s49
    s_cmp_lt_u32 s44, s47
    s_addc_u32 s45, s44, 1
    s_mul_i32 s54, s45, 40960
    s_add_u32 s56, s54, s52
    s_add_u32 s54, s54, s50
    s_cmp_lt_u32 s45, s46
    s_cselect_b32 s54, s54, 0x40000000
    s_cbranch_scc0 G1w_302
    s_sub_u32 s35, s44, 1
    s_cmp_gt_u32 s35, 1
    s_cbranch_scc1 G1w_302
    s_add_u32 s35, s57, 1
    v_min_u32 v180, 59, v1
    v_lshlrev_b32 v180, 7, v180
    s_mov_b32 s32, 1122304
    s_mov_b32 s48, 0
P_303:
    buffer_load_dword v176, v180, s[4:7], s32 offen sc1
    s_waitcnt vmcnt(0)
    v_cmp_gt_u32 vcc, s35, v176
    s_cbranch_vccz P_304
    s_add_u32 s48, s48, 1
    s_cmp_gt_u32 s48, 200000
    s_cbranch_scc1 L_end
    s_sleep 1
    s_branch P_303
P_304:
G1w_302:
    s_cmp_lt_u32 s44, 5
    s_cbranch_scc0 G1e_305
    s_waitcnt vmcnt(0) lgkmcnt(0)
    s_barrier
    s_mov_b64 exec, 1
    buffer_store_dword v172, off, s[4:7], s53 sc1
    s_mov_b64 exec, -1
    s_branch G1e_306
G1e_305:
    s_waitcnt lgkmcnt(0)
    s_barrier
G1e_306:
    ds_read_b128 v[56:59], v0 offset:0
    ds_read_b128 v[60:63], v0 offset:1024
    ds_read_b128 v[64:67], v0 offset:2048
    ds_read_b128 v[68:71], v0 offset:3072
    ds_read_b128 v[106:109], v4 offset:0
    ds_read_b128 v[110:113], v4 offset:16
    s_waitcnt lgkmcnt(5)
    v_mfma_f32_32x32x16_bf16 v[88:103], v[56:59], a[0:3], 0
    ds_read_b128 v[72:75], v0 offset:4096
    s_waitcnt lgkmcnt(5)
    v_mfma_f32_32x32x16_bf16 v[88:103], v[60:63], a[4:7], v[88:103]
    ds_read_b128 v[76:79], v0 offset:5120
    s_add_u32 m0, s52, 40960
    s_add_u32 s35, s54, 0
    buffer_load_dwordx4 v0, s[4:7], s35 offen offset:0 sc1 lds
    s_waitcnt lgkmcnt(5)
    v_mfma_f32_32x32x16_bf16 v[88:103], v[64:67], a[8:11], v[88:103]
    ds_read_b128 v[80:83], v0 offset:6144
    s_waitcnt lgkmcnt(5)
    v_mfma_f32_32x32x16_bf16 v[88:103], v[68:71], a[12:15], v[88:103]
    ds_read_b128 v[84:87], v0 offset:7168
    buffer_load_dwordx4 v0, s[4:7], s35 offen offset:1024 sc1 lds
    s_waitcnt lgkmcnt(3)
    v_mfma_f32_32x32x16_bf16 v[88:103], v[72:75], a[16:19], v[88:103]
    ds_read_b128 v[56:59], v0 offset:8192
    s_waitcnt lgkmcnt(3)
    v_mfma_f32_32x32x16_bf16 v[88:103], v[76:79], a[20:23], v[88:103]
    ds_read_b128 v[60:63], v0 offset:9216
    buffer_load_dwordx4 v0, s[4:7], s35 offen offset:2048 sc1 lds
    s_waitcnt lgkmcnt(3)
    v_mfma_f32_32x32x16_bf16 v[88:103], v[80:83], a[24:27], v[88:103]
    ds_read_b128 v[64:67], v0 offset:10240
    s_waitcnt lgkmcnt(3)
    v_mfma_f32_32x32x16_bf16 v[88:103], v[84:87], a[28:31], v[88:103]
    ds_read_b128 v[68:71], v0 offset:11264
    buffer_load_dwordx4 v0, s[4:7], s35 offen offset:3072 sc1 lds
    s_waitcnt lgkmcnt(3)
    v_mfma_f32_32x32x16_bf16 v[88:103], v[56:59], a[32:35], v[88:103]
    ds_read_b128 v[72:75], v0 offset:12288
    s_waitcnt lgkmcnt(3)
    v_mfma_f32_32x32x16_bf16 v[88:103], v[60:63], a[36:39], v[88:103]
    ds_read_b128 v[76:79], v0 offset:13312
    s_add_u32 m0, s52, 45056
    s_add_u32 s35, s54, 4096
    buffer_load_dwordx4 v0, s[4:7], s35 offen offset:0 sc1 lds
    s_waitcnt lgkmcnt(3)
    v_mfma_f32_32x32x16_bf16 v[88:103], v[64:67], a[40:43], v[88:103]
    ds_read_b128 v[80:83], v0 offset:14336
    s_waitcnt lgkmcnt(3)
    v_mfma_f32_32x32x16_bf16 v[88:103], v[68:71], a[44:47], v[88:103]
    ds_read_b128 v[84:87], v0 offset:15360
    buffer_load_dwordx4 v0, s[4:7], s35 offen offset:1024 sc1 lds
    s_waitcnt lgkmcnt(3)
    v_mfma_f32_32x32x16_bf16 v[88:103], v[72:75], a[48:51], v[88:103]
    ds_read_b128 v[56:59], v0 offset:16384
    s_waitcnt lgkmcnt(3)
    v_mfma_f32_32x32x16_bf16 v[88:103], v[76:79], a[52:55], v[88:103]
    ds_read_b128 v[60:63], v0 offset:17408
    buffer_load_dwordx4 v0, s[4:7], s35 offen offset:2048 sc1 lds
    s_waitcnt lgkmcnt(3)
    v_mfma_f32_32x32x16_bf16 v[88:103], v[80:83], a[56:59], v[88:103]
    ds_read_b128 v[64:67], v0 offset:18432
    s_waitcnt lgkmcnt(3)
    v_mfma_f32_32x32x16_bf16 v[88:103], v[84:87], a[60:63], v[88:103]
    ds_read_b128 v[68:71], v0 offset:19456
    buffer_load_dwordx4 v0, s[4:7], s35 offen offset:3072 sc1 lds
    s_waitcnt lgkmcnt(3)
    v_mfma_f32_32x32x16_bf16 v[88:103], v[56:59], a[64:67], v[88:103]
    ds_read_b128 v[72:75], v0 offset:20480
    s_waitcnt lgkmcnt(3)
    v_mfma_f32_32x32x16_bf16 v[88:103], v[60:63], a[68:71], v[88:103]
    ds_read_b128 v[76:79], v0 offset:21504
    s_add_u32 m0, s52, 49152
    s_add_u32 s35, s54, 8192
    buffer_load_dwordx4 v0, s[4:7], s35 offen offset:0 sc1 lds
    s_waitcnt lgkmcnt(3)
    v_mfma_f32_32x32x16_bf16 v[88:103], v[64:67], a[72:75], v[88:103]
    ds_read_b128 v[80:83], v0 offset:22528
    s_waitcnt lgkmcnt(3)
    v_mfma_f32_32x32x16_bf16 v[88:103], v[68:71], a[76:79], v[88:103]
    ds_read_b128 v[84:87], v0 offset:23552
    buffer_load_dwordx4 v0, s[4:7], s35 offen offset:1024 sc1 lds
    s_waitcnt lgkmcnt(3)
    v_mfma_f32_32x32x16_bf16 v[88:103], v[72:75], a[80:83], v[88:103]
    ds_read_b128 v[56:59], v0 offset:24576
    v_add_f32 v106, v106, v108
    v_add_f32 v107, v107, v109
    s_waitcnt lgkmcnt(3)
    v_mfma_f32_32x32x16_bf16 v[88:103], v[76:79], a[84:87], v[88:103]
    ds_read_b128 v[60:63], v0 offset:25600
    v_add_f32 v106, v106, v110
    v_add_f32 v107, v107, v111
    s_waitcnt lgkmcnt(3)
    v_mfma_f32_32x32x16_bf16 v[88:103], v[80:83], a[88:91], v[88:103]
    ds_read_b128 v[64:67], v0 offset:26624
    v_add_f32 v106, v106, v112
    v_add_f32 v107, v107, v113
    s_waitcnt lgkmcnt(3)
    v_mfma_f32_32x32x16_bf16 v[88:103], v[84:87], a[92:95], v[88:103]
    ds_read_b128 v[68:71], v0 offset:27648
    v_mul_f32 v106, 0x3acccccd, v106
    v_mul_f32 v107, 0x3acccccd, v107
    s_waitcnt lgkmcnt(3)
    v_mfma_f32_32x32x16_bf16 v[88:103], v[56:59], a[96:99], v[88:103]
    ds_read_b128 v[72:75], v0 offset:28672
    v_fma_f32 v107, -v106, v106, v107
    v_max_f32 v107, 0, v107
    s_waitcnt lgkmcnt(3)
    v_mfma_f32_32x32x16_bf16 v[88:103], v[60:63], a[100:103], v[88:103]
    ds_read_b128 v[76:79], v0 offset:29696
    v_add_f32 v107, 0x3727c5ac, v107
    v_rsq_f32 v107, v107
    s_waitcnt lgkmcnt(3)
    v_mfma_f32_32x32x16_bf16 v[88:103], v[64:67], a[104:107], v[88:103]
    ds_read_b128 v[80:83], v0 offset:30720
    ds_write2_b32 v6, v106, v107 offset0:0 offset1:32
    ds_read_b128 v[132:135], v7 offset:0
    s_waitcnt lgkmcnt(5)
    v_mfma_f32_32x32x16_bf16 v[88:103], v[68:71], a[108:111], v[88:103]
    ds_read_b128 v[84:87], v0 offset:31744
    ds_read_b128 v[136:139], v7 offset:16
    ds_read_b128 v[140:143], v7 offset:64
    s_waitcnt lgkmcnt(7)
    v_mfma_f32_32x32x16_bf16 v[88:103], v[72:75], a[112:115], v[88:103]
    ds_read_b128 v[56:59], v0 offset:32768
    ds_read_b128 v[144:147], v7 offset:80
    ds_read_b128 v[148:151], v7 offset:128
    s_waitcnt lgkmcnt(9)
    v_mfma_f32_32x32x16_bf16 v[88:103], v[76:79], a[116:119], v[88:103]
    ds_read_b128 v[60:63], v0 offset:33792
    ds_read_b128 v[152:155], v7 offset:144
    ds_read_b128 v[156:159], v7 offset:192
    s_waitcnt lgkmcnt(11)
    v_mfma_f32_32x32x16_bf16 v[88:103], v[80:83], a[120:123], v[88:103]
    ds_read_b128 v[64:67], v0 offset:34816
    ds_read_b128 v[160:163], v7 offset:208
    s_waitcnt lgkmcnt(10)
    v_mfma_f32_32x32x16_bf16 v[88:103], v[84:87], a[124:127], v[88:103]
    ds_read_b128 v[68:71], v0 offset:35840
    s_waitcnt lgkmcnt(8)
    v_mfma_f32_32x32x16_bf16 v[88:103], v[56:59], a[128:131], v[88:103]
    ds_read_b128 v[72:75], v0 offset:36864
    s_waitcnt lgkmcnt(6)
    v_mfma_f32_32x32x16_bf16 v[88:103], v[60:63], a[132:135], v[88:103]
    ds_read_b128 v[76:79], v0 offset:37888
    s_waitcnt lgkmcnt(4)
    v_mfma_f32_32x32x16_bf16 v[88:103], v[64:67], a[136:139], v[88:103]
    ds_read_b128 v[80:83], v0 offset:38912
    s_waitcnt lgkmcnt(3)
    v_mfma_f32_32x32x16_bf16 v[88:103], v[68:71], a[140:143], v[88:103]
    ds_read_b128 v[84:87], v0 offset:39936
    s_waitcnt lgkmcnt(3)
    v_mfma_f32_32x32x16_bf16 v[88:103], v[72:75], a[144:147], v[88:103]
    s_waitcnt lgkmcnt(2)
    v_mfma_f32_32x32x16_bf16 v[88:103], v[76:79], a[148:151], v[88:103]
    s_waitcnt vmcnt(10)
    s_barrier
    s_waitcnt lgkmcnt(1)
    v_mfma_f32_32x32x16_bf16 v[88:103], v[80:83], a[152:155], v[88:103]
    s_waitcnt lgkmcnt(0)
    v_mfma_f32_32x32x16_bf16 v[88:103], v[84:87], a[156:159], v[88:103]
    s_mul_i32 s55, s44, s58
    s_add_u32 s55, s55, s51
    s_xor_b32 s35, s44, s74
    s_and_b32 s35, s35, 2
    s_lshl_b32 s35, s35, 12
    s_add_u32 s55, s55, s35
    s_add_u32 s35, s55, s59
    s_add_u32 s49, s45, s61
    s_mov_b32 s44, s45
    s_nop 2
    v_pk_fma_f32 v[88:89], v[132:133], v[116:117], v[88:89] op_sel_hi:[1,0,1] neg_lo:[1,0,0] neg_hi:[1,0,0]
    s_nop 0
    v_pk_mul_f32 v[88:89], v[88:89], v[148:149]
    v_pk_fma_f32 v[90:91], v[134:135], v[116:117], v[90:91] op_sel_hi:[1,0,1] neg_lo:[1,0,0] neg_hi:[1,0,0]
    s_nop 0
    v_pk_mul_f32 v[90:91], v[90:91], v[150:151]
    v_pk_fma_f32 v[92:93], v[136:137], v[116:117], v[92:93] op_sel_hi:[1,0,1] neg_lo:[1,0,0] neg_hi:[1,0,0]
    s_nop 0
    v_pk_mul_f32 v[92:93], v[92:93], v[152:153]
    v_pk_fma_f32 v[94:95], v[138:139], v[116:117], v[94:95] op_sel_hi:[1,0,1] neg_lo:[1,0,0] neg_hi:[1,0,0]
    s_nop 0
    v_pk_mul_f32 v[94:95], v[94:95], v[154:155]
    v_pk_fma_f32 v[96:97], v[140:141], v[116:117], v[96:97] op_sel_hi:[1,0,1] neg_lo:[1,0,0] neg_hi:[1,0,0]
    s_nop 0
    v_pk_mul_f32 v[96:97], v[96:97], v[156:157]
    v_pk_fma_f32 v[98:99], v[142:143], v[116:117], v[98:99] op_sel_hi:[1,0,1] neg_lo:[1,0,0] neg_hi:[1,0,0]
    s_nop 0
    v_pk_mul_f32 v[98:99], v[98:99], v[158:159]
    v_pk_fma_f32 v[100:101], v[144:145], v[116:117], v[100:101] op_sel_hi:[1,0,1] neg_lo:[1,0,0] neg_hi:[1,0,0]
    s_nop 0
    v_pk_mul_f32 v[100:101], v[100:101], v[160:161]
    v_pk_fma_f32 v[102:103], v[146:147], v[116:117], v[102:103] op_sel_hi:[1,0,1] neg_lo:[1,0,0] neg_hi:[1,0,0]
    s_nop 0
    v_pk_mul_f32 v[102:103], v[102:103], v[162:163]
    v_cvt_pk_bf16_f32 v164, v88, v89
    v_cvt_pk_bf16_f32 v165, v90, v91
    v_cvt_pk_bf16_f32 v166, v92, v93
    v_cvt_pk_bf16_f32 v167, v94, v95
    v_cvt_pk_bf16_f32 v168, v96, v97
    v_cvt_pk_bf16_f32 v169, v98, v99
    v_cvt_pk_bf16_f32 v170, v100, v101
    v_cvt_pk_bf16_f32 v171, v102, v103
    buffer_store_dwordx4 v[164:167], v5, s[4:7], s55 offen sc1
    buffer_store_dwordx4 v[168:171], v5, s[4:7], s35 offen sc1
    s_mov_b64 exec, 1
    buffer_store_dword v172, off, s[4:7], s53 sc1
    s_mov_b64 exec, -1
    s_cmp_lt_u32 s44, s46
    s_cbranch_scc0 G1_296
    v_mov_b64 v[104:105], 0
    s_mov_b32 s34, 0x3f803f80
    s_waitcnt vmcnt(11)
    ds_read_b128 v[16:19], v2 offset:40960
    ds_read_b128 v[20:23], v2 offset:41984
    s_waitcnt vmcnt(9)
    ds_read_b128 v[24:27], v2 offset:43008
    ds_read_b128 v[28:31], v2 offset:44032
    s_waitcnt vmcnt(7)
    ds_read_b128 v[32:35], v2 offset:45056
    ds_read_b128 v[36:39], v2 offset:46080
    s_waitcnt lgkmcnt(5)
    v_dot2c_f32_bf16 v104, s34, v16
    v_dot2c_f32_bf16 v105, v16, v16
    v_dot2c_f32_bf16 v104, s34, v17
    v_dot2c_f32_bf16 v105, v17, v17
    v_dot2c_f32_bf16 v104, s34, v18
    v_dot2c_f32_bf16 v105, v18, v18
    v_dot2c_f32_bf16 v104, s34, v19
    v_dot2c_f32_bf16 v105, v19, v19
    s_waitcnt lgkmcnt(4)
    v_dot2c_f32_bf16 v104, s34, v20
    v_dot2c_f32_bf16 v105, v20, v20
    v_dot2c_f32_bf16 v104, s34, v21
    v_dot2c_f32_bf16 v105, v21, v21
    v_dot2c_f32_bf16 v104, s34, v22
    v_dot2c_f32_bf16 v105, v22, v22
    v_dot2c_f32_bf16 v104, s34, v23
    v_dot2c_f32_bf16 v105, v23, v23
    s_waitcnt vmcnt(5)
    ds_read_b128 v[40:43], v2 offset:47104
    ds_read_b128 v[44:47], v2 offset:48128
    s_waitcnt lgkmcnt(5)
    v_dot2c_f32_bf16 v104, s34, v24
    v_dot2c_f32_bf16 v105, v24, v24
    v_dot2c_f32_bf16 v104, s34, v25
    v_dot2c_f32_bf16 v105, v25, v25
    v_dot2c_f32_bf16 v104, s34, v26
    v_dot2c_f32_bf16 v105, v26, v26
    v_dot2c_f32_bf16 v104, s34, v27
    v_dot2c_f32_bf16 v105, v27, v27
    s_waitcnt lgkmcnt(4)
    v_dot2c_f32_bf16 v104, s34, v28
    v_dot2c_f32_bf16 v105, v28, v28
    v_dot2c_f32_bf16 v104, s34, v29
    v_dot2c_f32_bf16 v105, v29, v29
    v_dot2c_f32_bf16 v104, s34, v30
    v_dot2c_f32_bf16 v105, v30, v30
    v_dot2c_f32_bf16 v104, s34, v31
    v_dot2c_f32_bf16 v105, v31, v31
    s_waitcnt vmcnt(3)
    ds_read_b128 v[48:51], v2 offset:49152
    ds_read_b128 v[52:55], v2 offset:50176
    s_waitcnt lgkmcnt(5)
    v_dot2c_f32_bf16 v104, s34, v32
    v_dot2c_f32_bf16 v105, v32, v32
    v_dot2c_f32_bf16 v104, s34, v33
    v_dot2c_f32_bf16 v105, v33, v33
    v_dot2c_f32_bf16 v104, s34, v34
    v_dot2c_f32_bf16 v105, v34, v34
    v_dot2c_f32_bf16 v104, s34, v35
    v_dot2c_f32_bf16 v105, v35, v35
    s_waitcnt lgkmcnt(4)
    v_dot2c_f32_bf16 v104, s34, v36
    v_dot2c_f32_bf16 v105, v36, v36
    v_dot2c_f32_bf16 v104, s34, v37
    v_dot2c_f32_bf16 v105, v37, v37
    v_dot2c_f32_bf16 v104, s34, v38
    v_dot2c_f32_bf16 v105, v38, v38
    v_dot2c_f32_bf16 v104, s34, v39
    v_dot2c_f32_bf16 v105, v39, v39
    s_waitcnt lgkmcnt(3)
    v_dot2c_f32_bf16 v104, s34, v40
    v_dot2c_f32_bf16 v105, v40, v40
    v_dot2c_f32_bf16 v104, s34, v41
    v_dot2c_f32_bf16 v105, v41, v41
    v_dot2c_f32_bf16 v104, s34, v42
    v_dot2c_f32_bf16 v105, v42, v42
    v_dot2c_f32_bf16 v104, s34, v43
    v_dot2c_f32_bf16 v105, v43, v43
    s_waitcnt lgkmcnt(2)
    v_dot2c_f32_bf16 v104, s34, v44
    v_dot2c_f32_bf16 v105, v44, v44
    v_dot2c_f32_bf16 v104, s34, v45
    v_dot2c_f32_bf16 v105, v45, v45
    v_dot2c_f32_bf16 v104, s34, v46
    v_dot2c_f32_bf16 v105, v46, v46
    v_dot2c_f32_bf16 v104, s34, v47
    v_dot2c_f32_bf16 v105, v47, v47
    s_waitcnt lgkmcnt(1)
    v_dot2c_f32_bf16 v104, s34, v48
    v_dot2c_f32_bf16 v105, v48, v48
    v_dot2c_f32_bf16 v104, s34, v49
    v_dot2c_f32_bf16 v105, v49, v49
    v_dot2c_f32_bf16 v104, s34, v50
    v_dot2c_f32_bf16 v105, v50, v50
    v_dot2c_f32_bf16 v104, s34, v51
    v_dot2c_f32_bf16 v105, v51, v51
    s_waitcnt lgkmcnt(0)
    v_dot2c_f32_bf16 v104, s34, v52
    v_dot2c_f32_bf16 v105, v52, v52
    v_dot2c_f32_bf16 v104, s34, v53
    v_dot2c_f32_bf16 v105, v53, v53
    v_dot2c_f32_bf16 v104, s34, v54
    v_dot2c_f32_bf16 v105, v54, v54
    v_dot2c_f32_bf16 v104, s34, v55
    v_dot2c_f32_bf16 v105, v55, v55
    s_nop 2
    v_mov_b64 v[106:107], v[104:105]
    s_nop 1
    v_permlane32_swap_b32 v104, v106
    v_permlane32_swap_b32 v105, v107
    v_pk_add_f32 v[104:105], v[104:105], v[106:107]
    ds_write_b64 v3, v[104:105] offset:1024
    v_mov_b32 v172, s49
    s_cmp_lt_u32 s44, s47
    s_addc_u32 s45, s44, 1
    s_mul_i32 s54, s45, 40960
    s_add_u32 s56, s54, s52
    s_add_u32 s54, s54, s50
    s_cmp_lt_u32 s45, s46
    s_cselect_b32 s54, s54, 0x40000000
    s_cbranch_scc0 G1w_307
    s_sub_u32 s35, s44, 1
    s_cmp_gt_u32 s35, 1
    s_cbranch_scc1 G1w_307
    s_add_u32 s35, s57, 1
    v_min_u32 v180, 59, v1
    v_lshlrev_b32 v180, 7, v180
    s_mov_b32 s32, 1122304
    s_mov_b32 s48, 0
P_308:
    buffer_load_dword v176, v180, s[4:7], s32 offen sc1
    s_waitcnt vmcnt(0)
    v_cmp_gt_u32 vcc, s35, v176
    s_cbranch_vccz P_309
    s_add_u32 s48, s48, 1
    s_cmp_gt_u32 s48, 200000
    s_cbranch_scc1 L_end
    s_sleep 1
    s_branch P_308
P_309:
G1w_307:
    s_cmp_lt_u32 s44, 5
    s_cbranch_scc0 G1e_310
    s_waitcnt vmcnt(0) lgkmcnt(0)
    s_barrier
    s_mov_b64 exec, 1
    buffer_store_dword v172, off, s[4:7], s53 sc1
    s_mov_b64 exec, -1
    s_branch G1e_311
G1e_310:
    s_waitcnt lgkmcnt(0)
    s_barrier
G1e_311:
    ds_read_b128 v[56:59], v0 offset:40960
    ds_read_b128 v[60:63], v0 offset:41984
    ds_read_b128 v[64:67], v0 offset:43008
    ds_read_b128 v[68:71], v0 offset:44032
    ds_read_b128 v[106:109], v4 offset:1024
    ds_read_b128 v[110:113], v4 offset:1040
    s_waitcnt lgkmcnt(5)
    v_mfma_f32_32x32x16_bf16 v[88:103], v[56:59], a[0:3], 0
    ds_read_b128 v[72:75], v0 offset:45056
    s_waitcnt lgkmcnt(5)
    v_mfma_f32_32x32x16_bf16 v[88:103], v[60:63], a[4:7], v[88:103]
    ds_read_b128 v[76:79], v0 offset:46080
    s_add_u32 m0, s52, 0
    s_add_u32 s35, s54, 0
    buffer_load_dwordx4 v0, s[4:7], s35 offen offset:0 sc1 lds
    s_waitcnt lgkmcnt(5)
    v_mfma_f32_32x32x16_bf16 v[88:103], v[64:67], a[8:11], v[88:103]
    ds_read_b128 v[80:83], v0 offset:47104
    s_waitcnt lgkmcnt(5)
    v_mfma_f32_32x32x16_bf16 v[88:103], v[68:71], a[12:15], v[88:103]
    ds_read_b128 v[84:87], v0 offset:48128
    buffer_load_dwordx4 v0, s[4:7], s35 offen offset:1024 sc1 lds
    s_waitcnt lgkmcnt(3)
    v_mfma_f32_32x32x16_bf16 v[88:103], v[72:75], a[16:19], v[88:103]
    ds_read_b128 v[56:59], v0 offset:49152
    s_waitcnt lgkmcnt(3)
    v_mfma_f32_32x32x16_bf16 v[88:103], v[76:79], a[20:23], v[88:103]
    ds_read_b128 v[60:63], v0 offset:50176
    buffer_load_dwordx4 v0, s[4:7], s35 offen offset:2048 sc1 lds
    s_waitcnt lgkmcnt(3)
    v_mfma_f32_32x32x16_bf16 v[88:103], v[80:83], a[24:27], v[88:103]
    ds_read_b128 v[64:67], v0 offset:51200
    s_waitcnt lgkmcnt(3)
    v_mfma_f32_32x32x16_bf16 v[88:103], v[84:87], a[28:31], v[88:103]
    ds_read_b128 v[68:71], v0 offset:52224
    buffer_load_dwordx4 v0, s[4:7], s35 offen offset:3072 sc1 lds
    s_waitcnt lgkmcnt(3)
    v_mfma_f32_32x32x16_bf16 v[88:103], v[56:59], a[32:35], v[88:103]
    ds_read_b128 v[72:75], v0 offset:53248
    s_waitcnt lgkmcnt(3)
    v_mfma_f32_32x32x16_bf16 v[88:103], v[60:63], a[36:39], v[88:103]
    ds_read_b128 v[76:79], v0 offset:54272
    s_add_u32 m0, s52, 4096
    s_add_u32 s35, s54, 4096
    buffer_load_dwordx4 v0, s[4:7], s35 offen offset:0 sc1 lds
    s_waitcnt lgkmcnt(3)
    v_mfma_f32_32x32x16_bf16 v[88:103], v[64:67], a[40:43], v[88:103]
    ds_read_b128 v[80:83], v0 offset:55296
    s_waitcnt lgkmcnt(3)
    v_mfma_f32_32x32x16_bf16 v[88:103], v[68:71], a[44:47], v[88:103]
    ds_read_b128 v[84:87], v0 offset:56320
    buffer_load_dwordx4 v0, s[4:7], s35 offen offset:1024 sc1 lds
    s_waitcnt lgkmcnt(3)
    v_mfma_f32_32x32x16_bf16 v[88:103], v[72:75], a[48:51], v[88:103]
    ds_read_b128 v[56:59], v0 offset:57344
    s_waitcnt lgkmcnt(3)
    v_mfma_f32_32x32x16_bf16 v[88:103], v[76:79], a[52:55], v[88:103]
    ds_read_b128 v[60:63], v0 offset:58368
    buffer_load_dwordx4 v0, s[4:7], s35 offen offset:2048 sc1 lds
    s_waitcnt lgkmcnt(3)
    v_mfma_f32_32x32x16_bf16 v[88:103], v[80:83], a[56:59], v[88:103]
    ds_read_b128 v[64:67], v0 offset:59392
    s_waitcnt lgkmcnt(3)
    v_mfma_f32_32x32x16_bf16 v[88:103], v[84:87], a[60:63], v[88:103]
    ds_read_b128 v[68:71], v0 offset:60416
    buffer_load_dwordx4 v0, s[4:7], s35 offen offset:3072 sc1 lds
    s_waitcnt lgkmcnt(3)
    v_mfma_f32_32x32x16_bf16 v[88:103], v[56:59], a[64:67], v[88:103]
    ds_read_b128 v[72:75], v0 offset:61440
    s_waitcnt lgkmcnt(3)
    v_mfma_f32_32x32x16_bf16 v[88:103], v[60:63], a[68:71], v[88:103]
    ds_read_b128 v[76:79], v0 offset:62464
    s_add_u32 m0, s52, 8192
    s_add_u32 s35, s54, 8192
    buffer_load_dwordx4 v0, s[4:7], s35 offen offset:0 sc1 lds
    s_waitcnt lgkmcnt(3)
    v_mfma_f32_32x32x16_bf16 v[88:103], v[64:67], a[72:75], v[88:103]
    ds_read_b128 v[80:83], v0 offset:63488
    s_waitcnt lgkmcnt(3)
    v_mfma_f32_32x32x16_bf16 v[88:103], v[68:71], a[76:79], v[88:103]
    ds_read_b128 v[84:87], v0 offset:64512
    buffer_load_dwordx4 v0, s[4:7], s35 offen offset:1024 sc1 lds
    s_waitcnt lgkmcnt(3)
    v_mfma_f32_32x32x16_bf16 v[88:103], v[72:75], a[80:83], v[88:103]
    ds_read_b128 v[56:59], v8 offset:0
    v_add_f32 v106, v106, v108
    v_add_f32 v107, v107, v109
    s_waitcnt lgkmcnt(3)
    v_mfma_f32_32x32x16_bf16 v[88:103], v[76:79], a[84:87], v[88:103]
    ds_read_b128 v[60:63], v8 offset:1024
    v_add_f32 v106, v106, v110
    v_add_f32 v107, v107, v111
    s_waitcnt lgkmcnt(3)
    v_mfma_f32_32x32x16_bf16 v[88:103], v[80:83], a[88:91], v[88:103]
    ds_read_b128 v[64:67], v8 offset:2048
    v_add_f32 v106, v106, v112
    v_add_f32 v107, v107, v113
    s_waitcnt lgkmcnt(3)
    v_mfma_f32_32x32x16_bf16 v[88:103], v[84:87], a[92:95], v[88:103]
    ds_read_b128 v[68:71], v8 offset:3072
    v_mul_f32 v106, 0x3acccccd, v106
    v_mul_f32 v107, 0x3acccccd, v107
    s_waitcnt lgkmcnt(3)
    v_mfma_f32_32x32x16_bf16 v[88:103], v[56:59], a[96:99], v[88:103]
    ds_read_b128 v[72:75], v8 offset:4096
    v_fma_f32 v107, -v106, v106, v107
    v_max_f32 v107, 0, v107
    s_waitcnt lgkmcnt(3)
    v_mfma_f32_32x32x16_bf16 v[88:103], v[60:63], a[100:103], v[88:103]
    ds_read_b128 v[76:79], v8 offset:5120
    v_add_f32 v107, 0x3727c5ac, v107
    v_rsq_f32 v107, v107
    s_waitcnt lgkmcnt(3)
    v_mfma_f32_32x32x16_bf16 v[88:103], v[64:67], a[104:107], v[88:103]
    ds_read_b128 v[80:83], v8 offset:6144
    ds_write2_b32 v6, v106, v107 offset0:0 offset1:32
    ds_read_b128 v[132:135], v7 offset:0
    s_waitcnt lgkmcnt(5)
    v_mfma_f32_32x32x16_bf16 v[88:103], v[68:71], a[108:111], v[88:103]
    ds_read_b128 v[84:87], v8 offset:7168
    ds_read_b128 v[136:139], v7 offset:16
    ds_read_b128 v[140:143], v7 offset:64
    s_waitcnt lgkmcnt(7)
    v_mfma_f32_32x32x16_bf16 v[88:103], v[72:75], a[112:115], v[88:103]
    ds_read_b128 v[56:59], v8 offset:8192
    ds_read_b128 v[144:147], v7 offset:80
    ds_read_b128 v[148:151], v7 offset:128
    s_waitcnt lgkmcnt(9)
    v_mfma_f32_32x32x16_bf16 v[88:103], v[76:79], a[116:119], v[88:103]
    ds_read_b128 v[60:63], v8 offset:9216
    ds_read_b128 v[152:155], v7 offset:144
    ds_read_b128 v[156:159], v7 offset:192
    s_waitcnt lgkmcnt(11)
    v_mfma_f32_32x32x16_bf16 v[88:103], v[80:83], a[120:123], v[88:103]
    ds_read_b128 v[64:67], v8 offset:10240
    ds_read_b128 v[160:163], v7 offset:208
    s_waitcnt lgkmcnt(10)
    v_mfma_f32_32x32x16_bf16 v[88:103], v[84:87], a[124:127], v[88:103]
    ds_read_b128 v[68:71], v8 offset:11264
    s_waitcnt lgkmcnt(8)
    v_mfma_f32_32x32x16_bf16 v[88:103], v[56:59], a[128:131], v[88:103]
    ds_read_b128 v[72:75], v8 offset:12288
    s_waitcnt lgkmcnt(6)
    v_mfma_f32_32x32x16_bf16 v[88:103], v[60:63], a[132:135], v[88:103]
    ds_read_b128 v[76:79], v8 offset:13312
    s_waitcnt lgkmcnt(4)
    v_mfma_f32_32x32x16_bf16 v[88:103], v[64:67], a[136:139], v[88:103]
    ds_read_b128 v[80:83], v8 offset:14336
    s_waitcnt lgkmcnt(3)
    v_mfma_f32_32x32x16_bf16 v[88:103], v[68:71], a[140:143], v[88:103]
    ds_read_b128 v[84:87], v8 offset:15360
    s_waitcnt lgkmcnt(3)
    v_mfma_f32_32x32x16_bf16 v[88:103], v[72:75], a[144:147], v[88:103]
    s_waitcnt lgkmcnt(2)
    v_mfma_f32_32x32x16_bf16 v[88:103], v[76:79], a[148:151], v[88:103]
    s_waitcnt vmcnt(10)
    s_barrier
    s_waitcnt lgkmcnt(1)
    v_mfma_f32_32x32x16_bf16 v[88:103], v[80:83], a[152:155], v[88:103]
    s_waitcnt lgkmcnt(0)
    v_mfma_f32_32x32x16_bf16 v[88:103], v[84:87], a[156:159], v[88:103]
    s_mul_i32 s55, s44, s58
    s_add_u32 s55, s55, s51
    s_xor_b32 s35, s44, s74
    s_and_b32 s35, s35, 2
    s_lshl_b32 s35, s35, 12
    s_add_u32 s55, s55, s35
    s_add_u32 s35, s55, s59
    s_add_u32 s49, s45, s61
    s_mov_b32 s44, s45
    s_nop 2
    v_pk_fma_f32 v[88:89], v[132:133], v[116:117], v[88:89] op_sel_hi:[1,0,1] neg_lo:[1,0,0] neg_hi:[1,0,0]
    s_nop 0
    v_pk_mul_f32 v[88:89], v[88:89], v[148:149]
    v_pk_fma_f32 v[90:91], v[134:135], v[116:117], v[90:91] op_sel_hi:[1,0,1] neg_lo:[1,0,0] neg_hi:[1,0,0]
    s_nop 0
    v_pk_mul_f32 v[90:91], v[90:91], v[150:151]
    v_pk_fma_f32 v[92:93], v[136:137], v[116:117], v[92:93] op_sel_hi:[1,0,1] neg_lo:[1,0,0] neg_hi:[1,0,0]
    s_nop 0
    v_pk_mul_f32 v[92:93], v[92:93], v[152:153]
    v_pk_fma_f32 v[94:95], v[138:139], v[116:117], v[94:95] op_sel_hi:[1,0,1] neg_lo:[1,0,0] neg_hi:[1,0,0]
    s_nop 0
    v_pk_mul_f32 v[94:95], v[94:95], v[154:155]
    v_pk_fma_f32 v[96:97], v[140:141], v[116:117], v[96:97] op_sel_hi:[1,0,1] neg_lo:[1,0,0] neg_hi:[1,0,0]
    s_nop 0
    v_pk_mul_f32 v[96:97], v[96:97], v[156:157]
    v_pk_fma_f32 v[98:99], v[142:143], v[116:117], v[98:99] op_sel_hi:[1,0,1] neg_lo:[1,0,0] neg_hi:[1,0,0]
    s_nop 0
    v_pk_mul_f32 v[98:99], v[98:99], v[158:159]
    v_pk_fma_f32 v[100:101], v[144:145], v[116:117], v[100:101] op_sel_hi:[1,0,1] neg_lo:[1,0,0] neg_hi:[1,0,0]
    s_nop 0
    v_pk_mul_f32 v[100:101], v[100:101], v[160:161]
    v_pk_fma_f32 v[102:103], v[146:147], v[116:117], v[102:103] op_sel_hi:[1,0,1] neg_lo:[1,0,0] neg_hi:[1,0,0]
    s_nop 0
    v_pk_mul_f32 v[102:103], v[102:103], v[162:163]
    v_cvt_pk_bf16_f32 v164, v88, v89
    v_cvt_pk_bf16_f32 v165, v90, v91
    v_cvt_pk_bf16_f32 v166, v92, v93
    v_cvt_pk_bf16_f32 v167, v94, v95
    v_cvt_pk_bf16_f32 v168, v96, v97
    v_cvt_pk_bf16_f32 v169, v98, v99
    v_cvt_pk_bf16_f32 v170, v100, v101
    v_cvt_pk_bf16_f32 v171, v102, v103
    buffer_store_dwordx4 v[164:167], v5, s[4:7], s55 offen sc1
    buffer_store_dwordx4 v[168:171], v5, s[4:7], s35 offen sc1
    s_mov_b64 exec, 1
    buffer_store_dword v172, off, s[4:7], s53 sc1
    s_mov_b64 exec, -1
    s_cmp_lt_u32 s44, s46
    s_cbranch_scc1 G1_301
    s_branch G1_296
G1_298:
    v_min_u32 v180, 29, v1
    v_lshlrev_b32 v180, 7, v180
    s_mov_b32 s32, 1069056
    s_mov_b32 s48, 0
P_312:
    buffer_load_dword v176, v180, s[4:7], s32 offen sc1
    s_waitcnt vmcnt(0)
    v_cmp_gt_u32 vcc, s57, v176
    s_cbranch_vccz P_313
    s_add_u32 s48, s48, 1
    s_cmp_gt_u32 s48, 200000
    s_cbranch_scc1 L_end
    s_sleep 1
    s_branch P_312
P_313:
    v_bfe_u32 v7, v1, 5, 1
    v_mul_u32_u24 v7, 32, v7
    v_add_u32 v7, 90112, v7
    s_mul_i32 s35, s30, 16384
    s_add_u32 s35, s35, 5242880
    s_lshl_b32 s34, s29, 12
    s_add_u32 s35, s35, s34
    s_add_u32 m0, s34, 90112
    s_nop 0
    buffer_load_dwordx4 v0, s[4:7], s35 offen offset:0 sc1 lds
    buffer_load_dwordx4 v0, s[4:7], s35 offen offset:1024 sc1 lds
    buffer_load_dwordx4 v0, s[4:7], s35 offen offset:2048 sc1 lds
    buffer_load_dwordx4 v0, s[4:7], s35 offen offset:3072 sc1 lds
    s_mul_i32 s54, s44, 40960
    s_add_u32 s56, s54, s52
    s_add_u32 s54, s54, s50
    s_waitcnt lgkmcnt(0)
    s_add_u32 m0, s52, 0
    s_add_u32 s35, s54, 0
    buffer_load_dwordx4 v0, s[4:7], s35 offen offset:0 sc1 lds
    buffer_load_dwordx4 v0, s[4:7], s35 offen offset:1024 sc1 lds
    buffer_load_dwordx4 v0, s[4:7], s35 offen offset:2048 sc1 lds
    buffer_load_dwordx4 v0, s[4:7], s35 offen offset:3072 sc1 lds
    s_add_u32 m0, s52, 4096
    s_add_u32 s35, s54, 4096
    buffer_load_dwordx4 v0, s[4:7], s35 offen offset:0 sc1 lds
    buffer_load_dwordx4 v0, s[4:7], s35 offen offset:1024 sc1 lds
    buffer_load_dwordx4 v0, s[4:7], s35 offen offset:2048 sc1 lds
    buffer_load_dwordx4 v0, s[4:7], s35 offen offset:3072 sc1 lds
    s_add_u32 m0, s52, 8192
    s_add_u32 s35, s54, 8192
    buffer_load_dwordx4 v0, s[4:7], s35 offen offset:0 sc1 lds
    buffer_load_dwordx4 v0, s[4:7], s35 offen offset:1024 sc1 lds
    buffer_load_dword v185, off, s[8:11], 0
    buffer_load_dword v185, off, s[8:11], 0
    buffer_load_dword v185, off, s[8:11], 0
G1_314:
    v_mov_b32 v172, s49
    s_cmp_lt_u32 s44, s47
    s_addc_u32 s45, s44, 1
    s_mul_i32 s54, s45, 40960
    s_add_u32 s56, s54, s52
    s_add_u32 s54, s54, s50
    s_cmp_lt_u32 s45, s46
    s_cselect_b32 s54, s54, 0x40000000
    s_lshl_b32 s34, s44, 8
    v_add_u32 v104, s34, v7
    s_waitcnt vmcnt(3)
    s_barrier
    ds_read_b128 v[56:59], v0 offset:0
    ds_read_b128 v[60:63], v0 offset:1024
    ds_read_b128 v[64:67], v0 offset:2048
    ds_read_b128 v[68:71], v0 offset:3072
    s_waitcnt lgkmcnt(3)
    v_mfma_f32_32x32x16_bf16 v[88:103], v[56:59], a[0:3], 0
    ds_read_b128 v[72:75], v0 offset:4096
    s_waitcnt lgkmcnt(3)
    v_mfma_f32_32x32x16_bf16 v[88:103], v[60:63], a[4:7], v[88:103]
    ds_read_b128 v[76:79], v0 offset:5120
    s_add_u32 m0, s52, 40960
    s_add_u32 s35, s54, 0
    buffer_load_dwordx4 v0, s[4:7], s35 offen offset:0 sc1 lds
    s_waitcnt lgkmcnt(3)
    v_mfma_f32_32x32x16_bf16 v[88:103], v[64:67], a[8:11], v[88:103]
    ds_read_b128 v[80:83], v0 offset:6144
    s_waitcnt lgkmcnt(3)
    v_mfma_f32_32x32x16_bf16 v[88:103], v[68:71], a[12:15], v[88:103]
    ds_read_b128 v[84:87], v0 offset:7168
    buffer_load_dwordx4 v0, s[4:7], s35 offen offset:1024 sc1 lds
    s_waitcnt lgkmcnt(3)
    v_mfma_f32_32x32x16_bf16 v[88:103], v[72:75], a[16:19], v[88:103]
    ds_read_b128 v[56:59], v0 offset:8192
    s_waitcnt lgkmcnt(3)
    v_mfma_f32_32x32x16_bf16 v[88:103], v[76:79], a[20:23], v[88:103]
    ds_read_b128 v[60:63], v0 offset:9216
    buffer_load_dwordx4 v0, s[4:7], s35 offen offset:2048 sc1 lds
    s_waitcnt lgkmcnt(3)
    v_mfma_f32_32x32x16_bf16 v[88:103], v[80:83], a[24:27], v[88:103]
    ds_read_b128 v[64:67], v0 offset:10240
    s_waitcnt lgkmcnt(3)
    v_mfma_f32_32x32x16_bf16 v[88:103], v[84:87], a[28:31], v[88:103]
    ds_read_b128 v[68:71], v0 offset:11264
    buffer_load_dwordx4 v0, s[4:7], s35 offen offset:3072 sc1 lds
    s_waitcnt lgkmcnt(3)
    v_mfma_f32_32x32x16_bf16 v[88:103], v[56:59], a[32:35], v[88:103]
    ds_read_b128 v[72:75], v0 offset:12288
    s_waitcnt lgkmcnt(3)
    v_mfma_f32_32x32x16_bf16 v[88:103], v[60:63], a[36:39], v[88:103]
    ds_read_b128 v[76:79], v0 offset:13312
    s_add_u32 m0, s52, 45056
    s_add_u32 s35, s54, 4096
    buffer_load_dwordx4 v0, s[4:7], s35 offen offset:0 sc1 lds
    s_waitcnt lgkmcnt(3)
    v_mfma_f32_32x32x16_bf16 v[88:103], v[64:67], a[40:43], v[88:103]
    ds_read_b128 v[80:83], v0 offset:14336
    s_waitcnt lgkmcnt(3)
    v_mfma_f32_32x32x16_bf16 v[88:103], v[68:71], a[44:47], v[88:103]
    ds_read_b128 v[84:87], v0 offset:15360
    buffer_load_dwordx4 v0, s[4:7], s35 offen offset:1024 sc1 lds
    s_waitcnt lgkmcnt(3)
    v_mfma_f32_32x32x16_bf16 v[88:103], v[72:75], a[48:51], v[88:103]
    ds_read_b128 v[56:59], v0 offset:16384
    s_waitcnt lgkmcnt(3)
    v_mfma_f32_32x32x16_bf16 v[88:103], v[76:79], a[52:55], v[88:103]
    ds_read_b128 v[60:63], v0 offset:17408
    buffer_load_dwordx4 v0, s[4:7], s35 offen offset:2048 sc1 lds
    s_waitcnt lgkmcnt(3)
    v_mfma_f32_32x32x16_bf16 v[88:103], v[80:83], a[56:59], v[88:103]
    ds_read_b128 v[64:67], v0 offset:18432
    s_waitcnt lgkmcnt(3)
    v_mfma_f32_32x32x16_bf16 v[88:103], v[84:87], a[60:63], v[88:103]
    ds_read_b128 v[68:71], v0 offset:19456
    buffer_load_dwordx4 v0, s[4:7], s35 offen offset:3072 sc1 lds
    s_waitcnt lgkmcnt(3)
    v_mfma_f32_32x32x16_bf16 v[88:103], v[56:59], a[64:67], v[88:103]
    ds_read_b128 v[72:75], v0 offset:20480
    s_waitcnt lgkmcnt(3)
    v_mfma_f32_32x32x16_bf16 v[88:103], v[60:63], a[68:71], v[88:103]
    ds_read_b128 v[76:79], v0 offset:21504
    s_add_u32 m0, s52, 49152
    s_add_u32 s35, s54, 8192
    buffer_load_dwordx4 v0, s[4:7], s35 offen offset:0 sc1 lds
    s_waitcnt lgkmcnt(3)
    v_mfma_f32_32x32x16_bf16 v[88:103], v[64:67], a[72:75], v[88:103]
    ds_read_b128 v[80:83], v0 offset:22528
    s_waitcnt lgkmcnt(3)
    v_mfma_f32_32x32x16_bf16 v[88:103], v[68:71], a[76:79], v[88:103]
    ds_read_b128 v[84:87], v0 offset:23552
    buffer_load_dwordx4 v0, s[4:7], s35 offen offset:1024 sc1 lds
    s_waitcnt lgkmcnt(3)
    v_mfma_f32_32x32x16_bf16 v[88:103], v[72:75], a[80:83], v[88:103]
    ds_read_b128 v[56:59], v0 offset:24576
    ds_read_b128 v[132:135], v104 offset:0
    ds_read_b128 v[136:139], v104 offset:16
    s_waitcnt lgkmcnt(5)
    v_mfma_f32_32x32x16_bf16 v[88:103], v[76:79], a[84:87], v[88:103]
    ds_read_b128 v[60:63], v0 offset:25600
    ds_read_b128 v[140:143], v104 offset:64
    ds_read_b128 v[144:147], v104 offset:80
    s_waitcnt lgkmcnt(7)
    v_mfma_f32_32x32x16_bf16 v[88:103], v[80:83], a[88:91], v[88:103]
    ds_read_b128 v[64:67], v0 offset:26624
    ds_read_b128 v[148:151], v104 offset:128
    ds_read_b128 v[152:155], v104 offset:144
    s_waitcnt lgkmcnt(9)
    v_mfma_f32_32x32x16_bf16 v[88:103], v[84:87], a[92:95], v[88:103]
    ds_read_b128 v[68:71], v0 offset:27648
    ds_read_b128 v[156:159], v104 offset:192
    ds_read_b128 v[160:163], v104 offset:208
    s_waitcnt lgkmcnt(11)
    v_mfma_f32_32x32x16_bf16 v[88:103], v[56:59], a[96:99], v[88:103]
    ds_read_b128 v[72:75], v0 offset:28672
    s_waitcnt lgkmcnt(9)
    v_mfma_f32_32x32x16_bf16 v[88:103], v[60:63], a[100:103], v[88:103]
    ds_read_b128 v[76:79], v0 offset:29696
    s_waitcnt lgkmcnt(7)
    v_mfma_f32_32x32x16_bf16 v[88:103], v[64:67], a[104:107], v[88:103]
    ds_read_b128 v[80:83], v0 offset:30720
    s_waitcnt lgkmcnt(5)
    v_mfma_f32_32x32x16_bf16 v[88:103], v[68:71], a[108:111], v[88:103]
    ds_read_b128 v[84:87], v0 offset:31744
    s_waitcnt lgkmcnt(3)
    v_mfma_f32_32x32x16_bf16 v[88:103], v[72:75], a[112:115], v[88:103]
    ds_read_b128 v[56:59], v0 offset:32768
    s_waitcnt lgkmcnt(3)
    v_mfma_f32_32x32x16_bf16 v[88:103], v[76:79], a[116:119], v[88:103]
    ds_read_b128 v[60:63], v0 offset:33792
    s_waitcnt lgkmcnt(3)
    v_mfma_f32_32x32x16_bf16 v[88:103], v[80:83], a[120:123], v[88:103]
    ds_read_b128 v[64:67], v0 offset:34816
    s_waitcnt lgkmcnt(3)
    v_mfma_f32_32x32x16_bf16 v[88:103], v[84:87], a[124:127], v[88:103]
    ds_read_b128 v[68:71], v0 offset:35840
    s_waitcnt lgkmcnt(3)
    v_mfma_f32_32x32x16_bf16 v[88:103], v[56:59], a[128:131], v[88:103]
    ds_read_b128 v[72:75], v0 offset:36864
    s_waitcnt lgkmcnt(3)
    v_mfma_f32_32x32x16_bf16 v[88:103], v[60:63], a[132:135], v[88:103]
    ds_read_b128 v[76:79], v0 offset:37888
    s_waitcnt lgkmcnt(3)
    v_mfma_f32_32x32x16_bf16 v[88:103], v[64:67], a[136:139], v[88:103]
    ds_read_b128 v[80:83], v0 offset:38912
    s_waitcnt lgkmcnt(3)
    v_mfma_f32_32x32x16_bf16 v[88:103], v[68:71], a[140:143], v[88:103]
    ds_read_b128 v[84:87], v0 offset:39936
    s_waitcnt lgkmcnt(3)
    v_mfma_f32_32x32x16_bf16 v[88:103], v[72:75], a[144:147], v[88:103]
    s_waitcnt lgkmcnt(2)
    v_mfma_f32_32x32x16_bf16 v[88:103], v[76:79], a[148:151], v[88:103]
    s_waitcnt vmcnt(10)
    s_barrier
    s_waitcnt lgkmcnt(1)
    v_mfma_f32_32x32x16_bf16 v[88:103], v[80:83], a[152:155], v[88:103]
    s_waitcnt lgkmcnt(0)
    v_mfma_f32_32x32x16_bf16 v[88:103], v[84:87], a[156:159], v[88:103]
    s_mul_i32 s55, s44, s58
    s_add_u32 s55, s55, s51
    s_xor_b32 s35, s44, s74
    s_and_b32 s35, s35, 2
    s_lshl_b32 s35, s35, 12
    s_add_u32 s55, s55, s35
    s_add_u32 s35, s55, s59
    s_add_u32 s49, s45, s61
    s_mov_b32 s44, s45
    s_nop 2
    v_pk_fma_f32 v[88:89], v[132:133], v[116:117], v[88:89] op_sel_hi:[1,0,1] neg_lo:[1,0,0] neg_hi:[1,0,0]
    s_nop 0
    v_pk_mul_f32 v[88:89], v[88:89], v[148:149]
    v_pk_fma_f32 v[90:91], v[134:135], v[116:117], v[90:91] op_sel_hi:[1,0,1] neg_lo:[1,0,0] neg_hi:[1,0,0]
    s_nop 0
    v_pk_mul_f32 v[90:91], v[90:91], v[150:151]
    v_pk_fma_f32 v[92:93], v[136:137], v[116:117], v[92:93] op_sel_hi:[1,0,1] neg_lo:[1,0,0] neg_hi:[1,0,0]
    s_nop 0
    v_pk_mul_f32 v[92:93], v[92:93], v[152:153]
    v_pk_fma_f32 v[94:95], v[138:139], v[116:117], v[94:95] op_sel_hi:[1,0,1] neg_lo:[1,0,0] neg_hi:[1,0,0]
    s_nop 0
    v_pk_mul_f32 v[94:95], v[94:95], v[154:155]
    v_pk_fma_f32 v[96:97], v[140:141], v[116:117], v[96:97] op_sel_hi:[1,0,1] neg_lo:[1,0,0] neg_hi:[1,0,0]
    s_nop 0
    v_pk_mul_f32 v[96:97], v[96:97], v[156:157]
    v_pk_fma_f32 v[98:99], v[142:143], v[116:117], v[98:99] op_sel_hi:[1,0,1] neg_lo:[1,0,0] neg_hi:[1,0,0]
    s_nop 0
    v_pk_mul_f32 v[98:99], v[98:99], v[158:159]
    v_pk_fma_f32 v[100:101], v[144:145], v[116:117], v[100:101] op_sel_hi:[1,0,1] neg_lo:[1,0,0] neg_hi:[1,0,0]
    s_nop 0
    v_pk_mul_f32 v[100:101], v[100:101], v[160:161]
    v_pk_fma_f32 v[102:103], v[146:147], v[116:117], v[102:103] op_sel_hi:[1,0,1] neg_lo:[1,0,0] neg_hi:[1,0,0]
    s_nop 0
    v_pk_mul_f32 v[102:103], v[102:103], v[162:163]
    v_cvt_pk_bf16_f32 v164, v88, v89
    v_cvt_pk_bf16_f32 v165, v90, v91
    v_cvt_pk_bf16_f32 v166, v92, v93
    v_cvt_pk_bf16_f32 v167, v94, v95
    v_cvt_pk_bf16_f32 v168, v96, v97
    v_cvt_pk_bf16_f32 v169, v98, v99
    v_cvt_pk_bf16_f32 v170, v100, v101
    v_cvt_pk_bf16_f32 v171, v102, v103
    buffer_store_dwordx4 v[164:167], v5, s[4:7], s55 offen sc1
    buffer_store_dwordx4 v[168:171], v5, s[4:7], s35 offen sc1
    s_mov_b64 exec, 1
    buffer_store_dword v172, off, s[4:7], s53 sc1
    s_mov_b64 exec, -1
    s_cmp_lt_u32 s44, s46
    s_cbranch_scc0 G1_296
    v_mov_b32 v172, s49
    s_cmp_lt_u32 s44, s47
    s_addc_u32 s45, s44, 1
    s_mul_i32 s54, s45, 40960
    s_add_u32 s56, s54, s52
    s_add_u32 s54, s54, s50
    s_cmp_lt_u32 s45, s46
    s_cselect_b32 s54, s54, 0x40000000
    s_lshl_b32 s34, s44, 8
    v_add_u32 v104, s34, v7
    s_waitcnt vmcnt(3)
    s_barrier
    ds_read_b128 v[56:59], v0 offset:40960
    ds_read_b128 v[60:63], v0 offset:41984
    ds_read_b128 v[64:67], v0 offset:43008
    ds_read_b128 v[68:71], v0 offset:44032
    s_waitcnt lgkmcnt(3)
    v_mfma_f32_32x32x16_bf16 v[88:103], v[56:59], a[0:3], 0
    ds_read_b128 v[72:75], v0 offset:45056
    s_waitcnt lgkmcnt(3)
    v_mfma_f32_32x32x16_bf16 v[88:103], v[60:63], a[4:7], v[88:103]
    ds_read_b128 v[76:79], v0 offset:46080
    s_add_u32 m0, s52, 0
    s_add_u32 s35, s54, 0
    buffer_load_dwordx4 v0, s[4:7], s35 offen offset:0 sc1 lds
    s_waitcnt lgkmcnt(3)
    v_mfma_f32_32x32x16_bf16 v[88:103], v[64:67], a[8:11], v[88:103]
    ds_read_b128 v[80:83], v0 offset:47104
    s_waitcnt lgkmcnt(3)
    v_mfma_f32_32x32x16_bf16 v[88:103], v[68:71], a[12:15], v[88:103]
    ds_read_b128 v[84:87], v0 offset:48128
    buffer_load_dwordx4 v0, s[4:7], s35 offen offset:1024 sc1 lds
    s_waitcnt lgkmcnt(3)
    v_mfma_f32_32x32x16_bf16 v[88:103], v[72:75], a[16:19], v[88:103]
    ds_read_b128 v[56:59], v0 offset:49152
    s_waitcnt lgkmcnt(3)
    v_mfma_f32_32x32x16_bf16 v[88:103], v[76:79], a[20:23], v[88:103]
    ds_read_b128 v[60:63], v0 offset:50176
    buffer_load_dwordx4 v0, s[4:7], s35 offen offset:2048 sc1 lds
    s_waitcnt lgkmcnt(3)
    v_mfma_f32_32x32x16_bf16 v[88:103], v[80:83], a[24:27], v[88:103]
    ds_read_b128 v[64:67], v0 offset:51200
    s_waitcnt lgkmcnt(3)
    v_mfma_f32_32x32x16_bf16 v[88:103], v[84:87], a[28:31], v[88:103]
    ds_read_b128 v[68:71], v0 offset:52224
    buffer_load_dwordx4 v0, s[4:7], s35 offen offset:3072 sc1 lds
    s_waitcnt lgkmcnt(3)
    v_mfma_f32_32x32x16_bf16 v[88:103], v[56:59], a[32:35], v[88:103]
    ds_read_b128 v[72:75], v0 offset:53248
    s_waitcnt lgkmcnt(3)
    v_mfma_f32_32x32x16_bf16 v[88:103], v[60:63], a[36:39], v[88:103]
    ds_read_b128 v[76:79], v0 offset:54272
    s_add_u32 m0, s52, 4096
    s_add_u32 s35, s54, 4096
    buffer_load_dwordx4 v0, s[4:7], s35 offen offset:0 sc1 lds
    s_waitcnt lgkmcnt(3)
    v_mfma_f32_32x32x16_bf16 v[88:103], v[64:67], a[40:43], v[88:103]
    ds_read_b128 v[80:83], v0 offset:55296
    s_waitcnt lgkmcnt(3)
    v_mfma_f32_32x32x16_bf16 v[88:103], v[68:71], a[44:47], v[88:103]
    ds_read_b128 v[84:87], v0 offset:56320
    buffer_load_dwordx4 v0, s[4:7], s35 offen offset:1024 sc1 lds
    s_waitcnt lgkmcnt(3)
    v_mfma_f32_32x32x16_bf16 v[88:103], v[72:75], a[48:51], v[88:103]
    ds_read_b128 v[56:59], v0 offset:57344
    s_waitcnt lgkmcnt(3)
    v_mfma_f32_32x32x16_bf16 v[88:103], v[76:79], a[52:55], v[88:103]
    ds_read_b128 v[60:63], v0 offset:58368
    buffer_load_dwordx4 v0, s[4:7], s35 offen offset:2048 sc1 lds
    s_waitcnt lgkmcnt(3)
    v_mfma_f32_32x32x16_bf16 v[88:103], v[80:83], a[56:59], v[88:103]
    ds_read_b128 v[64:67], v0 offset:59392
    s_waitcnt lgkmcnt(3)
    v_mfma_f32_32x32x16_bf16 v[88:103], v[84:87], a[60:63], v[88:103]
    ds_read_b128 v[68:71], v0 offset:60416
    buffer_load_dwordx4 v0, s[4:7], s35 offen offset:3072 sc1 lds
    s_waitcnt lgkmcnt(3)
    v_mfma_f32_32x32x16_bf16 v[88:103], v[56:59], a[64:67], v[88:103]
    ds_read_b128 v[72:75], v0 offset:61440
    s_waitcnt lgkmcnt(3)
    v_mfma_f32_32x32x16_bf16 v[88:103], v[60:63], a[68:71], v[88:103]
    ds_read_b128 v[76:79], v0 offset:62464
    s_add_u32 m0, s52, 8192
    s_add_u32 s35, s54, 8192
    buffer_load_dwordx4 v0, s[4:7], s35 offen offset:0 sc1 lds
    s_waitcnt lgkmcnt(3)
    v_mfma_f32_32x32x16_bf16 v[88:103], v[64:67], a[72:75], v[88:103]
    ds_read_b128 v[80:83], v0 offset:63488
    s_waitcnt lgkmcnt(3)
    v_mfma_f32_32x32x16_bf16 v[88:103], v[68:71], a[76:79], v[88:103]
    ds_read_b128 v[84:87], v0 offset:64512
    buffer_load_dwordx4 v0, s[4:7], s35 offen offset:1024 sc1 lds
    s_waitcnt lgkmcnt(3)
    v_mfma_f32_32x32x16_bf16 v[88:103], v[72:75], a[80:83], v[88:103]
    ds_read_b128 v[56:59], v8 offset:0
    ds_read_b128 v[132:135], v104 offset:0
    ds_read_b128 v[136:139], v104 offset:16
    s_waitcnt lgkmcnt(5)
    v_mfma_f32_32x32x16_bf16 v[88:103], v[76:79], a[84:87], v[88:103]
    ds_read_b128 v[60:63], v8 offset:1024
    ds_read_b128 v[140:143], v104 offset:64
    ds_read_b128 v[144:147], v104 offset:80
    s_waitcnt lgkmcnt(7)
    v_mfma_f32_32x32x16_bf16 v[88:103], v[80:83], a[88:91], v[88:103]
    ds_read_b128 v[64:67], v8 offset:2048
    ds_read_b128 v[148:151], v104 offset:128
    ds_read_b128 v[152:155], v104 offset:144
    s_waitcnt lgkmcnt(9)
    v_mfma_f32_32x32x16_bf16 v[88:103], v[84:87], a[92:95], v[88:103]
    ds_read_b128 v[68:71], v8 offset:3072
    ds_read_b128 v[156:159], v104 offset:192
    ds_read_b128 v[160:163], v104 offset:208
    s_waitcnt lgkmcnt(11)
    v_mfma_f32_32x32x16_bf16 v[88:103], v[56:59], a[96:99], v[88:103]
    ds_read_b128 v[72:75], v8 offset:4096
    s_waitcnt lgkmcnt(9)
    v_mfma_f32_32x32x16_bf16 v[88:103], v[60:63], a[100:103], v[88:103]
    ds_read_b128 v[76:79], v8 offset:5120
    s_waitcnt lgkmcnt(7)
    v_mfma_f32_32x32x16_bf16 v[88:103], v[64:67], a[104:107], v[88:103]
    ds_read_b128 v[80:83], v8 offset:6144
    s_waitcnt lgkmcnt(5)
    v_mfma_f32_32x32x16_bf16 v[88:103], v[68:71], a[108:111], v[88:103]
    ds_read_b128 v[84:87], v8 offset:7168
    s_waitcnt lgkmcnt(3)
    v_mfma_f32_32x32x16_bf16 v[88:103], v[72:75], a[112:115], v[88:103]
    ds_read_b128 v[56:59], v8 offset:8192
    s_waitcnt lgkmcnt(3)
    v_mfma_f32_32x32x16_bf16 v[88:103], v[76:79], a[116:119], v[88:103]
    ds_read_b128 v[60:63], v8 offset:9216
    s_waitcnt lgkmcnt(3)
    v_mfma_f32_32x32x16_bf16 v[88:103], v[80:83], a[120:123], v[88:103]
    ds_read_b128 v[64:67], v8 offset:10240
    s_waitcnt lgkmcnt(3)
    v_mfma_f32_32x32x16_bf16 v[88:103], v[84:87], a[124:127], v[88:103]
    ds_read_b128 v[68:71], v8 offset:11264
    s_waitcnt lgkmcnt(3)
    v_mfma_f32_32x32x16_bf16 v[88:103], v[56:59], a[128:131], v[88:103]
    ds_read_b128 v[72:75], v8 offset:12288
    s_waitcnt lgkmcnt(3)
    v_mfma_f32_32x32x16_bf16 v[88:103], v[60:63], a[132:135], v[88:103]
    ds_read_b128 v[76:79], v8 offset:13312
    s_waitcnt lgkmcnt(3)
    v_mfma_f32_32x32x16_bf16 v[88:103], v[64:67], a[136:139], v[88:103]
    ds_read_b128 v[80:83], v8 offset:14336
    s_waitcnt lgkmcnt(3)
    v_mfma_f32_32x32x16_bf16 v[88:103], v[68:71], a[140:143], v[88:103]
    ds_read_b128 v[84:87], v8 offset:15360
    s_waitcnt lgkmcnt(3)
    v_mfma_f32_32x32x16_bf16 v[88:103], v[72:75], a[144:147], v[88:103]
    s_waitcnt lgkmcnt(2)
    v_mfma_f32_32x32x16_bf16 v[88:103], v[76:79], a[148:151], v[88:103]
    s_waitcnt vmcnt(10)
    s_barrier
    s_waitcnt lgkmcnt(1)
    v_mfma_f32_32x32x16_bf16 v[88:103], v[80:83], a[152:155], v[88:103]
    s_waitcnt lgkmcnt(0)
    v_mfma_f32_32x32x16_bf16 v[88:103], v[84:87], a[156:159], v[88:103]
    s_mul_i32 s55, s44, s58
    s_add_u32 s55, s55, s51
    s_xor_b32 s35, s44, s74
    s_and_b32 s35, s35, 2
    s_lshl_b32 s35, s35, 12
    s_add_u32 s55, s55, s35
    s_add_u32 s35, s55, s59
    s_add_u32 s49, s45, s61
    s_mov_b32 s44, s45
    s_nop 2
    v_pk_fma_f32 v[88:89], v[132:133], v[116:117], v[88:89] op_sel_hi:[1,0,1] neg_lo:[1,0,0] neg_hi:[1,0,0]
    s_nop 0
    v_pk_mul_f32 v[88:89], v[88:89], v[148:149]
    v_pk_fma_f32 v[90:91], v[134:135], v[116:117], v[90:91] op_sel_hi:[1,0,1] neg_lo:[1,0,0] neg_hi:[1,0,0]
    s_nop 0
    v_pk_mul_f32 v[90:91], v[90:91], v[150:151]
    v_pk_fma_f32 v[92:93], v[136:137], v[116:117], v[92:93] op_sel_hi:[1,0,1] neg_lo:[1,0,0] neg_hi:[1,0,0]
    s_nop 0
    v_pk_mul_f32 v[92:93], v[92:93], v[152:153]
    v_pk_fma_f32 v[94:95], v[138:139], v[116:117], v[94:95] op_sel_hi:[1,0,1] neg_lo:[1,0,0] neg_hi:[1,0,0]
    s_nop 0
    v_pk_mul_f32 v[94:95], v[94:95], v[154:155]
    v_pk_fma_f32 v[96:97], v[140:141], v[116:117], v[96:97] op_sel_hi:[1,0,1] neg_lo:[1,0,0] neg_hi:[1,0,0]
    s_nop 0
    v_pk_mul_f32 v[96:97], v[96:97], v[156:157]
    v_pk_fma_f32 v[98:99], v[142:143], v[116:117], v[98:99] op_sel_hi:[1,0,1] neg_lo:[1,0,0] neg_hi:[1,0,0]
    s_nop 0
    v_pk_mul_f32 v[98:99], v[98:99], v[158:159]
    v_pk_fma_f32 v[100:101], v[144:145], v[116:117], v[100:101] op_sel_hi:[1,0,1] neg_lo:[1,0,0] neg_hi:[1,0,0]
    s_nop 0
    v_pk_mul_f32 v[100:101], v[100:101], v[160:161]
    v_pk_fma_f32 v[102:103], v[146:147], v[116:117], v[102:103] op_sel_hi:[1,0,1] neg_lo:[1,0,0] neg_hi:[1,0,0]
    s_nop 0
    v_pk_mul_f32 v[102:103], v[102:103], v[162:163]
    v_cvt_pk_bf16_f32 v164, v88, v89
    v_cvt_pk_bf16_f32 v165, v90, v91
    v_cvt_pk_bf16_f32 v166, v92, v93
    v_cvt_pk_bf16_f32 v167, v94, v95
    v_cvt_pk_bf16_f32 v168, v96, v97
    v_cvt_pk_bf16_f32 v169, v98, v99
    v_cvt_pk_bf16_f32 v170, v100, v101
    v_cvt_pk_bf16_f32 v171, v102, v103
    buffer_store_dwordx4 v[164:167], v5, s[4:7], s55 offen sc1
    buffer_store_dwordx4 v[168:171], v5, s[4:7], s35 offen sc1
    s_mov_b64 exec, 1
    buffer_store_dword v172, off, s[4:7], s53 sc1
    s_mov_b64 exec, -1
    s_cmp_lt_u32 s44, s46
    s_cbranch_scc1 G1_314
    s_branch G1_296
G1_294:
    s_mul_i32 s51, s30, 67108864
    s_add_u32 s51, s51, 119537664
    s_lshl_b32 s34, s63, 15
    s_lshl_b32 s35, s29, 11
    s_add_u32 s51, s51, s34
    s_add_u32 s51, s51, s35
    s_and_b32 s34, s63, 1
    s_lshl_b32 s34, s34, 14
    s_xor_b32 s51, s51, s34
    s_mov_b32 s58, 1048576
    s_mov_b32 s59, 1024
    v_mov_b32 v5, v0
G1_295:
    v_bfe_u32 v184, v1, 5, 1
    v_mul_u32_u24 v184, 64, v184
    v_add_u32 v184, s37, v184
    s_cmp_gt_u32 s49, 1
    s_cbranch_scc1 G1_315
    s_mov_b32 s34, 0x3f803f80
    v_mov_b32 v16, s34
    v_mov_b32 v17, s34
    v_mov_b32 v18, s34
    v_mov_b32 v19, s34
    s_nop 1
    v_mfma_f32_32x32x16_bf16 v[88:103], a[0:3], v[16:19], 0
    v_mfma_f32_32x32x16_bf16 v[88:103], a[4:7], v[16:19], v[88:103]
    v_mfma_f32_32x32x16_bf16 v[88:103], a[8:11], v[16:19], v[88:103]
    v_mfma_f32_32x32x16_bf16 v[88:103], a[12:15], v[16:19], v[88:103]
    v_mfma_f32_32x32x16_bf16 v[88:103], a[16:19], v[16:19], v[88:103]
    v_mfma_f32_32x32x16_bf16 v[88:103], a[20:23], v[16:19], v[88:103]
    v_mfma_f32_32x32x16_bf16 v[88:103], a[24:27], v[16:19], v[88:103]
    v_mfma_f32_32x32x16_bf16 v[88:103], a[28:31], v[16:19], v[88:103]
    v_mfma_f32_32x32x16_bf16 v[88:103], a[32:35], v[16:19], v[88:103]
    v_mfma_f32_32x32x16_bf16 v[88:103], a[36:39], v[16:19], v[88:103]
    v_mfma_f32_32x32x16_bf16 v[88:103], a[40:43], v[16:19], v[88:103]
    v_mfma_f32_32x32x16_bf16 v[88:103], a[44:47], v[16:19], v[88:103]
    v_mfma_f32_32x32x16_bf16 v[88:103], a[48:51], v[16:19], v[88:103]
    v_mfma_f32_32x32x16_bf16 v[88:103], a[52:55], v[16:19], v[88:103]
    v_mfma_f32_32x32x16_bf16 v[88:103], a[56:59], v[16:19], v[88:103]
    v_mfma_f32_32x32x16_bf16 v[88:103], a[60:63], v[16:19], v[88:103]
    v_mfma_f32_32x32x16_bf16 v[88:103], a[64:67], v[16:19], v[88:103]
    v_mfma_f32_32x32x16_bf16 v[88:103], a[68:71], v[16:19], v[88:103]
    v_mfma_f32_32x32x16_bf16 v[88:103], a[72:75], v[16:19], v[88:103]
    v_mfma_f32_32x32x16_bf16 v[88:103], a[76:79], v[16:19], v[88:103]
    v_mfma_f32_32x32x16_bf16 v[88:103], a[80:83], v[16:19], v[88:103]
    v_mfma_f32_32x32x16_bf16 v[88:103], a[84:87], v[16:19], v[88:103]
    v_mfma_f32_32x32x16_bf16 v[88:103], a[88:91], v[16:19], v[88:103]
    v_mfma_f32_32x32x16_bf16 v[88:103], a[92:95], v[16:19], v[88:103]
    v_mfma_f32_32x32x16_bf16 v[88:103], a[96:99], v[16:19], v[88:103]
    v_mfma_f32_32x32x16_bf16 v[88:103], a[100:103], v[16:19], v[88:103]
    v_mfma_f32_32x32x16_bf16 v[88:103], a[104:107], v[16:19], v[88:103]
    v_mfma_f32_32x32x16_bf16 v[88:103], a[108:111], v[16:19], v[88:103]
    v_mfma_f32_32x32x16_bf16 v[88:103], a[112:115], v[16:19], v[88:103]
    v_mfma_f32_32x32x16_bf16 v[88:103], a[116:119], v[16:19], v[88:103]
    v_mfma_f32_32x32x16_bf16 v[88:103], a[120:123], v[16:19], v[88:103]
    v_mfma_f32_32x32x16_bf16 v[88:103], a[124:127], v[16:19], v[88:103]
    v_mfma_f32_32x32x16_bf16 v[88:103], a[128:131], v[16:19], v[88:103]
    v_mfma_f32_32x32x16_bf16 v[88:103], a[132:135], v[16:19], v[88:103]
    v_mfma_f32_32x32x16_bf16 v[88:103], a[136:139], v[16:19], v[88:103]
    v_mfma_f32_32x32x16_bf16 v[88:103], a[140:143], v[16:19], v[88:103]
    v_mfma_f32_32x32x16_bf16 v[88:103], a[144:147], v[16:19], v[88:103]
    v_mfma_f32_32x32x16_bf16 v[88:103], a[148:151], v[16:19], v[88:103]
    v_mfma_f32_32x32x16_bf16 v[88:103], a[152:155], v[16:19], v[88:103]
    v_mfma_f32_32x32x16_bf16 v[88:103], a[156:159], v[16:19], v[88:103]
    s_nop 11
    ds_write_b128 v184, v[88:91] offset:0
    ds_write_b128 v184, v[92:95] offset:16
    ds_write_b128 v184, v[96:99] offset:32
    ds_write_b128 v184, v[100:103] offset:48
G1_315:
    ds_read_b128 v[116:119], v184 offset:0
    ds_read_b128 v[120:123], v184 offset:16
    ds_read_b128 v[124:127], v184 offset:32
    ds_read_b128 v[128:131], v184 offset:48
    s_cmp_lg_u32 s68, 0
    s_cbranch_scc1 G1_316
    v_min_u32 v180, 29, v1
    v_lshlrev_b32 v180, 7, v180
    s_mov_b32 s32, 1142784
    s_mov_b32 s48, 0
P_317:
    buffer_load_dword v176, v180, s[4:7], s32 offen sc1
    s_waitcnt vmcnt(0)
    v_cmp_gt_u32 vcc, s57, v176
    s_cbranch_vccz P_318
    s_add_u32 s48, s48, 1
    s_cmp_gt_u32 s48, 200000
    s_cbranch_scc1 L_end
    s_sleep 1
    s_branch P_317
P_318:
    s_mul_i32 s54, s44, 40960
    s_add_u32 s56, s54, s52
    s_add_u32 s54, s54, s50
    s_waitcnt lgkmcnt(0)
    s_add_u32 m0, s52, 0
    s_add_u32 s35, s54, 0
    buffer_load_dwordx4 v0, s[4:7], s35 offen offset:0 sc1 lds
    buffer_load_dwordx4 v0, s[4:7], s35 offen offset:1024 sc1 lds
    buffer_load_dwordx4 v0, s[4:7], s35 offen offset:2048 sc1 lds
    buffer_load_dwordx4 v0, s[4:7], s35 offen offset:3072 sc1 lds
    s_add_u32 m0, s52, 4096
    s_add_u32 s35, s54, 4096
    buffer_load_dwordx4 v0, s[4:7], s35 offen offset:0 sc1 lds
    buffer_load_dwordx4 v0, s[4:7], s35 offen offset:1024 sc1 lds
    buffer_load_dwordx4 v0, s[4:7], s35 offen offset:2048 sc1 lds
    buffer_load_dwordx4 v0, s[4:7], s35 offen offset:3072 sc1 lds
    s_add_u32 m0, s52, 8192
    s_add_u32 s35, s54, 8192
    buffer_load_dwordx4 v0, s[4:7], s35 offen offset:0 sc1 lds
    buffer_load_dwordx4 v0, s[4:7], s35 offen offset:1024 sc1 lds
    buffer_load_dword v185, off, s[8:11], 0
    buffer_load_dword v185, off, s[8:11], 0
    buffer_load_dword v185, off, s[8:11], 0
G1_319:
    v_mov_b64 v[104:105], 0
    s_mov_b32 s34, 0x3f803f80
    s_waitcnt vmcnt(11)
    ds_read_b128 v[16:19], v2 offset:0
    ds_read_b128 v[20:23], v2 offset:1024
    s_waitcnt vmcnt(9)
    ds_read_b128 v[24:27], v2 offset:2048
    ds_read_b128 v[28:31], v2 offset:3072
    s_waitcnt vmcnt(7)
    ds_read_b128 v[32:35], v2 offset:4096
    ds_read_b128 v[36:39], v2 offset:5120
    s_waitcnt lgkmcnt(5)
    v_dot2c_f32_bf16 v104, s34, v16
    v_dot2c_f32_bf16 v105, v16, v16
    v_dot2c_f32_bf16 v104, s34, v17
    v_dot2c_f32_bf16 v105, v17, v17
    v_dot2c_f32_bf16 v104, s34, v18
    v_dot2c_f32_bf16 v105, v18, v18
    v_dot2c_f32_bf16 v104, s34, v19
    v_dot2c_f32_bf16 v105, v19, v19
    s_waitcnt lgkmcnt(4)
    v_dot2c_f32_bf16 v104, s34, v20
    v_dot2c_f32_bf16 v105, v20, v20
    v_dot2c_f32_bf16 v104, s34, v21
    v_dot2c_f32_bf16 v105, v21, v21
    v_dot2c_f32_bf16 v104, s34, v22
    v_dot2c_f32_bf16 v105, v22, v22
    v_dot2c_f32_bf16 v104, s34, v23
    v_dot2c_f32_bf16 v105, v23, v23
    s_waitcnt vmcnt(5)
    ds_read_b128 v[40:43], v2 offset:6144
    ds_read_b128 v[44:47], v2 offset:7168
    s_waitcnt lgkmcnt(5)
    v_dot2c_f32_bf16 v104, s34, v24
    v_dot2c_f32_bf16 v105, v24, v24
    v_dot2c_f32_bf16 v104, s34, v25
    v_dot2c_f32_bf16 v105, v25, v25
    v_dot2c_f32_bf16 v104, s34, v26
    v_dot2c_f32_bf16 v105, v26, v26
    v_dot2c_f32_bf16 v104, s34, v27
    v_dot2c_f32_bf16 v105, v27, v27
    s_waitcnt lgkmcnt(4)
    v_dot2c_f32_bf16 v104, s34, v28
    v_dot2c_f32_bf16 v105, v28, v28
    v_dot2c_f32_bf16 v104, s34, v29
    v_dot2c_f32_bf16 v105, v29, v29
    v_dot2c_f32_bf16 v104, s34, v30
    v_dot2c_f32_bf16 v105, v30, v30
    v_dot2c_f32_bf16 v104, s34, v31
    v_dot2c_f32_bf16 v105, v31, v31
    s_waitcnt vmcnt(3)
    ds_read_b128 v[48:51], v2 offset:8192
    ds_read_b128 v[52:55], v2 offset:9216
    s_waitcnt lgkmcnt(5)
    v_dot2c_f32_bf16 v104, s34, v32
    v_dot2c_f32_bf16 v105, v32, v32
    v_dot2c_f32_bf16 v104, s34, v33
    v_dot2c_f32_bf16 v105, v33, v33
    v_dot2c_f32_bf16 v104, s34, v34
    v_dot2c_f32_bf16 v105, v34, v34
    v_dot2c_f32_bf16 v104, s34, v35
    v_dot2c_f32_bf16 v105, v35, v35
    s_waitcnt lgkmcnt(4)
    v_dot2c_f32_bf16 v104, s34, v36
    v_dot2c_f32_bf16 v105, v36, v36
    v_dot2c_f32_bf16 v104, s34, v37
    v_dot2c_f32_bf16 v105, v37, v37
    v_dot2c_f32_bf16 v104, s34, v38
    v_dot2c_f32_bf16 v105, v38, v38
    v_dot2c_f32_bf16 v104, s34, v39
    v_dot2c_f32_bf16 v105, v39, v39
    s_waitcnt lgkmcnt(3)
    v_dot2c_f32_bf16 v104, s34, v40
    v_dot2c_f32_bf16 v105, v40, v40
    v_dot2c_f32_bf16 v104, s34, v41
    v_dot2c_f32_bf16 v105, v41, v41
    v_dot2c_f32_bf16 v104, s34, v42
    v_dot2c_f32_bf16 v105, v42, v42
    v_dot2c_f32_bf16 v104, s34, v43
    v_dot2c_f32_bf16 v105, v43, v43
    s_waitcnt lgkmcnt(2)
    v_dot2c_f32_bf16 v104, s34, v44
    v_dot2c_f32_bf16 v105, v44, v44
    v_dot2c_f32_bf16 v104, s34, v45
    v_dot2c_f32_bf16 v105, v45, v45
    v_dot2c_f32_bf16 v104, s34, v46
    v_dot2c_f32_bf16 v105, v46, v46
    v_dot2c_f32_bf16 v104, s34, v47
    v_dot2c_f32_bf16 v105, v47, v47
    s_waitcnt lgkmcnt(1)
    v_dot2c_f32_bf16 v104, s34, v48
    v_dot2c_f32_bf16 v105, v48, v48
    v_dot2c_f32_bf16 v104, s34, v49
    v_dot2c_f32_bf16 v105, v49, v49
    v_dot2c_f32_bf16 v104, s34, v50
    v_dot2c_f32_bf16 v105, v50, v50
    v_dot2c_f32_bf16 v104, s34, v51
    v_dot2c_f32_bf16 v105, v51, v51
    s_waitcnt lgkmcnt(0)
    v_dot2c_f32_bf16 v104, s34, v52
    v_dot2c_f32_bf16 v105, v52, v52
    v_dot2c_f32_bf16 v104, s34, v53
    v_dot2c_f32_bf16 v105, v53, v53
    v_dot2c_f32_bf16 v104, s34, v54
    v_dot2c_f32_bf16 v105, v54, v54
    v_dot2c_f32_bf16 v104, s34, v55
    v_dot2c_f32_bf16 v105, v55, v55
    s_nop 2
    v_mov_b64 v[106:107], v[104:105]
    s_nop 1
    v_permlane32_swap_b32 v104, v106
    v_permlane32_swap_b32 v105, v107
    v_pk_add_f32 v[104:105], v[104:105], v[106:107]
    ds_write_b64 v3, v[104:105] offset:0
    v_mov_b32 v172, s49
    s_cmp_lt_u32 s44, s47
    s_addc_u32 s45, s44, 1
    s_mul_i32 s54, s45, 40960
    s_add_u32 s56, s54, s52
    s_add_u32 s54, s54, s50
    s_cmp_lt_u32 s45, s46
    s_cselect_b32 s54, s54, 0x40000000
    s_cbranch_scc0 G1w_320
    s_sub_u32 s35, s44, 1
    s_cmp_gt_u32 s35, 1
    s_cbranch_scc1 G1w_320
    s_add_u32 s35, s57, 1
    v_min_u32 v180, 59, v1
    v_lshlrev_b32 v180, 7, v180
    s_mov_b32 s32, 1122304
    s_mov_b32 s48, 0
P_321:
    buffer_load_dword v176, v180, s[4:7], s32 offen sc1
    s_waitcnt vmcnt(0)
    v_cmp_gt_u32 vcc, s35, v176
    s_cbranch_vccz P_322
    s_add_u32 s48, s48, 1
    s_cmp_gt_u32 s48, 200000
    s_cbranch_scc1 L_end
    s_sleep 1
    s_branch P_321
P_322:
G1w_320:
    s_cmp_lt_u32 s44, 5
    s_cbranch_scc0 G1e_323
    s_waitcnt vmcnt(0) lgkmcnt(0)
    s_barrier
    s_mov_b64 exec, 1
    buffer_store_dword v172, off, s[4:7], s53 sc1
    s_mov_b64 exec, -1
    s_branch G1e_324
G1e_323:
    s_waitcnt lgkmcnt(0)
    s_barrier
G1e_324:
    ds_read_b128 v[56:59], v0 offset:0
    ds_read_b128 v[60:63], v0 offset:1024
    ds_read_b128 v[64:67], v0 offset:2048
    ds_read_b128 v[68:71], v0 offset:3072
    ds_read_b128 v[106:109], v4 offset:0
    ds_read_b128 v[110:113], v4 offset:16
    s_waitcnt lgkmcnt(5)
    v_mfma_f32_32x32x16_bf16 v[88:103], a[0:3], v[56:59], 0
    ds_read_b128 v[72:75], v0 offset:4096
    s_waitcnt lgkmcnt(5)
    v_mfma_f32_32x32x16_bf16 v[88:103], a[4:7], v[60:63], v[88:103]
    ds_read_b128 v[76:79], v0 offset:5120
    s_add_u32 m0, s52, 40960
    s_add_u32 s35, s54, 0
    buffer_load_dwordx4 v0, s[4:7], s35 offen offset:0 sc1 lds
    s_waitcnt lgkmcnt(5)
    v_mfma_f32_32x32x16_bf16 v[88:103], a[8:11], v[64:67], v[88:103]
    ds_read_b128 v[80:83], v0 offset:6144
    s_waitcnt lgkmcnt(5)
    v_mfma_f32_32x32x16_bf16 v[88:103], a[12:15], v[68:71], v[88:103]
    ds_read_b128 v[84:87], v0 offset:7168
    buffer_load_dwordx4 v0, s[4:7], s35 offen offset:1024 sc1 lds
    s_waitcnt lgkmcnt(3)
    v_mfma_f32_32x32x16_bf16 v[88:103], a[16:19], v[72:75], v[88:103]
    ds_read_b128 v[56:59], v0 offset:8192
    s_waitcnt lgkmcnt(3)
    v_mfma_f32_32x32x16_bf16 v[88:103], a[20:23], v[76:79], v[88:103]
    ds_read_b128 v[60:63], v0 offset:9216
    buffer_load_dwordx4 v0, s[4:7], s35 offen offset:2048 sc1 lds
    s_waitcnt lgkmcnt(3)
    v_mfma_f32_32x32x16_bf16 v[88:103], a[24:27], v[80:83], v[88:103]
    ds_read_b128 v[64:67], v0 offset:10240
    s_waitcnt lgkmcnt(3)
    v_mfma_f32_32x32x16_bf16 v[88:103], a[28:31], v[84:87], v[88:103]
    ds_read_b128 v[68:71], v0 offset:11264
    buffer_load_dwordx4 v0, s[4:7], s35 offen offset:3072 sc1 lds
    s_waitcnt lgkmcnt(3)
    v_mfma_f32_32x32x16_bf16 v[88:103], a[32:35], v[56:59], v[88:103]
    ds_read_b128 v[72:75], v0 offset:12288
    s_waitcnt lgkmcnt(3)
    v_mfma_f32_32x32x16_bf16 v[88:103], a[36:39], v[60:63], v[88:103]
    ds_read_b128 v[76:79], v0 offset:13312
    s_add_u32 m0, s52, 45056
    s_add_u32 s35, s54, 4096
    buffer_load_dwordx4 v0, s[4:7], s35 offen offset:0 sc1 lds
    s_waitcnt lgkmcnt(3)
    v_mfma_f32_32x32x16_bf16 v[88:103], a[40:43], v[64:67], v[88:103]
    ds_read_b128 v[80:83], v0 offset:14336
    s_waitcnt lgkmcnt(3)
    v_mfma_f32_32x32x16_bf16 v[88:103], a[44:47], v[68:71], v[88:103]
    ds_read_b128 v[84:87], v0 offset:15360
    buffer_load_dwordx4 v0, s[4:7], s35 offen offset:1024 sc1 lds
    s_waitcnt lgkmcnt(3)
    v_mfma_f32_32x32x16_bf16 v[88:103], a[48:51], v[72:75], v[88:103]
    ds_read_b128 v[56:59], v0 offset:16384
    s_waitcnt lgkmcnt(3)
    v_mfma_f32_32x32x16_bf16 v[88:103], a[52:55], v[76:79], v[88:103]
    ds_read_b128 v[60:63], v0 offset:17408
    buffer_load_dwordx4 v0, s[4:7], s35 offen offset:2048 sc1 lds
    s_waitcnt lgkmcnt(3)
    v_mfma_f32_32x32x16_bf16 v[88:103], a[56:59], v[80:83], v[88:103]
    ds_read_b128 v[64:67], v0 offset:18432
    s_waitcnt lgkmcnt(3)
    v_mfma_f32_32x32x16_bf16 v[88:103], a[60:63], v[84:87], v[88:103]
    ds_read_b128 v[68:71], v0 offset:19456
    buffer_load_dwordx4 v0, s[4:7], s35 offen offset:3072 sc1 lds
    s_waitcnt lgkmcnt(3)
    v_mfma_f32_32x32x16_bf16 v[88:103], a[64:67], v[56:59], v[88:103]
    ds_read_b128 v[72:75], v0 offset:20480
    s_waitcnt lgkmcnt(3)
    v_mfma_f32_32x32x16_bf16 v[88:103], a[68:71], v[60:63], v[88:103]
    ds_read_b128 v[76:79], v0 offset:21504
    s_add_u32 m0, s52, 49152
    s_add_u32 s35, s54, 8192
    buffer_load_dwordx4 v0, s[4:7], s35 offen offset:0 sc1 lds
    s_waitcnt lgkmcnt(3)
    v_mfma_f32_32x32x16_bf16 v[88:103], a[72:75], v[64:67], v[88:103]
    ds_read_b128 v[80:83], v0 offset:22528
    s_waitcnt lgkmcnt(3)
    v_mfma_f32_32x32x16_bf16 v[88:103], a[76:79], v[68:71], v[88:103]
    ds_read_b128 v[84:87], v0 offset:23552
    buffer_load_dwordx4 v0, s[4:7], s35 offen offset:1024 sc1 lds
    s_waitcnt lgkmcnt(3)
    v_mfma_f32_32x32x16_bf16 v[88:103], a[80:83], v[72:75], v[88:103]
    ds_read_b128 v[56:59], v0 offset:24576
    v_add_f32 v106, v106, v108
    v_add_f32 v107, v107, v109
    s_waitcnt lgkmcnt(3)
    v_mfma_f32_32x32x16_bf16 v[88:103], a[84:87], v[76:79], v[88:103]
    ds_read_b128 v[60:63], v0 offset:25600
    v_add_f32 v106, v106, v110
    v_add_f32 v107, v107, v111
    s_waitcnt lgkmcnt(3)
    v_mfma_f32_32x32x16_bf16 v[88:103], a[88:91], v[80:83], v[88:103]
    ds_read_b128 v[64:67], v0 offset:26624
    v_add_f32 v106, v106, v112
    v_add_f32 v107, v107, v113
    s_waitcnt lgkmcnt(3)
    v_mfma_f32_32x32x16_bf16 v[88:103], a[92:95], v[84:87], v[88:103]
    ds_read_b128 v[68:71], v0 offset:27648
    v_mul_f32 v106, 0x3acccccd, v106
    v_mul_f32 v107, 0x3acccccd, v107
    s_waitcnt lgkmcnt(3)
    v_mfma_f32_32x32x16_bf16 v[88:103], a[96:99], v[56:59], v[88:103]
    ds_read_b128 v[72:75], v0 offset:28672
    v_fma_f32 v107, -v106, v106, v107
    v_max_f32 v107, 0, v107
    s_waitcnt lgkmcnt(3)
    v_mfma_f32_32x32x16_bf16 v[88:103], a[100:103], v[60:63], v[88:103]
    ds_read_b128 v[76:79], v0 offset:29696
    v_add_f32 v107, 0x3727c5ac, v107
    v_rsq_f32 v107, v107
    s_waitcnt lgkmcnt(3)
    v_mfma_f32_32x32x16_bf16 v[88:103], a[104:107], v[64:67], v[88:103]
    ds_read_b128 v[80:83], v0 offset:30720
    s_waitcnt lgkmcnt(3)
    v_mfma_f32_32x32x16_bf16 v[88:103], a[108:111], v[68:71], v[88:103]
    ds_read_b128 v[84:87], v0 offset:31744
    s_waitcnt lgkmcnt(3)
    v_mfma_f32_32x32x16_bf16 v[88:103], a[112:115], v[72:75], v[88:103]
    ds_read_b128 v[56:59], v0 offset:32768
    s_waitcnt lgkmcnt(3)
    v_mfma_f32_32x32x16_bf16 v[88:103], a[116:119], v[76:79], v[88:103]
    ds_read_b128 v[60:63], v0 offset:33792
    s_waitcnt lgkmcnt(3)
    v_mfma_f32_32x32x16_bf16 v[88:103], a[120:123], v[80:83], v[88:103]
    ds_read_b128 v[64:67], v0 offset:34816
    s_waitcnt lgkmcnt(3)
    v_mfma_f32_32x32x16_bf16 v[88:103], a[124:127], v[84:87], v[88:103]
    ds_read_b128 v[68:71], v0 offset:35840
    s_waitcnt lgkmcnt(3)
    v_mfma_f32_32x32x16_bf16 v[88:103], a[128:131], v[56:59], v[88:103]
    ds_read_b128 v[72:75], v0 offset:36864
    s_waitcnt lgkmcnt(3)
    v_mfma_f32_32x32x16_bf16 v[88:103], a[132:135], v[60:63], v[88:103]
    ds_read_b128 v[76:79], v0 offset:37888
    s_waitcnt lgkmcnt(3)
    v_mfma_f32_32x32x16_bf16 v[88:103], a[136:139], v[64:67], v[88:103]
    ds_read_b128 v[80:83], v0 offset:38912
    s_waitcnt lgkmcnt(3)
    v_mfma_f32_32x32x16_bf16 v[88:103], a[140:143], v[68:71], v[88:103]
    ds_read_b128 v[84:87], v0 offset:39936
    s_waitcnt lgkmcnt(3)
    v_mfma_f32_32x32x16_bf16 v[88:103], a[144:147], v[72:75], v[88:103]
    s_waitcnt lgkmcnt(2)
    v_mfma_f32_32x32x16_bf16 v[88:103], a[148:151], v[76:79], v[88:103]
    s_waitcnt vmcnt(10)
    s_barrier
    s_waitcnt lgkmcnt(1)
    v_mfma_f32_32x32x16_bf16 v[88:103], a[152:155], v[80:83], v[88:103]
    s_waitcnt lgkmcnt(0)
    v_mfma_f32_32x32x16_bf16 v[88:103], a[156:159], v[84:87], v[88:103]
    s_mul_i32 s55, s44, s58
    s_add_u32 s55, s55, s51
    s_xor_b32 s35, s44, s74
    s_and_b32 s35, s35, 2
    s_lshl_b32 s35, s35, 12
    s_add_u32 s55, s55, s35
    s_add_u32 s35, s55, s59
    s_add_u32 s49, s45, s61
    s_mov_b32 s44, s45
    s_nop 2
    v_pk_fma_f32 v[88:89], v[106:107], v[116:117], v[88:89] op_sel_hi:[0,1,1] neg_lo:[1,0,0] neg_hi:[1,0,0]
    s_nop 0
    v_pk_mul_f32 v[88:89], v[88:89], v[106:107] op_sel:[0,1]
    v_pk_fma_f32 v[90:91], v[106:107], v[118:119], v[90:91] op_sel_hi:[0,1,1] neg_lo:[1,0,0] neg_hi:[1,0,0]
    s_nop 0
    v_pk_mul_f32 v[90:91], v[90:91], v[106:107] op_sel:[0,1]
    v_pk_fma_f32 v[92:93], v[106:107], v[120:121], v[92:93] op_sel_hi:[0,1,1] neg_lo:[1,0,0] neg_hi:[1,0,0]
    s_nop 0
    v_pk_mul_f32 v[92:93], v[92:93], v[106:107] op_sel:[0,1]
    v_pk_fma_f32 v[94:95], v[106:107], v[122:123], v[94:95] op_sel_hi:[0,1,1] neg_lo:[1,0,0] neg_hi:[1,0,0]
    s_nop 0
    v_pk_mul_f32 v[94:95], v[94:95], v[106:107] op_sel:[0,1]
    v_pk_fma_f32 v[96:97], v[106:107], v[124:125], v[96:97] op_sel_hi:[0,1,1] neg_lo:[1,0,0] neg_hi:[1,0,0]
    s_nop 0
    v_pk_mul_f32 v[96:97], v[96:97], v[106:107] op_sel:[0,1]
    v_pk_fma_f32 v[98:99], v[106:107], v[126:127], v[98:99] op_sel_hi:[0,1,1] neg_lo:[1,0,0] neg_hi:[1,0,0]
    s_nop 0
    v_pk_mul_f32 v[98:99], v[98:99], v[106:107] op_sel:[0,1]
    v_pk_fma_f32 v[100:101], v[106:107], v[128:129], v[100:101] op_sel_hi:[0,1,1] neg_lo:[1,0,0] neg_hi:[1,0,0]
    s_nop 0
    v_pk_mul_f32 v[100:101], v[100:101], v[106:107] op_sel:[0,1]
    v_pk_fma_f32 v[102:103], v[106:107], v[130:131], v[102:103] op_sel_hi:[0,1,1] neg_lo:[1,0,0] neg_hi:[1,0,0]
    s_nop 0
    v_pk_mul_f32 v[102:103], v[102:103], v[106:107] op_sel:[0,1]
    v_cvt_pk_bf16_f32 v164, v88, v89
    v_cvt_pk_bf16_f32 v165, v90, v91
    v_cvt_pk_bf16_f32 v166, v92, v93
    v_cvt_pk_bf16_f32 v167, v94, v95
    v_cvt_pk_bf16_f32 v168, v96, v97
    v_cvt_pk_bf16_f32 v169, v98, v99
    v_cvt_pk_bf16_f32 v170, v100, v101
    v_cvt_pk_bf16_f32 v171, v102, v103
    buffer_store_dwordx4 v[164:167], v5, s[4:7], s55 offen sc1
    buffer_store_dwordx4 v[168:171], v5, s[4:7], s35 offen sc1
    s_mov_b64 exec, 1
    buffer_store_dword v172, off, s[4:7], s53 sc1
    s_mov_b64 exec, -1
    s_cmp_lt_u32 s44, s46
    s_cbranch_scc0 G1_296
    v_mov_b64 v[104:105], 0
    s_mov_b32 s34, 0x3f803f80
    s_waitcnt vmcnt(11)
    ds_read_b128 v[16:19], v2 offset:40960
    ds_read_b128 v[20:23], v2 offset:41984
    s_waitcnt vmcnt(9)
    ds_read_b128 v[24:27], v2 offset:43008
    ds_read_b128 v[28:31], v2 offset:44032
    s_waitcnt vmcnt(7)
    ds_read_b128 v[32:35], v2 offset:45056
    ds_read_b128 v[36:39], v2 offset:46080
    s_waitcnt lgkmcnt(5)
    v_dot2c_f32_bf16 v104, s34, v16
    v_dot2c_f32_bf16 v105, v16, v16
    v_dot2c_f32_bf16 v104, s34, v17
    v_dot2c_f32_bf16 v105, v17, v17
    v_dot2c_f32_bf16 v104, s34, v18
    v_dot2c_f32_bf16 v105, v18, v18
    v_dot2c_f32_bf16 v104, s34, v19
    v_dot2c_f32_bf16 v105, v19, v19
    s_waitcnt lgkmcnt(4)
    v_dot2c_f32_bf16 v104, s34, v20
    v_dot2c_f32_bf16 v105, v20, v20
    v_dot2c_f32_bf16 v104, s34, v21
    v_dot2c_f32_bf16 v105, v21, v21
    v_dot2c_f32_bf16 v104, s34, v22
    v_dot2c_f32_bf16 v105, v22, v22
    v_dot2c_f32_bf16 v104, s34, v23
    v_dot2c_f32_bf16 v105, v23, v23
    s_waitcnt vmcnt(5)
    ds_read_b128 v[40:43], v2 offset:47104
    ds_read_b128 v[44:47], v2 offset:48128
    s_waitcnt lgkmcnt(5)
    v_dot2c_f32_bf16 v104, s34, v24
    v_dot2c_f32_bf16 v105, v24, v24
    v_dot2c_f32_bf16 v104, s34, v25
    v_dot2c_f32_bf16 v105, v25, v25
    v_dot2c_f32_bf16 v104, s34, v26
    v_dot2c_f32_bf16 v105, v26, v26
    v_dot2c_f32_bf16 v104, s34, v27
    v_dot2c_f32_bf16 v105, v27, v27
    s_waitcnt lgkmcnt(4)
    v_dot2c_f32_bf16 v104, s34, v28
    v_dot2c_f32_bf16 v105, v28, v28
    v_dot2c_f32_bf16 v104, s34, v29
    v_dot2c_f32_bf16 v105, v29, v29
    v_dot2c_f32_bf16 v104, s34, v30
    v_dot2c_f32_bf16 v105, v30, v30
    v_dot2c_f32_bf16 v104, s34, v31
    v_dot2c_f32_bf16 v105, v31, v31
    s_waitcnt vmcnt(3)
    ds_read_b128 v[48:51], v2 offset:49152
    ds_read_b128 v[52:55], v2 offset:50176
    s_waitcnt lgkmcnt(5)
    v_dot2c_f32_bf16 v104, s34, v32
    v_dot2c_f32_bf16 v105, v32, v32
    v_dot2c_f32_bf16 v104, s34, v33
    v_dot2c_f32_bf16 v105, v33, v33
    v_dot2c_f32_bf16 v104, s34, v34
    v_dot2c_f32_bf16 v105, v34, v34
    v_dot2c_f32_bf16 v104, s34, v35
    v_dot2c_f32_bf16 v105, v35, v35
    s_waitcnt lgkmcnt(4)
    v_dot2c_f32_bf16 v104, s34, v36
    v_dot2c_f32_bf16 v105, v36, v36
    v_dot2c_f32_bf16 v104, s34, v37
    v_dot2c_f32_bf16 v105, v37, v37
    v_dot2c_f32_bf16 v104, s34, v38
    v_dot2c_f32_bf16 v105, v38, v38
    v_dot2c_f32_bf16 v104, s34, v39
    v_dot2c_f32_bf16 v105, v39, v39
    s_waitcnt lgkmcnt(3)
    v_dot2c_f32_bf16 v104, s34, v40
    v_dot2c_f32_bf16 v105, v40, v40
    v_dot2c_f32_bf16 v104, s34, v41
    v_dot2c_f32_bf16 v105, v41, v41
    v_dot2c_f32_bf16 v104, s34, v42
    v_dot2c_f32_bf16 v105, v42, v42
    v_dot2c_f32_bf16 v104, s34, v43
    v_dot2c_f32_bf16 v105, v43, v43
    s_waitcnt lgkmcnt(2)
    v_dot2c_f32_bf16 v104, s34, v44
    v_dot2c_f32_bf16 v105, v44, v44
    v_dot2c_f32_bf16 v104, s34, v45
    v_dot2c_f32_bf16 v105, v45, v45
    v_dot2c_f32_bf16 v104, s34, v46
    v_dot2c_f32_bf16 v105, v46, v46
    v_dot2c_f32_bf16 v104, s34, v47
    v_dot2c_f32_bf16 v105, v47, v47
    s_waitcnt lgkmcnt(1)
    v_dot2c_f32_bf16 v104, s34, v48
    v_dot2c_f32_bf16 v105, v48, v48
    v_dot2c_f32_bf16 v104, s34, v49
    v_dot2c_f32_bf16 v105, v49, v49
    v_dot2c_f32_bf16 v104, s34, v50
    v_dot2c_f32_bf16 v105, v50, v50
    v_dot2c_f32_bf16 v104, s34, v51
    v_dot2c_f32_bf16 v105, v51, v51
    s_waitcnt lgkmcnt(0)
    v_dot2c_f32_bf16 v104, s34, v52
    v_dot2c_f32_bf16 v105, v52, v52
    v_dot2c_f32_bf16 v104, s34, v53
    v_dot2c_f32_bf16 v105, v53, v53
    v_dot2c_f32_bf16 v104, s34, v54
    v_dot2c_f32_bf16 v105, v54, v54
    v_dot2c_f32_bf16 v104, s34, v55
    v_dot2c_f32_bf16 v105, v55, v55
    s_nop 2
    v_mov_b64 v[106:107], v[104:105]
    s_nop 1
    v_permlane32_swap_b32 v104, v106
    v_permlane32_swap_b32 v105, v107
    v_pk_add_f32 v[104:105], v[104:105], v[106:107]
    ds_write_b64 v3, v[104:105] offset:1024
    v_mov_b32 v172, s49
    s_cmp_lt_u32 s44, s47
    s_addc_u32 s45, s44, 1
    s_mul_i32 s54, s45, 40960
    s_add_u32 s56, s54, s52
    s_add_u32 s54, s54, s50
    s_cmp_lt_u32 s45, s46
    s_cselect_b32 s54, s54, 0x40000000
    s_cbranch_scc0 G1w_325
    s_sub_u32 s35, s44, 1
    s_cmp_gt_u32 s35, 1
    s_cbranch_scc1 G1w_325
    s_add_u32 s35, s57, 1
    v_min_u32 v180, 59, v1
    v_lshlrev_b32 v180, 7, v180
    s_mov_b32 s32, 1122304
    s_mov_b32 s48, 0
P_326:
    buffer_load_dword v176, v180, s[4:7], s32 offen sc1
    s_waitcnt vmcnt(0)
    v_cmp_gt_u32 vcc, s35, v176
    s_cbranch_vccz P_327
    s_add_u32 s48, s48, 1
    s_cmp_gt_u32 s48, 200000
    s_cbranch_scc1 L_end
    s_sleep 1
    s_branch P_326
P_327:
G1w_325:
    s_cmp_lt_u32 s44, 5
    s_cbranch_scc0 G1e_328
    s_waitcnt vmcnt(0) lgkmcnt(0)
    s_barrier
    s_mov_b64 exec, 1
    buffer_store_dword v172, off, s[4:7], s53 sc1
    s_mov_b64 exec, -1
    s_branch G1e_329
G1e_328:
    s_waitcnt lgkmcnt(0)
    s_barrier
G1e_329:
    ds_read_b128 v[56:59], v0 offset:40960
    ds_read_b128 v[60:63], v0 offset:41984
    ds_read_b128 v[64:67], v0 offset:43008
    ds_read_b128 v[68:71], v0 offset:44032
    ds_read_b128 v[106:109], v4 offset:1024
    ds_read_b128 v[110:113], v4 offset:1040
    s_waitcnt lgkmcnt(5)
    v_mfma_f32_32x32x16_bf16 v[88:103], a[0:3], v[56:59], 0
    ds_read_b128 v[72:75], v0 offset:45056
    s_waitcnt lgkmcnt(5)
    v_mfma_f32_32x32x16_bf16 v[88:103], a[4:7], v[60:63], v[88:103]
    ds_read_b128 v[76:79], v0 offset:46080
    s_add_u32 m0, s52, 0
    s_add_u32 s35, s54, 0
    buffer_load_dwordx4 v0, s[4:7], s35 offen offset:0 sc1 lds
    s_waitcnt lgkmcnt(5)
    v_mfma_f32_32x32x16_bf16 v[88:103], a[8:11], v[64:67], v[88:103]
    ds_read_b128 v[80:83], v0 offset:47104
    s_waitcnt lgkmcnt(5)
    v_mfma_f32_32x32x16_bf16 v[88:103], a[12:15], v[68:71], v[88:103]
    ds_read_b128 v[84:87], v0 offset:48128
    buffer_load_dwordx4 v0, s[4:7], s35 offen offset:1024 sc1 lds
    s_waitcnt lgkmcnt(3)
    v_mfma_f32_32x32x16_bf16 v[88:103], a[16:19], v[72:75], v[88:103]
    ds_read_b128 v[56:59], v0 offset:49152
    s_waitcnt lgkmcnt(3)
    v_mfma_f32_32x32x16_bf16 v[88:103], a[20:23], v[76:79], v[88:103]
    ds_read_b128 v[60:63], v0 offset:50176
    buffer_load_dwordx4 v0, s[4:7], s35 offen offset:2048 sc1 lds
    s_waitcnt lgkmcnt(3)
    v_mfma_f32_32x32x16_bf16 v[88:103], a[24:27], v[80:83], v[88:103]
    ds_read_b128 v[64:67], v0 offset:51200
    s_waitcnt lgkmcnt(3)
    v_mfma_f32_32x32x16_bf16 v[88:103], a[28:31], v[84:87], v[88:103]
    ds_read_b128 v[68:71], v0 offset:52224
    buffer_load_dwordx4 v0, s[4:7], s35 offen offset:3072 sc1 lds
    s_waitcnt lgkmcnt(3)
    v_mfma_f32_32x32x16_bf16 v[88:103], a[32:35], v[56:59], v[88:103]
    ds_read_b128 v[72:75], v0 offset:53248
    s_waitcnt lgkmcnt(3)
    v_mfma_f32_32x32x16_bf16 v[88:103], a[36:39], v[60:63], v[88:103]
    ds_read_b128 v[76:79], v0 offset:54272
    s_add_u32 m0, s52, 4096
    s_add_u32 s35, s54, 4096
    buffer_load_dwordx4 v0, s[4:7], s35 offen offset:0 sc1 lds
    s_waitcnt lgkmcnt(3)
    v_mfma_f32_32x32x16_bf16 v[88:103], a[40:43], v[64:67], v[88:103]
    ds_read_b128 v[80:83], v0 offset:55296
    s_waitcnt lgkmcnt(3)
    v_mfma_f32_32x32x16_bf16 v[88:103], a[44:47], v[68:71], v[88:103]
    ds_read_b128 v[84:87], v0 offset:56320
    buffer_load_dwordx4 v0, s[4:7], s35 offen offset:1024 sc1 lds
    s_waitcnt lgkmcnt(3)
    v_mfma_f32_32x32x16_bf16 v[88:103], a[48:51], v[72:75], v[88:103]
    ds_read_b128 v[56:59], v0 offset:57344
    s_waitcnt lgkmcnt(3)
    v_mfma_f32_32x32x16_bf16 v[88:103], a[52:55], v[76:79], v[88:103]
    ds_read_b128 v[60:63], v0 offset:58368
    buffer_load_dwordx4 v0, s[4:7], s35 offen offset:2048 sc1 lds
    s_waitcnt lgkmcnt(3)
    v_mfma_f32_32x32x16_bf16 v[88:103], a[56:59], v[80:83], v[88:103]
    ds_read_b128 v[64:67], v0 offset:59392
    s_waitcnt lgkmcnt(3)
    v_mfma_f32_32x32x16_bf16 v[88:103], a[60:63], v[84:87], v[88:103]
    ds_read_b128 v[68:71], v0 offset:60416
    buffer_load_dwordx4 v0, s[4:7], s35 offen offset:3072 sc1 lds
    s_waitcnt lgkmcnt(3)
    v_mfma_f32_32x32x16_bf16 v[88:103], a[64:67], v[56:59], v[88:103]
    ds_read_b128 v[72:75], v0 offset:61440
    s_waitcnt lgkmcnt(3)
    v_mfma_f32_32x32x16_bf16 v[88:103], a[68:71], v[60:63], v[88:103]
    ds_read_b128 v[76:79], v0 offset:62464
    s_add_u32 m0, s52, 8192
    s_add_u32 s35, s54, 8192
    buffer_load_dwordx4 v0, s[4:7], s35 offen offset:0 sc1 lds
    s_waitcnt lgkmcnt(3)
    v_mfma_f32_32x32x16_bf16 v[88:103], a[72:75], v[64:67], v[88:103]
    ds_read_b128 v[80:83], v0 offset:63488
    s_waitcnt lgkmcnt(3)
    v_mfma_f32_32x32x16_bf16 v[88:103], a[76:79], v[68:71], v[88:103]
    ds_read_b128 v[84:87], v0 offset:64512
    buffer_load_dwordx4 v0, s[4:7], s35 offen offset:1024 sc1 lds
    s_waitcnt lgkmcnt(3)
    v_mfma_f32_32x32x16_bf16 v[88:103], a[80:83], v[72:75], v[88:103]
    ds_read_b128 v[56:59], v8 offset:0
    v_add_f32 v106, v106, v108
    v_add_f32 v107, v107, v109
    s_waitcnt lgkmcnt(3)
    v_mfma_f32_32x32x16_bf16 v[88:103], a[84:87], v[76:79], v[88:103]
    ds_read_b128 v[60:63], v8 offset:1024
    v_add_f32 v106, v106, v110
    v_add_f32 v107, v107, v111
    s_waitcnt lgkmcnt(3)
    v_mfma_f32_32x32x16_bf16 v[88:103], a[88:91], v[80:83], v[88:103]
    ds_read_b128 v[64:67], v8 offset:2048
    v_add_f32 v106, v106, v112
    v_add_f32 v107, v107, v113
    s_waitcnt lgkmcnt(3)
    v_mfma_f32_32x32x16_bf16 v[88:103], a[92:95], v[84:87], v[88:103]
    ds_read_b128 v[68:71], v8 offset:3072
    v_mul_f32 v106, 0x3acccccd, v106
    v_mul_f32 v107, 0x3acccccd, v107
    s_waitcnt lgkmcnt(3)
    v_mfma_f32_32x32x16_bf16 v[88:103], a[96:99], v[56:59], v[88:103]
    ds_read_b128 v[72:75], v8 offset:4096
    v_fma_f32 v107, -v106, v106, v107
    v_max_f32 v107, 0, v107
    s_waitcnt lgkmcnt(3)
    v_mfma_f32_32x32x16_bf16 v[88:103], a[100:103], v[60:63], v[88:103]
    ds_read_b128 v[76:79], v8 offset:5120
    v_add_f32 v107, 0x3727c5ac, v107
    v_rsq_f32 v107, v107
    s_waitcnt lgkmcnt(3)
    v_mfma_f32_32x32x16_bf16 v[88:103], a[104:107], v[64:67], v[88:103]
    ds_read_b128 v[80:83], v8 offset:6144
    s_waitcnt lgkmcnt(3)
    v_mfma_f32_32x32x16_bf16 v[88:103], a[108:111], v[68:71], v[88:103]
    ds_read_b128 v[84:87], v8 offset:7168
    s_waitcnt lgkmcnt(3)
    v_mfma_f32_32x32x16_bf16 v[88:103], a[112:115], v[72:75], v[88:103]
    ds_read_b128 v[56:59], v8 offset:8192
    s_waitcnt lgkmcnt(3)
    v_mfma_f32_32x32x16_bf16 v[88:103], a[116:119], v[76:79], v[88:103]
    ds_read_b128 v[60:63], v8 offset:9216
    s_waitcnt lgkmcnt(3)
    v_mfma_f32_32x32x16_bf16 v[88:103], a[120:123], v[80:83], v[88:103]
    ds_read_b128 v[64:67], v8 offset:10240
    s_waitcnt lgkmcnt(3)
    v_mfma_f32_32x32x16_bf16 v[88:103], a[124:127], v[84:87], v[88:103]
    ds_read_b128 v[68:71], v8 offset:11264
    s_waitcnt lgkmcnt(3)
    v_mfma_f32_32x32x16_bf16 v[88:103], a[128:131], v[56:59], v[88:103]
    ds_read_b128 v[72:75], v8 offset:12288
    s_waitcnt lgkmcnt(3)
    v_mfma_f32_32x32x16_bf16 v[88:103], a[132:135], v[60:63], v[88:103]
    ds_read_b128 v[76:79], v8 offset:13312
    s_waitcnt lgkmcnt(3)
    v_mfma_f32_32x32x16_bf16 v[88:103], a[136:139], v[64:67], v[88:103]
    ds_read_b128 v[80:83], v8 offset:14336
    s_waitcnt lgkmcnt(3)
    v_mfma_f32_32x32x16_bf16 v[88:103], a[140:143], v[68:71], v[88:103]
    ds_read_b128 v[84:87], v8 offset:15360
    s_waitcnt lgkmcnt(3)
    v_mfma_f32_32x32x16_bf16 v[88:103], a[144:147], v[72:75], v[88:103]
    s_waitcnt lgkmcnt(2)
    v_mfma_f32_32x32x16_bf16 v[88:103], a[148:151], v[76:79], v[88:103]
    s_waitcnt vmcnt(10)
    s_barrier
    s_waitcnt lgkmcnt(1)
    v_mfma_f32_32x32x16_bf16 v[88:103], a[152:155], v[80:83], v[88:103]
    s_waitcnt lgkmcnt(0)
    v_mfma_f32_32x32x16_bf16 v[88:103], a[156:159], v[84:87], v[88:103]
    s_mul_i32 s55, s44, s58
    s_add_u32 s55, s55, s51
    s_xor_b32 s35, s44, s74
    s_and_b32 s35, s35, 2
    s_lshl_b32 s35, s35, 12
    s_add_u32 s55, s55, s35
    s_add_u32 s35, s55, s59
    s_add_u32 s49, s45, s61
    s_mov_b32 s44, s45
    s_nop 2
    v_pk_fma_f32 v[88:89], v[106:107], v[116:117], v[88:89] op_sel_hi:[0,1,1] neg_lo:[1,0,0] neg_hi:[1,0,0]
    s_nop 0
    v_pk_mul_f32 v[88:89], v[88:89], v[106:107] op_sel:[0,1]
    v_pk_fma_f32 v[90:91], v[106:107], v[118:119], v[90:91] op_sel_hi:[0,1,1] neg_lo:[1,0,0] neg_hi:[1,0,0]
    s_nop 0
    v_pk_mul_f32 v[90:91], v[90:91], v[106:107] op_sel:[0,1]
    v_pk_fma_f32 v[92:93], v[106:107], v[120:121], v[92:93] op_sel_hi:[0,1,1] neg_lo:[1,0,0] neg_hi:[1,0,0]
    s_nop 0
    v_pk_mul_f32 v[92:93], v[92:93], v[106:107] op_sel:[0,1]
    v_pk_fma_f32 v[94:95], v[106:107], v[122:123], v[94:95] op_sel_hi:[0,1,1] neg_lo:[1,0,0] neg_hi:[1,0,0]
    s_nop 0
    v_pk_mul_f32 v[94:95], v[94:95], v[106:107] op_sel:[0,1]
    v_pk_fma_f32 v[96:97], v[106:107], v[124:125], v[96:97] op_sel_hi:[0,1,1] neg_lo:[1,0,0] neg_hi:[1,0,0]
    s_nop 0
    v_pk_mul_f32 v[96:97], v[96:97], v[106:107] op_sel:[0,1]
    v_pk_fma_f32 v[98:99], v[106:107], v[126:127], v[98:99] op_sel_hi:[0,1,1] neg_lo:[1,0,0] neg_hi:[1,0,0]
    s_nop 0
    v_pk_mul_f32 v[98:99], v[98:99], v[106:107] op_sel:[0,1]
    v_pk_fma_f32 v[100:101], v[106:107], v[128:129], v[100:101] op_sel_hi:[0,1,1] neg_lo:[1,0,0] neg_hi:[1,0,0]
    s_nop 0
    v_pk_mul_f32 v[100:101], v[100:101], v[106:107] op_sel:[0,1]
    v_pk_fma_f32 v[102:103], v[106:107], v[130:131], v[102:103] op_sel_hi:[0,1,1] neg_lo:[1,0,0] neg_hi:[1,0,0]
    s_nop 0
    v_pk_mul_f32 v[102:103], v[102:103], v[106:107] op_sel:[0,1]
    v_cvt_pk_bf16_f32 v164, v88, v89
    v_cvt_pk_bf16_f32 v165, v90, v91
    v_cvt_pk_bf16_f32 v166, v92, v93
    v_cvt_pk_bf16_f32 v167, v94, v95
    v_cvt_pk_bf16_f32 v168, v96, v97
    v_cvt_pk_bf16_f32 v169, v98, v99
    v_cvt_pk_bf16_f32 v170, v100, v101
    v_cvt_pk_bf16_f32 v171, v102, v103
    buffer_store_dwordx4 v[164:167], v5, s[4:7], s55 offen sc1
    buffer_store_dwordx4 v[168:171], v5, s[4:7], s35 offen sc1
    s_mov_b64 exec, 1
    buffer_store_dword v172, off, s[4:7], s53 sc1
    s_mov_b64 exec, -1
    s_cmp_lt_u32 s44, s46
    s_cbranch_scc1 G1_319
    s_branch G1_296
G1_316:
    v_min_u32 v180, 29, v1
    v_lshlrev_b32 v180, 7, v180
    s_mov_b32 s32, 1069056
    s_mov_b32 s48, 0
P_330:
    buffer_load_dword v176, v180, s[4:7], s32 offen sc1
    s_waitcnt vmcnt(0)
    v_cmp_gt_u32 vcc, s57, v176
    s_cbranch_vccz P_331
    s_add_u32 s48, s48, 1
    s_cmp_gt_u32 s48, 200000
    s_cbranch_scc1 L_end
    s_sleep 1
    s_branch P_330
P_331:
    v_bfe_u32 v7, v1, 0, 2
    v_mul_u32_u24 v7, 4, v7
    v_bfe_u32 v176, v1, 2, 1
    v_lshl_add_u32 v7, v176, 5, v7
    v_bfe_u32 v176, v1, 3, 1
    v_lshl_add_u32 v7, v176, 4, v7
    v_bfe_u32 v176, v1, 4, 1
    v_lshl_add_u32 v7, v176, 6, v7
    v_add_u32 v7, 90112, v7
    s_mul_i32 s35, s30, 16384
    s_add_u32 s35, s35, 5242880
    s_lshl_b32 s34, s29, 12
    s_add_u32 s35, s35, s34
    s_add_u32 m0, s34, 90112
    s_nop 0
    buffer_load_dwordx4 v0, s[4:7], s35 offen offset:0 sc1 lds
    buffer_load_dwordx4 v0, s[4:7], s35 offen offset:1024 sc1 lds
    buffer_load_dwordx4 v0, s[4:7], s35 offen offset:2048 sc1 lds
    buffer_load_dwordx4 v0, s[4:7], s35 offen offset:3072 sc1 lds
    s_mul_i32 s54, s44, 40960
    s_add_u32 s56, s54, s52
    s_add_u32 s54, s54, s50
    s_waitcnt lgkmcnt(0)
    s_add_u32 m0, s52, 0
    s_add_u32 s35, s54, 0
    buffer_load_dwordx4 v0, s[4:7], s35 offen offset:0 sc1 lds
    buffer_load_dwordx4 v0, s[4:7], s35 offen offset:1024 sc1 lds
    buffer_load_dwordx4 v0, s[4:7], s35 offen offset:2048 sc1 lds
    buffer_load_dwordx4 v0, s[4:7], s35 offen offset:3072 sc1 lds
    s_add_u32 m0, s52, 4096
    s_add_u32 s35, s54, 4096
    buffer_load_dwordx4 v0, s[4:7], s35 offen offset:0 sc1 lds
    buffer_load_dwordx4 v0, s[4:7], s35 offen offset:1024 sc1 lds
    buffer_load_dwordx4 v0, s[4:7], s35 offen offset:2048 sc1 lds
    buffer_load_dwordx4 v0, s[4:7], s35 offen offset:3072 sc1 lds
    s_add_u32 m0, s52, 8192
    s_add_u32 s35, s54, 8192
    buffer_load_dwordx4 v0, s[4:7], s35 offen offset:0 sc1 lds
    buffer_load_dwordx4 v0, s[4:7], s35 offen offset:1024 sc1 lds
    buffer_load_dword v185, off, s[8:11], 0
    buffer_load_dword v185, off, s[8:11], 0
    buffer_load_dword v185, off, s[8:11], 0
G1_332:
    v_mov_b32 v172, s49
    s_cmp_lt_u32 s44, s47
    s_addc_u32 s45, s44, 1
    s_mul_i32 s54, s45, 40960
    s_add_u32 s56, s54, s52
    s_add_u32 s54, s54, s50
    s_cmp_lt_u32 s45, s46
    s_cselect_b32 s54, s54, 0x40000000
    s_lshl_b32 s34, s44, 8
    v_add_u32 v104, s34, v7
    s_waitcnt vmcnt(3)
    s_barrier
    ds_read_b128 v[56:59], v0 offset:0
    ds_read_b128 v[60:63], v0 offset:1024
    ds_read_b128 v[64:67], v0 offset:2048
    ds_read_b128 v[68:71], v0 offset:3072
    s_waitcnt lgkmcnt(3)
    v_mfma_f32_32x32x16_bf16 v[88:103], a[0:3], v[56:59], 0
    ds_read_b128 v[72:75], v0 offset:4096
    s_waitcnt lgkmcnt(3)
    v_mfma_f32_32x32x16_bf16 v[88:103], a[4:7], v[60:63], v[88:103]
    ds_read_b128 v[76:79], v0 offset:5120
    s_add_u32 m0, s52, 40960
    s_add_u32 s35, s54, 0
    buffer_load_dwordx4 v0, s[4:7], s35 offen offset:0 sc1 lds
    s_waitcnt lgkmcnt(3)
    v_mfma_f32_32x32x16_bf16 v[88:103], a[8:11], v[64:67], v[88:103]
    ds_read_b128 v[80:83], v0 offset:6144
    s_waitcnt lgkmcnt(3)
    v_mfma_f32_32x32x16_bf16 v[88:103], a[12:15], v[68:71], v[88:103]
    ds_read_b128 v[84:87], v0 offset:7168
    buffer_load_dwordx4 v0, s[4:7], s35 offen offset:1024 sc1 lds
    s_waitcnt lgkmcnt(3)
    v_mfma_f32_32x32x16_bf16 v[88:103], a[16:19], v[72:75], v[88:103]
    ds_read_b128 v[56:59], v0 offset:8192
    s_waitcnt lgkmcnt(3)
    v_mfma_f32_32x32x16_bf16 v[88:103], a[20:23], v[76:79], v[88:103]
    ds_read_b128 v[60:63], v0 offset:9216
    buffer_load_dwordx4 v0, s[4:7], s35 offen offset:2048 sc1 lds
    s_waitcnt lgkmcnt(3)
    v_mfma_f32_32x32x16_bf16 v[88:103], a[24:27], v[80:83], v[88:103]
    ds_read_b128 v[64:67], v0 offset:10240
    s_waitcnt lgkmcnt(3)
    v_mfma_f32_32x32x16_bf16 v[88:103], a[28:31], v[84:87], v[88:103]
    ds_read_b128 v[68:71], v0 offset:11264
    buffer_load_dwordx4 v0, s[4:7], s35 offen offset:3072 sc1 lds
    s_waitcnt lgkmcnt(3)
    v_mfma_f32_32x32x16_bf16 v[88:103], a[32:35], v[56:59], v[88:103]
    ds_read_b128 v[72:75], v0 offset:12288
    s_waitcnt lgkmcnt(3)
    v_mfma_f32_32x32x16_bf16 v[88:103], a[36:39], v[60:63], v[88:103]
    ds_read_b128 v[76:79], v0 offset:13312
    s_add_u32 m0, s52, 45056
    s_add_u32 s35, s54, 4096
    buffer_load_dwordx4 v0, s[4:7], s35 offen offset:0 sc1 lds
    s_waitcnt lgkmcnt(3)
    v_mfma_f32_32x32x16_bf16 v[88:103], a[40:43], v[64:67], v[88:103]
    ds_read_b128 v[80:83], v0 offset:14336
    s_waitcnt lgkmcnt(3)
    v_mfma_f32_32x32x16_bf16 v[88:103], a[44:47], v[68:71], v[88:103]
    ds_read_b128 v[84:87], v0 offset:15360
    buffer_load_dwordx4 v0, s[4:7], s35 offen offset:1024 sc1 lds
    s_waitcnt lgkmcnt(3)
    v_mfma_f32_32x32x16_bf16 v[88:103], a[48:51], v[72:75], v[88:103]
    ds_read_b128 v[56:59], v0 offset:16384
    s_waitcnt lgkmcnt(3)
    v_mfma_f32_32x32x16_bf16 v[88:103], a[52:55], v[76:79], v[88:103]
    ds_read_b128 v[60:63], v0 offset:17408
    buffer_load_dwordx4 v0, s[4:7], s35 offen offset:2048 sc1 lds
    s_waitcnt lgkmcnt(3)
    v_mfma_f32_32x32x16_bf16 v[88:103], a[56:59], v[80:83], v[88:103]
    ds_read_b128 v[64:67], v0 offset:18432
    s_waitcnt lgkmcnt(3)
    v_mfma_f32_32x32x16_bf16 v[88:103], a[60:63], v[84:87], v[88:103]
    ds_read_b128 v[68:71], v0 offset:19456
    buffer_load_dwordx4 v0, s[4:7], s35 offen offset:3072 sc1 lds
    s_waitcnt lgkmcnt(3)
    v_mfma_f32_32x32x16_bf16 v[88:103], a[64:67], v[56:59], v[88:103]
    ds_read_b128 v[72:75], v0 offset:20480
    s_waitcnt lgkmcnt(3)
    v_mfma_f32_32x32x16_bf16 v[88:103], a[68:71], v[60:63], v[88:103]
    ds_read_b128 v[76:79], v0 offset:21504
    s_add_u32 m0, s52, 49152
    s_add_u32 s35, s54, 8192
    buffer_load_dwordx4 v0, s[4:7], s35 offen offset:0 sc1 lds
    s_waitcnt lgkmcnt(3)
    v_mfma_f32_32x32x16_bf16 v[88:103], a[72:75], v[64:67], v[88:103]
    ds_read_b128 v[80:83], v0 offset:22528
    s_waitcnt lgkmcnt(3)
    v_mfma_f32_32x32x16_bf16 v[88:103], a[76:79], v[68:71], v[88:103]
    ds_read_b128 v[84:87], v0 offset:23552
    buffer_load_dwordx4 v0, s[4:7], s35 offen offset:1024 sc1 lds
    s_waitcnt lgkmcnt(3)
    v_mfma_f32_32x32x16_bf16 v[88:103], a[80:83], v[72:75], v[88:103]
    ds_read_b128 v[56:59], v0 offset:24576
    ds_read2_b32 v[106:107], v104 offset0:0 offset1:32
    s_waitcnt lgkmcnt(4)
    v_mfma_f32_32x32x16_bf16 v[88:103], a[84:87], v[76:79], v[88:103]
    ds_read_b128 v[60:63], v0 offset:25600
    s_waitcnt lgkmcnt(4)
    v_mfma_f32_32x32x16_bf16 v[88:103], a[88:91], v[80:83], v[88:103]
    ds_read_b128 v[64:67], v0 offset:26624
    s_waitcnt lgkmcnt(4)
    v_mfma_f32_32x32x16_bf16 v[88:103], a[92:95], v[84:87], v[88:103]
    ds_read_b128 v[68:71], v0 offset:27648
    s_waitcnt lgkmcnt(4)
    v_mfma_f32_32x32x16_bf16 v[88:103], a[96:99], v[56:59], v[88:103]
    ds_read_b128 v[72:75], v0 offset:28672
    s_waitcnt lgkmcnt(3)
    v_mfma_f32_32x32x16_bf16 v[88:103], a[100:103], v[60:63], v[88:103]
    ds_read_b128 v[76:79], v0 offset:29696
    s_waitcnt lgkmcnt(3)
    v_mfma_f32_32x32x16_bf16 v[88:103], a[104:107], v[64:67], v[88:103]
    ds_read_b128 v[80:83], v0 offset:30720
    s_waitcnt lgkmcnt(3)
    v_mfma_f32_32x32x16_bf16 v[88:103], a[108:111], v[68:71], v[88:103]
    ds_read_b128 v[84:87], v0 offset:31744
    s_waitcnt lgkmcnt(3)
    v_mfma_f32_32x32x16_bf16 v[88:103], a[112:115], v[72:75], v[88:103]
    ds_read_b128 v[56:59], v0 offset:32768
    s_waitcnt lgkmcnt(3)
    v_mfma_f32_32x32x16_bf16 v[88:103], a[116:119], v[76:79], v[88:103]
    ds_read_b128 v[60:63], v0 offset:33792
    s_waitcnt lgkmcnt(3)
    v_mfma_f32_32x32x16_bf16 v[88:103], a[120:123], v[80:83], v[88:103]
    ds_read_b128 v[64:67], v0 offset:34816
    s_waitcnt lgkmcnt(3)
    v_mfma_f32_32x32x16_bf16 v[88:103], a[124:127], v[84:87], v[88:103]
    ds_read_b128 v[68:71], v0 offset:35840
    s_waitcnt lgkmcnt(3)
    v_mfma_f32_32x32x16_bf16 v[88:103], a[128:131], v[56:59], v[88:103]
    ds_read_b128 v[72:75], v0 offset:36864
    s_waitcnt lgkmcnt(3)
    v_mfma_f32_32x32x16_bf16 v[88:103], a[132:135], v[60:63], v[88:103]
    ds_read_b128 v[76:79], v0 offset:37888
    s_waitcnt lgkmcnt(3)
    v_mfma_f32_32x32x16_bf16 v[88:103], a[136:139], v[64:67], v[88:103]
    ds_read_b128 v[80:83], v0 offset:38912
    s_waitcnt lgkmcnt(3)
    v_mfma_f32_32x32x16_bf16 v[88:103], a[140:143], v[68:71], v[88:103]
    ds_read_b128 v[84:87], v0 offset:39936
    s_waitcnt lgkmcnt(3)
    v_mfma_f32_32x32x16_bf16 v[88:103], a[144:147], v[72:75], v[88:103]
    s_waitcnt lgkmcnt(2)
    v_mfma_f32_32x32x16_bf16 v[88:103], a[148:151], v[76:79], v[88:103]
    s_waitcnt vmcnt(10)
    s_barrier
    s_waitcnt lgkmcnt(1)
    v_mfma_f32_32x32x16_bf16 v[88:103], a[152:155], v[80:83], v[88:103]
    s_waitcnt lgkmcnt(0)
    v_mfma_f32_32x32x16_bf16 v[88:103], a[156:159], v[84:87], v[88:103]
    s_mul_i32 s55, s44, s58
    s_add_u32 s55, s55, s51
    s_xor_b32 s35, s44, s74
    s_and_b32 s35, s35, 2
    s_lshl_b32 s35, s35, 12
    s_add_u32 s55, s55, s35
    s_add_u32 s35, s55, s59
    s_add_u32 s49, s45, s61
    s_mov_b32 s44, s45
    s_nop 2
    v_pk_fma_f32 v[88:89], v[106:107], v[116:117], v[88:89] op_sel_hi:[0,1,1] neg_lo:[1,0,0] neg_hi:[1,0,0]
    s_nop 0
    v_pk_mul_f32 v[88:89], v[88:89], v[106:107] op_sel:[0,1]
    v_pk_fma_f32 v[90:91], v[106:107], v[118:119], v[90:91] op_sel_hi:[0,1,1] neg_lo:[1,0,0] neg_hi:[1,0,0]
    s_nop 0
    v_pk_mul_f32 v[90:91], v[90:91], v[106:107] op_sel:[0,1]
    v_pk_fma_f32 v[92:93], v[106:107], v[120:121], v[92:93] op_sel_hi:[0,1,1] neg_lo:[1,0,0] neg_hi:[1,0,0]
    s_nop 0
    v_pk_mul_f32 v[92:93], v[92:93], v[106:107] op_sel:[0,1]
    v_pk_fma_f32 v[94:95], v[106:107], v[122:123], v[94:95] op_sel_hi:[0,1,1] neg_lo:[1,0,0] neg_hi:[1,0,0]
    s_nop 0
    v_pk_mul_f32 v[94:95], v[94:95], v[106:107] op_sel:[0,1]
    v_pk_fma_f32 v[96:97], v[106:107], v[124:125], v[96:97] op_sel_hi:[0,1,1] neg_lo:[1,0,0] neg_hi:[1,0,0]
    s_nop 0
    v_pk_mul_f32 v[96:97], v[96:97], v[106:107] op_sel:[0,1]
    v_pk_fma_f32 v[98:99], v[106:107], v[126:127], v[98:99] op_sel_hi:[0,1,1] neg_lo:[1,0,0] neg_hi:[1,0,0]
    s_nop 0
    v_pk_mul_f32 v[98:99], v[98:99], v[106:107] op_sel:[0,1]
    v_pk_fma_f32 v[100:101], v[106:107], v[128:129], v[100:101] op_sel_hi:[0,1,1] neg_lo:[1,0,0] neg_hi:[1,0,0]
    s_nop 0
    v_pk_mul_f32 v[100:101], v[100:101], v[106:107] op_sel:[0,1]
    v_pk_fma_f32 v[102:103], v[106:107], v[130:131], v[102:103] op_sel_hi:[0,1,1] neg_lo:[1,0,0] neg_hi:[1,0,0]
    s_nop 0
    v_pk_mul_f32 v[102:103], v[102:103], v[106:107] op_sel:[0,1]
    v_cvt_pk_bf16_f32 v164, v88, v89
    v_cvt_pk_bf16_f32 v165, v90, v91
    v_cvt_pk_bf16_f32 v166, v92, v93
    v_cvt_pk_bf16_f32 v167, v94, v95
    v_cvt_pk_bf16_f32 v168, v96, v97
    v_cvt_pk_bf16_f32 v169, v98, v99
    v_cvt_pk_bf16_f32 v170, v100, v101
    v_cvt_pk_bf16_f32 v171, v102, v103
    buffer_store_dwordx4 v[164:167], v5, s[4:7], s55 offen sc1
    buffer_store_dwordx4 v[168:171], v5, s[4:7], s35 offen sc1
    s_mov_b64 exec, 1
    buffer_store_dword v172, off, s[4:7], s53 sc1
    s_mov_b64 exec, -1
    s_cmp_lt_u32 s44, s46
    s_cbranch_scc0 G1_296
    v_mov_b32 v172, s49
    s_cmp_lt_u32 s44, s47
    s_addc_u32 s45, s44, 1
    s_mul_i32 s54, s45, 40960
    s_add_u32 s56, s54, s52
    s_add_u32 s54, s54, s50
    s_cmp_lt_u32 s45, s46
    s_cselect_b32 s54, s54, 0x40000000
    s_lshl_b32 s34, s44, 8
    v_add_u32 v104, s34, v7
    s_waitcnt vmcnt(3)
    s_barrier
    ds_read_b128 v[56:59], v0 offset:40960
    ds_read_b128 v[60:63], v0 offset:41984
    ds_read_b128 v[64:67], v0 offset:43008
    ds_read_b128 v[68:71], v0 offset:44032
    s_waitcnt lgkmcnt(3)
    v_mfma_f32_32x32x16_bf16 v[88:103], a[0:3], v[56:59], 0
    ds_read_b128 v[72:75], v0 offset:45056
    s_waitcnt lgkmcnt(3)
    v_mfma_f32_32x32x16_bf16 v[88:103], a[4:7], v[60:63], v[88:103]
    ds_read_b128 v[76:79], v0 offset:46080
    s_add_u32 m0, s52, 0
    s_add_u32 s35, s54, 0
    buffer_load_dwordx4 v0, s[4:7], s35 offen offset:0 sc1 lds
    s_waitcnt lgkmcnt(3)
    v_mfma_f32_32x32x16_bf16 v[88:103], a[8:11], v[64:67], v[88:103]
    ds_read_b128 v[80:83], v0 offset:47104
    s_waitcnt lgkmcnt(3)
    v_mfma_f32_32x32x16_bf16 v[88:103], a[12:15], v[68:71], v[88:103]
    ds_read_b128 v[84:87], v0 offset:48128
    buffer_load_dwordx4 v0, s[4:7], s35 offen offset:1024 sc1 lds
    s_waitcnt lgkmcnt(3)
    v_mfma_f32_32x32x16_bf16 v[88:103], a[16:19], v[72:75], v[88:103]
    ds_read_b128 v[56:59], v0 offset:49152
    s_waitcnt lgkmcnt(3)
    v_mfma_f32_32x32x16_bf16 v[88:103], a[20:23], v[76:79], v[88:103]
    ds_read_b128 v[60:63], v0 offset:50176
    buffer_load_dwordx4 v0, s[4:7], s35 offen offset:2048 sc1 lds
    s_waitcnt lgkmcnt(3)
    v_mfma_f32_32x32x16_bf16 v[88:103], a[24:27], v[80:83], v[88:103]
    ds_read_b128 v[64:67], v0 offset:51200
    s_waitcnt lgkmcnt(3)
    v_mfma_f32_32x32x16_bf16 v[88:103], a[28:31], v[84:87], v[88:103]
    ds_read_b128 v[68:71], v0 offset:52224
    buffer_load_dwordx4 v0, s[4:7], s35 offen offset:3072 sc1 lds
    s_waitcnt lgkmcnt(3)
    v_mfma_f32_32x32x16_bf16 v[88:103], a[32:35], v[56:59], v[88:103]
    ds_read_b128 v[72:75], v0 offset:53248
    s_waitcnt lgkmcnt(3)
    v_mfma_f32_32x32x16_bf16 v[88:103], a[36:39], v[60:63], v[88:103]
    ds_read_b128 v[76:79], v0 offset:54272
    s_add_u32 m0, s52, 4096
    s_add_u32 s35, s54, 4096
    buffer_load_dwordx4 v0, s[4:7], s35 offen offset:0 sc1 lds
    s_waitcnt lgkmcnt(3)
    v_mfma_f32_32x32x16_bf16 v[88:103], a[40:43], v[64:67], v[88:103]
    ds_read_b128 v[80:83], v0 offset:55296
    s_waitcnt lgkmcnt(3)
    v_mfma_f32_32x32x16_bf16 v[88:103], a[44:47], v[68:71], v[88:103]
    ds_read_b128 v[84:87], v0 offset:56320
    buffer_load_dwordx4 v0, s[4:7], s35 offen offset:1024 sc1 lds
    s_waitcnt lgkmcnt(3)
    v_mfma_f32_32x32x16_bf16 v[88:103], a[48:51], v[72:75], v[88:103]
    ds_read_b128 v[56:59], v0 offset:57344
    s_waitcnt lgkmcnt(3)
    v_mfma_f32_32x32x16_bf16 v[88:103], a[52:55], v[76:79], v[88:103]
    ds_read_b128 v[60:63], v0 offset:58368
    buffer_load_dwordx4 v0, s[4:7], s35 offen offset:2048 sc1 lds
    s_waitcnt lgkmcnt(3)
    v_mfma_f32_32x32x16_bf16 v[88:103], a[56:59], v[80:83], v[88:103]
    ds_read_b128 v[64:67], v0 offset:59392
    s_waitcnt lgkmcnt(3)
    v_mfma_f32_32x32x16_bf16 v[88:103], a[60:63], v[84:87], v[88:103]
    ds_read_b128 v[68:71], v0 offset:60416
    buffer_load_dwordx4 v0, s[4:7], s35 offen offset:3072 sc1 lds
    s_waitcnt lgkmcnt(3)
    v_mfma_f32_32x32x16_bf16 v[88:103], a[64:67], v[56:59], v[88:103]
    ds_read_b128 v[72:75], v0 offset:61440
    s_waitcnt lgkmcnt(3)
    v_mfma_f32_32x32x16_bf16 v[88:103], a[68:71], v[60:63], v[88:103]
    ds_read_b128 v[76:79], v0 offset:62464
    s_add_u32 m0, s52, 8192
    s_add_u32 s35, s54, 8192
    buffer_load_dwordx4 v0, s[4:7], s35 offen offset:0 sc1 lds
    s_waitcnt lgkmcnt(3)
    v_mfma_f32_32x32x16_bf16 v[88:103], a[72:75], v[64:67], v[88:103]
    ds_read_b128 v[80:83], v0 offset:63488
    s_waitcnt lgkmcnt(3)
    v_mfma_f32_32x32x16_bf16 v[88:103], a[76:79], v[68:71], v[88:103]
    ds_read_b128 v[84:87], v0 offset:64512
    buffer_load_dwordx4 v0, s[4:7], s35 offen offset:1024 sc1 lds
    s_waitcnt lgkmcnt(3)
    v_mfma_f32_32x32x16_bf16 v[88:103], a[80:83], v[72:75], v[88:103]
    ds_read_b128 v[56:59], v8 offset:0
    ds_read2_b32 v[106:107], v104 offset0:0 offset1:32
    s_waitcnt lgkmcnt(4)
    v_mfma_f32_32x32x16_bf16 v[88:103], a[84:87], v[76:79], v[88:103]
    ds_read_b128 v[60:63], v8 offset:1024
    s_waitcnt lgkmcnt(4)
    v_mfma_f32_32x32x16_bf16 v[88:103], a[88:91], v[80:83], v[88:103]
    ds_read_b128 v[64:67], v8 offset:2048
    s_waitcnt lgkmcnt(4)
    v_mfma_f32_32x32x16_bf16 v[88:103], a[92:95], v[84:87], v[88:103]
    ds_read_b128 v[68:71], v8 offset:3072
    s_waitcnt lgkmcnt(4)
    v_mfma_f32_32x32x16_bf16 v[88:103], a[96:99], v[56:59], v[88:103]
    ds_read_b128 v[72:75], v8 offset:4096
    s_waitcnt lgkmcnt(3)
    v_mfma_f32_32x32x16_bf16 v[88:103], a[100:103], v[60:63], v[88:103]
    ds_read_b128 v[76:79], v8 offset:5120
    s_waitcnt lgkmcnt(3)
    v_mfma_f32_32x32x16_bf16 v[88:103], a[104:107], v[64:67], v[88:103]
    ds_read_b128 v[80:83], v8 offset:6144
    s_waitcnt lgkmcnt(3)
    v_mfma_f32_32x32x16_bf16 v[88:103], a[108:111], v[68:71], v[88:103]
    ds_read_b128 v[84:87], v8 offset:7168
    s_waitcnt lgkmcnt(3)
    v_mfma_f32_32x32x16_bf16 v[88:103], a[112:115], v[72:75], v[88:103]
    ds_read_b128 v[56:59], v8 offset:8192
    s_waitcnt lgkmcnt(3)
    v_mfma_f32_32x32x16_bf16 v[88:103], a[116:119], v[76:79], v[88:103]
    ds_read_b128 v[60:63], v8 offset:9216
    s_waitcnt lgkmcnt(3)
    v_mfma_f32_32x32x16_bf16 v[88:103], a[120:123], v[80:83], v[88:103]
    ds_read_b128 v[64:67], v8 offset:10240
    s_waitcnt lgkmcnt(3)
    v_mfma_f32_32x32x16_bf16 v[88:103], a[124:127], v[84:87], v[88:103]
    ds_read_b128 v[68:71], v8 offset:11264
    s_waitcnt lgkmcnt(3)
    v_mfma_f32_32x32x16_bf16 v[88:103], a[128:131], v[56:59], v[88:103]
    ds_read_b128 v[72:75], v8 offset:12288
    s_waitcnt lgkmcnt(3)
    v_mfma_f32_32x32x16_bf16 v[88:103], a[132:135], v[60:63], v[88:103]
    ds_read_b128 v[76:79], v8 offset:13312
    s_waitcnt lgkmcnt(3)
    v_mfma_f32_32x32x16_bf16 v[88:103], a[136:139], v[64:67], v[88:103]
    ds_read_b128 v[80:83], v8 offset:14336
    s_waitcnt lgkmcnt(3)
    v_mfma_f32_32x32x16_bf16 v[88:103], a[140:143], v[68:71], v[88:103]
    ds_read_b128 v[84:87], v8 offset:15360
    s_waitcnt lgkmcnt(3)
    v_mfma_f32_32x32x16_bf16 v[88:103], a[144:147], v[72:75], v[88:103]
    s_waitcnt lgkmcnt(2)
    v_mfma_f32_32x32x16_bf16 v[88:103], a[148:151], v[76:79], v[88:103]
    s_waitcnt vmcnt(10)
    s_barrier
    s_waitcnt lgkmcnt(1)
    v_mfma_f32_32x32x16_bf16 v[88:103], a[152:155], v[80:83], v[88:103]
    s_waitcnt lgkmcnt(0)
    v_mfma_f32_32x32x16_bf16 v[88:103], a[156:159], v[84:87], v[88:103]
    s_mul_i32 s55, s44, s58
    s_add_u32 s55, s55, s51
    s_xor_b32 s35, s44, s74
    s_and_b32 s35, s35, 2
    s_lshl_b32 s35, s35, 12
    s_add_u32 s55, s55, s35
    s_add_u32 s35, s55, s59
    s_add_u32 s49, s45, s61
    s_mov_b32 s44, s45
    s_nop 2
    v_pk_fma_f32 v[88:89], v[106:107], v[116:117], v[88:89] op_sel_hi:[0,1,1] neg_lo:[1,0,0] neg_hi:[1,0,0]
    s_nop 0
    v_pk_mul_f32 v[88:89], v[88:89], v[106:107] op_sel:[0,1]
    v_pk_fma_f32 v[90:91], v[106:107], v[118:119], v[90:91] op_sel_hi:[0,1,1] neg_lo:[1,0,0] neg_hi:[1,0,0]
    s_nop 0
    v_pk_mul_f32 v[90:91], v[90:91], v[106:107] op_sel:[0,1]
    v_pk_fma_f32 v[92:93], v[106:107], v[120:121], v[92:93] op_sel_hi:[0,1,1] neg_lo:[1,0,0] neg_hi:[1,0,0]
    s_nop 0
    v_pk_mul_f32 v[92:93], v[92:93], v[106:107] op_sel:[0,1]
    v_pk_fma_f32 v[94:95], v[106:107], v[122:123], v[94:95] op_sel_hi:[0,1,1] neg_lo:[1,0,0] neg_hi:[1,0,0]
    s_nop 0
    v_pk_mul_f32 v[94:95], v[94:95], v[106:107] op_sel:[0,1]
    v_pk_fma_f32 v[96:97], v[106:107], v[124:125], v[96:97] op_sel_hi:[0,1,1] neg_lo:[1,0,0] neg_hi:[1,0,0]
    s_nop 0
    v_pk_mul_f32 v[96:97], v[96:97], v[106:107] op_sel:[0,1]
    v_pk_fma_f32 v[98:99], v[106:107], v[126:127], v[98:99] op_sel_hi:[0,1,1] neg_lo:[1,0,0] neg_hi:[1,0,0]
    s_nop 0
    v_pk_mul_f32 v[98:99], v[98:99], v[106:107] op_sel:[0,1]
    v_pk_fma_f32 v[100:101], v[106:107], v[128:129], v[100:101] op_sel_hi:[0,1,1] neg_lo:[1,0,0] neg_hi:[1,0,0]
    s_nop 0
    v_pk_mul_f32 v[100:101], v[100:101], v[106:107] op_sel:[0,1]
    v_pk_fma_f32 v[102:103], v[106:107], v[130:131], v[102:103] op_sel_hi:[0,1,1] neg_lo:[1,0,0] neg_hi:[1,0,0]
    s_nop 0
    v_pk_mul_f32 v[102:103], v[102:103], v[106:107] op_sel:[0,1]
    v_cvt_pk_bf16_f32 v164, v88, v89
    v_cvt_pk_bf16_f32 v165, v90, v91
    v_cvt_pk_bf16_f32 v166, v92, v93
    v_cvt_pk_bf16_f32 v167, v94, v95
    v_cvt_pk_bf16_f32 v168, v96, v97
    v_cvt_pk_bf16_f32 v169, v98, v99
    v_cvt_pk_bf16_f32 v170, v100, v101
    v_cvt_pk_bf16_f32 v171, v102, v103
    buffer_store_dwordx4 v[164:167], v5, s[4:7], s55 offen sc1
    buffer_store_dwordx4 v[168:171], v5, s[4:7], s35 offen sc1
    s_mov_b64 exec, 1
    buffer_store_dword v172, off, s[4:7], s53 sc1
    s_mov_b64 exec, -1
    s_cmp_lt_u32 s44, s46
    s_cbranch_scc1 G1_332
G1_296:
    s_add_u32 s34, s61, 64
    s_cmp_ge_u32 s28, 128
    s_cselect_b32 s49, s34, s49
    v_mov_b32 v176, s49
    s_waitcnt vmcnt(0)
    s_barrier
    buffer_store_dword v176, off, s[4:7], s53 sc1
    s_waitcnt vmcnt(0) lgkmcnt(0)
    s_cmp_ge_u32 s28, 128
    s_cbranch_scc1 LAYER_262
    s_cmp_lg_u32 s68, 0
    s_cbranch_scc1 LAYER_261
    s_mov_b32 s68, 20
    s_mov_b32 s46, 64
    s_add_u32 s57, s57, 1
    s_branch LAYER_263
LAYER_262:
    s_sub_u32 s32, s28, 130
    s_cmp_ge_u32 s32, 60
    s_cbranch_scc1 LAYER_261
LAYER_266:
    s_cmp_lt_u32 s28, 64
    s_cselect_b32 s44, 3, 8
    s_cselect_b32 s46, 21, 64
    s_add_u32 s44, s44, s66
    s_mov_b32 s47, 6
    s_mul_i32 s50, s30, 3145728
    s_add_u32 s50, s50, 27262976
    s_mul_i32 s34, s29, 10240
    s_add_u32 s50, s50, s34
    s_mul_i32 s51, s30, 6291456
    s_add_u32 s51, s51, 11534336
    s_lshl_b32 s34, s67, 12
    s_add_u32 s51, s51, s34
    s_add_u32 s52, s34, 14680064
    s_mov_b32 s58, 40960
    v_bfe_u32 v2, v1, 5, 1
    v_mul_u32_u24 v2, 512, v2
    v_bfe_u32 v172, v1, 2, 2
    v_lshl_add_u32 v2, v172, 6, v2
    v_bfe_u32 v172, v1, 4, 1
    v_lshl_add_u32 v2, v172, 5, v2
    v_bfe_u32 v172, v1, 0, 1
    v_lshl_add_u32 v2, v172, 4, v2
    v_bfe_u32 v172, v1, 1, 1
    v_lshl_add_u32 v2, v172, 3, v2
    v_add_u32 v2, s60, v2
    s_lshl_b32 s34, s29, 13
    v_add_u32 v4, s34, v0
    s_lshl_b32 s34, s29, 3
    s_add_u32 s34, s34, 65536
    v_bfe_u32 v5, v1, 0, 5
    v_mul_u32_u24 v5, 32, v5
    v_add_u32 v5, s34, v5
    s_lshl_b32 s35, s29, 11
    s_lshl_b32 s36, s29, 8
    s_add_u32 s36, s36, 67584
    v_add_u32 v3, s35, v0
    s_lshl_b32 s34, s29, 10
    v_add_u32 v7, s34, v0
    v_bfe_u32 v6, v1, 0, 5
    v_mul_u32_u24 v6, 32, v6
    v_add_u32 v6, 65536, v6
    s_lshl_b32 s34, s29, 5
    v_bfe_u32 v8, v1, 0, 2
    v_mul_u32_u24 v8, 1280, v8
    v_bfe_u32 v172, v1, 2, 1
    v_mul_u32_u24 v172, 10240, v172
    v_add_u32 v8, v8, v172
    v_bfe_u32 v172, v1, 3, 1
    v_mul_u32_u24 v172, 5120, v172
    v_add_u32 v8, v8, v172
    v_bfe_u32 v172, v1, 4, 1
    v_mul_u32_u24 v172, 20480, v172
    v_add_u32 v8, v8, v172
    v_bfe_u32 v172, v1, 5, 1
    v_lshl_add_u32 v8, v172, 4, v8
    v_add_u32 v8, s34, v8
    s_cmp_lg_u32 s30, 0
    s_cbranch_scc1 F3_333
    s_lshl_b32 s52, s67, 7
    s_mov_b64 s[16:17], s[76:77]
    s_mov_b32 s18, 2621440
    s_mov_b32 s19, 0x20000
    s_branch F3_334
F3_333:
    v_mov_b32 v8, v7
    s_mov_b64 s[16:17], s[100:101]
    s_mov_b32 s18, 268435456
    s_mov_b32 s19, 0x20000
F3_334:
    s_add_u32 s57, s30, 1
    s_mul_i32 s37, s29, 40
    v_min_u32 v176, 39, v1
    v_lshlrev_b32 v176, 7, v176
    s_lshl_b32 s32, s37, 7
    s_add_u32 s32, s32, 1097728
    s_mov_b32 s48, 0
P_335:
    buffer_load_dword v172, v176, s[4:7], s32 offen sc1
    s_waitcnt vmcnt(0)
    v_cmp_gt_u32 vcc, s57, v172
    s_cbranch_vccz P_336
    s_add_u32 s48, s48, 1
    s_cmp_gt_u32 s48, 200000
    s_cbranch_scc1 L_end
    s_sleep 1
    s_branch P_335
P_336:
    s_mul_i32 s54, s44, 40960
    s_add_u32 s56, s54, s52
    s_add_u32 s54, s54, s50
    s_waitcnt vmcnt(0) lgkmcnt(0)
    s_add_u32 m0, s60, 0
    s_nop 0
    buffer_load_dwordx4 v0, s[4:7], s54 offen offset:0 sc1 lds
    buffer_load_dwordx4 v0, s[4:7], s54 offen offset:1024 sc1 lds
    buffer_load_dwordx4 v0, s[4:7], s54 offen offset:2048 sc1 lds
    buffer_load_dwordx4 v0, s[4:7], s54 offen offset:3072 sc1 lds
    s_add_u32 s54, s54, 4096
    s_add_u32 m0, s60, 4096
    s_nop 0
    buffer_load_dwordx4 v0, s[4:7], s54 offen offset:0 sc1 lds
    buffer_load_dwordx4 v0, s[4:7], s54 offen offset:1024 sc1 lds
    buffer_load_dwordx4 v0, s[4:7], s54 offen offset:2048 sc1 lds
    buffer_load_dwordx4 v0, s[4:7], s54 offen offset:3072 sc1 lds
    s_add_u32 s54, s54, 4096
    s_add_u32 m0, s60, 8192
    s_nop 0
    buffer_load_dwordx4 v0, s[4:7], s54 offen offset:0 sc1 lds
    buffer_load_dwordx4 v0, s[4:7], s54 offen offset:1024 sc1 lds
    buffer_load_dwordx4 v[164:167], v8, s[16:19], s56 offen sc1
    s_add_u32 s45, s44, s47
    s_mul_i32 s54, s45, 40960
    s_add_u32 s56, s54, s52
    s_add_u32 s54, s54, s50
    s_waitcnt vmcnt(0)
    ds_read_b64_tr_b16 v[16:17], v2 offset:0
    ds_read_b64_tr_b16 v[18:19], v2 offset:256
    ds_read_b64_tr_b16 v[20:21], v2 offset:1024
    ds_read_b64_tr_b16 v[22:23], v2 offset:1280
    ds_read_b64_tr_b16 v[24:25], v2 offset:2048
    ds_read_b64_tr_b16 v[26:27], v2 offset:2304
    ds_read_b64_tr_b16 v[28:29], v2 offset:3072
    ds_read_b64_tr_b16 v[30:31], v2 offset:3328
    ds_read_b64_tr_b16 v[32:33], v2 offset:4096
    ds_read_b64_tr_b16 v[34:35], v2 offset:4352
    ds_read_b64_tr_b16 v[36:37], v2 offset:5120
    ds_read_b64_tr_b16 v[38:39], v2 offset:5376
    ds_read_b64_tr_b16 v[40:41], v2 offset:6144
    ds_read_b64_tr_b16 v[42:43], v2 offset:6400
    ds_read_b64_tr_b16 v[44:45], v2 offset:7168
    ds_read_b64_tr_b16 v[46:47], v2 offset:7424
    ds_read_b64_tr_b16 v[48:49], v2 offset:8192
    ds_read_b64_tr_b16 v[50:51], v2 offset:8448
    ds_read_b64_tr_b16 v[52:53], v2 offset:9216
    ds_read_b64_tr_b16 v[54:55], v2 offset:9472
    s_waitcnt lgkmcnt(15)
    v_mfma_f32_32x32x16_bf16 v[96:111], a[160:163], v[16:19], 0
    v_mfma_f32_32x32x16_bf16 v[96:111], a[164:167], v[20:23], v[96:111]
    s_waitcnt lgkmcnt(14)
    v_mfma_f32_32x32x16_bf16 v[96:111], a[168:171], v[24:27], v[96:111]
    s_waitcnt lgkmcnt(12)
    v_mfma_f32_32x32x16_bf16 v[96:111], a[172:175], v[28:31], v[96:111]
    s_waitcnt lgkmcnt(10)
    v_mfma_f32_32x32x16_bf16 v[96:111], a[176:179], v[32:35], v[96:111]
    s_waitcnt lgkmcnt(8)
    v_mfma_f32_32x32x16_bf16 v[96:111], a[180:183], v[36:39], v[96:111]
    s_waitcnt lgkmcnt(6)
    v_mfma_f32_32x32x16_bf16 v[96:111], a[184:187], v[40:43], v[96:111]
    s_waitcnt lgkmcnt(4)
    v_mfma_f32_32x32x16_bf16 v[96:111], a[188:191], v[44:47], v[96:111]
    s_waitcnt lgkmcnt(2)
    v_mfma_f32_32x32x16_bf16 v[96:111], a[192:195], v[48:51], v[96:111]
    s_add_u32 m0, s60, 10240
    s_nop 0
    buffer_load_dwordx4 v0, s[4:7], s54 offen offset:0 sc1 lds
    s_waitcnt lgkmcnt(0)
    v_mfma_f32_32x32x16_bf16 v[96:111], a[196:199], v[52:55], v[96:111]
    buffer_load_dwordx4 v0, s[4:7], s54 offen offset:1024 sc1 lds
    v_mfma_f32_32x32x16_bf16 v[112:127], a[200:203], v[16:19], 0
    buffer_load_dwordx4 v0, s[4:7], s54 offen offset:2048 sc1 lds
    v_mfma_f32_32x32x16_bf16 v[112:127], a[204:207], v[20:23], v[112:127]
    buffer_load_dwordx4 v0, s[4:7], s54 offen offset:3072 sc1 lds
    v_mfma_f32_32x32x16_bf16 v[112:127], a[208:211], v[24:27], v[112:127]
    s_add_u32 s54, s54, 4096
    s_add_u32 m0, s60, 14336
    s_nop 0
    buffer_load_dwordx4 v0, s[4:7], s54 offen offset:0 sc1 lds
    v_mfma_f32_32x32x16_bf16 v[112:127], a[212:215], v[28:31], v[112:127]
    buffer_load_dwordx4 v0, s[4:7], s54 offen offset:1024 sc1 lds
    v_mfma_f32_32x32x16_bf16 v[112:127], a[216:219], v[32:35], v[112:127]
    buffer_load_dwordx4 v0, s[4:7], s54 offen offset:2048 sc1 lds
    v_mfma_f32_32x32x16_bf16 v[112:127], a[220:223], v[36:39], v[112:127]
    buffer_load_dwordx4 v0, s[4:7], s54 offen offset:3072 sc1 lds
    v_mfma_f32_32x32x16_bf16 v[112:127], a[224:227], v[40:43], v[112:127]
    s_add_u32 s54, s54, 4096
    s_add_u32 m0, s60, 18432
    s_nop 0
    buffer_load_dwordx4 v0, s[4:7], s54 offen offset:0 sc1 lds
    ds_write_b128 v4, v[96:99] offset:0
    v_mfma_f32_32x32x16_bf16 v[112:127], a[228:231], v[44:47], v[112:127]
    buffer_load_dwordx4 v0, s[4:7], s54 offen offset:1024 sc1 lds
    ds_write_b128 v4, v[100:103] offset:1024
    v_mfma_f32_32x32x16_bf16 v[112:127], a[232:235], v[48:51], v[112:127]
    ds_write_b128 v4, v[104:107] offset:2048
    v_mfma_f32_32x32x16_bf16 v[112:127], a[236:239], v[52:55], v[112:127]
    ds_write_b128 v4, v[108:111] offset:3072
    s_mov_b32 s59, 1073741824
    s_mul_i32 s55, s44, s58
    s_add_u32 s55, s55, s51
    buffer_load_dwordx4 v[168:171], v8, s[16:19], s56 offen sc1
G_337:
    s_mov_b32 s44, s45
    s_add_u32 s45, s44, s47
    s_cmp_lt_u32 s45, s46
    s_cbranch_scc0 G_340
    s_mul_i32 s54, s45, 40960
    s_add_u32 s56, s54, s52
    s_add_u32 s54, s54, s50
    s_waitcnt vmcnt(0)
    ds_read_b64_tr_b16 v[56:57], v2 offset:10240
    ds_read_b64_tr_b16 v[58:59], v2 offset:10496
    ds_read_b64_tr_b16 v[60:61], v2 offset:11264
    ds_read_b64_tr_b16 v[62:63], v2 offset:11520
    ds_read_b64_tr_b16 v[64:65], v2 offset:12288
    ds_read_b64_tr_b16 v[66:67], v2 offset:12544
    ds_read_b64_tr_b16 v[68:69], v2 offset:13312
    ds_read_b64_tr_b16 v[70:71], v2 offset:13568
    ds_read_b64_tr_b16 v[72:73], v2 offset:14336
    ds_read_b64_tr_b16 v[74:75], v2 offset:14592
    ds_read_b64_tr_b16 v[76:77], v2 offset:15360
    ds_read_b64_tr_b16 v[78:79], v2 offset:15616
    ds_read_b64_tr_b16 v[80:81], v2 offset:16384
    ds_read_b64_tr_b16 v[82:83], v2 offset:16640
    ds_read_b64_tr_b16 v[84:85], v2 offset:17408
    ds_read_b64_tr_b16 v[86:87], v2 offset:17664
    ds_read_b64_tr_b16 v[88:89], v2 offset:18432
    ds_read_b64_tr_b16 v[90:91], v2 offset:18688
    ds_read_b64_tr_b16 v[92:93], v2 offset:19456
    ds_read_b64_tr_b16 v[94:95], v2 offset:19712
    s_waitcnt lgkmcnt(15)
    v_mfma_f32_32x32x16_bf16 v[96:111], a[160:163], v[56:59], 0
    ds_write_b128 v4, v[112:115] offset:4096
    v_mfma_f32_32x32x16_bf16 v[96:111], a[164:167], v[60:63], v[96:111]
    ds_write_b128 v4, v[116:119] offset:5120
    s_waitcnt lgkmcnt(15)
    v_mfma_f32_32x32x16_bf16 v[96:111], a[168:171], v[64:67], v[96:111]
    ds_write_b128 v4, v[120:123] offset:6144
    s_waitcnt lgkmcnt(15)
    v_mfma_f32_32x32x16_bf16 v[96:111], a[172:175], v[68:71], v[96:111]
    ds_write_b128 v4, v[124:127] offset:7168
    s_waitcnt lgkmcnt(14)
    v_mfma_f32_32x32x16_bf16 v[96:111], a[176:179], v[72:75], v[96:111]
    s_waitcnt lgkmcnt(12)
    v_mfma_f32_32x32x16_bf16 v[96:111], a[180:183], v[76:79], v[96:111]
    s_waitcnt lgkmcnt(0)
    s_barrier
    buffer_store_dwordx4 v[172:175], v7, s[4:7], s59 offen sc1
    v_mfma_f32_32x32x16_bf16 v[96:111], a[184:187], v[80:83], v[96:111]
    ds_read_b128 v[184:187], v3 offset:0
    ds_read_b128 v[188:191], v3 offset:1024
    ds_read_b128 v[192:195], v3 offset:8192
    ds_read_b128 v[196:199], v3 offset:9216
    v_mfma_f32_32x32x16_bf16 v[96:111], a[188:191], v[84:87], v[96:111]
    ds_read_b128 v[200:203], v3 offset:16384
    ds_read_b128 v[204:207], v3 offset:17408
    ds_read_b128 v[208:211], v3 offset:24576
    ds_read_b128 v[212:215], v3 offset:25600
    v_mfma_f32_32x32x16_bf16 v[96:111], a[192:195], v[88:91], v[96:111]
    s_add_u32 m0, s60, 0
    s_nop 0
    buffer_load_dwordx4 v0, s[4:7], s54 offen offset:0 sc1 lds
    v_mfma_f32_32x32x16_bf16 v[96:111], a[196:199], v[92:95], v[96:111]
    buffer_load_dwordx4 v0, s[4:7], s54 offen offset:1024 sc1 lds
    v_mfma_f32_32x32x16_bf16 v[112:127], a[200:203], v[56:59], 0
    buffer_load_dwordx4 v0, s[4:7], s54 offen offset:2048 sc1 lds
    s_waitcnt lgkmcnt(5)
    v_add_f32 v184, v184, v192
    v_add_f32 v185, v185, v193
    v_add_f32 v186, v186, v194
    v_add_f32 v187, v187, v195
    s_waitcnt lgkmcnt(4)
    v_add_f32 v188, v188, v196
    v_add_f32 v189, v189, v197
    v_mfma_f32_32x32x16_bf16 v[112:127], a[204:207], v[60:63], v[112:127]
    buffer_load_dwordx4 v0, s[4:7], s54 offen offset:3072 sc1 lds
    v_add_f32 v190, v190, v198
    v_add_f32 v191, v191, v199
    s_waitcnt lgkmcnt(3)
    v_add_f32 v184, v184, v200
    v_add_f32 v185, v185, v201
    v_add_f32 v186, v186, v202
    v_add_f32 v187, v187, v203
    v_mfma_f32_32x32x16_bf16 v[112:127], a[208:211], v[64:67], v[112:127]
    s_add_u32 s54, s54, 4096
    s_add_u32 m0, s60, 4096
    s_nop 0
    buffer_load_dwordx4 v0, s[4:7], s54 offen offset:0 sc1 lds
    s_waitcnt lgkmcnt(2)
    v_add_f32 v188, v188, v204
    v_add_f32 v189, v189, v205
    v_add_f32 v190, v190, v206
    v_add_f32 v191, v191, v207
    s_waitcnt lgkmcnt(1)
    v_add_f32 v184, v184, v208
    v_add_f32 v185, v185, v209
    v_mfma_f32_32x32x16_bf16 v[112:127], a[212:215], v[68:71], v[112:127]
    buffer_load_dwordx4 v0, s[4:7], s54 offen offset:1024 sc1 lds
    v_add_f32 v186, v186, v210
    v_add_f32 v187, v187, v211
    s_waitcnt lgkmcnt(0)
    v_add_f32 v188, v188, v212
    v_add_f32 v189, v189, v213
    v_add_f32 v190, v190, v214
    v_add_f32 v191, v191, v215
    v_mfma_f32_32x32x16_bf16 v[112:127], a[216:219], v[72:75], v[112:127]
    buffer_load_dwordx4 v0, s[4:7], s54 offen offset:2048 sc1 lds
    v_cvt_pk_bf16_f32 v172, v184, v185
    v_cvt_pk_bf16_f32 v173, v186, v187
    v_cvt_pk_bf16_f32 v174, v188, v189
    v_cvt_pk_bf16_f32 v175, v190, v191
    v_lshlrev_b32 v184, 16, v172
    v_lshlrev_b32 v185, 16, v164
    v_mfma_f32_32x32x16_bf16 v[112:127], a[220:223], v[76:79], v[112:127]
    buffer_load_dwordx4 v0, s[4:7], s54 offen offset:3072 sc1 lds
    v_and_b32 v186, 0xffff0000, v172
    v_and_b32 v187, 0xffff0000, v164
    v_add_f32 v184, v184, v185
    v_add_f32 v186, v186, v187
    v_cvt_pk_bf16_f32 v172, v184, v186
    v_lshlrev_b32 v184, 16, v173
    v_mfma_f32_32x32x16_bf16 v[112:127], a[224:227], v[80:83], v[112:127]
    s_add_u32 s54, s54, 4096
    s_add_u32 m0, s60, 8192
    s_nop 0
    buffer_load_dwordx4 v0, s[4:7], s54 offen offset:0 sc1 lds
    ds_write_b128 v4, v[96:99] offset:32768
    v_lshlrev_b32 v185, 16, v165
    v_and_b32 v186, 0xffff0000, v173
    v_and_b32 v187, 0xffff0000, v165
    v_add_f32 v184, v184, v185
    v_add_f32 v186, v186, v187
    v_cvt_pk_bf16_f32 v173, v184, v186
    v_mfma_f32_32x32x16_bf16 v[112:127], a[228:231], v[84:87], v[112:127]
    buffer_load_dwordx4 v0, s[4:7], s54 offen offset:1024 sc1 lds
    ds_write_b128 v4, v[100:103] offset:33792
    v_lshlrev_b32 v184, 16, v174
    v_lshlrev_b32 v185, 16, v166
    v_and_b32 v186, 0xffff0000, v174
    v_and_b32 v187, 0xffff0000, v166
    v_add_f32 v184, v184, v185
    v_add_f32 v186, v186, v187
    v_mfma_f32_32x32x16_bf16 v[112:127], a[232:235], v[88:91], v[112:127]
    ds_write_b128 v4, v[104:107] offset:34816
    v_cvt_pk_bf16_f32 v174, v184, v186
    v_lshlrev_b32 v184, 16, v175
    v_lshlrev_b32 v185, 16, v167
    v_and_b32 v186, 0xffff0000, v175
    v_and_b32 v187, 0xffff0000, v167
    v_add_f32 v184, v184, v185
    v_mfma_f32_32x32x16_bf16 v[112:127], a[236:239], v[92:95], v[112:127]
    ds_write_b128 v4, v[108:111] offset:35840
    v_add_f32 v186, v186, v187
    v_cvt_pk_bf16_f32 v175, v184, v186
    s_mov_b32 s59, s55
    s_mul_i32 s55, s44, s58
    s_add_u32 s55, s55, s51
    buffer_load_dwordx4 v[164:167], v8, s[16:19], s56 offen sc1
    s_mov_b32 s44, s45
    s_add_u32 s45, s44, s47
    s_cmp_lt_u32 s45, s46
    s_cbranch_scc0 G_339
    s_mul_i32 s54, s45, 40960
    s_add_u32 s56, s54, s52
    s_add_u32 s54, s54, s50
    s_waitcnt vmcnt(0)
    ds_read_b64_tr_b16 v[16:17], v2 offset:0
    ds_read_b64_tr_b16 v[18:19], v2 offset:256
    ds_read_b64_tr_b16 v[20:21], v2 offset:1024
    ds_read_b64_tr_b16 v[22:23], v2 offset:1280
    ds_read_b64_tr_b16 v[24:25], v2 offset:2048
    ds_read_b64_tr_b16 v[26:27], v2 offset:2304
    ds_read_b64_tr_b16 v[28:29], v2 offset:3072
    ds_read_b64_tr_b16 v[30:31], v2 offset:3328
    ds_read_b64_tr_b16 v[32:33], v2 offset:4096
    ds_read_b64_tr_b16 v[34:35], v2 offset:4352
    ds_read_b64_tr_b16 v[36:37], v2 offset:5120
    ds_read_b64_tr_b16 v[38:39], v2 offset:5376
    ds_read_b64_tr_b16 v[40:41], v2 offset:6144
    ds_read_b64_tr_b16 v[42:43], v2 offset:6400
    ds_read_b64_tr_b16 v[44:45], v2 offset:7168
    ds_read_b64_tr_b16 v[46:47], v2 offset:7424
    ds_read_b64_tr_b16 v[48:49], v2 offset:8192
    ds_read_b64_tr_b16 v[50:51], v2 offset:8448
    ds_read_b64_tr_b16 v[52:53], v2 offset:9216
    ds_read_b64_tr_b16 v[54:55], v2 offset:9472
    s_waitcnt lgkmcnt(15)
    v_mfma_f32_32x32x16_bf16 v[96:111], a[160:163], v[16:19], 0
    ds_write_b128 v4, v[112:115] offset:36864
    v_mfma_f32_32x32x16_bf16 v[96:111], a[164:167], v[20:23], v[96:111]
    ds_write_b128 v4, v[116:119] offset:37888
    s_waitcnt lgkmcnt(15)
    v_mfma_f32_32x32x16_bf16 v[96:111], a[168:171], v[24:27], v[96:111]
    ds_write_b128 v4, v[120:123] offset:38912
    s_waitcnt lgkmcnt(15)
    v_mfma_f32_32x32x16_bf16 v[96:111], a[172:175], v[28:31], v[96:111]
    ds_write_b128 v4, v[124:127] offset:39936
    s_waitcnt lgkmcnt(14)
    v_mfma_f32_32x32x16_bf16 v[96:111], a[176:179], v[32:35], v[96:111]
    s_waitcnt lgkmcnt(12)
    v_mfma_f32_32x32x16_bf16 v[96:111], a[180:183], v[36:39], v[96:111]
    s_waitcnt lgkmcnt(0)
    s_barrier
    buffer_store_dwordx4 v[172:175], v7, s[4:7], s59 offen sc1
    v_mfma_f32_32x32x16_bf16 v[96:111], a[184:187], v[40:43], v[96:111]
    ds_read_b128 v[184:187], v3 offset:32768
    ds_read_b128 v[188:191], v3 offset:33792
    ds_read_b128 v[192:195], v3 offset:40960
    ds_read_b128 v[196:199], v3 offset:41984
    v_mfma_f32_32x32x16_bf16 v[96:111], a[188:191], v[44:47], v[96:111]
    ds_read_b128 v[200:203], v3 offset:49152
    ds_read_b128 v[204:207], v3 offset:50176
    ds_read_b128 v[208:211], v3 offset:57344
    ds_read_b128 v[212:215], v3 offset:58368
    v_mfma_f32_32x32x16_bf16 v[96:111], a[192:195], v[48:51], v[96:111]
    s_add_u32 m0, s60, 10240
    s_nop 0
    buffer_load_dwordx4 v0, s[4:7], s54 offen offset:0 sc1 lds
    v_mfma_f32_32x32x16_bf16 v[96:111], a[196:199], v[52:55], v[96:111]
    buffer_load_dwordx4 v0, s[4:7], s54 offen offset:1024 sc1 lds
    v_mfma_f32_32x32x16_bf16 v[112:127], a[200:203], v[16:19], 0
    buffer_load_dwordx4 v0, s[4:7], s54 offen offset:2048 sc1 lds
    s_waitcnt lgkmcnt(5)
    v_add_f32 v184, v184, v192
    v_add_f32 v185, v185, v193
    v_add_f32 v186, v186, v194
    v_add_f32 v187, v187, v195
    s_waitcnt lgkmcnt(4)
    v_add_f32 v188, v188, v196
    v_add_f32 v189, v189, v197
    v_mfma_f32_32x32x16_bf16 v[112:127], a[204:207], v[20:23], v[112:127]
    buffer_load_dwordx4 v0, s[4:7], s54 offen offset:3072 sc1 lds
    v_add_f32 v190, v190, v198
    v_add_f32 v191, v191, v199
    s_waitcnt lgkmcnt(3)
    v_add_f32 v184, v184, v200
    v_add_f32 v185, v185, v201
    v_add_f32 v186, v186, v202
    v_add_f32 v187, v187, v203
    v_mfma_f32_32x32x16_bf16 v[112:127], a[208:211], v[24:27], v[112:127]
    s_add_u32 s54, s54, 4096
    s_add_u32 m0, s60, 14336
    s_nop 0
    buffer_load_dwordx4 v0, s[4:7], s54 offen offset:0 sc1 lds
    s_waitcnt lgkmcnt(2)
    v_add_f32 v188, v188, v204
    v_add_f32 v189, v189, v205
    v_add_f32 v190, v190, v206
    v_add_f32 v191, v191, v207
    s_waitcnt lgkmcnt(1)
    v_add_f32 v184, v184, v208
    v_add_f32 v185, v185, v209
    v_mfma_f32_32x32x16_bf16 v[112:127], a[212:215], v[28:31], v[112:127]
    buffer_load_dwordx4 v0, s[4:7], s54 offen offset:1024 sc1 lds
    v_add_f32 v186, v186, v210
    v_add_f32 v187, v187, v211
    s_waitcnt lgkmcnt(0)
    v_add_f32 v188, v188, v212
    v_add_f32 v189, v189, v213
    v_add_f32 v190, v190, v214
    v_add_f32 v191, v191, v215
    v_mfma_f32_32x32x16_bf16 v[112:127], a[216:219], v[32:35], v[112:127]
    buffer_load_dwordx4 v0, s[4:7], s54 offen offset:2048 sc1 lds
    v_cvt_pk_bf16_f32 v172, v184, v185
    v_cvt_pk_bf16_f32 v173, v186, v187
    v_cvt_pk_bf16_f32 v174, v188, v189
    v_cvt_pk_bf16_f32 v175, v190, v191
    v_lshlrev_b32 v184, 16, v172
    v_lshlrev_b32 v185, 16, v168
    v_mfma_f32_32x32x16_bf16 v[112:127], a[220:223], v[36:39], v[112:127]
    buffer_load_dwordx4 v0, s[4:7], s54 offen offset:3072 sc1 lds
    v_and_b32 v186, 0xffff0000, v172
    v_and_b32 v187, 0xffff0000, v168
    v_add_f32 v184, v184, v185
    v_add_f32 v186, v186, v187
    v_cvt_pk_bf16_f32 v172, v184, v186
    v_lshlrev_b32 v184, 16, v173
    v_mfma_f32_32x32x16_bf16 v[112:127], a[224:227], v[40:43], v[112:127]
    s_add_u32 s54, s54, 4096
    s_add_u32 m0, s60, 18432
    s_nop 0
    buffer_load_dwordx4 v0, s[4:7], s54 offen offset:0 sc1 lds
    ds_write_b128 v4, v[96:99] offset:0
    v_lshlrev_b32 v185, 16, v169
    v_and_b32 v186, 0xffff0000, v173
    v_and_b32 v187, 0xffff0000, v169
    v_add_f32 v184, v184, v185
    v_add_f32 v186, v186, v187
    v_cvt_pk_bf16_f32 v173, v184, v186
    v_mfma_f32_32x32x16_bf16 v[112:127], a[228:231], v[44:47], v[112:127]
    buffer_load_dwordx4 v0, s[4:7], s54 offen offset:1024 sc1 lds
    ds_write_b128 v4, v[100:103] offset:1024
    v_lshlrev_b32 v184, 16, v174
    v_lshlrev_b32 v185, 16, v170
    v_and_b32 v186, 0xffff0000, v174
    v_and_b32 v187, 0xffff0000, v170
    v_add_f32 v184, v184, v185
    v_add_f32 v186, v186, v187
    v_mfma_f32_32x32x16_bf16 v[112:127], a[232:235], v[48:51], v[112:127]
    ds_write_b128 v4, v[104:107] offset:2048
    v_cvt_pk_bf16_f32 v174, v184, v186
    v_lshlrev_b32 v184, 16, v175
    v_lshlrev_b32 v185, 16, v171
    v_and_b32 v186, 0xffff0000, v175
    v_and_b32 v187, 0xffff0000, v171
    v_add_f32 v184, v184, v185
    v_mfma_f32_32x32x16_bf16 v[112:127], a[236:239], v[52:55], v[112:127]
    ds_write_b128 v4, v[108:111] offset:3072
    v_add_f32 v186, v186, v187
    v_cvt_pk_bf16_f32 v175, v184, v186
    s_mov_b32 s59, s55
    s_mul_i32 s55, s44, s58
    s_add_u32 s55, s55, s51
    buffer_load_dwordx4 v[168:171], v8, s[16:19], s56 offen sc1
    s_branch G_337
G_340:
    s_waitcnt vmcnt(0)
    ds_read_b64_tr_b16 v[56:57], v2 offset:10240
    ds_read_b64_tr_b16 v[58:59], v2 offset:10496
    ds_read_b64_tr_b16 v[60:61], v2 offset:11264
    ds_read_b64_tr_b16 v[62:63], v2 offset:11520
    ds_read_b64_tr_b16 v[64:65], v2 offset:12288
    ds_read_b64_tr_b16 v[66:67], v2 offset:12544
    ds_read_b64_tr_b16 v[68:69], v2 offset:13312
    ds_read_b64_tr_b16 v[70:71], v2 offset:13568
    ds_read_b64_tr_b16 v[72:73], v2 offset:14336
    ds_read_b64_tr_b16 v[74:75], v2 offset:14592
    ds_read_b64_tr_b16 v[76:77], v2 offset:15360
    ds_read_b64_tr_b16 v[78:79], v2 offset:15616
    ds_read_b64_tr_b16 v[80:81], v2 offset:16384
    ds_read_b64_tr_b16 v[82:83], v2 offset:16640
    ds_read_b64_tr_b16 v[84:85], v2 offset:17408
    ds_read_b64_tr_b16 v[86:87], v2 offset:17664
    ds_read_b64_tr_b16 v[88:89], v2 offset:18432
    ds_read_b64_tr_b16 v[90:91], v2 offset:18688
    ds_read_b64_tr_b16 v[92:93], v2 offset:19456
    ds_read_b64_tr_b16 v[94:95], v2 offset:19712
    s_waitcnt lgkmcnt(15)
    v_mfma_f32_32x32x16_bf16 v[96:111], a[160:163], v[56:59], 0
    ds_write_b128 v4, v[112:115] offset:4096
    v_mfma_f32_32x32x16_bf16 v[96:111], a[164:167], v[60:63], v[96:111]
    ds_write_b128 v4, v[116:119] offset:5120
    s_waitcnt lgkmcnt(15)
    v_mfma_f32_32x32x16_bf16 v[96:111], a[168:171], v[64:67], v[96:111]
    ds_write_b128 v4, v[120:123] offset:6144
    s_waitcnt lgkmcnt(15)
    v_mfma_f32_32x32x16_bf16 v[96:111], a[172:175], v[68:71], v[96:111]
    ds_write_b128 v4, v[124:127] offset:7168
    s_waitcnt lgkmcnt(14)
    v_mfma_f32_32x32x16_bf16 v[96:111], a[176:179], v[72:75], v[96:111]
    s_waitcnt lgkmcnt(12)
    v_mfma_f32_32x32x16_bf16 v[96:111], a[180:183], v[76:79], v[96:111]
    s_waitcnt lgkmcnt(0)
    s_barrier
    buffer_store_dwordx4 v[172:175], v7, s[4:7], s59 offen sc1
    v_mfma_f32_32x32x16_bf16 v[96:111], a[184:187], v[80:83], v[96:111]
    ds_read_b128 v[184:187], v3 offset:0
    ds_read_b128 v[188:191], v3 offset:1024
    ds_read_b128 v[192:195], v3 offset:8192
    ds_read_b128 v[196:199], v3 offset:9216
    v_mfma_f32_32x32x16_bf16 v[96:111], a[188:191], v[84:87], v[96:111]
    ds_read_b128 v[200:203], v3 offset:16384
    ds_read_b128 v[204:207], v3 offset:17408
    ds_read_b128 v[208:211], v3 offset:24576
    ds_read_b128 v[212:215], v3 offset:25600
    v_mfma_f32_32x32x16_bf16 v[96:111], a[192:195], v[88:91], v[96:111]
    v_mfma_f32_32x32x16_bf16 v[96:111], a[196:199], v[92:95], v[96:111]
    v_mfma_f32_32x32x16_bf16 v[112:127], a[200:203], v[56:59], 0
    s_waitcnt lgkmcnt(5)
    v_add_f32 v184, v184, v192
    v_add_f32 v185, v185, v193
    v_add_f32 v186, v186, v194
    v_add_f32 v187, v187, v195
    s_waitcnt lgkmcnt(4)
    v_add_f32 v188, v188, v196
    v_add_f32 v189, v189, v197
    v_mfma_f32_32x32x16_bf16 v[112:127], a[204:207], v[60:63], v[112:127]
    v_add_f32 v190, v190, v198
    v_add_f32 v191, v191, v199
    s_waitcnt lgkmcnt(3)
    v_add_f32 v184, v184, v200
    v_add_f32 v185, v185, v201
    v_add_f32 v186, v186, v202
    v_add_f32 v187, v187, v203
    v_mfma_f32_32x32x16_bf16 v[112:127], a[208:211], v[64:67], v[112:127]
    s_waitcnt lgkmcnt(2)
    v_add_f32 v188, v188, v204
    v_add_f32 v189, v189, v205
    v_add_f32 v190, v190, v206
    v_add_f32 v191, v191, v207
    s_waitcnt lgkmcnt(1)
    v_add_f32 v184, v184, v208
    v_add_f32 v185, v185, v209
    v_mfma_f32_32x32x16_bf16 v[112:127], a[212:215], v[68:71], v[112:127]
    v_add_f32 v186, v186, v210
    v_add_f32 v187, v187, v211
    s_waitcnt lgkmcnt(0)
    v_add_f32 v188, v188, v212
    v_add_f32 v189, v189, v213
    v_add_f32 v190, v190, v214
    v_add_f32 v191, v191, v215
    v_mfma_f32_32x32x16_bf16 v[112:127], a[216:219], v[72:75], v[112:127]
    v_cvt_pk_bf16_f32 v172, v184, v185
    v_cvt_pk_bf16_f32 v173, v186, v187
    v_cvt_pk_bf16_f32 v174, v188, v189
    v_cvt_pk_bf16_f32 v175, v190, v191
    v_lshlrev_b32 v184, 16, v172
    v_lshlrev_b32 v185, 16, v164
    v_mfma_f32_32x32x16_bf16 v[112:127], a[220:223], v[76:79], v[112:127]
    v_and_b32 v186, 0xffff0000, v172
    v_and_b32 v187, 0xffff0000, v164
    v_add_f32 v184, v184, v185
    v_add_f32 v186, v186, v187
    v_cvt_pk_bf16_f32 v172, v184, v186
    v_lshlrev_b32 v184, 16, v173
    v_mfma_f32_32x32x16_bf16 v[112:127], a[224:227], v[80:83], v[112:127]
    ds_write_b128 v4, v[96:99] offset:32768
    v_lshlrev_b32 v185, 16, v165
    v_and_b32 v186, 0xffff0000, v173
    v_and_b32 v187, 0xffff0000, v165
    v_add_f32 v184, v184, v185
    v_add_f32 v186, v186, v187
    v_cvt_pk_bf16_f32 v173, v184, v186
    v_mfma_f32_32x32x16_bf16 v[112:127], a[228:231], v[84:87], v[112:127]
    ds_write_b128 v4, v[100:103] offset:33792
    v_lshlrev_b32 v184, 16, v174
    v_lshlrev_b32 v185, 16, v166
    v_and_b32 v186, 0xffff0000, v174
    v_and_b32 v187, 0xffff0000, v166
    v_add_f32 v184, v184, v185
    v_add_f32 v186, v186, v187
    v_mfma_f32_32x32x16_bf16 v[112:127], a[232:235], v[88:91], v[112:127]
    ds_write_b128 v4, v[104:107] offset:34816
    v_cvt_pk_bf16_f32 v174, v184, v186
    v_lshlrev_b32 v184, 16, v175
    v_lshlrev_b32 v185, 16, v167
    v_and_b32 v186, 0xffff0000, v175
    v_and_b32 v187, 0xffff0000, v167
    v_add_f32 v184, v184, v185
    v_mfma_f32_32x32x16_bf16 v[112:127], a[236:239], v[92:95], v[112:127]
    ds_write_b128 v4, v[108:111] offset:35840
    v_add_f32 v186, v186, v187
    v_cvt_pk_bf16_f32 v175, v184, v186
    s_mov_b32 s59, s55
    s_mul_i32 s55, s44, s58
    s_add_u32 s55, s55, s51
    s_nop 3
    ds_write_b128 v4, v[112:115] offset:36864
    ds_write_b128 v4, v[116:119] offset:37888
    ds_write_b128 v4, v[120:123] offset:38912
    ds_write_b128 v4, v[124:127] offset:39936
    s_waitcnt vmcnt(0)
    s_waitcnt lgkmcnt(0)
    s_barrier
    buffer_store_dwordx4 v[172:175], v7, s[4:7], s59 offen sc1
    ds_read_b128 v[184:187], v3 offset:32768
    ds_read_b128 v[188:191], v3 offset:33792
    ds_read_b128 v[192:195], v3 offset:40960
    ds_read_b128 v[196:199], v3 offset:41984
    ds_read_b128 v[200:203], v3 offset:49152
    ds_read_b128 v[204:207], v3 offset:50176
    ds_read_b128 v[208:211], v3 offset:57344
    ds_read_b128 v[212:215], v3 offset:58368
    s_waitcnt lgkmcnt(5)
    v_add_f32 v184, v184, v192
    v_add_f32 v185, v185, v193
    v_add_f32 v186, v186, v194
    v_add_f32 v187, v187, v195
    s_waitcnt lgkmcnt(4)
    v_add_f32 v188, v188, v196
    v_add_f32 v189, v189, v197
    v_add_f32 v190, v190, v198
    v_add_f32 v191, v191, v199
    s_waitcnt lgkmcnt(3)
    v_add_f32 v184, v184, v200
    v_add_f32 v185, v185, v201
    v_add_f32 v186, v186, v202
    v_add_f32 v187, v187, v203
    s_waitcnt lgkmcnt(2)
    v_add_f32 v188, v188, v204
    v_add_f32 v189, v189, v205
    v_add_f32 v190, v190, v206
    v_add_f32 v191, v191, v207
    s_waitcnt lgkmcnt(1)
    v_add_f32 v184, v184, v208
    v_add_f32 v185, v185, v209
    v_add_f32 v186, v186, v210
    v_add_f32 v187, v187, v211
    s_waitcnt lgkmcnt(0)
    v_add_f32 v188, v188, v212
    v_add_f32 v189, v189, v213
    v_add_f32 v190, v190, v214
    v_add_f32 v191, v191, v215
    v_cvt_pk_bf16_f32 v172, v184, v185
    v_cvt_pk_bf16_f32 v173, v186, v187
    v_cvt_pk_bf16_f32 v174, v188, v189
    v_cvt_pk_bf16_f32 v175, v190, v191
    v_lshlrev_b32 v184, 16, v172
    v_lshlrev_b32 v185, 16, v168
    v_and_b32 v186, 0xffff0000, v172
    v_and_b32 v187, 0xffff0000, v168
    v_add_f32 v184, v184, v185
    v_add_f32 v186, v186, v187
    v_cvt_pk_bf16_f32 v172, v184, v186
    v_lshlrev_b32 v184, 16, v173
    v_lshlrev_b32 v185, 16, v169
    v_and_b32 v186, 0xffff0000, v173
    v_and_b32 v187, 0xffff0000, v169
    v_add_f32 v184, v184, v185
    v_add_f32 v186, v186, v187
    v_cvt_pk_bf16_f32 v173, v184, v186
    v_lshlrev_b32 v184, 16, v174
    v_lshlrev_b32 v185, 16, v170
    v_and_b32 v186, 0xffff0000, v174
    v_and_b32 v187, 0xffff0000, v170
    v_add_f32 v184, v184, v185
    v_add_f32 v186, v186, v187
    v_cvt_pk_bf16_f32 v174, v184, v186
    v_lshlrev_b32 v184, 16, v175
    v_lshlrev_b32 v185, 16, v171
    v_and_b32 v186, 0xffff0000, v175
    v_and_b32 v187, 0xffff0000, v171
    v_add_f32 v184, v184, v185
    v_add_f32 v186, v186, v187
    v_cvt_pk_bf16_f32 v175, v184, v186
    s_mov_b32 s59, s55
    buffer_store_dwordx4 v[172:175], v7, s[4:7], s59 offen sc1
    s_branch G_338
G_339:
    s_waitcnt vmcnt(0)
    ds_read_b64_tr_b16 v[16:17], v2 offset:0
    ds_read_b64_tr_b16 v[18:19], v2 offset:256
    ds_read_b64_tr_b16 v[20:21], v2 offset:1024
    ds_read_b64_tr_b16 v[22:23], v2 offset:1280
    ds_read_b64_tr_b16 v[24:25], v2 offset:2048
    ds_read_b64_tr_b16 v[26:27], v2 offset:2304
    ds_read_b64_tr_b16 v[28:29], v2 offset:3072
    ds_read_b64_tr_b16 v[30:31], v2 offset:3328
    ds_read_b64_tr_b16 v[32:33], v2 offset:4096
    ds_read_b64_tr_b16 v[34:35], v2 offset:4352
    ds_read_b64_tr_b16 v[36:37], v2 offset:5120
    ds_read_b64_tr_b16 v[38:39], v2 offset:5376
    ds_read_b64_tr_b16 v[40:41], v2 offset:6144
    ds_read_b64_tr_b16 v[42:43], v2 offset:6400
    ds_read_b64_tr_b16 v[44:45], v2 offset:7168
    ds_read_b64_tr_b16 v[46:47], v2 offset:7424
    ds_read_b64_tr_b16 v[48:49], v2 offset:8192
    ds_read_b64_tr_b16 v[50:51], v2 offset:8448
    ds_read_b64_tr_b16 v[52:53], v2 offset:9216
    ds_read_b64_tr_b16 v[54:55], v2 offset:9472
    s_waitcnt lgkmcnt(15)
    v_mfma_f32_32x32x16_bf16 v[96:111], a[160:163], v[16:19], 0
    ds_write_b128 v4, v[112:115] offset:36864
    v_mfma_f32_32x32x16_bf16 v[96:111], a[164:167], v[20:23], v[96:111]
    ds_write_b128 v4, v[116:119] offset:37888
    s_waitcnt lgkmcnt(15)
    v_mfma_f32_32x32x16_bf16 v[96:111], a[168:171], v[24:27], v[96:111]
    ds_write_b128 v4, v[120:123] offset:38912
    s_waitcnt lgkmcnt(15)
    v_mfma_f32_32x32x16_bf16 v[96:111], a[172:175], v[28:31], v[96:111]
    ds_write_b128 v4, v[124:127] offset:39936
    s_waitcnt lgkmcnt(14)
    v_mfma_f32_32x32x16_bf16 v[96:111], a[176:179], v[32:35], v[96:111]
    s_waitcnt lgkmcnt(12)
    v_mfma_f32_32x32x16_bf16 v[96:111], a[180:183], v[36:39], v[96:111]
    s_waitcnt lgkmcnt(0)
    s_barrier
    buffer_store_dwordx4 v[172:175], v7, s[4:7], s59 offen sc1
    v_mfma_f32_32x32x16_bf16 v[96:111], a[184:187], v[40:43], v[96:111]
    ds_read_b128 v[184:187], v3 offset:32768
    ds_read_b128 v[188:191], v3 offset:33792
    ds_read_b128 v[192:195], v3 offset:40960
    ds_read_b128 v[196:199], v3 offset:41984
    v_mfma_f32_32x32x16_bf16 v[96:111], a[188:191], v[44:47], v[96:111]
    ds_read_b128 v[200:203], v3 offset:49152
    ds_read_b128 v[204:207], v3 offset:50176
    ds_read_b128 v[208:211], v3 offset:57344
    ds_read_b128 v[212:215], v3 offset:58368
    v_mfma_f32_32x32x16_bf16 v[96:111], a[192:195], v[48:51], v[96:111]
    v_mfma_f32_32x32x16_bf16 v[96:111], a[196:199], v[52:55], v[96:111]
    v_mfma_f32_32x32x16_bf16 v[112:127], a[200:203], v[16:19], 0
    s_waitcnt lgkmcnt(5)
    v_add_f32 v184, v184, v192
    v_add_f32 v185, v185, v193
    v_add_f32 v186, v186, v194
    v_add_f32 v187, v187, v195
    s_waitcnt lgkmcnt(4)
    v_add_f32 v188, v188, v196
    v_add_f32 v189, v189, v197
    v_mfma_f32_32x32x16_bf16 v[112:127], a[204:207], v[20:23], v[112:127]
    v_add_f32 v190, v190, v198
    v_add_f32 v191, v191, v199
    s_waitcnt lgkmcnt(3)
    v_add_f32 v184, v184, v200
    v_add_f32 v185, v185, v201
    v_add_f32 v186, v186, v202
    v_add_f32 v187, v187, v203
    v_mfma_f32_32x32x16_bf16 v[112:127], a[208:211], v[24:27], v[112:127]
    s_waitcnt lgkmcnt(2)
    v_add_f32 v188, v188, v204
    v_add_f32 v189, v189, v205
    v_add_f32 v190, v190, v206
    v_add_f32 v191, v191, v207
    s_waitcnt lgkmcnt(1)
    v_add_f32 v184, v184, v208
    v_add_f32 v185, v185, v209
    v_mfma_f32_32x32x16_bf16 v[112:127], a[212:215], v[28:31], v[112:127]
    v_add_f32 v186, v186, v210
    v_add_f32 v187, v187, v211
    s_waitcnt lgkmcnt(0)
    v_add_f32 v188, v188, v212
    v_add_f32 v189, v189, v213
    v_add_f32 v190, v190, v214
    v_add_f32 v191, v191, v215
    v_mfma_f32_32x32x16_bf16 v[112:127], a[216:219], v[32:35], v[112:127]
    v_cvt_pk_bf16_f32 v172, v184, v185
    v_cvt_pk_bf16_f32 v173, v186, v187
    v_cvt_pk_bf16_f32 v174, v188, v189
    v_cvt_pk_bf16_f32 v175, v190, v191
    v_lshlrev_b32 v184, 16, v172
    v_lshlrev_b32 v185, 16, v168
    v_mfma_f32_32x32x16_bf16 v[112:127], a[220:223], v[36:39], v[112:127]
    v_and_b32 v186, 0xffff0000, v172
    v_and_b32 v187, 0xffff0000, v168
    v_add_f32 v184, v184, v185
    v_add_f32 v186, v186, v187
    v_cvt_pk_bf16_f32 v172, v184, v186
    v_lshlrev_b32 v184, 16, v173
    v_mfma_f32_32x32x16_bf16 v[112:127], a[224:227], v[40:43], v[112:127]
    ds_write_b128 v4, v[96:99] offset:0
    v_lshlrev_b32 v185, 16, v169
    v_and_b32 v186, 0xffff0000, v173
    v_and_b32 v187, 0xffff0000, v169
    v_add_f32 v184, v184, v185
    v_add_f32 v186, v186, v187
    v_cvt_pk_bf16_f32 v173, v184, v186
    v_mfma_f32_32x32x16_bf16 v[112:127], a[228:231], v[44:47], v[112:127]
    ds_write_b128 v4, v[100:103] offset:1024
    v_lshlrev_b32 v184, 16, v174
    v_lshlrev_b32 v185, 16, v170
    v_and_b32 v186, 0xffff0000, v174
    v_and_b32 v187, 0xffff0000, v170
    v_add_f32 v184, v184, v185
    v_add_f32 v186, v186, v187
    v_mfma_f32_32x32x16_bf16 v[112:127], a[232:235], v[48:51], v[112:127]
    ds_write_b128 v4, v[104:107] offset:2048
    v_cvt_pk_bf16_f32 v174, v184, v186
    v_lshlrev_b32 v184, 16, v175
    v_lshlrev_b32 v185, 16, v171
    v_and_b32 v186, 0xffff0000, v175
    v_and_b32 v187, 0xffff0000, v171
    v_add_f32 v184, v184, v185
    v_mfma_f32_32x32x16_bf16 v[112:127], a[236:239], v[52:55], v[112:127]
    ds_write_b128 v4, v[108:111] offset:3072
    v_add_f32 v186, v186, v187
    v_cvt_pk_bf16_f32 v175, v184, v186
    s_mov_b32 s59, s55
    s_mul_i32 s55, s44, s58
    s_add_u32 s55, s55, s51
    s_nop 3
    ds_write_b128 v4, v[112:115] offset:4096
    ds_write_b128 v4, v[116:119] offset:5120
    ds_write_b128 v4, v[120:123] offset:6144
    ds_write_b128 v4, v[124:127] offset:7168
    s_waitcnt vmcnt(0)
    s_waitcnt lgkmcnt(0)
    s_barrier
    buffer_store_dwordx4 v[172:175], v7, s[4:7], s59 offen sc1
    ds_read_b128 v[184:187], v3 offset:0
    ds_read_b128 v[188:191], v3 offset:1024
    ds_read_b128 v[192:195], v3 offset:8192
    ds_read_b128 v[196:199], v3 offset:9216
    ds_read_b128 v[200:203], v3 offset:16384
    ds_read_b128 v[204:207], v3 offset:17408
    ds_read_b128 v[208:211], v3 offset:24576
    ds_read_b128 v[212:215], v3 offset:25600
    s_waitcnt lgkmcnt(5)
    v_add_f32 v184, v184, v192
    v_add_f32 v185, v185, v193
    v_add_f32 v186, v186, v194
    v_add_f32 v187, v187, v195
    s_waitcnt lgkmcnt(4)
    v_add_f32 v188, v188, v196
    v_add_f32 v189, v189, v197
    v_add_f32 v190, v190, v198
    v_add_f32 v191, v191, v199
    s_waitcnt lgkmcnt(3)
    v_add_f32 v184, v184, v200
    v_add_f32 v185, v185, v201
    v_add_f32 v186, v186, v202
    v_add_f32 v187, v187, v203
    s_waitcnt lgkmcnt(2)
    v_add_f32 v188, v188, v204
    v_add_f32 v189, v189, v205
    v_add_f32 v190, v190, v206
    v_add_f32 v191, v191, v207
    s_waitcnt lgkmcnt(1)
    v_add_f32 v184, v184, v208
    v_add_f32 v185, v185, v209
    v_add_f32 v186, v186, v210
    v_add_f32 v187, v187, v211
    s_waitcnt lgkmcnt(0)
    v_add_f32 v188, v188, v212
    v_add_f32 v189, v189, v213
    v_add_f32 v190, v190, v214
    v_add_f32 v191, v191, v215
    v_cvt_pk_bf16_f32 v172, v184, v185
    v_cvt_pk_bf16_f32 v173, v186, v187
    v_cvt_pk_bf16_f32 v174, v188, v189
    v_cvt_pk_bf16_f32 v175, v190, v191
    v_lshlrev_b32 v184, 16, v172
    v_lshlrev_b32 v185, 16, v164
    v_and_b32 v186, 0xffff0000, v172
    v_and_b32 v187, 0xffff0000, v164
    v_add_f32 v184, v184, v185
    v_add_f32 v186, v186, v187
    v_cvt_pk_bf16_f32 v172, v184, v186
    v_lshlrev_b32 v184, 16, v173
    v_lshlrev_b32 v185, 16, v165
    v_and_b32 v186, 0xffff0000, v173
    v_and_b32 v187, 0xffff0000, v165
    v_add_f32 v184, v184, v185
    v_add_f32 v186, v186, v187
    v_cvt_pk_bf16_f32 v173, v184, v186
    v_lshlrev_b32 v184, 16, v174
    v_lshlrev_b32 v185, 16, v166
    v_and_b32 v186, 0xffff0000, v174
    v_and_b32 v187, 0xffff0000, v166
    v_add_f32 v184, v184, v185
    v_add_f32 v186, v186, v187
    v_cvt_pk_bf16_f32 v174, v184, v186
    v_lshlrev_b32 v184, 16, v175
    v_lshlrev_b32 v185, 16, v167
    v_and_b32 v186, 0xffff0000, v175
    v_and_b32 v187, 0xffff0000, v167
    v_add_f32 v184, v184, v185
    v_add_f32 v186, v186, v187
    v_cvt_pk_bf16_f32 v175, v184, v186
    s_mov_b32 s59, s55
    buffer_store_dwordx4 v[172:175], v7, s[4:7], s59 offen sc1
G_338:
    s_lshl_b32 s57, s30, 1
    s_add_u32 s57, s57, 2
    s_waitcnt vmcnt(0)
    s_barrier
    s_cmp_lg_u32 s29, 0
    s_cbranch_scc1 F_341
    s_lshl_b32 s32, s28, 5
    s_add_u32 s32, s32, s29
    s_lshl_b32 s32, s32, 2
    s_add_u32 s32, s32, 1122304
    v_mov_b32 v172, s57
    s_mov_b64 exec, 1
    buffer_store_dword v172, off, s[4:7], s32 sc1
    s_mov_b64 exec, -1
F_341:
    s_waitcnt vmcnt(0) lgkmcnt(0)
    s_cmp_lt_u32 s28, 60
    s_cbranch_scc1 LAYER_265
    s_cmp_lt_u32 s28, 160
    s_cbranch_scc1 R_342
    s_cmp_ge_u32 s28, 190
    s_cbranch_scc1 R_342
    s_lshl_b32 s57, s30, 1
    s_add_u32 s57, s57, 2
    v_min_u32 v180, 59, v1
    v_lshlrev_b32 v180, 7, v180
    s_mov_b32 s32, 1138944
    s_mov_b32 s48, 0
P_344:
    buffer_load_dword v176, v180, s[4:7], s32 offen sc1
    s_waitcnt vmcnt(0)
    v_cmp_gt_u32 vcc, s57, v176
    s_cbranch_vccz P_345
    s_add_u32 s48, s48, 1
    s_cmp_gt_u32 s48, 200000
    s_cbranch_scc1 L_end
    s_sleep 1
    s_branch P_344
P_345:
    v_min_u32 v180, 59, v1
    v_lshlrev_b32 v180, 7, v180
    s_mov_b32 s32, 1122304
    s_mov_b32 s48, 0
P_346:
    buffer_load_dword v176, v180, s[4:7], s32 offen sc1
    s_waitcnt vmcnt(0)
    v_cmp_gt_u32 vcc, s57, v176
    s_cbranch_vccz P_347
    s_add_u32 s48, s48, 1
    s_cmp_gt_u32 s48, 200000
    s_cbranch_scc1 L_end
    s_sleep 1
    s_branch P_346
P_347:
    s_mul_i32 s34, s29, 30
    s_add_u32 s34, s34, s28
    s_sub_u32 s34, s34, 140
    s_cmp_ge_u32 s34, 64
    s_cbranch_scc1 ST_343
    s_mul_i32 s35, s30, 6291456
    s_add_u32 s35, s35, 11534336
    s_mul_i32 s36, s34, 40960
    s_add_u32 s35, s35, s36
    buffer_load_dwordx4 v[16:19], v0, s[4:7], s35 offen offset:0 sc1
    buffer_load_dwordx4 v[20:23], v0, s[4:7], s35 offen offset:1024 sc1
    buffer_load_dwordx4 v[24:27], v0, s[4:7], s35 offen offset:2048 sc1
    buffer_load_dwordx4 v[28:31], v0, s[4:7], s35 offen offset:3072 sc1
    s_add_u32 s35, s35, 4096
    buffer_load_dwordx4 v[32:35], v0, s[4:7], s35 offen offset:0 sc1
    buffer_load_dwordx4 v[36:39], v0, s[4:7], s35 offen offset:1024 sc1
    buffer_load_dwordx4 v[40:43], v0, s[4:7], s35 offen offset:2048 sc1
    buffer_load_dwordx4 v[44:47], v0, s[4:7], s35 offen offset:3072 sc1
    s_add_u32 s35, s35, 4096
    buffer_load_dwordx4 v[48:51], v0, s[4:7], s35 offen offset:0 sc1
    buffer_load_dwordx4 v[52:55], v0, s[4:7], s35 offen offset:1024 sc1
    buffer_load_dwordx4 v[56:59], v0, s[4:7], s35 offen offset:2048 sc1
    buffer_load_dwordx4 v[60:63], v0, s[4:7], s35 offen offset:3072 sc1
    s_add_u32 s35, s35, 4096
    buffer_load_dwordx4 v[64:67], v0, s[4:7], s35 offen offset:0 sc1
    buffer_load_dwordx4 v[68:71], v0, s[4:7], s35 offen offset:1024 sc1
    buffer_load_dwordx4 v[72:75], v0, s[4:7], s35 offen offset:2048 sc1
    buffer_load_dwordx4 v[76:79], v0, s[4:7], s35 offen offset:3072 sc1
    s_add_u32 s35, s35, 4096
    buffer_load_dwordx4 v[80:83], v0, s[4:7], s35 offen offset:0 sc1
    buffer_load_dwordx4 v[84:87], v0, s[4:7], s35 offen offset:1024 sc1
    buffer_load_dwordx4 v[88:91], v0, s[4:7], s35 offen offset:2048 sc1
    buffer_load_dwordx4 v[92:95], v0, s[4:7], s35 offen offset:3072 sc1
    s_add_u32 s35, s35, 4096
    buffer_load_dwordx4 v[96:99], v0, s[4:7], s35 offen offset:0 sc1
    buffer_load_dwordx4 v[100:103], v0, s[4:7], s35 offen offset:1024 sc1
    buffer_load_dwordx4 v[104:107], v0, s[4:7], s35 offen offset:2048 sc1
    buffer_load_dwordx4 v[108:111], v0, s[4:7], s35 offen offset:3072 sc1
    s_add_u32 s35, s35, 4096
    buffer_load_dwordx4 v[112:115], v0, s[4:7], s35 offen offset:0 sc1
    buffer_load_dwordx4 v[116:119], v0, s[4:7], s35 offen offset:1024 sc1
    buffer_load_dwordx4 v[120:123], v0, s[4:7], s35 offen offset:2048 sc1
    buffer_load_dwordx4 v[124:127], v0, s[4:7], s35 offen offset:3072 sc1
    s_add_u32 s35, s35, 4096
    buffer_load_dwordx4 v[128:131], v0, s[4:7], s35 offen offset:0 sc1
    buffer_load_dwordx4 v[132:135], v0, s[4:7], s35 offen offset:1024 sc1
    buffer_load_dwordx4 v[136:139], v0, s[4:7], s35 offen offset:2048 sc1
    buffer_load_dwordx4 v[140:143], v0, s[4:7], s35 offen offset:3072 sc1
    s_add_u32 s35, s35, 4096
    buffer_load_dwordx4 v[144:147], v0, s[4:7], s35 offen offset:0 sc1
    buffer_load_dwordx4 v[148:151], v0, s[4:7], s35 offen offset:1024 sc1
    buffer_load_dwordx4 v[152:155], v0, s[4:7], s35 offen offset:2048 sc1
    buffer_load_dwordx4 v[156:159], v0, s[4:7], s35 offen offset:3072 sc1
    s_add_u32 s35, s35, 4096
    buffer_load_dwordx4 v[160:163], v0, s[4:7], s35 offen offset:0 sc1
    buffer_load_dwordx4 v[164:167], v0, s[4:7], s35 offen offset:1024 sc1
    buffer_load_dwordx4 v[168:171], v0, s[4:7], s35 offen offset:2048 sc1
    buffer_load_dwordx4 v[172:175], v0, s[4:7], s35 offen offset:3072 sc1
    v_bfe_u32 v2, v1, 0, 2
    v_mul_u32_u24 v2, 4, v2
    v_bfe_u32 v3, v1, 2, 1
    v_lshl_add_u32 v2, v3, 5, v2
    v_bfe_u32 v3, v1, 3, 1
    v_lshl_add_u32 v2, v3, 4, v2
    v_bfe_u32 v3, v1, 4, 2
    v_lshl_add_u32 v2, v3, 6, v2
    v_mov_b64 v[8:9], 0
    s_mov_b32 s36, 0x3f803f80
    s_waitcnt vmcnt(39)
    v_dot2c_f32_bf16 v8, s36, v16
    v_dot2c_f32_bf16 v9, v16, v16
    v_dot2c_f32_bf16 v8, s36, v17
    v_dot2c_f32_bf16 v9, v17, v17
    v_dot2c_f32_bf16 v8, s36, v18
    v_dot2c_f32_bf16 v9, v18, v18
    v_dot2c_f32_bf16 v8, s36, v19
    v_dot2c_f32_bf16 v9, v19, v19
    s_waitcnt vmcnt(38)
    v_dot2c_f32_bf16 v8, s36, v20
    v_dot2c_f32_bf16 v9, v20, v20
    v_dot2c_f32_bf16 v8, s36, v21
    v_dot2c_f32_bf16 v9, v21, v21
    v_dot2c_f32_bf16 v8, s36, v22
    v_dot2c_f32_bf16 v9, v22, v22
    v_dot2c_f32_bf16 v8, s36, v23
    v_dot2c_f32_bf16 v9, v23, v23
    s_waitcnt vmcnt(37)
    v_dot2c_f32_bf16 v8, s36, v24
    v_dot2c_f32_bf16 v9, v24, v24
    v_dot2c_f32_bf16 v8, s36, v25
    v_dot2c_f32_bf16 v9, v25, v25
    v_dot2c_f32_bf16 v8, s36, v26
    v_dot2c_f32_bf16 v9, v26, v26
    v_dot2c_f32_bf16 v8, s36, v27
    v_dot2c_f32_bf16 v9, v27, v27
    s_waitcnt vmcnt(36)
    v_dot2c_f32_bf16 v8, s36, v28
    v_dot2c_f32_bf16 v9, v28, v28
    v_dot2c_f32_bf16 v8, s36, v29
    v_dot2c_f32_bf16 v9, v29, v29
    v_dot2c_f32_bf16 v8, s36, v30
    v_dot2c_f32_bf16 v9, v30, v30
    v_dot2c_f32_bf16 v8, s36, v31
    v_dot2c_f32_bf16 v9, v31, v31
    s_waitcnt vmcnt(35)
    v_dot2c_f32_bf16 v8, s36, v32
    v_dot2c_f32_bf16 v9, v32, v32
    v_dot2c_f32_bf16 v8, s36, v33
    v_dot2c_f32_bf16 v9, v33, v33
    v_dot2c_f32_bf16 v8, s36, v34
    v_dot2c_f32_bf16 v9, v34, v34
    v_dot2c_f32_bf16 v8, s36, v35
    v_dot2c_f32_bf16 v9, v35, v35
    s_waitcnt vmcnt(34)
    v_dot2c_f32_bf16 v8, s36, v36
    v_dot2c_f32_bf16 v9, v36, v36
    v_dot2c_f32_bf16 v8, s36, v37
    v_dot2c_f32_bf16 v9, v37, v37
    v_dot2c_f32_bf16 v8, s36, v38
    v_dot2c_f32_bf16 v9, v38, v38
    v_dot2c_f32_bf16 v8, s36, v39
    v_dot2c_f32_bf16 v9, v39, v39
    s_waitcnt vmcnt(33)
    v_dot2c_f32_bf16 v8, s36, v40
    v_dot2c_f32_bf16 v9, v40, v40
    v_dot2c_f32_bf16 v8, s36, v41
    v_dot2c_f32_bf16 v9, v41, v41
    v_dot2c_f32_bf16 v8, s36, v42
    v_dot2c_f32_bf16 v9, v42, v42
    v_dot2c_f32_bf16 v8, s36, v43
    v_dot2c_f32_bf16 v9, v43, v43
    s_waitcnt vmcnt(32)
    v_dot2c_f32_bf16 v8, s36, v44
    v_dot2c_f32_bf16 v9, v44, v44
    v_dot2c_f32_bf16 v8, s36, v45
    v_dot2c_f32_bf16 v9, v45, v45
    v_dot2c_f32_bf16 v8, s36, v46
    v_dot2c_f32_bf16 v9, v46, v46
    v_dot2c_f32_bf16 v8, s36, v47
    v_dot2c_f32_bf16 v9, v47, v47
    s_waitcnt vmcnt(31)
    v_dot2c_f32_bf16 v8, s36, v48
    v_dot2c_f32_bf16 v9, v48, v48
    v_dot2c_f32_bf16 v8, s36, v49
    v_dot2c_f32_bf16 v9, v49, v49
    v_dot2c_f32_bf16 v8, s36, v50
    v_dot2c_f32_bf16 v9, v50, v50
    v_dot2c_f32_bf16 v8, s36, v51
    v_dot2c_f32_bf16 v9, v51, v51
    s_waitcnt vmcnt(30)
    v_dot2c_f32_bf16 v8, s36, v52
    v_dot2c_f32_bf16 v9, v52, v52
    v_dot2c_f32_bf16 v8, s36, v53
    v_dot2c_f32_bf16 v9, v53, v53
    v_dot2c_f32_bf16 v8, s36, v54
    v_dot2c_f32_bf16 v9, v54, v54
    v_dot2c_f32_bf16 v8, s36, v55
    v_dot2c_f32_bf16 v9, v55, v55
    s_waitcnt vmcnt(29)
    v_dot2c_f32_bf16 v8, s36, v56
    v_dot2c_f32_bf16 v9, v56, v56
    v_dot2c_f32_bf16 v8, s36, v57
    v_dot2c_f32_bf16 v9, v57, v57
    v_dot2c_f32_bf16 v8, s36, v58
    v_dot2c_f32_bf16 v9, v58, v58
    v_dot2c_f32_bf16 v8, s36, v59
    v_dot2c_f32_bf16 v9, v59, v59
    s_waitcnt vmcnt(28)
    v_dot2c_f32_bf16 v8, s36, v60
    v_dot2c_f32_bf16 v9, v60, v60
    v_dot2c_f32_bf16 v8, s36, v61
    v_dot2c_f32_bf16 v9, v61, v61
    v_dot2c_f32_bf16 v8, s36, v62
    v_dot2c_f32_bf16 v9, v62, v62
    v_dot2c_f32_bf16 v8, s36, v63
    v_dot2c_f32_bf16 v9, v63, v63
    s_waitcnt vmcnt(27)
    v_dot2c_f32_bf16 v8, s36, v64
    v_dot2c_f32_bf16 v9, v64, v64
    v_dot2c_f32_bf16 v8, s36, v65
    v_dot2c_f32_bf16 v9, v65, v65
    v_dot2c_f32_bf16 v8, s36, v66
    v_dot2c_f32_bf16 v9, v66, v66
    v_dot2c_f32_bf16 v8, s36, v67
    v_dot2c_f32_bf16 v9, v67, v67
    s_waitcnt vmcnt(26)
    v_dot2c_f32_bf16 v8, s36, v68
    v_dot2c_f32_bf16 v9, v68, v68
    v_dot2c_f32_bf16 v8, s36, v69
    v_dot2c_f32_bf16 v9, v69, v69
    v_dot2c_f32_bf16 v8, s36, v70
    v_dot2c_f32_bf16 v9, v70, v70
    v_dot2c_f32_bf16 v8, s36, v71
    v_dot2c_f32_bf16 v9, v71, v71
    s_waitcnt vmcnt(25)
    v_dot2c_f32_bf16 v8, s36, v72
    v_dot2c_f32_bf16 v9, v72, v72
    v_dot2c_f32_bf16 v8, s36, v73
    v_dot2c_f32_bf16 v9, v73, v73
    v_dot2c_f32_bf16 v8, s36, v74
    v_dot2c_f32_bf16 v9, v74, v74
    v_dot2c_f32_bf16 v8, s36, v75
    v_dot2c_f32_bf16 v9, v75, v75
    s_waitcnt vmcnt(24)
    v_dot2c_f32_bf16 v8, s36, v76
    v_dot2c_f32_bf16 v9, v76, v76
    v_dot2c_f32_bf16 v8, s36, v77
    v_dot2c_f32_bf16 v9, v77, v77
    v_dot2c_f32_bf16 v8, s36, v78
    v_dot2c_f32_bf16 v9, v78, v78
    v_dot2c_f32_bf16 v8, s36, v79
    v_dot2c_f32_bf16 v9, v79, v79
    s_waitcnt vmcnt(23)
    v_dot2c_f32_bf16 v8, s36, v80
    v_dot2c_f32_bf16 v9, v80, v80
    v_dot2c_f32_bf16 v8, s36, v81
    v_dot2c_f32_bf16 v9, v81, v81
    v_dot2c_f32_bf16 v8, s36, v82
    v_dot2c_f32_bf16 v9, v82, v82
    v_dot2c_f32_bf16 v8, s36, v83
    v_dot2c_f32_bf16 v9, v83, v83
    s_waitcnt vmcnt(22)
    v_dot2c_f32_bf16 v8, s36, v84
    v_dot2c_f32_bf16 v9, v84, v84
    v_dot2c_f32_bf16 v8, s36, v85
    v_dot2c_f32_bf16 v9, v85, v85
    v_dot2c_f32_bf16 v8, s36, v86
    v_dot2c_f32_bf16 v9, v86, v86
    v_dot2c_f32_bf16 v8, s36, v87
    v_dot2c_f32_bf16 v9, v87, v87
    s_waitcnt vmcnt(21)
    v_dot2c_f32_bf16 v8, s36, v88
    v_dot2c_f32_bf16 v9, v88, v88
    v_dot2c_f32_bf16 v8, s36, v89
    v_dot2c_f32_bf16 v9, v89, v89
    v_dot2c_f32_bf16 v8, s36, v90
    v_dot2c_f32_bf16 v9, v90, v90
    v_dot2c_f32_bf16 v8, s36, v91
    v_dot2c_f32_bf16 v9, v91, v91
    s_waitcnt vmcnt(20)
    v_dot2c_f32_bf16 v8, s36, v92
    v_dot2c_f32_bf16 v9, v92, v92
    v_dot2c_f32_bf16 v8, s36, v93
    v_dot2c_f32_bf16 v9, v93, v93
    v_dot2c_f32_bf16 v8, s36, v94
    v_dot2c_f32_bf16 v9, v94, v94
    v_dot2c_f32_bf16 v8, s36, v95
    v_dot2c_f32_bf16 v9, v95, v95
    s_waitcnt vmcnt(19)
    v_dot2c_f32_bf16 v8, s36, v96
    v_dot2c_f32_bf16 v9, v96, v96
    v_dot2c_f32_bf16 v8, s36, v97
    v_dot2c_f32_bf16 v9, v97, v97
    v_dot2c_f32_bf16 v8, s36, v98
    v_dot2c_f32_bf16 v9, v98, v98
    v_dot2c_f32_bf16 v8, s36, v99
    v_dot2c_f32_bf16 v9, v99, v99
    s_waitcnt vmcnt(18)
    v_dot2c_f32_bf16 v8, s36, v100
    v_dot2c_f32_bf16 v9, v100, v100
    v_dot2c_f32_bf16 v8, s36, v101
    v_dot2c_f32_bf16 v9, v101, v101
    v_dot2c_f32_bf16 v8, s36, v102
    v_dot2c_f32_bf16 v9, v102, v102
    v_dot2c_f32_bf16 v8, s36, v103
    v_dot2c_f32_bf16 v9, v103, v103
    s_waitcnt vmcnt(17)
    v_dot2c_f32_bf16 v8, s36, v104
    v_dot2c_f32_bf16 v9, v104, v104
    v_dot2c_f32_bf16 v8, s36, v105
    v_dot2c_f32_bf16 v9, v105, v105
    v_dot2c_f32_bf16 v8, s36, v106
    v_dot2c_f32_bf16 v9, v106, v106
    v_dot2c_f32_bf16 v8, s36, v107
    v_dot2c_f32_bf16 v9, v107, v107
    s_waitcnt vmcnt(16)
    v_dot2c_f32_bf16 v8, s36, v108
    v_dot2c_f32_bf16 v9, v108, v108
    v_dot2c_f32_bf16 v8, s36, v109
    v_dot2c_f32_bf16 v9, v109, v109
    v_dot2c_f32_bf16 v8, s36, v110
    v_dot2c_f32_bf16 v9, v110, v110
    v_dot2c_f32_bf16 v8, s36, v111
    v_dot2c_f32_bf16 v9, v111, v111
    s_waitcnt vmcnt(15)
    v_dot2c_f32_bf16 v8, s36, v112
    v_dot2c_f32_bf16 v9, v112, v112
    v_dot2c_f32_bf16 v8, s36, v113
    v_dot2c_f32_bf16 v9, v113, v113
    v_dot2c_f32_bf16 v8, s36, v114
    v_dot2c_f32_bf16 v9, v114, v114
    v_dot2c_f32_bf16 v8, s36, v115
    v_dot2c_f32_bf16 v9, v115, v115
    s_waitcnt vmcnt(14)
    v_dot2c_f32_bf16 v8, s36, v116
    v_dot2c_f32_bf16 v9, v116, v116
    v_dot2c_f32_bf16 v8, s36, v117
    v_dot2c_f32_bf16 v9, v117, v117
    v_dot2c_f32_bf16 v8, s36, v118
    v_dot2c_f32_bf16 v9, v118, v118
    v_dot2c_f32_bf16 v8, s36, v119
    v_dot2c_f32_bf16 v9, v119, v119
    s_waitcnt vmcnt(13)
    v_dot2c_f32_bf16 v8, s36, v120
    v_dot2c_f32_bf16 v9, v120, v120
    v_dot2c_f32_bf16 v8, s36, v121
    v_dot2c_f32_bf16 v9, v121, v121
    v_dot2c_f32_bf16 v8, s36, v122
    v_dot2c_f32_bf16 v9, v122, v122
    v_dot2c_f32_bf16 v8, s36, v123
    v_dot2c_f32_bf16 v9, v123, v123
    s_waitcnt vmcnt(12)
    v_dot2c_f32_bf16 v8, s36, v124
    v_dot2c_f32_bf16 v9, v124, v124
    v_dot2c_f32_bf16 v8, s36, v125
    v_dot2c_f32_bf16 v9, v125, v125
    v_dot2c_f32_bf16 v8, s36, v126
    v_dot2c_f32_bf16 v9, v126, v126
    v_dot2c_f32_bf16 v8, s36, v127
    v_dot2c_f32_bf16 v9, v127, v127
    s_waitcnt vmcnt(11)
    v_dot2c_f32_bf16 v8, s36, v128
    v_dot2c_f32_bf16 v9, v128, v128
    v_dot2c_f32_bf16 v8, s36, v129
    v_dot2c_f32_bf16 v9, v129, v129
    v_dot2c_f32_bf16 v8, s36, v130
    v_dot2c_f32_bf16 v9, v130, v130
    v_dot2c_f32_bf16 v8, s36, v131
    v_dot2c_f32_bf16 v9, v131, v131
    s_waitcnt vmcnt(10)
    v_dot2c_f32_bf16 v8, s36, v132
    v_dot2c_f32_bf16 v9, v132, v132
    v_dot2c_f32_bf16 v8, s36, v133
    v_dot2c_f32_bf16 v9, v133, v133
    v_dot2c_f32_bf16 v8, s36, v134
    v_dot2c_f32_bf16 v9, v134, v134
    v_dot2c_f32_bf16 v8, s36, v135
    v_dot2c_f32_bf16 v9, v135, v135
    s_waitcnt vmcnt(9)
    v_dot2c_f32_bf16 v8, s36, v136
    v_dot2c_f32_bf16 v9, v136, v136
    v_dot2c_f32_bf16 v8, s36, v137
    v_dot2c_f32_bf16 v9, v137, v137
    v_dot2c_f32_bf16 v8, s36, v138
    v_dot2c_f32_bf16 v9, v138, v138
    v_dot2c_f32_bf16 v8, s36, v139
    v_dot2c_f32_bf16 v9, v139, v139
    s_waitcnt vmcnt(8)
    v_dot2c_f32_bf16 v8, s36, v140
    v_dot2c_f32_bf16 v9, v140, v140
    v_dot2c_f32_bf16 v8, s36, v141
    v_dot2c_f32_bf16 v9, v141, v141
    v_dot2c_f32_bf16 v8, s36, v142
    v_dot2c_f32_bf16 v9, v142, v142
    v_dot2c_f32_bf16 v8, s36, v143
    v_dot2c_f32_bf16 v9, v143, v143
    s_waitcnt vmcnt(7)
    v_dot2c_f32_bf16 v8, s36, v144
    v_dot2c_f32_bf16 v9, v144, v144
    v_dot2c_f32_bf16 v8, s36, v145
    v_dot2c_f32_bf16 v9, v145, v145
    v_dot2c_f32_bf16 v8, s36, v146
    v_dot2c_f32_bf16 v9, v146, v146
    v_dot2c_f32_bf16 v8, s36, v147
    v_dot2c_f32_bf16 v9, v147, v147
    s_waitcnt vmcnt(6)
    v_dot2c_f32_bf16 v8, s36, v148
    v_dot2c_f32_bf16 v9, v148, v148
    v_dot2c_f32_bf16 v8, s36, v149
    v_dot2c_f32_bf16 v9, v149, v149
    v_dot2c_f32_bf16 v8, s36, v150
    v_dot2c_f32_bf16 v9, v150, v150
    v_dot2c_f32_bf16 v8, s36, v151
    v_dot2c_f32_bf16 v9, v151, v151
    s_waitcnt vmcnt(5)
    v_dot2c_f32_bf16 v8, s36, v152
    v_dot2c_f32_bf16 v9, v152, v152
    v_dot2c_f32_bf16 v8, s36, v153
    v_dot2c_f32_bf16 v9, v153, v153
    v_dot2c_f32_bf16 v8, s36, v154
    v_dot2c_f32_bf16 v9, v154, v154
    v_dot2c_f32_bf16 v8, s36, v155
    v_dot2c_f32_bf16 v9, v155, v155
    s_waitcnt vmcnt(4)
    v_dot2c_f32_bf16 v8, s36, v156
    v_dot2c_f32_bf16 v9, v156, v156
    v_dot2c_f32_bf16 v8, s36, v157
    v_dot2c_f32_bf16 v9, v157, v157
    v_dot2c_f32_bf16 v8, s36, v158
    v_dot2c_f32_bf16 v9, v158, v158
    v_dot2c_f32_bf16 v8, s36, v159
    v_dot2c_f32_bf16 v9, v159, v159
    s_waitcnt vmcnt(3)
    v_dot2c_f32_bf16 v8, s36, v160
    v_dot2c_f32_bf16 v9, v160, v160
    v_dot2c_f32_bf16 v8, s36, v161
    v_dot2c_f32_bf16 v9, v161, v161
    v_dot2c_f32_bf16 v8, s36, v162
    v_dot2c_f32_bf16 v9, v162, v162
    v_dot2c_f32_bf16 v8, s36, v163
    v_dot2c_f32_bf16 v9, v163, v163
    s_waitcnt vmcnt(2)
    v_dot2c_f32_bf16 v8, s36, v164
    v_dot2c_f32_bf16 v9, v164, v164
    v_dot2c_f32_bf16 v8, s36, v165
    v_dot2c_f32_bf16 v9, v165, v165
    v_dot2c_f32_bf16 v8, s36, v166
    v_dot2c_f32_bf16 v9, v166, v166
    v_dot2c_f32_bf16 v8, s36, v167
    v_dot2c_f32_bf16 v9, v167, v167
    s_waitcnt vmcnt(1)
    v_dot2c_f32_bf16 v8, s36, v168
    v_dot2c_f32_bf16 v9, v168, v168
    v_dot2c_f32_bf16 v8, s36, v169
    v_dot2c_f32_bf16 v9, v169, v169
    v_dot2c_f32_bf16 v8, s36, v170
    v_dot2c_f32_bf16 v9, v170, v170
    v_dot2c_f32_bf16 v8, s36, v171
    v_dot2c_f32_bf16 v9, v171, v171
    s_waitcnt vmcnt(0)
    v_dot2c_f32_bf16 v8, s36, v172
    v_dot2c_f32_bf16 v9, v172, v172
    v_dot2c_f32_bf16 v8, s36, v173
    v_dot2c_f32_bf16 v9, v173, v173
    v_dot2c_f32_bf16 v8, s36, v174
    v_dot2c_f32_bf16 v9, v174, v174
    v_dot2c_f32_bf16 v8, s36, v175
    v_dot2c_f32_bf16 v9, v175, v175
    s_nop 2
    v_mov_b64 v[10:11], v[8:9]
    s_nop 1
    v_permlane32_swap_b32 v8, v10
    v_permlane32_swap_b32 v9, v11
    v_pk_add_f32 v[8:9], v[8:9], v[10:11]
    v_mul_f32 v8, 0x3acccccd, v8
    v_mul_f32 v9, 0x3acccccd, v9
    v_fma_f32 v9, -v8, v8, v9
    v_max_f32 v9, 0, v9
    v_add_f32 v9, 0x3727c5ac, v9
    v_rsq_f32 v9, v9
    v_cmp_lt_u32 vcc, 31, v1
    s_nop 1
    v_cndmask_b32 v8, v8, v9, vcc
    s_mul_i32 s35, s30, 16384
    s_add_u32 s35, s35, 5242880
    s_lshl_b32 s34, s34, 8
    s_add_u32 s35, s35, s34
    buffer_store_dword v8, v2, s[4:7], s35 offen sc1
ST_343:
    s_waitcnt vmcnt(0)
    s_barrier
    s_cmp_lg_u32 s29, 0
    s_cbranch_scc1 F_348
    s_lshl_b32 s32, s28, 5
    s_add_u32 s32, s32, s29
    s_lshl_b32 s32, s32, 2
    s_add_u32 s32, s32, 1048576
    v_mov_b32 v176, s57
    s_mov_b64 exec, 1
    buffer_store_dword v176, off, s[4:7], s32 sc1
    s_mov_b64 exec, -1
F_348:
R_342:
LAYER_261:
    s_sub_u32 s32, s28, 128
    s_cmp_lt_u32 s32, 32
    s_cbranch_scc1 R_349
    v_add_u32 v2, s60, v0
    ds_write_b128 v2, a[160:163] offset:0
    ds_write_b128 v2, a[164:167] offset:1024
    ds_write_b128 v2, a[168:171] offset:2048
    ds_write_b128 v2, a[172:175] offset:3072
    ds_write_b128 v2, a[176:179] offset:4096
    ds_write_b128 v2, a[180:183] offset:5120
    ds_write_b128 v2, a[184:187] offset:6144
    ds_write_b128 v2, a[188:191] offset:7168
    ds_write_b128 v2, a[192:195] offset:8192
    ds_write_b128 v2, a[196:199] offset:9216
    ds_write_b128 v2, a[200:203] offset:10240
    ds_write_b128 v2, a[204:207] offset:11264
    ds_write_b128 v2, a[208:211] offset:12288
    ds_write_b128 v2, a[212:215] offset:13312
    ds_write_b128 v2, a[216:219] offset:14336
    ds_write_b128 v2, a[220:223] offset:15360
    ds_write_b128 v2, a[224:227] offset:16384
    ds_write_b128 v2, a[228:231] offset:17408
    ds_write_b128 v2, a[232:235] offset:18432
    ds_write_b128 v2, a[236:239] offset:19456
    s_waitcnt lgkmcnt(0)
R_349:
    s_cmp_lt_u32 s28, 128
    s_cbranch_scc1 R_350
    s_cmp_ge_u32 s28, 160
    s_cbranch_scc1 R_350
    s_sub_u32 s40, s28, 128
    v_bfe_u32 v2, v1, 1, 1
    v_mul_u32_u24 v2, 2048, v2
    v_bfe_u32 v8, v1, 3, 1
    v_lshl_add_u32 v2, v8, 12, v2
    v_bfe_u32 v8, v1, 2, 1
    v_lshl_add_u32 v2, v8, 6, v2
    v_bfe_u32 v8, v1, 4, 1
    v_lshl_add_u32 v2, v8, 7, v2
    v_bfe_u32 v8, v1, 5, 1
    v_lshl_add_u32 v2, v8, 5, v2
    v_bfe_u32 v8, v1, 0, 1
    v_lshl_add_u32 v2, v8, 4, v2
    v_bfe_u32 v3, v1, 4, 1
    v_mul_u32_u24 v3, 1024, v3
    v_bfe_u32 v8, v1, 5, 1
    v_lshl_add_u32 v3, v8, 8, v3
    v_bfe_u32 v8, v1, 0, 2
    v_lshl_add_u32 v3, v8, 4, v3
    v_bfe_u32 v8, v1, 2, 1
    v_lshl_add_u32 v3, v8, 7, v3
    v_bfe_u32 v8, v1, 3, 1
    v_lshl_add_u32 v3, v8, 6, v3
    v_bfe_u32 v4, v1, 0, 1
    v_mul_u32_u24 v4, 256, v4
    v_bfe_u32 v8, v1, 5, 1
    v_lshl_add_u32 v4, v8, 7, v4
    v_bfe_u32 v8, v1, 2, 2
    v_lshl_add_u32 v4, v8, 3, v4
    v_add_u32 v4, s60, v4
    s_mov_b32 m0, s60
    v_bfe_u32 v5, v1, 0, 2
    v_mul_u32_u24 v5, 8, v5
    v_bfe_u32 v8, v1, 2, 1
    v_lshl_add_u32 v5, v8, 6, v5
    v_bfe_u32 v8, v1, 3, 1
    v_lshl_add_u32 v5, v8, 5, v5
    v_bfe_u32 v8, v1, 4, 2
    v_lshl_add_u32 v5, v8, 7, v5
    v_add_u32 v5, 2048, v5
    v_bfe_u32 v6, v1, 4, 1
    v_mul_u32_u24 v6, 131072, v6
    v_bfe_u32 v8, v1, 5, 1
    v_lshl_add_u32 v6, v8, 8, v6
    v_bfe_u32 v8, v1, 0, 4
    v_lshl_add_u32 v6, v8, 4, v6
    v_bfe_u32 v9, v1, 0, 2
    v_bfe_u32 v8, v1, 2, 1
    v_lshl_add_u32 v9, v8, 3, v9
    v_bfe_u32 v8, v1, 3, 1
    v_lshl_add_u32 v9, v8, 2, v9
    v_bfe_u32 v8, v1, 4, 1
    v_lshl_add_u32 v9, v8, 4, v9
    v_bfe_u32 v10, v1, 5, 1
    v_mul_u32_u24 v10, 8, v10
    v_sub_u32 v9, v9, v10
    v_mov_b32 v10, 0xf149f2ca
    v_cmp_gt_i32 vcc, 0, v9
    s_nop 1
    v_cndmask_b32 v152, 0, v10, vcc
    v_cmp_gt_i32 vcc, 1, v9
    s_nop 1
    v_cndmask_b32 v153, 0, v10, vcc
    v_cmp_gt_i32 vcc, 2, v9
    s_nop 1
    v_cndmask_b32 v154, 0, v10, vcc
    v_cmp_gt_i32 vcc, 3, v9
    s_nop 1
    v_cndmask_b32 v155, 0, v10, vcc
    v_cmp_gt_i32 vcc, 4, v9
    s_nop 1
    v_cndmask_b32 v156, 0, v10, vcc
    v_cmp_gt_i32 vcc, 5, v9
    s_nop 1
    v_cndmask_b32 v157, 0, v10, vcc
    v_cmp_gt_i32 vcc, 6, v9
    s_nop 1
    v_cndmask_b32 v158, 0, v10, vcc
    v_cmp_gt_i32 vcc, 7, v9
    s_nop 1
    v_cndmask_b32 v159, 0, v10, vcc
    v_cmp_gt_i32 vcc, 16, v9
    s_nop 1
    v_cndmask_b32 v160, 0, v10, vcc
    v_cmp_gt_i32 vcc, 17, v9
    s_nop 1
    v_cndmask_b32 v161, 0, v10, vcc
    v_cmp_gt_i32 vcc, 18, v9
    s_nop 1
    v_cndmask_b32 v162, 0, v10, vcc
    v_cmp_gt_i32 vcc, 19, v9
    s_nop 1
    v_cndmask_b32 v163, 0, v10, vcc
    v_cmp_gt_i32 vcc, 20, v9
    s_nop 1
    v_cndmask_b32 v164, 0, v10, vcc
    v_cmp_gt_i32 vcc, 21, v9
    s_nop 1
    v_cndmask_b32 v165, 0, v10, vcc
    v_cmp_gt_i32 vcc, 22, v9
    s_nop 1
    v_cndmask_b32 v166, 0, v10, vcc
    v_cmp_gt_i32 vcc, 23, v9
    s_nop 1
    v_cndmask_b32 v167, 0, v10, vcc
    s_lshl_b32 s41, s31, 4
    s_add_u32 s41, s41, s40
    s_lshl_b32 s41, s41, 8
    s_add_u32 s41, s41, 1220608
    v_bfe_u32 v7, v1, 0, 1
    v_mul_u32_u24 v7, 128, v7
    v_add_u32 v7, s41, v7
    s_mul_i32 s34, s40, 768
    s_add_u32 s34, s34, 1146880
    v_min_u32 v14, 5, v1
    v_lshlrev_b32 v14, 7, v14
    v_add_u32 v14, s34, v14
    s_mov_b32 s44, s29
    s_add_u32 s49, s61, 1
    s_mov_b32 s68, 0x3e0293ee
    s_add_u32 s57, s61, 4
    s_mov_b32 s48, 0
P_352:
    buffer_load_dword v8, v14, s[4:7], 0 offen sc1
    s_waitcnt vmcnt(0)
    v_cmp_gt_u32 vcc, s57, v8
    s_cbranch_vccz P_353
    s_add_u32 s48, s48, 1
    s_cmp_gt_u32 s48, 200000
    s_cbranch_scc1 L_end
    s_sleep 8
    s_branch P_352
P_353:
    s_waitcnt vmcnt(0) lgkmcnt(0)
AT_351:
    s_add_u32 s57, s44, s61
    s_add_u32 s57, s57, 1
    s_lshl_b32 s34, s44, 5
    s_add_u32 s34, s34, s40
    s_mul_i32 s37, s30, 67108864
    s_add_u32 s37, s37, 119537664
    s_lshl_b32 s36, s34, 15
    s_add_u32 s37, s37, s36
    s_xor_b32 s36, s44, s31
    s_and_b32 s36, s36, 2
    s_lshl_b32 s36, s36, 12
    s_add_u32 s37, s37, s36
    s_and_b32 s36, s40, 1
    s_lshl_b32 s36, s36, 14
    s_add_u32 s37, s37, s36
    s_xor_b32 s35, s37, 8192
    buffer_load_dwordx4 v[16:19], v0, s[4:7], s35 offen offset:0 sc1
    buffer_load_dwordx4 v[48:51], v2, s[4:7], s37 offen offset:0 sc1
    buffer_load_dwordx4 v[20:23], v0, s[4:7], s35 offen offset:1024 sc1
    buffer_load_dwordx4 v[52:55], v2, s[4:7], s37 offen offset:256 sc1
    buffer_load_dwordx4 v[24:27], v0, s[4:7], s35 offen offset:2048 sc1
    buffer_load_dwordx4 v[56:59], v2, s[4:7], s37 offen offset:512 sc1
    buffer_load_dwordx4 v[28:31], v0, s[4:7], s35 offen offset:3072 sc1
    buffer_load_dwordx4 v[60:63], v2, s[4:7], s37 offen offset:768 sc1
    s_add_u32 s35, s35, 4096
    buffer_load_dwordx4 v[32:35], v0, s[4:7], s35 offen offset:0 sc1
    buffer_load_dwordx4 v[64:67], v2, s[4:7], s37 offen offset:1024 sc1
    buffer_load_dwordx4 v[36:39], v0, s[4:7], s35 offen offset:1024 sc1
    buffer_load_dwordx4 v[68:71], v2, s[4:7], s37 offen offset:1280 sc1
    buffer_load_dwordx4 v[40:43], v0, s[4:7], s35 offen offset:2048 sc1
    buffer_load_dwordx4 v[72:75], v2, s[4:7], s37 offen offset:1536 sc1
    buffer_load_dwordx4 v[44:47], v0, s[4:7], s35 offen offset:3072 sc1
    buffer_load_dwordx4 v[76:79], v2, s[4:7], s37 offen offset:1792 sc1
    s_xor_b32 s37, s37, 16384
    buffer_load_dwordx4 v[80:83], v3, s[4:7], s37 offen offset:0 sc1
    buffer_load_dwordx4 v[84:87], v3, s[4:7], s37 offen offset:512 sc1
    buffer_load_dwordx4 v[88:91], v3, s[4:7], s37 offen offset:2048 sc1
    buffer_load_dwordx4 v[92:95], v3, s[4:7], s37 offen offset:2560 sc1
    s_xor_b32 s37, s37, 4096
    buffer_load_dwordx4 v[96:99], v3, s[4:7], s37 offen offset:0 sc1
    buffer_load_dwordx4 v[100:103], v3, s[4:7], s37 offen offset:512 sc1
    buffer_load_dwordx4 v[104:107], v3, s[4:7], s37 offen offset:2048 sc1
    buffer_load_dwordx4 v[108:111], v3, s[4:7], s37 offen offset:2560 sc1
    s_waitcnt vmcnt(22)
    v_mfma_f32_32x32x16_bf16 v[168:183], v[48:51], v[16:19], v[152:167]
    s_waitcnt vmcnt(20)
    v_mfma_f32_32x32x16_bf16 v[168:183], v[52:55], v[20:23], v[168:183]
    s_waitcnt vmcnt(18)
    v_mfma_f32_32x32x16_bf16 v[168:183], v[56:59], v[24:27], v[168:183]
    s_waitcnt vmcnt(16)
    v_mfma_f32_32x32x16_bf16 v[168:183], v[60:63], v[28:31], v[168:183]
    s_waitcnt vmcnt(14)
    v_mfma_f32_32x32x16_bf16 v[168:183], v[64:67], v[32:35], v[168:183]
    s_waitcnt vmcnt(12)
    v_mfma_f32_32x32x16_bf16 v[168:183], v[68:71], v[36:39], v[168:183]
    s_waitcnt vmcnt(10)
    v_mfma_f32_32x32x16_bf16 v[168:183], v[72:75], v[40:43], v[168:183]
    s_waitcnt vmcnt(8)
    v_mfma_f32_32x32x16_bf16 v[168:183], v[76:79], v[44:47], v[168:183]
    s_add_u32 s35, s44, 5
    s_min_u32 s35, s35, 64
    s_add_u32 s35, s35, s61
    s_mov_b32 s48, 0
P_354:
    buffer_load_dword v8, v14, s[4:7], 0 offen sc1
    s_waitcnt vmcnt(0)
    v_cmp_gt_u32 vcc, s35, v8
    s_cbranch_vccz P_355
    s_add_u32 s48, s48, 1
    s_cmp_gt_u32 s48, 200000
    s_cbranch_scc1 L_end
    s_sleep 8
    s_branch P_354
P_355:
    s_add_u32 s72, s4, s41
    s_addc_u32 s73, s5, 0
    s_mov_b32 s48, 0
P_356:
    s_load_dword s70, s[72:73], 0 glc
    s_load_dword s71, s[72:73], 128 glc
    s_waitcnt lgkmcnt(0)
    s_min_u32 s70, s70, s71
    s_cmp_ge_u32 s70, s57
    s_cbranch_scc1 P_357
    s_add_u32 s48, s48, 1
    s_cmp_gt_u32 s48, 200000
    s_cbranch_scc1 L_end
    s_sleep 2
    s_add_u32 s70, s70, 2
    s_cmp_ge_u32 s70, s57
    s_cbranch_scc1 P_356
    s_sleep 32
    s_branch P_356
P_357:
    s_mul_i32 s35, s30, 67108864
    s_add_u32 s35, s35, 35651584
    s_lshr_b32 s36, s34, 1
    s_lshl_b32 s36, s36, 14
    s_add_u32 s35, s35, s36
    s_and_b32 s36, s40, 1
    s_lshl_b32 s36, s36, 12
    s_add_u32 s35, s35, s36
    s_lshr_b32 s36, s44, 2
    s_xor_b32 s36, s36, s31
    s_and_b32 s36, s36, 2
    s_lshl_b32 s36, s36, 12
    s_add_u32 s35, s35, s36
    buffer_load_dwordx4 v0, s[4:7], s35 offen offset:0 sc1 lds
    buffer_load_dwordx4 v0, s[4:7], s35 offen offset:1024 sc1 lds
    buffer_load_dwordx2 v[144:145], v5, s[4:7], s35 offen offset:0 sc1
    buffer_load_dwordx2 v[146:147], v5, s[4:7], s35 offen offset:512 sc1
    buffer_load_dwordx2 v[148:149], v5, s[4:7], s35 offen offset:1024 sc1
    buffer_load_dwordx2 v[150:151], v5, s[4:7], s35 offen offset:1536 sc1
    v_max3_f32 v8, v168, v169, v170
    v_max3_f32 v8, v8, v171, v172
    v_max3_f32 v8, v8, v173, v174
    v_max3_f32 v8, v8, v175, v176
    v_max3_f32 v8, v8, v177, v178
    v_max3_f32 v8, v8, v179, v180
    v_max3_f32 v8, v8, v181, v182
    v_max_f32 v8, v8, v183
    s_waitcnt vmcnt(4)
    ds_read_b64_tr_b16 v[112:113], v4 offset:0
    ds_read_b64_tr_b16 v[114:115], v4 offset:32
    ds_read_b64_tr_b16 v[116:117], v4 offset:64
    ds_read_b64_tr_b16 v[118:119], v4 offset:96
    ds_read_b64_tr_b16 v[120:121], v4 offset:512
    ds_read_b64_tr_b16 v[122:123], v4 offset:544
    ds_read_b64_tr_b16 v[124:125], v4 offset:576
    ds_read_b64_tr_b16 v[126:127], v4 offset:608
    ds_read_b64_tr_b16 v[128:129], v4 offset:1024
    ds_read_b64_tr_b16 v[130:131], v4 offset:1056
    ds_read_b64_tr_b16 v[132:133], v4 offset:1088
    ds_read_b64_tr_b16 v[134:135], v4 offset:1120
    ds_read_b64_tr_b16 v[136:137], v4 offset:1536
    ds_read_b64_tr_b16 v[138:139], v4 offset:1568
    ds_read_b64_tr_b16 v[140:141], v4 offset:1600
    ds_read_b64_tr_b16 v[142:143], v4 offset:1632
    s_waitcnt lgkmcnt(14)
    v_mfma_f32_32x32x16_bf16 v[184:199], v[112:115], v[16:19], 0
    s_waitcnt lgkmcnt(12)
    v_mfma_f32_32x32x16_bf16 v[184:199], v[116:119], v[20:23], v[184:199]
    s_waitcnt lgkmcnt(10)
    v_mfma_f32_32x32x16_bf16 v[184:199], v[120:123], v[24:27], v[184:199]
    s_waitcnt lgkmcnt(8)
    v_mfma_f32_32x32x16_bf16 v[184:199], v[124:127], v[28:31], v[184:199]
    s_waitcnt lgkmcnt(6)
    v_mfma_f32_32x32x16_bf16 v[184:199], v[128:131], v[32:35], v[184:199]
    s_waitcnt lgkmcnt(4)
    v_mfma_f32_32x32x16_bf16 v[184:199], v[132:135], v[36:39], v[184:199]
    s_waitcnt lgkmcnt(2)
    v_mfma_f32_32x32x16_bf16 v[184:199], v[136:139], v[40:43], v[184:199]
    s_waitcnt lgkmcnt(0)
    v_mfma_f32_32x32x16_bf16 v[184:199], v[140:143], v[44:47], v[184:199]
    s_nop 11
    v_max3_f32 v8, v8, v184, v185
    v_max3_f32 v8, v8, v186, v187
    v_mov_b32 v9, v8
    s_nop 1
    v_permlane32_swap_b32 v8, v9
    v_max_f32 v8, v8, v9
    v_mul_f32 v8, s68, v8
    v_fma_f32 v168, v168, s68, -v8
    v_fma_f32 v169, v169, s68, -v8
    v_fma_f32 v170, v170, s68, -v8
    v_fma_f32 v171, v171, s68, -v8
    v_fma_f32 v172, v172, s68, -v8
    v_fma_f32 v173, v173, s68, -v8
    v_fma_f32 v174, v174, s68, -v8
    v_fma_f32 v175, v175, s68, -v8
    v_fma_f32 v176, v176, s68, -v8
    v_fma_f32 v177, v177, s68, -v8
    v_fma_f32 v178, v178, s68, -v8
    v_fma_f32 v179, v179, s68, -v8
    v_fma_f32 v180, v180, s68, -v8
    v_fma_f32 v181, v181, s68, -v8
    v_fma_f32 v182, v182, s68, -v8
    v_fma_f32 v183, v183, s68, -v8
    v_fma_f32 v184, v184, s68, -v8
    v_fma_f32 v185, v185, s68, -v8
    v_fma_f32 v186, v186, s68, -v8
    v_fma_f32 v187, v187, s68, -v8
    v_exp_f32 v168, v168
    v_exp_f32 v169, v169
    v_exp_f32 v170, v170
    v_exp_f32 v171, v171
    v_exp_f32 v172, v172
    v_exp_f32 v173, v173
    v_exp_f32 v174, v174
    v_exp_f32 v175, v175
    v_exp_f32 v176, v176
    v_exp_f32 v177, v177
    v_exp_f32 v178, v178
    v_exp_f32 v179, v179
    v_exp_f32 v180, v180
    v_exp_f32 v181, v181
    v_exp_f32 v182, v182
    v_exp_f32 v183, v183
    v_exp_f32 v184, v184
    v_exp_f32 v185, v185
    v_exp_f32 v186, v186
    v_exp_f32 v187, v187
    v_pk_add_f32 v[8:9], v[168:169], v[170:171]
    v_pk_add_f32 v[8:9], v[8:9], v[172:173]
    v_pk_add_f32 v[8:9], v[8:9], v[174:175]
    v_pk_add_f32 v[8:9], v[8:9], v[176:177]
    v_pk_add_f32 v[8:9], v[8:9], v[178:179]
    v_pk_add_f32 v[8:9], v[8:9], v[180:181]
    v_pk_add_f32 v[8:9], v[8:9], v[182:183]
    v_pk_add_f32 v[8:9], v[8:9], v[184:185]
    v_pk_add_f32 v[8:9], v[8:9], v[186:187]
    v_add_f32 v8, v8, v9
    v_mov_b32 v9, v8
    s_nop 1
    v_permlane32_swap_b32 v8, v9
    v_add_f32 v8, v8, v9
    v_rcp_f32 v8, v8
    s_nop 0
    v_pk_mul_f32 v[168:169], v[168:169], v[8:9] op_sel_hi:[1,0]
    s_nop 0
    v_cvt_pk_bf16_f32 v188, v168, v169
    v_pk_mul_f32 v[170:171], v[170:171], v[8:9] op_sel_hi:[1,0]
    s_nop 0
    v_cvt_pk_bf16_f32 v189, v170, v171
    v_pk_mul_f32 v[172:173], v[172:173], v[8:9] op_sel_hi:[1,0]
    s_nop 0
    v_cvt_pk_bf16_f32 v190, v172, v173
    v_pk_mul_f32 v[174:175], v[174:175], v[8:9] op_sel_hi:[1,0]
    s_nop 0
    v_cvt_pk_bf16_f32 v191, v174, v175
    v_pk_mul_f32 v[176:177], v[176:177], v[8:9] op_sel_hi:[1,0]
    s_nop 0
    v_cvt_pk_bf16_f32 v192, v176, v177
    v_pk_mul_f32 v[178:179], v[178:179], v[8:9] op_sel_hi:[1,0]
    s_nop 0
    v_cvt_pk_bf16_f32 v193, v178, v179
    v_pk_mul_f32 v[180:181], v[180:181], v[8:9] op_sel_hi:[1,0]
    s_nop 0
    v_cvt_pk_bf16_f32 v194, v180, v181
    v_pk_mul_f32 v[182:183], v[182:183], v[8:9] op_sel_hi:[1,0]
    s_nop 0
    v_cvt_pk_bf16_f32 v195, v182, v183
    v_pk_mul_f32 v[184:185], v[184:185], v[8:9] op_sel_hi:[1,0]
    s_nop 0
    v_cvt_pk_bf16_f32 v196, v184, v185
    v_pk_mul_f32 v[186:187], v[186:187], v[8:9] op_sel_hi:[1,0]
    s_nop 0
    v_cvt_pk_bf16_f32 v197, v186, v187
    s_waitcnt vmcnt(3)
    s_nop 0
    v_mfma_f32_32x32x8_bf16 v[16:31], v[144:145], v[196:197], 0
    s_waitcnt vmcnt(2)
    v_mfma_f32_32x32x8_bf16 v[32:47], v[146:147], v[196:197], 0
    s_waitcnt vmcnt(1)
    v_mfma_f32_32x32x8_bf16 v[48:63], v[148:149], v[196:197], 0
    s_waitcnt vmcnt(0)
    v_mfma_f32_32x32x8_bf16 v[64:79], v[150:151], v[196:197], 0
    v_mfma_f32_32x32x16_bf16 v[16:31], v[80:83], v[188:191], v[16:31]
    v_mfma_f32_32x32x16_bf16 v[16:31], v[84:87], v[192:195], v[16:31]
    v_mfma_f32_32x32x16_bf16 v[32:47], v[88:91], v[188:191], v[32:47]
    v_mfma_f32_32x32x16_bf16 v[32:47], v[92:95], v[192:195], v[32:47]
    v_mfma_f32_32x32x16_bf16 v[48:63], v[96:99], v[188:191], v[48:63]
    v_mfma_f32_32x32x16_bf16 v[48:63], v[100:103], v[192:195], v[48:63]
    v_mfma_f32_32x32x16_bf16 v[64:79], v[104:107], v[188:191], v[64:79]
    v_mfma_f32_32x32x16_bf16 v[64:79], v[108:111], v[192:195], v[64:79]
    s_mul_i32 s35, s30, 16777216
    s_add_u32 s35, s35, 67108864
    s_lshl_b32 s36, s44, 18
    s_add_u32 s35, s35, s36
    s_lshl_b32 s36, s40, 12
    s_add_u32 s35, s35, s36
    v_cvt_pk_bf16_f32 v112, v16, v17
    v_cvt_pk_bf16_f32 v113, v18, v19
    v_cvt_pk_bf16_f32 v114, v20, v21
    v_cvt_pk_bf16_f32 v115, v22, v23
    v_cvt_pk_bf16_f32 v116, v24, v25
    v_cvt_pk_bf16_f32 v117, v26, v27
    v_cvt_pk_bf16_f32 v118, v28, v29
    v_cvt_pk_bf16_f32 v119, v30, v31
    v_cvt_pk_bf16_f32 v120, v32, v33
    v_cvt_pk_bf16_f32 v121, v34, v35
    v_cvt_pk_bf16_f32 v122, v36, v37
    v_cvt_pk_bf16_f32 v123, v38, v39
    v_cvt_pk_bf16_f32 v124, v40, v41
    v_cvt_pk_bf16_f32 v125, v42, v43
    v_cvt_pk_bf16_f32 v126, v44, v45
    v_cvt_pk_bf16_f32 v127, v46, v47
    v_cvt_pk_bf16_f32 v128, v48, v49
    v_cvt_pk_bf16_f32 v129, v50, v51
    v_cvt_pk_bf16_f32 v130, v52, v53
    v_cvt_pk_bf16_f32 v131, v54, v55
    v_cvt_pk_bf16_f32 v132, v56, v57
    v_cvt_pk_bf16_f32 v133, v58, v59
    v_cvt_pk_bf16_f32 v134, v60, v61
    v_cvt_pk_bf16_f32 v135, v62, v63
    v_cvt_pk_bf16_f32 v136, v64, v65
    v_cvt_pk_bf16_f32 v137, v66, v67
    v_cvt_pk_bf16_f32 v138, v68, v69
    v_cvt_pk_bf16_f32 v139, v70, v71
    v_cvt_pk_bf16_f32 v140, v72, v73
    v_cvt_pk_bf16_f32 v141, v74, v75
    v_cvt_pk_bf16_f32 v142, v76, v77
    v_cvt_pk_bf16_f32 v143, v78, v79
    buffer_store_dwordx4 v[112:115], v6, s[4:7], s35 offen offset:0 sc1
    buffer_store_dwordx4 v[116:119], v6, s[4:7], s35 offen offset:512 sc1
    buffer_store_dwordx4 v[120:123], v6, s[4:7], s35 offen offset:1024 sc1
    buffer_store_dwordx4 v[124:127], v6, s[4:7], s35 offen offset:1536 sc1
    buffer_store_dwordx4 v[128:131], v6, s[4:7], s35 offen offset:2048 sc1
    buffer_store_dwordx4 v[132:135], v6, s[4:7], s35 offen offset:2560 sc1
    buffer_store_dwordx4 v[136:139], v6, s[4:7], s35 offen offset:3072 sc1
    buffer_store_dwordx4 v[140:143], v6, s[4:7], s35 offen offset:3584 sc1
    s_waitcnt vmcnt(0)
    s_lshl_b32 s32, s28, 5
    s_add_u32 s32, s32, s29
    s_lshl_b32 s32, s32, 2
    s_add_u32 s32, s32, 1171456
    v_mov_b32 v8, s49
    s_mov_b64 exec, 1
    buffer_store_dword v8, off, s[4:7], s32 sc1
    s_mov_b64 exec, -1
F_358:
    s_add_u32 s49, s49, 1
    s_add_u32 s44, s44, 4
    s_cmp_lt_u32 s44, 64
    s_cbranch_scc1 AT_351
R_350:
    s_and_b32 s32, s28, 0xbf
    s_cmp_ge_u32 s32, 60
    s_cbranch_scc1 R_359
    s_and_b32 s34, s28, 63
    s_mul_i32 s68, s34, 3277
    s_lshr_b32 s68, s68, 16
    s_mul_i32 s69, s68, 20
    s_sub_u32 s69, s34, s69
    s_cmp_ge_u32 s28, 64
    s_cselect_b32 s34, 63, 0
    s_add_u32 s68, s68, s34
    s_mov_b64 s[16:17], s[92:93]
    s_mov_b32 s18, 5242880
    s_mov_b32 s19, 0x20000
    v_bfe_u32 v2, v1, 2, 4
    v_mul_u32_u24 v2, 1280, v2
    v_bfe_u32 v8, v1, 0, 2
    v_lshl_add_u32 v2, v8, 4, v2
    s_lshl_b32 s36, s29, 14
    v_bfe_u32 v3, v1, 4, 2
    v_mul_u32_u24 v3, 512, v3
    v_bfe_u32 v8, v1, 2, 2
    v_lshl_add_u32 v3, v8, 6, v3
    v_bfe_u32 v8, v1, 0, 2
    v_lshl_add_u32 v3, v8, 4, v3
    v_add_u32 v3, s36, v3
    s_mul_i32 s34, s29, 1310720
    s_lshl_b32 s35, s69, 6
    s_add_u32 s34, s34, s35
    s_add_u32 m0, s36, 0
    s_add_u32 s35, s34, 0
    buffer_load_dwordx4 v2, s[16:19], s35 offen lds
    s_add_u32 m0, s36, 1024
    s_add_u32 s35, s34, 20480
    buffer_load_dwordx4 v2, s[16:19], s35 offen lds
    s_add_u32 m0, s36, 2048
    s_add_u32 s35, s34, 40960
    buffer_load_dwordx4 v2, s[16:19], s35 offen lds
    s_add_u32 m0, s36, 3072
    s_add_u32 s35, s34, 61440
    buffer_load_dwordx4 v2, s[16:19], s35 offen lds
    s_add_u32 m0, s36, 4096
    s_add_u32 s35, s34, 81920
    buffer_load_dwordx4 v2, s[16:19], s35 offen lds
    s_add_u32 m0, s36, 5120
    s_add_u32 s35, s34, 102400
    buffer_load_dwordx4 v2, s[16:19], s35 offen lds
    s_add_u32 m0, s36, 6144
    s_add_u32 s35, s34, 122880
    buffer_load_dwordx4 v2, s[16:19], s35 offen lds
    s_add_u32 m0, s36, 7168
    s_add_u32 s35, s34, 143360
    buffer_load_dwordx4 v2, s[16:19], s35 offen lds
    s_add_u32 m0, s36, 8192
    s_add_u32 s35, s34, 163840
    buffer_load_dwordx4 v2, s[16:19], s35 offen lds
    s_add_u32 m0, s36, 9216
    s_add_u32 s35, s34, 184320
    buffer_load_dwordx4 v2, s[16:19], s35 offen lds
    s_add_u32 m0, s36, 10240
    s_add_u32 s35, s34, 204800
    buffer_load_dwordx4 v2, s[16:19], s35 offen lds
    s_add_u32 m0, s36, 11264
    s_add_u32 s35, s34, 225280
    buffer_load_dwordx4 v2, s[16:19], s35 offen lds
    s_add_u32 m0, s36, 12288
    s_add_u32 s35, s34, 245760
    buffer_load_dwordx4 v2, s[16:19], s35 offen lds
    s_add_u32 m0, s36, 13312
    s_add_u32 s35, s34, 266240
    buffer_load_dwordx4 v2, s[16:19], s35 offen lds
    s_add_u32 m0, s36, 14336
    s_add_u32 s35, s34, 286720
    buffer_load_dwordx4 v2, s[16:19], s35 offen lds
    s_add_u32 m0, s36, 15360
    s_add_u32 s35, s34, 307200
    buffer_load_dwordx4 v2, s[16:19], s35 offen lds
    s_waitcnt vmcnt(0)
    ds_read_b64_tr_b16 v[96:97], v3 offset:0
    ds_read_b64_tr_b16 v[98:99], v3 offset:256
    ds_read_b64_tr_b16 v[100:101], v3 offset:8
    ds_read_b64_tr_b16 v[102:103], v3 offset:264
    ds_read_b64_tr_b16 v[104:105], v3 offset:2048
    ds_read_b64_tr_b16 v[106:107], v3 offset:2304
    ds_read_b64_tr_b16 v[108:109], v3 offset:2056
    ds_read_b64_tr_b16 v[110:111], v3 offset:2312
    ds_read_b64_tr_b16 v[112:113], v3 offset:4096
    ds_read_b64_tr_b16 v[114:115], v3 offset:4352
    ds_read_b64_tr_b16 v[116:117], v3 offset:4104
    ds_read_b64_tr_b16 v[118:119], v3 offset:4360
    ds_read_b64_tr_b16 v[120:121], v3 offset:6144
    ds_read_b64_tr_b16 v[122:123], v3 offset:6400
    ds_read_b64_tr_b16 v[124:125], v3 offset:6152
    ds_read_b64_tr_b16 v[126:127], v3 offset:6408
    ds_read_b64_tr_b16 v[128:129], v3 offset:8192
    ds_read_b64_tr_b16 v[130:131], v3 offset:8448
    ds_read_b64_tr_b16 v[132:133], v3 offset:8200
    ds_read_b64_tr_b16 v[134:135], v3 offset:8456
    ds_read_b64_tr_b16 v[136:137], v3 offset:10240
    ds_read_b64_tr_b16 v[138:139], v3 offset:10496
    ds_read_b64_tr_b16 v[140:141], v3 offset:10248
    ds_read_b64_tr_b16 v[142:143], v3 offset:10504
    ds_read_b64_tr_b16 v[144:145], v3 offset:12288
    ds_read_b64_tr_b16 v[146:147], v3 offset:12544
    ds_read_b64_tr_b16 v[148:149], v3 offset:12296
    ds_read_b64_tr_b16 v[150:151], v3 offset:12552
    ds_read_b64_tr_b16 v[152:153], v3 offset:14336
    ds_read_b64_tr_b16 v[154:155], v3 offset:14592
    ds_read_b64_tr_b16 v[156:157], v3 offset:14344
    ds_read_b64_tr_b16 v[158:159], v3 offset:14600
    s_waitcnt lgkmcnt(0)
    s_add_u32 m0, s36, 0
    s_add_u32 s35, s34, 327680
    buffer_load_dwordx4 v2, s[16:19], s35 offen lds
    s_add_u32 m0, s36, 1024
    s_add_u32 s35, s34, 348160
    buffer_load_dwordx4 v2, s[16:19], s35 offen lds
    s_add_u32 m0, s36, 2048
    s_add_u32 s35, s34, 368640
    buffer_load_dwordx4 v2, s[16:19], s35 offen lds
    s_add_u32 m0, s36, 3072
    s_add_u32 s35, s34, 389120
    buffer_load_dwordx4 v2, s[16:19], s35 offen lds
    s_add_u32 m0, s36, 4096
    s_add_u32 s35, s34, 409600
    buffer_load_dwordx4 v2, s[16:19], s35 offen lds
    s_add_u32 m0, s36, 5120
    s_add_u32 s35, s34, 430080
    buffer_load_dwordx4 v2, s[16:19], s35 offen lds
    s_add_u32 m0, s36, 6144
    s_add_u32 s35, s34, 450560
    buffer_load_dwordx4 v2, s[16:19], s35 offen lds
    s_add_u32 m0, s36, 7168
    s_add_u32 s35, s34, 471040
    buffer_load_dwordx4 v2, s[16:19], s35 offen lds
    s_add_u32 m0, s36, 8192
    s_add_u32 s35, s34, 491520
    buffer_load_dwordx4 v2, s[16:19], s35 offen lds
    s_add_u32 m0, s36, 9216
    s_add_u32 s35, s34, 512000
    buffer_load_dwordx4 v2, s[16:19], s35 offen lds
    s_add_u32 m0, s36, 10240
    s_add_u32 s35, s34, 532480
    buffer_load_dwordx4 v2, s[16:19], s35 offen lds
    s_add_u32 m0, s36, 11264
    s_add_u32 s35, s34, 552960
    buffer_load_dwordx4 v2, s[16:19], s35 offen lds
    s_add_u32 m0, s36, 12288
    s_add_u32 s35, s34, 573440
    buffer_load_dwordx4 v2, s[16:19], s35 offen lds
    s_add_u32 m0, s36, 13312
    s_add_u32 s35, s34, 593920
    buffer_load_dwordx4 v2, s[16:19], s35 offen lds
    s_add_u32 m0, s36, 14336
    s_add_u32 s35, s34, 614400
    buffer_load_dwordx4 v2, s[16:19], s35 offen lds
    s_add_u32 m0, s36, 15360
    s_add_u32 s35, s34, 634880
    buffer_load_dwordx4 v2, s[16:19], s35 offen lds
    s_waitcnt vmcnt(0)
    ds_read_b64_tr_b16 v[160:161], v3 offset:0
    ds_read_b64_tr_b16 v[162:163], v3 offset:256
    ds_read_b64_tr_b16 v[164:165], v3 offset:8
    ds_read_b64_tr_b16 v[166:167], v3 offset:264
    ds_read_b64_tr_b16 v[168:169], v3 offset:2048
    ds_read_b64_tr_b16 v[170:171], v3 offset:2304
    ds_read_b64_tr_b16 v[172:173], v3 offset:2056
    ds_read_b64_tr_b16 v[174:175], v3 offset:2312
    ds_read_b64_tr_b16 v[176:177], v3 offset:4096
    ds_read_b64_tr_b16 v[178:179], v3 offset:4352
    ds_read_b64_tr_b16 v[180:181], v3 offset:4104
    ds_read_b64_tr_b16 v[182:183], v3 offset:4360
    ds_read_b64_tr_b16 v[184:185], v3 offset:6144
    ds_read_b64_tr_b16 v[186:187], v3 offset:6400
    ds_read_b64_tr_b16 v[188:189], v3 offset:6152
    ds_read_b64_tr_b16 v[190:191], v3 offset:6408
    ds_read_b64_tr_b16 v[192:193], v3 offset:8192
    ds_read_b64_tr_b16 v[194:195], v3 offset:8448
    ds_read_b64_tr_b16 v[196:197], v3 offset:8200
    ds_read_b64_tr_b16 v[198:199], v3 offset:8456
    ds_read_b64_tr_b16 v[200:201], v3 offset:10240
    ds_read_b64_tr_b16 v[202:203], v3 offset:10496
    ds_read_b64_tr_b16 v[204:205], v3 offset:10248
    ds_read_b64_tr_b16 v[206:207], v3 offset:10504
    ds_read_b64_tr_b16 v[208:209], v3 offset:12288
    ds_read_b64_tr_b16 v[210:211], v3 offset:12544
    ds_read_b64_tr_b16 v[212:213], v3 offset:12296
    ds_read_b64_tr_b16 v[214:215], v3 offset:12552
    ds_read_b64_tr_b16 v[216:217], v3 offset:14336
    ds_read_b64_tr_b16 v[218:219], v3 offset:14592
    ds_read_b64_tr_b16 v[220:221], v3 offset:14344
    ds_read_b64_tr_b16 v[222:223], v3 offset:14600
    s_waitcnt lgkmcnt(0)
    s_add_u32 m0, s36, 0
    s_add_u32 s35, s34, 655360
    buffer_load_dwordx4 v2, s[16:19], s35 offen lds
    s_add_u32 m0, s36, 1024
    s_add_u32 s35, s34, 675840
    buffer_load_dwordx4 v2, s[16:19], s35 offen lds
    s_add_u32 m0, s36, 2048
    s_add_u32 s35, s34, 696320
    buffer_load_dwordx4 v2, s[16:19], s35 offen lds
    s_add_u32 m0, s36, 3072
    s_add_u32 s35, s34, 716800
    buffer_load_dwordx4 v2, s[16:19], s35 offen lds
    s_add_u32 m0, s36, 4096
    s_add_u32 s35, s34, 737280
    buffer_load_dwordx4 v2, s[16:19], s35 offen lds
    s_add_u32 m0, s36, 5120
    s_add_u32 s35, s34, 757760
    buffer_load_dwordx4 v2, s[16:19], s35 offen lds
    s_add_u32 m0, s36, 6144
    s_add_u32 s35, s34, 778240
    buffer_load_dwordx4 v2, s[16:19], s35 offen lds
    s_add_u32 m0, s36, 7168
    s_add_u32 s35, s34, 798720
    buffer_load_dwordx4 v2, s[16:19], s35 offen lds
    s_add_u32 m0, s36, 8192
    s_add_u32 s35, s34, 819200
    buffer_load_dwordx4 v2, s[16:19], s35 offen lds
    s_add_u32 m0, s36, 9216
    s_add_u32 s35, s34, 839680
    buffer_load_dwordx4 v2, s[16:19], s35 offen lds
    s_add_u32 m0, s36, 10240
    s_add_u32 s35, s34, 860160
    buffer_load_dwordx4 v2, s[16:19], s35 offen lds
    s_add_u32 m0, s36, 11264
    s_add_u32 s35, s34, 880640
    buffer_load_dwordx4 v2, s[16:19], s35 offen lds
    s_add_u32 m0, s36, 12288
    s_add_u32 s35, s34, 901120
    buffer_load_dwordx4 v2, s[16:19], s35 offen lds
    s_add_u32 m0, s36, 13312
    s_add_u32 s35, s34, 921600
    buffer_load_dwordx4 v2, s[16:19], s35 offen lds
    s_add_u32 m0, s36, 14336
    s_add_u32 s35, s34, 942080
    buffer_load_dwordx4 v2, s[16:19], s35 offen lds
    s_add_u32 m0, s36, 15360
    s_add_u32 s35, s34, 962560
    buffer_load_dwordx4 v2, s[16:19], s35 offen lds
    s_waitcnt vmcnt(0)
    ds_read_b64_tr_b16 v[224:225], v3 offset:0
    ds_read_b64_tr_b16 v[226:227], v3 offset:256
    ds_read_b64_tr_b16 v[228:229], v3 offset:8
    ds_read_b64_tr_b16 v[230:231], v3 offset:264
    ds_read_b64_tr_b16 v[232:233], v3 offset:2048
    ds_read_b64_tr_b16 v[234:235], v3 offset:2304
    ds_read_b64_tr_b16 v[236:237], v3 offset:2056
    ds_read_b64_tr_b16 v[238:239], v3 offset:2312
    ds_read_b64_tr_b16 v[240:241], v3 offset:4096
    ds_read_b64_tr_b16 v[242:243], v3 offset:4352
    ds_read_b64_tr_b16 v[244:245], v3 offset:4104
    ds_read_b64_tr_b16 v[246:247], v3 offset:4360
    ds_read_b64_tr_b16 v[248:249], v3 offset:6144
    ds_read_b64_tr_b16 v[250:251], v3 offset:6400
    ds_read_b64_tr_b16 v[252:253], v3 offset:6152
    ds_read_b64_tr_b16 v[254:255], v3 offset:6408
    ds_read_b64_tr_b16 a[160:161], v3 offset:8192
    ds_read_b64_tr_b16 a[162:163], v3 offset:8448
    ds_read_b64_tr_b16 a[164:165], v3 offset:8200
    ds_read_b64_tr_b16 a[166:167], v3 offset:8456
    ds_read_b64_tr_b16 a[168:169], v3 offset:10240
    ds_read_b64_tr_b16 a[170:171], v3 offset:10496
    ds_read_b64_tr_b16 a[172:173], v3 offset:10248
    ds_read_b64_tr_b16 a[174:175], v3 offset:10504
    ds_read_b64_tr_b16 a[176:177], v3 offset:12288
    ds_read_b64_tr_b16 a[178:179], v3 offset:12544
    ds_read_b64_tr_b16 a[180:181], v3 offset:12296
    ds_read_b64_tr_b16 a[182:183], v3 offset:12552
    ds_read_b64_tr_b16 a[184:185], v3 offset:14336
    ds_read_b64_tr_b16 a[186:187], v3 offset:14592
    ds_read_b64_tr_b16 a[188:189], v3 offset:14344
    ds_read_b64_tr_b16 a[190:191], v3 offset:14600
    s_waitcnt lgkmcnt(0)
    s_add_u32 m0, s36, 0
    s_add_u32 s35, s34, 983040
    buffer_load_dwordx4 v2, s[16:19], s35 offen lds
    s_add_u32 m0, s36, 1024
    s_add_u32 s35, s34, 1003520
    buffer_load_dwordx4 v2, s[16:19], s35 offen lds
    s_add_u32 m0, s36, 2048
    s_add_u32 s35, s34, 1024000
    buffer_load_dwordx4 v2, s[16:19], s35 offen lds
    s_add_u32 m0, s36, 3072
    s_add_u32 s35, s34, 1044480
    buffer_load_dwordx4 v2, s[16:19], s35 offen lds
    s_add_u32 m0, s36, 4096
    s_add_u32 s35, s34, 1064960
    buffer_load_dwordx4 v2, s[16:19], s35 offen lds
    s_add_u32 m0, s36, 5120
    s_add_u32 s35, s34, 1085440
    buffer_load_dwordx4 v2, s[16:19], s35 offen lds
    s_add_u32 m0, s36, 6144
    s_add_u32 s35, s34, 1105920
    buffer_load_dwordx4 v2, s[16:19], s35 offen lds
    s_add_u32 m0, s36, 7168
    s_add_u32 s35, s34, 1126400
    buffer_load_dwordx4 v2, s[16:19], s35 offen lds
    s_add_u32 m0, s36, 8192
    s_add_u32 s35, s34, 1146880
    buffer_load_dwordx4 v2, s[16:19], s35 offen lds
    s_add_u32 m0, s36, 9216
    s_add_u32 s35, s34, 1167360
    buffer_load_dwordx4 v2, s[16:19], s35 offen lds
    s_add_u32 m0, s36, 10240
    s_add_u32 s35, s34, 1187840
    buffer_load_dwordx4 v2, s[16:19], s35 offen lds
    s_add_u32 m0, s36, 11264
    s_add_u32 s35, s34, 1208320
    buffer_load_dwordx4 v2, s[16:19], s35 offen lds
    s_add_u32 m0, s36, 12288
    s_add_u32 s35, s34, 1228800
    buffer_load_dwordx4 v2, s[16:19], s35 offen lds
    s_add_u32 m0, s36, 13312
    s_add_u32 s35, s34, 1249280
    buffer_load_dwordx4 v2, s[16:19], s35 offen lds
    s_add_u32 m0, s36, 14336
    s_add_u32 s35, s34, 1269760
    buffer_load_dwordx4 v2, s[16:19], s35 offen lds
    s_add_u32 m0, s36, 15360
    s_add_u32 s35, s34, 1290240
    buffer_load_dwordx4 v2, s[16:19], s35 offen lds
    s_waitcnt vmcnt(0)
    ds_read_b64_tr_b16 a[192:193], v3 offset:0
    ds_read_b64_tr_b16 a[194:195], v3 offset:256
    ds_read_b64_tr_b16 a[196:197], v3 offset:8
    ds_read_b64_tr_b16 a[198:199], v3 offset:264
    ds_read_b64_tr_b16 a[200:201], v3 offset:2048
    ds_read_b64_tr_b16 a[202:203], v3 offset:2304
    ds_read_b64_tr_b16 a[204:205], v3 offset:2056
    ds_read_b64_tr_b16 a[206:207], v3 offset:2312
    ds_read_b64_tr_b16 a[208:209], v3 offset:4096
    ds_read_b64_tr_b16 a[210:211], v3 offset:4352
    ds_read_b64_tr_b16 a[212:213], v3 offset:4104
    ds_read_b64_tr_b16 a[214:215], v3 offset:4360
    ds_read_b64_tr_b16 a[216:217], v3 offset:6144
    ds_read_b64_tr_b16 a[218:219], v3 offset:6400
    ds_read_b64_tr_b16 a[220:221], v3 offset:6152
    ds_read_b64_tr_b16 a[222:223], v3 offset:6408
    ds_read_b64_tr_b16 a[224:225], v3 offset:8192
    ds_read_b64_tr_b16 a[226:227], v3 offset:8448
    ds_read_b64_tr_b16 a[228:229], v3 offset:8200
    ds_read_b64_tr_b16 a[230:231], v3 offset:8456
    ds_read_b64_tr_b16 a[232:233], v3 offset:10240
    ds_read_b64_tr_b16 a[234:235], v3 offset:10496
    ds_read_b64_tr_b16 a[236:237], v3 offset:10248
    ds_read_b64_tr_b16 a[238:239], v3 offset:10504
    ds_read_b64_tr_b16 a[240:241], v3 offset:12288
    ds_read_b64_tr_b16 a[242:243], v3 offset:12544
    ds_read_b64_tr_b16 a[244:245], v3 offset:12296
    ds_read_b64_tr_b16 a[246:247], v3 offset:12552
    ds_read_b64_tr_b16 a[248:249], v3 offset:14336
    ds_read_b64_tr_b16 a[250:251], v3 offset:14592
    ds_read_b64_tr_b16 a[252:253], v3 offset:14344
    ds_read_b64_tr_b16 a[254:255], v3 offset:14600
    s_waitcnt lgkmcnt(0)
    v_bfe_u32 v4, v1, 4, 2
    v_mul_u32_u24 v4, 512, v4
    v_bfe_u32 v8, v1, 0, 4
    v_lshl_add_u32 v4, v8, 4, v4
    v_bfe_u32 v5, v1, 0, 2
    v_mul_u32_u24 v5, 1280, v5
    v_bfe_u32 v8, v1, 2, 1
    v_mul_u32_u24 v8, 10240, v8
    v_add_u32 v5, v5, v8
    v_bfe_u32 v8, v1, 3, 1
    v_mul_u32_u24 v8, 5120, v8
    v_add_u32 v5, v5, v8
    v_bfe_u32 v8, v1, 4, 2
    v_lshl_add_u32 v5, v8, 4, v5
    s_lshl_b32 s34, s29, 10
    s_add_u32 s34, s34, 1187840
    v_bfe_u32 v6, v1, 0, 3
    v_mul_u32_u24 v6, 128, v6
    v_add_u32 v6, s34, v6
    s_lshl_b32 s34, s29, 11
    v_add_u32 v7, s34, v0
    s_mov_b32 s45, s68
    s_mov_b32 s56, 0
    s_mov_b32 s75, 0
    s_lshl_b32 s53, s28, 7
    s_add_u32 s53, s53, 1196032
    s_lshr_b32 s57, s45, 3
    s_add_u32 s57, s57, s61
    s_add_u32 s57, s57, 1
    s_and_b32 s59, s45, 6
    s_lshl_b32 s59, s59, 1
    s_waitcnt vmcnt(0) lgkmcnt(0)
    s_barrier
G4_363:
    s_mov_b32 s48, 0
P_366:
    buffer_load_dword v8, v6, s[4:7], s59 offen sc1
    s_waitcnt vmcnt(0)
    v_cmp_gt_u32 vcc, s57, v8
    s_cbranch_vccz P_367
    s_add_u32 s48, s48, 1
    s_cmp_gt_u32 s48, 200000
    s_cbranch_scc1 L_end
    s_sleep 1
    s_branch P_366
P_367:
G4_360:
    s_mov_b32 s44, s45
    s_mul_i32 s54, s30, 16777216
    s_add_u32 s54, s54, 67108864
    s_lshl_b32 s34, s44, 17
    s_add_u32 s54, s54, s34
    s_lshl_b32 s34, s29, 15
    s_add_u32 s54, s54, s34
    buffer_load_dwordx4 v[32:35], v0, s[4:7], s54 offen offset:0 sc1
    buffer_load_dwordx4 v[36:39], v0, s[4:7], s54 offen offset:1024 sc1
    buffer_load_dwordx4 v[40:43], v0, s[4:7], s54 offen offset:2048 sc1
    buffer_load_dwordx4 v[44:47], v0, s[4:7], s54 offen offset:3072 sc1
    s_add_u32 s54, s54, 4096
    buffer_load_dwordx4 v[48:51], v0, s[4:7], s54 offen offset:0 sc1
    buffer_load_dwordx4 v[52:55], v0, s[4:7], s54 offen offset:1024 sc1
    buffer_load_dwordx4 v[56:59], v0, s[4:7], s54 offen offset:2048 sc1
    buffer_load_dwordx4 v[60:63], v0, s[4:7], s54 offen offset:3072 sc1
    s_add_u32 s54, s54, 4096
    buffer_load_dwordx4 v[64:67], v0, s[4:7], s54 offen offset:0 sc1
    buffer_load_dwordx4 v[68:71], v0, s[4:7], s54 offen offset:1024 sc1
    buffer_load_dwordx4 v[72:75], v0, s[4:7], s54 offen offset:2048 sc1
    buffer_load_dwordx4 v[76:79], v0, s[4:7], s54 offen offset:3072 sc1
    s_add_u32 s54, s54, 4096
    buffer_load_dwordx4 v[80:83], v0, s[4:7], s54 offen offset:0 sc1
    buffer_load_dwordx4 v[84:87], v0, s[4:7], s54 offen offset:1024 sc1
    buffer_load_dwordx4 v[88:91], v0, s[4:7], s54 offen offset:2048 sc1
    buffer_load_dwordx4 v[92:95], v0, s[4:7], s54 offen offset:3072 sc1
    s_lshr_b32 s40, s44, 1
    s_and_b32 s41, s44, 1
    s_mul_i32 s42, s40, 40960
    s_lshl_b32 s34, s69, 11
    s_add_u32 s43, s42, s34
    s_lshl_b32 s34, s41, 8
    s_add_u32 s43, s43, s34
    s_mul_i32 s34, s30, 6291456
    s_add_u32 s34, s34, 11534336
    s_add_u32 s34, s34, s43
    buffer_load_dwordx4 v[24:27], v4, s[4:7], s34 offen sc1
    s_cmp_lt_u32 s44, 60
    s_cselect_b32 s34, 3, 6
    s_add_u32 s45, s44, s34
    s_lshr_b32 s57, s45, 3
    s_add_u32 s57, s57, s61
    s_add_u32 s57, s57, 1
    s_and_b32 s59, s45, 6
    s_lshl_b32 s59, s59, 1
    s_waitcnt vmcnt(16)
    v_mfma_f32_16x16x32_bf16 v[16:19], v[96:99], v[32:35], 0
    v_mfma_f32_16x16x32_bf16 v[20:23], v[100:103], v[32:35], 0
    s_add_u32 s54, s54, 4096
    buffer_load_dwordx4 v[32:35], v0, s[4:7], s54 offen offset:0 sc1
    s_waitcnt vmcnt(16)
    v_mfma_f32_16x16x32_bf16 v[16:19], v[104:107], v[36:39], v[16:19]
    v_mfma_f32_16x16x32_bf16 v[20:23], v[108:111], v[36:39], v[20:23]
    buffer_load_dwordx4 v[36:39], v0, s[4:7], s54 offen offset:1024 sc1
    s_waitcnt vmcnt(16)
    v_mfma_f32_16x16x32_bf16 v[16:19], v[112:115], v[40:43], v[16:19]
    v_mfma_f32_16x16x32_bf16 v[20:23], v[116:119], v[40:43], v[20:23]
    buffer_load_dwordx4 v[40:43], v0, s[4:7], s54 offen offset:2048 sc1
    s_waitcnt vmcnt(16)
    v_mfma_f32_16x16x32_bf16 v[16:19], v[120:123], v[44:47], v[16:19]
    v_mfma_f32_16x16x32_bf16 v[20:23], v[124:127], v[44:47], v[20:23]
    buffer_load_dwordx4 v[44:47], v0, s[4:7], s54 offen offset:3072 sc1
    s_waitcnt vmcnt(16)
    v_mfma_f32_16x16x32_bf16 v[16:19], v[128:131], v[48:51], v[16:19]
    v_mfma_f32_16x16x32_bf16 v[20:23], v[132:135], v[48:51], v[20:23]
    s_add_u32 s54, s54, 4096
    buffer_load_dwordx4 v[48:51], v0, s[4:7], s54 offen offset:0 sc1
    s_waitcnt vmcnt(16)
    v_mfma_f32_16x16x32_bf16 v[16:19], v[136:139], v[52:55], v[16:19]
    v_mfma_f32_16x16x32_bf16 v[20:23], v[140:143], v[52:55], v[20:23]
    buffer_load_dwordx4 v[52:55], v0, s[4:7], s54 offen offset:1024 sc1
    s_waitcnt vmcnt(16)
    v_mfma_f32_16x16x32_bf16 v[16:19], v[144:147], v[56:59], v[16:19]
    v_mfma_f32_16x16x32_bf16 v[20:23], v[148:151], v[56:59], v[20:23]
    buffer_load_dwordx4 v[56:59], v0, s[4:7], s54 offen offset:2048 sc1
    s_waitcnt vmcnt(16)
    v_mfma_f32_16x16x32_bf16 v[16:19], v[152:155], v[60:63], v[16:19]
    v_mfma_f32_16x16x32_bf16 v[20:23], v[156:159], v[60:63], v[20:23]
    buffer_load_dwordx4 v[60:63], v0, s[4:7], s54 offen offset:3072 sc1
    s_waitcnt vmcnt(16)
    v_mfma_f32_16x16x32_bf16 v[16:19], v[160:163], v[64:67], v[16:19]
    v_mfma_f32_16x16x32_bf16 v[20:23], v[164:167], v[64:67], v[20:23]
    s_add_u32 s54, s54, 4096
    buffer_load_dwordx4 v[64:67], v0, s[4:7], s54 offen offset:0 sc1
    s_waitcnt vmcnt(16)
    v_mfma_f32_16x16x32_bf16 v[16:19], v[168:171], v[68:71], v[16:19]
    v_mfma_f32_16x16x32_bf16 v[20:23], v[172:175], v[68:71], v[20:23]
    buffer_load_dwordx4 v[68:71], v0, s[4:7], s54 offen offset:1024 sc1
    s_waitcnt vmcnt(16)
    v_mfma_f32_16x16x32_bf16 v[16:19], v[176:179], v[72:75], v[16:19]
    v_mfma_f32_16x16x32_bf16 v[20:23], v[180:183], v[72:75], v[20:23]
    buffer_load_dwordx4 v[72:75], v0, s[4:7], s54 offen offset:2048 sc1
    s_waitcnt vmcnt(16)
    v_mfma_f32_16x16x32_bf16 v[16:19], v[184:187], v[76:79], v[16:19]
    v_mfma_f32_16x16x32_bf16 v[20:23], v[188:191], v[76:79], v[20:23]
    buffer_load_dwordx4 v[76:79], v0, s[4:7], s54 offen offset:3072 sc1
    s_waitcnt vmcnt(16)
    v_mfma_f32_16x16x32_bf16 v[16:19], v[192:195], v[80:83], v[16:19]
    v_mfma_f32_16x16x32_bf16 v[20:23], v[196:199], v[80:83], v[20:23]
    s_add_u32 s54, s54, 4096
    buffer_load_dwordx4 v[80:83], v0, s[4:7], s54 offen offset:0 sc1
    s_waitcnt vmcnt(16)
    v_mfma_f32_16x16x32_bf16 v[16:19], v[200:203], v[84:87], v[16:19]
    v_mfma_f32_16x16x32_bf16 v[20:23], v[204:207], v[84:87], v[20:23]
    buffer_load_dwordx4 v[84:87], v0, s[4:7], s54 offen offset:1024 sc1
    s_waitcnt vmcnt(16)
    v_mfma_f32_16x16x32_bf16 v[16:19], v[208:211], v[88:91], v[16:19]
    v_mfma_f32_16x16x32_bf16 v[20:23], v[212:215], v[88:91], v[20:23]
    buffer_load_dwordx4 v[88:91], v0, s[4:7], s54 offen offset:2048 sc1
    s_waitcnt vmcnt(16)
    v_mfma_f32_16x16x32_bf16 v[16:19], v[216:219], v[92:95], v[16:19]
    v_mfma_f32_16x16x32_bf16 v[20:23], v[220:223], v[92:95], v[20:23]
    buffer_load_dwordx4 v[92:95], v0, s[4:7], s54 offen offset:3072 sc1
    buffer_load_dword v28, v6, s[4:7], s59 offen sc1
    s_waitcnt vmcnt(16)
    v_mfma_f32_16x16x32_bf16 v[16:19], v[224:227], v[32:35], v[16:19]
    v_mfma_f32_16x16x32_bf16 v[20:23], v[228:231], v[32:35], v[20:23]
    s_waitcnt vmcnt(15)
    v_mfma_f32_16x16x32_bf16 v[16:19], v[232:235], v[36:39], v[16:19]
    v_mfma_f32_16x16x32_bf16 v[20:23], v[236:239], v[36:39], v[20:23]
    s_waitcnt vmcnt(14)
    v_mfma_f32_16x16x32_bf16 v[16:19], v[240:243], v[40:43], v[16:19]
    v_mfma_f32_16x16x32_bf16 v[20:23], v[244:247], v[40:43], v[20:23]
    s_waitcnt vmcnt(13)
    v_mfma_f32_16x16x32_bf16 v[16:19], v[248:251], v[44:47], v[16:19]
    v_mfma_f32_16x16x32_bf16 v[20:23], v[252:255], v[44:47], v[20:23]
    s_waitcnt vmcnt(12)
    v_mfma_f32_16x16x32_bf16 v[16:19], a[160:163], v[48:51], v[16:19]
    v_mfma_f32_16x16x32_bf16 v[20:23], a[164:167], v[48:51], v[20:23]
    s_waitcnt vmcnt(11)
    v_mfma_f32_16x16x32_bf16 v[16:19], a[168:171], v[52:55], v[16:19]
    v_mfma_f32_16x16x32_bf16 v[20:23], a[172:175], v[52:55], v[20:23]
    s_waitcnt vmcnt(10)
    v_mfma_f32_16x16x32_bf16 v[16:19], a[176:179], v[56:59], v[16:19]
    v_mfma_f32_16x16x32_bf16 v[20:23], a[180:183], v[56:59], v[20:23]
    s_waitcnt vmcnt(9)
    v_mfma_f32_16x16x32_bf16 v[16:19], a[184:187], v[60:63], v[16:19]
    v_mfma_f32_16x16x32_bf16 v[20:23], a[188:191], v[60:63], v[20:23]
    s_waitcnt vmcnt(8)
    v_mfma_f32_16x16x32_bf16 v[16:19], a[192:195], v[64:67], v[16:19]
    v_mfma_f32_16x16x32_bf16 v[20:23], a[196:199], v[64:67], v[20:23]
    s_waitcnt vmcnt(7)
    v_mfma_f32_16x16x32_bf16 v[16:19], a[200:203], v[68:71], v[16:19]
    v_mfma_f32_16x16x32_bf16 v[20:23], a[204:207], v[68:71], v[20:23]
    s_waitcnt vmcnt(6)
    v_mfma_f32_16x16x32_bf16 v[16:19], a[208:211], v[72:75], v[16:19]
    v_mfma_f32_16x16x32_bf16 v[20:23], a[212:215], v[72:75], v[20:23]
    s_waitcnt vmcnt(5)
    v_mfma_f32_16x16x32_bf16 v[16:19], a[216:219], v[76:79], v[16:19]
    v_mfma_f32_16x16x32_bf16 v[20:23], a[220:223], v[76:79], v[20:23]
    s_waitcnt vmcnt(4)
    v_mfma_f32_16x16x32_bf16 v[16:19], a[224:227], v[80:83], v[16:19]
    v_mfma_f32_16x16x32_bf16 v[20:23], a[228:231], v[80:83], v[20:23]
    s_waitcnt vmcnt(3)
    v_mfma_f32_16x16x32_bf16 v[16:19], a[232:235], v[84:87], v[16:19]
    v_mfma_f32_16x16x32_bf16 v[20:23], a[236:239], v[84:87], v[20:23]
    s_waitcnt vmcnt(2)
    v_mfma_f32_16x16x32_bf16 v[16:19], a[240:243], v[88:91], v[16:19]
    v_mfma_f32_16x16x32_bf16 v[20:23], a[244:247], v[88:91], v[20:23]
    s_waitcnt vmcnt(1)
    v_mfma_f32_16x16x32_bf16 v[16:19], a[248:251], v[92:95], v[16:19]
    v_mfma_f32_16x16x32_bf16 v[20:23], a[252:255], v[92:95], v[20:23]
    v_add_u32 v8, s56, v7
    s_nop 1
    ds_write_b128 v8, v[16:19]
    s_nop 0
    ds_write_b128 v8, v[20:23] offset:1024
    s_waitcnt vmcnt(0)
    v_cmp_gt_u32 vcc, s57, v28
    s_waitcnt lgkmcnt(0)
    s_barrier
    s_cmp_lg_u32 s29, 0
    s_cbranch_scc1 G4_361
    ds_read_b128 v[32:35], v8 offset:2048
    ds_read_b128 v[36:39], v8 offset:3072
    ds_read_b128 v[40:43], v8 offset:4096
    ds_read_b128 v[44:47], v8 offset:5120
    ds_read_b128 v[48:51], v8 offset:6144
    ds_read_b128 v[52:55], v8 offset:7168
    s_waitcnt lgkmcnt(5)
    v_pk_add_f32 v[16:17], v[16:17], v[32:33]
    v_pk_add_f32 v[18:19], v[18:19], v[34:35]
    s_waitcnt lgkmcnt(4)
    v_pk_add_f32 v[20:21], v[20:21], v[36:37]
    v_pk_add_f32 v[22:23], v[22:23], v[38:39]
    s_waitcnt lgkmcnt(3)
    v_pk_add_f32 v[16:17], v[16:17], v[40:41]
    v_pk_add_f32 v[18:19], v[18:19], v[42:43]
    s_waitcnt lgkmcnt(2)
    v_pk_add_f32 v[20:21], v[20:21], v[44:45]
    v_pk_add_f32 v[22:23], v[22:23], v[46:47]
    s_waitcnt lgkmcnt(1)
    v_pk_add_f32 v[16:17], v[16:17], v[48:49]
    v_pk_add_f32 v[18:19], v[18:19], v[50:51]
    s_waitcnt lgkmcnt(0)
    v_pk_add_f32 v[20:21], v[20:21], v[52:53]
    v_pk_add_f32 v[22:23], v[22:23], v[54:55]
    v_cvt_pk_bf16_f32 v10, v16, v17
    v_cvt_pk_bf16_f32 v11, v18, v19
    v_cvt_pk_bf16_f32 v12, v20, v21
    v_cvt_pk_bf16_f32 v13, v22, v23
    v_lshlrev_b32 v32, 16, v10
    v_lshlrev_b32 v33, 16, v24
    v_and_b32 v34, 0xffff0000, v10
    v_and_b32 v35, 0xffff0000, v24
    v_add_f32 v32, v32, v33
    v_add_f32 v34, v34, v35
    v_cvt_pk_bf16_f32 v10, v32, v34
    v_lshlrev_b32 v32, 16, v11
    v_lshlrev_b32 v33, 16, v25
    v_and_b32 v34, 0xffff0000, v11
    v_and_b32 v35, 0xffff0000, v25
    v_add_f32 v32, v32, v33
    v_add_f32 v34, v34, v35
    v_cvt_pk_bf16_f32 v11, v32, v34
    v_lshlrev_b32 v32, 16, v12
    v_lshlrev_b32 v33, 16, v26
    v_and_b32 v34, 0xffff0000, v12
    v_and_b32 v35, 0xffff0000, v26
    v_add_f32 v32, v32, v33
    v_add_f32 v34, v34, v35
    v_cvt_pk_bf16_f32 v12, v32, v34
    v_lshlrev_b32 v32, 16, v13
    v_lshlrev_b32 v33, 16, v27
    v_and_b32 v34, 0xffff0000, v13
    v_and_b32 v35, 0xffff0000, v27
    v_add_f32 v32, v32, v33
    v_add_f32 v34, v34, v35
    v_cvt_pk_bf16_f32 v13, v32, v34
    s_cmp_lg_u32 s30, 0
    s_cbranch_scc1 G4_362
    s_add_u32 s34, s43, 14680064
    v_mov_b32 v29, s75
    buffer_store_dwordx4 v[10:13], v4, s[4:7], s34 offen sc1
    s_add_u32 s75, s44, 1
    s_cbranch_vccz G4_364
    v_mov_b32 v29, s75
    s_waitcnt vmcnt(0)
G4_364:
    s_mov_b64 exec, 1
    buffer_store_dword v29, off, s[4:7], s53 sc1
    s_mov_b64 exec, -1
    s_branch G4_361
G4_362:
    s_mul_i32 s34, s41, 20480
    s_add_u32 s34, s34, s42
    s_lshl_b32 s35, s69, 6
    s_add_u32 s34, s34, s35
    buffer_store_dwordx4 v[10:13], v5, s[12:15], s34 offen
G4_361:
    s_xor_b32 s56, s56, 8192
    s_cmp_ge_u32 s45, 128
    s_cbranch_scc1 G4_365
    s_cbranch_vccz G4_360
    s_branch G4_363
G4_365:
    s_waitcnt vmcnt(0)
    s_barrier
R_359:
    s_cmp_lg_u32 s30, 0
    s_cbranch_scc1 L_end
    s_cmp_lt_u32 s28, 160
    s_cbranch_scc1 R_368
    s_cmp_ge_u32 s28, 190
    s_cbranch_scc1 R_368
    s_mov_b32 s35, 0x3acccccd
    s_lshl_b32 s34, s67, 6
    s_add_u32 s34, s34, 0
    s_lshr_b32 s34, s34, 1
    s_add_u32 s34, s34, 1
    v_bfe_u32 v173, v1, 1, 4
    v_add_u32 v173, s34, v173
    s_mul_i32 s36, s29, 160
    v_bfe_u32 v172, v1, 5, 1
    v_mul_u32_u24 v172, 8, v172
    v_add_u32 v172, s36, v172
    v_mul_u32_u24 v172, v172, v173
    v_and_b32 v174, 1, v1
    v_mul_u32_u24 v174, 160, v174
    v_add_u32 v172, v172, v174
    v_cvt_f32_u32 v172, v172
    v_cvt_f32_u32 v173, v173
    v_mul_f32 v172, s35, v172
    v_mul_f32 v173, s35, v173
    v_fract_f32 v172, v172
    v_fmamk_f32 v174, v173, 0x0, v172
    v_fmamk_f32 v175, v173, 0x3f800000, v172
    v_cos_f32 v175, v175
    v_cos_f32 v174, v174
    s_nop 0
    v_cvt_pk_bf16_f32 v178, v174, v175
    v_fmamk_f32 v176, v173, 0x40000000, v172
    v_fmamk_f32 v177, v173, 0x40400000, v172
    v_cos_f32 v177, v177
    v_cos_f32 v176, v176
    v_accvgpr_write_b32 a160, v178
    v_cvt_pk_bf16_f32 v178, v176, v177
    v_fmamk_f32 v174, v173, 0x40800000, v172
    v_fmamk_f32 v175, v173, 0x40a00000, v172
    v_cos_f32 v175, v175
    v_cos_f32 v174, v174
    v_accvgpr_write_b32 a161, v178
    v_cvt_pk_bf16_f32 v178, v174, v175
    v_fmamk_f32 v176, v173, 0x40c00000, v172
    v_fmamk_f32 v177, v173, 0x40e00000, v172
    v_cos_f32 v177, v177
    v_cos_f32 v176, v176
    v_accvgpr_write_b32 a162, v178
    v_cvt_pk_bf16_f32 v178, v176, v177
    v_fmamk_f32 v174, v173, 0x41800000, v172
    v_fmamk_f32 v175, v173, 0x41880000, v172
    v_cos_f32 v175, v175
    v_cos_f32 v174, v174
    v_accvgpr_write_b32 a163, v178
    v_cvt_pk_bf16_f32 v178, v174, v175
    v_fmamk_f32 v176, v173, 0x41900000, v172
    v_fmamk_f32 v177, v173, 0x41980000, v172
    v_cos_f32 v177, v177
    v_cos_f32 v176, v176
    v_accvgpr_write_b32 a164, v178
    v_cvt_pk_bf16_f32 v178, v176, v177
    v_fmamk_f32 v174, v173, 0x41a00000, v172
    v_fmamk_f32 v175, v173, 0x41a80000, v172
    v_cos_f32 v175, v175
    v_cos_f32 v174, v174
    v_accvgpr_write_b32 a165, v178
    v_cvt_pk_bf16_f32 v178, v174, v175
    v_fmamk_f32 v176, v173, 0x41b00000, v172
    v_fmamk_f32 v177, v173, 0x41b80000, v172
    v_cos_f32 v177, v177
    v_cos_f32 v176, v176
    v_accvgpr_write_b32 a166, v178
    v_cvt_pk_bf16_f32 v178, v176, v177
    v_fmamk_f32 v174, v173, 0x42000000, v172
    v_fmamk_f32 v175, v173, 0x42040000, v172
    v_cos_f32 v175, v175
    v_cos_f32 v174, v174
    v_accvgpr_write_b32 a167, v178
    v_cvt_pk_bf16_f32 v178, v174, v175
    v_fmamk_f32 v176, v173, 0x42080000, v172
    v_fmamk_f32 v177, v173, 0x420c0000, v172
    v_cos_f32 v177, v177
    v_cos_f32 v176, v176
    v_accvgpr_write_b32 a168, v178
    v_cvt_pk_bf16_f32 v178, v176, v177
    v_fmamk_f32 v174, v173, 0x42100000, v172
    v_fmamk_f32 v175, v173, 0x42140000, v172
    v_cos_f32 v175, v175
    v_cos_f32 v174, v174
    v_accvgpr_write_b32 a169, v178
    v_cvt_pk_bf16_f32 v178, v174, v175
    v_fmamk_f32 v176, v173, 0x42180000, v172
    v_fmamk_f32 v177, v173, 0x421c0000, v172
    v_cos_f32 v177, v177
    v_cos_f32 v176, v176
    v_accvgpr_write_b32 a170, v178
    v_cvt_pk_bf16_f32 v178, v176, v177
    v_fmamk_f32 v174, v173, 0x42400000, v172
    v_fmamk_f32 v175, v173, 0x42440000, v172
    v_cos_f32 v175, v175
    v_cos_f32 v174, v174
    v_accvgpr_write_b32 a171, v178
    v_cvt_pk_bf16_f32 v178, v174, v175
    v_fmamk_f32 v176, v173, 0x42480000, v172
    v_fmamk_f32 v177, v173, 0x424c0000, v172
    v_cos_f32 v177, v177
    v_cos_f32 v176, v176
    v_accvgpr_write_b32 a172, v178
    v_cvt_pk_bf16_f32 v178, v176, v177
    v_fmamk_f32 v174, v173, 0x42500000, v172
    v_fmamk_f32 v175, v173, 0x42540000, v172
    v_cos_f32 v175, v175
    v_cos_f32 v174, v174
    v_accvgpr_write_b32 a173, v178
    v_cvt_pk_bf16_f32 v178, v174, v175
    v_fmamk_f32 v176, v173, 0x42580000, v172
    v_fmamk_f32 v177, v173, 0x425c0000, v172
    v_cos_f32 v177, v177
    v_cos_f32 v176, v176
    v_accvgpr_write_b32 a174, v178
    v_cvt_pk_bf16_f32 v178, v176, v177
    v_fmamk_f32 v174, v173, 0x42800000, v172
    v_fmamk_f32 v175, v173, 0x42820000, v172
    v_cos_f32 v175, v175
    v_cos_f32 v174, v174
    v_accvgpr_write_b32 a175, v178
    v_cvt_pk_bf16_f32 v178, v174, v175
    v_fmamk_f32 v176, v173, 0x42840000, v172
    v_fmamk_f32 v177, v173, 0x42860000, v172
    v_cos_f32 v177, v177
    v_cos_f32 v176, v176
    v_accvgpr_write_b32 a176, v178
    v_cvt_pk_bf16_f32 v178, v176, v177
    v_fmamk_f32 v174, v173, 0x42880000, v172
    v_fmamk_f32 v175, v173, 0x428a0000, v172
    v_cos_f32 v175, v175
    v_cos_f32 v174, v174
    v_accvgpr_write_b32 a177, v178
    v_cvt_pk_bf16_f32 v178, v174, v175
    v_fmamk_f32 v176, v173, 0x428c0000, v172
    v_fmamk_f32 v177, v173, 0x428e0000, v172
    v_cos_f32 v177, v177
    v_cos_f32 v176, v176
    v_accvgpr_write_b32 a178, v178
    v_cvt_pk_bf16_f32 v178, v176, v177
    v_fmamk_f32 v174, v173, 0x42a00000, v172
    v_fmamk_f32 v175, v173, 0x42a20000, v172
    v_cos_f32 v175, v175
    v_cos_f32 v174, v174
    v_accvgpr_write_b32 a179, v178
    v_cvt_pk_bf16_f32 v178, v174, v175
    v_fmamk_f32 v176, v173, 0x42a40000, v172
    v_fmamk_f32 v177, v173, 0x42a60000, v172
    v_cos_f32 v177, v177
    v_cos_f32 v176, v176
    v_accvgpr_write_b32 a180, v178
    v_cvt_pk_bf16_f32 v178, v176, v177
    v_fmamk_f32 v174, v173, 0x42a80000, v172
    v_fmamk_f32 v175, v173, 0x42aa0000, v172
    v_cos_f32 v175, v175
    v_cos_f32 v174, v174
    v_accvgpr_write_b32 a181, v178
    v_cvt_pk_bf16_f32 v178, v174, v175
    v_fmamk_f32 v176, v173, 0x42ac0000, v172
    v_fmamk_f32 v177, v173, 0x42ae0000, v172
    v_cos_f32 v177, v177
    v_cos_f32 v176, v176
    v_accvgpr_write_b32 a182, v178
    v_cvt_pk_bf16_f32 v178, v176, v177
    v_fmamk_f32 v174, v173, 0x42c00000, v172
    v_fmamk_f32 v175, v173, 0x42c20000, v172
    v_cos_f32 v175, v175
    v_cos_f32 v174, v174
    v_accvgpr_write_b32 a183, v178
    v_cvt_pk_bf16_f32 v178, v174, v175
    v_fmamk_f32 v176, v173, 0x42c40000, v172
    v_fmamk_f32 v177, v173, 0x42c60000, v172
    v_cos_f32 v177, v177
    v_cos_f32 v176, v176
    v_accvgpr_write_b32 a184, v178
    v_cvt_pk_bf16_f32 v178, v176, v177
    v_fmamk_f32 v174, v173, 0x42c80000, v172
    v_fmamk_f32 v175, v173, 0x42ca0000, v172
    v_cos_f32 v175, v175
    v_cos_f32 v174, v174
    v_accvgpr_write_b32 a185, v178
    v_cvt_pk_bf16_f32 v178, v174, v175
    v_fmamk_f32 v176, v173, 0x42cc0000, v172
    v_fmamk_f32 v177, v173, 0x42ce0000, v172
    v_cos_f32 v177, v177
    v_cos_f32 v176, v176
    v_accvgpr_write_b32 a186, v178
    v_cvt_pk_bf16_f32 v178, v176, v177
    v_fmamk_f32 v174, v173, 0x42e00000, v172
    v_fmamk_f32 v175, v173, 0x42e20000, v172
    v_cos_f32 v175, v175
    v_cos_f32 v174, v174
    v_accvgpr_write_b32 a187, v178
    v_cvt_pk_bf16_f32 v178, v174, v175
    v_fmamk_f32 v176, v173, 0x42e40000, v172
    v_fmamk_f32 v177, v173, 0x42e60000, v172
    v_cos_f32 v177, v177
    v_cos_f32 v176, v176
    v_accvgpr_write_b32 a188, v178
    v_cvt_pk_bf16_f32 v178, v176, v177
    v_fmamk_f32 v174, v173, 0x42e80000, v172
    v_fmamk_f32 v175, v173, 0x42ea0000, v172
    v_cos_f32 v175, v175
    v_cos_f32 v174, v174
    v_accvgpr_write_b32 a189, v178
    v_cvt_pk_bf16_f32 v178, v174, v175
    v_fmamk_f32 v176, v173, 0x42ec0000, v172
    v_fmamk_f32 v177, v173, 0x42ee0000, v172
    v_cos_f32 v177, v177
    v_cos_f32 v176, v176
    v_accvgpr_write_b32 a190, v178
    v_cvt_pk_bf16_f32 v178, v176, v177
    v_fmamk_f32 v174, v173, 0x43000000, v172
    v_fmamk_f32 v175, v173, 0x43010000, v172
    v_cos_f32 v175, v175
    v_cos_f32 v174, v174
    v_accvgpr_write_b32 a191, v178
    v_cvt_pk_bf16_f32 v178, v174, v175
    v_fmamk_f32 v176, v173, 0x43020000, v172
    v_fmamk_f32 v177, v173, 0x43030000, v172
    v_cos_f32 v177, v177
    v_cos_f32 v176, v176
    v_accvgpr_write_b32 a192, v178
    v_cvt_pk_bf16_f32 v178, v176, v177
    v_fmamk_f32 v174, v173, 0x43040000, v172
    v_fmamk_f32 v175, v173, 0x43050000, v172
    v_cos_f32 v175, v175
    v_cos_f32 v174, v174
    v_accvgpr_write_b32 a193, v178
    v_cvt_pk_bf16_f32 v178, v174, v175
    v_fmamk_f32 v176, v173, 0x43060000, v172
    v_fmamk_f32 v177, v173, 0x43070000, v172
    v_cos_f32 v177, v177
    v_cos_f32 v176, v176
    v_accvgpr_write_b32 a194, v178
    v_cvt_pk_bf16_f32 v178, v176, v177
    v_fmamk_f32 v174, v173, 0x43100000, v172
    v_fmamk_f32 v175, v173, 0x43110000, v172
    v_cos_f32 v175, v175
    v_cos_f32 v174, v174
    v_accvgpr_write_b32 a195, v178
    v_cvt_pk_bf16_f32 v178, v174, v175
    v_fmamk_f32 v176, v173, 0x43120000, v172
    v_fmamk_f32 v177, v173, 0x43130000, v172
    v_cos_f32 v177, v177
    v_cos_f32 v176, v176
    v_accvgpr_write_b32 a196, v178
    v_cvt_pk_bf16_f32 v178, v176, v177
    v_fmamk_f32 v174, v173, 0x43140000, v172
    v_fmamk_f32 v175, v173, 0x43150000, v172
    v_cos_f32 v175, v175
    v_cos_f32 v174, v174
    v_accvgpr_write_b32 a197, v178
    v_cvt_pk_bf16_f32 v178, v174, v175
    v_fmamk_f32 v176, v173, 0x43160000, v172
    v_fmamk_f32 v177, v173, 0x43170000, v172
    v_cos_f32 v177, v177
    v_cos_f32 v176, v176
    v_accvgpr_write_b32 a198, v178
    v_cvt_pk_bf16_f32 v178, v176, v177
    v_accvgpr_write_b32 a199, v178
    s_lshl_b32 s34, s67, 6
    s_add_u32 s34, s34, 32
    s_lshr_b32 s34, s34, 1
    s_add_u32 s34, s34, 1
    v_bfe_u32 v173, v1, 1, 4
    v_add_u32 v173, s34, v173
    s_mul_i32 s36, s29, 160
    v_bfe_u32 v172, v1, 5, 1
    v_mul_u32_u24 v172, 8, v172
    v_add_u32 v172, s36, v172
    v_mul_u32_u24 v172, v172, v173
    v_and_b32 v174, 1, v1
    v_mul_u32_u24 v174, 160, v174
    v_add_u32 v172, v172, v174
    v_cvt_f32_u32 v172, v172
    v_cvt_f32_u32 v173, v173
    v_mul_f32 v172, s35, v172
    v_mul_f32 v173, s35, v173
    v_fract_f32 v172, v172
    v_fmamk_f32 v174, v173, 0x0, v172
    v_fmamk_f32 v175, v173, 0x3f800000, v172
    v_cos_f32 v175, v175
    v_cos_f32 v174, v174
    s_nop 0
    v_cvt_pk_bf16_f32 v178, v174, v175
    v_fmamk_f32 v176, v173, 0x40000000, v172
    v_fmamk_f32 v177, v173, 0x40400000, v172
    v_cos_f32 v177, v177
    v_cos_f32 v176, v176
    v_accvgpr_write_b32 a200, v178
    v_cvt_pk_bf16_f32 v178, v176, v177
    v_fmamk_f32 v174, v173, 0x40800000, v172
    v_fmamk_f32 v175, v173, 0x40a00000, v172
    v_cos_f32 v175, v175
    v_cos_f32 v174, v174
    v_accvgpr_write_b32 a201, v178
    v_cvt_pk_bf16_f32 v178, v174, v175
    v_fmamk_f32 v176, v173, 0x40c00000, v172
    v_fmamk_f32 v177, v173, 0x40e00000, v172
    v_cos_f32 v177, v177
    v_cos_f32 v176, v176
    v_accvgpr_write_b32 a202, v178
    v_cvt_pk_bf16_f32 v178, v176, v177
    v_fmamk_f32 v174, v173, 0x41800000, v172
    v_fmamk_f32 v175, v173, 0x41880000, v172
    v_cos_f32 v175, v175
    v_cos_f32 v174, v174
    v_accvgpr_write_b32 a203, v178
    v_cvt_pk_bf16_f32 v178, v174, v175
    v_fmamk_f32 v176, v173, 0x41900000, v172
    v_fmamk_f32 v177, v173, 0x41980000, v172
    v_cos_f32 v177, v177
    v_cos_f32 v176, v176
    v_accvgpr_write_b32 a204, v178
    v_cvt_pk_bf16_f32 v178, v176, v177
    v_fmamk_f32 v174, v173, 0x41a00000, v172
    v_fmamk_f32 v175, v173, 0x41a80000, v172
    v_cos_f32 v175, v175
    v_cos_f32 v174, v174
    v_accvgpr_write_b32 a205, v178
    v_cvt_pk_bf16_f32 v178, v174, v175
    v_fmamk_f32 v176, v173, 0x41b00000, v172
    v_fmamk_f32 v177, v173, 0x41b80000, v172
    v_cos_f32 v177, v177
    v_cos_f32 v176, v176
    v_accvgpr_write_b32 a206, v178
    v_cvt_pk_bf16_f32 v178, v176, v177
    v_fmamk_f32 v174, v173, 0x42000000, v172
    v_fmamk_f32 v175, v173, 0x42040000, v172
    v_cos_f32 v175, v175
    v_cos_f32 v174, v174
    v_accvgpr_write_b32 a207, v178
    v_cvt_pk_bf16_f32 v178, v174, v175
    v_fmamk_f32 v176, v173, 0x42080000, v172
    v_fmamk_f32 v177, v173, 0x420c0000, v172
    v_cos_f32 v177, v177
    v_cos_f32 v176, v176
    v_accvgpr_write_b32 a208, v178
    v_cvt_pk_bf16_f32 v178, v176, v177
    v_fmamk_f32 v174, v173, 0x42100000, v172
    v_fmamk_f32 v175, v173, 0x42140000, v172
    v_cos_f32 v175, v175
    v_cos_f32 v174, v174
    v_accvgpr_write_b32 a209, v178
    v_cvt_pk_bf16_f32 v178, v174, v175
    v_fmamk_f32 v176, v173, 0x42180000, v172
    v_fmamk_f32 v177, v173, 0x421c0000, v172
    v_cos_f32 v177, v177
    v_cos_f32 v176, v176
    v_accvgpr_write_b32 a210, v178
    v_cvt_pk_bf16_f32 v178, v176, v177
    v_fmamk_f32 v174, v173, 0x42400000, v172
    v_fmamk_f32 v175, v173, 0x42440000, v172
    v_cos_f32 v175, v175
    v_cos_f32 v174, v174
    v_accvgpr_write_b32 a211, v178
    v_cvt_pk_bf16_f32 v178, v174, v175
    v_fmamk_f32 v176, v173, 0x42480000, v172
    v_fmamk_f32 v177, v173, 0x424c0000, v172
    v_cos_f32 v177, v177
    v_cos_f32 v176, v176
    v_accvgpr_write_b32 a212, v178
    v_cvt_pk_bf16_f32 v178, v176, v177
    v_fmamk_f32 v174, v173, 0x42500000, v172
    v_fmamk_f32 v175, v173, 0x42540000, v172
    v_cos_f32 v175, v175
    v_cos_f32 v174, v174
    v_accvgpr_write_b32 a213, v178
    v_cvt_pk_bf16_f32 v178, v174, v175
    v_fmamk_f32 v176, v173, 0x42580000, v172
    v_fmamk_f32 v177, v173, 0x425c0000, v172
    v_cos_f32 v177, v177
    v_cos_f32 v176, v176
    v_accvgpr_write_b32 a214, v178
    v_cvt_pk_bf16_f32 v178, v176, v177
    v_fmamk_f32 v174, v173, 0x42800000, v172
    v_fmamk_f32 v175, v173, 0x42820000, v172
    v_cos_f32 v175, v175
    v_cos_f32 v174, v174
    v_accvgpr_write_b32 a215, v178
    v_cvt_pk_bf16_f32 v178, v174, v175
    v_fmamk_f32 v176, v173, 0x42840000, v172
    v_fmamk_f32 v177, v173, 0x42860000, v172
    v_cos_f32 v177, v177
    v_cos_f32 v176, v176
    v_accvgpr_write_b32 a216, v178
    v_cvt_pk_bf16_f32 v178, v176, v177
    v_fmamk_f32 v174, v173, 0x42880000, v172
    v_fmamk_f32 v175, v173, 0x428a0000, v172
    v_cos_f32 v175, v175
    v_cos_f32 v174, v174
    v_accvgpr_write_b32 a217, v178
    v_cvt_pk_bf16_f32 v178, v174, v175
    v_fmamk_f32 v176, v173, 0x428c0000, v172
    v_fmamk_f32 v177, v173, 0x428e0000, v172
    v_cos_f32 v177, v177
    v_cos_f32 v176, v176
    v_accvgpr_write_b32 a218, v178
    v_cvt_pk_bf16_f32 v178, v176, v177
    v_fmamk_f32 v174, v173, 0x42a00000, v172
    v_fmamk_f32 v175, v173, 0x42a20000, v172
    v_cos_f32 v175, v175
    v_cos_f32 v174, v174
    v_accvgpr_write_b32 a219, v178
    v_cvt_pk_bf16_f32 v178, v174, v175
    v_fmamk_f32 v176, v173, 0x42a40000, v172
    v_fmamk_f32 v177, v173, 0x42a60000, v172
    v_cos_f32 v177, v177
    v_cos_f32 v176, v176
    v_accvgpr_write_b32 a220, v178
    v_cvt_pk_bf16_f32 v178, v176, v177
    v_fmamk_f32 v174, v173, 0x42a80000, v172
    v_fmamk_f32 v175, v173, 0x42aa0000, v172
    v_cos_f32 v175, v175
    v_cos_f32 v174, v174
    v_accvgpr_write_b32 a221, v178
    v_cvt_pk_bf16_f32 v178, v174, v175
    v_fmamk_f32 v176, v173, 0x42ac0000, v172
    v_fmamk_f32 v177, v173, 0x42ae0000, v172
    v_cos_f32 v177, v177
    v_cos_f32 v176, v176
    v_accvgpr_write_b32 a222, v178
    v_cvt_pk_bf16_f32 v178, v176, v177
    v_fmamk_f32 v174, v173, 0x42c00000, v172
    v_fmamk_f32 v175, v173, 0x42c20000, v172
    v_cos_f32 v175, v175
    v_cos_f32 v174, v174
    v_accvgpr_write_b32 a223, v178
    v_cvt_pk_bf16_f32 v178, v174, v175
    v_fmamk_f32 v176, v173, 0x42c40000, v172
    v_fmamk_f32 v177, v173, 0x42c60000, v172
    v_cos_f32 v177, v177
    v_cos_f32 v176, v176
    v_accvgpr_write_b32 a224, v178
    v_cvt_pk_bf16_f32 v178, v176, v177
    v_fmamk_f32 v174, v173, 0x42c80000, v172
    v_fmamk_f32 v175, v173, 0x42ca0000, v172
    v_cos_f32 v175, v175
    v_cos_f32 v174, v174
    v_accvgpr_write_b32 a225, v178
    v_cvt_pk_bf16_f32 v178, v174, v175
    v_fmamk_f32 v176, v173, 0x42cc0000, v172
    v_fmamk_f32 v177, v173, 0x42ce0000, v172
    v_cos_f32 v177, v177
    v_cos_f32 v176, v176
    v_accvgpr_write_b32 a226, v178
    v_cvt_pk_bf16_f32 v178, v176, v177
    v_fmamk_f32 v174, v173, 0x42e00000, v172
    v_fmamk_f32 v175, v173, 0x42e20000, v172
    v_cos_f32 v175, v175
    v_cos_f32 v174, v174
    v_accvgpr_write_b32 a227, v178
    v_cvt_pk_bf16_f32 v178, v174, v175
    v_fmamk_f32 v176, v173, 0x42e40000, v172
    v_fmamk_f32 v177, v173, 0x42e60000, v172
    v_cos_f32 v177, v177
    v_cos_f32 v176, v176
    v_accvgpr_write_b32 a228, v178
    v_cvt_pk_bf16_f32 v178, v176, v177
    v_fmamk_f32 v174, v173, 0x42e80000, v172
    v_fmamk_f32 v175, v173, 0x42ea0000, v172
    v_cos_f32 v175, v175
    v_cos_f32 v174, v174
    v_accvgpr_write_b32 a229, v178
    v_cvt_pk_bf16_f32 v178, v174, v175
    v_fmamk_f32 v176, v173, 0x42ec0000, v172
    v_fmamk_f32 v177, v173, 0x42ee0000, v172
    v_cos_f32 v177, v177
    v_cos_f32 v176, v176
    v_accvgpr_write_b32 a230, v178
    v_cvt_pk_bf16_f32 v178, v176, v177
    v_fmamk_f32 v174, v173, 0x43000000, v172
    v_fmamk_f32 v175, v173, 0x43010000, v172
    v_cos_f32 v175, v175
    v_cos_f32 v174, v174
    v_accvgpr_write_b32 a231, v178
    v_cvt_pk_bf16_f32 v178, v174, v175
    v_fmamk_f32 v176, v173, 0x43020000, v172
    v_fmamk_f32 v177, v173, 0x43030000, v172
    v_cos_f32 v177, v177
    v_cos_f32 v176, v176
    v_accvgpr_write_b32 a232, v178
    v_cvt_pk_bf16_f32 v178, v176, v177
    v_fmamk_f32 v174, v173, 0x43040000, v172
    v_fmamk_f32 v175, v173, 0x43050000, v172
    v_cos_f32 v175, v175
    v_cos_f32 v174, v174
    v_accvgpr_write_b32 a233, v178
    v_cvt_pk_bf16_f32 v178, v174, v175
    v_fmamk_f32 v176, v173, 0x43060000, v172
    v_fmamk_f32 v177, v173, 0x43070000, v172
    v_cos_f32 v177, v177
    v_cos_f32 v176, v176
    v_accvgpr_write_b32 a234, v178
    v_cvt_pk_bf16_f32 v178, v176, v177
    v_fmamk_f32 v174, v173, 0x43100000, v172
    v_fmamk_f32 v175, v173, 0x43110000, v172
    v_cos_f32 v175, v175
    v_cos_f32 v174, v174
    v_accvgpr_write_b32 a235, v178
    v_cvt_pk_bf16_f32 v178, v174, v175
    v_fmamk_f32 v176, v173, 0x43120000, v172
    v_fmamk_f32 v177, v173, 0x43130000, v172
    v_cos_f32 v177, v177
    v_cos_f32 v176, v176
    v_accvgpr_write_b32 a236, v178
    v_cvt_pk_bf16_f32 v178, v176, v177
    v_fmamk_f32 v174, v173, 0x43140000, v172
    v_fmamk_f32 v175, v173, 0x43150000, v172
    v_cos_f32 v175, v175
    v_cos_f32 v174, v174
    v_accvgpr_write_b32 a237, v178
    v_cvt_pk_bf16_f32 v178, v174, v175
    v_fmamk_f32 v176, v173, 0x43160000, v172
    v_fmamk_f32 v177, v173, 0x43170000, v172
    v_cos_f32 v177, v177
    v_cos_f32 v176, v176
    v_accvgpr_write_b32 a238, v178
    v_cvt_pk_bf16_f32 v178, v176, v177
    v_accvgpr_write_b32 a239, v178
    s_lshl_b32 s34, s29, 13
    v_add_u32 v4, s34, v0
    s_lshl_b32 s34, s29, 3
    s_add_u32 s34, s34, 65536
    v_bfe_u32 v5, v1, 0, 5
    v_mul_u32_u24 v5, 32, v5
    v_add_u32 v5, s34, v5
    s_lshl_b32 s35, s29, 11
    s_lshl_b32 s36, s29, 8
    s_add_u32 s36, s36, 67584
    s_lshr_b32 s34, s29, 1
    s_lshl_b32 s34, s34, 12
    s_and_b32 s37, s29, 1
    s_lshl_b32 s37, s37, 8
    s_add_u32 s34, s34, s37
    v_bfe_u32 v3, v1, 1, 1
    v_mul_u32_u24 v3, 2048, v3
    v_bfe_u32 v172, v1, 0, 1
    v_lshl_add_u32 v3, v172, 9, v3
    v_bfe_u32 v172, v1, 2, 4
    v_lshl_add_u32 v3, v172, 4, v3
    v_add_u32 v3, s34, v3
    v_bfe_u32 v10, v1, 0, 2
    v_mul_u32_u24 v10, 32, v10
    v_add_u32 v10, s36, v10
    s_lshl_b32 s34, s29, 10
    v_add_u32 v7, s34, v0
    v_bfe_u32 v6, v1, 0, 5
    v_mul_u32_u24 v6, 32, v6
    v_add_u32 v6, 65536, v6
    v_bfe_u32 v9, v1, 0, 2
    v_mul_u32_u24 v9, 4, v9
    v_bfe_u32 v172, v1, 2, 1
    v_lshl_add_u32 v9, v172, 5, v9
    v_bfe_u32 v172, v1, 3, 1
    v_lshl_add_u32 v9, v172, 4, v9
    v_bfe_u32 v172, v1, 4, 1
    v_lshl_add_u32 v9, v172, 6, v9
    v_add_u32 v9, s36, v9
    s_sub_u32 s44, s66, 16
    s_mov_b32 s47, 3
    s_mul_i32 s50, s29, 10240
    s_add_u32 s50, s50, 14680064
    s_mov_b32 s52, 0
    s_lshl_b32 s51, s67, 12
    s_add_u32 s51, s51, 24117248
    s_mov_b32 s58, 40960
    s_mul_i32 s34, s29, 640
    s_add_u32 s34, s34, 1196032
    v_lshrrev_b32 v181, 1, v1
    v_min_u32 v181, 4, v181
    v_lshlrev_b32 v181, 7, v181
    v_add_u32 v181, s34, v181
    s_waitcnt vmcnt(0) lgkmcnt(0)
G_369:
    s_lshl_b32 s37, s44, 1
    s_mul_i32 s38, s37, 10923
    s_lshr_b32 s38, s38, 16
    s_mul_i32 s39, s38, 6
    s_sub_u32 s39, s37, s39
    v_and_b32 v180, 1, v1
    v_add_u32 v182, s39, v180
    s_cmp_lt_u32 s37, 60
    s_cselect_b32 s38, -60, 4
    s_lshl_b32 s38, s38, 7
    v_cmp_lt_u32 vcc, 2, v182
    v_mov_b32 v183, s38
    s_nop 0
    v_cndmask_b32 v183, 0, v183, vcc
    v_mul_u32_u24 v182, 2560, v182
    v_add3_u32 v182, v182, v183, v181
    s_add_u32 s37, s37, 1
    v_add_u32 v180, s37, v180
    s_mov_b32 s48, 0
P_371:
    buffer_load_dword v172, v182, s[4:7], 0 offen sc1
    s_waitcnt vmcnt(0)
    v_cmp_gt_u32 vcc, v180, v172
    s_cbranch_vccz P_372
    s_add_u32 s48, s48, 1
    s_cmp_gt_u32 s48, 200000
    s_cbranch_scc1 L_end
    s_sleep 1
    v_add_u32 v172, 12, v172
    v_cmp_gt_u32 vcc, v180, v172
    s_cbranch_vccz P_371
    s_sleep 24
    s_branch P_371
P_372:
    s_mul_i32 s54, s44, 40960
    s_add_u32 s56, s54, s52
    s_add_u32 s54, s54, s50
    buffer_load_dwordx4 v[16:19], v0, s[4:7], s54 offen offset:0 sc1
    buffer_load_dwordx4 v[20:23], v0, s[4:7], s54 offen offset:1024 sc1
    buffer_load_dwordx4 v[24:27], v0, s[4:7], s54 offen offset:2048 sc1
    buffer_load_dwordx4 v[28:31], v0, s[4:7], s54 offen offset:3072 sc1
    s_add_u32 s54, s54, 4096
    buffer_load_dwordx4 v[32:35], v0, s[4:7], s54 offen offset:0 sc1
    buffer_load_dwordx4 v[36:39], v0, s[4:7], s54 offen offset:1024 sc1
    buffer_load_dwordx4 v[40:43], v0, s[4:7], s54 offen offset:2048 sc1
    buffer_load_dwordx4 v[44:47], v0, s[4:7], s54 offen offset:3072 sc1
    s_add_u32 s54, s54, 4096
    buffer_load_dwordx4 v[48:51], v0, s[4:7], s54 offen offset:0 sc1
    buffer_load_dwordx4 v[52:55], v0, s[4:7], s54 offen offset:1024 sc1
    s_waitcnt vmcnt(9)
    v_mfma_f32_32x32x16_bf16 v[96:111], v[16:19], a[160:163], 0
    v_mfma_f32_32x32x16_bf16 v[112:127], v[16:19], a[200:203], 0
    s_waitcnt vmcnt(8)
    v_mfma_f32_32x32x16_bf16 v[96:111], v[20:23], a[164:167], v[96:111]
    v_mfma_f32_32x32x16_bf16 v[112:127], v[20:23], a[204:207], v[112:127]
    s_waitcnt vmcnt(7)
    v_mfma_f32_32x32x16_bf16 v[96:111], v[24:27], a[168:171], v[96:111]
    v_mfma_f32_32x32x16_bf16 v[112:127], v[24:27], a[208:211], v[112:127]
    s_waitcnt vmcnt(6)
    v_mfma_f32_32x32x16_bf16 v[96:111], v[28:31], a[172:175], v[96:111]
    v_mfma_f32_32x32x16_bf16 v[112:127], v[28:31], a[212:215], v[112:127]
    s_waitcnt vmcnt(5)
    v_mfma_f32_32x32x16_bf16 v[96:111], v[32:35], a[176:179], v[96:111]
    v_mfma_f32_32x32x16_bf16 v[112:127], v[32:35], a[216:219], v[112:127]
    s_waitcnt vmcnt(4)
    v_mfma_f32_32x32x16_bf16 v[96:111], v[36:39], a[180:183], v[96:111]
    v_mfma_f32_32x32x16_bf16 v[112:127], v[36:39], a[220:223], v[112:127]
    s_waitcnt vmcnt(3)
    v_mfma_f32_32x32x16_bf16 v[96:111], v[40:43], a[184:187], v[96:111]
    v_mfma_f32_32x32x16_bf16 v[112:127], v[40:43], a[224:227], v[112:127]
    s_waitcnt vmcnt(2)
    v_mfma_f32_32x32x16_bf16 v[96:111], v[44:47], a[188:191], v[96:111]
    v_mfma_f32_32x32x16_bf16 v[112:127], v[44:47], a[228:231], v[112:127]
    s_waitcnt vmcnt(1)
    v_mfma_f32_32x32x16_bf16 v[96:111], v[48:51], a[192:195], v[96:111]
    v_mfma_f32_32x32x16_bf16 v[112:127], v[48:51], a[232:235], v[112:127]
    s_waitcnt vmcnt(0)
    v_mfma_f32_32x32x16_bf16 v[96:111], v[52:55], a[196:199], v[96:111]
    v_mfma_f32_32x32x16_bf16 v[112:127], v[52:55], a[236:239], v[112:127]
    s_mul_i32 s55, s44, s58
    s_add_u32 s55, s55, s51
    s_nop 1
    ds_write_b128 v4, v[96:99] offset:0
    v_mov_b64 v[128:129], 0
    s_mov_b32 s34, 0x3f803f80
    v_dot2c_f32_bf16 v128, s34, v16
    v_dot2c_f32_bf16 v129, v16, v16
    v_dot2c_f32_bf16 v128, s34, v17
    v_dot2c_f32_bf16 v129, v17, v17
    v_dot2c_f32_bf16 v128, s34, v18
    v_dot2c_f32_bf16 v129, v18, v18
    v_dot2c_f32_bf16 v128, s34, v19
    v_dot2c_f32_bf16 v129, v19, v19
    v_dot2c_f32_bf16 v128, s34, v20
    v_dot2c_f32_bf16 v129, v20, v20
    ds_write_b128 v4, v[100:103] offset:1024
    v_dot2c_f32_bf16 v128, s34, v21
    v_dot2c_f32_bf16 v129, v21, v21
    v_dot2c_f32_bf16 v128, s34, v22
    v_dot2c_f32_bf16 v129, v22, v22
    v_dot2c_f32_bf16 v128, s34, v23
    v_dot2c_f32_bf16 v129, v23, v23
    v_dot2c_f32_bf16 v128, s34, v24
    v_dot2c_f32_bf16 v129, v24, v24
    v_dot2c_f32_bf16 v128, s34, v25
    v_dot2c_f32_bf16 v129, v25, v25
    ds_write_b128 v4, v[104:107] offset:2048
    v_dot2c_f32_bf16 v128, s34, v26
    v_dot2c_f32_bf16 v129, v26, v26
    v_dot2c_f32_bf16 v128, s34, v27
    v_dot2c_f32_bf16 v129, v27, v27
    v_dot2c_f32_bf16 v128, s34, v28
    v_dot2c_f32_bf16 v129, v28, v28
    v_dot2c_f32_bf16 v128, s34, v29
    v_dot2c_f32_bf16 v129, v29, v29
    v_dot2c_f32_bf16 v128, s34, v30
    v_dot2c_f32_bf16 v129, v30, v30
    ds_write_b128 v4, v[108:111] offset:3072
    v_dot2c_f32_bf16 v128, s34, v31
    v_dot2c_f32_bf16 v129, v31, v31
    v_dot2c_f32_bf16 v128, s34, v32
    v_dot2c_f32_bf16 v129, v32, v32
    v_dot2c_f32_bf16 v128, s34, v33
    v_dot2c_f32_bf16 v129, v33, v33
    v_dot2c_f32_bf16 v128, s34, v34
    v_dot2c_f32_bf16 v129, v34, v34
    v_dot2c_f32_bf16 v128, s34, v35
    v_dot2c_f32_bf16 v129, v35, v35
    ds_write_b128 v4, v[112:115] offset:4096
    v_dot2c_f32_bf16 v128, s34, v36
    v_dot2c_f32_bf16 v129, v36, v36
    v_dot2c_f32_bf16 v128, s34, v37
    v_dot2c_f32_bf16 v129, v37, v37
    v_dot2c_f32_bf16 v128, s34, v38
    v_dot2c_f32_bf16 v129, v38, v38
    v_dot2c_f32_bf16 v128, s34, v39
    v_dot2c_f32_bf16 v129, v39, v39
    v_dot2c_f32_bf16 v128, s34, v40
    v_dot2c_f32_bf16 v129, v40, v40
    ds_write_b128 v4, v[116:119] offset:5120
    v_dot2c_f32_bf16 v128, s34, v41
    v_dot2c_f32_bf16 v129, v41, v41
    v_dot2c_f32_bf16 v128, s34, v42
    v_dot2c_f32_bf16 v129, v42, v42
    v_dot2c_f32_bf16 v128, s34, v43
    v_dot2c_f32_bf16 v129, v43, v43
    v_dot2c_f32_bf16 v128, s34, v44
    v_dot2c_f32_bf16 v129, v44, v44
    v_dot2c_f32_bf16 v128, s34, v45
    v_dot2c_f32_bf16 v129, v45, v45
    ds_write_b128 v4, v[120:123] offset:6144
    v_dot2c_f32_bf16 v128, s34, v46
    v_dot2c_f32_bf16 v129, v46, v46
    v_dot2c_f32_bf16 v128, s34, v47
    v_dot2c_f32_bf16 v129, v47, v47
    v_dot2c_f32_bf16 v128, s34, v48
    v_dot2c_f32_bf16 v129, v48, v48
    v_dot2c_f32_bf16 v128, s34, v49
    v_dot2c_f32_bf16 v129, v49, v49
    v_dot2c_f32_bf16 v128, s34, v50
    v_dot2c_f32_bf16 v129, v50, v50
    ds_write_b128 v4, v[124:127] offset:7168
    v_dot2c_f32_bf16 v128, s34, v51
    v_dot2c_f32_bf16 v129, v51, v51
    v_dot2c_f32_bf16 v128, s34, v52
    v_dot2c_f32_bf16 v129, v52, v52
    v_dot2c_f32_bf16 v128, s34, v53
    v_dot2c_f32_bf16 v129, v53, v53
    v_dot2c_f32_bf16 v128, s34, v54
    v_dot2c_f32_bf16 v129, v54, v54
    v_dot2c_f32_bf16 v128, s34, v55
    v_dot2c_f32_bf16 v129, v55, v55
    s_nop 2
    v_mov_b64 v[172:173], v[128:129]
    s_nop 1
    v_permlane32_swap_b32 v128, v172
    v_permlane32_swap_b32 v129, v173
    v_pk_add_f32 v[128:129], v[128:129], v[172:173]
    ds_write_b64 v5, v[128:129] offset:0
    s_waitcnt lgkmcnt(0)
    s_barrier
    ds_read_b128 v[130:133], v6 offset:0
    ds_read_b128 v[134:137], v6 offset:16
    ds_read_b128 v[96:99], v3 offset:0
    ds_read_b128 v[100:103], v3 offset:1024
    ds_read_b128 v[104:107], v3 offset:8192
    ds_read_b128 v[108:111], v3 offset:9216
    ds_read_b128 v[112:115], v3 offset:16384
    ds_read_b128 v[116:119], v3 offset:17408
    ds_read_b128 v[120:123], v3 offset:24576
    ds_read_b128 v[124:127], v3 offset:25600
    s_waitcnt lgkmcnt(9)
    v_pk_add_f32 v[130:131], v[130:131], v[132:133]
    s_waitcnt lgkmcnt(8)
    v_pk_add_f32 v[134:135], v[134:135], v[136:137]
    v_pk_add_f32 v[130:131], v[130:131], v[134:135]
    v_mul_f32 v130, 0x3acccccd, v130
    v_mul_f32 v131, 0x3acccccd, v131
    v_fma_f32 v131, -v130, v130, v131
    v_max_f32 v131, 0, v131
    v_add_f32 v131, 0x3727c5ac, v131
    v_rsq_f32 v131, v131
    s_nop 0
    ds_write2_b32 v9, v130, v131 offset0:0 offset1:32
    ds_read_b128 v[146:149], v10 offset:128
    ds_read_b128 v[150:153], v10 offset:144
    s_waitcnt lgkmcnt(8)
    v_pk_add_f32 v[96:97], v[96:97], v[104:105]
    v_pk_add_f32 v[98:99], v[98:99], v[106:107]
    s_waitcnt lgkmcnt(7)
    v_pk_add_f32 v[100:101], v[100:101], v[108:109]
    v_pk_add_f32 v[102:103], v[102:103], v[110:111]
    s_waitcnt lgkmcnt(6)
    v_pk_add_f32 v[96:97], v[96:97], v[112:113]
    v_pk_add_f32 v[98:99], v[98:99], v[114:115]
    s_waitcnt lgkmcnt(5)
    v_pk_add_f32 v[100:101], v[100:101], v[116:117]
    v_pk_add_f32 v[102:103], v[102:103], v[118:119]
    s_waitcnt lgkmcnt(4)
    v_pk_add_f32 v[96:97], v[96:97], v[120:121]
    v_pk_add_f32 v[98:99], v[98:99], v[122:123]
    s_waitcnt lgkmcnt(3)
    v_pk_add_f32 v[100:101], v[100:101], v[124:125]
    v_pk_add_f32 v[102:103], v[102:103], v[126:127]
    s_waitcnt lgkmcnt(1)
    v_mul_f32 v96, v96, v146
    v_mul_f32 v97, v97, v147
    v_mul_f32 v98, v98, v148
    v_mul_f32 v99, v99, v149
    s_waitcnt lgkmcnt(0)
    v_mul_f32 v100, v100, v150
    v_mul_f32 v101, v101, v151
    v_mul_f32 v102, v102, v152
    v_mul_f32 v103, v103, v153
    v_cvt_pk_bf16_f32 v172, v96, v97
    v_cvt_pk_bf16_f32 v173, v98, v99
    v_cvt_pk_bf16_f32 v174, v100, v101
    v_cvt_pk_bf16_f32 v175, v102, v103
    buffer_store_dwordx4 v[172:175], v7, s[4:7], s55 offen sc1
    s_add_u32 s44, s44, s47
    s_cmp_lt_u32 s44, 64
    s_cbranch_scc0 G_370
    s_lshl_b32 s37, s44, 1
    s_mul_i32 s38, s37, 10923
    s_lshr_b32 s38, s38, 16
    s_mul_i32 s39, s38, 6
    s_sub_u32 s39, s37, s39
    v_and_b32 v180, 1, v1
    v_add_u32 v182, s39, v180
    s_cmp_lt_u32 s37, 60
    s_cselect_b32 s38, -60, 4
    s_lshl_b32 s38, s38, 7
    v_cmp_lt_u32 vcc, 2, v182
    v_mov_b32 v183, s38
    s_nop 0
    v_cndmask_b32 v183, 0, v183, vcc
    v_mul_u32_u24 v182, 2560, v182
    v_add3_u32 v182, v182, v183, v181
    s_add_u32 s37, s37, 1
    v_add_u32 v180, s37, v180
    s_mov_b32 s48, 0
P_373:
    buffer_load_dword v172, v182, s[4:7], 0 offen sc1
    s_waitcnt vmcnt(0)
    v_cmp_gt_u32 vcc, v180, v172
    s_cbranch_vccz P_374
    s_add_u32 s48, s48, 1
    s_cmp_gt_u32 s48, 200000
    s_cbranch_scc1 L_end
    s_sleep 1
    v_add_u32 v172, 12, v172
    v_cmp_gt_u32 vcc, v180, v172
    s_cbranch_vccz P_373
    s_sleep 24
    s_branch P_373
P_374:
    s_mul_i32 s54, s44, 40960
    s_add_u32 s56, s54, s52
    s_add_u32 s54, s54, s50
    buffer_load_dwordx4 v[56:59], v0, s[4:7], s54 offen offset:0 sc1
    buffer_load_dwordx4 v[60:63], v0, s[4:7], s54 offen offset:1024 sc1
    buffer_load_dwordx4 v[64:67], v0, s[4:7], s54 offen offset:2048 sc1
    buffer_load_dwordx4 v[68:71], v0, s[4:7], s54 offen offset:3072 sc1
    s_add_u32 s54, s54, 4096
    buffer_load_dwordx4 v[72:75], v0, s[4:7], s54 offen offset:0 sc1
    buffer_load_dwordx4 v[76:79], v0, s[4:7], s54 offen offset:1024 sc1
    buffer_load_dwordx4 v[80:83], v0, s[4:7], s54 offen offset:2048 sc1
    buffer_load_dwordx4 v[84:87], v0, s[4:7], s54 offen offset:3072 sc1
    s_add_u32 s54, s54, 4096
    buffer_load_dwordx4 v[88:91], v0, s[4:7], s54 offen offset:0 sc1
    buffer_load_dwordx4 v[92:95], v0, s[4:7], s54 offen offset:1024 sc1
    s_waitcnt vmcnt(9)
    v_mfma_f32_32x32x16_bf16 v[96:111], v[56:59], a[160:163], 0
    v_mfma_f32_32x32x16_bf16 v[112:127], v[56:59], a[200:203], 0
    s_waitcnt vmcnt(8)
    v_mfma_f32_32x32x16_bf16 v[96:111], v[60:63], a[164:167], v[96:111]
    v_mfma_f32_32x32x16_bf16 v[112:127], v[60:63], a[204:207], v[112:127]
    s_waitcnt vmcnt(7)
    v_mfma_f32_32x32x16_bf16 v[96:111], v[64:67], a[168:171], v[96:111]
    v_mfma_f32_32x32x16_bf16 v[112:127], v[64:67], a[208:211], v[112:127]
    s_waitcnt vmcnt(6)
    v_mfma_f32_32x32x16_bf16 v[96:111], v[68:71], a[172:175], v[96:111]
    v_mfma_f32_32x32x16_bf16 v[112:127], v[68:71], a[212:215], v[112:127]
    s_waitcnt vmcnt(5)
    v_mfma_f32_32x32x16_bf16 v[96:111], v[72:75], a[176:179], v[96:111]
    v_mfma_f32_32x32x16_bf16 v[112:127], v[72:75], a[216:219], v[112:127]
    s_waitcnt vmcnt(4)
    v_mfma_f32_32x32x16_bf16 v[96:111], v[76:79], a[180:183], v[96:111]
    v_mfma_f32_32x32x16_bf16 v[112:127], v[76:79], a[220:223], v[112:127]
    s_waitcnt vmcnt(3)
    v_mfma_f32_32x32x16_bf16 v[96:111], v[80:83], a[184:187], v[96:111]
    v_mfma_f32_32x32x16_bf16 v[112:127], v[80:83], a[224:227], v[112:127]
    s_waitcnt vmcnt(2)
    v_mfma_f32_32x32x16_bf16 v[96:111], v[84:87], a[188:191], v[96:111]
    v_mfma_f32_32x32x16_bf16 v[112:127], v[84:87], a[228:231], v[112:127]
    s_waitcnt vmcnt(1)
    v_mfma_f32_32x32x16_bf16 v[96:111], v[88:91], a[192:195], v[96:111]
    v_mfma_f32_32x32x16_bf16 v[112:127], v[88:91], a[232:235], v[112:127]
    s_waitcnt vmcnt(0)
    v_mfma_f32_32x32x16_bf16 v[96:111], v[92:95], a[196:199], v[96:111]
    v_mfma_f32_32x32x16_bf16 v[112:127], v[92:95], a[236:239], v[112:127]
    s_mul_i32 s55, s44, s58
    s_add_u32 s55, s55, s51
    s_nop 1
    ds_write_b128 v4, v[96:99] offset:32768
    v_mov_b64 v[128:129], 0
    s_mov_b32 s34, 0x3f803f80
    v_dot2c_f32_bf16 v128, s34, v56
    v_dot2c_f32_bf16 v129, v56, v56
    v_dot2c_f32_bf16 v128, s34, v57
    v_dot2c_f32_bf16 v129, v57, v57
    v_dot2c_f32_bf16 v128, s34, v58
    v_dot2c_f32_bf16 v129, v58, v58
    v_dot2c_f32_bf16 v128, s34, v59
    v_dot2c_f32_bf16 v129, v59, v59
    v_dot2c_f32_bf16 v128, s34, v60
    v_dot2c_f32_bf16 v129, v60, v60
    ds_write_b128 v4, v[100:103] offset:33792
    v_dot2c_f32_bf16 v128, s34, v61
    v_dot2c_f32_bf16 v129, v61, v61
    v_dot2c_f32_bf16 v128, s34, v62
    v_dot2c_f32_bf16 v129, v62, v62
    v_dot2c_f32_bf16 v128, s34, v63
    v_dot2c_f32_bf16 v129, v63, v63
    v_dot2c_f32_bf16 v128, s34, v64
    v_dot2c_f32_bf16 v129, v64, v64
    v_dot2c_f32_bf16 v128, s34, v65
    v_dot2c_f32_bf16 v129, v65, v65
    ds_write_b128 v4, v[104:107] offset:34816
    v_dot2c_f32_bf16 v128, s34, v66
    v_dot2c_f32_bf16 v129, v66, v66
    v_dot2c_f32_bf16 v128, s34, v67
    v_dot2c_f32_bf16 v129, v67, v67
    v_dot2c_f32_bf16 v128, s34, v68
    v_dot2c_f32_bf16 v129, v68, v68
    v_dot2c_f32_bf16 v128, s34, v69
    v_dot2c_f32_bf16 v129, v69, v69
    v_dot2c_f32_bf16 v128, s34, v70
    v_dot2c_f32_bf16 v129, v70, v70
    ds_write_b128 v4, v[108:111] offset:35840
    v_dot2c_f32_bf16 v128, s34, v71
    v_dot2c_f32_bf16 v129, v71, v71
    v_dot2c_f32_bf16 v128, s34, v72
    v_dot2c_f32_bf16 v129, v72, v72
    v_dot2c_f32_bf16 v128, s34, v73
    v_dot2c_f32_bf16 v129, v73, v73
    v_dot2c_f32_bf16 v128, s34, v74
    v_dot2c_f32_bf16 v129, v74, v74
    v_dot2c_f32_bf16 v128, s34, v75
    v_dot2c_f32_bf16 v129, v75, v75
    ds_write_b128 v4, v[112:115] offset:36864
    v_dot2c_f32_bf16 v128, s34, v76
    v_dot2c_f32_bf16 v129, v76, v76
    v_dot2c_f32_bf16 v128, s34, v77
    v_dot2c_f32_bf16 v129, v77, v77
    v_dot2c_f32_bf16 v128, s34, v78
    v_dot2c_f32_bf16 v129, v78, v78
    v_dot2c_f32_bf16 v128, s34, v79
    v_dot2c_f32_bf16 v129, v79, v79
    v_dot2c_f32_bf16 v128, s34, v80
    v_dot2c_f32_bf16 v129, v80, v80
    ds_write_b128 v4, v[116:119] offset:37888
    v_dot2c_f32_bf16 v128, s34, v81
    v_dot2c_f32_bf16 v129, v81, v81
    v_dot2c_f32_bf16 v128, s34, v82
    v_dot2c_f32_bf16 v129, v82, v82
    v_dot2c_f32_bf16 v128, s34, v83
    v_dot2c_f32_bf16 v129, v83, v83
    v_dot2c_f32_bf16 v128, s34, v84
    v_dot2c_f32_bf16 v129, v84, v84
    v_dot2c_f32_bf16 v128, s34, v85
    v_dot2c_f32_bf16 v129, v85, v85
    ds_write_b128 v4, v[120:123] offset:38912
    v_dot2c_f32_bf16 v128, s34, v86
    v_dot2c_f32_bf16 v129, v86, v86
    v_dot2c_f32_bf16 v128, s34, v87
    v_dot2c_f32_bf16 v129, v87, v87
    v_dot2c_f32_bf16 v128, s34, v88
    v_dot2c_f32_bf16 v129, v88, v88
    v_dot2c_f32_bf16 v128, s34, v89
    v_dot2c_f32_bf16 v129, v89, v89
    v_dot2c_f32_bf16 v128, s34, v90
    v_dot2c_f32_bf16 v129, v90, v90
    ds_write_b128 v4, v[124:127] offset:39936
    v_dot2c_f32_bf16 v128, s34, v91
    v_dot2c_f32_bf16 v129, v91, v91
    v_dot2c_f32_bf16 v128, s34, v92
    v_dot2c_f32_bf16 v129, v92, v92
    v_dot2c_f32_bf16 v128, s34, v93
    v_dot2c_f32_bf16 v129, v93, v93
    v_dot2c_f32_bf16 v128, s34, v94
    v_dot2c_f32_bf16 v129, v94, v94
    v_dot2c_f32_bf16 v128, s34, v95
    v_dot2c_f32_bf16 v129, v95, v95
    s_nop 2
    v_mov_b64 v[172:173], v[128:129]
    s_nop 1
    v_permlane32_swap_b32 v128, v172
    v_permlane32_swap_b32 v129, v173
    v_pk_add_f32 v[128:129], v[128:129], v[172:173]
    ds_write_b64 v5, v[128:129] offset:1024
    s_waitcnt lgkmcnt(0)
    s_barrier
    ds_read_b128 v[130:133], v6 offset:1024
    ds_read_b128 v[134:137], v6 offset:1040
    ds_read_b128 v[96:99], v3 offset:32768
    ds_read_b128 v[100:103], v3 offset:33792
    ds_read_b128 v[104:107], v3 offset:40960
    ds_read_b128 v[108:111], v3 offset:41984
    ds_read_b128 v[112:115], v3 offset:49152
    ds_read_b128 v[116:119], v3 offset:50176
    ds_read_b128 v[120:123], v3 offset:57344
    ds_read_b128 v[124:127], v3 offset:58368
    s_waitcnt lgkmcnt(9)
    v_pk_add_f32 v[130:131], v[130:131], v[132:133]
    s_waitcnt lgkmcnt(8)
    v_pk_add_f32 v[134:135], v[134:135], v[136:137]
    v_pk_add_f32 v[130:131], v[130:131], v[134:135]
    v_mul_f32 v130, 0x3acccccd, v130
    v_mul_f32 v131, 0x3acccccd, v131
    v_fma_f32 v131, -v130, v130, v131
    v_max_f32 v131, 0, v131
    v_add_f32 v131, 0x3727c5ac, v131
    v_rsq_f32 v131, v131
    s_nop 0
    ds_write2_b32 v9, v130, v131 offset0:0 offset1:32
    ds_read_b128 v[146:149], v10 offset:128
    ds_read_b128 v[150:153], v10 offset:144
    s_waitcnt lgkmcnt(8)
    v_pk_add_f32 v[96:97], v[96:97], v[104:105]
    v_pk_add_f32 v[98:99], v[98:99], v[106:107]
    s_waitcnt lgkmcnt(7)
    v_pk_add_f32 v[100:101], v[100:101], v[108:109]
    v_pk_add_f32 v[102:103], v[102:103], v[110:111]
    s_waitcnt lgkmcnt(6)
    v_pk_add_f32 v[96:97], v[96:97], v[112:113]
    v_pk_add_f32 v[98:99], v[98:99], v[114:115]
    s_waitcnt lgkmcnt(5)
    v_pk_add_f32 v[100:101], v[100:101], v[116:117]
    v_pk_add_f32 v[102:103], v[102:103], v[118:119]
    s_waitcnt lgkmcnt(4)
    v_pk_add_f32 v[96:97], v[96:97], v[120:121]
    v_pk_add_f32 v[98:99], v[98:99], v[122:123]
    s_waitcnt lgkmcnt(3)
    v_pk_add_f32 v[100:101], v[100:101], v[124:125]
    v_pk_add_f32 v[102:103], v[102:103], v[126:127]
    s_waitcnt lgkmcnt(1)
    v_mul_f32 v96, v96, v146
    v_mul_f32 v97, v97, v147
    v_mul_f32 v98, v98, v148
    v_mul_f32 v99, v99, v149
    s_waitcnt lgkmcnt(0)
    v_mul_f32 v100, v100, v150
    v_mul_f32 v101, v101, v151
    v_mul_f32 v102, v102, v152
    v_mul_f32 v103, v103, v153
    v_cvt_pk_bf16_f32 v172, v96, v97
    v_cvt_pk_bf16_f32 v173, v98, v99
    v_cvt_pk_bf16_f32 v174, v100, v101
    v_cvt_pk_bf16_f32 v175, v102, v103
    buffer_store_dwordx4 v[172:175], v7, s[4:7], s55 offen sc1
    s_add_u32 s44, s44, s47
    s_cmp_lt_u32 s44, 64
    s_cbranch_scc1 G_369
G_370:
    s_waitcnt vmcnt(0)
    s_barrier
    s_cmp_lg_u32 s29, 0
    s_cbranch_scc1 F_375
    s_lshl_b32 s32, s28, 5
    s_add_u32 s32, s32, s29
    s_lshl_b32 s32, s32, 2
    s_add_u32 s32, s32, 1073152
    v_mov_b32 v172, 2
    s_mov_b64 exec, 1
    buffer_store_dword v172, off, s[4:7], s32 sc1
    s_mov_b64 exec, -1
F_375:
R_368:
    s_sub_u32 s32, s28, 128
    s_cmp_lt_u32 s32, 32
    s_cbranch_scc1 R_376
    v_add_u32 v2, s60, v0
    ds_read_b128 a[160:163], v2 offset:0
    ds_read_b128 a[164:167], v2 offset:1024
    ds_read_b128 a[168:171], v2 offset:2048
    ds_read_b128 a[172:175], v2 offset:3072
    ds_read_b128 a[176:179], v2 offset:4096
    ds_read_b128 a[180:183], v2 offset:5120
    ds_read_b128 a[184:187], v2 offset:6144
    ds_read_b128 a[188:191], v2 offset:7168
    ds_read_b128 a[192:195], v2 offset:8192
    ds_read_b128 a[196:199], v2 offset:9216
    ds_read_b128 a[200:203], v2 offset:10240
    ds_read_b128 a[204:207], v2 offset:11264
    ds_read_b128 a[208:211], v2 offset:12288
    ds_read_b128 a[212:215], v2 offset:13312
    ds_read_b128 a[216:219], v2 offset:14336
    ds_read_b128 a[220:223], v2 offset:15360
    ds_read_b128 a[224:227], v2 offset:16384
    ds_read_b128 a[228:231], v2 offset:17408
    ds_read_b128 a[232:235], v2 offset:18432
    ds_read_b128 a[236:239], v2 offset:19456
    s_waitcnt lgkmcnt(0)
R_376:
    s_mov_b32 s30, 1
    s_mov_b32 s61, 64
    s_waitcnt vmcnt(0) lgkmcnt(0)
    s_branch LAYER_260

L_last:
s_endpgm
.section .rodata,"a"
.p2align 6
.amdhsa_kernel interleave_layers__spectral_gfnet__memory_aug_recurrent_mem_tr__prompt_kernel
  .amdhsa_next_free_vgpr 512
  .amdhsa_next_free_sgpr 102
  .amdhsa_accum_offset 256
  .amdhsa_group_segment_fixed_size 0
  .amdhsa_kernarg_size 104
  .amdhsa_user_sgpr_count 2
  .amdhsa_user_sgpr_kernarg_segment_ptr 1
  .amdhsa_system_sgpr_workgroup_id_x 1
  .amdhsa_float_denorm_mode_32 3
.end_amdhsa_kernel
```
